```python
import torch

def _softmax(x, axis=-1):
    return torch.softmax(x, dim=axis)
def _gelu(x):
    return torch.nn.functional.gelu(x, approximate="tanh")
def _silu(x):
    return torch.nn.functional.silu(x)
def _sigmoid(x):
    return torch.sigmoid(x)
def _layernorm(x, axis=-1, eps=1e-5):
    m = x.mean(dim=axis, keepdim=True)
    v = x.var(dim=axis, keepdim=True, unbiased=False)
    return (x - m) / torch.sqrt(v + eps)
def _scatter_add(tgt, idx, src, axis=0):
    return tgt.clone().index_add_(axis, idx, src)
def _segment_sum(src, seg, n):
    out = torch.zeros((n,) + src.shape[1:], dtype=src.dtype)
    return out.index_add_(0, seg, src)
def _pad(x, pw):
    flat = tuple(v for pair in reversed(pw) for v in pair)
    return torch.nn.functional.pad(x, flat)

kernel_name = 'parallel_sum__linear_attn_block__moe_arch_mod__prompt'

def setup_inputs():

    _w = (lambda a: (lambda t: t.to(torch.bfloat16) if t.is_floating_point() else t)(torch.as_tensor(a)))
    def _A_setup():
        B, S, D = 1, 2048, 1024
        return {
            "x": _w((lambda *s: torch.randn(*s, dtype=torch.bfloat16) * 0.05)(B, S, D)),
            "wqkv": _w((lambda *s: torch.randn(*s, dtype=torch.bfloat16) * 0.4)(D, 3 * D)),
            "wo": _w((lambda *s: torch.randn(*s, dtype=torch.bfloat16) * 0.2)(D, D)),
        }
    _A_in = _A_setup()

    def _B_setup():
        B, S, D, F, C = 1, 2048, 1024, 3584, 8
        return {
            "x": _w((lambda *s: torch.randn(*s, dtype=torch.bfloat16) * 0.05)(B, S, D)),
            "w_r": _w((lambda *s: torch.randn(*s, dtype=torch.bfloat16) * 0.05)(D)),
            "w_gate": _w((lambda *s: torch.randn(*s, dtype=torch.bfloat16) * 0.05)(D, F)),
            "w_up": _w((lambda *s: torch.randn(*s, dtype=torch.bfloat16) * 0.05)(D, F)),
            "w_down": _w((lambda *s: torch.randn(*s, dtype=torch.bfloat16) * 0.05)(F, D)),
        }
    _B_in = _B_setup()

    return {
        "A_x": _A_in["x"],
        "A_wqkv": _A_in["wqkv"],
        "A_wo": _A_in["wo"],
        "B_x": _B_in["x"],
        "B_w_r": _B_in["w_r"],
        "B_w_gate": _B_in["w_gate"],
        "B_w_up": _B_in["w_up"],
        "B_w_down": _B_in["w_down"],
    }

def reference(A_x, A_wqkv, A_wo, B_x, B_w_r, B_w_gate, B_w_up, B_w_down):
    def _A_ref(x, wqkv, wo):
        B, S, D = x.shape
        H = 32; Dh = D // H
        qkv = (lambda x, *d: x.permute(*d))((x @ wqkv).reshape(B, S, 3, H, Dh), 2, 0, 3, 1, 4)
        q, k, v = qkv[0], qkv[1], qkv[2]
        phi = lambda t: torch.where(t > 0, t + 1, torch.exp(t)) + 1e-6
        pq, pk = phi(q), phi(k)
        kv = torch.einsum("bhsd,bhse->bhde", pk, v)
        z = torch.einsum("bhsd->bhd", pk)
        num = torch.einsum("bhqd,bhde->bhqe", pq, kv)
        den = torch.einsum("bhqd,bhd->bhq", pq, z)[..., None] + 1e-6
        o = num / den
        return (lambda x, *d: x.permute(*d))(o, 0, 2, 1, 3).reshape(B, S, D) @ wo

    def _B_ref(x, w_r, w_gate, w_up, w_down):
        B, S, D = x.shape
        C = 8
        r = x @ w_r
        idx = torch.argsort(-r, axis=-1)[:, :C]
        idx_e = (lambda x, n, axis: torch.repeat_interleave(x, n, dim=axis))(idx.reshape(B, C, 1), D, axis=2)
        x_sel = (lambda x, i, axis: torch.take_along_dim(x, i, dim=axis))(x, idx_e, axis=1)
        g = _silu(x_sel @ w_gate)
        u = x_sel @ w_up
        y = (g * u) @ w_down
        r_sel = _sigmoid((lambda x, i, axis: torch.take_along_dim(x, i, dim=axis))(r, idx, axis=1))
        y = y * r_sel.reshape(B, C, 1)
        b_off = (torch.arange(B) * S).reshape(B, 1)
        flat_idx = (idx + b_off).reshape(B * C)
        zero = (x * 0.0).reshape(B * S, D)
        upd = _scatter_add(zero, flat_idx, y.reshape(B * C, D), axis=0)
        return x + upd.reshape(B, S, D)

    x = A_x
    xn = _layernorm(x, axis=-1)
    return x + _A_ref(xn, A_wqkv, A_wo) + _B_ref(xn, B_w_r, B_w_gate, B_w_up, B_w_down)
```

```asm
; @launch grid=(256,1,1) block=(768,1,1) lds=163840
.amdgcn_target "amdgcn-amd-amdhsa--gfx950"
.text
.globl parallel_sum__linear_attn_block__moe_arch_mod__prompt_kernel
.p2align 12
.p2align 8
.type parallel_sum__linear_attn_block__moe_arch_mod__prompt_kernel,@function
parallel_sum__linear_attn_block__moe_arch_mod__prompt_kernel:
    s_load_dwordx4 s[4:7], s[0:1], 0
    s_load_dwordx2 s[8:9], s[0:1], 16
    s_load_dwordx8 s[60:67], s[0:1], 32
    s_load_dwordx4 s[68:71], s[0:1], 64
    s_load_dwordx2 s[72:73], s[0:1], 80
    s_cmp_ge_u32 s2, 256
    s_cbranch_scc1 F_end
    v_lshrrev_b32 v1, 6, v0
    v_and_b32 v0, 63, v0
    s_and_b32 s30, s2, 7
    v_readfirstlane_b32 s3, v1
    s_lshr_b32 s31, s2, 3
    s_and_b32 s36, s30, 1
    s_lshl_b32 s32, s36, 3
    s_and_b32 s35, s31, 7
    s_add_u32 s32, s32, s35
    s_lshr_b32 s37, s30, 1
    s_lshl_b32 s33, s37, 2
    s_lshr_b32 s34, s31, 3
    s_add_u32 s33, s33, s34
    s_add_u32 s10, s33, 4
    s_and_b32 s10, s10, 15
    s_add_u32 s11, s35, s34
    s_and_b32 s11, s11, 3
    s_and_b32 s28, s32, 11
    s_and_b32 s29, s37, 1
    s_lshl_b32 s29, s29, 2
    s_add_u32 s28, s28, s29
    s_lshr_b32 s29, s37, 1
    s_lshl_b32 s29, s29, 3
    s_and_b32 s38, s35, 4
    s_add_u32 s29, s29, s38
    s_add_u32 s38, s34, 1
    s_and_b32 s38, s38, 3
    s_add_u32 s29, s29, s38

    s_lshl_b32 s11, s34, 1
    s_add_u32 s11, s11, s35
    s_and_b32 s11, s11, 7
    s_mul_i32 s89, s36, 8
    s_mul_i32 s38, s37, 2
    s_add_u32 s89, s89, s38

    s_mov_b32 s94, 0x53176420
    s_mov_b32 s95, 0xdb9fca8e
    s_cmp_eq_u32 s11, 1
    s_cselect_b32 s94, 0x42067531, s94
    s_cselect_b32 s95, 0xca8edb9f, s95
    s_cmp_eq_u32 s11, 2
    s_cselect_b32 s94, 0x53806412, s94
    s_cselect_b32 s95, 0xfdbeca97, s95
    s_cmp_eq_u32 s11, 3
    s_cselect_b32 s94, 0x42917503, s94
    s_cselect_b32 s95, 0xecafdb86, s95
    s_cmp_eq_u32 s11, 4
    s_cselect_b32 s94, 0x5a120364, s94
    s_cselect_b32 s95, 0xfd9ecb87, s95
    s_cmp_eq_u32 s11, 5
    s_cselect_b32 s94, 0x4b031275, s94
    s_cselect_b32 s95, 0xec8fda96, s95
    s_cmp_eq_u32 s11, 6
    s_cselect_b32 s94, 0xc3145206, s94
    s_cselect_b32 s95, 0xfb9eda87, s95
    s_cmp_eq_u32 s11, 7
    s_cselect_b32 s94, 0xd2054317, s94
    s_cselect_b32 s95, 0xea8fcb96, s95
    s_cmp_ge_u32 s3, 8
    s_cbranch_scc1 F_aux
    s_cmp_ge_u32 s3, 4
    s_cbranch_scc1 F_nl
    v_lshrrev_b32 v2, 3, v0
    v_and_b32 v3, 7, v0
    v_lshrrev_b32 v4, 1, v2
    v_xor_b32 v5, v3, v4
    v_xor_b32 v6, 4, v5
    v_lshlrev_b32 v5, 4, v5
    v_lshlrev_b32 v6, 4, v6
    v_lshlrev_b32 v7, 11, v2
    v_add_u32 v5, v5, v7
    v_add_u32 v6, v6, v7
    v_and_b32 v4, 1, v4
    v_lshlrev_b32 v4, 1, v4
    v_xor_b32 v8, v3, v4
    v_xor_b32 v9, 4, v8
    v_lshlrev_b32 v8, 4, v8
    v_lshlrev_b32 v9, 4, v9
    v_mul_u32_u24 v7, 6144, v2
    v_add_u32 v8, v8, v7
    v_add_u32 v9, v9, v7
    v_add_u32 v9, 49152, v9
    s_lshl_b32 s36, s32, 18
    s_lshl_b32 s37, s3, 16
    s_add_u32 s36, s36, s37
    s_lshl_b32 s38, s33, 7
    s_mul_i32 s37, s3, 98304
    s_add_u32 s38, s38, s37
    s_lshl_b32 s47, s10, 7
    s_add_u32 s47, s47, s37
    s_lshl_b32 s44, s3, 12
    s_lshl_b32 s45, s3, 11
    s_add_u32 s43, s45, 1024
    s_mov_b32 s14, 4194304
    s_mov_b32 s15, 0x20000
    s_mov_b32 s18, 6291456
    s_mov_b32 s19, 0x20000
    s_waitcnt lgkmcnt(0)
    s_mov_b32 s12, s4
    s_mov_b32 s13, s5
    s_mov_b32 s16, s6
    s_mov_b32 s17, s7

    s_setprio 3
    s_bfe_u32 s40, s94, 0x40000
    s_add_u32 s40, s89, s40
    s_and_b32 s40, s40, 15
    s_mul_i32 s41, s40, 393216
    s_lshl_b32 s40, s40, 7
    s_add_u32 s40, s40, s36
    s_add_u32 s42, s41, s47
    s_add_u32 s41, s41, s38
    s_add_u32 m0, s44, 0
    s_add_u32 s46, s40, 0
    s_nop 0
    buffer_load_dwordx4 v5, s[12:15], s46 offen lds
    s_add_u32 m0, s44, 1024
    s_add_u32 s46, s40, 16384
    buffer_load_dwordx4 v6, s[12:15], s46 offen lds
    s_add_u32 m0, s44, 2048
    s_add_u32 s46, s40, 32768
    buffer_load_dwordx4 v5, s[12:15], s46 offen lds
    s_add_u32 m0, s44, 3072
    s_add_u32 s46, s40, 49152
    buffer_load_dwordx4 v6, s[12:15], s46 offen lds
    s_add_u32 m0, s45, 65536
    s_add_u32 s46, s41, 2048
    buffer_load_dwordx4 v8, s[16:19], s46 offen lds
    s_add_u32 m0, s43, 65536
    s_add_u32 s46, s41, 2048
    buffer_load_dwordx4 v9, s[16:19], s46 offen lds
    s_add_u32 m0, s45, 73728
    s_add_u32 s46, s41, 4096
    buffer_load_dwordx4 v8, s[16:19], s46 offen lds
    s_add_u32 m0, s43, 73728
    s_add_u32 s46, s41, 4096
    buffer_load_dwordx4 v9, s[16:19], s46 offen lds
    s_lshl_b32 s51, s32, 4
    s_add_u32 s51, s51, s33
    s_lshl_b32 s51, s51, 14
    s_add_u32 s51, s51, s45
    v_lshlrev_b32 v165, 4, v0
    s_mov_b32 s20, s60
    s_mov_b32 s21, s61
    s_mov_b32 s22, 0x800
    s_mov_b32 s23, 0x00020000
    s_add_u32 m0, s45, 81920
    s_add_u32 s46, s51, 0
    buffer_load_dwordx4 v165, s[12:15], s46 offen lds
    s_add_u32 m0, s45, 82944
    s_add_u32 s46, s51, 1024
    buffer_load_dwordx4 v165, s[12:15], s46 offen lds
    s_and_b32 s46, s3, 1
    s_lshl_b32 s46, s46, 10
    s_add_u32 m0, s46, 161792
    s_nop 0
    s_nop 0
    buffer_load_dwordx4 v165, s[20:23], s46 offen lds
    s_add_u32 m0, s45, 90112
    s_add_u32 s46, s51, 8192
    buffer_load_dwordx4 v165, s[12:15], s46 offen lds
    s_add_u32 m0, s45, 91136
    s_add_u32 s46, s51, 9216
    buffer_load_dwordx4 v165, s[12:15], s46 offen lds
    s_add_u32 m0, s45, 147456
    s_nop 0
    buffer_load_dwordx4 v8, s[16:19], s42 offen lds
    s_add_u32 m0, s43, 147456
    s_nop 0
    buffer_load_dwordx4 v9, s[16:19], s42 offen lds
    v_and_b32 v1, 15, v0
    v_lshrrev_b32 v7, 4, v0
    v_lshrrev_b32 v3, 1, v1
    v_xor_b32 v3, v3, v7
    v_lshlrev_b32 v3, 4, v3
    v_lshlrev_b32 v1, 7, v1
    v_add3_u32 v2, v1, v3, s44
    v_xor_b32 v3, 64, v2
    v_add_u32 v14, 0x10000, v2
    v_add_u32 v15, 0x10000, v3
    v_bfe_u32 v1, v0, 2, 2
    v_lshl_add_u32 v4, v7, 3, v1
    v_lshrrev_b32 v1, 1, v1
    v_and_b32 v7, 1, v7
    v_lshl_add_u32 v1, v7, 1, v1
    v_lshlrev_b32 v1, 5, v1
    v_lshl_add_u32 v1, v4, 7, v1
    v_and_b32 v7, 3, v0
    v_lshl_add_u32 v1, v7, 3, v1
    v_add_u32 v10, 90112, v1
    v_xor_b32 v11, 32, v10
    v_xor_b32 v12, 64, v10
    v_xor_b32 v13, 96, v10
    v_lshlrev_b32 v1, 2, v7
    v_add_u32 v1, 159040, v1
    s_lshl_b32 s50, s3, 2
    s_add_u32 s50, s50, 159040
    v_mov_b32 v4, s50
    v_mov_b32 v164, 1

    s_waitcnt vmcnt(7)
    s_barrier
    s_bfe_u32 s40, s94, 0x40004
    s_add_u32 s40, s89, s40
    s_and_b32 s40, s40, 15
    s_mul_i32 s41, s40, 393216
    s_lshl_b32 s40, s40, 7
    s_add_u32 s40, s40, s36
    s_add_u32 s42, s41, s47
    s_add_u32 s41, s41, s38
    s_add_u32 m0, s44, 16384
    s_add_u32 s46, s40, 0
    buffer_load_dwordx4 v5, s[12:15], s46 offen lds
    ds_read_b128 v[48:51], v2 offset:0
    s_add_u32 m0, s44, 17408
    s_add_u32 s46, s40, 16384
    buffer_load_dwordx4 v6, s[12:15], s46 offen lds
    ds_read_b128 v[52:55], v2 offset:2048
    s_add_u32 m0, s44, 18432
    s_add_u32 s46, s40, 32768
    buffer_load_dwordx4 v5, s[12:15], s46 offen lds
    ds_read_b128 v[56:59], v3 offset:0
    s_add_u32 m0, s44, 19456
    s_add_u32 s46, s40, 49152
    buffer_load_dwordx4 v6, s[12:15], s46 offen lds
    ds_read_b128 v[60:63], v3 offset:2048
    s_add_u32 m0, s45, 98304
    s_add_u32 s46, s41, 2048
    buffer_load_dwordx4 v8, s[16:19], s46 offen lds
    s_add_u32 m0, s43, 98304
    s_add_u32 s46, s41, 2048
    buffer_load_dwordx4 v9, s[16:19], s46 offen lds
    s_add_u32 m0, s45, 106496
    s_add_u32 s46, s41, 4096
    buffer_load_dwordx4 v8, s[16:19], s46 offen lds
    s_add_u32 m0, s43, 106496
    s_add_u32 s46, s41, 4096
    buffer_load_dwordx4 v9, s[16:19], s46 offen lds
    s_bfe_u32 s40, s94, 0x40008
    s_add_u32 s40, s89, s40
    s_and_b32 s40, s40, 15
    s_mul_i32 s41, s40, 393216
    s_lshl_b32 s40, s40, 7
    s_add_u32 s40, s40, s36
    s_add_u32 s42, s41, s47
    s_add_u32 s41, s41, s38
    s_add_u32 m0, s44, 32768
    s_add_u32 s46, s40, 0
    buffer_load_dwordx4 v5, s[12:15], s46 offen lds
    s_add_u32 m0, s44, 33792
    s_add_u32 s46, s40, 16384
    buffer_load_dwordx4 v6, s[12:15], s46 offen lds
    s_add_u32 m0, s44, 34816
    s_add_u32 s46, s40, 32768
    buffer_load_dwordx4 v5, s[12:15], s46 offen lds
    s_waitcnt vmcnt(3) lgkmcnt(0)
    s_barrier
    s_nop 0
    s_add_u32 m0, s44, 35840
    s_add_u32 s46, s40, 49152
    buffer_load_dwordx4 v6, s[12:15], s46 offen lds
    ds_read_b64_tr_b16 v[64:65], v10 offset:57344
    ds_read_b64_tr_b16 v[66:67], v10 offset:57856
    s_add_u32 m0, s45, 114688
    s_add_u32 s46, s41, 2048
    buffer_load_dwordx4 v8, s[16:19], s46 offen lds
    ds_read_b128 v[68:71], v2 offset:16384
    s_add_u32 m0, s43, 114688
    s_add_u32 s46, s41, 2048
    buffer_load_dwordx4 v9, s[16:19], s46 offen lds
    ds_read_b64_tr_b16 v[72:73], v11 offset:57344
    ds_read_b64_tr_b16 v[74:75], v11 offset:57856
    s_add_u32 m0, s45, 122880
    s_add_u32 s46, s41, 4096
    buffer_load_dwordx4 v8, s[16:19], s46 offen lds
    ds_read_b128 v[76:79], v2 offset:18432
    s_add_u32 m0, s43, 122880
    s_add_u32 s46, s41, 4096
    buffer_load_dwordx4 v9, s[16:19], s46 offen lds
    ds_read_b64_tr_b16 v[80:81], v12 offset:57344
    ds_read_b64_tr_b16 v[82:83], v12 offset:57856
    s_bfe_u32 s40, s94, 0x40004
    s_add_u32 s40, s89, s40
    s_and_b32 s40, s40, 15
    s_mul_i32 s41, s40, 393216
    s_lshl_b32 s40, s40, 7
    s_add_u32 s40, s40, s36
    s_add_u32 s42, s41, s47
    s_add_u32 s41, s41, s38
    s_add_u32 m0, s45, 139264
    s_nop 0
    buffer_load_dwordx4 v8, s[16:19], s42 offen lds
    ds_read_b128 v[84:87], v3 offset:16384
    s_add_u32 m0, s43, 139264
    s_nop 0
    buffer_load_dwordx4 v9, s[16:19], s42 offen lds
    ds_read_b64_tr_b16 v[88:89], v13 offset:57344
    ds_read_b64_tr_b16 v[90:91], v13 offset:57856
    s_bfe_u32 s40, s94, 0x4000c
    s_add_u32 s40, s89, s40
    s_and_b32 s40, s40, 15
    s_mul_i32 s41, s40, 393216
    s_lshl_b32 s40, s40, 7
    s_add_u32 s40, s40, s36
    s_add_u32 s42, s41, s47
    s_add_u32 s41, s41, s38
    s_add_u32 m0, s44, 49152
    s_add_u32 s46, s40, 0
    s_nop 0
    buffer_load_dwordx4 v5, s[12:15], s46 offen lds
    ds_read_b128 v[92:95], v3 offset:18432
    s_add_u32 m0, s44, 50176
    s_add_u32 s46, s40, 16384
    buffer_load_dwordx4 v6, s[12:15], s46 offen lds
    s_add_u32 m0, s44, 51200
    s_add_u32 s46, s40, 32768
    buffer_load_dwordx4 v5, s[12:15], s46 offen lds
    s_add_u32 m0, s44, 52224
    s_add_u32 s46, s40, 49152
    buffer_load_dwordx4 v6, s[12:15], s46 offen lds
    s_waitcnt vmcnt(4) lgkmcnt(0)
    s_barrier
    s_add_u32 m0, s45, 131072
    s_add_u32 s46, s41, 2048
    buffer_load_dwordx4 v8, s[16:19], s46 offen lds
    v_mfma_f32_16x16x32_bf16 v[16:19], v[64:67], v[48:51], 0
    ds_read_b64_tr_b16 v[96:97], v10 offset:61440
    ds_read_b64_tr_b16 v[98:99], v10 offset:61952
    s_add_u32 m0, s43, 131072
    s_add_u32 s46, s41, 2048
    buffer_load_dwordx4 v9, s[16:19], s46 offen lds
    v_mfma_f32_16x16x32_bf16 v[32:35], v[64:67], v[52:55], 0
    ds_read_b128 v[100:103], v2 offset:32768
    s_add_u32 m0, s45, 65536
    s_add_u32 s46, s41, 4096
    buffer_load_dwordx4 v8, s[16:19], s46 offen lds
    v_mfma_f32_16x16x32_bf16 v[20:23], v[72:75], v[48:51], 0
    ds_read_b64_tr_b16 v[104:105], v11 offset:61440
    ds_read_b64_tr_b16 v[106:107], v11 offset:61952
    s_add_u32 m0, s43, 65536
    s_add_u32 s46, s41, 4096
    buffer_load_dwordx4 v9, s[16:19], s46 offen lds
    v_mfma_f32_16x16x32_bf16 v[36:39], v[72:75], v[52:55], 0
    ds_read_b128 v[108:111], v2 offset:34816
    s_bfe_u32 s40, s94, 0x40008
    s_add_u32 s40, s89, s40
    s_and_b32 s40, s40, 15
    s_mul_i32 s41, s40, 393216
    s_lshl_b32 s40, s40, 7
    s_add_u32 s40, s40, s36
    s_add_u32 s42, s41, s47
    s_add_u32 s41, s41, s38
    s_add_u32 m0, s45, 106496
    s_nop 0
    buffer_load_dwordx4 v8, s[16:19], s42 offen lds
    v_mfma_f32_16x16x32_bf16 v[24:27], v[80:83], v[48:51], 0
    ds_read_b64_tr_b16 v[112:113], v12 offset:61440
    ds_read_b64_tr_b16 v[114:115], v12 offset:61952
    s_add_u32 m0, s43, 106496
    s_nop 0
    buffer_load_dwordx4 v9, s[16:19], s42 offen lds
    v_mfma_f32_16x16x32_bf16 v[40:43], v[80:83], v[52:55], 0
    ds_read_b128 v[116:119], v3 offset:32768
    s_bfe_u32 s40, s94, 0x40010
    s_add_u32 s40, s89, s40
    s_and_b32 s40, s40, 15
    s_mul_i32 s41, s40, 393216
    s_lshl_b32 s40, s40, 7
    s_add_u32 s40, s40, s36
    s_add_u32 s42, s41, s47
    s_add_u32 s41, s41, s38
    s_add_u32 m0, s44, 0
    s_add_u32 s46, s40, 0
    buffer_load_dwordx4 v5, s[12:15], s46 offen lds
    v_mfma_f32_16x16x32_bf16 v[28:31], v[88:91], v[48:51], 0
    ds_read_b64_tr_b16 v[120:121], v13 offset:61440
    ds_read_b64_tr_b16 v[122:123], v13 offset:61952
    s_add_u32 m0, s44, 1024
    s_add_u32 s46, s40, 16384
    buffer_load_dwordx4 v6, s[12:15], s46 offen lds
    v_mfma_f32_16x16x32_bf16 v[44:47], v[88:91], v[52:55], 0
    ds_read_b128 v[124:127], v3 offset:34816
    s_add_u32 m0, s44, 2048
    s_add_u32 s46, s40, 32768
    buffer_load_dwordx4 v5, s[12:15], s46 offen lds
    ds_read_b64_tr_b16 v[128:129], v10 offset:49152
    ds_read_b64_tr_b16 v[130:131], v10 offset:49664
    s_add_u32 m0, s44, 3072
    s_add_u32 s46, s40, 49152
    buffer_load_dwordx4 v6, s[12:15], s46 offen lds
    ds_read_b64_tr_b16 v[132:133], v11 offset:49152
    s_waitcnt lgkmcnt(8)
    s_nop 0
    ds_read_b64_tr_b16 v[134:135], v11 offset:49664
    s_add_u32 m0, s45, 73728
    s_add_u32 s46, s41, 2048
    buffer_load_dwordx4 v8, s[16:19], s46 offen lds
    ds_read_b64_tr_b16 v[136:137], v12 offset:49152
    ds_read_b64_tr_b16 v[138:139], v12 offset:49664
    ds_read_b64_tr_b16 v[140:141], v13 offset:49152
    ds_read_b64_tr_b16 v[142:143], v13 offset:49664
    s_waitcnt vmcnt(5) lgkmcnt(0)
    s_barrier
    s_add_u32 m0, s43, 73728
    s_add_u32 s46, s41, 2048
    buffer_load_dwordx4 v9, s[16:19], s46 offen lds
    v_mfma_f32_16x16x32_bf16 v[16:19], v[96:99], v[56:59], v[16:19]
    ds_read_b64_tr_b16 v[144:145], v10 offset:53248
    ds_read_b64_tr_b16 v[146:147], v10 offset:53760
    s_add_u32 m0, s45, 81920
    s_add_u32 s46, s41, 4096
    buffer_load_dwordx4 v8, s[16:19], s46 offen lds
    v_mfma_f32_16x16x32_bf16 v[32:35], v[96:99], v[60:63], v[32:35]
    ds_read_b128 v[148:151], v2 offset:49152
    s_add_u32 m0, s43, 81920
    s_add_u32 s46, s41, 4096
    buffer_load_dwordx4 v9, s[16:19], s46 offen lds
    v_mfma_f32_16x16x32_bf16 v[20:23], v[104:107], v[56:59], v[20:23]
    ds_read_b64_tr_b16 v[152:153], v11 offset:53248
    ds_read_b64_tr_b16 v[154:155], v11 offset:53760
    s_bfe_u32 s40, s94, 0x40014
    s_add_u32 s40, s89, s40
    s_and_b32 s40, s40, 15
    s_mul_i32 s41, s40, 393216
    s_lshl_b32 s40, s40, 7
    s_add_u32 s40, s40, s36
    s_add_u32 s42, s41, s47
    s_add_u32 s41, s41, s38
    s_add_u32 m0, s44, 16384
    s_add_u32 s46, s40, 0
    s_nop 0
    buffer_load_dwordx4 v5, s[12:15], s46 offen lds
    v_mfma_f32_16x16x32_bf16 v[36:39], v[104:107], v[60:63], v[36:39]
    ds_read_b128 v[156:159], v2 offset:51200
    s_add_u32 m0, s44, 17408
    s_add_u32 s46, s40, 16384
    buffer_load_dwordx4 v6, s[12:15], s46 offen lds
    v_mfma_f32_16x16x32_bf16 v[24:27], v[112:115], v[56:59], v[24:27]
    ds_read_b64_tr_b16 v[160:161], v12 offset:53248
    ds_read_b64_tr_b16 v[162:163], v12 offset:53760
    s_add_u32 m0, s44, 18432
    s_add_u32 s46, s40, 32768
    buffer_load_dwordx4 v5, s[12:15], s46 offen lds
    v_mfma_f32_16x16x32_bf16 v[40:43], v[112:115], v[60:63], v[40:43]
    ds_read_b128 v[64:67], v3 offset:49152
    s_add_u32 m0, s44, 19456
    s_add_u32 s46, s40, 49152
    buffer_load_dwordx4 v6, s[12:15], s46 offen lds
    v_mfma_f32_16x16x32_bf16 v[28:31], v[120:123], v[56:59], v[28:31]
    ds_read_b64_tr_b16 v[72:73], v13 offset:53248
    ds_read_b64_tr_b16 v[74:75], v13 offset:53760
    s_add_u32 m0, s45, 90112
    s_add_u32 s46, s41, 2048
    buffer_load_dwordx4 v8, s[16:19], s46 offen lds
    v_mfma_f32_16x16x32_bf16 v[44:47], v[120:123], v[60:63], v[44:47]
    ds_read_b128 v[80:83], v3 offset:51200
    s_add_u32 m0, s43, 90112
    s_add_u32 s46, s41, 2048
    buffer_load_dwordx4 v9, s[16:19], s46 offen lds
    v_mfma_f32_16x16x32_bf16 v[16:19], v[128:131], v[68:71], v[16:19]
    ds_read_b64_tr_b16 v[48:49], v10 offset:16384
    ds_read_b64_tr_b16 v[50:51], v10 offset:16896
    s_add_u32 m0, s45, 98304
    s_add_u32 s46, s41, 4096
    buffer_load_dwordx4 v8, s[16:19], s46 offen lds
    v_mfma_f32_16x16x32_bf16 v[32:35], v[128:131], v[76:79], v[32:35]
    ds_read_b64_tr_b16 v[88:89], v11 offset:16384
    s_waitcnt lgkmcnt(8)
    s_nop 0
    ds_read_b64_tr_b16 v[90:91], v11 offset:16896
    s_add_u32 m0, s43, 98304
    s_add_u32 s46, s41, 4096
    buffer_load_dwordx4 v9, s[16:19], s46 offen lds
    v_mfma_f32_16x16x32_bf16 v[20:23], v[132:135], v[68:71], v[20:23]
    ds_read_b64_tr_b16 v[52:53], v12 offset:16384
    ds_read_b64_tr_b16 v[54:55], v12 offset:16896
    v_mfma_f32_16x16x32_bf16 v[36:39], v[132:135], v[76:79], v[36:39]
    ds_read_b64_tr_b16 v[96:97], v13 offset:16384
    ds_read_b64_tr_b16 v[98:99], v13 offset:16896
    v_mfma_f32_16x16x32_bf16 v[24:27], v[136:139], v[68:71], v[24:27]
    v_mfma_f32_16x16x32_bf16 v[40:43], v[136:139], v[76:79], v[40:43]
    v_mfma_f32_16x16x32_bf16 v[28:31], v[140:143], v[68:71], v[28:31]
    v_mfma_f32_16x16x32_bf16 v[44:47], v[140:143], v[76:79], v[44:47]
    s_waitcnt vmcnt(8) lgkmcnt(0)
    s_barrier
    s_bfe_u32 s40, s94, 0x4000c
    s_add_u32 s40, s89, s40
    s_and_b32 s40, s40, 15
    s_mul_i32 s41, s40, 393216
    s_lshl_b32 s40, s40, 7
    s_add_u32 s40, s40, s36
    s_add_u32 s42, s41, s47
    s_add_u32 s41, s41, s38
    s_add_u32 m0, s45, 147456
    s_nop 0
    buffer_load_dwordx4 v8, s[16:19], s42 offen lds
    v_mfma_f32_16x16x32_bf16 v[16:19], v[144:147], v[84:87], v[16:19]
    ds_read_b64_tr_b16 v[104:105], v10 offset:20480
    ds_read_b64_tr_b16 v[106:107], v10 offset:20992
    s_add_u32 m0, s43, 147456
    s_nop 0
    buffer_load_dwordx4 v9, s[16:19], s42 offen lds
    v_mfma_f32_16x16x32_bf16 v[32:35], v[144:147], v[92:95], v[32:35]
    ds_read_b128 v[112:115], v2 offset:0
    s_bfe_u32 s40, s94, 0x40018
    s_add_u32 s40, s89, s40
    s_and_b32 s40, s40, 15
    s_mul_i32 s41, s40, 393216
    s_lshl_b32 s40, s40, 7
    s_add_u32 s40, s40, s36
    s_add_u32 s42, s41, s47
    s_add_u32 s41, s41, s38
    s_add_u32 m0, s44, 32768
    s_branch IW_s0
IW_w0:
    s_branch IW_r0
IW_s0:
    s_add_u32 s46, s40, 0
    s_nop 0
    buffer_load_dwordx4 v5, s[12:15], s46 offen lds
    v_mfma_f32_16x16x32_bf16 v[20:23], v[152:155], v[84:87], v[20:23]
    ds_read_b64_tr_b16 v[56:57], v11 offset:20480
    ds_read_b64_tr_b16 v[58:59], v11 offset:20992
    s_add_u32 m0, s44, 33792
    s_add_u32 s46, s40, 16384
    buffer_load_dwordx4 v6, s[12:15], s46 offen lds
    v_mfma_f32_16x16x32_bf16 v[36:39], v[152:155], v[92:95], v[36:39]
    ds_read_b128 v[120:123], v2 offset:2048
    s_add_u32 m0, s44, 34816
    s_add_u32 s46, s40, 32768
    buffer_load_dwordx4 v5, s[12:15], s46 offen lds
    v_mfma_f32_16x16x32_bf16 v[24:27], v[160:163], v[84:87], v[24:27]
    ds_read_b64_tr_b16 v[60:61], v12 offset:20480
    ds_read_b64_tr_b16 v[62:63], v12 offset:20992
    s_add_u32 m0, s44, 35840
    s_add_u32 s46, s40, 49152
    buffer_load_dwordx4 v6, s[12:15], s46 offen lds
    v_mfma_f32_16x16x32_bf16 v[40:43], v[160:163], v[92:95], v[40:43]
    ds_read_b128 v[128:131], v3 offset:0
    s_add_u32 m0, s45, 114688
    s_add_u32 s46, s41, 2048
    buffer_load_dwordx4 v8, s[16:19], s46 offen lds
    v_mfma_f32_16x16x32_bf16 v[28:31], v[72:75], v[84:87], v[28:31]
    ds_read_b64_tr_b16 v[132:133], v13 offset:20480
    ds_read_b64_tr_b16 v[134:135], v13 offset:20992
    s_add_u32 m0, s43, 114688
    s_add_u32 s46, s41, 2048
    buffer_load_dwordx4 v9, s[16:19], s46 offen lds
    v_mfma_f32_16x16x32_bf16 v[44:47], v[72:75], v[92:95], v[44:47]
    ds_read_b128 v[136:139], v3 offset:2048
    s_add_u32 m0, s45, 122880
    s_add_u32 s46, s41, 4096
    buffer_load_dwordx4 v8, s[16:19], s46 offen lds
    v_mfma_f32_16x16x32_bf16 v[16:19], v[48:51], v[100:103], v[16:19]
    s_add_u32 m0, s43, 122880
    s_add_u32 s46, s41, 4096
    buffer_load_dwordx4 v9, s[16:19], s46 offen lds
    v_mfma_f32_16x16x32_bf16 v[32:35], v[48:51], v[108:111], v[32:35]
    s_bfe_u32 s40, s94, 0x4001c
    s_add_u32 s40, s89, s40
    s_and_b32 s40, s40, 15
    s_mul_i32 s41, s40, 393216
    s_lshl_b32 s40, s40, 7
    s_add_u32 s40, s40, s36
    s_add_u32 s42, s41, s47
    s_add_u32 s41, s41, s38
    s_add_u32 m0, s44, 49152
    s_add_u32 s46, s40, 0
    buffer_load_dwordx4 v5, s[12:15], s46 offen lds
    v_mfma_f32_16x16x32_bf16 v[20:23], v[88:91], v[100:103], v[20:23]
    v_mfma_f32_16x16x32_bf16 v[36:39], v[88:91], v[108:111], v[36:39]
    v_mfma_f32_16x16x32_bf16 v[24:27], v[52:55], v[100:103], v[24:27]
    v_mfma_f32_16x16x32_bf16 v[40:43], v[52:55], v[108:111], v[40:43]
    v_mfma_f32_16x16x32_bf16 v[28:31], v[96:99], v[100:103], v[28:31]
    v_mfma_f32_16x16x32_bf16 v[44:47], v[96:99], v[108:111], v[44:47]
    s_waitcnt vmcnt(9) lgkmcnt(0)
    s_barrier
    s_nop 0
    s_add_u32 m0, s44, 50176
    s_add_u32 s46, s40, 16384
    buffer_load_dwordx4 v6, s[12:15], s46 offen lds
    v_mfma_f32_16x16x32_bf16 v[16:19], v[104:107], v[116:119], v[16:19]
    ds_read_b64_tr_b16 v[68:69], v10 offset:57344
    ds_read_b64_tr_b16 v[70:71], v10 offset:57856
    s_add_u32 m0, s44, 51200
    s_add_u32 s46, s40, 32768
    buffer_load_dwordx4 v5, s[12:15], s46 offen lds
    v_mfma_f32_16x16x32_bf16 v[32:35], v[104:107], v[124:127], v[32:35]
    ds_read_b128 v[140:143], v2 offset:16384
    s_add_u32 m0, s44, 52224
    s_add_u32 s46, s40, 49152
    buffer_load_dwordx4 v6, s[12:15], s46 offen lds
    v_mfma_f32_16x16x32_bf16 v[20:23], v[56:59], v[116:119], v[20:23]
    ds_read_b64_tr_b16 v[76:77], v11 offset:57344
    ds_read_b64_tr_b16 v[78:79], v11 offset:57856
    s_add_u32 m0, s45, 65536
    s_add_u32 s46, s41, 2048
    buffer_load_dwordx4 v8, s[16:19], s46 offen lds
    v_mfma_f32_16x16x32_bf16 v[36:39], v[56:59], v[124:127], v[36:39]
    ds_read_b128 v[144:147], v2 offset:18432
    s_add_u32 m0, s43, 65536
    s_add_u32 s46, s41, 2048
    buffer_load_dwordx4 v9, s[16:19], s46 offen lds
    v_mfma_f32_16x16x32_bf16 v[24:27], v[60:63], v[116:119], v[24:27]
    ds_read_b64_tr_b16 v[152:153], v12 offset:57344
    ds_read_b64_tr_b16 v[154:155], v12 offset:57856
    s_add_u32 m0, s45, 131072
    s_add_u32 s46, s41, 4096
    buffer_load_dwordx4 v8, s[16:19], s46 offen lds
    v_mfma_f32_16x16x32_bf16 v[40:43], v[60:63], v[124:127], v[40:43]
    ds_read_b128 v[160:163], v3 offset:16384
    s_add_u32 m0, s43, 131072
    s_add_u32 s46, s41, 4096
    buffer_load_dwordx4 v9, s[16:19], s46 offen lds
    v_mfma_f32_16x16x32_bf16 v[28:31], v[132:135], v[116:119], v[28:31]
    ds_read_b64_tr_b16 v[84:85], v13 offset:57344
    ds_read_b64_tr_b16 v[86:87], v13 offset:57856
    s_bfe_u32 s40, s94, 0x40010
    s_add_u32 s40, s89, s40
    s_and_b32 s40, s40, 15
    s_mul_i32 s41, s40, 393216
    s_lshl_b32 s40, s40, 7
    s_add_u32 s40, s40, s36
    s_add_u32 s42, s41, s47
    s_add_u32 s41, s41, s38
    s_add_u32 m0, s45, 139264
    s_nop 0
    buffer_load_dwordx4 v8, s[16:19], s42 offen lds
    v_mfma_f32_16x16x32_bf16 v[44:47], v[132:135], v[124:127], v[44:47]
    ds_read_b128 v[72:75], v3 offset:18432
    s_add_u32 m0, s43, 139264
    s_nop 0
    buffer_load_dwordx4 v9, s[16:19], s42 offen lds
    s_bfe_u32 s40, s95, 0x40000
    s_add_u32 s40, s89, s40
    s_and_b32 s40, s40, 15
    s_mul_i32 s41, s40, 393216
    s_lshl_b32 s40, s40, 7
    s_add_u32 s40, s40, s36
    s_add_u32 s42, s41, s47
    s_add_u32 s41, s41, s38
    s_add_u32 m0, s44, 0
    s_add_u32 s46, s40, 0
    buffer_load_dwordx4 v5, s[12:15], s46 offen lds
    s_add_u32 m0, s44, 1024
    s_add_u32 s46, s40, 16384
    buffer_load_dwordx4 v6, s[12:15], s46 offen lds
    s_waitcnt vmcnt(12) lgkmcnt(0)
    s_barrier
    s_add_u32 m0, s44, 2048
    s_add_u32 s46, s40, 32768
    buffer_load_dwordx4 v5, s[12:15], s46 offen lds
    v_mfma_f32_16x16x32_bf16 v[16:19], v[68:71], v[148:151], v[16:19]
    ds_read_b64_tr_b16 v[92:93], v10 offset:61440
    ds_read_b64_tr_b16 v[94:95], v10 offset:61952
    s_add_u32 m0, s44, 3072
    s_add_u32 s46, s40, 49152
    buffer_load_dwordx4 v6, s[12:15], s46 offen lds
    v_mfma_f32_16x16x32_bf16 v[32:35], v[68:71], v[156:159], v[32:35]
    ds_read_b128 v[48:51], v2 offset:32768
    s_add_u32 m0, s45, 73728
    s_add_u32 s46, s41, 2048
    buffer_load_dwordx4 v8, s[16:19], s46 offen lds
    v_mfma_f32_16x16x32_bf16 v[20:23], v[76:79], v[148:151], v[20:23]
    ds_read_b64_tr_b16 v[88:89], v11 offset:61440
    ds_read_b64_tr_b16 v[90:91], v11 offset:61952
    s_add_u32 m0, s43, 73728
    s_add_u32 s46, s41, 2048
    buffer_load_dwordx4 v9, s[16:19], s46 offen lds
    v_mfma_f32_16x16x32_bf16 v[36:39], v[76:79], v[156:159], v[36:39]
    ds_read_b128 v[52:55], v2 offset:34816
    s_add_u32 m0, s45, 81920
    s_add_u32 s46, s41, 4096
    buffer_load_dwordx4 v8, s[16:19], s46 offen lds
    v_mfma_f32_16x16x32_bf16 v[24:27], v[152:155], v[148:151], v[24:27]
    ds_read_b64_tr_b16 v[100:101], v12 offset:61440
    ds_read_b64_tr_b16 v[102:103], v12 offset:61952
    s_add_u32 m0, s43, 81920
    s_add_u32 s46, s41, 4096
    buffer_load_dwordx4 v9, s[16:19], s46 offen lds
    v_mfma_f32_16x16x32_bf16 v[40:43], v[152:155], v[156:159], v[40:43]
    ds_read_b128 v[96:99], v3 offset:32768
    s_bfe_u32 s40, s95, 0x40004
    s_add_u32 s40, s89, s40
    s_and_b32 s40, s40, 15
    s_mul_i32 s41, s40, 393216
    s_lshl_b32 s40, s40, 7
    s_add_u32 s40, s40, s36
    s_add_u32 s42, s41, s47
    s_add_u32 s41, s41, s38
    s_add_u32 m0, s44, 16384
    s_add_u32 s46, s40, 0
    s_nop 0
    buffer_load_dwordx4 v5, s[12:15], s46 offen lds
    v_mfma_f32_16x16x32_bf16 v[28:31], v[84:87], v[148:151], v[28:31]
    ds_read_b64_tr_b16 v[108:109], v13 offset:61440
    ds_read_b64_tr_b16 v[110:111], v13 offset:61952
    s_add_u32 m0, s44, 17408
    s_add_u32 s46, s40, 16384
    buffer_load_dwordx4 v6, s[12:15], s46 offen lds
    v_mfma_f32_16x16x32_bf16 v[44:47], v[84:87], v[156:159], v[44:47]
    ds_read_b128 v[104:107], v3 offset:34816
    s_add_u32 m0, s44, 18432
    s_add_u32 s46, s40, 32768
    buffer_load_dwordx4 v5, s[12:15], s46 offen lds
    s_add_u32 m0, s44, 19456
    s_add_u32 s46, s40, 49152
    buffer_load_dwordx4 v6, s[12:15], s46 offen lds
    s_add_u32 m0, s45, 90112
    s_add_u32 s46, s41, 2048
    buffer_load_dwordx4 v8, s[16:19], s46 offen lds
    s_waitcnt vmcnt(13) lgkmcnt(0)
    s_barrier
    s_add_u32 m0, s43, 90112
    s_add_u32 s46, s41, 2048
    buffer_load_dwordx4 v9, s[16:19], s46 offen lds
    v_mfma_f32_16x16x32_bf16 v[16:19], v[92:95], v[64:67], v[16:19]
    ds_read_b64_tr_b16 v[56:57], v10 offset:49152
    ds_read_b64_tr_b16 v[58:59], v10 offset:49664
    s_add_u32 m0, s45, 98304
    s_add_u32 s46, s41, 4096
    buffer_load_dwordx4 v8, s[16:19], s46 offen lds
    v_mfma_f32_16x16x32_bf16 v[32:35], v[92:95], v[80:83], v[32:35]
    ds_read_b128 v[60:63], v2 offset:49152
    s_add_u32 m0, s43, 98304
    s_add_u32 s46, s41, 4096
    buffer_load_dwordx4 v9, s[16:19], s46 offen lds
    v_mfma_f32_16x16x32_bf16 v[20:23], v[88:91], v[64:67], v[20:23]
    ds_read_b64_tr_b16 v[116:117], v11 offset:49152
    ds_read_b64_tr_b16 v[118:119], v11 offset:49664
    s_bfe_u32 s40, s94, 0x40014
    s_add_u32 s40, s89, s40
    s_and_b32 s40, s40, 15
    s_mul_i32 s41, s40, 393216
    s_lshl_b32 s40, s40, 7
    s_add_u32 s40, s40, s36
    s_add_u32 s42, s41, s47
    s_add_u32 s41, s41, s38
    s_add_u32 m0, s45, 106496
    s_nop 0
    buffer_load_dwordx4 v8, s[16:19], s42 offen lds
    v_mfma_f32_16x16x32_bf16 v[36:39], v[88:91], v[80:83], v[36:39]
    ds_read_b128 v[132:135], v2 offset:51200
    s_add_u32 m0, s43, 106496
    s_nop 0
    buffer_load_dwordx4 v9, s[16:19], s42 offen lds
    v_mfma_f32_16x16x32_bf16 v[24:27], v[100:103], v[64:67], v[24:27]
    ds_read_b64_tr_b16 v[124:125], v12 offset:49152
    ds_read_b64_tr_b16 v[126:127], v12 offset:49664
    s_bfe_u32 s40, s95, 0x40008
    s_add_u32 s40, s89, s40
    s_and_b32 s40, s40, 15
    s_mul_i32 s41, s40, 393216
    s_lshl_b32 s40, s40, 7
    s_add_u32 s40, s40, s36
    s_add_u32 s42, s41, s47
    s_add_u32 s41, s41, s38
    s_add_u32 m0, s44, 32768
    s_add_u32 s46, s40, 0
    s_nop 0
    buffer_load_dwordx4 v5, s[12:15], s46 offen lds
    v_mfma_f32_16x16x32_bf16 v[40:43], v[100:103], v[80:83], v[40:43]
    ds_read_b128 v[68:71], v3 offset:49152
    s_add_u32 m0, s44, 33792
    s_add_u32 s46, s40, 16384
    buffer_load_dwordx4 v6, s[12:15], s46 offen lds
    v_mfma_f32_16x16x32_bf16 v[28:31], v[108:111], v[64:67], v[28:31]
    ds_read_b64_tr_b16 v[76:77], v13 offset:49152
    ds_read_b64_tr_b16 v[78:79], v13 offset:49664
    s_add_u32 m0, s44, 34816
    s_add_u32 s46, s40, 32768
    buffer_load_dwordx4 v5, s[12:15], s46 offen lds
    v_mfma_f32_16x16x32_bf16 v[44:47], v[108:111], v[80:83], v[44:47]
    ds_read_b128 v[152:155], v3 offset:51200
    s_add_u32 m0, s44, 35840
    s_add_u32 s46, s40, 49152
    buffer_load_dwordx4 v6, s[12:15], s46 offen lds
    s_add_u32 m0, s45, 114688
    s_add_u32 s46, s41, 2048
    buffer_load_dwordx4 v8, s[16:19], s46 offen lds
    s_add_u32 m0, s43, 114688
    s_add_u32 s46, s41, 2048
    buffer_load_dwordx4 v9, s[16:19], s46 offen lds
    s_waitcnt vmcnt(16) lgkmcnt(0)
    s_barrier
    s_add_u32 m0, s45, 122880
    s_add_u32 s46, s41, 4096
    buffer_load_dwordx4 v8, s[16:19], s46 offen lds
    v_mfma_f32_16x16x32_bf16 v[16:19], v[56:59], v[112:115], v[16:19]
    ds_read_b64_tr_b16 v[148:149], v10 offset:53248
    ds_read_b64_tr_b16 v[150:151], v10 offset:53760
    s_add_u32 m0, s43, 122880
    s_add_u32 s46, s41, 4096
    buffer_load_dwordx4 v9, s[16:19], s46 offen lds
    v_mfma_f32_16x16x32_bf16 v[32:35], v[56:59], v[120:123], v[32:35]
    ds_read_b128 v[84:87], v2 offset:0
    s_bfe_u32 s40, s95, 0x4000c
    s_add_u32 s40, s89, s40
    s_and_b32 s40, s40, 15
    s_mul_i32 s41, s40, 393216
    s_lshl_b32 s40, s40, 7
    s_add_u32 s40, s40, s36
    s_add_u32 s42, s41, s47
    s_add_u32 s41, s41, s38
    s_add_u32 m0, s44, 49152
    s_add_u32 s46, s40, 0
    s_nop 0
    buffer_load_dwordx4 v5, s[12:15], s46 offen lds
    v_mfma_f32_16x16x32_bf16 v[20:23], v[116:119], v[112:115], v[20:23]
    ds_read_b64_tr_b16 v[156:157], v11 offset:53248
    ds_read_b64_tr_b16 v[158:159], v11 offset:53760
    s_add_u32 m0, s44, 50176
    s_add_u32 s46, s40, 16384
    buffer_load_dwordx4 v6, s[12:15], s46 offen lds
    v_mfma_f32_16x16x32_bf16 v[36:39], v[116:119], v[120:123], v[36:39]
    ds_read_b128 v[92:95], v2 offset:2048
    s_add_u32 m0, s44, 51200
    s_add_u32 s46, s40, 32768
    buffer_load_dwordx4 v5, s[12:15], s46 offen lds
    v_mfma_f32_16x16x32_bf16 v[24:27], v[124:127], v[112:115], v[24:27]
    ds_read_b64_tr_b16 v[88:89], v12 offset:53248
    ds_read_b64_tr_b16 v[90:91], v12 offset:53760
    s_add_u32 m0, s44, 52224
    s_add_u32 s46, s40, 49152
    buffer_load_dwordx4 v6, s[12:15], s46 offen lds
    v_mfma_f32_16x16x32_bf16 v[40:43], v[124:127], v[120:123], v[40:43]
    ds_read_b128 v[100:103], v3 offset:0
    s_add_u32 m0, s45, 65536
    s_add_u32 s46, s41, 2048
    buffer_load_dwordx4 v8, s[16:19], s46 offen lds
    v_mfma_f32_16x16x32_bf16 v[28:31], v[76:79], v[112:115], v[28:31]
    ds_read_b64_tr_b16 v[64:65], v13 offset:53248
    ds_read_b64_tr_b16 v[66:67], v13 offset:53760
    s_add_u32 m0, s43, 65536
    s_add_u32 s46, s41, 2048
    buffer_load_dwordx4 v9, s[16:19], s46 offen lds
    v_mfma_f32_16x16x32_bf16 v[44:47], v[76:79], v[120:123], v[44:47]
    ds_read_b128 v[108:111], v3 offset:2048
    s_add_u32 m0, s45, 131072
    s_add_u32 s46, s41, 4096
    buffer_load_dwordx4 v8, s[16:19], s46 offen lds
    s_add_u32 m0, s43, 131072
    s_add_u32 s46, s41, 4096
    buffer_load_dwordx4 v9, s[16:19], s46 offen lds
    s_waitcnt vmcnt(16) lgkmcnt(0)
    s_barrier
    s_bfe_u32 s40, s95, 0x40010
    s_add_u32 s40, s89, s40
    s_and_b32 s40, s40, 15
    s_mul_i32 s41, s40, 393216
    s_lshl_b32 s40, s40, 7
    s_add_u32 s40, s40, s36
    s_add_u32 s42, s41, s47
    s_add_u32 s41, s41, s38
    s_add_u32 m0, s44, 0
    s_add_u32 s46, s40, 0
    buffer_load_dwordx4 v5, s[12:15], s46 offen lds
    v_mfma_f32_16x16x32_bf16 v[16:19], v[148:151], v[128:131], v[16:19]
    ds_read_b64_tr_b16 v[80:81], v10 offset:16384
    ds_read_b64_tr_b16 v[82:83], v10 offset:16896
    s_add_u32 m0, s44, 1024
    s_add_u32 s46, s40, 16384
    buffer_load_dwordx4 v6, s[12:15], s46 offen lds
    v_mfma_f32_16x16x32_bf16 v[32:35], v[148:151], v[136:139], v[32:35]
    ds_read_b128 v[56:59], v2 offset:16384
    s_add_u32 m0, s44, 2048
    s_add_u32 s46, s40, 32768
    buffer_load_dwordx4 v5, s[12:15], s46 offen lds
    v_mfma_f32_16x16x32_bf16 v[20:23], v[156:159], v[128:131], v[20:23]
    ds_read_b64_tr_b16 v[116:117], v11 offset:16384
    ds_read_b64_tr_b16 v[118:119], v11 offset:16896
    s_add_u32 m0, s44, 3072
    s_add_u32 s46, s40, 49152
    buffer_load_dwordx4 v6, s[12:15], s46 offen lds
    v_mfma_f32_16x16x32_bf16 v[36:39], v[156:159], v[136:139], v[36:39]
    ds_read_b128 v[124:127], v2 offset:18432
    s_add_u32 m0, s45, 73728
    s_add_u32 s46, s41, 2048
    buffer_load_dwordx4 v8, s[16:19], s46 offen lds
    v_mfma_f32_16x16x32_bf16 v[24:27], v[88:91], v[128:131], v[24:27]
    ds_read_b64_tr_b16 v[112:113], v12 offset:16384
    ds_read_b64_tr_b16 v[114:115], v12 offset:16896
    s_add_u32 m0, s43, 73728
    s_add_u32 s46, s41, 2048
    buffer_load_dwordx4 v9, s[16:19], s46 offen lds
    v_mfma_f32_16x16x32_bf16 v[40:43], v[88:91], v[136:139], v[40:43]
    ds_read_b128 v[76:79], v3 offset:16384
    s_add_u32 m0, s45, 81920
    s_add_u32 s46, s41, 4096
    buffer_load_dwordx4 v8, s[16:19], s46 offen lds
    v_mfma_f32_16x16x32_bf16 v[28:31], v[64:67], v[128:131], v[28:31]
    ds_read_b64_tr_b16 v[120:121], v13 offset:16384
    ds_read_b64_tr_b16 v[122:123], v13 offset:16896
    s_add_u32 m0, s43, 81920
    s_add_u32 s46, s41, 4096
    buffer_load_dwordx4 v9, s[16:19], s46 offen lds
    v_mfma_f32_16x16x32_bf16 v[44:47], v[64:67], v[136:139], v[44:47]
    ds_read_b128 v[148:151], v3 offset:18432
    s_waitcnt vmcnt(16) lgkmcnt(0)
    s_barrier
    s_bfe_u32 s40, s95, 0x40014
    s_add_u32 s40, s89, s40
    s_and_b32 s40, s40, 15
    s_mul_i32 s41, s40, 393216
    s_lshl_b32 s40, s40, 7
    s_add_u32 s40, s40, s36
    s_add_u32 s42, s41, s47
    s_add_u32 s41, s41, s38
    s_add_u32 m0, s44, 16384
    s_add_u32 s46, s40, 0
    s_nop 0
    buffer_load_dwordx4 v5, s[12:15], s46 offen lds
    v_mfma_f32_16x16x32_bf16 v[16:19], v[80:83], v[140:143], v[16:19]
    ds_read_b64_tr_b16 v[156:157], v10 offset:20480
    ds_read_b64_tr_b16 v[158:159], v10 offset:20992
    s_add_u32 m0, s44, 17408
    s_add_u32 s46, s40, 16384
    buffer_load_dwordx4 v6, s[12:15], s46 offen lds
    v_mfma_f32_16x16x32_bf16 v[32:35], v[80:83], v[144:147], v[32:35]
    ds_read_b128 v[88:91], v2 offset:32768
    s_add_u32 m0, s44, 18432
    s_add_u32 s46, s40, 32768
    buffer_load_dwordx4 v5, s[12:15], s46 offen lds
    v_mfma_f32_16x16x32_bf16 v[20:23], v[116:119], v[140:143], v[20:23]
    ds_read_b64_tr_b16 v[128:129], v11 offset:20480
    ds_read_b64_tr_b16 v[130:131], v11 offset:20992
    s_add_u32 m0, s44, 19456
    s_add_u32 s46, s40, 49152
    buffer_load_dwordx4 v6, s[12:15], s46 offen lds
    v_mfma_f32_16x16x32_bf16 v[36:39], v[116:119], v[144:147], v[36:39]
    ds_read_b128 v[64:67], v2 offset:34816
    s_add_u32 m0, s45, 90112
    s_add_u32 s46, s41, 2048
    buffer_load_dwordx4 v8, s[16:19], s46 offen lds
    v_mfma_f32_16x16x32_bf16 v[24:27], v[112:115], v[140:143], v[24:27]
    ds_read_b64_tr_b16 v[136:137], v12 offset:20480
    ds_read_b64_tr_b16 v[138:139], v12 offset:20992
    s_add_u32 m0, s43, 90112
    s_add_u32 s46, s41, 2048
    buffer_load_dwordx4 v9, s[16:19], s46 offen lds
    v_mfma_f32_16x16x32_bf16 v[40:43], v[112:115], v[144:147], v[40:43]
    ds_read_b128 v[80:83], v3 offset:32768
    s_add_u32 m0, s45, 98304
    s_add_u32 s46, s41, 4096
    buffer_load_dwordx4 v8, s[16:19], s46 offen lds
    v_mfma_f32_16x16x32_bf16 v[28:31], v[120:123], v[140:143], v[28:31]
    ds_read_b64_tr_b16 v[116:117], v13 offset:20480
    ds_read_b64_tr_b16 v[118:119], v13 offset:20992
    s_add_u32 m0, s43, 98304
    s_add_u32 s46, s41, 4096
    buffer_load_dwordx4 v9, s[16:19], s46 offen lds
    v_mfma_f32_16x16x32_bf16 v[44:47], v[120:123], v[144:147], v[44:47]
    ds_read_b128 v[112:115], v3 offset:34816
    s_waitcnt vmcnt(16) lgkmcnt(0)
    s_barrier
    s_bfe_u32 s40, s95, 0x40018
    s_add_u32 s40, s89, s40
    s_and_b32 s40, s40, 15
    s_mul_i32 s41, s40, 393216
    s_lshl_b32 s40, s40, 7
    s_add_u32 s40, s40, s36
    s_add_u32 s42, s41, s47
    s_add_u32 s41, s41, s38
    s_add_u32 m0, s44, 32768
    s_add_u32 s46, s40, 0
    s_nop 0
    buffer_load_dwordx4 v5, s[12:15], s46 offen lds
    v_mfma_f32_16x16x32_bf16 v[16:19], v[156:159], v[160:163], v[16:19]
    ds_read_b128 v[140:143], v2 offset:49152
    s_add_u32 m0, s44, 33792
    s_add_u32 s46, s40, 16384
    buffer_load_dwordx4 v6, s[12:15], s46 offen lds
    v_mfma_f32_16x16x32_bf16 v[32:35], v[156:159], v[72:75], v[32:35]
    ds_read_b128 v[120:123], v2 offset:51200
    s_add_u32 m0, s44, 34816
    s_add_u32 s46, s40, 32768
    buffer_load_dwordx4 v5, s[12:15], s46 offen lds
    v_mfma_f32_16x16x32_bf16 v[20:23], v[128:131], v[160:163], v[20:23]
    ds_read_b128 v[144:147], v3 offset:49152
    s_add_u32 m0, s44, 35840
    s_add_u32 s46, s40, 49152
    buffer_load_dwordx4 v6, s[12:15], s46 offen lds
    v_mfma_f32_16x16x32_bf16 v[36:39], v[128:131], v[72:75], v[36:39]
    ds_read_b128 v[156:159], v3 offset:51200
    s_add_u32 m0, s45, 106496
    s_add_u32 s46, s41, 2048
    buffer_load_dwordx4 v8, s[16:19], s46 offen lds
    v_mfma_f32_16x16x32_bf16 v[24:27], v[136:139], v[160:163], v[24:27]
    s_add_u32 m0, s43, 106496
    s_add_u32 s46, s41, 2048
    buffer_load_dwordx4 v9, s[16:19], s46 offen lds
    v_mfma_f32_16x16x32_bf16 v[40:43], v[136:139], v[72:75], v[40:43]
    s_add_u32 m0, s45, 114688
    s_add_u32 s46, s41, 4096
    buffer_load_dwordx4 v8, s[16:19], s46 offen lds
    v_mfma_f32_16x16x32_bf16 v[28:31], v[116:119], v[160:163], v[28:31]
    s_add_u32 m0, s43, 114688
    s_add_u32 s46, s41, 4096
    buffer_load_dwordx4 v9, s[16:19], s46 offen lds
    v_mfma_f32_16x16x32_bf16 v[44:47], v[116:119], v[72:75], v[44:47]
    s_waitcnt vmcnt(16) lgkmcnt(0)
    s_barrier
    s_bfe_u32 s40, s95, 0x4001c
    s_add_u32 s40, s89, s40
    s_and_b32 s40, s40, 15
    s_mul_i32 s41, s40, 393216
    s_lshl_b32 s40, s40, 7
    s_add_u32 s40, s40, s36
    s_add_u32 s42, s41, s47
    s_add_u32 s41, s41, s38
    s_add_u32 m0, s44, 49152
    s_add_u32 s46, s40, 0
    s_nop 0
    buffer_load_dwordx4 v5, s[12:15], s46 offen lds
    s_add_u32 m0, s44, 50176
    s_add_u32 s46, s40, 16384
    buffer_load_dwordx4 v6, s[12:15], s46 offen lds
    s_add_u32 m0, s44, 51200
    s_add_u32 s46, s40, 32768
    buffer_load_dwordx4 v5, s[12:15], s46 offen lds
    s_add_u32 m0, s44, 52224
    s_add_u32 s46, s40, 49152
    buffer_load_dwordx4 v6, s[12:15], s46 offen lds
    s_add_u32 m0, s45, 65536
    s_add_u32 s46, s41, 2048
    buffer_load_dwordx4 v8, s[16:19], s46 offen lds
    s_add_u32 m0, s43, 65536
    s_add_u32 s46, s41, 2048
    buffer_load_dwordx4 v9, s[16:19], s46 offen lds
    s_add_u32 m0, s45, 122880
    s_add_u32 s46, s41, 4096
    buffer_load_dwordx4 v8, s[16:19], s46 offen lds
    s_add_u32 m0, s43, 122880
    s_add_u32 s46, s41, 4096
    buffer_load_dwordx4 v9, s[16:19], s46 offen lds
    s_waitcnt vmcnt(16)
    s_barrier
    s_bfe_u32 s40, s94, 0x40018
    s_add_u32 s40, s89, s40
    s_and_b32 s40, s40, 15
    s_mul_i32 s41, s40, 393216
    s_lshl_b32 s40, s40, 7
    s_add_u32 s40, s40, s36
    s_add_u32 s42, s41, s47
    s_add_u32 s41, s41, s38
    s_add_u32 m0, s45, 147456
    s_nop 0
    buffer_load_dwordx4 v8, s[16:19], s42 offen lds
    s_add_u32 m0, s43, 147456
    s_nop 0
    buffer_load_dwordx4 v9, s[16:19], s42 offen lds
    s_waitcnt vmcnt(10)
    s_barrier
    s_bfe_u32 s40, s95, 0x40010
    s_add_u32 s40, s89, s40
    s_and_b32 s40, s40, 15
    s_mul_i32 s41, s40, 393216
    s_lshl_b32 s40, s40, 7
    s_add_u32 s40, s40, s36
    s_add_u32 s42, s41, s47
    s_add_u32 s41, s41, s38
    s_add_u32 m0, s45, 139264
    s_nop 0
    buffer_load_dwordx4 v8, s[16:19], s42 offen lds
    s_add_u32 m0, s43, 139264
    s_nop 0
    buffer_load_dwordx4 v9, s[16:19], s42 offen lds
    s_waitcnt vmcnt(4)
    s_barrier
    s_bfe_u32 s40, s95, 0x40014
    s_add_u32 s40, s89, s40
    s_and_b32 s40, s40, 15
    s_mul_i32 s41, s40, 393216
    s_lshl_b32 s40, s40, 7
    s_add_u32 s40, s40, s36
    s_add_u32 s42, s41, s47
    s_add_u32 s41, s41, s38
    s_add_u32 m0, s45, 131072
    s_nop 0
    buffer_load_dwordx4 v8, s[16:19], s42 offen lds
    s_add_u32 m0, s43, 131072
    s_nop 0
    buffer_load_dwordx4 v9, s[16:19], s42 offen lds
    s_waitcnt vmcnt(2)
    s_barrier
    s_bfe_u32 s40, s95, 0x40018
    s_add_u32 s40, s89, s40
    s_and_b32 s40, s40, 15
    s_mul_i32 s41, s40, 393216
    s_lshl_b32 s40, s40, 7
    s_add_u32 s40, s40, s36
    s_add_u32 s42, s41, s47
    s_add_u32 s41, s41, s38
    s_add_u32 m0, s45, 81920
    s_nop 0
    buffer_load_dwordx4 v8, s[16:19], s42 offen lds
    s_add_u32 m0, s43, 81920
    s_nop 0
    buffer_load_dwordx4 v9, s[16:19], s42 offen lds
    s_bfe_u32 s40, s95, 0x4001c
    s_add_u32 s40, s89, s40
    s_branch IW_s1
IW_w1:
    s_branch IW_r1
IW_s1:
    s_and_b32 s40, s40, 15
    s_mul_i32 s41, s40, 393216
    s_lshl_b32 s40, s40, 7
    s_add_u32 s40, s40, s36
    s_add_u32 s42, s41, s47
    s_add_u32 s41, s41, s38
    s_add_u32 m0, s45, 73728
    s_nop 0
    buffer_load_dwordx4 v8, s[16:19], s42 offen lds
    s_add_u32 m0, s43, 73728
    s_nop 0
    buffer_load_dwordx4 v9, s[16:19], s42 offen lds
    s_bfe_u32 s40, s94, 0x4001c
    s_add_u32 s40, s89, s40
    s_and_b32 s40, s40, 15
    s_mul_i32 s41, s40, 393216
    s_lshl_b32 s40, s40, 7
    s_add_u32 s40, s40, s36
    s_add_u32 s42, s41, s47
    s_add_u32 s41, s41, s38
    s_add_u32 m0, s45, 98304
    s_nop 0
    buffer_load_dwordx4 v8, s[16:19], s42 offen lds
    s_add_u32 m0, s43, 98304
    s_nop 0
    buffer_load_dwordx4 v9, s[16:19], s42 offen lds
    s_bfe_u32 s40, s95, 0x40000
    s_add_u32 s40, s89, s40
    s_and_b32 s40, s40, 15
    s_mul_i32 s41, s40, 393216
    s_lshl_b32 s40, s40, 7
    s_add_u32 s40, s40, s36
    s_add_u32 s42, s41, s47
    s_add_u32 s41, s41, s38
    s_add_u32 m0, s45, 90112
    s_nop 0
    buffer_load_dwordx4 v8, s[16:19], s42 offen lds
    s_add_u32 m0, s43, 90112
    s_nop 0
    buffer_load_dwordx4 v9, s[16:19], s42 offen lds
    s_bfe_u32 s40, s95, 0x40004
    s_add_u32 s40, s89, s40
    s_and_b32 s40, s40, 15
    s_mul_i32 s41, s40, 393216
    s_lshl_b32 s40, s40, 7
    s_add_u32 s40, s40, s36
    s_add_u32 s42, s41, s47
    s_add_u32 s41, s41, s38
    s_add_u32 m0, s45, 114688
    s_nop 0
    buffer_load_dwordx4 v8, s[16:19], s42 offen lds
    s_add_u32 m0, s43, 114688
    s_nop 0
    buffer_load_dwordx4 v9, s[16:19], s42 offen lds
    s_bfe_u32 s40, s95, 0x40008
    s_add_u32 s40, s89, s40
    s_and_b32 s40, s40, 15
    s_mul_i32 s41, s40, 393216
    s_lshl_b32 s40, s40, 7
    s_add_u32 s40, s40, s36
    s_add_u32 s42, s41, s47
    s_add_u32 s41, s41, s38
    s_add_u32 m0, s45, 106496
    s_nop 0
    buffer_load_dwordx4 v8, s[16:19], s42 offen lds
    s_add_u32 m0, s43, 106496
    s_nop 0
    buffer_load_dwordx4 v9, s[16:19], s42 offen lds
    s_bfe_u32 s40, s95, 0x4000c
    s_add_u32 s40, s89, s40
    s_and_b32 s40, s40, 15
    s_mul_i32 s41, s40, 393216
    s_lshl_b32 s40, s40, 7
    s_add_u32 s40, s40, s36
    s_add_u32 s42, s41, s47
    s_add_u32 s41, s41, s38
    s_add_u32 m0, s45, 122880
    s_nop 0
    buffer_load_dwordx4 v8, s[16:19], s42 offen lds
    s_add_u32 m0, s43, 122880
    s_nop 0
    buffer_load_dwordx4 v9, s[16:19], s42 offen lds
    s_setprio 1
    v_subrev_u32 v5, 24576, v10
    v_subrev_u32 v6, 24576, v11
    v_subrev_u32 v8, 24576, v12
    v_subrev_u32 v9, 24576, v13
    s_add_u32 s16, s72, 0x400000
    s_addc_u32 s17, s73, 0
    s_mov_b32 s18, 0x400000
    s_mov_b32 s19, 0x00020000
    s_add_u32 s24, s72, 0x800000
    s_addc_u32 s25, s73, 0
    s_mov_b32 s26, 0x48000
    s_mov_b32 s27, 0x00020000
    ds_read_b32 v7, v1 offset:32
FW_1:
    s_waitcnt lgkmcnt(0)
    v_cmp_gt_u32 vcc, 1, v7
    s_cbranch_vccz FO_2
    s_sleep 2
    ds_read_b32 v7, v1 offset:32
    s_branch FW_1
FO_2:
    s_waitcnt vmcnt(0)
    s_mov_b64 exec, 1
    ds_add_u32 v4, v164 offset:112
    s_mov_b64 exec, -1
    s_nop 0
    ds_read_b64_tr_b16 v[128:129], v10 offset:57344
    ds_read_b64_tr_b16 v[130:131], v10 offset:57856
    ds_read_b64_tr_b16 v[136:137], v11 offset:57344
    ds_read_b64_tr_b16 v[138:139], v11 offset:57856
    ds_read_b64_tr_b16 v[160:161], v12 offset:57344
    ds_read_b64_tr_b16 v[162:163], v12 offset:57856
    ds_read_b64_tr_b16 v[116:117], v13 offset:57344
    ds_read_b64_tr_b16 v[118:119], v13 offset:57856
    ds_read_b64_tr_b16 v[72:73], v10 offset:61440
    ds_read_b64_tr_b16 v[74:75], v10 offset:61952
    s_waitcnt lgkmcnt(8)
    v_mfma_f32_16x16x32_bf16 v[16:19], v[128:131], v[48:51], v[16:19]
    v_mfma_f32_16x16x32_bf16 v[32:35], v[128:131], v[52:55], v[32:35]
    ds_read_b64_tr_b16 v[128:129], v11 offset:61440
    ds_read_b64_tr_b16 v[130:131], v11 offset:61952
    s_waitcnt lgkmcnt(8)
    v_mfma_f32_16x16x32_bf16 v[20:23], v[136:139], v[48:51], v[20:23]
    v_mfma_f32_16x16x32_bf16 v[36:39], v[136:139], v[52:55], v[36:39]
    ds_read_b64_tr_b16 v[136:137], v12 offset:61440
    ds_read_b64_tr_b16 v[138:139], v12 offset:61952
    s_waitcnt lgkmcnt(8)
    v_mfma_f32_16x16x32_bf16 v[24:27], v[160:163], v[48:51], v[24:27]
    v_mfma_f32_16x16x32_bf16 v[40:43], v[160:163], v[52:55], v[40:43]
    ds_read_b64_tr_b16 v[160:161], v13 offset:61440
    ds_read_b64_tr_b16 v[162:163], v13 offset:61952
    s_waitcnt lgkmcnt(8)
    v_mfma_f32_16x16x32_bf16 v[28:31], v[116:119], v[48:51], v[28:31]
    ds_read_b128 v[48:51], v2 offset:0
    v_mfma_f32_16x16x32_bf16 v[44:47], v[116:119], v[52:55], v[44:47]
    ds_read_b64_tr_b16 v[116:117], v10 offset:49152
    ds_read_b64_tr_b16 v[118:119], v10 offset:49664
    s_waitcnt lgkmcnt(9)
    v_mfma_f32_16x16x32_bf16 v[16:19], v[72:75], v[96:99], v[16:19]
    ds_read_b128 v[52:55], v2 offset:2048
    v_mfma_f32_16x16x32_bf16 v[32:35], v[72:75], v[104:107], v[32:35]
    ds_read_b64_tr_b16 v[72:73], v11 offset:49152
    ds_read_b64_tr_b16 v[74:75], v11 offset:49664
    s_waitcnt lgkmcnt(10)
    v_mfma_f32_16x16x32_bf16 v[20:23], v[128:131], v[96:99], v[20:23]
    v_mfma_f32_16x16x32_bf16 v[36:39], v[128:131], v[104:107], v[36:39]
    ds_read_b64_tr_b16 v[128:129], v12 offset:49152
    ds_read_b64_tr_b16 v[130:131], v12 offset:49664
    s_waitcnt lgkmcnt(8)
    s_mov_b64 exec, 1
    ds_add_u32 v4, v164 offset:0
    s_mov_b64 exec, -1
    s_nop 0
    v_mfma_f32_16x16x32_bf16 v[24:27], v[136:139], v[96:99], v[24:27]
    v_mfma_f32_16x16x32_bf16 v[40:43], v[136:139], v[104:107], v[40:43]
    ds_read_b64_tr_b16 v[136:137], v13 offset:49152
    ds_read_b64_tr_b16 v[138:139], v13 offset:49664
    v_mfma_f32_16x16x32_bf16 v[28:31], v[160:163], v[96:99], v[28:31]
    ds_read_b128 v[96:99], v3 offset:0
    v_mfma_f32_16x16x32_bf16 v[44:47], v[160:163], v[104:107], v[44:47]
    ds_read_b64_tr_b16 v[160:161], v10 offset:53248
    ds_read_b64_tr_b16 v[162:163], v10 offset:53760
    s_waitcnt lgkmcnt(11)
    v_mfma_f32_16x16x32_bf16 v[16:19], v[116:119], v[48:51], v[16:19]
    ds_read_b128 v[104:107], v3 offset:2048
    s_waitcnt lgkmcnt(11)
    v_mfma_f32_16x16x32_bf16 v[32:35], v[116:119], v[52:55], v[32:35]
    ds_read_b64_tr_b16 v[116:117], v11 offset:53248
    ds_read_b64_tr_b16 v[118:119], v11 offset:53760
    s_waitcnt lgkmcnt(11)
    v_mfma_f32_16x16x32_bf16 v[20:23], v[72:75], v[48:51], v[20:23]
    v_mfma_f32_16x16x32_bf16 v[36:39], v[72:75], v[52:55], v[36:39]
    ds_read_b64_tr_b16 v[72:73], v12 offset:53248
    ds_read_b64_tr_b16 v[74:75], v12 offset:53760
    s_waitcnt lgkmcnt(11)
    v_mfma_f32_16x16x32_bf16 v[24:27], v[128:131], v[48:51], v[24:27]
    v_mfma_f32_16x16x32_bf16 v[40:43], v[128:131], v[52:55], v[40:43]
    ds_read_b64_tr_b16 v[128:129], v13 offset:53248
    ds_read_b64_tr_b16 v[130:131], v13 offset:53760
    s_waitcnt lgkmcnt(10)
    v_mfma_f32_16x16x32_bf16 v[28:31], v[136:139], v[48:51], v[28:31]
    ds_read_b32 v7, v1 offset:112
FW_3:
    s_waitcnt lgkmcnt(0)
    v_cmp_gt_u32 vcc, 1, v7
    s_cbranch_vccz FO_4
    ds_read_b32 v7, v1 offset:112
    s_branch FW_3
FO_4:
    s_nop 0
    ds_read_b128 v[48:51], v2 offset:16384
    v_mfma_f32_16x16x32_bf16 v[44:47], v[136:139], v[52:55], v[44:47]
    ds_read_b64_tr_b16 v[136:137], v10 offset:40960
    ds_read_b64_tr_b16 v[138:139], v10 offset:41472
    v_mfma_f32_16x16x32_bf16 v[16:19], v[160:163], v[96:99], v[16:19]
    ds_read_b128 v[52:55], v2 offset:18432
    v_mfma_f32_16x16x32_bf16 v[32:35], v[160:163], v[104:107], v[32:35]
    ds_read_b64_tr_b16 v[160:161], v11 offset:40960
    ds_read_b64_tr_b16 v[162:163], v11 offset:41472
    v_mfma_f32_16x16x32_bf16 v[20:23], v[116:119], v[96:99], v[20:23]
    v_mfma_f32_16x16x32_bf16 v[36:39], v[116:119], v[104:107], v[36:39]
    ds_read_b64_tr_b16 v[116:117], v12 offset:40960
    ds_read_b64_tr_b16 v[118:119], v12 offset:41472
    s_mov_b64 exec, 1
    ds_add_u32 v4, v164 offset:0
    s_mov_b64 exec, -1
    v_mfma_f32_16x16x32_bf16 v[24:27], v[72:75], v[96:99], v[24:27]
    v_mfma_f32_16x16x32_bf16 v[40:43], v[72:75], v[104:107], v[40:43]
    ds_read_b64_tr_b16 v[72:73], v13 offset:40960
    ds_read_b64_tr_b16 v[74:75], v13 offset:41472
    v_mfma_f32_16x16x32_bf16 v[28:31], v[128:131], v[96:99], v[28:31]
    ds_read_b128 v[96:99], v3 offset:16384
    v_mfma_f32_16x16x32_bf16 v[44:47], v[128:131], v[104:107], v[44:47]
    ds_read_b64_tr_b16 v[128:129], v10 offset:45056
    ds_read_b64_tr_b16 v[130:131], v10 offset:45568
    s_waitcnt lgkmcnt(11)
    v_mfma_f32_16x16x32_bf16 v[16:19], v[136:139], v[48:51], v[16:19]
    ds_read_b128 v[104:107], v3 offset:18432
    s_waitcnt lgkmcnt(11)
    v_mfma_f32_16x16x32_bf16 v[32:35], v[136:139], v[52:55], v[32:35]
    ds_read_b64_tr_b16 v[136:137], v11 offset:45056
    ds_read_b64_tr_b16 v[138:139], v11 offset:45568
    s_waitcnt lgkmcnt(11)
    v_mfma_f32_16x16x32_bf16 v[20:23], v[160:163], v[48:51], v[20:23]
    v_mfma_f32_16x16x32_bf16 v[36:39], v[160:163], v[52:55], v[36:39]
    ds_read_b64_tr_b16 v[160:161], v12 offset:45056
    ds_read_b64_tr_b16 v[162:163], v12 offset:45568
    s_waitcnt lgkmcnt(11)
    v_mfma_f32_16x16x32_bf16 v[24:27], v[116:119], v[48:51], v[24:27]
    v_mfma_f32_16x16x32_bf16 v[40:43], v[116:119], v[52:55], v[40:43]
    ds_read_b64_tr_b16 v[116:117], v13 offset:45056
    ds_read_b64_tr_b16 v[118:119], v13 offset:45568
    s_waitcnt lgkmcnt(10)
    v_mfma_f32_16x16x32_bf16 v[28:31], v[72:75], v[48:51], v[28:31]
    ds_read_b128 v[48:51], v2 offset:32768
    v_mfma_f32_16x16x32_bf16 v[44:47], v[72:75], v[52:55], v[44:47]
    ds_read_b64_tr_b16 v[72:73], v5 offset:16384
    ds_read_b64_tr_b16 v[74:75], v5 offset:16896
    s_waitcnt lgkmcnt(10)
    v_mfma_f32_16x16x32_bf16 v[16:19], v[128:131], v[96:99], v[16:19]
    ds_read_b128 v[52:55], v2 offset:34816
    s_waitcnt lgkmcnt(10)
    v_mfma_f32_16x16x32_bf16 v[32:35], v[128:131], v[104:107], v[32:35]
    ds_read_b64_tr_b16 v[128:129], v6 offset:16384
    ds_read_b64_tr_b16 v[130:131], v6 offset:16896
    s_waitcnt lgkmcnt(10)
    v_mfma_f32_16x16x32_bf16 v[20:23], v[136:139], v[96:99], v[20:23]
    v_mfma_f32_16x16x32_bf16 v[36:39], v[136:139], v[104:107], v[36:39]
    ds_read_b64_tr_b16 v[136:137], v8 offset:16384
    ds_read_b64_tr_b16 v[138:139], v8 offset:16896
    s_waitcnt lgkmcnt(8)
    s_mov_b64 exec, 1
    ds_add_u32 v4, v164 offset:0
    s_mov_b64 exec, -1
    s_nop 0
    v_mfma_f32_16x16x32_bf16 v[24:27], v[160:163], v[96:99], v[24:27]
    v_mfma_f32_16x16x32_bf16 v[40:43], v[160:163], v[104:107], v[40:43]
    ds_read_b64_tr_b16 v[160:161], v9 offset:16384
    ds_read_b64_tr_b16 v[162:163], v9 offset:16896
    v_mfma_f32_16x16x32_bf16 v[28:31], v[116:119], v[96:99], v[28:31]
    ds_read_b128 v[96:99], v3 offset:32768
    v_mfma_f32_16x16x32_bf16 v[44:47], v[116:119], v[104:107], v[44:47]
    ds_read_b64_tr_b16 v[116:117], v5 offset:20480
    ds_read_b64_tr_b16 v[118:119], v5 offset:20992
    s_waitcnt lgkmcnt(11)
    v_mfma_f32_16x16x32_bf16 v[16:19], v[72:75], v[48:51], v[16:19]
    ds_read_b128 v[104:107], v3 offset:34816
    s_waitcnt lgkmcnt(11)
    v_mfma_f32_16x16x32_bf16 v[32:35], v[72:75], v[52:55], v[32:35]
    ds_read_b64_tr_b16 v[72:73], v6 offset:20480
    ds_read_b64_tr_b16 v[74:75], v6 offset:20992
    s_waitcnt lgkmcnt(11)
    v_mfma_f32_16x16x32_bf16 v[20:23], v[128:131], v[48:51], v[20:23]
    v_mfma_f32_16x16x32_bf16 v[36:39], v[128:131], v[52:55], v[36:39]
    ds_read_b64_tr_b16 v[128:129], v8 offset:20480
    ds_read_b64_tr_b16 v[130:131], v8 offset:20992
    s_waitcnt lgkmcnt(11)
    v_mfma_f32_16x16x32_bf16 v[24:27], v[136:139], v[48:51], v[24:27]
    v_mfma_f32_16x16x32_bf16 v[40:43], v[136:139], v[52:55], v[40:43]
    ds_read_b64_tr_b16 v[136:137], v9 offset:20480
    ds_read_b64_tr_b16 v[138:139], v9 offset:20992
    s_waitcnt lgkmcnt(10)
    v_mfma_f32_16x16x32_bf16 v[28:31], v[160:163], v[48:51], v[28:31]
    ds_read_b128 v[48:51], v2 offset:49152
    v_mfma_f32_16x16x32_bf16 v[44:47], v[160:163], v[52:55], v[44:47]
    ds_read_b64_tr_b16 v[160:161], v5 offset:8192
    ds_read_b64_tr_b16 v[162:163], v5 offset:8704
    s_waitcnt lgkmcnt(10)
    v_mfma_f32_16x16x32_bf16 v[16:19], v[116:119], v[96:99], v[16:19]
    ds_read_b128 v[52:55], v2 offset:51200
    s_waitcnt lgkmcnt(10)
    v_mfma_f32_16x16x32_bf16 v[32:35], v[116:119], v[104:107], v[32:35]
    ds_read_b64_tr_b16 v[116:117], v6 offset:8192
    ds_read_b64_tr_b16 v[118:119], v6 offset:8704
    s_waitcnt lgkmcnt(10)
    v_mfma_f32_16x16x32_bf16 v[20:23], v[72:75], v[96:99], v[20:23]
    v_mfma_f32_16x16x32_bf16 v[36:39], v[72:75], v[104:107], v[36:39]
    ds_read_b64_tr_b16 v[72:73], v8 offset:8192
    ds_read_b64_tr_b16 v[74:75], v8 offset:8704
    s_waitcnt lgkmcnt(8)
    s_mov_b64 exec, 1
    ds_add_u32 v4, v164 offset:0
    s_mov_b64 exec, -1
    s_nop 0
    v_mfma_f32_16x16x32_bf16 v[24:27], v[128:131], v[96:99], v[24:27]
    v_mfma_f32_16x16x32_bf16 v[40:43], v[128:131], v[104:107], v[40:43]
    ds_read_b64_tr_b16 v[128:129], v9 offset:8192
    ds_read_b64_tr_b16 v[130:131], v9 offset:8704
    v_mfma_f32_16x16x32_bf16 v[28:31], v[136:139], v[96:99], v[28:31]
    ds_read_b128 v[96:99], v3 offset:49152
    v_mfma_f32_16x16x32_bf16 v[44:47], v[136:139], v[104:107], v[44:47]
    ds_read_b64_tr_b16 v[136:137], v5 offset:12288
    ds_read_b64_tr_b16 v[138:139], v5 offset:12800
    s_waitcnt lgkmcnt(11)
    v_mfma_f32_16x16x32_bf16 v[16:19], v[160:163], v[48:51], v[16:19]
    ds_read_b128 v[104:107], v3 offset:51200
    s_waitcnt lgkmcnt(11)
    v_mfma_f32_16x16x32_bf16 v[32:35], v[160:163], v[52:55], v[32:35]
    ds_read_b64_tr_b16 v[160:161], v6 offset:12288
    ds_read_b64_tr_b16 v[162:163], v6 offset:12800
    s_waitcnt lgkmcnt(11)
    v_mfma_f32_16x16x32_bf16 v[20:23], v[116:119], v[48:51], v[20:23]
    v_mfma_f32_16x16x32_bf16 v[36:39], v[116:119], v[52:55], v[36:39]
    ds_read_b64_tr_b16 v[116:117], v8 offset:12288
    ds_read_b64_tr_b16 v[118:119], v8 offset:12800
    s_waitcnt lgkmcnt(11)
    v_mfma_f32_16x16x32_bf16 v[24:27], v[72:75], v[48:51], v[24:27]
    v_mfma_f32_16x16x32_bf16 v[40:43], v[72:75], v[52:55], v[40:43]
    ds_read_b64_tr_b16 v[72:73], v9 offset:12288
    ds_read_b64_tr_b16 v[74:75], v9 offset:12800
    s_waitcnt lgkmcnt(10)
    v_mfma_f32_16x16x32_bf16 v[28:31], v[128:131], v[48:51], v[28:31]
    ds_read_b64_tr_b16 v[48:49], v10 offset:8192
    v_mfma_f32_16x16x32_bf16 v[44:47], v[128:131], v[52:55], v[44:47]
    ds_read_b64_tr_b16 v[50:51], v10 offset:8704
    ds_read_b64_tr_b16 v[128:129], v11 offset:8192
    s_waitcnt lgkmcnt(10)
    v_mfma_f32_16x16x32_bf16 v[16:19], v[136:139], v[96:99], v[16:19]
    ds_read_b64_tr_b16 v[130:131], v11 offset:8704
    s_waitcnt lgkmcnt(10)
    v_mfma_f32_16x16x32_bf16 v[32:35], v[136:139], v[104:107], v[32:35]
    ds_read_b64_tr_b16 v[52:53], v12 offset:8192
    ds_read_b64_tr_b16 v[54:55], v12 offset:8704
    s_waitcnt lgkmcnt(10)
    v_mfma_f32_16x16x32_bf16 v[20:23], v[160:163], v[96:99], v[20:23]
    ds_read_b64_tr_b16 v[136:137], v13 offset:8192
    v_mfma_f32_16x16x32_bf16 v[36:39], v[160:163], v[104:107], v[36:39]
    ds_read_b64_tr_b16 v[138:139], v13 offset:8704
    ds_read_b64_tr_b16 v[160:161], v10 offset:12288
    s_waitcnt lgkmcnt(9)
    s_mov_b64 exec, 1
    ds_add_u32 v4, v164 offset:0
    s_mov_b64 exec, -1
    s_nop 0
    v_mfma_f32_16x16x32_bf16 v[24:27], v[116:119], v[96:99], v[24:27]
    ds_read_b64_tr_b16 v[162:163], v10 offset:12800
    v_mfma_f32_16x16x32_bf16 v[40:43], v[116:119], v[104:107], v[40:43]
    ds_read_b64_tr_b16 v[116:117], v11 offset:12288
    ds_read_b64_tr_b16 v[118:119], v11 offset:12800
    v_mfma_f32_16x16x32_bf16 v[28:31], v[72:75], v[96:99], v[28:31]
    ds_read_b64_tr_b16 v[96:97], v12 offset:12288
    v_mfma_f32_16x16x32_bf16 v[44:47], v[72:75], v[104:107], v[44:47]
    ds_read_b64_tr_b16 v[98:99], v12 offset:12800
    s_waitcnt lgkmcnt(8)
    ds_read_b64_tr_b16 v[72:73], v13 offset:12288
    s_waitcnt lgkmcnt(14)
    v_mfma_f32_16x16x32_bf16 v[16:19], v[48:51], v[60:63], v[16:19]
    ds_read_b64_tr_b16 v[74:75], v13 offset:12800
    v_mfma_f32_16x16x32_bf16 v[32:35], v[48:51], v[132:135], v[32:35]
    ds_read_b64_tr_b16 v[104:105], v10 offset:0
    ds_read_b64_tr_b16 v[106:107], v10 offset:512
    s_waitcnt lgkmcnt(15)
    v_mfma_f32_16x16x32_bf16 v[20:23], v[128:131], v[60:63], v[20:23]
    ds_read_b64_tr_b16 v[48:49], v11 offset:0
    v_mfma_f32_16x16x32_bf16 v[36:39], v[128:131], v[132:135], v[36:39]
    ds_read_b64_tr_b16 v[50:51], v11 offset:512
    ds_read_b64_tr_b16 v[128:129], v12 offset:0
    s_waitcnt lgkmcnt(15)
    v_mfma_f32_16x16x32_bf16 v[24:27], v[52:55], v[60:63], v[24:27]
    s_waitcnt lgkmcnt(8)
    ds_read_b64_tr_b16 v[130:131], v12 offset:512
    v_mfma_f32_16x16x32_bf16 v[40:43], v[52:55], v[132:135], v[40:43]
    ds_read_b64_tr_b16 v[52:53], v13 offset:0
    ds_read_b64_tr_b16 v[54:55], v13 offset:512
    s_waitcnt lgkmcnt(8)
    s_mov_b64 exec, 1
    ds_add_u32 v4, v164 offset:0
    s_mov_b64 exec, -1
    v_mfma_f32_16x16x32_bf16 v[28:31], v[136:139], v[60:63], v[28:31]
    v_mfma_f32_16x16x32_bf16 v[44:47], v[136:139], v[132:135], v[44:47]
    v_mfma_f32_16x16x32_bf16 v[16:19], v[160:163], v[68:71], v[16:19]
    ds_read_b64_tr_b16 v[60:61], v10 offset:4096
    v_mfma_f32_16x16x32_bf16 v[32:35], v[160:163], v[152:155], v[32:35]
    ds_read_b64_tr_b16 v[62:63], v10 offset:4608
    ds_read_b64_tr_b16 v[136:137], v11 offset:4096
    v_mfma_f32_16x16x32_bf16 v[20:23], v[116:119], v[68:71], v[20:23]
    ds_read_b64_tr_b16 v[138:139], v11 offset:4608
    v_mfma_f32_16x16x32_bf16 v[36:39], v[116:119], v[152:155], v[36:39]
    ds_read_b64_tr_b16 v[132:133], v12 offset:4096
    ds_read_b64_tr_b16 v[134:135], v12 offset:4608
    v_mfma_f32_16x16x32_bf16 v[24:27], v[96:99], v[68:71], v[24:27]
    s_waitcnt lgkmcnt(8)
    ds_read_b64_tr_b16 v[160:161], v13 offset:4096
    v_mfma_f32_16x16x32_bf16 v[40:43], v[96:99], v[152:155], v[40:43]
    ds_read_b64_tr_b16 v[162:163], v13 offset:4608
    v_mfma_f32_16x16x32_bf16 v[28:31], v[72:75], v[68:71], v[28:31]
    v_mfma_f32_16x16x32_bf16 v[44:47], v[72:75], v[152:155], v[44:47]
    s_waitcnt lgkmcnt(15)
    v_mfma_f32_16x16x32_bf16 v[16:19], v[104:107], v[84:87], v[16:19]
    ds_read_b64_tr_b16 v[116:117], v10 offset:24576
    v_mfma_f32_16x16x32_bf16 v[32:35], v[104:107], v[92:95], v[32:35]
    ds_read_b64_tr_b16 v[118:119], v10 offset:25088
    ds_read_b64_tr_b16 v[96:97], v11 offset:24576
    s_waitcnt lgkmcnt(15)
    v_mfma_f32_16x16x32_bf16 v[20:23], v[48:51], v[84:87], v[20:23]
    ds_read_b64_tr_b16 v[98:99], v11 offset:25088
    s_waitcnt lgkmcnt(4)
    s_mov_b64 exec, 1
    ds_add_u32 v4, v164 offset:0
    s_mov_b64 exec, -1
    v_mfma_f32_16x16x32_bf16 v[36:39], v[48:51], v[92:95], v[36:39]
    ds_read_b64_tr_b16 v[68:69], v12 offset:24576
    ds_read_b64_tr_b16 v[70:71], v12 offset:25088
    v_mfma_f32_16x16x32_bf16 v[24:27], v[128:131], v[84:87], v[24:27]
    ds_read_b64_tr_b16 v[72:73], v13 offset:24576
    v_mfma_f32_16x16x32_bf16 v[40:43], v[128:131], v[92:95], v[40:43]
    ds_read_b64_tr_b16 v[74:75], v13 offset:25088
    v_mfma_f32_16x16x32_bf16 v[28:31], v[52:55], v[84:87], v[28:31]
    v_mfma_f32_16x16x32_bf16 v[44:47], v[52:55], v[92:95], v[44:47]
    v_mfma_f32_16x16x32_bf16 v[16:19], v[60:63], v[100:103], v[16:19]
    ds_read_b64_tr_b16 v[152:153], v10 offset:28672
    v_mfma_f32_16x16x32_bf16 v[32:35], v[60:63], v[108:111], v[32:35]
    ds_read_b64_tr_b16 v[154:155], v10 offset:29184
    ds_read_b64_tr_b16 v[104:105], v11 offset:28672
    v_mfma_f32_16x16x32_bf16 v[20:23], v[136:139], v[100:103], v[20:23]
    ds_read_b64_tr_b16 v[106:107], v11 offset:29184
    v_mfma_f32_16x16x32_bf16 v[36:39], v[136:139], v[108:111], v[36:39]
    ds_read_b64_tr_b16 v[48:49], v12 offset:28672
    ds_read_b64_tr_b16 v[50:51], v12 offset:29184
    v_mfma_f32_16x16x32_bf16 v[24:27], v[132:135], v[100:103], v[24:27]
    s_waitcnt lgkmcnt(8)
    ds_read_b64_tr_b16 v[128:129], v13 offset:28672
    v_mfma_f32_16x16x32_bf16 v[40:43], v[132:135], v[108:111], v[40:43]
    ds_read_b64_tr_b16 v[130:131], v13 offset:29184
    v_mfma_f32_16x16x32_bf16 v[28:31], v[160:163], v[100:103], v[28:31]
    v_mfma_f32_16x16x32_bf16 v[44:47], v[160:163], v[108:111], v[44:47]
    s_waitcnt lgkmcnt(15)
    v_mfma_f32_16x16x32_bf16 v[16:19], v[116:119], v[56:59], v[16:19]
    ds_read_b64_tr_b16 v[84:85], v10 offset:16384
    v_mfma_f32_16x16x32_bf16 v[32:35], v[116:119], v[124:127], v[32:35]
    ds_read_b64_tr_b16 v[86:87], v10 offset:16896
    ds_read_b64_tr_b16 v[52:53], v11 offset:16384
    s_waitcnt lgkmcnt(15)
    v_mfma_f32_16x16x32_bf16 v[20:23], v[96:99], v[56:59], v[20:23]
    ds_read_b64_tr_b16 v[54:55], v11 offset:16896
    s_waitcnt lgkmcnt(4)
    s_mov_b64 exec, 1
    ds_add_u32 v4, v164 offset:0
    s_mov_b64 exec, -1
    v_mfma_f32_16x16x32_bf16 v[36:39], v[96:99], v[124:127], v[36:39]
    ds_read_b64_tr_b16 v[92:93], v12 offset:16384
    ds_read_b64_tr_b16 v[94:95], v12 offset:16896
    v_mfma_f32_16x16x32_bf16 v[24:27], v[68:71], v[56:59], v[24:27]
    ds_read_b64_tr_b16 v[60:61], v13 offset:16384
    v_mfma_f32_16x16x32_bf16 v[40:43], v[68:71], v[124:127], v[40:43]
    ds_read_b64_tr_b16 v[62:63], v13 offset:16896
    v_mfma_f32_16x16x32_bf16 v[28:31], v[72:75], v[56:59], v[28:31]
    v_mfma_f32_16x16x32_bf16 v[44:47], v[72:75], v[124:127], v[44:47]
    v_mfma_f32_16x16x32_bf16 v[16:19], v[152:155], v[76:79], v[16:19]
    ds_read_b64_tr_b16 v[136:137], v10 offset:20480
    v_mfma_f32_16x16x32_bf16 v[32:35], v[152:155], v[148:151], v[32:35]
    ds_read_b64_tr_b16 v[138:139], v10 offset:20992
    ds_read_b64_tr_b16 v[132:133], v11 offset:20480
    v_mfma_f32_16x16x32_bf16 v[20:23], v[104:107], v[76:79], v[20:23]
    ds_read_b64_tr_b16 v[134:135], v11 offset:20992
    v_mfma_f32_16x16x32_bf16 v[36:39], v[104:107], v[148:151], v[36:39]
    ds_read_b64_tr_b16 v[100:101], v12 offset:20480
    ds_read_b64_tr_b16 v[102:103], v12 offset:20992
    v_mfma_f32_16x16x32_bf16 v[24:27], v[48:51], v[76:79], v[24:27]
    s_waitcnt lgkmcnt(8)
    ds_read_b64_tr_b16 v[160:161], v13 offset:20480
    v_mfma_f32_16x16x32_bf16 v[40:43], v[48:51], v[148:151], v[40:43]
    ds_read_b64_tr_b16 v[162:163], v13 offset:20992
    v_mfma_f32_16x16x32_bf16 v[28:31], v[128:131], v[76:79], v[28:31]
    v_mfma_f32_16x16x32_bf16 v[44:47], v[128:131], v[148:151], v[44:47]
    s_waitcnt lgkmcnt(15)
    v_mfma_f32_16x16x32_bf16 v[16:19], v[84:87], v[88:91], v[16:19]
    ds_read_b64_tr_b16 v[108:109], v10 offset:32768
    v_mfma_f32_16x16x32_bf16 v[32:35], v[84:87], v[64:67], v[32:35]
    ds_read_b64_tr_b16 v[110:111], v10 offset:33280
    ds_read_b64_tr_b16 v[116:117], v11 offset:32768
    s_waitcnt lgkmcnt(15)
    v_mfma_f32_16x16x32_bf16 v[20:23], v[52:55], v[88:91], v[20:23]
    ds_read_b64_tr_b16 v[118:119], v11 offset:33280
    s_waitcnt lgkmcnt(4)
    s_mov_b64 exec, 1
    ds_add_u32 v4, v164 offset:0
    s_mov_b64 exec, -1
    v_mfma_f32_16x16x32_bf16 v[36:39], v[52:55], v[64:67], v[36:39]
    ds_read_b64_tr_b16 v[96:97], v12 offset:32768
    ds_read_b64_tr_b16 v[98:99], v12 offset:33280
    v_mfma_f32_16x16x32_bf16 v[24:27], v[92:95], v[88:91], v[24:27]
    ds_read_b64_tr_b16 v[68:69], v13 offset:32768
    v_mfma_f32_16x16x32_bf16 v[40:43], v[92:95], v[64:67], v[40:43]
    ds_read_b64_tr_b16 v[70:71], v13 offset:33280
    v_mfma_f32_16x16x32_bf16 v[28:31], v[60:63], v[88:91], v[28:31]
    v_mfma_f32_16x16x32_bf16 v[44:47], v[60:63], v[64:67], v[44:47]
    v_mfma_f32_16x16x32_bf16 v[16:19], v[136:139], v[80:83], v[16:19]
    ds_read_b64_tr_b16 v[56:57], v10 offset:36864
    v_mfma_f32_16x16x32_bf16 v[32:35], v[136:139], v[112:115], v[32:35]
    ds_read_b64_tr_b16 v[58:59], v10 offset:37376
    ds_read_b64_tr_b16 v[72:73], v11 offset:36864
    v_mfma_f32_16x16x32_bf16 v[20:23], v[132:135], v[80:83], v[20:23]
    ds_read_b64_tr_b16 v[74:75], v11 offset:37376
    v_mfma_f32_16x16x32_bf16 v[36:39], v[132:135], v[112:115], v[36:39]
    ds_read_b64_tr_b16 v[124:125], v12 offset:36864
    ds_read_b64_tr_b16 v[126:127], v12 offset:37376
    v_mfma_f32_16x16x32_bf16 v[24:27], v[100:103], v[80:83], v[24:27]
    s_waitcnt lgkmcnt(8)
    ds_read_b64_tr_b16 v[152:153], v13 offset:36864
    v_mfma_f32_16x16x32_bf16 v[40:43], v[100:103], v[112:115], v[40:43]
    ds_read_b64_tr_b16 v[154:155], v13 offset:37376
    v_mfma_f32_16x16x32_bf16 v[28:31], v[160:163], v[80:83], v[28:31]
    v_mfma_f32_16x16x32_bf16 v[44:47], v[160:163], v[112:115], v[44:47]
    s_waitcnt lgkmcnt(15)
    v_mfma_f32_16x16x32_bf16 v[16:19], v[108:111], v[140:143], v[16:19]
    v_mfma_f32_16x16x32_bf16 v[32:35], v[108:111], v[120:123], v[32:35]
    s_waitcnt lgkmcnt(13)
    v_mfma_f32_16x16x32_bf16 v[20:23], v[116:119], v[140:143], v[20:23]
    s_waitcnt lgkmcnt(0)
    s_mov_b64 exec, 1
    ds_add_u32 v4, v164 offset:0
    s_mov_b64 exec, -1
    v_mfma_f32_16x16x32_bf16 v[36:39], v[116:119], v[120:123], v[36:39]
    v_mfma_f32_16x16x32_bf16 v[24:27], v[96:99], v[140:143], v[24:27]
    v_mfma_f32_16x16x32_bf16 v[40:43], v[96:99], v[120:123], v[40:43]
    v_mfma_f32_16x16x32_bf16 v[28:31], v[68:71], v[140:143], v[28:31]
    v_mfma_f32_16x16x32_bf16 v[44:47], v[68:71], v[120:123], v[44:47]
    v_mfma_f32_16x16x32_bf16 v[16:19], v[56:59], v[144:147], v[16:19]
    v_mfma_f32_16x16x32_bf16 v[32:35], v[56:59], v[156:159], v[32:35]
    v_mfma_f32_16x16x32_bf16 v[20:23], v[72:75], v[144:147], v[20:23]
    v_mfma_f32_16x16x32_bf16 v[36:39], v[72:75], v[156:159], v[36:39]
    v_mfma_f32_16x16x32_bf16 v[24:27], v[124:127], v[144:147], v[24:27]
    v_mfma_f32_16x16x32_bf16 v[40:43], v[124:127], v[156:159], v[40:43]
    v_mfma_f32_16x16x32_bf16 v[28:31], v[152:155], v[144:147], v[28:31]
    v_mfma_f32_16x16x32_bf16 v[44:47], v[152:155], v[156:159], v[44:47]
    s_setprio 3
    s_mov_b32 s40, 0x21317218
    s_mov_b32 s41, s40
    s_mov_b32 s74, 0x358637bd
    s_mov_b32 s75, s74
    s_mov_b32 s76, 0x5d800000
    s_mov_b32 s77, s76
    v_and_b32 v2, 15, v0
    v_lshlrev_b32 v2, 2, v2
    s_lshl_b32 s42, s3, 7
    s_add_u32 s42, s42, 155648
    v_add_u32 v2, s42, v2
    v_add_u32 v3, 1024, v2
    v_and_b32_e64 v5, 0x30, v0
    v_add_u32 v5, 158208, v5

    ds_read2_b32 v[48:49], v2 offset0:0 offset1:0
    ds_read2_b32 v[50:51], v2 offset0:16 offset1:16
    ds_read_b128 v[56:59], v5 offset:0
    ds_read_b128 v[60:63], v5 offset:64
    ds_read_b128 v[64:67], v5 offset:128
    ds_read_b128 v[68:71], v5 offset:192
    ds_read2_b32 v[52:53], v3 offset0:0 offset1:0
    ds_read2_b32 v[54:55], v3 offset0:16 offset1:16
    v_lshlrev_b32 v6, 4, v0
    v_lshlrev_b32 v8, 2, v0
    v_add_u32 v8, 65536, v8
    s_lshl_b32 s79, s32, 18
    s_lshl_b32 s80, s3, 16
    s_add_u32 s79, s79, s80
    s_lshl_b32 s80, s10, 11
    s_add_u32 s79, s79, s80
    s_add_u32 s80, s79, 0x8000
    s_lshl_b32 s45, s32, 2
    s_add_u32 s45, s45, s3
    s_lshl_b32 s45, s45, 9
    s_mov_b32 s46, 0x3fb8aa3b
    v_mov_b32 v11, 0x35c1a2a0

    s_add_u32 s54, s45, 0x831000
    s_add_u32 s54, s72, s54
    s_addc_u32 s55, s73, 0
    s_waitcnt lgkmcnt(5)
    v_pk_fma_f32 v[16:17], v[56:57], v[48:49], v[16:17]
    v_pk_fma_f32 v[18:19], v[58:59], v[48:49], v[18:19]
    v_pk_fma_f32 v[32:33], v[56:57], v[50:51], v[32:33]
    v_pk_fma_f32 v[34:35], v[58:59], v[50:51], v[34:35]
    s_waitcnt lgkmcnt(4)
    v_pk_fma_f32 v[20:21], v[60:61], v[48:49], v[20:21]
    v_pk_fma_f32 v[22:23], v[62:63], v[48:49], v[22:23]
    v_pk_fma_f32 v[36:37], v[60:61], v[50:51], v[36:37]
    v_pk_fma_f32 v[38:39], v[62:63], v[50:51], v[38:39]
    s_waitcnt lgkmcnt(3)
    v_pk_fma_f32 v[24:25], v[64:65], v[48:49], v[24:25]
    s_branch IW_s2
IW_w2:
    s_branch IW_r2
IW_s2:
    v_pk_fma_f32 v[26:27], v[66:67], v[48:49], v[26:27]
    v_pk_fma_f32 v[40:41], v[64:65], v[50:51], v[40:41]
    v_pk_fma_f32 v[42:43], v[66:67], v[50:51], v[42:43]
    s_waitcnt lgkmcnt(2)
    v_pk_fma_f32 v[28:29], v[68:69], v[48:49], v[28:29]
    v_pk_fma_f32 v[30:31], v[70:71], v[48:49], v[30:31]
    v_pk_fma_f32 v[44:45], v[68:69], v[50:51], v[44:45]
    v_pk_fma_f32 v[46:47], v[70:71], v[50:51], v[46:47]
    s_waitcnt lgkmcnt(1)
    s_nop 0
    v_pk_mul_f32 v[16:17], v[16:17], v[52:53]
    v_pk_mul_f32 v[18:19], v[18:19], v[52:53]
    v_pk_mul_f32 v[20:21], v[20:21], v[52:53]
    v_pk_mul_f32 v[22:23], v[22:23], v[52:53]
    v_pk_mul_f32 v[24:25], v[24:25], v[52:53]
    v_pk_mul_f32 v[26:27], v[26:27], v[52:53]
    v_pk_mul_f32 v[28:29], v[28:29], v[52:53]
    v_pk_mul_f32 v[30:31], v[30:31], v[52:53]
    s_waitcnt lgkmcnt(0)
    s_nop 0
    v_pk_mul_f32 v[32:33], v[32:33], v[54:55]
    v_pk_mul_f32 v[34:35], v[34:35], v[54:55]
    v_pk_mul_f32 v[36:37], v[36:37], v[54:55]
    v_pk_mul_f32 v[38:39], v[38:39], v[54:55]
    v_pk_mul_f32 v[40:41], v[40:41], v[54:55]
    v_pk_mul_f32 v[42:43], v[42:43], v[54:55]
    v_pk_mul_f32 v[44:45], v[44:45], v[54:55]
    v_pk_mul_f32 v[46:47], v[46:47], v[54:55]
    v_exp_f32 v80, v16 clamp
    v_exp_f32 v81, v17 clamp
    v_exp_f32 v82, v18 clamp
    v_exp_f32 v83, v19 clamp
    v_exp_f32 v84, v20 clamp
    v_exp_f32 v85, v21 clamp
    v_exp_f32 v86, v22 clamp
    v_exp_f32 v87, v23 clamp
    v_exp_f32 v88, v24 clamp
    v_exp_f32 v89, v25 clamp
    v_exp_f32 v90, v26 clamp
    v_exp_f32 v91, v27 clamp
    v_exp_f32 v92, v28 clamp
    v_exp_f32 v93, v29 clamp
    v_exp_f32 v94, v30 clamp
    v_exp_f32 v95, v31 clamp
    v_exp_f32 v96, v32 clamp
    v_exp_f32 v97, v33 clamp
    v_exp_f32 v98, v34 clamp
    v_exp_f32 v99, v35 clamp
    v_exp_f32 v100, v36 clamp
    v_exp_f32 v101, v37 clamp
    v_exp_f32 v102, v38 clamp
    v_exp_f32 v103, v39 clamp
    v_exp_f32 v104, v40 clamp
    v_exp_f32 v105, v41 clamp
    v_exp_f32 v106, v42 clamp
    v_exp_f32 v107, v43 clamp
    v_exp_f32 v108, v44 clamp
    v_exp_f32 v109, v45 clamp
    v_exp_f32 v110, v46 clamp
    v_exp_f32 v111, v47 clamp
    v_pk_mul_f32 v[16:17], v[16:17], s[40:41] clamp
    v_pk_mul_f32 v[18:19], v[18:19], s[40:41] clamp
    v_pk_mul_f32 v[20:21], v[20:21], s[40:41] clamp
    v_pk_mul_f32 v[22:23], v[22:23], s[40:41] clamp
    v_pk_mul_f32 v[24:25], v[24:25], s[40:41] clamp
    v_pk_mul_f32 v[26:27], v[26:27], s[40:41] clamp
    v_pk_mul_f32 v[28:29], v[28:29], s[40:41] clamp
    v_pk_mul_f32 v[30:31], v[30:31], s[40:41] clamp
    v_pk_mul_f32 v[32:33], v[32:33], s[40:41] clamp
    v_pk_mul_f32 v[34:35], v[34:35], s[40:41] clamp
    v_pk_mul_f32 v[36:37], v[36:37], s[40:41] clamp
    v_pk_mul_f32 v[38:39], v[38:39], s[40:41] clamp
    v_pk_mul_f32 v[40:41], v[40:41], s[40:41] clamp
    v_pk_mul_f32 v[42:43], v[42:43], s[40:41] clamp
    v_pk_mul_f32 v[44:45], v[44:45], s[40:41] clamp
    v_pk_mul_f32 v[46:47], v[46:47], s[40:41] clamp
    v_pk_add_f32 v[80:81], v[80:81], s[74:75]
    v_pk_add_f32 v[82:83], v[82:83], s[74:75]
    v_pk_add_f32 v[84:85], v[84:85], s[74:75]
    v_pk_add_f32 v[86:87], v[86:87], s[74:75]
    v_pk_add_f32 v[88:89], v[88:89], s[74:75]
    v_pk_add_f32 v[90:91], v[90:91], s[74:75]
    v_pk_add_f32 v[92:93], v[92:93], s[74:75]
    v_pk_add_f32 v[94:95], v[94:95], s[74:75]
    v_pk_add_f32 v[96:97], v[96:97], s[74:75]
    v_pk_add_f32 v[98:99], v[98:99], s[74:75]
    v_pk_add_f32 v[100:101], v[100:101], s[74:75]
    v_pk_add_f32 v[102:103], v[102:103], s[74:75]
    v_pk_add_f32 v[104:105], v[104:105], s[74:75]
    v_pk_add_f32 v[106:107], v[106:107], s[74:75]
    v_pk_add_f32 v[108:109], v[108:109], s[74:75]
    v_pk_add_f32 v[110:111], v[110:111], s[74:75]
    v_pk_fma_f32 v[16:17], v[16:17], s[76:77], v[80:81]
    v_pk_fma_f32 v[18:19], v[18:19], s[76:77], v[82:83]
    v_pk_fma_f32 v[20:21], v[20:21], s[76:77], v[84:85]
    v_pk_fma_f32 v[22:23], v[22:23], s[76:77], v[86:87]
    v_pk_fma_f32 v[24:25], v[24:25], s[76:77], v[88:89]
    v_pk_fma_f32 v[26:27], v[26:27], s[76:77], v[90:91]
    v_pk_fma_f32 v[28:29], v[28:29], s[76:77], v[92:93]
    v_pk_fma_f32 v[30:31], v[30:31], s[76:77], v[94:95]
    v_pk_fma_f32 v[32:33], v[32:33], s[76:77], v[96:97]
    v_pk_fma_f32 v[34:35], v[34:35], s[76:77], v[98:99]
    v_pk_fma_f32 v[36:37], v[36:37], s[76:77], v[100:101]
    v_pk_fma_f32 v[38:39], v[38:39], s[76:77], v[102:103]
    v_pk_fma_f32 v[40:41], v[40:41], s[76:77], v[104:105]
    v_pk_fma_f32 v[42:43], v[42:43], s[76:77], v[106:107]
    v_pk_fma_f32 v[44:45], v[44:45], s[76:77], v[108:109]
    v_pk_fma_f32 v[46:47], v[46:47], s[76:77], v[110:111]
    v_cvt_pk_bf16_f32 v112, v16, v17
    v_cvt_pk_bf16_f32 v113, v18, v19
    v_cvt_pk_bf16_f32 v114, v20, v21
    v_cvt_pk_bf16_f32 v115, v22, v23
    v_cvt_pk_bf16_f32 v116, v24, v25
    v_cvt_pk_bf16_f32 v117, v26, v27
    v_cvt_pk_bf16_f32 v118, v28, v29
    v_cvt_pk_bf16_f32 v119, v30, v31
    v_cvt_pk_bf16_f32 v120, v32, v33
    v_cvt_pk_bf16_f32 v121, v34, v35
    v_cvt_pk_bf16_f32 v122, v36, v37
    v_cvt_pk_bf16_f32 v123, v38, v39
    v_cvt_pk_bf16_f32 v124, v40, v41
    v_cvt_pk_bf16_f32 v125, v42, v43
    v_cvt_pk_bf16_f32 v126, v44, v45
    v_cvt_pk_bf16_f32 v127, v46, v47
    v_and_b32 v9, 0xfffffff7, v1
    v_and_b32 v5, 0x30, v0
    v_add_u32 v5, 159232, v5
    ds_read_b32 v7, v9 offset:128
FW_5:
    s_waitcnt lgkmcnt(0)
    v_cmp_gt_u32 vcc, 1, v7
    s_cbranch_vccz FO_6
    s_sleep 1
    ds_read_b32 v7, v9 offset:128
    s_branch FW_5
FO_6:
    ds_read_b32 v7, v9 offset:128
FW_7:
    s_waitcnt lgkmcnt(0)
    v_cmp_gt_u32 vcc, 2, v7
    s_cbranch_vccz FO_8
    ds_read_b32 v7, v9 offset:128
    s_branch FW_7
FO_8:
    s_nop 0
    ds_read_b128 v[32:35], v5 offset:0
    ds_read_b128 v[36:39], v5 offset:64
    ds_read2st64_b32 v[16:17], v8 offset0:0 offset1:1
    ds_read2st64_b32 v[18:19], v8 offset0:2 offset1:3
    ds_read2st64_b32 v[20:21], v8 offset0:4 offset1:5
    ds_read2st64_b32 v[22:23], v8 offset0:6 offset1:7
    ds_read2st64_b32 v[24:25], v8 offset0:16 offset1:17
    ds_read2st64_b32 v[26:27], v8 offset0:18 offset1:19
    ds_read2st64_b32 v[28:29], v8 offset0:20 offset1:21
    ds_read2st64_b32 v[30:31], v8 offset0:22 offset1:23
    s_waitcnt lgkmcnt(5)
    s_nop 0
    ds_read_b128 v[56:59], v5 offset:128
    ds_read_b128 v[60:63], v5 offset:192
    ds_read2st64_b32 v[40:41], v8 offset0:8 offset1:9
    ds_read2st64_b32 v[42:43], v8 offset0:10 offset1:11
    ds_read2st64_b32 v[44:45], v8 offset0:12 offset1:13
    ds_read2st64_b32 v[46:47], v8 offset0:14 offset1:15
    ds_read2st64_b32 v[48:49], v8 offset0:24 offset1:25
    ds_read2st64_b32 v[50:51], v8 offset0:26 offset1:27
    ds_read2st64_b32 v[52:53], v8 offset0:28 offset1:29
    ds_read2st64_b32 v[54:55], v8 offset0:30 offset1:31
    s_waitcnt lgkmcnt(10)
    s_nop 0
    v_cvt_pk_bf16_f32 v128, v16, v17
    v_cvt_pk_bf16_f32 v129, v18, v19
    v_cvt_pk_bf16_f32 v130, v20, v21
    v_cvt_pk_bf16_f32 v131, v22, v23
    v_cvt_pk_bf16_f32 v132, v24, v25
    v_cvt_pk_bf16_f32 v133, v26, v27
    v_cvt_pk_bf16_f32 v134, v28, v29
    v_cvt_pk_bf16_f32 v135, v30, v31
    v_cvt_pk_bf16_f32 v136, v32, v33
    v_cvt_pk_bf16_f32 v137, v34, v35
    v_cvt_pk_bf16_f32 v138, v36, v37
    v_cvt_pk_bf16_f32 v139, v38, v39
    s_nop 1
    v_mfma_f32_16x16x32_bf16 v[72:75], v[136:139], v[112:115], 0
    v_mfma_f32_16x16x32_bf16 v[64:67], v[128:131], v[112:115], 0
    v_mfma_f32_16x16x32_bf16 v[68:71], v[132:135], v[112:115], 0
    v_mfma_f32_16x16x32_bf16 v[84:87], v[136:139], v[120:123], 0
    v_mfma_f32_16x16x32_bf16 v[76:79], v[128:131], v[120:123], 0
    v_mfma_f32_16x16x32_bf16 v[80:83], v[132:135], v[120:123], 0
    s_waitcnt lgkmcnt(0)
    v_cvt_pk_bf16_f32 v140, v40, v41
    v_cvt_pk_bf16_f32 v141, v42, v43
    v_cvt_pk_bf16_f32 v142, v44, v45
    v_cvt_pk_bf16_f32 v143, v46, v47
    v_cvt_pk_bf16_f32 v144, v48, v49
    v_cvt_pk_bf16_f32 v145, v50, v51
    v_cvt_pk_bf16_f32 v146, v52, v53
    v_cvt_pk_bf16_f32 v147, v54, v55
    v_cvt_pk_bf16_f32 v148, v56, v57
    v_cvt_pk_bf16_f32 v149, v58, v59
    v_cvt_pk_bf16_f32 v150, v60, v61
    v_cvt_pk_bf16_f32 v151, v62, v63
    s_nop 1
    v_mfma_f32_16x16x32_bf16 v[96:99], v[148:151], v[116:119], 0
    v_mfma_f32_16x16x32_bf16 v[88:91], v[140:143], v[116:119], 0
    v_mfma_f32_16x16x32_bf16 v[92:95], v[144:147], v[116:119], 0
    v_mfma_f32_16x16x32_bf16 v[108:111], v[148:151], v[124:127], 0
    v_mfma_f32_16x16x32_bf16 v[100:103], v[140:143], v[124:127], 0
    v_mfma_f32_16x16x32_bf16 v[104:107], v[144:147], v[124:127], 0
    v_fma_f32 v72, v72, s46, v11
    v_rcp_f32 v72, v72
    s_nop 0
    v_mul_f32 v64, v64, v72
    v_mul_f32 v65, v65, v72
    v_mul_f32 v66, v66, v72
    v_mul_f32 v67, v67, v72
    v_mul_f32 v68, v68, v72
    v_mul_f32 v69, v69, v72
    v_mul_f32 v70, v70, v72
    v_mul_f32 v71, v71, v72
    v_cvt_pk_bf16_f32 v16, v64, v65
    v_cvt_pk_bf16_f32 v17, v66, v67
    v_cvt_pk_bf16_f32 v18, v68, v69
    v_cvt_pk_bf16_f32 v19, v70, v71
    buffer_store_dwordx4 v[16:19], v6, s[16:19], s79 offen offset:0 sc0 sc1
    v_fma_f32 v84, v84, s46, v11
    v_rcp_f32 v84, v84
    s_nop 0
    v_mul_f32 v76, v76, v84
    v_mul_f32 v77, v77, v84
    v_mul_f32 v78, v78, v84
    v_mul_f32 v79, v79, v84
    v_mul_f32 v80, v80, v84
    v_mul_f32 v81, v81, v84
    v_mul_f32 v82, v82, v84
    v_mul_f32 v83, v83, v84
    v_cvt_pk_bf16_f32 v20, v76, v77
    v_cvt_pk_bf16_f32 v21, v78, v79
    v_cvt_pk_bf16_f32 v22, v80, v81
    v_cvt_pk_bf16_f32 v23, v82, v83
    buffer_store_dwordx4 v[20:23], v6, s[16:19], s80 offen offset:0 sc0 sc1
    v_fma_f32 v96, v96, s46, v11
    v_rcp_f32 v96, v96
    s_nop 0
    v_mul_f32 v88, v88, v96
    v_mul_f32 v89, v89, v96
    v_mul_f32 v90, v90, v96
    v_mul_f32 v91, v91, v96
    v_mul_f32 v92, v92, v96
    v_mul_f32 v93, v93, v96
    v_mul_f32 v94, v94, v96
    v_mul_f32 v95, v95, v96
    v_cvt_pk_bf16_f32 v24, v88, v89
    v_cvt_pk_bf16_f32 v25, v90, v91
    v_cvt_pk_bf16_f32 v26, v92, v93
    v_cvt_pk_bf16_f32 v27, v94, v95
    buffer_store_dwordx4 v[24:27], v6, s[16:19], s79 offen offset:1024 sc0 sc1
    v_fma_f32 v108, v108, s46, v11
    v_rcp_f32 v108, v108
    s_nop 0
    v_mul_f32 v100, v100, v108
    v_mul_f32 v101, v101, v108
    v_mul_f32 v102, v102, v108
    v_mul_f32 v103, v103, v108
    v_mul_f32 v104, v104, v108
    v_mul_f32 v105, v105, v108
    v_mul_f32 v106, v106, v108
    v_mul_f32 v107, v107, v108
    v_cvt_pk_bf16_f32 v28, v100, v101
    v_cvt_pk_bf16_f32 v29, v102, v103
    v_cvt_pk_bf16_f32 v30, v104, v105
    v_cvt_pk_bf16_f32 v31, v106, v107
    buffer_store_dwordx4 v[28:31], v6, s[16:19], s80 offen offset:1024 sc0 sc1
    s_mov_b64 exec, 1
    ds_write_b32 v4, v164 offset:144
    s_waitcnt vmcnt(0)
    s_mov_b32 s45, 1
    s_atomic_add s45, s[54:55], 0x0
    s_atomic_add s45, s[54:55], 0x80
    s_atomic_add s45, s[54:55], 0x100
    s_atomic_add s45, s[54:55], 0x180
    ds_add_u32 v4, v164 offset:144
    s_mov_b64 exec, -1
    s_cmp_lg_u32 s3, 0
    s_cbranch_scc1 F_end
    s_setprio 0
    s_lshr_b32 s50, s29, 1
    s_lshl_b32 s50, s50, 2
    s_and_b32 s51, s28, 3
    s_add_u32 s50, s50, s51
    s_lshl_b32 s50, s50, 7
    s_add_u32 s56, s50, 0x839000
    s_add_u32 s56, s72, s56
    s_addc_u32 s57, s73, 0
    v_mov_b32 v2, 159096
    ds_read_b32 v7, v2 offset:0
FW_9:
    s_waitcnt lgkmcnt(0)
    v_cmp_gt_u32 vcc, 1, v7
    s_cbranch_vccz FO_10
    s_sleep 2
    ds_read_b32 v7, v2 offset:0
    s_branch FW_9
FO_10:
    v_and_b32 v2, 7, v0
    v_lshlrev_b32 v2, 2, v2
    v_add_u32 v2, 158976, v2
    ds_read_b32 v2, v2
    s_sub_u32 s51, 15, s28
    s_waitcnt lgkmcnt(0)
    v_bfe_u32 v2, v2, 7, 4
    v_cmp_eq_u32 vcc, s51, v2
    s_cbranch_vccz F_ny

    v_lshrrev_b32 v2, 4, v0
    v_and_b32 v6, 15, v0
    v_lshlrev_b32 v6, 4, v6
    v_lshl_add_u32 v2, v2, 12, v6
    s_lshl_b32 s50, s29, 8
    s_add_u32 s50, s50, 135168

SP_11:
    s_load_dword s58, s[56:57], 0 glc
    s_waitcnt lgkmcnt(0)
    s_cmp_ge_u32 s58, 32
    s_cbranch_scc1 SD_12
    s_sleep 4
    s_branch SP_11
SD_12:
    s_mov_b32 m0, 159744
    s_nop 0
    buffer_load_dwordx4 v2, s[24:27], s50 offen sc0 sc1 lds
    s_add_u32 s50, s50, 16384
    s_add_u32 m0, m0, 1024
    s_nop 0
    buffer_load_dwordx4 v2, s[24:27], s50 offen sc0 sc1 lds
    s_waitcnt vmcnt(0)
    v_mov_b32 v7, 1
    s_mov_b64 exec, 1
    ds_write_b32 v4, v7 offset:96
    s_mov_b64 exec, -1
F_ny:
F_end:
    s_endpgm
F_nl:
    s_sub_u32 s3, s3, 4
    s_setprio 2
    s_lshr_b32 s36, s3, 1
    s_and_b32 s37, s3, 1
    v_and_b32 v1, 15, v0
    v_lshrrev_b32 v2, 4, v0
    v_lshrrev_b32 v3, 1, v1
    v_xor_b32 v3, v3, v2
    v_lshlrev_b32 v3, 4, v3
    v_lshlrev_b32 v1, 7, v1
    s_lshl_b32 s38, s36, 13
    v_add3_u32 v4, v1, v3, s38
    v_xor_b32 v5, 64, v4
    v_add_u32 v6, 0x10000, v4
    v_add_u32 v7, 0x10000, v5
    v_bfe_u32 v1, v0, 2, 2
    v_lshl_add_u32 v3, v2, 3, v1
    v_lshrrev_b32 v1, 1, v1
    v_and_b32 v2, 1, v2
    v_lshl_add_u32 v1, v2, 1, v1
    s_lshl_b32 s38, s37, 1
    s_add_u32 s38, s38, s36
    v_xor_b32 v1, s38, v1
    v_lshlrev_b32 v1, 5, v1
    v_lshl_add_u32 v1, v3, 7, v1
    v_and_b32 v2, 3, v0
    v_lshl_add_u32 v1, v2, 3, v1
    v_add_u32 v8, 0x10000, v1
    v_xor_b32 v9, 32, v8
    v_add_u32 v10, 0x8000, v8
    v_add_u32 v11, 0x8000, v9
    s_mov_b32 s40, 0x21317218
    s_mov_b32 s41, s40
    s_mov_b32 s74, 0x358637bd
    s_mov_b32 s75, s74
    s_mov_b32 s76, 0x5d800000
    s_mov_b32 s77, s76
    v_and_b32 v164, 0x30, v0
    s_lshl_b32 s42, s36, 8
    s_add_u32 s42, s42, 155648
    v_add_u32 v164, s42, v164
    v_and_b32 v165, 15, v0
    v_lshlrev_b32 v165, 2, v165
    s_lshl_b32 s42, s38, 6
    s_add_u32 s42, s42, 158208
    v_add_u32 v165, s42, v165
    s_lshl_b32 s42, s3, 2
    s_add_u32 s42, s42, 159040
    v_mov_b32 v3, s42
    v_lshlrev_b32 v1, 2, v2
    v_add_u32 v1, 159040, v1
    v_xor_b32 v2, 64, v165
    s_lshl_b32 s44, s33, 1
    s_add_u32 s44, s44, s37
    s_mul_i32 s45, s44, 4224
    s_mul_i32 s46, s36, 3072
    s_add_u32 s46, s46, s45
    s_lshl_b32 s47, s36, 10
    s_add_u32 s47, s47, 1024
    s_add_u32 s47, s47, s45
    s_lshl_b32 s48, s36, 6
    s_add_u32 s48, s48, 4096
    s_add_u32 s48, s48, s45
    s_lshl_b32 s49, s44, 9
    s_lshl_b32 s52, s3, 11
    s_add_u32 s52, s52, 65536
    s_lshl_b32 s53, s3, 7
    s_lshl_b32 s43, s36, 6
    s_add_u32 s53, s53, s43
    s_add_u32 s53, s53, 159232
    s_mov_b32 s50, 159068
    s_waitcnt lgkmcnt(0)
    s_lshl_b32 s64, s28, 7
    s_lshl_b32 s65, s3, 5
    s_add_u32 s64, s64, s65
    s_lshl_b32 s42, s64, 11
    s_lshl_b32 s65, s29, 7
    s_add_u32 s42, s42, s65
    s_add_u32 s43, s42, 0x8000
    s_lshl_b32 s66, s44, 1
    s_add_u32 s66, s66, s36
    s_lshl_b32 s66, s66, 4
    s_add_u32 s66, s66, s32
    s_lshl_b32 s66, s66, 10

    s_mov_b32 s12, s4
    s_mov_b32 s13, s5
    s_mov_b32 s14, 0x400000
    s_mov_b32 s15, 0x00020000
    s_mov_b32 s16, s6
    s_mov_b32 s17, s7
    s_mov_b32 s18, 0x600000
    s_mov_b32 s19, 0x00020000
    s_mov_b32 s20, s8
    s_mov_b32 s21, s9
    s_mov_b32 s22, 0x200000
    s_mov_b32 s23, 0x00020000
    s_add_u32 s24, s72, 0x800000
    s_addc_u32 s25, s73, 0
    s_mov_b32 s26, 0x48000
    s_mov_b32 s27, 0x00020000
    s_add_u32 s84, s72, 0xa00000
    s_addc_u32 s85, s73, 0
    s_mov_b32 s86, 0x100000
    s_mov_b32 s87, 0x00020000
    s_barrier
    s_nop 0
    ds_read_b128 v[12:15], v4 offset:0
    ds_read_b64_tr_b16 v[44:45], v8 offset:0
    ds_read_b64_tr_b16 v[46:47], v8 offset:512
    ds_read_b128 v[16:19], v4 offset:2048
    ds_read_b128 v[20:23], v4 offset:4096
    ds_read_b128 v[24:27], v4 offset:6144
    ds_read_b64_tr_b16 v[48:49], v9 offset:0
    ds_read_b64_tr_b16 v[50:51], v9 offset:512
    ds_read_b64_tr_b16 v[52:53], v8 offset:8192
    ds_read_b64_tr_b16 v[54:55], v8 offset:8704
    ds_read_b64_tr_b16 v[56:57], v9 offset:8192
    ds_read_b64_tr_b16 v[58:59], v9 offset:8704
    s_waitcnt lgkmcnt(9)
    v_mfma_f32_16x16x32_bf16 v[100:103], v[12:15], v[44:47], 0
    ds_read_b128 v[28:31], v5 offset:0
    s_waitcnt lgkmcnt(9)
    v_mfma_f32_16x16x32_bf16 v[104:107], v[16:19], v[44:47], 0
    ds_read_b64_tr_b16 v[60:61], v8 offset:4096
    s_waitcnt lgkmcnt(9)
    v_mfma_f32_16x16x32_bf16 v[108:111], v[20:23], v[44:47], 0
    ds_read_b64_tr_b16 v[62:63], v8 offset:4608
    s_waitcnt lgkmcnt(9)
    v_mfma_f32_16x16x32_bf16 v[112:115], v[24:27], v[44:47], 0
    ds_read_b128 v[32:35], v5 offset:2048
    s_waitcnt lgkmcnt(8)
    s_nop 0
    v_mfma_f32_16x16x32_bf16 v[116:119], v[12:15], v[48:51], 0
    ds_read_b128 v[36:39], v5 offset:4096
    v_mfma_f32_16x16x32_bf16 v[120:123], v[16:19], v[48:51], 0
    ds_read_b128 v[40:43], v5 offset:6144
    v_mfma_f32_16x16x32_bf16 v[124:127], v[20:23], v[48:51], 0
    ds_read_b64_tr_b16 v[64:65], v9 offset:4096
    v_mfma_f32_16x16x32_bf16 v[128:131], v[24:27], v[48:51], 0
    ds_read_b64_tr_b16 v[66:67], v9 offset:4608
    s_waitcnt lgkmcnt(10)
    s_nop 0
    v_mfma_f32_16x16x32_bf16 v[132:135], v[12:15], v[52:55], 0
    ds_read_b64_tr_b16 v[44:45], v8 offset:12288
    v_mfma_f32_16x16x32_bf16 v[136:139], v[16:19], v[52:55], 0
    ds_read_b64_tr_b16 v[46:47], v8 offset:12800
    v_mfma_f32_16x16x32_bf16 v[140:143], v[20:23], v[52:55], 0
    ds_read_b64_tr_b16 v[48:49], v9 offset:12288
    v_mfma_f32_16x16x32_bf16 v[144:147], v[24:27], v[52:55], 0
    ds_read_b64_tr_b16 v[50:51], v9 offset:12800
    s_waitcnt lgkmcnt(12)
    v_mfma_f32_16x16x32_bf16 v[148:151], v[12:15], v[56:59], 0
    v_mfma_f32_16x16x32_bf16 v[152:155], v[16:19], v[56:59], 0
    v_mfma_f32_16x16x32_bf16 v[156:159], v[20:23], v[56:59], 0
    v_mfma_f32_16x16x32_bf16 v[160:163], v[24:27], v[56:59], 0
    s_waitcnt lgkmcnt(9)
    v_mfma_f32_16x16x32_bf16 v[100:103], v[28:31], v[60:63], v[100:103]
    s_waitcnt lgkmcnt(8)
    v_mfma_f32_16x16x32_bf16 v[104:107], v[32:35], v[60:63], v[104:107]
    s_waitcnt lgkmcnt(0)
    s_barrier
    s_nop 0
    v_mfma_f32_16x16x32_bf16 v[108:111], v[36:39], v[60:63], v[108:111]
    ds_read_b128 v[12:15], v4 offset:16384
    v_mfma_f32_16x16x32_bf16 v[112:115], v[40:43], v[60:63], v[112:115]
    ds_read_b64_tr_b16 v[52:53], v10 offset:0
    v_mfma_f32_16x16x32_bf16 v[116:119], v[28:31], v[64:67], v[116:119]
    ds_read_b64_tr_b16 v[54:55], v10 offset:512
    v_mfma_f32_16x16x32_bf16 v[120:123], v[32:35], v[64:67], v[120:123]
    ds_read_b128 v[16:19], v4 offset:18432
    v_mfma_f32_16x16x32_bf16 v[124:127], v[36:39], v[64:67], v[124:127]
    ds_read_b128 v[20:23], v4 offset:20480
    v_mfma_f32_16x16x32_bf16 v[128:131], v[40:43], v[64:67], v[128:131]
    ds_read_b128 v[24:27], v4 offset:22528
    v_mfma_f32_16x16x32_bf16 v[132:135], v[28:31], v[44:47], v[132:135]
    ds_read_b64_tr_b16 v[56:57], v11 offset:0
    v_mfma_f32_16x16x32_bf16 v[136:139], v[32:35], v[44:47], v[136:139]
    ds_read_b64_tr_b16 v[58:59], v11 offset:512
    v_mfma_f32_16x16x32_bf16 v[140:143], v[36:39], v[44:47], v[140:143]
    ds_read_b64_tr_b16 v[60:61], v10 offset:8192
    v_mfma_f32_16x16x32_bf16 v[144:147], v[40:43], v[44:47], v[144:147]
    ds_read_b64_tr_b16 v[62:63], v10 offset:8704
    v_mfma_f32_16x16x32_bf16 v[148:151], v[28:31], v[48:51], v[148:151]
    ds_read_b64_tr_b16 v[64:65], v11 offset:8192
    v_mfma_f32_16x16x32_bf16 v[152:155], v[32:35], v[48:51], v[152:155]
    ds_read_b64_tr_b16 v[66:67], v11 offset:8704
    v_mfma_f32_16x16x32_bf16 v[156:159], v[36:39], v[48:51], v[156:159]
    v_mfma_f32_16x16x32_bf16 v[160:163], v[40:43], v[48:51], v[160:163]
    s_waitcnt lgkmcnt(9)
    v_mfma_f32_16x16x32_bf16 v[100:103], v[12:15], v[52:55], v[100:103]
    ds_read_b128 v[28:31], v5 offset:16384
    s_waitcnt lgkmcnt(9)
    v_mfma_f32_16x16x32_bf16 v[104:107], v[16:19], v[52:55], v[104:107]
    ds_read_b64_tr_b16 v[44:45], v10 offset:4096
    s_waitcnt lgkmcnt(9)
    v_mfma_f32_16x16x32_bf16 v[108:111], v[20:23], v[52:55], v[108:111]
    ds_read_b64_tr_b16 v[46:47], v10 offset:4608
    s_waitcnt lgkmcnt(9)
    v_mfma_f32_16x16x32_bf16 v[112:115], v[24:27], v[52:55], v[112:115]
    ds_read_b128 v[32:35], v5 offset:18432
    s_waitcnt lgkmcnt(8)
    s_nop 0
    v_mfma_f32_16x16x32_bf16 v[116:119], v[12:15], v[56:59], v[116:119]
    ds_read_b128 v[36:39], v5 offset:20480
    v_mfma_f32_16x16x32_bf16 v[120:123], v[16:19], v[56:59], v[120:123]
    ds_read_b128 v[40:43], v5 offset:22528
    v_mfma_f32_16x16x32_bf16 v[124:127], v[20:23], v[56:59], v[124:127]
    ds_read_b64_tr_b16 v[48:49], v11 offset:4096
    v_mfma_f32_16x16x32_bf16 v[128:131], v[24:27], v[56:59], v[128:131]
    ds_read_b64_tr_b16 v[50:51], v11 offset:4608
    s_waitcnt lgkmcnt(10)
    s_nop 0
    v_mfma_f32_16x16x32_bf16 v[132:135], v[12:15], v[60:63], v[132:135]
    ds_read_b64_tr_b16 v[52:53], v10 offset:12288
    v_mfma_f32_16x16x32_bf16 v[136:139], v[16:19], v[60:63], v[136:139]
    ds_read_b64_tr_b16 v[54:55], v10 offset:12800
    v_mfma_f32_16x16x32_bf16 v[140:143], v[20:23], v[60:63], v[140:143]
    ds_read_b64_tr_b16 v[56:57], v11 offset:12288
    v_mfma_f32_16x16x32_bf16 v[144:147], v[24:27], v[60:63], v[144:147]
    ds_read_b64_tr_b16 v[58:59], v11 offset:12800
    s_waitcnt lgkmcnt(12)
    v_mfma_f32_16x16x32_bf16 v[148:151], v[12:15], v[64:67], v[148:151]
    v_mfma_f32_16x16x32_bf16 v[152:155], v[16:19], v[64:67], v[152:155]
    v_mfma_f32_16x16x32_bf16 v[156:159], v[20:23], v[64:67], v[156:159]
    v_mfma_f32_16x16x32_bf16 v[160:163], v[24:27], v[64:67], v[160:163]
    s_waitcnt lgkmcnt(9)
    v_mfma_f32_16x16x32_bf16 v[100:103], v[28:31], v[44:47], v[100:103]
    s_waitcnt lgkmcnt(8)
    v_mfma_f32_16x16x32_bf16 v[104:107], v[32:35], v[44:47], v[104:107]
    s_waitcnt lgkmcnt(0)
    s_barrier
    s_nop 0
    v_mfma_f32_16x16x32_bf16 v[108:111], v[36:39], v[44:47], v[108:111]
    ds_read_b128 v[12:15], v4 offset:32768
    v_mfma_f32_16x16x32_bf16 v[112:115], v[40:43], v[44:47], v[112:115]
    ds_read_b64_tr_b16 v[60:61], v10 offset:16384
    v_mfma_f32_16x16x32_bf16 v[116:119], v[28:31], v[48:51], v[116:119]
    ds_read_b64_tr_b16 v[62:63], v10 offset:16896
    v_mfma_f32_16x16x32_bf16 v[120:123], v[32:35], v[48:51], v[120:123]
    ds_read_b128 v[16:19], v4 offset:34816
    v_mfma_f32_16x16x32_bf16 v[124:127], v[36:39], v[48:51], v[124:127]
    ds_read_b128 v[20:23], v4 offset:36864
    v_mfma_f32_16x16x32_bf16 v[128:131], v[40:43], v[48:51], v[128:131]
    ds_read_b128 v[24:27], v4 offset:38912
    v_mfma_f32_16x16x32_bf16 v[132:135], v[28:31], v[52:55], v[132:135]
    ds_read_b64_tr_b16 v[64:65], v11 offset:16384
    v_mfma_f32_16x16x32_bf16 v[136:139], v[32:35], v[52:55], v[136:139]
    ds_read_b64_tr_b16 v[66:67], v11 offset:16896
    v_mfma_f32_16x16x32_bf16 v[140:143], v[36:39], v[52:55], v[140:143]
    ds_read_b64_tr_b16 v[44:45], v10 offset:24576
    v_mfma_f32_16x16x32_bf16 v[144:147], v[40:43], v[52:55], v[144:147]
    ds_read_b64_tr_b16 v[46:47], v10 offset:25088
    v_mfma_f32_16x16x32_bf16 v[148:151], v[28:31], v[56:59], v[148:151]
    ds_read_b64_tr_b16 v[48:49], v11 offset:24576
    v_mfma_f32_16x16x32_bf16 v[152:155], v[32:35], v[56:59], v[152:155]
    ds_read_b64_tr_b16 v[50:51], v11 offset:25088
    v_mfma_f32_16x16x32_bf16 v[156:159], v[36:39], v[56:59], v[156:159]
    v_mfma_f32_16x16x32_bf16 v[160:163], v[40:43], v[56:59], v[160:163]
    s_waitcnt lgkmcnt(9)
    v_mfma_f32_16x16x32_bf16 v[100:103], v[12:15], v[60:63], v[100:103]
    ds_read_b128 v[28:31], v5 offset:32768
    s_waitcnt lgkmcnt(9)
    v_mfma_f32_16x16x32_bf16 v[104:107], v[16:19], v[60:63], v[104:107]
    ds_read_b64_tr_b16 v[52:53], v10 offset:20480
    s_waitcnt lgkmcnt(9)
    v_mfma_f32_16x16x32_bf16 v[108:111], v[20:23], v[60:63], v[108:111]
    ds_read_b64_tr_b16 v[54:55], v10 offset:20992
    s_waitcnt lgkmcnt(9)
    v_mfma_f32_16x16x32_bf16 v[112:115], v[24:27], v[60:63], v[112:115]
    ds_read_b128 v[32:35], v5 offset:34816
    s_waitcnt lgkmcnt(8)
    s_nop 0
    v_mfma_f32_16x16x32_bf16 v[116:119], v[12:15], v[64:67], v[116:119]
    ds_read_b128 v[36:39], v5 offset:36864
    v_mfma_f32_16x16x32_bf16 v[120:123], v[16:19], v[64:67], v[120:123]
    ds_read_b128 v[40:43], v5 offset:38912
    v_mfma_f32_16x16x32_bf16 v[124:127], v[20:23], v[64:67], v[124:127]
    ds_read_b64_tr_b16 v[56:57], v11 offset:20480
    v_mfma_f32_16x16x32_bf16 v[128:131], v[24:27], v[64:67], v[128:131]
    ds_read_b64_tr_b16 v[58:59], v11 offset:20992
    s_waitcnt lgkmcnt(10)
    s_nop 0
    v_mfma_f32_16x16x32_bf16 v[132:135], v[12:15], v[44:47], v[132:135]
    ds_read_b64_tr_b16 v[60:61], v10 offset:28672
    v_mfma_f32_16x16x32_bf16 v[136:139], v[16:19], v[44:47], v[136:139]
    s_branch IW_s3
IW_w3:
    s_branch IW_r3
IW_s3:
    ds_read_b64_tr_b16 v[62:63], v10 offset:29184
    v_mfma_f32_16x16x32_bf16 v[140:143], v[20:23], v[44:47], v[140:143]
    ds_read_b64_tr_b16 v[64:65], v11 offset:28672
    v_mfma_f32_16x16x32_bf16 v[144:147], v[24:27], v[44:47], v[144:147]
    ds_read_b64_tr_b16 v[66:67], v11 offset:29184
    s_waitcnt lgkmcnt(12)
    v_mfma_f32_16x16x32_bf16 v[148:151], v[12:15], v[48:51], v[148:151]
    v_mfma_f32_16x16x32_bf16 v[152:155], v[16:19], v[48:51], v[152:155]
    v_mfma_f32_16x16x32_bf16 v[156:159], v[20:23], v[48:51], v[156:159]
    v_mfma_f32_16x16x32_bf16 v[160:163], v[24:27], v[48:51], v[160:163]
    s_waitcnt lgkmcnt(9)
    v_mfma_f32_16x16x32_bf16 v[100:103], v[28:31], v[52:55], v[100:103]
    s_waitcnt lgkmcnt(8)
    v_mfma_f32_16x16x32_bf16 v[104:107], v[32:35], v[52:55], v[104:107]
    s_waitcnt lgkmcnt(0)
    s_barrier
    s_nop 0
    v_mfma_f32_16x16x32_bf16 v[108:111], v[36:39], v[52:55], v[108:111]
    ds_read_b128 v[12:15], v4 offset:49152
    v_mfma_f32_16x16x32_bf16 v[112:115], v[40:43], v[52:55], v[112:115]
    ds_read_b64_tr_b16 v[44:45], v10 offset:32768
    v_mfma_f32_16x16x32_bf16 v[116:119], v[28:31], v[56:59], v[116:119]
    ds_read_b64_tr_b16 v[46:47], v10 offset:33280
    v_mfma_f32_16x16x32_bf16 v[120:123], v[32:35], v[56:59], v[120:123]
    ds_read_b128 v[16:19], v4 offset:51200
    v_mfma_f32_16x16x32_bf16 v[124:127], v[36:39], v[56:59], v[124:127]
    ds_read_b128 v[20:23], v4 offset:53248
    v_mfma_f32_16x16x32_bf16 v[128:131], v[40:43], v[56:59], v[128:131]
    ds_read_b128 v[24:27], v4 offset:55296
    v_mfma_f32_16x16x32_bf16 v[132:135], v[28:31], v[60:63], v[132:135]
    ds_read_b64_tr_b16 v[48:49], v11 offset:32768
    v_mfma_f32_16x16x32_bf16 v[136:139], v[32:35], v[60:63], v[136:139]
    ds_read_b64_tr_b16 v[50:51], v11 offset:33280
    v_mfma_f32_16x16x32_bf16 v[140:143], v[36:39], v[60:63], v[140:143]
    ds_read_b64_tr_b16 v[52:53], v8 offset:0
    v_mfma_f32_16x16x32_bf16 v[144:147], v[40:43], v[60:63], v[144:147]
    ds_read_b64_tr_b16 v[54:55], v8 offset:512
    v_mfma_f32_16x16x32_bf16 v[148:151], v[28:31], v[64:67], v[148:151]
    ds_read_b64_tr_b16 v[56:57], v9 offset:0
    v_mfma_f32_16x16x32_bf16 v[152:155], v[32:35], v[64:67], v[152:155]
    ds_read_b64_tr_b16 v[58:59], v9 offset:512
    v_mfma_f32_16x16x32_bf16 v[156:159], v[36:39], v[64:67], v[156:159]
    v_mfma_f32_16x16x32_bf16 v[160:163], v[40:43], v[64:67], v[160:163]
    s_waitcnt lgkmcnt(9)
    v_mfma_f32_16x16x32_bf16 v[100:103], v[12:15], v[44:47], v[100:103]
    ds_read_b128 v[28:31], v5 offset:49152
    s_waitcnt lgkmcnt(9)
    v_mfma_f32_16x16x32_bf16 v[104:107], v[16:19], v[44:47], v[104:107]
    ds_read_b64_tr_b16 v[60:61], v10 offset:36864
    s_waitcnt lgkmcnt(9)
    v_mfma_f32_16x16x32_bf16 v[108:111], v[20:23], v[44:47], v[108:111]
    ds_read_b64_tr_b16 v[62:63], v10 offset:37376
    s_waitcnt lgkmcnt(9)
    v_mfma_f32_16x16x32_bf16 v[112:115], v[24:27], v[44:47], v[112:115]
    ds_read_b128 v[32:35], v5 offset:51200
    s_waitcnt lgkmcnt(8)
    s_nop 0
    v_mfma_f32_16x16x32_bf16 v[116:119], v[12:15], v[48:51], v[116:119]
    ds_read_b128 v[36:39], v5 offset:53248
    v_mfma_f32_16x16x32_bf16 v[120:123], v[16:19], v[48:51], v[120:123]
    ds_read_b128 v[40:43], v5 offset:55296
    v_mfma_f32_16x16x32_bf16 v[124:127], v[20:23], v[48:51], v[124:127]
    ds_read_b64_tr_b16 v[64:65], v11 offset:36864
    v_mfma_f32_16x16x32_bf16 v[128:131], v[24:27], v[48:51], v[128:131]
    ds_read_b64_tr_b16 v[66:67], v11 offset:37376
    s_waitcnt lgkmcnt(10)
    s_nop 0
    v_mfma_f32_16x16x32_bf16 v[132:135], v[12:15], v[52:55], v[132:135]
    ds_read_b64_tr_b16 v[44:45], v8 offset:4096
    v_mfma_f32_16x16x32_bf16 v[136:139], v[16:19], v[52:55], v[136:139]
    ds_read_b64_tr_b16 v[46:47], v8 offset:4608
    v_mfma_f32_16x16x32_bf16 v[140:143], v[20:23], v[52:55], v[140:143]
    ds_read_b64_tr_b16 v[48:49], v9 offset:4096
    v_mfma_f32_16x16x32_bf16 v[144:147], v[24:27], v[52:55], v[144:147]
    ds_read_b64_tr_b16 v[50:51], v9 offset:4608
    s_waitcnt lgkmcnt(12)
    v_mfma_f32_16x16x32_bf16 v[148:151], v[12:15], v[56:59], v[148:151]
    v_mfma_f32_16x16x32_bf16 v[152:155], v[16:19], v[56:59], v[152:155]
    v_mfma_f32_16x16x32_bf16 v[156:159], v[20:23], v[56:59], v[156:159]
    v_mfma_f32_16x16x32_bf16 v[160:163], v[24:27], v[56:59], v[160:163]
    s_waitcnt lgkmcnt(9)
    v_mfma_f32_16x16x32_bf16 v[100:103], v[28:31], v[60:63], v[100:103]
    s_waitcnt lgkmcnt(8)
    v_mfma_f32_16x16x32_bf16 v[104:107], v[32:35], v[60:63], v[104:107]
    s_waitcnt lgkmcnt(0)
    s_barrier
    s_nop 0
    v_mfma_f32_16x16x32_bf16 v[108:111], v[36:39], v[60:63], v[108:111]
    ds_read_b128 v[12:15], v4 offset:0
    v_mfma_f32_16x16x32_bf16 v[112:115], v[40:43], v[60:63], v[112:115]
    ds_read_b64_tr_b16 v[52:53], v8 offset:8192
    v_mfma_f32_16x16x32_bf16 v[116:119], v[28:31], v[64:67], v[116:119]
    ds_read_b64_tr_b16 v[54:55], v8 offset:8704
    v_mfma_f32_16x16x32_bf16 v[120:123], v[32:35], v[64:67], v[120:123]
    ds_read_b128 v[16:19], v4 offset:2048
    v_mfma_f32_16x16x32_bf16 v[124:127], v[36:39], v[64:67], v[124:127]
    ds_read_b128 v[20:23], v4 offset:4096
    v_mfma_f32_16x16x32_bf16 v[128:131], v[40:43], v[64:67], v[128:131]
    ds_read_b128 v[24:27], v4 offset:6144
    v_mfma_f32_16x16x32_bf16 v[132:135], v[28:31], v[44:47], v[132:135]
    ds_read_b64_tr_b16 v[56:57], v9 offset:8192
    v_mfma_f32_16x16x32_bf16 v[136:139], v[32:35], v[44:47], v[136:139]
    ds_read_b64_tr_b16 v[58:59], v9 offset:8704
    v_mfma_f32_16x16x32_bf16 v[140:143], v[36:39], v[44:47], v[140:143]
    ds_read_b64_tr_b16 v[60:61], v8 offset:16384
    v_mfma_f32_16x16x32_bf16 v[144:147], v[40:43], v[44:47], v[144:147]
    ds_read_b64_tr_b16 v[62:63], v8 offset:16896
    v_mfma_f32_16x16x32_bf16 v[148:151], v[28:31], v[48:51], v[148:151]
    ds_read_b64_tr_b16 v[64:65], v9 offset:16384
    v_mfma_f32_16x16x32_bf16 v[152:155], v[32:35], v[48:51], v[152:155]
    ds_read_b64_tr_b16 v[66:67], v9 offset:16896
    v_mfma_f32_16x16x32_bf16 v[156:159], v[36:39], v[48:51], v[156:159]
    v_mfma_f32_16x16x32_bf16 v[160:163], v[40:43], v[48:51], v[160:163]
    s_waitcnt lgkmcnt(9)
    v_mfma_f32_16x16x32_bf16 v[100:103], v[12:15], v[52:55], v[100:103]
    ds_read_b128 v[28:31], v5 offset:0
    s_waitcnt lgkmcnt(9)
    v_mfma_f32_16x16x32_bf16 v[104:107], v[16:19], v[52:55], v[104:107]
    ds_read_b64_tr_b16 v[44:45], v8 offset:12288
    s_waitcnt lgkmcnt(9)
    v_mfma_f32_16x16x32_bf16 v[108:111], v[20:23], v[52:55], v[108:111]
    ds_read_b64_tr_b16 v[46:47], v8 offset:12800
    s_waitcnt lgkmcnt(9)
    v_mfma_f32_16x16x32_bf16 v[112:115], v[24:27], v[52:55], v[112:115]
    ds_read_b128 v[32:35], v5 offset:2048
    s_waitcnt lgkmcnt(8)
    s_nop 0
    v_mfma_f32_16x16x32_bf16 v[116:119], v[12:15], v[56:59], v[116:119]
    ds_read_b128 v[36:39], v5 offset:4096
    v_mfma_f32_16x16x32_bf16 v[120:123], v[16:19], v[56:59], v[120:123]
    ds_read_b128 v[40:43], v5 offset:6144
    v_mfma_f32_16x16x32_bf16 v[124:127], v[20:23], v[56:59], v[124:127]
    ds_read_b64_tr_b16 v[48:49], v9 offset:12288
    v_mfma_f32_16x16x32_bf16 v[128:131], v[24:27], v[56:59], v[128:131]
    ds_read_b64_tr_b16 v[50:51], v9 offset:12800
    s_waitcnt lgkmcnt(10)
    s_nop 0
    v_mfma_f32_16x16x32_bf16 v[132:135], v[12:15], v[60:63], v[132:135]
    ds_read_b64_tr_b16 v[52:53], v8 offset:20480
    v_mfma_f32_16x16x32_bf16 v[136:139], v[16:19], v[60:63], v[136:139]
    ds_read_b64_tr_b16 v[54:55], v8 offset:20992
    v_mfma_f32_16x16x32_bf16 v[140:143], v[20:23], v[60:63], v[140:143]
    ds_read_b64_tr_b16 v[56:57], v9 offset:20480
    v_mfma_f32_16x16x32_bf16 v[144:147], v[24:27], v[60:63], v[144:147]
    ds_read_b64_tr_b16 v[58:59], v9 offset:20992
    s_waitcnt lgkmcnt(12)
    v_mfma_f32_16x16x32_bf16 v[148:151], v[12:15], v[64:67], v[148:151]
    v_mfma_f32_16x16x32_bf16 v[152:155], v[16:19], v[64:67], v[152:155]
    v_mfma_f32_16x16x32_bf16 v[156:159], v[20:23], v[64:67], v[156:159]
    v_mfma_f32_16x16x32_bf16 v[160:163], v[24:27], v[64:67], v[160:163]
    s_waitcnt lgkmcnt(9)
    v_mfma_f32_16x16x32_bf16 v[100:103], v[28:31], v[44:47], v[100:103]
    s_waitcnt lgkmcnt(8)
    v_mfma_f32_16x16x32_bf16 v[104:107], v[32:35], v[44:47], v[104:107]
    s_waitcnt lgkmcnt(0)
    s_barrier
    s_nop 0
    v_mfma_f32_16x16x32_bf16 v[108:111], v[36:39], v[44:47], v[108:111]
    ds_read_b128 v[12:15], v4 offset:16384
    v_mfma_f32_16x16x32_bf16 v[112:115], v[40:43], v[44:47], v[112:115]
    ds_read_b64_tr_b16 v[60:61], v8 offset:24576
    v_mfma_f32_16x16x32_bf16 v[116:119], v[28:31], v[48:51], v[116:119]
    ds_read_b64_tr_b16 v[62:63], v8 offset:25088
    v_mfma_f32_16x16x32_bf16 v[120:123], v[32:35], v[48:51], v[120:123]
    ds_read_b128 v[16:19], v4 offset:18432
    v_mfma_f32_16x16x32_bf16 v[124:127], v[36:39], v[48:51], v[124:127]
    ds_read_b128 v[20:23], v4 offset:20480
    v_mfma_f32_16x16x32_bf16 v[128:131], v[40:43], v[48:51], v[128:131]
    ds_read_b128 v[24:27], v4 offset:22528
    v_mfma_f32_16x16x32_bf16 v[132:135], v[28:31], v[52:55], v[132:135]
    ds_read_b64_tr_b16 v[64:65], v9 offset:24576
    v_mfma_f32_16x16x32_bf16 v[136:139], v[32:35], v[52:55], v[136:139]
    ds_read_b64_tr_b16 v[66:67], v9 offset:25088
    v_mfma_f32_16x16x32_bf16 v[140:143], v[36:39], v[52:55], v[140:143]
    ds_read_b64_tr_b16 v[44:45], v10 offset:0
    v_mfma_f32_16x16x32_bf16 v[144:147], v[40:43], v[52:55], v[144:147]
    ds_read_b64_tr_b16 v[46:47], v10 offset:512
    v_mfma_f32_16x16x32_bf16 v[148:151], v[28:31], v[56:59], v[148:151]
    ds_read_b64_tr_b16 v[48:49], v11 offset:0
    v_mfma_f32_16x16x32_bf16 v[152:155], v[32:35], v[56:59], v[152:155]
    ds_read_b64_tr_b16 v[50:51], v11 offset:512
    v_mfma_f32_16x16x32_bf16 v[156:159], v[36:39], v[56:59], v[156:159]
    v_mfma_f32_16x16x32_bf16 v[160:163], v[40:43], v[56:59], v[160:163]
    s_waitcnt lgkmcnt(9)
    v_mfma_f32_16x16x32_bf16 v[100:103], v[12:15], v[60:63], v[100:103]
    ds_read_b128 v[28:31], v5 offset:16384
    s_waitcnt lgkmcnt(9)
    v_mfma_f32_16x16x32_bf16 v[104:107], v[16:19], v[60:63], v[104:107]
    ds_read_b64_tr_b16 v[52:53], v8 offset:28672
    s_waitcnt lgkmcnt(9)
    v_mfma_f32_16x16x32_bf16 v[108:111], v[20:23], v[60:63], v[108:111]
    ds_read_b64_tr_b16 v[54:55], v8 offset:29184
    s_waitcnt lgkmcnt(9)
    v_mfma_f32_16x16x32_bf16 v[112:115], v[24:27], v[60:63], v[112:115]
    ds_read_b128 v[32:35], v5 offset:18432
    s_waitcnt lgkmcnt(8)
    s_nop 0
    v_mfma_f32_16x16x32_bf16 v[116:119], v[12:15], v[64:67], v[116:119]
    ds_read_b128 v[36:39], v5 offset:20480
    v_mfma_f32_16x16x32_bf16 v[120:123], v[16:19], v[64:67], v[120:123]
    ds_read_b128 v[40:43], v5 offset:22528
    v_mfma_f32_16x16x32_bf16 v[124:127], v[20:23], v[64:67], v[124:127]
    ds_read_b64_tr_b16 v[56:57], v9 offset:28672
    v_mfma_f32_16x16x32_bf16 v[128:131], v[24:27], v[64:67], v[128:131]
    ds_read_b64_tr_b16 v[58:59], v9 offset:29184
    s_waitcnt lgkmcnt(10)
    s_nop 0
    v_mfma_f32_16x16x32_bf16 v[132:135], v[12:15], v[44:47], v[132:135]
    ds_read_b64_tr_b16 v[60:61], v10 offset:4096
    v_mfma_f32_16x16x32_bf16 v[136:139], v[16:19], v[44:47], v[136:139]
    ds_read_b64_tr_b16 v[62:63], v10 offset:4608
    v_mfma_f32_16x16x32_bf16 v[140:143], v[20:23], v[44:47], v[140:143]
    ds_read_b64_tr_b16 v[64:65], v11 offset:4096
    v_mfma_f32_16x16x32_bf16 v[144:147], v[24:27], v[44:47], v[144:147]
    ds_read_b64_tr_b16 v[66:67], v11 offset:4608
    s_waitcnt lgkmcnt(12)
    v_mfma_f32_16x16x32_bf16 v[148:151], v[12:15], v[48:51], v[148:151]
    v_mfma_f32_16x16x32_bf16 v[152:155], v[16:19], v[48:51], v[152:155]
    v_mfma_f32_16x16x32_bf16 v[156:159], v[20:23], v[48:51], v[156:159]
    v_mfma_f32_16x16x32_bf16 v[160:163], v[24:27], v[48:51], v[160:163]
    s_waitcnt lgkmcnt(9)
    v_mfma_f32_16x16x32_bf16 v[100:103], v[28:31], v[52:55], v[100:103]
    s_waitcnt lgkmcnt(8)
    v_mfma_f32_16x16x32_bf16 v[104:107], v[32:35], v[52:55], v[104:107]
    s_waitcnt lgkmcnt(0)
    s_barrier
    s_nop 0
    v_mfma_f32_16x16x32_bf16 v[108:111], v[36:39], v[52:55], v[108:111]
    ds_read_b128 v[12:15], v4 offset:32768
    v_mfma_f32_16x16x32_bf16 v[112:115], v[40:43], v[52:55], v[112:115]
    ds_read_b64_tr_b16 v[44:45], v10 offset:16384
    v_mfma_f32_16x16x32_bf16 v[116:119], v[28:31], v[56:59], v[116:119]
    ds_read_b64_tr_b16 v[46:47], v10 offset:16896
    v_mfma_f32_16x16x32_bf16 v[120:123], v[32:35], v[56:59], v[120:123]
    ds_read_b128 v[16:19], v4 offset:34816
    v_mfma_f32_16x16x32_bf16 v[124:127], v[36:39], v[56:59], v[124:127]
    ds_read_b128 v[20:23], v4 offset:36864
    v_mfma_f32_16x16x32_bf16 v[128:131], v[40:43], v[56:59], v[128:131]
    ds_read_b128 v[24:27], v4 offset:38912
    v_mfma_f32_16x16x32_bf16 v[132:135], v[28:31], v[60:63], v[132:135]
    ds_read_b64_tr_b16 v[48:49], v11 offset:16384
    v_mfma_f32_16x16x32_bf16 v[136:139], v[32:35], v[60:63], v[136:139]
    ds_read_b64_tr_b16 v[50:51], v11 offset:16896
    v_mfma_f32_16x16x32_bf16 v[140:143], v[36:39], v[60:63], v[140:143]
    ds_read_b64_tr_b16 v[52:53], v10 offset:24576
    v_mfma_f32_16x16x32_bf16 v[144:147], v[40:43], v[60:63], v[144:147]
    ds_read_b64_tr_b16 v[54:55], v10 offset:25088
    v_mfma_f32_16x16x32_bf16 v[148:151], v[28:31], v[64:67], v[148:151]
    ds_read_b64_tr_b16 v[56:57], v11 offset:24576
    v_mfma_f32_16x16x32_bf16 v[152:155], v[32:35], v[64:67], v[152:155]
    ds_read_b64_tr_b16 v[58:59], v11 offset:25088
    v_mfma_f32_16x16x32_bf16 v[156:159], v[36:39], v[64:67], v[156:159]
    v_mfma_f32_16x16x32_bf16 v[160:163], v[40:43], v[64:67], v[160:163]
    s_waitcnt lgkmcnt(9)
    v_mfma_f32_16x16x32_bf16 v[100:103], v[12:15], v[44:47], v[100:103]
    ds_read_b128 v[28:31], v5 offset:32768
    s_waitcnt lgkmcnt(9)
    v_mfma_f32_16x16x32_bf16 v[104:107], v[16:19], v[44:47], v[104:107]
    ds_read_b64_tr_b16 v[60:61], v10 offset:20480
    s_waitcnt lgkmcnt(9)
    v_mfma_f32_16x16x32_bf16 v[108:111], v[20:23], v[44:47], v[108:111]
    ds_read_b64_tr_b16 v[62:63], v10 offset:20992
    s_waitcnt lgkmcnt(9)
    v_mfma_f32_16x16x32_bf16 v[112:115], v[24:27], v[44:47], v[112:115]
    ds_read_b128 v[32:35], v5 offset:34816
    s_waitcnt lgkmcnt(8)
    s_nop 0
    v_mfma_f32_16x16x32_bf16 v[116:119], v[12:15], v[48:51], v[116:119]
    ds_read_b128 v[36:39], v5 offset:36864
    v_mfma_f32_16x16x32_bf16 v[120:123], v[16:19], v[48:51], v[120:123]
    ds_read_b128 v[40:43], v5 offset:38912
    v_mfma_f32_16x16x32_bf16 v[124:127], v[20:23], v[48:51], v[124:127]
    ds_read_b64_tr_b16 v[64:65], v11 offset:20480
    v_mfma_f32_16x16x32_bf16 v[128:131], v[24:27], v[48:51], v[128:131]
    ds_read_b64_tr_b16 v[66:67], v11 offset:20992
    s_waitcnt lgkmcnt(10)
    s_nop 0
    v_mfma_f32_16x16x32_bf16 v[132:135], v[12:15], v[52:55], v[132:135]
    ds_read_b64_tr_b16 v[44:45], v10 offset:28672
    v_mfma_f32_16x16x32_bf16 v[136:139], v[16:19], v[52:55], v[136:139]
    ds_read_b64_tr_b16 v[46:47], v10 offset:29184
    v_mfma_f32_16x16x32_bf16 v[140:143], v[20:23], v[52:55], v[140:143]
    ds_read_b64_tr_b16 v[48:49], v11 offset:28672
    v_mfma_f32_16x16x32_bf16 v[144:147], v[24:27], v[52:55], v[144:147]
    ds_read_b64_tr_b16 v[50:51], v11 offset:29184
    s_waitcnt lgkmcnt(12)
    v_mfma_f32_16x16x32_bf16 v[148:151], v[12:15], v[56:59], v[148:151]
    v_mfma_f32_16x16x32_bf16 v[152:155], v[16:19], v[56:59], v[152:155]
    v_mfma_f32_16x16x32_bf16 v[156:159], v[20:23], v[56:59], v[156:159]
    v_mfma_f32_16x16x32_bf16 v[160:163], v[24:27], v[56:59], v[160:163]
    s_waitcnt lgkmcnt(9)
    v_mfma_f32_16x16x32_bf16 v[100:103], v[28:31], v[60:63], v[100:103]
    s_waitcnt lgkmcnt(8)
    v_mfma_f32_16x16x32_bf16 v[104:107], v[32:35], v[60:63], v[104:107]
    s_waitcnt lgkmcnt(0)
    s_barrier
    s_nop 0
    v_mfma_f32_16x16x32_bf16 v[108:111], v[36:39], v[60:63], v[108:111]
    ds_read_b128 v[12:15], v4 offset:49152
    v_mfma_f32_16x16x32_bf16 v[112:115], v[40:43], v[60:63], v[112:115]
    ds_read_b64_tr_b16 v[52:53], v8 offset:0
    v_mfma_f32_16x16x32_bf16 v[116:119], v[28:31], v[64:67], v[116:119]
    ds_read_b64_tr_b16 v[54:55], v8 offset:512
    v_mfma_f32_16x16x32_bf16 v[120:123], v[32:35], v[64:67], v[120:123]
    ds_read_b128 v[16:19], v4 offset:51200
    v_mfma_f32_16x16x32_bf16 v[124:127], v[36:39], v[64:67], v[124:127]
    ds_read_b128 v[20:23], v4 offset:53248
    v_mfma_f32_16x16x32_bf16 v[128:131], v[40:43], v[64:67], v[128:131]
    ds_read_b128 v[24:27], v4 offset:55296
    v_mfma_f32_16x16x32_bf16 v[132:135], v[28:31], v[44:47], v[132:135]
    ds_read_b64_tr_b16 v[56:57], v9 offset:0
    v_mfma_f32_16x16x32_bf16 v[136:139], v[32:35], v[44:47], v[136:139]
    ds_read_b64_tr_b16 v[58:59], v9 offset:512
    v_mfma_f32_16x16x32_bf16 v[140:143], v[36:39], v[44:47], v[140:143]
    ds_read_b64_tr_b16 v[60:61], v10 offset:32768
    v_mfma_f32_16x16x32_bf16 v[144:147], v[40:43], v[44:47], v[144:147]
    ds_read_b64_tr_b16 v[62:63], v10 offset:33280
    v_mfma_f32_16x16x32_bf16 v[148:151], v[28:31], v[48:51], v[148:151]
    ds_read_b64_tr_b16 v[64:65], v11 offset:32768
    v_mfma_f32_16x16x32_bf16 v[152:155], v[32:35], v[48:51], v[152:155]
    ds_read_b64_tr_b16 v[66:67], v11 offset:33280
    v_mfma_f32_16x16x32_bf16 v[156:159], v[36:39], v[48:51], v[156:159]
    v_mfma_f32_16x16x32_bf16 v[160:163], v[40:43], v[48:51], v[160:163]
    s_waitcnt lgkmcnt(9)
    v_mfma_f32_16x16x32_bf16 v[100:103], v[12:15], v[52:55], v[100:103]
    ds_read_b128 v[28:31], v5 offset:49152
    s_waitcnt lgkmcnt(9)
    v_mfma_f32_16x16x32_bf16 v[104:107], v[16:19], v[52:55], v[104:107]
    ds_read_b64_tr_b16 v[44:45], v8 offset:4096
    s_waitcnt lgkmcnt(9)
    v_mfma_f32_16x16x32_bf16 v[108:111], v[20:23], v[52:55], v[108:111]
    ds_read_b64_tr_b16 v[46:47], v8 offset:4608
    s_waitcnt lgkmcnt(9)
    v_mfma_f32_16x16x32_bf16 v[112:115], v[24:27], v[52:55], v[112:115]
    ds_read_b128 v[32:35], v5 offset:51200
    s_waitcnt lgkmcnt(8)
    s_nop 0
    v_mfma_f32_16x16x32_bf16 v[116:119], v[12:15], v[56:59], v[116:119]
    ds_read_b128 v[36:39], v5 offset:53248
    v_mfma_f32_16x16x32_bf16 v[120:123], v[16:19], v[56:59], v[120:123]
    ds_read_b128 v[40:43], v5 offset:55296
    v_mfma_f32_16x16x32_bf16 v[124:127], v[20:23], v[56:59], v[124:127]
    ds_read_b64_tr_b16 v[48:49], v9 offset:4096
    v_mfma_f32_16x16x32_bf16 v[128:131], v[24:27], v[56:59], v[128:131]
    ds_read_b64_tr_b16 v[50:51], v9 offset:4608
    s_waitcnt lgkmcnt(10)
    s_nop 0
    v_mfma_f32_16x16x32_bf16 v[132:135], v[12:15], v[60:63], v[132:135]
    ds_read_b64_tr_b16 v[52:53], v10 offset:36864
    v_mfma_f32_16x16x32_bf16 v[136:139], v[16:19], v[60:63], v[136:139]
    ds_read_b64_tr_b16 v[54:55], v10 offset:37376
    v_mfma_f32_16x16x32_bf16 v[140:143], v[20:23], v[60:63], v[140:143]
    ds_read_b64_tr_b16 v[56:57], v11 offset:36864
    v_mfma_f32_16x16x32_bf16 v[144:147], v[24:27], v[60:63], v[144:147]
    ds_read_b64_tr_b16 v[58:59], v11 offset:37376
    s_waitcnt lgkmcnt(12)
    v_mfma_f32_16x16x32_bf16 v[148:151], v[12:15], v[64:67], v[148:151]
    v_mfma_f32_16x16x32_bf16 v[152:155], v[16:19], v[64:67], v[152:155]
    v_mfma_f32_16x16x32_bf16 v[156:159], v[20:23], v[64:67], v[156:159]
    v_mfma_f32_16x16x32_bf16 v[160:163], v[24:27], v[64:67], v[160:163]
    s_waitcnt lgkmcnt(9)
    v_mfma_f32_16x16x32_bf16 v[100:103], v[28:31], v[44:47], v[100:103]
    s_waitcnt lgkmcnt(8)
    v_mfma_f32_16x16x32_bf16 v[104:107], v[32:35], v[44:47], v[104:107]
    s_waitcnt lgkmcnt(0)
    s_barrier
    s_nop 0
    v_mfma_f32_16x16x32_bf16 v[108:111], v[36:39], v[44:47], v[108:111]
    ds_read_b128 v[12:15], v4 offset:0
    v_mfma_f32_16x16x32_bf16 v[112:115], v[40:43], v[44:47], v[112:115]
    ds_read_b64_tr_b16 v[60:61], v8 offset:8192
    v_mfma_f32_16x16x32_bf16 v[116:119], v[28:31], v[48:51], v[116:119]
    ds_read_b64_tr_b16 v[62:63], v8 offset:8704
    v_mfma_f32_16x16x32_bf16 v[120:123], v[32:35], v[48:51], v[120:123]
    ds_read_b128 v[16:19], v4 offset:2048
    v_mfma_f32_16x16x32_bf16 v[124:127], v[36:39], v[48:51], v[124:127]
    ds_read_b128 v[20:23], v4 offset:4096
    v_mfma_f32_16x16x32_bf16 v[128:131], v[40:43], v[48:51], v[128:131]
    ds_read_b128 v[24:27], v4 offset:6144
    v_mfma_f32_16x16x32_bf16 v[132:135], v[28:31], v[52:55], v[132:135]
    ds_read_b64_tr_b16 v[64:65], v9 offset:8192
    v_mfma_f32_16x16x32_bf16 v[136:139], v[32:35], v[52:55], v[136:139]
    ds_read_b64_tr_b16 v[66:67], v9 offset:8704
    v_mfma_f32_16x16x32_bf16 v[140:143], v[36:39], v[52:55], v[140:143]
    ds_read_b64_tr_b16 v[44:45], v8 offset:16384
    v_mfma_f32_16x16x32_bf16 v[144:147], v[40:43], v[52:55], v[144:147]
    ds_read_b64_tr_b16 v[46:47], v8 offset:16896
    v_mfma_f32_16x16x32_bf16 v[148:151], v[28:31], v[56:59], v[148:151]
    ds_read_b64_tr_b16 v[48:49], v9 offset:16384
    v_mfma_f32_16x16x32_bf16 v[152:155], v[32:35], v[56:59], v[152:155]
    ds_read_b64_tr_b16 v[50:51], v9 offset:16896
    v_mfma_f32_16x16x32_bf16 v[156:159], v[36:39], v[56:59], v[156:159]
    v_mfma_f32_16x16x32_bf16 v[160:163], v[40:43], v[56:59], v[160:163]
    s_waitcnt lgkmcnt(9)
    v_mfma_f32_16x16x32_bf16 v[100:103], v[12:15], v[60:63], v[100:103]
    ds_read_b128 v[28:31], v5 offset:0
    s_waitcnt lgkmcnt(9)
    v_mfma_f32_16x16x32_bf16 v[104:107], v[16:19], v[60:63], v[104:107]
    ds_read_b64_tr_b16 v[52:53], v8 offset:12288
    s_waitcnt lgkmcnt(9)
    v_mfma_f32_16x16x32_bf16 v[108:111], v[20:23], v[60:63], v[108:111]
    ds_read_b64_tr_b16 v[54:55], v8 offset:12800
    s_waitcnt lgkmcnt(9)
    v_mfma_f32_16x16x32_bf16 v[112:115], v[24:27], v[60:63], v[112:115]
    ds_read_b128 v[32:35], v5 offset:2048
    s_waitcnt lgkmcnt(8)
    s_nop 0
    v_mfma_f32_16x16x32_bf16 v[116:119], v[12:15], v[64:67], v[116:119]
    ds_read_b128 v[36:39], v5 offset:4096
    v_mfma_f32_16x16x32_bf16 v[120:123], v[16:19], v[64:67], v[120:123]
    ds_read_b128 v[40:43], v5 offset:6144
    v_mfma_f32_16x16x32_bf16 v[124:127], v[20:23], v[64:67], v[124:127]
    ds_read_b64_tr_b16 v[56:57], v9 offset:12288
    v_mfma_f32_16x16x32_bf16 v[128:131], v[24:27], v[64:67], v[128:131]
    ds_read_b64_tr_b16 v[58:59], v9 offset:12800
    s_waitcnt lgkmcnt(10)
    s_nop 0
    v_mfma_f32_16x16x32_bf16 v[132:135], v[12:15], v[44:47], v[132:135]
    ds_read_b64_tr_b16 v[60:61], v8 offset:20480
    v_mfma_f32_16x16x32_bf16 v[136:139], v[16:19], v[44:47], v[136:139]
    ds_read_b64_tr_b16 v[62:63], v8 offset:20992
    v_mfma_f32_16x16x32_bf16 v[140:143], v[20:23], v[44:47], v[140:143]
    ds_read_b64_tr_b16 v[64:65], v9 offset:20480
    v_mfma_f32_16x16x32_bf16 v[144:147], v[24:27], v[44:47], v[144:147]
    ds_read_b64_tr_b16 v[66:67], v9 offset:20992
    s_waitcnt lgkmcnt(12)
    v_mfma_f32_16x16x32_bf16 v[148:151], v[12:15], v[48:51], v[148:151]
    v_mfma_f32_16x16x32_bf16 v[152:155], v[16:19], v[48:51], v[152:155]
    v_mfma_f32_16x16x32_bf16 v[156:159], v[20:23], v[48:51], v[156:159]
    v_mfma_f32_16x16x32_bf16 v[160:163], v[24:27], v[48:51], v[160:163]
    s_waitcnt lgkmcnt(9)
    v_mfma_f32_16x16x32_bf16 v[100:103], v[28:31], v[52:55], v[100:103]
    s_waitcnt lgkmcnt(8)
    v_mfma_f32_16x16x32_bf16 v[104:107], v[32:35], v[52:55], v[104:107]
    s_waitcnt lgkmcnt(0)
    s_barrier
    s_nop 0
    v_mfma_f32_16x16x32_bf16 v[108:111], v[36:39], v[52:55], v[108:111]
    ds_read_b128 v[12:15], v4 offset:16384
    v_mfma_f32_16x16x32_bf16 v[112:115], v[40:43], v[52:55], v[112:115]
    ds_read_b64_tr_b16 v[44:45], v8 offset:24576
    v_mfma_f32_16x16x32_bf16 v[116:119], v[28:31], v[56:59], v[116:119]
    ds_read_b64_tr_b16 v[46:47], v8 offset:25088
    v_mfma_f32_16x16x32_bf16 v[120:123], v[32:35], v[56:59], v[120:123]
    ds_read_b128 v[16:19], v4 offset:18432
    v_mfma_f32_16x16x32_bf16 v[124:127], v[36:39], v[56:59], v[124:127]
    ds_read_b128 v[20:23], v4 offset:20480
    v_mfma_f32_16x16x32_bf16 v[128:131], v[40:43], v[56:59], v[128:131]
    ds_read_b128 v[24:27], v4 offset:22528
    v_mfma_f32_16x16x32_bf16 v[132:135], v[28:31], v[60:63], v[132:135]
    ds_read_b64_tr_b16 v[48:49], v9 offset:24576
    v_mfma_f32_16x16x32_bf16 v[136:139], v[32:35], v[60:63], v[136:139]
    ds_read_b64_tr_b16 v[50:51], v9 offset:25088
    v_mfma_f32_16x16x32_bf16 v[140:143], v[36:39], v[60:63], v[140:143]
    ds_read_b64_tr_b16 v[52:53], v10 offset:0
    v_mfma_f32_16x16x32_bf16 v[144:147], v[40:43], v[60:63], v[144:147]
    ds_read_b64_tr_b16 v[54:55], v10 offset:512
    v_mfma_f32_16x16x32_bf16 v[148:151], v[28:31], v[64:67], v[148:151]
    ds_read_b64_tr_b16 v[56:57], v11 offset:0
    v_mfma_f32_16x16x32_bf16 v[152:155], v[32:35], v[64:67], v[152:155]
    ds_read_b64_tr_b16 v[58:59], v11 offset:512
    v_mfma_f32_16x16x32_bf16 v[156:159], v[36:39], v[64:67], v[156:159]
    v_mfma_f32_16x16x32_bf16 v[160:163], v[40:43], v[64:67], v[160:163]
    s_waitcnt lgkmcnt(9)
    v_mfma_f32_16x16x32_bf16 v[100:103], v[12:15], v[44:47], v[100:103]
    ds_read_b128 v[28:31], v5 offset:16384
    s_waitcnt lgkmcnt(9)
    v_mfma_f32_16x16x32_bf16 v[104:107], v[16:19], v[44:47], v[104:107]
    ds_read_b64_tr_b16 v[60:61], v8 offset:28672
    s_waitcnt lgkmcnt(9)
    v_mfma_f32_16x16x32_bf16 v[108:111], v[20:23], v[44:47], v[108:111]
    ds_read_b64_tr_b16 v[62:63], v8 offset:29184
    s_waitcnt lgkmcnt(9)
    v_mfma_f32_16x16x32_bf16 v[112:115], v[24:27], v[44:47], v[112:115]
    ds_read_b128 v[32:35], v5 offset:18432
    s_waitcnt lgkmcnt(8)
    s_nop 0
    v_mfma_f32_16x16x32_bf16 v[116:119], v[12:15], v[48:51], v[116:119]
    ds_read_b128 v[36:39], v5 offset:20480
    v_mfma_f32_16x16x32_bf16 v[120:123], v[16:19], v[48:51], v[120:123]
    ds_read_b128 v[40:43], v5 offset:22528
    v_mfma_f32_16x16x32_bf16 v[124:127], v[20:23], v[48:51], v[124:127]
    ds_read_b64_tr_b16 v[64:65], v9 offset:28672
    v_mfma_f32_16x16x32_bf16 v[128:131], v[24:27], v[48:51], v[128:131]
    ds_read_b64_tr_b16 v[66:67], v9 offset:29184
    s_waitcnt lgkmcnt(10)
    s_nop 0
    v_mfma_f32_16x16x32_bf16 v[132:135], v[12:15], v[52:55], v[132:135]
    ds_read_b64_tr_b16 v[44:45], v10 offset:4096
    v_mfma_f32_16x16x32_bf16 v[136:139], v[16:19], v[52:55], v[136:139]
    ds_read_b64_tr_b16 v[46:47], v10 offset:4608
    v_mfma_f32_16x16x32_bf16 v[140:143], v[20:23], v[52:55], v[140:143]
    ds_read_b64_tr_b16 v[48:49], v11 offset:4096
    v_mfma_f32_16x16x32_bf16 v[144:147], v[24:27], v[52:55], v[144:147]
    ds_read_b64_tr_b16 v[50:51], v11 offset:4608
    s_waitcnt lgkmcnt(12)
    v_mfma_f32_16x16x32_bf16 v[148:151], v[12:15], v[56:59], v[148:151]
    v_mfma_f32_16x16x32_bf16 v[152:155], v[16:19], v[56:59], v[152:155]
    v_mfma_f32_16x16x32_bf16 v[156:159], v[20:23], v[56:59], v[156:159]
    v_mfma_f32_16x16x32_bf16 v[160:163], v[24:27], v[56:59], v[160:163]
    s_waitcnt lgkmcnt(9)
    v_mfma_f32_16x16x32_bf16 v[100:103], v[28:31], v[60:63], v[100:103]
    s_waitcnt lgkmcnt(8)
    v_mfma_f32_16x16x32_bf16 v[104:107], v[32:35], v[60:63], v[104:107]
    s_waitcnt lgkmcnt(0)
    s_barrier
    s_nop 0
    v_mfma_f32_16x16x32_bf16 v[108:111], v[36:39], v[60:63], v[108:111]
    ds_read_b128 v[12:15], v4 offset:32768
    v_mfma_f32_16x16x32_bf16 v[112:115], v[40:43], v[60:63], v[112:115]
    ds_read_b64_tr_b16 v[52:53], v10 offset:16384
    v_mfma_f32_16x16x32_bf16 v[116:119], v[28:31], v[64:67], v[116:119]
    ds_read_b64_tr_b16 v[54:55], v10 offset:16896
    v_mfma_f32_16x16x32_bf16 v[120:123], v[32:35], v[64:67], v[120:123]
    ds_read_b128 v[16:19], v4 offset:34816
    v_mfma_f32_16x16x32_bf16 v[124:127], v[36:39], v[64:67], v[124:127]
    ds_read_b128 v[20:23], v4 offset:36864
    v_mfma_f32_16x16x32_bf16 v[128:131], v[40:43], v[64:67], v[128:131]
    ds_read_b128 v[24:27], v4 offset:38912
    v_mfma_f32_16x16x32_bf16 v[132:135], v[28:31], v[44:47], v[132:135]
    ds_read_b64_tr_b16 v[56:57], v11 offset:16384
    v_mfma_f32_16x16x32_bf16 v[136:139], v[32:35], v[44:47], v[136:139]
    ds_read_b64_tr_b16 v[58:59], v11 offset:16896
    v_mfma_f32_16x16x32_bf16 v[140:143], v[36:39], v[44:47], v[140:143]
    ds_read_b64_tr_b16 v[60:61], v10 offset:24576
    v_mfma_f32_16x16x32_bf16 v[144:147], v[40:43], v[44:47], v[144:147]
    ds_read_b64_tr_b16 v[62:63], v10 offset:25088
    v_mfma_f32_16x16x32_bf16 v[148:151], v[28:31], v[48:51], v[148:151]
    ds_read_b64_tr_b16 v[64:65], v11 offset:24576
    v_mfma_f32_16x16x32_bf16 v[152:155], v[32:35], v[48:51], v[152:155]
    ds_read_b64_tr_b16 v[66:67], v11 offset:25088
    v_mfma_f32_16x16x32_bf16 v[156:159], v[36:39], v[48:51], v[156:159]
    v_mfma_f32_16x16x32_bf16 v[160:163], v[40:43], v[48:51], v[160:163]
    s_waitcnt lgkmcnt(9)
    v_mfma_f32_16x16x32_bf16 v[100:103], v[12:15], v[52:55], v[100:103]
    ds_read_b128 v[28:31], v5 offset:32768
    s_waitcnt lgkmcnt(9)
    v_mfma_f32_16x16x32_bf16 v[104:107], v[16:19], v[52:55], v[104:107]
    ds_read_b64_tr_b16 v[44:45], v10 offset:20480
    s_waitcnt lgkmcnt(9)
    v_mfma_f32_16x16x32_bf16 v[108:111], v[20:23], v[52:55], v[108:111]
    ds_read_b64_tr_b16 v[46:47], v10 offset:20992
    s_waitcnt lgkmcnt(9)
    v_mfma_f32_16x16x32_bf16 v[112:115], v[24:27], v[52:55], v[112:115]
    ds_read_b128 v[32:35], v5 offset:34816
    s_waitcnt lgkmcnt(8)
    s_nop 0
    v_mfma_f32_16x16x32_bf16 v[116:119], v[12:15], v[56:59], v[116:119]
    ds_read_b128 v[36:39], v5 offset:36864
    v_mfma_f32_16x16x32_bf16 v[120:123], v[16:19], v[56:59], v[120:123]
    ds_read_b128 v[40:43], v5 offset:38912
    v_mfma_f32_16x16x32_bf16 v[124:127], v[20:23], v[56:59], v[124:127]
    ds_read_b64_tr_b16 v[48:49], v11 offset:20480
    v_mfma_f32_16x16x32_bf16 v[128:131], v[24:27], v[56:59], v[128:131]
    ds_read_b64_tr_b16 v[50:51], v11 offset:20992
    s_waitcnt lgkmcnt(10)
    s_nop 0
    v_mfma_f32_16x16x32_bf16 v[132:135], v[12:15], v[60:63], v[132:135]
    ds_read_b64_tr_b16 v[52:53], v10 offset:28672
    v_mfma_f32_16x16x32_bf16 v[136:139], v[16:19], v[60:63], v[136:139]
    ds_read_b64_tr_b16 v[54:55], v10 offset:29184
    v_mfma_f32_16x16x32_bf16 v[140:143], v[20:23], v[60:63], v[140:143]
    ds_read_b64_tr_b16 v[56:57], v11 offset:28672
    v_mfma_f32_16x16x32_bf16 v[144:147], v[24:27], v[60:63], v[144:147]
    ds_read_b64_tr_b16 v[58:59], v11 offset:29184
    s_waitcnt lgkmcnt(12)
    v_mfma_f32_16x16x32_bf16 v[148:151], v[12:15], v[64:67], v[148:151]
    s_branch IW_s4
IW_w4:
    s_branch IW_r4
IW_s4:
    v_mfma_f32_16x16x32_bf16 v[152:155], v[16:19], v[64:67], v[152:155]
    v_mfma_f32_16x16x32_bf16 v[156:159], v[20:23], v[64:67], v[156:159]
    v_mfma_f32_16x16x32_bf16 v[160:163], v[24:27], v[64:67], v[160:163]
    s_waitcnt lgkmcnt(9)
    v_mfma_f32_16x16x32_bf16 v[100:103], v[28:31], v[44:47], v[100:103]
    s_waitcnt lgkmcnt(8)
    v_mfma_f32_16x16x32_bf16 v[104:107], v[32:35], v[44:47], v[104:107]
    s_waitcnt lgkmcnt(0)
    s_barrier
    s_nop 0
    v_mfma_f32_16x16x32_bf16 v[108:111], v[36:39], v[44:47], v[108:111]
    ds_read_b128 v[12:15], v4 offset:49152
    v_mfma_f32_16x16x32_bf16 v[112:115], v[40:43], v[44:47], v[112:115]
    ds_read_b64_tr_b16 v[60:61], v8 offset:0
    v_mfma_f32_16x16x32_bf16 v[116:119], v[28:31], v[48:51], v[116:119]
    ds_read_b64_tr_b16 v[62:63], v8 offset:512
    v_mfma_f32_16x16x32_bf16 v[120:123], v[32:35], v[48:51], v[120:123]
    ds_read_b128 v[16:19], v4 offset:51200
    v_mfma_f32_16x16x32_bf16 v[124:127], v[36:39], v[48:51], v[124:127]
    ds_read_b128 v[20:23], v4 offset:53248
    v_mfma_f32_16x16x32_bf16 v[128:131], v[40:43], v[48:51], v[128:131]
    ds_read_b128 v[24:27], v4 offset:55296
    v_mfma_f32_16x16x32_bf16 v[132:135], v[28:31], v[52:55], v[132:135]
    ds_read_b64_tr_b16 v[64:65], v9 offset:0
    v_mfma_f32_16x16x32_bf16 v[136:139], v[32:35], v[52:55], v[136:139]
    ds_read_b64_tr_b16 v[66:67], v9 offset:512
    v_mfma_f32_16x16x32_bf16 v[140:143], v[36:39], v[52:55], v[140:143]
    ds_read_b64_tr_b16 v[44:45], v10 offset:32768
    v_mfma_f32_16x16x32_bf16 v[144:147], v[40:43], v[52:55], v[144:147]
    ds_read_b64_tr_b16 v[46:47], v10 offset:33280
    v_mfma_f32_16x16x32_bf16 v[148:151], v[28:31], v[56:59], v[148:151]
    ds_read_b64_tr_b16 v[48:49], v11 offset:32768
    v_mfma_f32_16x16x32_bf16 v[152:155], v[32:35], v[56:59], v[152:155]
    ds_read_b64_tr_b16 v[50:51], v11 offset:33280
    v_mfma_f32_16x16x32_bf16 v[156:159], v[36:39], v[56:59], v[156:159]
    v_mfma_f32_16x16x32_bf16 v[160:163], v[40:43], v[56:59], v[160:163]
    s_waitcnt lgkmcnt(9)
    v_mfma_f32_16x16x32_bf16 v[100:103], v[12:15], v[60:63], v[100:103]
    ds_read_b128 v[28:31], v5 offset:49152
    s_waitcnt lgkmcnt(9)
    v_mfma_f32_16x16x32_bf16 v[104:107], v[16:19], v[60:63], v[104:107]
    ds_read_b64_tr_b16 v[52:53], v8 offset:4096
    s_waitcnt lgkmcnt(9)
    v_mfma_f32_16x16x32_bf16 v[108:111], v[20:23], v[60:63], v[108:111]
    ds_read_b64_tr_b16 v[54:55], v8 offset:4608
    s_waitcnt lgkmcnt(9)
    v_mfma_f32_16x16x32_bf16 v[112:115], v[24:27], v[60:63], v[112:115]
    ds_read_b128 v[32:35], v5 offset:51200
    s_waitcnt lgkmcnt(8)
    s_nop 0
    v_mfma_f32_16x16x32_bf16 v[116:119], v[12:15], v[64:67], v[116:119]
    ds_read_b128 v[36:39], v5 offset:53248
    v_mfma_f32_16x16x32_bf16 v[120:123], v[16:19], v[64:67], v[120:123]
    ds_read_b128 v[40:43], v5 offset:55296
    v_mfma_f32_16x16x32_bf16 v[124:127], v[20:23], v[64:67], v[124:127]
    ds_read_b64_tr_b16 v[56:57], v9 offset:4096
    v_mfma_f32_16x16x32_bf16 v[128:131], v[24:27], v[64:67], v[128:131]
    ds_read_b64_tr_b16 v[58:59], v9 offset:4608
    s_waitcnt lgkmcnt(10)
    s_nop 0
    v_mfma_f32_16x16x32_bf16 v[132:135], v[12:15], v[44:47], v[132:135]
    ds_read_b64_tr_b16 v[60:61], v10 offset:36864
    v_mfma_f32_16x16x32_bf16 v[136:139], v[16:19], v[44:47], v[136:139]
    ds_read_b64_tr_b16 v[62:63], v10 offset:37376
    v_mfma_f32_16x16x32_bf16 v[140:143], v[20:23], v[44:47], v[140:143]
    ds_read_b64_tr_b16 v[64:65], v11 offset:36864
    v_mfma_f32_16x16x32_bf16 v[144:147], v[24:27], v[44:47], v[144:147]
    ds_read_b64_tr_b16 v[66:67], v11 offset:37376
    s_waitcnt lgkmcnt(12)
    v_mfma_f32_16x16x32_bf16 v[148:151], v[12:15], v[48:51], v[148:151]
    v_mfma_f32_16x16x32_bf16 v[152:155], v[16:19], v[48:51], v[152:155]
    v_mfma_f32_16x16x32_bf16 v[156:159], v[20:23], v[48:51], v[156:159]
    v_mfma_f32_16x16x32_bf16 v[160:163], v[24:27], v[48:51], v[160:163]
    s_waitcnt lgkmcnt(9)
    v_mfma_f32_16x16x32_bf16 v[100:103], v[28:31], v[52:55], v[100:103]
    s_waitcnt lgkmcnt(8)
    v_mfma_f32_16x16x32_bf16 v[104:107], v[32:35], v[52:55], v[104:107]
    s_waitcnt lgkmcnt(0)
    s_barrier
    s_nop 0
    v_mfma_f32_16x16x32_bf16 v[108:111], v[36:39], v[52:55], v[108:111]
    ds_read_b128 v[12:15], v4 offset:0
    v_mfma_f32_16x16x32_bf16 v[112:115], v[40:43], v[52:55], v[112:115]
    ds_read_b64_tr_b16 v[44:45], v8 offset:8192
    v_mfma_f32_16x16x32_bf16 v[116:119], v[28:31], v[56:59], v[116:119]
    ds_read_b64_tr_b16 v[46:47], v8 offset:8704
    v_mfma_f32_16x16x32_bf16 v[120:123], v[32:35], v[56:59], v[120:123]
    ds_read_b128 v[16:19], v4 offset:2048
    v_mfma_f32_16x16x32_bf16 v[124:127], v[36:39], v[56:59], v[124:127]
    ds_read_b128 v[20:23], v4 offset:4096
    v_mfma_f32_16x16x32_bf16 v[128:131], v[40:43], v[56:59], v[128:131]
    ds_read_b128 v[24:27], v4 offset:6144
    v_mfma_f32_16x16x32_bf16 v[132:135], v[28:31], v[60:63], v[132:135]
    ds_read_b64_tr_b16 v[48:49], v9 offset:8192
    v_mfma_f32_16x16x32_bf16 v[136:139], v[32:35], v[60:63], v[136:139]
    ds_read_b64_tr_b16 v[50:51], v9 offset:8704
    v_mfma_f32_16x16x32_bf16 v[140:143], v[36:39], v[60:63], v[140:143]
    ds_read_b64_tr_b16 v[52:53], v8 offset:16384
    v_mfma_f32_16x16x32_bf16 v[144:147], v[40:43], v[60:63], v[144:147]
    ds_read_b64_tr_b16 v[54:55], v8 offset:16896
    v_mfma_f32_16x16x32_bf16 v[148:151], v[28:31], v[64:67], v[148:151]
    ds_read_b64_tr_b16 v[56:57], v9 offset:16384
    v_mfma_f32_16x16x32_bf16 v[152:155], v[32:35], v[64:67], v[152:155]
    ds_read_b64_tr_b16 v[58:59], v9 offset:16896
    v_mfma_f32_16x16x32_bf16 v[156:159], v[36:39], v[64:67], v[156:159]
    v_mfma_f32_16x16x32_bf16 v[160:163], v[40:43], v[64:67], v[160:163]
    s_waitcnt lgkmcnt(9)
    v_mfma_f32_16x16x32_bf16 v[100:103], v[12:15], v[44:47], v[100:103]
    ds_read_b128 v[28:31], v5 offset:0
    s_waitcnt lgkmcnt(9)
    v_mfma_f32_16x16x32_bf16 v[104:107], v[16:19], v[44:47], v[104:107]
    ds_read_b64_tr_b16 v[60:61], v8 offset:12288
    s_waitcnt lgkmcnt(9)
    v_mfma_f32_16x16x32_bf16 v[108:111], v[20:23], v[44:47], v[108:111]
    ds_read_b64_tr_b16 v[62:63], v8 offset:12800
    s_waitcnt lgkmcnt(9)
    v_mfma_f32_16x16x32_bf16 v[112:115], v[24:27], v[44:47], v[112:115]
    ds_read_b128 v[32:35], v5 offset:2048
    s_waitcnt lgkmcnt(8)
    s_nop 0
    v_mfma_f32_16x16x32_bf16 v[116:119], v[12:15], v[48:51], v[116:119]
    ds_read_b128 v[36:39], v5 offset:4096
    v_mfma_f32_16x16x32_bf16 v[120:123], v[16:19], v[48:51], v[120:123]
    ds_read_b128 v[40:43], v5 offset:6144
    v_mfma_f32_16x16x32_bf16 v[124:127], v[20:23], v[48:51], v[124:127]
    ds_read_b64_tr_b16 v[64:65], v9 offset:12288
    v_mfma_f32_16x16x32_bf16 v[128:131], v[24:27], v[48:51], v[128:131]
    ds_read_b64_tr_b16 v[66:67], v9 offset:12800
    s_waitcnt lgkmcnt(10)
    s_nop 0
    v_mfma_f32_16x16x32_bf16 v[132:135], v[12:15], v[52:55], v[132:135]
    ds_read_b64_tr_b16 v[44:45], v8 offset:20480
    v_mfma_f32_16x16x32_bf16 v[136:139], v[16:19], v[52:55], v[136:139]
    ds_read_b64_tr_b16 v[46:47], v8 offset:20992
    v_mfma_f32_16x16x32_bf16 v[140:143], v[20:23], v[52:55], v[140:143]
    ds_read_b64_tr_b16 v[48:49], v9 offset:20480
    v_mfma_f32_16x16x32_bf16 v[144:147], v[24:27], v[52:55], v[144:147]
    ds_read_b64_tr_b16 v[50:51], v9 offset:20992
    s_waitcnt lgkmcnt(12)
    v_mfma_f32_16x16x32_bf16 v[148:151], v[12:15], v[56:59], v[148:151]
    v_mfma_f32_16x16x32_bf16 v[152:155], v[16:19], v[56:59], v[152:155]
    v_mfma_f32_16x16x32_bf16 v[156:159], v[20:23], v[56:59], v[156:159]
    v_mfma_f32_16x16x32_bf16 v[160:163], v[24:27], v[56:59], v[160:163]
    s_waitcnt lgkmcnt(9)
    v_mfma_f32_16x16x32_bf16 v[100:103], v[28:31], v[60:63], v[100:103]
    s_waitcnt lgkmcnt(8)
    v_mfma_f32_16x16x32_bf16 v[104:107], v[32:35], v[60:63], v[104:107]
    s_waitcnt lgkmcnt(0)
    s_barrier
    s_nop 0
    v_mfma_f32_16x16x32_bf16 v[108:111], v[36:39], v[60:63], v[108:111]
    ds_read_b128 v[12:15], v4 offset:16384
    v_mfma_f32_16x16x32_bf16 v[112:115], v[40:43], v[60:63], v[112:115]
    ds_read_b64_tr_b16 v[52:53], v8 offset:24576
    v_mfma_f32_16x16x32_bf16 v[116:119], v[28:31], v[64:67], v[116:119]
    ds_read_b64_tr_b16 v[54:55], v8 offset:25088
    v_mfma_f32_16x16x32_bf16 v[120:123], v[32:35], v[64:67], v[120:123]
    ds_read_b128 v[16:19], v4 offset:18432
    v_mfma_f32_16x16x32_bf16 v[124:127], v[36:39], v[64:67], v[124:127]
    ds_read_b128 v[20:23], v4 offset:20480
    v_mfma_f32_16x16x32_bf16 v[128:131], v[40:43], v[64:67], v[128:131]
    ds_read_b128 v[24:27], v4 offset:22528
    v_mfma_f32_16x16x32_bf16 v[132:135], v[28:31], v[44:47], v[132:135]
    ds_read_b64_tr_b16 v[56:57], v9 offset:24576
    v_mfma_f32_16x16x32_bf16 v[136:139], v[32:35], v[44:47], v[136:139]
    ds_read_b64_tr_b16 v[58:59], v9 offset:25088
    v_mfma_f32_16x16x32_bf16 v[140:143], v[36:39], v[44:47], v[140:143]
    ds_read_b64_tr_b16 v[60:61], v10 offset:0
    v_mfma_f32_16x16x32_bf16 v[144:147], v[40:43], v[44:47], v[144:147]
    ds_read_b64_tr_b16 v[62:63], v10 offset:512
    v_mfma_f32_16x16x32_bf16 v[148:151], v[28:31], v[48:51], v[148:151]
    ds_read_b64_tr_b16 v[64:65], v11 offset:0
    v_mfma_f32_16x16x32_bf16 v[152:155], v[32:35], v[48:51], v[152:155]
    ds_read_b64_tr_b16 v[66:67], v11 offset:512
    v_mfma_f32_16x16x32_bf16 v[156:159], v[36:39], v[48:51], v[156:159]
    v_mfma_f32_16x16x32_bf16 v[160:163], v[40:43], v[48:51], v[160:163]
    s_waitcnt lgkmcnt(9)
    v_mfma_f32_16x16x32_bf16 v[100:103], v[12:15], v[52:55], v[100:103]
    ds_read_b128 v[28:31], v5 offset:16384
    s_waitcnt lgkmcnt(9)
    v_mfma_f32_16x16x32_bf16 v[104:107], v[16:19], v[52:55], v[104:107]
    ds_read_b64_tr_b16 v[44:45], v8 offset:28672
    s_waitcnt lgkmcnt(9)
    v_mfma_f32_16x16x32_bf16 v[108:111], v[20:23], v[52:55], v[108:111]
    ds_read_b64_tr_b16 v[46:47], v8 offset:29184
    s_waitcnt lgkmcnt(9)
    v_mfma_f32_16x16x32_bf16 v[112:115], v[24:27], v[52:55], v[112:115]
    ds_read_b128 v[32:35], v5 offset:18432
    s_waitcnt lgkmcnt(8)
    s_nop 0
    v_mfma_f32_16x16x32_bf16 v[116:119], v[12:15], v[56:59], v[116:119]
    ds_read_b128 v[36:39], v5 offset:20480
    v_mfma_f32_16x16x32_bf16 v[120:123], v[16:19], v[56:59], v[120:123]
    ds_read_b128 v[40:43], v5 offset:22528
    v_mfma_f32_16x16x32_bf16 v[124:127], v[20:23], v[56:59], v[124:127]
    ds_read_b64_tr_b16 v[48:49], v9 offset:28672
    v_mfma_f32_16x16x32_bf16 v[128:131], v[24:27], v[56:59], v[128:131]
    ds_read_b64_tr_b16 v[50:51], v9 offset:29184
    s_waitcnt lgkmcnt(10)
    s_nop 0
    v_mfma_f32_16x16x32_bf16 v[132:135], v[12:15], v[60:63], v[132:135]
    ds_read_b64_tr_b16 v[52:53], v10 offset:4096
    v_mfma_f32_16x16x32_bf16 v[136:139], v[16:19], v[60:63], v[136:139]
    ds_read_b64_tr_b16 v[54:55], v10 offset:4608
    v_mfma_f32_16x16x32_bf16 v[140:143], v[20:23], v[60:63], v[140:143]
    ds_read_b64_tr_b16 v[56:57], v11 offset:4096
    v_mfma_f32_16x16x32_bf16 v[144:147], v[24:27], v[60:63], v[144:147]
    ds_read_b64_tr_b16 v[58:59], v11 offset:4608
    s_waitcnt lgkmcnt(12)
    v_mfma_f32_16x16x32_bf16 v[148:151], v[12:15], v[64:67], v[148:151]
    v_mfma_f32_16x16x32_bf16 v[152:155], v[16:19], v[64:67], v[152:155]
    v_mfma_f32_16x16x32_bf16 v[156:159], v[20:23], v[64:67], v[156:159]
    v_mfma_f32_16x16x32_bf16 v[160:163], v[24:27], v[64:67], v[160:163]
    s_waitcnt lgkmcnt(9)
    v_mfma_f32_16x16x32_bf16 v[100:103], v[28:31], v[44:47], v[100:103]
    s_waitcnt lgkmcnt(8)
    v_mfma_f32_16x16x32_bf16 v[104:107], v[32:35], v[44:47], v[104:107]
    s_waitcnt lgkmcnt(0)
    s_barrier
    s_nop 0
    v_mfma_f32_16x16x32_bf16 v[108:111], v[36:39], v[44:47], v[108:111]
    ds_read_b128 v[12:15], v4 offset:32768
    v_mfma_f32_16x16x32_bf16 v[112:115], v[40:43], v[44:47], v[112:115]
    ds_read_b64_tr_b16 v[60:61], v10 offset:8192
    v_mfma_f32_16x16x32_bf16 v[116:119], v[28:31], v[48:51], v[116:119]
    ds_read_b64_tr_b16 v[62:63], v10 offset:8704
    v_mfma_f32_16x16x32_bf16 v[120:123], v[32:35], v[48:51], v[120:123]
    ds_read_b128 v[16:19], v4 offset:34816
    v_mfma_f32_16x16x32_bf16 v[124:127], v[36:39], v[48:51], v[124:127]
    ds_read_b128 v[20:23], v4 offset:36864
    v_mfma_f32_16x16x32_bf16 v[128:131], v[40:43], v[48:51], v[128:131]
    ds_read_b128 v[24:27], v4 offset:38912
    v_mfma_f32_16x16x32_bf16 v[132:135], v[28:31], v[52:55], v[132:135]
    ds_read_b64_tr_b16 v[64:65], v11 offset:8192
    v_mfma_f32_16x16x32_bf16 v[136:139], v[32:35], v[52:55], v[136:139]
    ds_read_b64_tr_b16 v[66:67], v11 offset:8704
    v_mfma_f32_16x16x32_bf16 v[140:143], v[36:39], v[52:55], v[140:143]
    ds_read_b64_tr_b16 v[44:45], v10 offset:16384
    v_mfma_f32_16x16x32_bf16 v[144:147], v[40:43], v[52:55], v[144:147]
    ds_read_b64_tr_b16 v[46:47], v10 offset:16896
    v_mfma_f32_16x16x32_bf16 v[148:151], v[28:31], v[56:59], v[148:151]
    ds_read_b64_tr_b16 v[48:49], v11 offset:16384
    v_mfma_f32_16x16x32_bf16 v[152:155], v[32:35], v[56:59], v[152:155]
    ds_read_b64_tr_b16 v[50:51], v11 offset:16896
    v_mfma_f32_16x16x32_bf16 v[156:159], v[36:39], v[56:59], v[156:159]
    v_mfma_f32_16x16x32_bf16 v[160:163], v[40:43], v[56:59], v[160:163]
    s_waitcnt lgkmcnt(9)
    v_mfma_f32_16x16x32_bf16 v[100:103], v[12:15], v[60:63], v[100:103]
    ds_read_b128 v[28:31], v5 offset:32768
    s_waitcnt lgkmcnt(9)
    v_mfma_f32_16x16x32_bf16 v[104:107], v[16:19], v[60:63], v[104:107]
    ds_read_b64_tr_b16 v[52:53], v10 offset:12288
    s_waitcnt lgkmcnt(9)
    v_mfma_f32_16x16x32_bf16 v[108:111], v[20:23], v[60:63], v[108:111]
    ds_read_b64_tr_b16 v[54:55], v10 offset:12800
    s_waitcnt lgkmcnt(9)
    v_mfma_f32_16x16x32_bf16 v[112:115], v[24:27], v[60:63], v[112:115]
    ds_read_b128 v[32:35], v5 offset:34816
    s_waitcnt lgkmcnt(8)
    s_nop 0
    v_mfma_f32_16x16x32_bf16 v[116:119], v[12:15], v[64:67], v[116:119]
    ds_read_b128 v[36:39], v5 offset:36864
    v_mfma_f32_16x16x32_bf16 v[120:123], v[16:19], v[64:67], v[120:123]
    ds_read_b128 v[40:43], v5 offset:38912
    v_mfma_f32_16x16x32_bf16 v[124:127], v[20:23], v[64:67], v[124:127]
    ds_read_b64_tr_b16 v[56:57], v11 offset:12288
    v_mfma_f32_16x16x32_bf16 v[128:131], v[24:27], v[64:67], v[128:131]
    ds_read_b64_tr_b16 v[58:59], v11 offset:12800
    s_waitcnt lgkmcnt(10)
    s_nop 0
    v_mfma_f32_16x16x32_bf16 v[132:135], v[12:15], v[44:47], v[132:135]
    ds_read_b64_tr_b16 v[60:61], v10 offset:20480
    v_mfma_f32_16x16x32_bf16 v[136:139], v[16:19], v[44:47], v[136:139]
    ds_read_b64_tr_b16 v[62:63], v10 offset:20992
    v_mfma_f32_16x16x32_bf16 v[140:143], v[20:23], v[44:47], v[140:143]
    ds_read_b64_tr_b16 v[64:65], v11 offset:20480
    v_mfma_f32_16x16x32_bf16 v[144:147], v[24:27], v[44:47], v[144:147]
    ds_read_b64_tr_b16 v[66:67], v11 offset:20992
    s_waitcnt lgkmcnt(12)
    v_mfma_f32_16x16x32_bf16 v[148:151], v[12:15], v[48:51], v[148:151]
    v_mfma_f32_16x16x32_bf16 v[152:155], v[16:19], v[48:51], v[152:155]
    v_mfma_f32_16x16x32_bf16 v[156:159], v[20:23], v[48:51], v[156:159]
    v_mfma_f32_16x16x32_bf16 v[160:163], v[24:27], v[48:51], v[160:163]
    s_waitcnt lgkmcnt(9)
    v_mfma_f32_16x16x32_bf16 v[100:103], v[28:31], v[52:55], v[100:103]
    s_waitcnt lgkmcnt(8)
    v_mfma_f32_16x16x32_bf16 v[104:107], v[32:35], v[52:55], v[104:107]
    s_waitcnt lgkmcnt(0)
    s_barrier
    s_nop 0
    v_mfma_f32_16x16x32_bf16 v[108:111], v[36:39], v[52:55], v[108:111]
    ds_read_b128 v[12:15], v4 offset:49152
    v_mfma_f32_16x16x32_bf16 v[112:115], v[40:43], v[52:55], v[112:115]
    ds_read_b64_tr_b16 v[44:45], v8 offset:0
    v_mfma_f32_16x16x32_bf16 v[116:119], v[28:31], v[56:59], v[116:119]
    ds_read_b64_tr_b16 v[46:47], v8 offset:512
    v_mfma_f32_16x16x32_bf16 v[120:123], v[32:35], v[56:59], v[120:123]
    ds_read_b128 v[16:19], v4 offset:51200
    v_mfma_f32_16x16x32_bf16 v[124:127], v[36:39], v[56:59], v[124:127]
    ds_read_b128 v[20:23], v4 offset:53248
    v_mfma_f32_16x16x32_bf16 v[128:131], v[40:43], v[56:59], v[128:131]
    ds_read_b128 v[24:27], v4 offset:55296
    v_mfma_f32_16x16x32_bf16 v[132:135], v[28:31], v[60:63], v[132:135]
    ds_read_b64_tr_b16 v[48:49], v9 offset:0
    v_mfma_f32_16x16x32_bf16 v[136:139], v[32:35], v[60:63], v[136:139]
    ds_read_b64_tr_b16 v[50:51], v9 offset:512
    v_mfma_f32_16x16x32_bf16 v[140:143], v[36:39], v[60:63], v[140:143]
    ds_read_b64_tr_b16 v[52:53], v10 offset:24576
    v_mfma_f32_16x16x32_bf16 v[144:147], v[40:43], v[60:63], v[144:147]
    ds_read_b64_tr_b16 v[54:55], v10 offset:25088
    v_mfma_f32_16x16x32_bf16 v[148:151], v[28:31], v[64:67], v[148:151]
    ds_read_b64_tr_b16 v[56:57], v11 offset:24576
    v_mfma_f32_16x16x32_bf16 v[152:155], v[32:35], v[64:67], v[152:155]
    ds_read_b64_tr_b16 v[58:59], v11 offset:25088
    v_mfma_f32_16x16x32_bf16 v[156:159], v[36:39], v[64:67], v[156:159]
    v_mfma_f32_16x16x32_bf16 v[160:163], v[40:43], v[64:67], v[160:163]
    ds_read_b32 v68, v1 offset:48
    s_waitcnt lgkmcnt(10)
    v_mfma_f32_16x16x32_bf16 v[100:103], v[12:15], v[44:47], v[100:103]
    ds_read_b128 v[28:31], v5 offset:49152
    s_waitcnt lgkmcnt(10)
    v_mfma_f32_16x16x32_bf16 v[104:107], v[16:19], v[44:47], v[104:107]
    ds_read_b64_tr_b16 v[60:61], v8 offset:4096
    s_waitcnt lgkmcnt(10)
    v_mfma_f32_16x16x32_bf16 v[108:111], v[20:23], v[44:47], v[108:111]
    ds_read_b64_tr_b16 v[62:63], v8 offset:4608
    s_waitcnt lgkmcnt(10)
    v_mfma_f32_16x16x32_bf16 v[112:115], v[24:27], v[44:47], v[112:115]
    ds_read_b128 v[32:35], v5 offset:51200
    s_waitcnt lgkmcnt(9)
    s_nop 0
    v_mfma_f32_16x16x32_bf16 v[116:119], v[12:15], v[48:51], v[116:119]
    ds_read_b128 v[36:39], v5 offset:53248
    v_mfma_f32_16x16x32_bf16 v[120:123], v[16:19], v[48:51], v[120:123]
    ds_read_b128 v[40:43], v5 offset:55296
    v_mfma_f32_16x16x32_bf16 v[124:127], v[20:23], v[48:51], v[124:127]
    ds_read_b64_tr_b16 v[64:65], v9 offset:4096
    v_mfma_f32_16x16x32_bf16 v[128:131], v[24:27], v[48:51], v[128:131]
    ds_read_b64_tr_b16 v[66:67], v9 offset:4608
    s_waitcnt lgkmcnt(11)
    s_nop 0
    v_mfma_f32_16x16x32_bf16 v[132:135], v[12:15], v[52:55], v[132:135]
    ds_read_b64_tr_b16 v[44:45], v10 offset:28672
    v_mfma_f32_16x16x32_bf16 v[136:139], v[16:19], v[52:55], v[136:139]
    ds_read_b64_tr_b16 v[46:47], v10 offset:29184
    v_mfma_f32_16x16x32_bf16 v[140:143], v[20:23], v[52:55], v[140:143]
    ds_read_b64_tr_b16 v[48:49], v11 offset:28672
    v_mfma_f32_16x16x32_bf16 v[144:147], v[24:27], v[52:55], v[144:147]
    ds_read_b64_tr_b16 v[50:51], v11 offset:29184
    s_waitcnt lgkmcnt(13)
    v_mfma_f32_16x16x32_bf16 v[148:151], v[12:15], v[56:59], v[148:151]
    v_mfma_f32_16x16x32_bf16 v[152:155], v[16:19], v[56:59], v[152:155]
    v_mfma_f32_16x16x32_bf16 v[156:159], v[20:23], v[56:59], v[156:159]
    v_mfma_f32_16x16x32_bf16 v[160:163], v[24:27], v[56:59], v[160:163]
    s_waitcnt lgkmcnt(9)
    v_mfma_f32_16x16x32_bf16 v[100:103], v[28:31], v[60:63], v[100:103]
    v_lshlrev_b32 v18, 4, v0
    v_add_u32 v12, s52, v18
    s_waitcnt lgkmcnt(8)
    v_mfma_f32_16x16x32_bf16 v[104:107], v[32:35], v[60:63], v[104:107]
    v_xor_b32 v13, 4096, v12
    v_and_b32 v14, 0x30, v0
    s_waitcnt lgkmcnt(0)
    s_barrier
    v_cmp_gt_u32 vcc, 1, v68
    s_nop 0
    s_and_b32 vcc_lo, vcc_lo, 3
    s_cbranch_scc0 SCK_13
    v_and_b32 v69, 1, v0
    v_lshlrev_b32 v69, 2, v69
    v_add_u32 v69, 159088, v69
    ds_read_b32 v68, v69 offset:0
FW_14:
    s_waitcnt lgkmcnt(0)
    v_cmp_gt_u32 vcc, 1, v68
    s_cbranch_vccz FO_15
    ds_read_b32 v68, v69 offset:0
    s_branch FW_14
FO_15:
SCK_13:
    v_mfma_f32_16x16x32_bf16 v[108:111], v[36:39], v[60:63], v[108:111]
    ds_read_b128 v[68:71], v164 offset:0
    v_add_u32 v14, s53, v14
    v_mfma_f32_16x16x32_bf16 v[112:115], v[40:43], v[60:63], v[112:115]
    ds_read2_b32 v[52:53], v165 offset0:64 offset1:64
    v_xor_b32 v15, 64, v14
    v_mfma_f32_16x16x32_bf16 v[116:119], v[28:31], v[64:67], v[116:119]
    ds_read2_b32 v[54:55], v2 offset0:64 offset1:64
    v_lshlrev_b32 v19, 2, v0
    v_mfma_f32_16x16x32_bf16 v[120:123], v[32:35], v[64:67], v[120:123]
    ds_read2_b32 v[56:57], v165 offset0:128 offset1:128
    v_add_u32 v16, s53, v19
    v_mfma_f32_16x16x32_bf16 v[124:127], v[36:39], v[64:67], v[124:127]
    ds_read2_b32 v[58:59], v2 offset0:128 offset1:128
    v_xor_b32 v17, 256, v16
    v_mfma_f32_16x16x32_bf16 v[128:131], v[40:43], v[64:67], v[128:131]
    ds_read_b128 v[72:75], v164 offset:1024
    v_xor_b32_e64 v18, 8, v3
    v_mfma_f32_16x16x32_bf16 v[132:135], v[28:31], v[44:47], v[132:135]
    ds_read_b128 v[76:79], v164 offset:64
    v_writelane_b32 v18, s50, 1
    v_mfma_f32_16x16x32_bf16 v[136:139], v[32:35], v[44:47], v[136:139]
    ds_read_b128 v[80:83], v164 offset:1088
    v_mov_b32 v20, 0x3f803f80
    v_mfma_f32_16x16x32_bf16 v[140:143], v[36:39], v[44:47], v[140:143]
    ds_read_b128 v[84:87], v164 offset:128
    v_mov_b32 v21, 0x3f803f80
    v_mfma_f32_16x16x32_bf16 v[144:147], v[40:43], v[44:47], v[144:147]
    ds_read_b128 v[88:91], v164 offset:1152
    v_mov_b32 v22, 0x3f803f80
    v_mfma_f32_16x16x32_bf16 v[148:151], v[28:31], v[48:51], v[148:151]
    ds_read_b128 v[92:95], v164 offset:192
    v_mov_b32 v23, 0x3f803f80
    v_mfma_f32_16x16x32_bf16 v[152:155], v[32:35], v[48:51], v[152:155]
    ds_read_b128 v[96:99], v164 offset:1216
    v_mov_b32 v24, 1
    v_and_b32 v4, 15, v0
    v_mfma_f32_16x16x32_bf16 v[156:159], v[36:39], v[48:51], v[156:159]
    v_bfe_u32 v5, v0, 4, 1
    v_lshlrev_b32 v5, 5, v5
    v_mfma_f32_16x16x32_bf16 v[160:163], v[40:43], v[48:51], v[160:163]
    v_lshrrev_b32 v6, 5, v0
    v_lshl_add_u32 v5, v6, 4, v5
    v_lshl_add_u32 v7, v4, 11, v5
    v_lshlrev_b32 v6, 4, v0
    s_waitcnt lgkmcnt(10)
    v_pk_fma_f32 v[100:101], v[68:69], v[52:53], v[100:101]
    v_pk_fma_f32 v[102:103], v[70:71], v[52:53], v[102:103]
    s_waitcnt lgkmcnt(9)
    v_pk_fma_f32 v[116:117], v[68:69], v[54:55], v[116:117]
    v_pk_fma_f32 v[118:119], v[70:71], v[54:55], v[118:119]
    s_waitcnt lgkmcnt(8)
    v_pk_fma_f32 v[132:133], v[68:69], v[56:57], v[132:133]
    v_pk_fma_f32 v[134:135], v[70:71], v[56:57], v[134:135]
    s_waitcnt lgkmcnt(7)
    v_pk_fma_f32 v[148:149], v[68:69], v[58:59], v[148:149]
    v_pk_fma_f32 v[150:151], v[70:71], v[58:59], v[150:151]
    s_waitcnt lgkmcnt(6)
    v_pk_mul_f32 v[100:101], v[100:101], v[72:73]
    v_pk_mul_f32 v[102:103], v[102:103], v[74:75]
    v_pk_mul_f32 v[116:117], v[116:117], v[72:73]
    v_pk_mul_f32 v[118:119], v[118:119], v[74:75]
    v_pk_mul_f32 v[132:133], v[132:133], v[72:73]
    v_pk_mul_f32 v[134:135], v[134:135], v[74:75]
    v_pk_mul_f32 v[148:149], v[148:149], v[72:73]
    v_pk_mul_f32 v[150:151], v[150:151], v[74:75]
    v_exp_f32 v28, v100 clamp
    v_exp_f32 v29, v101 clamp
    v_exp_f32 v30, v102 clamp
    v_exp_f32 v31, v103 clamp
    v_exp_f32 v32, v116 clamp
    v_exp_f32 v33, v117 clamp
    v_exp_f32 v34, v118 clamp
    v_exp_f32 v35, v119 clamp
    v_cvt_pk_bf16_f32 v132, v132, v133
    v_cvt_pk_bf16_f32 v133, v134, v135
    v_cvt_pk_bf16_f32 v148, v148, v149
    v_cvt_pk_bf16_f32 v149, v150, v151
    v_pk_mul_f32 v[100:101], v[100:101], s[40:41] clamp
    v_pk_mul_f32 v[102:103], v[102:103], s[40:41] clamp
    v_pk_mul_f32 v[116:117], v[116:117], s[40:41] clamp
    v_pk_mul_f32 v[118:119], v[118:119], s[40:41] clamp
    v_pk_add_f32 v[28:29], v[28:29], s[74:75]
    v_pk_add_f32 v[30:31], v[30:31], s[74:75]
    v_pk_add_f32 v[32:33], v[32:33], s[74:75]
    v_pk_add_f32 v[34:35], v[34:35], s[74:75]
    v_pk_fma_f32 v[100:101], v[100:101], s[76:77], v[28:29]
    v_pk_fma_f32 v[102:103], v[102:103], s[76:77], v[30:31]
    v_pk_fma_f32 v[116:117], v[116:117], s[76:77], v[32:33]
    v_pk_fma_f32 v[118:119], v[118:119], s[76:77], v[34:35]
    v_cvt_pk_bf16_f32 v100, v100, v101
    v_cvt_pk_bf16_f32 v101, v102, v103
    v_cvt_pk_bf16_f32 v116, v116, v117
    v_cvt_pk_bf16_f32 v117, v118, v119
    s_waitcnt lgkmcnt(5)
    s_nop 0
    v_pk_fma_f32 v[104:105], v[76:77], v[52:53], v[104:105]
    v_pk_fma_f32 v[106:107], v[78:79], v[52:53], v[106:107]
    v_pk_fma_f32 v[120:121], v[76:77], v[54:55], v[120:121]
    v_pk_fma_f32 v[122:123], v[78:79], v[54:55], v[122:123]
    v_pk_fma_f32 v[136:137], v[76:77], v[56:57], v[136:137]
    v_pk_fma_f32 v[138:139], v[78:79], v[56:57], v[138:139]
    v_pk_fma_f32 v[152:153], v[76:77], v[58:59], v[152:153]
    v_pk_fma_f32 v[154:155], v[78:79], v[58:59], v[154:155]
    s_waitcnt lgkmcnt(4)
    s_nop 0
    v_pk_mul_f32 v[104:105], v[104:105], v[80:81]
    v_pk_mul_f32 v[106:107], v[106:107], v[82:83]
    v_pk_mul_f32 v[120:121], v[120:121], v[80:81]
    v_pk_mul_f32 v[122:123], v[122:123], v[82:83]
    v_pk_mul_f32 v[136:137], v[136:137], v[80:81]
    v_pk_mul_f32 v[138:139], v[138:139], v[82:83]
    v_pk_mul_f32 v[152:153], v[152:153], v[80:81]
    v_pk_mul_f32 v[154:155], v[154:155], v[82:83]
    v_exp_f32 v36, v104 clamp
    v_exp_f32 v37, v105 clamp
    v_exp_f32 v38, v106 clamp
    v_exp_f32 v39, v107 clamp
    v_exp_f32 v40, v120 clamp
    v_exp_f32 v41, v121 clamp
    v_exp_f32 v42, v122 clamp
    v_exp_f32 v43, v123 clamp
    v_cvt_pk_bf16_f32 v134, v136, v137
    v_cvt_pk_bf16_f32 v135, v138, v139
    v_cvt_pk_bf16_f32 v150, v152, v153
    v_cvt_pk_bf16_f32 v151, v154, v155
    v_pk_mul_f32 v[104:105], v[104:105], s[40:41] clamp
    v_pk_mul_f32 v[106:107], v[106:107], s[40:41] clamp
    v_pk_mul_f32 v[120:121], v[120:121], s[40:41] clamp
    v_pk_mul_f32 v[122:123], v[122:123], s[40:41] clamp
    v_pk_add_f32 v[36:37], v[36:37], s[74:75]
    v_pk_add_f32 v[38:39], v[38:39], s[74:75]
    v_pk_add_f32 v[40:41], v[40:41], s[74:75]
    v_pk_add_f32 v[42:43], v[42:43], s[74:75]
    v_pk_fma_f32 v[104:105], v[104:105], s[76:77], v[36:37]
    v_pk_fma_f32 v[106:107], v[106:107], s[76:77], v[38:39]
    v_pk_fma_f32 v[120:121], v[120:121], s[76:77], v[40:41]
    v_pk_fma_f32 v[122:123], v[122:123], s[76:77], v[42:43]
    v_cvt_pk_bf16_f32 v102, v104, v105
    v_cvt_pk_bf16_f32 v103, v106, v107
    v_cvt_pk_bf16_f32 v118, v120, v121
    v_cvt_pk_bf16_f32 v119, v122, v123
    s_waitcnt lgkmcnt(3)
    s_nop 0
    v_pk_fma_f32 v[108:109], v[84:85], v[52:53], v[108:109]
    v_pk_fma_f32 v[110:111], v[86:87], v[52:53], v[110:111]
    v_pk_fma_f32 v[124:125], v[84:85], v[54:55], v[124:125]
    v_pk_fma_f32 v[126:127], v[86:87], v[54:55], v[126:127]
    v_pk_fma_f32 v[140:141], v[84:85], v[56:57], v[140:141]
    v_pk_fma_f32 v[142:143], v[86:87], v[56:57], v[142:143]
    v_pk_fma_f32 v[156:157], v[84:85], v[58:59], v[156:157]
    v_pk_fma_f32 v[158:159], v[86:87], v[58:59], v[158:159]
    s_waitcnt lgkmcnt(2)
    s_nop 0
    v_pk_mul_f32 v[108:109], v[108:109], v[88:89]
    v_pk_mul_f32 v[110:111], v[110:111], v[90:91]
    v_pk_mul_f32 v[124:125], v[124:125], v[88:89]
    v_pk_mul_f32 v[126:127], v[126:127], v[90:91]
    v_pk_mul_f32 v[140:141], v[140:141], v[88:89]
    v_pk_mul_f32 v[142:143], v[142:143], v[90:91]
    v_pk_mul_f32 v[156:157], v[156:157], v[88:89]
    v_pk_mul_f32 v[158:159], v[158:159], v[90:91]
    v_mfma_f32_16x16x32_bf16 v[60:63], v[100:103], v[148:151], 0
    v_exp_f32 v28, v108 clamp
    v_exp_f32 v29, v109 clamp
    v_mfma_f32_16x16x32_bf16 v[64:67], v[116:119], v[148:151], 0
    v_exp_f32 v30, v110 clamp
    v_exp_f32 v31, v111 clamp
    v_mfma_f32_16x16x32_bf16 v[68:71], v[100:103], v[20:23], 0
    v_exp_f32 v32, v124 clamp
    v_exp_f32 v33, v125 clamp
    v_exp_f32 v34, v126 clamp
    v_exp_f32 v35, v127 clamp
    v_cvt_pk_bf16_f32 v136, v140, v141
    v_cvt_pk_bf16_f32 v137, v142, v143
    v_cvt_pk_bf16_f32 v152, v156, v157
    v_cvt_pk_bf16_f32 v153, v158, v159
    v_pk_mul_f32 v[108:109], v[108:109], s[40:41] clamp
    v_pk_mul_f32 v[110:111], v[110:111], s[40:41] clamp
    v_pk_mul_f32 v[124:125], v[124:125], s[40:41] clamp
    v_pk_mul_f32 v[126:127], v[126:127], s[40:41] clamp
    v_pk_add_f32 v[28:29], v[28:29], s[74:75]
    v_pk_add_f32 v[30:31], v[30:31], s[74:75]
    v_pk_add_f32 v[32:33], v[32:33], s[74:75]
    v_pk_add_f32 v[34:35], v[34:35], s[74:75]
    v_pk_fma_f32 v[108:109], v[108:109], s[76:77], v[28:29]
    v_pk_fma_f32 v[110:111], v[110:111], s[76:77], v[30:31]
    v_pk_fma_f32 v[124:125], v[124:125], s[76:77], v[32:33]
    v_pk_fma_f32 v[126:127], v[126:127], s[76:77], v[34:35]
    s_branch IW_s5
IW_w5:
    s_branch IW_r5
IW_s5:
    v_cvt_pk_bf16_f32 v104, v108, v109
    v_cvt_pk_bf16_f32 v105, v110, v111
    v_cvt_pk_bf16_f32 v120, v124, v125
    v_cvt_pk_bf16_f32 v121, v126, v127
    s_waitcnt lgkmcnt(1)
    s_nop 0
    v_pk_fma_f32 v[112:113], v[92:93], v[52:53], v[112:113]
    v_pk_fma_f32 v[114:115], v[94:95], v[52:53], v[114:115]
    v_pk_fma_f32 v[128:129], v[92:93], v[54:55], v[128:129]
    v_pk_fma_f32 v[130:131], v[94:95], v[54:55], v[130:131]
    v_pk_fma_f32 v[144:145], v[92:93], v[56:57], v[144:145]
    v_pk_fma_f32 v[146:147], v[94:95], v[56:57], v[146:147]
    v_pk_fma_f32 v[160:161], v[92:93], v[58:59], v[160:161]
    v_pk_fma_f32 v[162:163], v[94:95], v[58:59], v[162:163]
    s_waitcnt lgkmcnt(0)
    s_nop 0
    v_pk_mul_f32 v[112:113], v[112:113], v[96:97]
    v_pk_mul_f32 v[114:115], v[114:115], v[98:99]
    v_pk_mul_f32 v[128:129], v[128:129], v[96:97]
    v_pk_mul_f32 v[130:131], v[130:131], v[98:99]
    v_pk_mul_f32 v[144:145], v[144:145], v[96:97]
    v_pk_mul_f32 v[146:147], v[146:147], v[98:99]
    v_pk_mul_f32 v[160:161], v[160:161], v[96:97]
    v_pk_mul_f32 v[162:163], v[162:163], v[98:99]
    v_mfma_f32_16x16x32_bf16 v[72:75], v[116:119], v[20:23], 0
    v_exp_f32 v36, v112 clamp
    v_exp_f32 v37, v113 clamp
    v_mfma_f32_16x16x32_bf16 v[44:47], v[100:103], v[132:135], 0
    v_exp_f32 v38, v114 clamp
    v_exp_f32 v39, v115 clamp
    v_mfma_f32_16x16x32_bf16 v[48:51], v[116:119], v[132:135], 0
    v_exp_f32 v40, v128 clamp
    v_exp_f32 v41, v129 clamp
    v_exp_f32 v42, v130 clamp
    v_exp_f32 v43, v131 clamp
    v_cvt_pk_bf16_f32 v138, v144, v145
    v_cvt_pk_bf16_f32 v139, v146, v147
    v_cvt_pk_bf16_f32 v154, v160, v161
    v_cvt_pk_bf16_f32 v155, v162, v163
    v_pk_mul_f32 v[112:113], v[112:113], s[40:41] clamp
    v_pk_mul_f32 v[114:115], v[114:115], s[40:41] clamp
    v_pk_mul_f32 v[128:129], v[128:129], s[40:41] clamp
    v_pk_mul_f32 v[130:131], v[130:131], s[40:41] clamp
    v_pk_add_f32 v[36:37], v[36:37], s[74:75]
    v_pk_add_f32 v[38:39], v[38:39], s[74:75]
    v_pk_add_f32 v[40:41], v[40:41], s[74:75]
    v_pk_add_f32 v[42:43], v[42:43], s[74:75]
    v_pk_fma_f32 v[112:113], v[112:113], s[76:77], v[36:37]
    v_pk_fma_f32 v[114:115], v[114:115], s[76:77], v[38:39]
    v_pk_fma_f32 v[128:129], v[128:129], s[76:77], v[40:41]
    v_pk_fma_f32 v[130:131], v[130:131], s[76:77], v[42:43]
    v_cvt_pk_bf16_f32 v106, v112, v113
    v_cvt_pk_bf16_f32 v107, v114, v115
    v_cvt_pk_bf16_f32 v122, v128, v129
    v_cvt_pk_bf16_f32 v123, v130, v131
    v_mfma_f32_16x16x32_bf16 v[60:63], v[104:107], v[152:155], v[60:63]
    s_nop 0
    s_nop 0
    v_mfma_f32_16x16x32_bf16 v[64:67], v[120:123], v[152:155], v[64:67]
    v_mfma_f32_16x16x32_bf16 v[68:71], v[104:107], v[20:23], v[68:71]
    v_mfma_f32_16x16x32_bf16 v[72:75], v[120:123], v[20:23], v[72:75]
    v_mfma_f32_16x16x32_bf16 v[44:47], v[104:107], v[136:139], v[44:47]
    v_mfma_f32_16x16x32_bf16 v[48:51], v[120:123], v[136:139], v[48:51]
    buffer_load_dwordx4 v[140:143], v7, s[12:15], s42 offen offset:0
    buffer_load_dwordx4 v[144:147], v7, s[12:15], s42 offen offset:64
    buffer_load_dwordx4 v[156:159], v7, s[12:15], s43 offen offset:0
    buffer_load_dwordx4 v[160:163], v7, s[12:15], s43 offen offset:64
    ds_write_b128 v12, v[60:63] offset:0
    ds_write_b128 v12, v[64:67] offset:1024
    s_mov_b32 exec_lo, 0x10001
    s_mov_b32 exec_hi, 0x10001
    ds_write_b128 v14, v[68:71]
    ds_write_b128 v15, v[72:75]
    s_mov_b64 exec, 1
    ds_write_b32 v3, v24 offset:32
    s_mov_b64 exec, -1
F_xw:
    ds_read_b32 v25, v18 offset:32
    ds_read_b128 v[28:31], v13 offset:1024
    ds_read_b128 v[32:35], v13
    ds_read_b32 v26, v16
    ds_read_b32 v27, v17
    s_waitcnt lgkmcnt(4)
    v_cmp_eq_u32 vcc, 0, v25
    s_cbranch_vccz F_xx
    s_waitcnt lgkmcnt(0)
    s_branch F_xw
F_xx:
    s_waitcnt lgkmcnt(3)
    v_add_f32 v44, v44, v28
    v_add_f32 v45, v45, v29
    v_add_f32 v46, v46, v30
    v_add_f32 v47, v47, v31
    buffer_atomic_add_f32 v44, v19, s[24:27], s46 offen offset:0
    buffer_atomic_add_f32 v45, v19, s[24:27], s46 offen offset:256
    buffer_atomic_add_f32 v46, v19, s[24:27], s46 offen offset:512
    buffer_atomic_add_f32 v47, v19, s[24:27], s46 offen offset:768
    s_waitcnt lgkmcnt(2)
    v_add_f32 v48, v48, v32
    v_add_f32 v49, v49, v33
    v_add_f32 v50, v50, v34
    v_add_f32 v51, v51, v35
    buffer_atomic_add_f32 v48, v19, s[24:27], s47 offen offset:0
    buffer_atomic_add_f32 v49, v19, s[24:27], s47 offen offset:256
    buffer_atomic_add_f32 v50, v19, s[24:27], s47 offen offset:512
    buffer_atomic_add_f32 v51, v19, s[24:27], s47 offen offset:768
    s_waitcnt lgkmcnt(0)
    v_add_f32 v26, v26, v27
    s_mov_b64 exec, 0xffff
    buffer_atomic_add_f32 v26, v19, s[24:27], s48 offen
    s_mov_b64 exec, 1
    ds_add_u32 v3, v24 offset:32
    s_mov_b64 exec, -1
    s_setprio 2
    v_mov_b32 v2, v7
    s_lshl_b32 s47, s3, 7
    s_add_u32 s47, s47, 157184
    v_lshlrev_b32 v5, 2, v4
    v_add_u32 v5, s47, v5
    ds_read2_b32 v[76:77], v5 offset0:0 offset1:128
    ds_read2_b32 v[78:79], v5 offset0:16 offset1:144
    v_lshrrev_b32 v4, 3, v0
    v_and_b32 v5, 7, v0
    v_lshrrev_b32 v6, 1, v4
    v_lshlrev_b32 v7, 1, v6
    v_xor_b32 v7, v5, v7
    v_lshlrev_b32 v7, 4, v7
    v_lshl_add_u32 v40, v4, 11, v7
    v_and_b32 v6, 1, v6
    v_lshlrev_b32 v6, 1, v6
    v_xor_b32 v41, v5, v6
    v_xor_b32 v42, 4, v41
    v_lshlrev_b32 v41, 4, v41
    v_lshlrev_b32 v42, 4, v42
    v_mul_u32_u24 v7, 6144, v4
    v_add_u32 v41, v41, v7
    v_add_u32 v42, v42, v7
    v_add_u32 v42, 49152, v42
    s_mul_i32 s56, s3, 98304
    s_lshl_b32 s47, s10, 7
    s_add_u32 s56, s56, s47
    s_lshl_b32 s57, s29, 7
    s_lshl_b32 s47, s3, 15
    s_add_u32 s57, s57, s47
    s_and_b32 s81, s28, 3
    s_mul_i32 s81, s81, 4
    s_lshr_b32 s47, s28, 2
    s_mul_i32 s47, s47, 1
    s_add_u32 s81, s81, s47
    s_lshl_b32 s78, s3, 11
    s_lshl_b32 s44, s10, 1
    s_add_u32 s44, s44, s37
    s_mul_i32 s45, s44, 4224
    s_mov_b32 s52, s45
    s_add_u32 s53, s45, 4096
    s_lshl_b32 s51, s44, 2
    s_and_b32 s47, s32, 3
    s_add_u32 s51, s51, s47
    s_lshl_b32 s51, s51, 7
    v_xor_b32 v18, 8, v3
    v_mov_b32 v25, 0

    s_add_u32 s54, s51, 0x82d000
    s_add_u32 s54, s72, s54
    s_addc_u32 s55, s73, 0
    s_add_u32 s82, s49, 0x82d000
    s_add_u32 s82, s72, s82
    s_addc_u32 s83, s73, 0
    s_setprio 2
    s_waitcnt lgkmcnt(0)
    v_mul_f32 v76, v76, v77
    v_add_f32 v77, 1.0, v77
    v_mul_f32 v78, v78, v79
    v_add_f32 v79, 1.0, v79
    s_waitcnt vmcnt(9)
    v_lshlrev_b32 v100, 16, v140
    v_and_b32 v101, 0xffff0000, v140
    v_lshlrev_b32 v102, 16, v141
    v_and_b32 v103, 0xffff0000, v141
    v_lshlrev_b32 v104, 16, v142
    v_and_b32 v105, 0xffff0000, v142
    v_lshlrev_b32_e64 v106, 16, v143
    v_and_b32 v107, 0xffff0000, v143
    v_fma_f32 v100, v100, v77, v76
    v_fma_f32 v101, v101, v77, v76
    v_fma_f32 v102, v102, v77, v76
    v_fma_f32 v103, v103, v77, v76
    v_fma_f32 v104, v104, v77, v76
    v_fma_f32 v105, v105, v77, v76
    v_fma_f32 v106, v106, v77, v76
    v_fma_f32 v107, v107, v77, v76
    v_lshlrev_b32 v108, 16, v144
    v_and_b32 v109, 0xffff0000, v144
    v_lshlrev_b32 v110, 16, v145
    v_and_b32 v111, 0xffff0000, v145
    v_lshlrev_b32 v112, 16, v146
    v_and_b32 v113, 0xffff0000, v146
    v_lshlrev_b32 v114, 16, v147
    v_and_b32 v115, 0xffff0000, v147
    v_fma_f32 v108, v108, v77, v76
    v_fma_f32 v109, v109, v77, v76
    v_fma_f32 v110, v110, v77, v76
    v_fma_f32 v111, v111, v77, v76
    v_fma_f32 v112, v112, v77, v76
    v_fma_f32 v113, v113, v77, v76
    v_fma_f32 v114, v114, v77, v76
    v_fma_f32 v115, v115, v77, v76
    v_lshlrev_b32 v116, 16, v156
    v_and_b32 v117, 0xffff0000, v156
    v_lshlrev_b32 v118, 16, v157
    v_and_b32 v119, 0xffff0000, v157
    v_lshlrev_b32 v120, 16, v158
    v_and_b32 v121, 0xffff0000, v158
    v_lshlrev_b32 v122, 16, v159
    v_and_b32 v123, 0xffff0000, v159
    v_fma_f32 v116, v116, v79, v78
    v_fma_f32 v117, v117, v79, v78
    v_fma_f32 v118, v118, v79, v78
    v_fma_f32 v119, v119, v79, v78
    v_fma_f32 v120, v120, v79, v78
    v_fma_f32 v121, v121, v79, v78
    v_fma_f32 v122, v122, v79, v78
    v_fma_f32 v123, v123, v79, v78
    v_lshlrev_b32 v124, 16, v160
    v_and_b32 v125, 0xffff0000, v160
    v_lshlrev_b32 v126, 16, v161
    v_and_b32 v127, 0xffff0000, v161
    v_lshlrev_b32 v128, 16, v162
    v_and_b32 v129, 0xffff0000, v162
    v_lshlrev_b32 v130, 16, v163
    v_and_b32 v131, 0xffff0000, v163
    v_fma_f32 v124, v124, v79, v78
    v_fma_f32 v125, v125, v79, v78
    v_fma_f32 v126, v126, v79, v78
    v_fma_f32 v127, v127, v79, v78
    v_fma_f32 v128, v128, v79, v78
    v_fma_f32 v129, v129, v79, v78
    v_fma_f32 v130, v130, v79, v78
    v_fma_f32 v131, v131, v79, v78
    v_permlane16_swap_b32 v100, v104
    v_permlane16_swap_b32 v101, v105
    v_permlane16_swap_b32 v102, v106
    v_permlane16_swap_b32 v103, v107
    v_permlane16_swap_b32 v108, v112
    v_permlane16_swap_b32 v109, v113
    v_permlane16_swap_b32 v110, v114
    v_permlane16_swap_b32 v111, v115
    v_permlane16_swap_b32 v116, v120
    v_permlane16_swap_b32 v117, v121
    v_permlane16_swap_b32 v118, v122
    v_permlane16_swap_b32 v119, v123
    v_permlane16_swap_b32 v124, v128
    v_permlane16_swap_b32 v125, v129
    v_permlane16_swap_b32 v126, v130
    v_permlane16_swap_b32 v127, v131
    s_setprio 2
    s_waitcnt vmcnt(0)
    s_mov_b32 s49, 1
    s_atomic_add s49, s[82:83], 0x0
    s_atomic_add s49, s[82:83], 0x80
    s_atomic_add s49, s[82:83], 0x100
    s_atomic_add s49, s[82:83], 0x180
    v_mov_b32 v26, 3
    s_mov_b64 exec, 1
    ds_write_b32 v3, v26 offset:32
    s_mov_b64 exec, -1
    s_lshl_b32 s57, s29, 7
    s_and_b32 s47, s3, 1
    s_lshl_b32 s79, s47, 12
    s_lshl_b32 s47, s47, 16
    s_add_u32 s57, s57, s47

    s_cmp_ge_u32 s3, 2
    s_cbranch_scc1 F_wo
    ds_read_b32 v26, v18 offset:32
FW_16:
    s_waitcnt lgkmcnt(0)
    v_cmp_gt_u32 vcc, 2, v26
    s_cbranch_vccz FO_17
    ds_read_b32 v26, v18 offset:32
    s_branch FW_16
FO_17:
    v_lshlrev_b32 v9, 4, v0
    s_lshl_b32 s50, s3, 7
    s_add_u32 s50, s50, 159232
    s_add_u32 m0, s78, 65536
SP_18:
    s_load_dword s58, s[54:55], 0 glc
    s_waitcnt lgkmcnt(0)
    s_cmp_ge_u32 s58, 32
    s_cbranch_scc1 SD_19
    s_sleep 1
    s_branch SP_18
SD_19:
    buffer_load_dwordx4 v9, s[24:27], s52 offen offset:0 sc1 lds
    buffer_load_dwordx4 v9, s[24:27], s52 offen offset:1024 sc1 lds
    s_add_u32 m0, m0, 2048
    s_nop 0
    buffer_load_dwordx4 v9, s[24:27], s52 offen offset:2048 sc1 lds
    buffer_load_dwordx4 v9, s[24:27], s52 offen offset:3072 sc1 lds
    s_mov_b32 m0, s50
    s_mov_b32 exec_hi, 0
    buffer_load_dword v19, s[24:27], s53 offen sc1 lds
    s_mov_b64 exec, 1
    s_lshl_b32 s50, s3, 2
    s_add_u32 m0, s50, 159168
    s_add_u32 s51, s51, 184320
    buffer_load_dword v19, s[24:27], s51 offen sc1 lds
    s_waitcnt vmcnt(0)
    s_mov_b64 exec, 1
    s_mov_b64 exec, -1
    s_branch F_wj
F_wo:
    v_cmp_gt_u32 vcc, 1, v25
    s_cbranch_vccz CW_20
    ds_read_b32 v25, v1 offset:0
FW_21:
    s_waitcnt lgkmcnt(0)
    v_cmp_gt_u32 vcc, 1, v25
    s_cbranch_vccz FO_22
    s_sleep 2
    ds_read_b32 v25, v1 offset:0
    s_branch FW_21
FO_22:
CW_20:
    s_add_u32 s47, s81, 0
    s_and_b32 s47, s47, 15
    s_lshl_b32 s47, s47, 17
    s_add_u32 m0, s79, 147456
    s_add_u32 s47, s47, s57
    buffer_load_dwordx4 v40, s[20:23], s47 offen lds
    s_add_u32 m0, m0, 1024
    s_add_u32 s47, s47, 16384
    buffer_load_dwordx4 v40, s[20:23], s47 offen lds
    s_add_u32 m0, m0, 1024
    s_add_u32 s47, s47, 16384
    buffer_load_dwordx4 v40, s[20:23], s47 offen lds
    s_add_u32 m0, m0, 1024
    s_add_u32 s47, s47, 16384
    buffer_load_dwordx4 v40, s[20:23], s47 offen lds
    v_cmp_gt_u32 vcc, 2, v25
    s_cbranch_vccz CW_23
    ds_read_b32 v25, v1 offset:0
FW_24:
    s_waitcnt lgkmcnt(0)
    v_cmp_gt_u32 vcc, 2, v25
    s_cbranch_vccz FO_25
    s_sleep 2
    ds_read_b32 v25, v1 offset:0
    s_branch FW_24
FO_25:
CW_23:
    s_add_u32 s47, s81, 1
    s_and_b32 s47, s47, 15
    s_lshl_b32 s47, s47, 17
    s_add_u32 m0, s79, 139264
    s_add_u32 s47, s47, s57
    s_nop 0
    buffer_load_dwordx4 v40, s[20:23], s47 offen lds
    s_add_u32 m0, m0, 1024
    s_add_u32 s47, s47, 16384
    buffer_load_dwordx4 v40, s[20:23], s47 offen lds
    s_add_u32 m0, m0, 1024
    s_add_u32 s47, s47, 16384
    buffer_load_dwordx4 v40, s[20:23], s47 offen lds
    s_add_u32 m0, m0, 1024
    s_add_u32 s47, s47, 16384
    buffer_load_dwordx4 v40, s[20:23], s47 offen lds
    v_cmp_gt_u32 vcc, 3, v25
    s_cbranch_vccz CW_26
    ds_read_b32 v25, v1 offset:0
FW_27:
    s_waitcnt lgkmcnt(0)
    v_cmp_gt_u32 vcc, 3, v25
    s_cbranch_vccz FO_28
    s_sleep 2
    ds_read_b32 v25, v1 offset:0
    s_branch FW_27
FO_28:
CW_26:
    s_add_u32 s47, s81, 2
    s_and_b32 s47, s47, 15
    s_lshl_b32 s47, s47, 17
    s_add_u32 m0, s79, 16384
    s_add_u32 s47, s47, s57
    s_nop 0
    buffer_load_dwordx4 v40, s[20:23], s47 offen lds
    s_add_u32 m0, m0, 1024
    s_add_u32 s47, s47, 16384
    buffer_load_dwordx4 v40, s[20:23], s47 offen lds
    s_add_u32 m0, m0, 1024
    s_add_u32 s47, s47, 16384
    buffer_load_dwordx4 v40, s[20:23], s47 offen lds
    s_add_u32 m0, m0, 1024
    s_add_u32 s47, s47, 16384
    buffer_load_dwordx4 v40, s[20:23], s47 offen lds
    v_cmp_gt_u32 vcc, 3, v25
    s_cbranch_vccz CW_29
    ds_read_b32 v25, v1 offset:0
FW_30:
    s_waitcnt lgkmcnt(0)
    v_cmp_gt_u32 vcc, 3, v25
    s_cbranch_vccz FO_31
    s_sleep 2
    ds_read_b32 v25, v1 offset:0
    s_branch FW_30
FO_31:
CW_29:
    s_waitcnt vmcnt(8)
    s_add_u32 s47, s81, 3
    s_and_b32 s47, s47, 15
    s_lshl_b32 s47, s47, 17
    s_add_u32 m0, s79, 24576
    s_add_u32 s47, s47, s57
    buffer_load_dwordx4 v40, s[20:23], s47 offen lds
    s_add_u32 m0, m0, 1024
    s_add_u32 s47, s47, 16384
    buffer_load_dwordx4 v40, s[20:23], s47 offen lds
    s_add_u32 m0, m0, 1024
    s_add_u32 s47, s47, 16384
    buffer_load_dwordx4 v40, s[20:23], s47 offen lds
    s_add_u32 m0, m0, 1024
    s_add_u32 s47, s47, 16384
    buffer_load_dwordx4 v40, s[20:23], s47 offen lds
    v_cmp_gt_u32 vcc, 3, v25
    s_cbranch_vccz CW_32
    ds_read_b32 v25, v1 offset:0
FW_33:
    s_waitcnt lgkmcnt(0)
    v_cmp_gt_u32 vcc, 3, v25
    s_cbranch_vccz FO_34
    s_sleep 2
    ds_read_b32 v25, v1 offset:0
    s_branch FW_33
FO_34:
CW_32:
    s_waitcnt vmcnt(8)
    s_add_u32 s47, s81, 4
    s_and_b32 s47, s47, 15
    s_lshl_b32 s47, s47, 17
    s_add_u32 m0, s79, 131072
    s_add_u32 s47, s47, s57
    buffer_load_dwordx4 v40, s[20:23], s47 offen lds
    s_add_u32 m0, m0, 1024
    s_add_u32 s47, s47, 16384
    buffer_load_dwordx4 v40, s[20:23], s47 offen lds
    s_add_u32 m0, m0, 1024
    s_add_u32 s47, s47, 16384
    buffer_load_dwordx4 v40, s[20:23], s47 offen lds
    s_add_u32 m0, m0, 1024
    s_add_u32 s47, s47, 16384
    buffer_load_dwordx4 v40, s[20:23], s47 offen lds
    v_cmp_gt_u32 vcc, 4, v25
    s_cbranch_vccz CW_35
    ds_read_b32 v25, v1 offset:0
FW_36:
    s_waitcnt lgkmcnt(0)
    v_cmp_gt_u32 vcc, 4, v25
    s_cbranch_vccz FO_37
    s_sleep 2
    ds_read_b32 v25, v1 offset:0
    s_branch FW_36
FO_37:
CW_35:
    s_waitcnt vmcnt(8)
    s_add_u32 s47, s81, 5
    s_and_b32 s47, s47, 15
    s_lshl_b32 s47, s47, 17
    s_add_u32 m0, s79, 32768
    s_add_u32 s47, s47, s57
    buffer_load_dwordx4 v40, s[20:23], s47 offen lds
    s_add_u32 m0, m0, 1024
    s_add_u32 s47, s47, 16384
    buffer_load_dwordx4 v40, s[20:23], s47 offen lds
    s_add_u32 m0, m0, 1024
    s_add_u32 s47, s47, 16384
    buffer_load_dwordx4 v40, s[20:23], s47 offen lds
    s_add_u32 m0, m0, 1024
    s_add_u32 s47, s47, 16384
    buffer_load_dwordx4 v40, s[20:23], s47 offen lds
    v_cmp_gt_u32 vcc, 4, v25
    s_cbranch_vccz CW_38
    ds_read_b32 v25, v1 offset:0
FW_39:
    s_waitcnt lgkmcnt(0)
    v_cmp_gt_u32 vcc, 4, v25
    s_cbranch_vccz FO_40
    s_sleep 2
    ds_read_b32 v25, v1 offset:0
    s_branch FW_39
FO_40:
CW_38:
    s_waitcnt vmcnt(8)
    s_add_u32 s47, s81, 6
    s_and_b32 s47, s47, 15
    s_lshl_b32 s47, s47, 17
    s_add_u32 m0, s79, 40960
    s_add_u32 s47, s47, s57
    buffer_load_dwordx4 v40, s[20:23], s47 offen lds
    s_add_u32 m0, m0, 1024
    s_add_u32 s47, s47, 16384
    buffer_load_dwordx4 v40, s[20:23], s47 offen lds
    s_add_u32 m0, m0, 1024
    s_add_u32 s47, s47, 16384
    buffer_load_dwordx4 v40, s[20:23], s47 offen lds
    s_add_u32 m0, m0, 1024
    s_add_u32 s47, s47, 16384
    buffer_load_dwordx4 v40, s[20:23], s47 offen lds
    v_cmp_gt_u32 vcc, 4, v25
    s_cbranch_vccz CW_41
    ds_read_b32 v25, v1 offset:0
FW_42:
    s_waitcnt lgkmcnt(0)
    v_cmp_gt_u32 vcc, 4, v25
    s_cbranch_vccz FO_43
    s_sleep 2
    ds_read_b32 v25, v1 offset:0
    s_branch FW_42
FO_43:
CW_41:
    s_waitcnt vmcnt(8)
    s_add_u32 s47, s81, 7
    s_and_b32 s47, s47, 15
    s_lshl_b32 s47, s47, 17
    s_add_u32 m0, s79, 81920
    s_add_u32 s47, s47, s57
    buffer_load_dwordx4 v40, s[20:23], s47 offen lds
    s_add_u32 m0, m0, 1024
    s_add_u32 s47, s47, 16384
    buffer_load_dwordx4 v40, s[20:23], s47 offen lds
    s_add_u32 m0, m0, 1024
    s_add_u32 s47, s47, 16384
    buffer_load_dwordx4 v40, s[20:23], s47 offen lds
    s_add_u32 m0, m0, 1024
    s_add_u32 s47, s47, 16384
    buffer_load_dwordx4 v40, s[20:23], s47 offen lds
    v_cmp_gt_u32 vcc, 5, v25
    s_cbranch_vccz CW_44
    ds_read_b32 v25, v1 offset:0
FW_45:
    s_waitcnt lgkmcnt(0)
    v_cmp_gt_u32 vcc, 5, v25
    s_cbranch_vccz FO_46
    s_sleep 2
    ds_read_b32 v25, v1 offset:0
    s_branch FW_45
FO_46:
CW_44:
    s_waitcnt vmcnt(8)
    s_add_u32 s47, s81, 8
    s_and_b32 s47, s47, 15
    s_lshl_b32 s47, s47, 17
    s_add_u32 m0, s79, 49152
    s_add_u32 s47, s47, s57
    buffer_load_dwordx4 v40, s[20:23], s47 offen lds
    s_add_u32 m0, m0, 1024
    s_add_u32 s47, s47, 16384
    buffer_load_dwordx4 v40, s[20:23], s47 offen lds
    s_add_u32 m0, m0, 1024
    s_add_u32 s47, s47, 16384
    buffer_load_dwordx4 v40, s[20:23], s47 offen lds
    s_add_u32 m0, m0, 1024
    s_add_u32 s47, s47, 16384
    buffer_load_dwordx4 v40, s[20:23], s47 offen lds
    v_cmp_gt_u32 vcc, 5, v25
    s_cbranch_vccz CW_47
    ds_read_b32 v25, v1 offset:0
FW_48:
    s_waitcnt lgkmcnt(0)
    v_cmp_gt_u32 vcc, 5, v25
    s_cbranch_vccz FO_49
    s_sleep 2
    ds_read_b32 v25, v1 offset:0
    s_branch FW_48
FO_49:
CW_47:
    s_waitcnt vmcnt(8)
    s_add_u32 s47, s81, 9
    s_and_b32 s47, s47, 15
    s_lshl_b32 s47, s47, 17
    s_add_u32 m0, s79, 57344
    s_add_u32 s47, s47, s57
    buffer_load_dwordx4 v40, s[20:23], s47 offen lds
    s_add_u32 m0, m0, 1024
    s_add_u32 s47, s47, 16384
    buffer_load_dwordx4 v40, s[20:23], s47 offen lds
    s_add_u32 m0, m0, 1024
    s_add_u32 s47, s47, 16384
    buffer_load_dwordx4 v40, s[20:23], s47 offen lds
    s_add_u32 m0, m0, 1024
    s_add_u32 s47, s47, 16384
    buffer_load_dwordx4 v40, s[20:23], s47 offen lds
    v_cmp_gt_u32 vcc, 5, v25
    s_cbranch_vccz CW_50
    ds_read_b32 v25, v1 offset:0
FW_51:
    s_waitcnt lgkmcnt(0)
    v_cmp_gt_u32 vcc, 5, v25
    s_cbranch_vccz FO_52
    s_sleep 2
    ds_read_b32 v25, v1 offset:0
    s_branch FW_51
FO_52:
CW_50:
    s_waitcnt vmcnt(8)
    s_add_u32 s47, s81, 10
    s_and_b32 s47, s47, 15
    s_lshl_b32 s47, s47, 17
    s_add_u32 m0, s79, 73728
    s_add_u32 s47, s47, s57
    buffer_load_dwordx4 v40, s[20:23], s47 offen lds
    s_add_u32 m0, m0, 1024
    s_add_u32 s47, s47, 16384
    buffer_load_dwordx4 v40, s[20:23], s47 offen lds
    s_add_u32 m0, m0, 1024
    s_add_u32 s47, s47, 16384
    buffer_load_dwordx4 v40, s[20:23], s47 offen lds
    s_add_u32 m0, m0, 1024
    s_add_u32 s47, s47, 16384
    buffer_load_dwordx4 v40, s[20:23], s47 offen lds
    v_cmp_gt_u32 vcc, 6, v25
    s_cbranch_vccz CW_53
    ds_read_b32 v25, v1 offset:0
FW_54:
    s_waitcnt lgkmcnt(0)
    v_cmp_gt_u32 vcc, 6, v25
    s_cbranch_vccz FO_55
    s_sleep 2
    ds_read_b32 v25, v1 offset:0
    s_branch FW_54
FO_55:
CW_53:
    s_waitcnt vmcnt(8)
    s_add_u32 s47, s81, 11
    s_and_b32 s47, s47, 15
    s_lshl_b32 s47, s47, 17
    s_add_u32 m0, s79, 98304
    s_add_u32 s47, s47, s57
    buffer_load_dwordx4 v40, s[20:23], s47 offen lds
    s_add_u32 m0, m0, 1024
    s_add_u32 s47, s47, 16384
    buffer_load_dwordx4 v40, s[20:23], s47 offen lds
    s_add_u32 m0, m0, 1024
    s_add_u32 s47, s47, 16384
    buffer_load_dwordx4 v40, s[20:23], s47 offen lds
    s_add_u32 m0, m0, 1024
    s_add_u32 s47, s47, 16384
    buffer_load_dwordx4 v40, s[20:23], s47 offen lds
    v_cmp_gt_u32 vcc, 7, v25
    s_cbranch_vccz CW_56
    ds_read_b32 v25, v1 offset:0
FW_57:
    s_waitcnt lgkmcnt(0)
    v_cmp_gt_u32 vcc, 7, v25
    s_cbranch_vccz FO_58
    s_sleep 2
    ds_read_b32 v25, v1 offset:0
    s_branch FW_57
FO_58:
CW_56:
    s_waitcnt vmcnt(8)
    s_add_u32 s47, s81, 12
    s_and_b32 s47, s47, 15
    s_lshl_b32 s47, s47, 17
    s_add_u32 m0, s79, 90112
    s_add_u32 s47, s47, s57
    buffer_load_dwordx4 v40, s[20:23], s47 offen lds
    s_add_u32 m0, m0, 1024
    s_add_u32 s47, s47, 16384
    buffer_load_dwordx4 v40, s[20:23], s47 offen lds
    s_add_u32 m0, m0, 1024
    s_add_u32 s47, s47, 16384
    buffer_load_dwordx4 v40, s[20:23], s47 offen lds
    s_add_u32 m0, m0, 1024
    s_add_u32 s47, s47, 16384
    buffer_load_dwordx4 v40, s[20:23], s47 offen lds
    v_cmp_gt_u32 vcc, 8, v25
    s_cbranch_vccz CW_59
    ds_read_b32 v25, v1 offset:0
FW_60:
    s_waitcnt lgkmcnt(0)
    v_cmp_gt_u32 vcc, 8, v25
    s_cbranch_vccz FO_61
    s_sleep 2
    ds_read_b32 v25, v1 offset:0
    s_branch FW_60
FO_61:
CW_59:
    s_waitcnt vmcnt(8)
    s_add_u32 s47, s81, 13
    s_and_b32 s47, s47, 15
    s_lshl_b32 s47, s47, 17
    s_add_u32 m0, s79, 114688
    s_add_u32 s47, s47, s57
    buffer_load_dwordx4 v40, s[20:23], s47 offen lds
    s_add_u32 m0, m0, 1024
    s_add_u32 s47, s47, 16384
    buffer_load_dwordx4 v40, s[20:23], s47 offen lds
    s_add_u32 m0, m0, 1024
    s_add_u32 s47, s47, 16384
    buffer_load_dwordx4 v40, s[20:23], s47 offen lds
    s_add_u32 m0, m0, 1024
    s_add_u32 s47, s47, 16384
    buffer_load_dwordx4 v40, s[20:23], s47 offen lds
    v_cmp_gt_u32 vcc, 9, v25
    s_cbranch_vccz CW_62
    ds_read_b32 v25, v1 offset:0
FW_63:
    s_waitcnt lgkmcnt(0)
    v_cmp_gt_u32 vcc, 9, v25
    s_cbranch_vccz FO_64
    s_sleep 2
    ds_read_b32 v25, v1 offset:0
    s_branch FW_63
FO_64:
CW_62:
    s_waitcnt vmcnt(8)
    s_add_u32 s47, s81, 14
    s_and_b32 s47, s47, 15
    s_lshl_b32 s47, s47, 17
    s_add_u32 m0, s79, 106496
    s_add_u32 s47, s47, s57
    buffer_load_dwordx4 v40, s[20:23], s47 offen lds
    s_add_u32 m0, m0, 1024
    s_add_u32 s47, s47, 16384
    s_branch IW_s6
IW_w6:
    s_branch IW_r6
IW_s6:
    buffer_load_dwordx4 v40, s[20:23], s47 offen lds
    s_add_u32 m0, m0, 1024
    s_add_u32 s47, s47, 16384
    buffer_load_dwordx4 v40, s[20:23], s47 offen lds
    s_add_u32 m0, m0, 1024
    s_add_u32 s47, s47, 16384
    buffer_load_dwordx4 v40, s[20:23], s47 offen lds
    v_cmp_gt_u32 vcc, 10, v25
    s_cbranch_vccz CW_65
    ds_read_b32 v25, v1 offset:0
FW_66:
    s_waitcnt lgkmcnt(0)
    v_cmp_gt_u32 vcc, 10, v25
    s_cbranch_vccz FO_67
    s_sleep 2
    ds_read_b32 v25, v1 offset:0
    s_branch FW_66
FO_67:
CW_65:
    s_waitcnt vmcnt(8)
    s_add_u32 s47, s81, 15
    s_and_b32 s47, s47, 15
    s_lshl_b32 s47, s47, 17
    s_add_u32 m0, s79, 122880
    s_add_u32 s47, s47, s57
    buffer_load_dwordx4 v40, s[20:23], s47 offen lds
    s_add_u32 m0, m0, 1024
    s_add_u32 s47, s47, 16384
    buffer_load_dwordx4 v40, s[20:23], s47 offen lds
    s_add_u32 m0, m0, 1024
    s_add_u32 s47, s47, 16384
    buffer_load_dwordx4 v40, s[20:23], s47 offen lds
    s_add_u32 m0, m0, 1024
    s_add_u32 s47, s47, 16384
    buffer_load_dwordx4 v40, s[20:23], s47 offen lds
    s_waitcnt vmcnt(0)
    s_mov_b64 exec, 1
    ds_write_b32 v3, v24 offset:160
    s_mov_b64 exec, -1
F_wj:
    v_mov_b32 v5, 159096
    ds_read_b32 v6, v5 offset:0
FW_68:
    s_waitcnt lgkmcnt(0)
    v_cmp_gt_u32 vcc, 1, v6
    s_cbranch_vccz FO_69
    s_sleep 1
    ds_read_b32 v6, v5 offset:0
    s_branch FW_68
FO_69:
    v_and_b32 v5, 7, v0
    v_lshlrev_b32 v5, 2, v5
    v_add_u32 v5, 158976, v5
    ds_read_b32 v5, v5
    s_lshr_b32 s47, s64, 5
    s_sub_u32 s47, 63, s47
    s_mov_b64 s[60:61], 0
    s_waitcnt lgkmcnt(0)
    v_bfe_u32 v5, v5, 5, 6
    v_cmp_eq_u32 vcc, s47, v5
    s_cbranch_vccz F_ns

    v_mov_b32 v5, 158976
    ds_read_b128 v[44:47], v5
    ds_read_b128 v[48:51], v5 offset:16
    v_and_b32 v6, 15, v0
    v_add_u32 v6, s64, v6
    v_sub_u32 v6, 2047, v6
    v_subrev_u32 v7, 16, v6
    v_mov_b32 v164, 0
    v_mov_b32 v165, 0
    s_waitcnt lgkmcnt(0)
    v_and_b32 v5, 0x7ff, v44
    v_or_b32 v44, 0x4000, v44
    v_cmp_eq_u32 vcc, v5, v6
    v_cmp_eq_u32 s[62:63], v5, v7
    s_nop 0
    v_cndmask_b32 v164, v164, v44, vcc
    v_cndmask_b32 v165, v165, v44, s[62:63]
    v_and_b32 v5, 0x7ff, v45
    v_or_b32 v45, 0x4800, v45
    v_cmp_eq_u32 vcc, v5, v6
    v_cmp_eq_u32 s[62:63], v5, v7
    s_nop 0
    v_cndmask_b32 v164, v164, v45, vcc
    v_cndmask_b32 v165, v165, v45, s[62:63]
    v_and_b32 v5, 0x7ff, v46
    v_or_b32 v46, 0x5000, v46
    v_cmp_eq_u32 vcc, v5, v6
    v_cmp_eq_u32 s[62:63], v5, v7
    s_nop 0
    v_cndmask_b32 v164, v164, v46, vcc
    v_cndmask_b32 v165, v165, v46, s[62:63]
    v_and_b32 v5, 0x7ff, v47
    v_or_b32 v47, 0x5800, v47
    v_cmp_eq_u32 vcc, v5, v6
    v_cmp_eq_u32 s[62:63], v5, v7
    s_nop 0
    v_cndmask_b32 v164, v164, v47, vcc
    v_cndmask_b32 v165, v165, v47, s[62:63]
    v_and_b32 v5, 0x7ff, v48
    v_or_b32 v48, 0x6000, v48
    v_cmp_eq_u32 vcc, v5, v6
    v_cmp_eq_u32 s[62:63], v5, v7
    s_nop 0
    v_cndmask_b32 v164, v164, v48, vcc
    v_cndmask_b32 v165, v165, v48, s[62:63]
    v_and_b32 v5, 0x7ff, v49
    v_or_b32 v49, 0x6800, v49
    v_cmp_eq_u32 vcc, v5, v6
    v_cmp_eq_u32 s[62:63], v5, v7
    s_nop 0
    v_cndmask_b32 v164, v164, v49, vcc
    v_cndmask_b32 v165, v165, v49, s[62:63]
    v_and_b32 v5, 0x7ff, v50
    v_or_b32 v50, 0x7000, v50
    v_cmp_eq_u32 vcc, v5, v6
    v_cmp_eq_u32 s[62:63], v5, v7
    s_nop 0
    v_cndmask_b32 v164, v164, v50, vcc
    v_cndmask_b32 v165, v165, v50, s[62:63]
    v_and_b32 v5, 0x7ff, v51
    v_or_b32 v51, 0x7800, v51
    v_cmp_eq_u32 vcc, v5, v6
    v_cmp_eq_u32 s[62:63], v5, v7
    s_nop 0
    v_cndmask_b32 v164, v164, v51, vcc
    v_cndmask_b32 v165, v165, v51, s[62:63]
    s_mov_b64 s[60:61], 1
F_ns:
    s_lshl_b32 s51, s28, 2
    s_add_u32 s51, s51, s3
    s_lshl_b32 s51, s51, 2
    s_and_b32 s47, s29, 3
    s_add_u32 s51, s51, s47
    s_lshl_b32 s51, s51, 7

    s_add_u32 s54, s51, 0x831000
    s_add_u32 s54, s72, s54
    s_addc_u32 s55, s73, 0
    v_lshlrev_b32 v98, 4, v0
    v_lshrrev_b32 v16, 4, v0
    v_bfe_u32 v17, v0, 2, 2
    v_lshl_add_u32 v17, v16, 2, v17
    v_bfe_u32 v16, v17, 1, 2
    v_lshlrev_b32 v16, 5, v16
    v_lshl_add_u32 v16, v17, 7, v16
    v_and_b32 v17, 3, v0
    v_lshl_add_u32 v4, v17, 3, v16
    v_xor_b32 v5, 32, v4
    v_xor_b32 v6, 64, v4
    v_xor_b32 v7, 96, v4
    s_lshl_b32 s79, s28, 18
    s_lshl_b32 s80, s3, 16
    s_add_u32 s79, s79, s80
    s_lshl_b32 s81, s81, 11
    v_mov_b32 v99, 1

    v_add_u32 v8, 57344, v4
    v_add_u32 v9, 57344, v5
    v_add_u32 v10, 57344, v6
    v_add_u32 v11, 57344, v7
    v_add_u32 v12, 114688, v4
    v_add_u32 v13, 114688, v5
    v_add_u32 v14, 114688, v6
    v_add_u32 v15, 114688, v7
    s_add_u32 s16, s72, 0x400000
    s_addc_u32 s17, s73, 0
    s_mov_b32 s18, 0x400000
    s_mov_b32 s19, 0x00020000
    s_mov_b32 s12, s68
    s_mov_b32 s13, s69
    s_mov_b32 s14, 0x400000
    s_mov_b32 s15, 0x00020000
    s_setprio 2
SP_70:
    s_load_dword s47, s[54:55], 0 glc
    s_waitcnt lgkmcnt(0)
    s_cmp_ge_u32 s47, 16
    s_cbranch_scc1 SD_71
    s_branch SP_70
SD_71:
    s_add_u32 s80, s81, 0
    s_and_b32 s80, s80, 0x7fff
    s_add_u32 s80, s80, s79
    s_add_u32 s82, s80, 0x8000
    buffer_load_dwordx4 v[48:51], v98, s[16:19], s80 offen offset:0 sc1
    buffer_load_dwordx4 v[52:55], v98, s[16:19], s82 offen offset:0 sc1
    buffer_load_dwordx4 v[56:59], v98, s[16:19], s80 offen offset:1024 sc1
    buffer_load_dwordx4 v[60:63], v98, s[16:19], s82 offen offset:1024 sc1
    s_add_u32 s80, s81, 2048
    s_and_b32 s80, s80, 0x7fff
    s_add_u32 s80, s80, s79
    s_add_u32 s82, s80, 0x8000
    buffer_load_dwordx4 v[64:67], v98, s[16:19], s80 offen offset:0 sc1
    buffer_load_dwordx4 v[68:71], v98, s[16:19], s82 offen offset:0 sc1
    buffer_load_dwordx4 v[72:75], v98, s[16:19], s80 offen offset:1024 sc1
    buffer_load_dwordx4 v[76:79], v98, s[16:19], s82 offen offset:1024 sc1
    s_add_u32 s80, s81, 4096
    s_and_b32 s80, s80, 0x7fff
    s_add_u32 s80, s80, s79
    s_add_u32 s82, s80, 0x8000
    buffer_load_dwordx4 v[80:83], v98, s[16:19], s80 offen offset:0 sc1
    buffer_load_dwordx4 v[84:87], v98, s[16:19], s82 offen offset:0 sc1
    buffer_load_dwordx4 v[88:91], v98, s[16:19], s80 offen offset:1024 sc1
    buffer_load_dwordx4 v[92:95], v98, s[16:19], s82 offen offset:1024 sc1
    v_or_b32 v17, 8, v1
    ds_read_b32 v16, v17 offset:160
FW_72:
    s_waitcnt lgkmcnt(0)
    v_cmp_gt_u32 vcc, 1, v16
    s_cbranch_vccz FO_73
    ds_read_b32 v16, v17 offset:160
    s_branch FW_72
FO_73:
    s_nop 0
    ds_read_b64_tr_b16 v[16:17], v12 offset:32768
    ds_read_b64_tr_b16 v[18:19], v12 offset:34816
    ds_read_b64_tr_b16 v[20:21], v13 offset:32768
    ds_read_b64_tr_b16 v[22:23], v13 offset:34816
    ds_read_b64_tr_b16 v[24:25], v14 offset:32768
    ds_read_b64_tr_b16 v[26:27], v14 offset:34816
    ds_read_b64_tr_b16 v[28:29], v15 offset:32768
    ds_read_b64_tr_b16 v[30:31], v15 offset:34816
    s_waitcnt vmcnt(10)
    s_waitcnt lgkmcnt(6)
    v_mfma_f32_16x16x32_bf16 v[100:103], v[16:19], v[48:51], v[100:103]
    ds_read_b64_tr_b16 v[32:33], v12 offset:36864
    v_mfma_f32_16x16x32_bf16 v[116:119], v[16:19], v[52:55], v[116:119]
    ds_read_b64_tr_b16 v[34:35], v12 offset:38912
    s_add_u32 s80, s81, 6144
    s_and_b32 s80, s80, 0x7fff
    s_add_u32 s80, s80, s79
    s_add_u32 s82, s80, 0x8000
    buffer_load_dwordx4 v[132:135], v98, s[16:19], s80 offen offset:0 sc1
    s_waitcnt lgkmcnt(6)
    v_mfma_f32_16x16x32_bf16 v[104:107], v[20:23], v[48:51], v[104:107]
    ds_read_b64_tr_b16 v[36:37], v13 offset:36864
    v_mfma_f32_16x16x32_bf16 v[120:123], v[20:23], v[52:55], v[120:123]
    ds_read_b64_tr_b16 v[38:39], v13 offset:38912
    s_waitcnt lgkmcnt(6)
    v_mfma_f32_16x16x32_bf16 v[108:111], v[24:27], v[48:51], v[108:111]
    ds_read_b64_tr_b16 v[40:41], v14 offset:36864
    buffer_load_dwordx4 v[136:139], v98, s[16:19], s82 offen offset:0 sc1
    v_mfma_f32_16x16x32_bf16 v[124:127], v[24:27], v[52:55], v[124:127]
    ds_read_b64_tr_b16 v[42:43], v14 offset:38912
    s_waitcnt lgkmcnt(6)
    v_mfma_f32_16x16x32_bf16 v[112:115], v[28:31], v[48:51], v[112:115]
    ds_read_b64_tr_b16 v[44:45], v15 offset:36864
    v_mfma_f32_16x16x32_bf16 v[128:131], v[28:31], v[52:55], v[128:131]
    ds_read_b64_tr_b16 v[46:47], v15 offset:38912
    s_waitcnt vmcnt(10)
    s_waitcnt lgkmcnt(6)
    v_mfma_f32_16x16x32_bf16 v[100:103], v[32:35], v[56:59], v[100:103]
    ds_read_b64_tr_b16 v[16:17], v12 offset:24576
    v_mfma_f32_16x16x32_bf16 v[116:119], v[32:35], v[60:63], v[116:119]
    ds_read_b64_tr_b16 v[18:19], v12 offset:26624
    buffer_load_dwordx4 v[48:51], v98, s[16:19], s80 offen offset:1024 sc1
    s_waitcnt lgkmcnt(6)
    v_mfma_f32_16x16x32_bf16 v[104:107], v[36:39], v[56:59], v[104:107]
    ds_read_b64_tr_b16 v[20:21], v13 offset:24576
    v_mfma_f32_16x16x32_bf16 v[120:123], v[36:39], v[60:63], v[120:123]
    ds_read_b64_tr_b16 v[22:23], v13 offset:26624
    s_waitcnt lgkmcnt(6)
    v_mfma_f32_16x16x32_bf16 v[108:111], v[40:43], v[56:59], v[108:111]
    ds_read_b64_tr_b16 v[24:25], v14 offset:24576
    buffer_load_dwordx4 v[52:55], v98, s[16:19], s82 offen offset:1024 sc1
    v_mfma_f32_16x16x32_bf16 v[124:127], v[40:43], v[60:63], v[124:127]
    ds_read_b64_tr_b16 v[26:27], v14 offset:26624
    s_waitcnt lgkmcnt(6)
    v_mfma_f32_16x16x32_bf16 v[112:115], v[44:47], v[56:59], v[112:115]
    ds_read_b64_tr_b16 v[28:29], v15 offset:24576
    v_mfma_f32_16x16x32_bf16 v[128:131], v[44:47], v[60:63], v[128:131]
    ds_read_b64_tr_b16 v[30:31], v15 offset:26624
    s_waitcnt vmcnt(10)
    s_waitcnt lgkmcnt(6)
    v_mfma_f32_16x16x32_bf16 v[100:103], v[16:19], v[64:67], v[100:103]
    ds_read_b64_tr_b16 v[32:33], v12 offset:28672
    v_mfma_f32_16x16x32_bf16 v[116:119], v[16:19], v[68:71], v[116:119]
    ds_read_b64_tr_b16 v[34:35], v12 offset:30720
    s_add_u32 s80, s81, 8192
    s_and_b32 s80, s80, 0x7fff
    s_add_u32 s80, s80, s79
    s_add_u32 s82, s80, 0x8000
    buffer_load_dwordx4 v[56:59], v98, s[16:19], s80 offen offset:0 sc1
    s_waitcnt lgkmcnt(6)
    v_mfma_f32_16x16x32_bf16 v[104:107], v[20:23], v[64:67], v[104:107]
    ds_read_b64_tr_b16 v[36:37], v13 offset:28672
    v_mfma_f32_16x16x32_bf16 v[120:123], v[20:23], v[68:71], v[120:123]
    ds_read_b64_tr_b16 v[38:39], v13 offset:30720
    s_waitcnt lgkmcnt(6)
    v_mfma_f32_16x16x32_bf16 v[108:111], v[24:27], v[64:67], v[108:111]
    ds_read_b64_tr_b16 v[40:41], v14 offset:28672
    buffer_load_dwordx4 v[60:63], v98, s[16:19], s82 offen offset:0 sc1
    v_mfma_f32_16x16x32_bf16 v[124:127], v[24:27], v[68:71], v[124:127]
    ds_read_b64_tr_b16 v[42:43], v14 offset:30720
    s_waitcnt lgkmcnt(6)
    v_mfma_f32_16x16x32_bf16 v[112:115], v[28:31], v[64:67], v[112:115]
    ds_read_b64_tr_b16 v[44:45], v15 offset:28672
    v_mfma_f32_16x16x32_bf16 v[128:131], v[28:31], v[68:71], v[128:131]
    ds_read_b64_tr_b16 v[46:47], v15 offset:30720
    s_waitcnt vmcnt(10)
    s_waitcnt lgkmcnt(6)
    v_mfma_f32_16x16x32_bf16 v[100:103], v[32:35], v[72:75], v[100:103]
    ds_read_b64_tr_b16 v[16:17], v4 offset:16384
    v_mfma_f32_16x16x32_bf16 v[116:119], v[32:35], v[76:79], v[116:119]
    ds_read_b64_tr_b16 v[18:19], v4 offset:18432
    buffer_load_dwordx4 v[64:67], v98, s[16:19], s80 offen offset:1024 sc1
    s_waitcnt lgkmcnt(6)
    v_mfma_f32_16x16x32_bf16 v[104:107], v[36:39], v[72:75], v[104:107]
    ds_read_b64_tr_b16 v[20:21], v5 offset:16384
    v_mfma_f32_16x16x32_bf16 v[120:123], v[36:39], v[76:79], v[120:123]
    ds_read_b64_tr_b16 v[22:23], v5 offset:18432
    s_waitcnt lgkmcnt(6)
    v_mfma_f32_16x16x32_bf16 v[108:111], v[40:43], v[72:75], v[108:111]
    ds_read_b64_tr_b16 v[24:25], v6 offset:16384
    buffer_load_dwordx4 v[68:71], v98, s[16:19], s82 offen offset:1024 sc1
    v_mfma_f32_16x16x32_bf16 v[124:127], v[40:43], v[76:79], v[124:127]
    ds_read_b64_tr_b16 v[26:27], v6 offset:18432
    s_waitcnt lgkmcnt(6)
    v_mfma_f32_16x16x32_bf16 v[112:115], v[44:47], v[72:75], v[112:115]
    ds_read_b64_tr_b16 v[28:29], v7 offset:16384
    v_mfma_f32_16x16x32_bf16 v[128:131], v[44:47], v[76:79], v[128:131]
    ds_read_b64_tr_b16 v[30:31], v7 offset:18432
    s_waitcnt vmcnt(10)
    s_waitcnt lgkmcnt(6)
    v_mfma_f32_16x16x32_bf16 v[100:103], v[16:19], v[80:83], v[100:103]
    ds_read_b64_tr_b16 v[32:33], v4 offset:20480
    v_mfma_f32_16x16x32_bf16 v[116:119], v[16:19], v[84:87], v[116:119]
    ds_read_b64_tr_b16 v[34:35], v4 offset:22528
    s_add_u32 s80, s81, 10240
    s_and_b32 s80, s80, 0x7fff
    s_add_u32 s80, s80, s79
    s_add_u32 s82, s80, 0x8000
    buffer_load_dwordx4 v[72:75], v98, s[16:19], s80 offen offset:0 sc1
    s_waitcnt lgkmcnt(6)
    v_mfma_f32_16x16x32_bf16 v[104:107], v[20:23], v[80:83], v[104:107]
    ds_read_b64_tr_b16 v[36:37], v5 offset:20480
    v_mfma_f32_16x16x32_bf16 v[120:123], v[20:23], v[84:87], v[120:123]
    ds_read_b64_tr_b16 v[38:39], v5 offset:22528
    s_waitcnt lgkmcnt(6)
    v_mfma_f32_16x16x32_bf16 v[108:111], v[24:27], v[80:83], v[108:111]
    ds_read_b64_tr_b16 v[40:41], v6 offset:20480
    buffer_load_dwordx4 v[76:79], v98, s[16:19], s82 offen offset:0 sc1
    v_mfma_f32_16x16x32_bf16 v[124:127], v[24:27], v[84:87], v[124:127]
    ds_read_b64_tr_b16 v[42:43], v6 offset:22528
    s_waitcnt lgkmcnt(6)
    v_mfma_f32_16x16x32_bf16 v[112:115], v[28:31], v[80:83], v[112:115]
    ds_read_b64_tr_b16 v[44:45], v7 offset:20480
    v_mfma_f32_16x16x32_bf16 v[128:131], v[28:31], v[84:87], v[128:131]
    ds_read_b64_tr_b16 v[46:47], v7 offset:22528
    s_waitcnt vmcnt(10)
    s_waitcnt lgkmcnt(6)
    v_mfma_f32_16x16x32_bf16 v[100:103], v[32:35], v[88:91], v[100:103]
    ds_read_b64_tr_b16 v[16:17], v4 offset:24576
    v_mfma_f32_16x16x32_bf16 v[116:119], v[32:35], v[92:95], v[116:119]
    ds_read_b64_tr_b16 v[18:19], v4 offset:26624
    buffer_load_dwordx4 v[80:83], v98, s[16:19], s80 offen offset:1024 sc1
    s_waitcnt lgkmcnt(6)
    v_mfma_f32_16x16x32_bf16 v[104:107], v[36:39], v[88:91], v[104:107]
    ds_read_b64_tr_b16 v[20:21], v5 offset:24576
    v_mfma_f32_16x16x32_bf16 v[120:123], v[36:39], v[92:95], v[120:123]
    ds_read_b64_tr_b16 v[22:23], v5 offset:26624
    s_waitcnt lgkmcnt(6)
    v_mfma_f32_16x16x32_bf16 v[108:111], v[40:43], v[88:91], v[108:111]
    ds_read_b64_tr_b16 v[24:25], v6 offset:24576
    buffer_load_dwordx4 v[84:87], v98, s[16:19], s82 offen offset:1024 sc1
    v_mfma_f32_16x16x32_bf16 v[124:127], v[40:43], v[92:95], v[124:127]
    ds_read_b64_tr_b16 v[26:27], v6 offset:26624
    s_waitcnt lgkmcnt(6)
    v_mfma_f32_16x16x32_bf16 v[112:115], v[44:47], v[88:91], v[112:115]
    ds_read_b64_tr_b16 v[28:29], v7 offset:24576
    v_mfma_f32_16x16x32_bf16 v[128:131], v[44:47], v[92:95], v[128:131]
    ds_read_b64_tr_b16 v[30:31], v7 offset:26624
    s_waitcnt vmcnt(10)
    s_waitcnt lgkmcnt(6)
    v_mfma_f32_16x16x32_bf16 v[100:103], v[16:19], v[132:135], v[100:103]
    ds_read_b64_tr_b16 v[32:33], v4 offset:28672
    v_mfma_f32_16x16x32_bf16 v[116:119], v[16:19], v[136:139], v[116:119]
    ds_read_b64_tr_b16 v[34:35], v4 offset:30720
    s_add_u32 s80, s81, 12288
    s_and_b32 s80, s80, 0x7fff
    s_add_u32 s80, s80, s79
    s_add_u32 s82, s80, 0x8000
    buffer_load_dwordx4 v[88:91], v98, s[16:19], s80 offen offset:0 sc1
    s_waitcnt lgkmcnt(6)
    v_mfma_f32_16x16x32_bf16 v[104:107], v[20:23], v[132:135], v[104:107]
    ds_read_b64_tr_b16 v[36:37], v5 offset:28672
    v_mfma_f32_16x16x32_bf16 v[120:123], v[20:23], v[136:139], v[120:123]
    ds_read_b64_tr_b16 v[38:39], v5 offset:30720
    s_waitcnt lgkmcnt(6)
    v_mfma_f32_16x16x32_bf16 v[108:111], v[24:27], v[132:135], v[108:111]
    ds_read_b64_tr_b16 v[40:41], v6 offset:28672
    buffer_load_dwordx4 v[92:95], v98, s[16:19], s82 offen offset:0 sc1
    v_mfma_f32_16x16x32_bf16 v[124:127], v[24:27], v[136:139], v[124:127]
    ds_read_b64_tr_b16 v[42:43], v6 offset:30720
    s_waitcnt lgkmcnt(6)
    v_mfma_f32_16x16x32_bf16 v[112:115], v[28:31], v[132:135], v[112:115]
    ds_read_b64_tr_b16 v[44:45], v7 offset:28672
    v_mfma_f32_16x16x32_bf16 v[128:131], v[28:31], v[136:139], v[128:131]
    ds_read_b64_tr_b16 v[46:47], v7 offset:30720
    s_waitcnt vmcnt(10)
    s_waitcnt lgkmcnt(6)
    v_mfma_f32_16x16x32_bf16 v[100:103], v[32:35], v[48:51], v[100:103]
    ds_read_b64_tr_b16 v[16:17], v12 offset:16384
    v_mfma_f32_16x16x32_bf16 v[116:119], v[32:35], v[52:55], v[116:119]
    ds_read_b64_tr_b16 v[18:19], v12 offset:18432
    buffer_load_dwordx4 v[132:135], v98, s[16:19], s80 offen offset:1024 sc1
    s_waitcnt lgkmcnt(6)
    v_mfma_f32_16x16x32_bf16 v[104:107], v[36:39], v[48:51], v[104:107]
    ds_read_b64_tr_b16 v[20:21], v13 offset:16384
    v_mfma_f32_16x16x32_bf16 v[120:123], v[36:39], v[52:55], v[120:123]
    ds_read_b64_tr_b16 v[22:23], v13 offset:18432
    s_waitcnt lgkmcnt(6)
    v_mfma_f32_16x16x32_bf16 v[108:111], v[40:43], v[48:51], v[108:111]
    ds_read_b64_tr_b16 v[24:25], v14 offset:16384
    buffer_load_dwordx4 v[136:139], v98, s[16:19], s82 offen offset:1024 sc1
    v_mfma_f32_16x16x32_bf16 v[124:127], v[40:43], v[52:55], v[124:127]
    ds_read_b64_tr_b16 v[26:27], v14 offset:18432
    s_waitcnt lgkmcnt(6)
    v_mfma_f32_16x16x32_bf16 v[112:115], v[44:47], v[48:51], v[112:115]
    ds_read_b64_tr_b16 v[28:29], v15 offset:16384
    v_mfma_f32_16x16x32_bf16 v[128:131], v[44:47], v[52:55], v[128:131]
    ds_read_b64_tr_b16 v[30:31], v15 offset:18432
    s_waitcnt vmcnt(10)
    s_waitcnt lgkmcnt(6)
    v_mfma_f32_16x16x32_bf16 v[100:103], v[16:19], v[56:59], v[100:103]
    ds_read_b64_tr_b16 v[32:33], v12 offset:20480
    v_mfma_f32_16x16x32_bf16 v[116:119], v[16:19], v[60:63], v[116:119]
    ds_read_b64_tr_b16 v[34:35], v12 offset:22528
    s_add_u32 s80, s81, 14336
    s_and_b32 s80, s80, 0x7fff
    s_add_u32 s80, s80, s79
    s_add_u32 s82, s80, 0x8000
    buffer_load_dwordx4 v[48:51], v98, s[16:19], s80 offen offset:0 sc1
    s_waitcnt lgkmcnt(6)
    v_mfma_f32_16x16x32_bf16 v[104:107], v[20:23], v[56:59], v[104:107]
    ds_read_b64_tr_b16 v[36:37], v13 offset:20480
    v_mfma_f32_16x16x32_bf16 v[120:123], v[20:23], v[60:63], v[120:123]
    ds_read_b64_tr_b16 v[38:39], v13 offset:22528
    s_waitcnt lgkmcnt(6)
    v_mfma_f32_16x16x32_bf16 v[108:111], v[24:27], v[56:59], v[108:111]
    ds_read_b64_tr_b16 v[40:41], v14 offset:20480
    buffer_load_dwordx4 v[52:55], v98, s[16:19], s82 offen offset:0 sc1
    v_mfma_f32_16x16x32_bf16 v[124:127], v[24:27], v[60:63], v[124:127]
    ds_read_b64_tr_b16 v[42:43], v14 offset:22528
    s_waitcnt lgkmcnt(6)
    v_mfma_f32_16x16x32_bf16 v[112:115], v[28:31], v[56:59], v[112:115]
    ds_read_b64_tr_b16 v[44:45], v15 offset:20480
    v_mfma_f32_16x16x32_bf16 v[128:131], v[28:31], v[60:63], v[128:131]
    ds_read_b64_tr_b16 v[46:47], v15 offset:22528
    s_waitcnt vmcnt(10)
    s_waitcnt lgkmcnt(6)
    v_mfma_f32_16x16x32_bf16 v[100:103], v[32:35], v[64:67], v[100:103]
    ds_read_b64_tr_b16 v[16:17], v4 offset:32768
    v_mfma_f32_16x16x32_bf16 v[116:119], v[32:35], v[68:71], v[116:119]
    ds_read_b64_tr_b16 v[18:19], v4 offset:34816
    buffer_load_dwordx4 v[56:59], v98, s[16:19], s80 offen offset:1024 sc1
    s_waitcnt lgkmcnt(6)
    v_mfma_f32_16x16x32_bf16 v[104:107], v[36:39], v[64:67], v[104:107]
    ds_read_b64_tr_b16 v[20:21], v5 offset:32768
    v_mfma_f32_16x16x32_bf16 v[120:123], v[36:39], v[68:71], v[120:123]
    ds_read_b64_tr_b16 v[22:23], v5 offset:34816
    s_waitcnt lgkmcnt(6)
    v_mfma_f32_16x16x32_bf16 v[108:111], v[40:43], v[64:67], v[108:111]
    ds_read_b64_tr_b16 v[24:25], v6 offset:32768
    buffer_load_dwordx4 v[60:63], v98, s[16:19], s82 offen offset:1024 sc1
    v_mfma_f32_16x16x32_bf16 v[124:127], v[40:43], v[68:71], v[124:127]
    ds_read_b64_tr_b16 v[26:27], v6 offset:34816
    s_waitcnt lgkmcnt(6)
    v_mfma_f32_16x16x32_bf16 v[112:115], v[44:47], v[64:67], v[112:115]
    ds_read_b64_tr_b16 v[28:29], v7 offset:32768
    v_mfma_f32_16x16x32_bf16 v[128:131], v[44:47], v[68:71], v[128:131]
    ds_read_b64_tr_b16 v[30:31], v7 offset:34816
    s_waitcnt vmcnt(10)
    s_waitcnt lgkmcnt(6)
    v_mfma_f32_16x16x32_bf16 v[100:103], v[16:19], v[72:75], v[100:103]
    ds_read_b64_tr_b16 v[32:33], v4 offset:36864
    v_mfma_f32_16x16x32_bf16 v[116:119], v[16:19], v[76:79], v[116:119]
    ds_read_b64_tr_b16 v[34:35], v4 offset:38912
    s_add_u32 s80, s81, 16384
    s_and_b32 s80, s80, 0x7fff
    s_add_u32 s80, s80, s79
    s_add_u32 s82, s80, 0x8000
    buffer_load_dwordx4 v[64:67], v98, s[16:19], s80 offen offset:0 sc1
    s_waitcnt lgkmcnt(6)
    v_mfma_f32_16x16x32_bf16 v[104:107], v[20:23], v[72:75], v[104:107]
    ds_read_b64_tr_b16 v[36:37], v5 offset:36864
    v_mfma_f32_16x16x32_bf16 v[120:123], v[20:23], v[76:79], v[120:123]
    ds_read_b64_tr_b16 v[38:39], v5 offset:38912
    s_waitcnt lgkmcnt(6)
    v_mfma_f32_16x16x32_bf16 v[108:111], v[24:27], v[72:75], v[108:111]
    ds_read_b64_tr_b16 v[40:41], v6 offset:36864
    buffer_load_dwordx4 v[68:71], v98, s[16:19], s82 offen offset:0 sc1
    v_mfma_f32_16x16x32_bf16 v[124:127], v[24:27], v[76:79], v[124:127]
    ds_read_b64_tr_b16 v[42:43], v6 offset:38912
    s_waitcnt lgkmcnt(6)
    v_mfma_f32_16x16x32_bf16 v[112:115], v[28:31], v[72:75], v[112:115]
    ds_read_b64_tr_b16 v[44:45], v7 offset:36864
    v_mfma_f32_16x16x32_bf16 v[128:131], v[28:31], v[76:79], v[128:131]
    ds_read_b64_tr_b16 v[46:47], v7 offset:38912
    s_waitcnt vmcnt(10)
    s_waitcnt lgkmcnt(6)
    v_mfma_f32_16x16x32_bf16 v[100:103], v[32:35], v[80:83], v[100:103]
    ds_read_b64_tr_b16 v[16:17], v4 offset:40960
    v_mfma_f32_16x16x32_bf16 v[116:119], v[32:35], v[84:87], v[116:119]
    ds_read_b64_tr_b16 v[18:19], v4 offset:43008
    buffer_load_dwordx4 v[72:75], v98, s[16:19], s80 offen offset:1024 sc1
    s_waitcnt lgkmcnt(6)
    v_mfma_f32_16x16x32_bf16 v[104:107], v[36:39], v[80:83], v[104:107]
    ds_read_b64_tr_b16 v[20:21], v5 offset:40960
    v_mfma_f32_16x16x32_bf16 v[120:123], v[36:39], v[84:87], v[120:123]
    ds_read_b64_tr_b16 v[22:23], v5 offset:43008
    s_waitcnt lgkmcnt(6)
    v_mfma_f32_16x16x32_bf16 v[108:111], v[40:43], v[80:83], v[108:111]
    ds_read_b64_tr_b16 v[24:25], v6 offset:40960
    buffer_load_dwordx4 v[76:79], v98, s[16:19], s82 offen offset:1024 sc1
    v_mfma_f32_16x16x32_bf16 v[124:127], v[40:43], v[84:87], v[124:127]
    ds_read_b64_tr_b16 v[26:27], v6 offset:43008
    s_waitcnt lgkmcnt(6)
    v_mfma_f32_16x16x32_bf16 v[112:115], v[44:47], v[80:83], v[112:115]
    ds_read_b64_tr_b16 v[28:29], v7 offset:40960
    v_mfma_f32_16x16x32_bf16 v[128:131], v[44:47], v[84:87], v[128:131]
    ds_read_b64_tr_b16 v[30:31], v7 offset:43008
    s_waitcnt vmcnt(10)
    s_waitcnt lgkmcnt(6)
    v_mfma_f32_16x16x32_bf16 v[100:103], v[16:19], v[88:91], v[100:103]
    ds_read_b64_tr_b16 v[32:33], v4 offset:45056
    v_mfma_f32_16x16x32_bf16 v[116:119], v[16:19], v[92:95], v[116:119]
    ds_read_b64_tr_b16 v[34:35], v4 offset:47104
    s_add_u32 s80, s81, 18432
    s_and_b32 s80, s80, 0x7fff
    s_add_u32 s80, s80, s79
    s_add_u32 s82, s80, 0x8000
    buffer_load_dwordx4 v[80:83], v98, s[16:19], s80 offen offset:0 sc1
    s_waitcnt lgkmcnt(6)
    v_mfma_f32_16x16x32_bf16 v[104:107], v[20:23], v[88:91], v[104:107]
    ds_read_b64_tr_b16 v[36:37], v5 offset:45056
    v_mfma_f32_16x16x32_bf16 v[120:123], v[20:23], v[92:95], v[120:123]
    ds_read_b64_tr_b16 v[38:39], v5 offset:47104
    s_waitcnt lgkmcnt(6)
    v_mfma_f32_16x16x32_bf16 v[108:111], v[24:27], v[88:91], v[108:111]
    ds_read_b64_tr_b16 v[40:41], v6 offset:45056
    buffer_load_dwordx4 v[84:87], v98, s[16:19], s82 offen offset:0 sc1
    v_mfma_f32_16x16x32_bf16 v[124:127], v[24:27], v[92:95], v[124:127]
    ds_read_b64_tr_b16 v[42:43], v6 offset:47104
    s_waitcnt lgkmcnt(6)
    v_mfma_f32_16x16x32_bf16 v[112:115], v[28:31], v[88:91], v[112:115]
    ds_read_b64_tr_b16 v[44:45], v7 offset:45056
    v_mfma_f32_16x16x32_bf16 v[128:131], v[28:31], v[92:95], v[128:131]
    ds_read_b64_tr_b16 v[46:47], v7 offset:47104
    s_waitcnt vmcnt(10)
    s_waitcnt lgkmcnt(6)
    v_mfma_f32_16x16x32_bf16 v[100:103], v[32:35], v[132:135], v[100:103]
    ds_read_b64_tr_b16 v[16:17], v8 offset:24576
    v_mfma_f32_16x16x32_bf16 v[116:119], v[32:35], v[136:139], v[116:119]
    ds_read_b64_tr_b16 v[18:19], v8 offset:26624
    buffer_load_dwordx4 v[88:91], v98, s[16:19], s80 offen offset:1024 sc1
    s_waitcnt lgkmcnt(6)
    v_mfma_f32_16x16x32_bf16 v[104:107], v[36:39], v[132:135], v[104:107]
    ds_read_b64_tr_b16 v[20:21], v9 offset:24576
    v_mfma_f32_16x16x32_bf16 v[120:123], v[36:39], v[136:139], v[120:123]
    ds_read_b64_tr_b16 v[22:23], v9 offset:26624
    s_waitcnt lgkmcnt(6)
    v_mfma_f32_16x16x32_bf16 v[108:111], v[40:43], v[132:135], v[108:111]
    ds_read_b64_tr_b16 v[24:25], v10 offset:24576
    buffer_load_dwordx4 v[92:95], v98, s[16:19], s82 offen offset:1024 sc1
    v_mfma_f32_16x16x32_bf16 v[124:127], v[40:43], v[136:139], v[124:127]
    ds_read_b64_tr_b16 v[26:27], v10 offset:26624
    s_waitcnt lgkmcnt(6)
    v_mfma_f32_16x16x32_bf16 v[112:115], v[44:47], v[132:135], v[112:115]
    ds_read_b64_tr_b16 v[28:29], v11 offset:24576
    v_mfma_f32_16x16x32_bf16 v[128:131], v[44:47], v[136:139], v[128:131]
    ds_read_b64_tr_b16 v[30:31], v11 offset:26624
    s_waitcnt vmcnt(10)
    s_waitcnt lgkmcnt(6)
    v_mfma_f32_16x16x32_bf16 v[100:103], v[16:19], v[48:51], v[100:103]
    ds_read_b64_tr_b16 v[32:33], v8 offset:28672
    v_mfma_f32_16x16x32_bf16 v[116:119], v[16:19], v[52:55], v[116:119]
    ds_read_b64_tr_b16 v[34:35], v8 offset:30720
    s_add_u32 s80, s81, 20480
    s_and_b32 s80, s80, 0x7fff
    s_add_u32 s80, s80, s79
    s_add_u32 s82, s80, 0x8000
    buffer_load_dwordx4 v[132:135], v98, s[16:19], s80 offen offset:0 sc1
    s_waitcnt lgkmcnt(6)
    v_mfma_f32_16x16x32_bf16 v[104:107], v[20:23], v[48:51], v[104:107]
    ds_read_b64_tr_b16 v[36:37], v9 offset:28672
    v_mfma_f32_16x16x32_bf16 v[120:123], v[20:23], v[52:55], v[120:123]
    ds_read_b64_tr_b16 v[38:39], v9 offset:30720
    s_waitcnt lgkmcnt(6)
    v_mfma_f32_16x16x32_bf16 v[108:111], v[24:27], v[48:51], v[108:111]
    ds_read_b64_tr_b16 v[40:41], v10 offset:28672
    buffer_load_dwordx4 v[136:139], v98, s[16:19], s82 offen offset:0 sc1
    v_mfma_f32_16x16x32_bf16 v[124:127], v[24:27], v[52:55], v[124:127]
    ds_read_b64_tr_b16 v[42:43], v10 offset:30720
    s_waitcnt lgkmcnt(6)
    v_mfma_f32_16x16x32_bf16 v[112:115], v[28:31], v[48:51], v[112:115]
    ds_read_b64_tr_b16 v[44:45], v11 offset:28672
    v_mfma_f32_16x16x32_bf16 v[128:131], v[28:31], v[52:55], v[128:131]
    ds_read_b64_tr_b16 v[46:47], v11 offset:30720
    s_waitcnt vmcnt(10)
    s_waitcnt lgkmcnt(6)
    v_mfma_f32_16x16x32_bf16 v[100:103], v[32:35], v[56:59], v[100:103]
    ds_read_b64_tr_b16 v[16:17], v4 offset:49152
    v_mfma_f32_16x16x32_bf16 v[116:119], v[32:35], v[60:63], v[116:119]
    ds_read_b64_tr_b16 v[18:19], v4 offset:51200
    buffer_load_dwordx4 v[48:51], v98, s[16:19], s80 offen offset:1024 sc1
    s_waitcnt lgkmcnt(6)
    v_mfma_f32_16x16x32_bf16 v[104:107], v[36:39], v[56:59], v[104:107]
    ds_read_b64_tr_b16 v[20:21], v5 offset:49152
    v_mfma_f32_16x16x32_bf16 v[120:123], v[36:39], v[60:63], v[120:123]
    ds_read_b64_tr_b16 v[22:23], v5 offset:51200
    s_waitcnt lgkmcnt(6)
    v_mfma_f32_16x16x32_bf16 v[108:111], v[40:43], v[56:59], v[108:111]
    ds_read_b64_tr_b16 v[24:25], v6 offset:49152
    s_branch IW_s7
IW_w7:
    s_branch IW_r7
IW_s7:
    buffer_load_dwordx4 v[52:55], v98, s[16:19], s82 offen offset:1024 sc1
    v_mfma_f32_16x16x32_bf16 v[124:127], v[40:43], v[60:63], v[124:127]
    ds_read_b64_tr_b16 v[26:27], v6 offset:51200
    s_waitcnt lgkmcnt(6)
    v_mfma_f32_16x16x32_bf16 v[112:115], v[44:47], v[56:59], v[112:115]
    ds_read_b64_tr_b16 v[28:29], v7 offset:49152
    v_mfma_f32_16x16x32_bf16 v[128:131], v[44:47], v[60:63], v[128:131]
    ds_read_b64_tr_b16 v[30:31], v7 offset:51200
    s_waitcnt vmcnt(10)
    s_waitcnt lgkmcnt(6)
    v_mfma_f32_16x16x32_bf16 v[100:103], v[16:19], v[64:67], v[100:103]
    ds_read_b64_tr_b16 v[32:33], v4 offset:53248
    v_mfma_f32_16x16x32_bf16 v[116:119], v[16:19], v[68:71], v[116:119]
    ds_read_b64_tr_b16 v[34:35], v4 offset:55296
    s_add_u32 s80, s81, 22528
    s_and_b32 s80, s80, 0x7fff
    s_add_u32 s80, s80, s79
    s_add_u32 s82, s80, 0x8000
    buffer_load_dwordx4 v[56:59], v98, s[16:19], s80 offen offset:0 sc1
    s_waitcnt lgkmcnt(6)
    v_mfma_f32_16x16x32_bf16 v[104:107], v[20:23], v[64:67], v[104:107]
    ds_read_b64_tr_b16 v[36:37], v5 offset:53248
    v_mfma_f32_16x16x32_bf16 v[120:123], v[20:23], v[68:71], v[120:123]
    ds_read_b64_tr_b16 v[38:39], v5 offset:55296
    s_waitcnt lgkmcnt(6)
    v_mfma_f32_16x16x32_bf16 v[108:111], v[24:27], v[64:67], v[108:111]
    ds_read_b64_tr_b16 v[40:41], v6 offset:53248
    buffer_load_dwordx4 v[60:63], v98, s[16:19], s82 offen offset:0 sc1
    v_mfma_f32_16x16x32_bf16 v[124:127], v[24:27], v[68:71], v[124:127]
    ds_read_b64_tr_b16 v[42:43], v6 offset:55296
    s_waitcnt lgkmcnt(6)
    v_mfma_f32_16x16x32_bf16 v[112:115], v[28:31], v[64:67], v[112:115]
    ds_read_b64_tr_b16 v[44:45], v7 offset:53248
    v_mfma_f32_16x16x32_bf16 v[128:131], v[28:31], v[68:71], v[128:131]
    ds_read_b64_tr_b16 v[46:47], v7 offset:55296
    s_waitcnt vmcnt(10)
    s_waitcnt lgkmcnt(6)
    v_mfma_f32_16x16x32_bf16 v[100:103], v[32:35], v[72:75], v[100:103]
    ds_read_b64_tr_b16 v[16:17], v8 offset:0
    v_mfma_f32_16x16x32_bf16 v[116:119], v[32:35], v[76:79], v[116:119]
    ds_read_b64_tr_b16 v[18:19], v8 offset:2048
    buffer_load_dwordx4 v[64:67], v98, s[16:19], s80 offen offset:1024 sc1
    s_waitcnt lgkmcnt(6)
    v_mfma_f32_16x16x32_bf16 v[104:107], v[36:39], v[72:75], v[104:107]
    ds_read_b64_tr_b16 v[20:21], v9 offset:0
    v_mfma_f32_16x16x32_bf16 v[120:123], v[36:39], v[76:79], v[120:123]
    ds_read_b64_tr_b16 v[22:23], v9 offset:2048
    s_waitcnt lgkmcnt(6)
    v_mfma_f32_16x16x32_bf16 v[108:111], v[40:43], v[72:75], v[108:111]
    ds_read_b64_tr_b16 v[24:25], v10 offset:0
    buffer_load_dwordx4 v[68:71], v98, s[16:19], s82 offen offset:1024 sc1
    v_mfma_f32_16x16x32_bf16 v[124:127], v[40:43], v[76:79], v[124:127]
    ds_read_b64_tr_b16 v[26:27], v10 offset:2048
    s_waitcnt lgkmcnt(6)
    v_mfma_f32_16x16x32_bf16 v[112:115], v[44:47], v[72:75], v[112:115]
    ds_read_b64_tr_b16 v[28:29], v11 offset:0
    v_mfma_f32_16x16x32_bf16 v[128:131], v[44:47], v[76:79], v[128:131]
    ds_read_b64_tr_b16 v[30:31], v11 offset:2048
    s_waitcnt vmcnt(10)
    s_waitcnt lgkmcnt(6)
    v_mfma_f32_16x16x32_bf16 v[100:103], v[16:19], v[80:83], v[100:103]
    ds_read_b64_tr_b16 v[32:33], v8 offset:4096
    v_mfma_f32_16x16x32_bf16 v[116:119], v[16:19], v[84:87], v[116:119]
    ds_read_b64_tr_b16 v[34:35], v8 offset:6144
    s_add_u32 s80, s81, 24576
    s_and_b32 s80, s80, 0x7fff
    s_add_u32 s80, s80, s79
    s_add_u32 s82, s80, 0x8000
    buffer_load_dwordx4 v[72:75], v98, s[16:19], s80 offen offset:0 sc1
    s_waitcnt lgkmcnt(6)
    v_mfma_f32_16x16x32_bf16 v[104:107], v[20:23], v[80:83], v[104:107]
    ds_read_b64_tr_b16 v[36:37], v9 offset:4096
    v_mfma_f32_16x16x32_bf16 v[120:123], v[20:23], v[84:87], v[120:123]
    ds_read_b64_tr_b16 v[38:39], v9 offset:6144
    s_waitcnt lgkmcnt(6)
    v_mfma_f32_16x16x32_bf16 v[108:111], v[24:27], v[80:83], v[108:111]
    ds_read_b64_tr_b16 v[40:41], v10 offset:4096
    buffer_load_dwordx4 v[76:79], v98, s[16:19], s82 offen offset:0 sc1
    v_mfma_f32_16x16x32_bf16 v[124:127], v[24:27], v[84:87], v[124:127]
    ds_read_b64_tr_b16 v[42:43], v10 offset:6144
    s_waitcnt lgkmcnt(6)
    v_mfma_f32_16x16x32_bf16 v[112:115], v[28:31], v[80:83], v[112:115]
    ds_read_b64_tr_b16 v[44:45], v11 offset:4096
    v_mfma_f32_16x16x32_bf16 v[128:131], v[28:31], v[84:87], v[128:131]
    ds_read_b64_tr_b16 v[46:47], v11 offset:6144
    s_waitcnt vmcnt(10)
    s_waitcnt lgkmcnt(6)
    v_mfma_f32_16x16x32_bf16 v[100:103], v[32:35], v[88:91], v[100:103]
    ds_read_b64_tr_b16 v[16:17], v8 offset:16384
    v_mfma_f32_16x16x32_bf16 v[116:119], v[32:35], v[92:95], v[116:119]
    ds_read_b64_tr_b16 v[18:19], v8 offset:18432
    buffer_load_dwordx4 v[80:83], v98, s[16:19], s80 offen offset:1024 sc1
    s_waitcnt lgkmcnt(6)
    v_mfma_f32_16x16x32_bf16 v[104:107], v[36:39], v[88:91], v[104:107]
    ds_read_b64_tr_b16 v[20:21], v9 offset:16384
    v_mfma_f32_16x16x32_bf16 v[120:123], v[36:39], v[92:95], v[120:123]
    ds_read_b64_tr_b16 v[22:23], v9 offset:18432
    s_waitcnt lgkmcnt(6)
    v_mfma_f32_16x16x32_bf16 v[108:111], v[40:43], v[88:91], v[108:111]
    ds_read_b64_tr_b16 v[24:25], v10 offset:16384
    buffer_load_dwordx4 v[84:87], v98, s[16:19], s82 offen offset:1024 sc1
    v_mfma_f32_16x16x32_bf16 v[124:127], v[40:43], v[92:95], v[124:127]
    ds_read_b64_tr_b16 v[26:27], v10 offset:18432
    s_waitcnt lgkmcnt(6)
    v_mfma_f32_16x16x32_bf16 v[112:115], v[44:47], v[88:91], v[112:115]
    ds_read_b64_tr_b16 v[28:29], v11 offset:16384
    v_mfma_f32_16x16x32_bf16 v[128:131], v[44:47], v[92:95], v[128:131]
    ds_read_b64_tr_b16 v[30:31], v11 offset:18432
    s_waitcnt vmcnt(10)
    s_waitcnt lgkmcnt(6)
    v_mfma_f32_16x16x32_bf16 v[100:103], v[16:19], v[132:135], v[100:103]
    ds_read_b64_tr_b16 v[32:33], v8 offset:20480
    v_mfma_f32_16x16x32_bf16 v[116:119], v[16:19], v[136:139], v[116:119]
    ds_read_b64_tr_b16 v[34:35], v8 offset:22528
    s_add_u32 s80, s81, 26624
    s_and_b32 s80, s80, 0x7fff
    s_add_u32 s80, s80, s79
    s_add_u32 s82, s80, 0x8000
    buffer_load_dwordx4 v[88:91], v98, s[16:19], s80 offen offset:0 sc1
    s_waitcnt lgkmcnt(6)
    v_mfma_f32_16x16x32_bf16 v[104:107], v[20:23], v[132:135], v[104:107]
    ds_read_b64_tr_b16 v[36:37], v9 offset:20480
    v_mfma_f32_16x16x32_bf16 v[120:123], v[20:23], v[136:139], v[120:123]
    ds_read_b64_tr_b16 v[38:39], v9 offset:22528
    s_waitcnt lgkmcnt(6)
    v_mfma_f32_16x16x32_bf16 v[108:111], v[24:27], v[132:135], v[108:111]
    ds_read_b64_tr_b16 v[40:41], v10 offset:20480
    buffer_load_dwordx4 v[92:95], v98, s[16:19], s82 offen offset:0 sc1
    v_mfma_f32_16x16x32_bf16 v[124:127], v[24:27], v[136:139], v[124:127]
    ds_read_b64_tr_b16 v[42:43], v10 offset:22528
    s_waitcnt lgkmcnt(6)
    v_mfma_f32_16x16x32_bf16 v[112:115], v[28:31], v[132:135], v[112:115]
    ds_read_b64_tr_b16 v[44:45], v11 offset:20480
    v_mfma_f32_16x16x32_bf16 v[128:131], v[28:31], v[136:139], v[128:131]
    ds_read_b64_tr_b16 v[46:47], v11 offset:22528
    s_waitcnt vmcnt(10)
    s_waitcnt lgkmcnt(6)
    v_mfma_f32_16x16x32_bf16 v[100:103], v[32:35], v[48:51], v[100:103]
    ds_read_b64_tr_b16 v[16:17], v8 offset:40960
    v_mfma_f32_16x16x32_bf16 v[116:119], v[32:35], v[52:55], v[116:119]
    ds_read_b64_tr_b16 v[18:19], v8 offset:43008
    buffer_load_dwordx4 v[132:135], v98, s[16:19], s80 offen offset:1024 sc1
    s_waitcnt lgkmcnt(6)
    v_mfma_f32_16x16x32_bf16 v[104:107], v[36:39], v[48:51], v[104:107]
    ds_read_b64_tr_b16 v[20:21], v9 offset:40960
    v_mfma_f32_16x16x32_bf16 v[120:123], v[36:39], v[52:55], v[120:123]
    ds_read_b64_tr_b16 v[22:23], v9 offset:43008
    s_waitcnt lgkmcnt(6)
    v_mfma_f32_16x16x32_bf16 v[108:111], v[40:43], v[48:51], v[108:111]
    ds_read_b64_tr_b16 v[24:25], v10 offset:40960
    buffer_load_dwordx4 v[136:139], v98, s[16:19], s82 offen offset:1024 sc1
    v_mfma_f32_16x16x32_bf16 v[124:127], v[40:43], v[52:55], v[124:127]
    ds_read_b64_tr_b16 v[26:27], v10 offset:43008
    s_waitcnt lgkmcnt(6)
    v_mfma_f32_16x16x32_bf16 v[112:115], v[44:47], v[48:51], v[112:115]
    ds_read_b64_tr_b16 v[28:29], v11 offset:40960
    v_mfma_f32_16x16x32_bf16 v[128:131], v[44:47], v[52:55], v[128:131]
    ds_read_b64_tr_b16 v[30:31], v11 offset:43008
    s_waitcnt vmcnt(10)
    s_waitcnt lgkmcnt(6)
    v_mfma_f32_16x16x32_bf16 v[100:103], v[16:19], v[56:59], v[100:103]
    ds_read_b64_tr_b16 v[32:33], v8 offset:45056
    v_mfma_f32_16x16x32_bf16 v[116:119], v[16:19], v[60:63], v[116:119]
    ds_read_b64_tr_b16 v[34:35], v8 offset:47104
    s_add_u32 s80, s81, 28672
    s_and_b32 s80, s80, 0x7fff
    s_add_u32 s80, s80, s79
    s_add_u32 s82, s80, 0x8000
    buffer_load_dwordx4 v[48:51], v98, s[16:19], s80 offen offset:0 sc1
    s_waitcnt lgkmcnt(6)
    v_mfma_f32_16x16x32_bf16 v[104:107], v[20:23], v[56:59], v[104:107]
    ds_read_b64_tr_b16 v[36:37], v9 offset:45056
    v_mfma_f32_16x16x32_bf16 v[120:123], v[20:23], v[60:63], v[120:123]
    ds_read_b64_tr_b16 v[38:39], v9 offset:47104
    s_waitcnt lgkmcnt(6)
    v_mfma_f32_16x16x32_bf16 v[108:111], v[24:27], v[56:59], v[108:111]
    ds_read_b64_tr_b16 v[40:41], v10 offset:45056
    buffer_load_dwordx4 v[52:55], v98, s[16:19], s82 offen offset:0 sc1
    v_mfma_f32_16x16x32_bf16 v[124:127], v[24:27], v[60:63], v[124:127]
    ds_read_b64_tr_b16 v[42:43], v10 offset:47104
    s_waitcnt lgkmcnt(6)
    v_mfma_f32_16x16x32_bf16 v[112:115], v[28:31], v[56:59], v[112:115]
    ds_read_b64_tr_b16 v[44:45], v11 offset:45056
    v_mfma_f32_16x16x32_bf16 v[128:131], v[28:31], v[60:63], v[128:131]
    ds_read_b64_tr_b16 v[46:47], v11 offset:47104
    s_waitcnt vmcnt(10)
    s_waitcnt lgkmcnt(6)
    v_mfma_f32_16x16x32_bf16 v[100:103], v[32:35], v[64:67], v[100:103]
    ds_read_b64_tr_b16 v[16:17], v8 offset:32768
    v_mfma_f32_16x16x32_bf16 v[116:119], v[32:35], v[68:71], v[116:119]
    ds_read_b64_tr_b16 v[18:19], v8 offset:34816
    buffer_load_dwordx4 v[56:59], v98, s[16:19], s80 offen offset:1024 sc1
    s_waitcnt lgkmcnt(6)
    v_mfma_f32_16x16x32_bf16 v[104:107], v[36:39], v[64:67], v[104:107]
    ds_read_b64_tr_b16 v[20:21], v9 offset:32768
    v_mfma_f32_16x16x32_bf16 v[120:123], v[36:39], v[68:71], v[120:123]
    ds_read_b64_tr_b16 v[22:23], v9 offset:34816
    s_waitcnt lgkmcnt(6)
    v_mfma_f32_16x16x32_bf16 v[108:111], v[40:43], v[64:67], v[108:111]
    ds_read_b64_tr_b16 v[24:25], v10 offset:32768
    buffer_load_dwordx4 v[60:63], v98, s[16:19], s82 offen offset:1024 sc1
    v_mfma_f32_16x16x32_bf16 v[124:127], v[40:43], v[68:71], v[124:127]
    ds_read_b64_tr_b16 v[26:27], v10 offset:34816
    s_waitcnt lgkmcnt(6)
    v_mfma_f32_16x16x32_bf16 v[112:115], v[44:47], v[64:67], v[112:115]
    ds_read_b64_tr_b16 v[28:29], v11 offset:32768
    v_mfma_f32_16x16x32_bf16 v[128:131], v[44:47], v[68:71], v[128:131]
    ds_read_b64_tr_b16 v[30:31], v11 offset:34816
    s_waitcnt vmcnt(10)
    s_waitcnt lgkmcnt(6)
    v_mfma_f32_16x16x32_bf16 v[100:103], v[16:19], v[72:75], v[100:103]
    ds_read_b64_tr_b16 v[32:33], v8 offset:36864
    v_mfma_f32_16x16x32_bf16 v[116:119], v[16:19], v[76:79], v[116:119]
    ds_read_b64_tr_b16 v[34:35], v8 offset:38912
    s_add_u32 s80, s81, 30720
    s_and_b32 s80, s80, 0x7fff
    s_add_u32 s80, s80, s79
    s_add_u32 s82, s80, 0x8000
    buffer_load_dwordx4 v[64:67], v98, s[16:19], s80 offen offset:0 sc1
    s_waitcnt lgkmcnt(6)
    v_mfma_f32_16x16x32_bf16 v[104:107], v[20:23], v[72:75], v[104:107]
    ds_read_b64_tr_b16 v[36:37], v9 offset:36864
    v_mfma_f32_16x16x32_bf16 v[120:123], v[20:23], v[76:79], v[120:123]
    ds_read_b64_tr_b16 v[38:39], v9 offset:38912
    s_waitcnt lgkmcnt(6)
    v_mfma_f32_16x16x32_bf16 v[108:111], v[24:27], v[72:75], v[108:111]
    ds_read_b64_tr_b16 v[40:41], v10 offset:36864
    buffer_load_dwordx4 v[68:71], v98, s[16:19], s82 offen offset:0 sc1
    v_mfma_f32_16x16x32_bf16 v[124:127], v[24:27], v[76:79], v[124:127]
    ds_read_b64_tr_b16 v[42:43], v10 offset:38912
    s_waitcnt lgkmcnt(6)
    v_mfma_f32_16x16x32_bf16 v[112:115], v[28:31], v[72:75], v[112:115]
    ds_read_b64_tr_b16 v[44:45], v11 offset:36864
    v_mfma_f32_16x16x32_bf16 v[128:131], v[28:31], v[76:79], v[128:131]
    ds_read_b64_tr_b16 v[46:47], v11 offset:38912
    s_waitcnt vmcnt(10)
    s_waitcnt lgkmcnt(6)
    v_mfma_f32_16x16x32_bf16 v[100:103], v[32:35], v[80:83], v[100:103]
    ds_read_b64_tr_b16 v[16:17], v12 offset:0
    v_mfma_f32_16x16x32_bf16 v[116:119], v[32:35], v[84:87], v[116:119]
    ds_read_b64_tr_b16 v[18:19], v12 offset:2048
    buffer_load_dwordx4 v[72:75], v98, s[16:19], s80 offen offset:1024 sc1
    s_waitcnt lgkmcnt(6)
    v_mfma_f32_16x16x32_bf16 v[104:107], v[36:39], v[80:83], v[104:107]
    ds_read_b64_tr_b16 v[20:21], v13 offset:0
    v_mfma_f32_16x16x32_bf16 v[120:123], v[36:39], v[84:87], v[120:123]
    ds_read_b64_tr_b16 v[22:23], v13 offset:2048
    s_waitcnt lgkmcnt(6)
    v_mfma_f32_16x16x32_bf16 v[108:111], v[40:43], v[80:83], v[108:111]
    ds_read_b64_tr_b16 v[24:25], v14 offset:0
    buffer_load_dwordx4 v[76:79], v98, s[16:19], s82 offen offset:1024 sc1
    v_mfma_f32_16x16x32_bf16 v[124:127], v[40:43], v[84:87], v[124:127]
    ds_read_b64_tr_b16 v[26:27], v14 offset:2048
    s_waitcnt lgkmcnt(6)
    v_mfma_f32_16x16x32_bf16 v[112:115], v[44:47], v[80:83], v[112:115]
    ds_read_b64_tr_b16 v[28:29], v15 offset:0
    v_mfma_f32_16x16x32_bf16 v[128:131], v[44:47], v[84:87], v[128:131]
    ds_read_b64_tr_b16 v[30:31], v15 offset:2048
    s_waitcnt vmcnt(10)
    s_waitcnt lgkmcnt(6)
    v_mfma_f32_16x16x32_bf16 v[100:103], v[16:19], v[88:91], v[100:103]
    ds_read_b64_tr_b16 v[32:33], v12 offset:4096
    v_mfma_f32_16x16x32_bf16 v[116:119], v[16:19], v[92:95], v[116:119]
    ds_read_b64_tr_b16 v[34:35], v12 offset:6144
    s_waitcnt lgkmcnt(6)
    v_mfma_f32_16x16x32_bf16 v[104:107], v[20:23], v[88:91], v[104:107]
    ds_read_b64_tr_b16 v[36:37], v13 offset:4096
    v_mfma_f32_16x16x32_bf16 v[120:123], v[20:23], v[92:95], v[120:123]
    ds_read_b64_tr_b16 v[38:39], v13 offset:6144
    s_waitcnt lgkmcnt(6)
    v_mfma_f32_16x16x32_bf16 v[108:111], v[24:27], v[88:91], v[108:111]
    ds_read_b64_tr_b16 v[40:41], v14 offset:4096
    v_mfma_f32_16x16x32_bf16 v[124:127], v[24:27], v[92:95], v[124:127]
    ds_read_b64_tr_b16 v[42:43], v14 offset:6144
    s_waitcnt lgkmcnt(6)
    v_mfma_f32_16x16x32_bf16 v[112:115], v[28:31], v[88:91], v[112:115]
    ds_read_b64_tr_b16 v[44:45], v15 offset:4096
    v_mfma_f32_16x16x32_bf16 v[128:131], v[28:31], v[92:95], v[128:131]
    ds_read_b64_tr_b16 v[46:47], v15 offset:6144
    s_waitcnt vmcnt(8)
    s_waitcnt lgkmcnt(6)
    v_mfma_f32_16x16x32_bf16 v[100:103], v[32:35], v[132:135], v[100:103]
    ds_read_b64_tr_b16 v[16:17], v8 offset:49152
    v_mfma_f32_16x16x32_bf16 v[116:119], v[32:35], v[136:139], v[116:119]
    ds_read_b64_tr_b16 v[18:19], v8 offset:51200
    s_waitcnt lgkmcnt(6)
    v_mfma_f32_16x16x32_bf16 v[104:107], v[36:39], v[132:135], v[104:107]
    ds_read_b64_tr_b16 v[20:21], v9 offset:49152
    v_mfma_f32_16x16x32_bf16 v[120:123], v[36:39], v[136:139], v[120:123]
    ds_read_b64_tr_b16 v[22:23], v9 offset:51200
    s_waitcnt lgkmcnt(6)
    v_mfma_f32_16x16x32_bf16 v[108:111], v[40:43], v[132:135], v[108:111]
    ds_read_b64_tr_b16 v[24:25], v10 offset:49152
    v_mfma_f32_16x16x32_bf16 v[124:127], v[40:43], v[136:139], v[124:127]
    ds_read_b64_tr_b16 v[26:27], v10 offset:51200
    s_waitcnt lgkmcnt(6)
    v_mfma_f32_16x16x32_bf16 v[112:115], v[44:47], v[132:135], v[112:115]
    ds_read_b64_tr_b16 v[28:29], v11 offset:49152
    v_mfma_f32_16x16x32_bf16 v[128:131], v[44:47], v[136:139], v[128:131]
    ds_read_b64_tr_b16 v[30:31], v11 offset:51200
    s_waitcnt vmcnt(6)
    s_waitcnt lgkmcnt(6)
    v_mfma_f32_16x16x32_bf16 v[100:103], v[16:19], v[48:51], v[100:103]
    ds_read_b64_tr_b16 v[32:33], v8 offset:53248
    v_mfma_f32_16x16x32_bf16 v[116:119], v[16:19], v[52:55], v[116:119]
    ds_read_b64_tr_b16 v[34:35], v8 offset:55296
    s_waitcnt lgkmcnt(6)
    v_mfma_f32_16x16x32_bf16 v[104:107], v[20:23], v[48:51], v[104:107]
    ds_read_b64_tr_b16 v[36:37], v9 offset:53248
    v_mfma_f32_16x16x32_bf16 v[120:123], v[20:23], v[52:55], v[120:123]
    ds_read_b64_tr_b16 v[38:39], v9 offset:55296
    s_waitcnt lgkmcnt(6)
    v_mfma_f32_16x16x32_bf16 v[108:111], v[24:27], v[48:51], v[108:111]
    ds_read_b64_tr_b16 v[40:41], v10 offset:53248
    v_mfma_f32_16x16x32_bf16 v[124:127], v[24:27], v[52:55], v[124:127]
    ds_read_b64_tr_b16 v[42:43], v10 offset:55296
    s_waitcnt lgkmcnt(6)
    v_mfma_f32_16x16x32_bf16 v[112:115], v[28:31], v[48:51], v[112:115]
    ds_read_b64_tr_b16 v[44:45], v11 offset:53248
    v_mfma_f32_16x16x32_bf16 v[128:131], v[28:31], v[52:55], v[128:131]
    ds_read_b64_tr_b16 v[46:47], v11 offset:55296
    s_waitcnt vmcnt(4)
    s_waitcnt lgkmcnt(6)
    v_mfma_f32_16x16x32_bf16 v[100:103], v[32:35], v[56:59], v[100:103]
    ds_read_b64_tr_b16 v[16:17], v12 offset:8192
    v_mfma_f32_16x16x32_bf16 v[116:119], v[32:35], v[60:63], v[116:119]
    ds_read_b64_tr_b16 v[18:19], v12 offset:10240
    s_waitcnt lgkmcnt(6)
    v_mfma_f32_16x16x32_bf16 v[104:107], v[36:39], v[56:59], v[104:107]
    ds_read_b64_tr_b16 v[20:21], v13 offset:8192
    v_mfma_f32_16x16x32_bf16 v[120:123], v[36:39], v[60:63], v[120:123]
    ds_read_b64_tr_b16 v[22:23], v13 offset:10240
    s_waitcnt lgkmcnt(6)
    v_mfma_f32_16x16x32_bf16 v[108:111], v[40:43], v[56:59], v[108:111]
    ds_read_b64_tr_b16 v[24:25], v14 offset:8192
    v_mfma_f32_16x16x32_bf16 v[124:127], v[40:43], v[60:63], v[124:127]
    ds_read_b64_tr_b16 v[26:27], v14 offset:10240
    s_waitcnt lgkmcnt(6)
    v_mfma_f32_16x16x32_bf16 v[112:115], v[44:47], v[56:59], v[112:115]
    ds_read_b64_tr_b16 v[28:29], v15 offset:8192
    v_mfma_f32_16x16x32_bf16 v[128:131], v[44:47], v[60:63], v[128:131]
    ds_read_b64_tr_b16 v[30:31], v15 offset:10240
    s_waitcnt vmcnt(2)
    s_waitcnt lgkmcnt(6)
    v_mfma_f32_16x16x32_bf16 v[100:103], v[16:19], v[64:67], v[100:103]
    ds_read_b64_tr_b16 v[32:33], v12 offset:12288
    v_mfma_f32_16x16x32_bf16 v[116:119], v[16:19], v[68:71], v[116:119]
    ds_read_b64_tr_b16 v[34:35], v12 offset:14336
    s_waitcnt lgkmcnt(6)
    v_mfma_f32_16x16x32_bf16 v[104:107], v[20:23], v[64:67], v[104:107]
    ds_read_b64_tr_b16 v[36:37], v13 offset:12288
    v_mfma_f32_16x16x32_bf16 v[120:123], v[20:23], v[68:71], v[120:123]
    ds_read_b64_tr_b16 v[38:39], v13 offset:14336
    s_waitcnt lgkmcnt(6)
    v_mfma_f32_16x16x32_bf16 v[108:111], v[24:27], v[64:67], v[108:111]
    ds_read_b64_tr_b16 v[40:41], v14 offset:12288
    v_mfma_f32_16x16x32_bf16 v[124:127], v[24:27], v[68:71], v[124:127]
    ds_read_b64_tr_b16 v[42:43], v14 offset:14336
    s_waitcnt lgkmcnt(6)
    v_mfma_f32_16x16x32_bf16 v[112:115], v[28:31], v[64:67], v[112:115]
    ds_read_b64_tr_b16 v[44:45], v15 offset:12288
    v_mfma_f32_16x16x32_bf16 v[128:131], v[28:31], v[68:71], v[128:131]
    ds_read_b64_tr_b16 v[46:47], v15 offset:14336
    s_waitcnt vmcnt(0)
    s_waitcnt lgkmcnt(6)
    v_mfma_f32_16x16x32_bf16 v[100:103], v[32:35], v[72:75], v[100:103]
    v_mfma_f32_16x16x32_bf16 v[116:119], v[32:35], v[76:79], v[116:119]
    s_waitcnt lgkmcnt(4)
    v_mfma_f32_16x16x32_bf16 v[104:107], v[36:39], v[72:75], v[104:107]
    v_mfma_f32_16x16x32_bf16 v[120:123], v[36:39], v[76:79], v[120:123]
    s_waitcnt lgkmcnt(2)
    v_mfma_f32_16x16x32_bf16 v[108:111], v[40:43], v[72:75], v[108:111]
    v_mfma_f32_16x16x32_bf16 v[124:127], v[40:43], v[76:79], v[124:127]
    s_waitcnt lgkmcnt(0)
    v_mfma_f32_16x16x32_bf16 v[112:115], v[44:47], v[72:75], v[112:115]
    v_mfma_f32_16x16x32_bf16 v[128:131], v[44:47], v[76:79], v[128:131]
    s_nop 0
    v_permlane16_swap_b32 v100, v104
    v_permlane16_swap_b32 v101, v105
    v_permlane16_swap_b32 v102, v106
    v_permlane16_swap_b32 v103, v107
    s_nop 1
    v_permlane16_swap_b32 v108, v112
    v_permlane16_swap_b32 v109, v113
    v_permlane16_swap_b32 v110, v114
    v_permlane16_swap_b32 v111, v115
    v_permlane16_swap_b32 v116, v120
    v_permlane16_swap_b32 v117, v121
    v_permlane16_swap_b32 v118, v122
    v_permlane16_swap_b32 v119, v123
    v_permlane16_swap_b32 v124, v128
    v_permlane16_swap_b32 v125, v129
    v_permlane16_swap_b32 v126, v130
    v_permlane16_swap_b32 v127, v131
    s_cmp_eq_u64 s[60:61], 0
    s_cbranch_scc1 F_fin
    s_mov_b32 s48, 0xbfb8aa3b
    v_and_b32 v7, 0x3f, v2
    v_lshlrev_b32 v7, 1, v7
    v_add_u32 v7, 159744, v7
    v_mov_b32 v6, 159136

    ds_read_b32 v5, v6 offset:0
FW_74:
    s_waitcnt lgkmcnt(0)
    v_cmp_gt_u32 vcc, 1, v5
    s_cbranch_vccz FO_75
    ds_read_b32 v5, v6 offset:0
    s_branch FW_74
FO_75:
    v_bfe_u32 v4, v164, 11, 3
    v_lshl_add_u32 v4, v4, 8, v7
    v_cmp_ne_u32 vcc, 0, v164
    s_nop 0
    s_and_saveexec_b64 s[50:51], vcc
    s_cbranch_execz F_rb_76
    ds_read_b128 v[16:19], v4 offset:0
    ds_read_b128 v[20:23], v4 offset:16
    ds_read_b128 v[24:27], v4 offset:128
    ds_read_b128 v[28:31], v4 offset:144
    v_and_b32 v5, 0xffff0000, v164
    v_ashrrev_i32 v6, 31, v5
    v_not_b32 v6, v6
    v_or_b32 v6, 0x80000000, v6
    v_xor_b32 v5, v5, v6
    v_and_b32 v5, 0xffff0000, v5
    v_mul_f32 v5, s48, v5
    v_exp_f32 v5, v5
    s_nop 0
    v_add_f32 v5, 1.0, v5
    v_rcp_f32 v5, v5
    s_nop 0
    v_cvt_pk_bf16_f32 v5, v5, v5
    v_lshlrev_b32 v5, 16, v5
    s_waitcnt lgkmcnt(0)
    v_fmac_f32 v100, v16, v5
    v_fmac_f32 v101, v17, v5
    v_fmac_f32 v102, v18, v5
    v_fmac_f32 v103, v19, v5
    v_fmac_f32 v104, v20, v5
    v_fmac_f32 v105, v21, v5
    v_fmac_f32 v106, v22, v5
    v_fmac_f32 v107, v23, v5
    v_fmac_f32 v108, v24, v5
    v_fmac_f32 v109, v25, v5
    v_fmac_f32 v110, v26, v5
    v_fmac_f32 v111, v27, v5
    v_fmac_f32 v112, v28, v5
    v_fmac_f32 v113, v29, v5
    v_fmac_f32 v114, v30, v5
    v_fmac_f32 v115, v31, v5
F_rb_76:
    s_mov_b64 exec, s[50:51]
    v_bfe_u32 v4, v165, 11, 3
    v_lshl_add_u32 v4, v4, 8, v7
    v_cmp_ne_u32 vcc, 0, v165
    s_nop 0
    s_and_saveexec_b64 s[50:51], vcc
    s_cbranch_execz F_rb_77
    ds_read_b128 v[16:19], v4 offset:0
    ds_read_b128 v[20:23], v4 offset:16
    ds_read_b128 v[24:27], v4 offset:128
    ds_read_b128 v[28:31], v4 offset:144
    v_and_b32 v5, 0xffff0000, v165
    v_ashrrev_i32 v6, 31, v5
    v_not_b32 v6, v6
    v_or_b32 v6, 0x80000000, v6
    v_xor_b32 v5, v5, v6
    v_and_b32 v5, 0xffff0000, v5
    v_mul_f32 v5, s48, v5
    v_exp_f32 v5, v5
    s_nop 0
    v_add_f32 v5, 1.0, v5
    v_rcp_f32 v5, v5
    s_nop 0
    v_cvt_pk_bf16_f32 v5, v5, v5
    v_lshlrev_b32 v5, 16, v5
    s_waitcnt lgkmcnt(0)
    v_fmac_f32 v116, v16, v5
    v_fmac_f32 v117, v17, v5
    v_fmac_f32 v118, v18, v5
    v_fmac_f32 v119, v19, v5
    v_fmac_f32 v120, v20, v5
    v_fmac_f32 v121, v21, v5
    v_fmac_f32 v122, v22, v5
    v_fmac_f32 v123, v23, v5
    v_fmac_f32 v124, v24, v5
    v_fmac_f32 v125, v25, v5
    v_fmac_f32 v126, v26, v5
    v_fmac_f32 v127, v27, v5
    v_fmac_f32 v128, v28, v5
    v_fmac_f32 v129, v29, v5
    v_fmac_f32 v130, v30, v5
    v_fmac_f32 v131, v31, v5
F_rb_77:
    s_mov_b64 exec, s[50:51]
F_fin:
    s_nop 0
    v_cvt_pk_bf16_f32 v48, v100, v101
    v_cvt_pk_bf16_f32 v49, v102, v103
    v_cvt_pk_bf16_f32 v50, v104, v105
    v_cvt_pk_bf16_f32 v51, v106, v107
    buffer_store_dwordx4 v[48:51], v2, s[12:15], s42 offen offset:0 sc1
    v_cvt_pk_bf16_f32 v52, v108, v109
    v_cvt_pk_bf16_f32 v53, v110, v111
    v_cvt_pk_bf16_f32 v54, v112, v113
    v_cvt_pk_bf16_f32 v55, v114, v115
    buffer_store_dwordx4 v[52:55], v2, s[12:15], s42 offen offset:64 sc1
    v_cvt_pk_bf16_f32 v56, v116, v117
    v_cvt_pk_bf16_f32 v57, v118, v119
    v_cvt_pk_bf16_f32 v58, v120, v121
    v_cvt_pk_bf16_f32 v59, v122, v123
    buffer_store_dwordx4 v[56:59], v2, s[12:15], s43 offen offset:0 sc1
    v_cvt_pk_bf16_f32 v60, v124, v125
    v_cvt_pk_bf16_f32 v61, v126, v127
    v_cvt_pk_bf16_f32 v62, v128, v129
    v_cvt_pk_bf16_f32 v63, v130, v131
    buffer_store_dwordx4 v[60:63], v2, s[12:15], s43 offen offset:64 sc1
    s_endpgm
F_aux:
    s_setprio 3
    s_sub_u32 s3, s3, 8
    s_mov_b32 s88, s3
    v_lshrrev_b32 v5, 4, v0
    s_cmp_eq_u32 s3, 1
    s_mov_b32 s45, 73728
    s_cselect_b32 s45, 65536, s45
    s_cmp_eq_u32 s3, 2
    s_cselect_b32 s45, 147456, s45
    v_bfe_u32 v60, v0, 2, 2
    v_lshl_add_u32 v62, v5, 3, v60
    v_lshrrev_b32 v60, 1, v60
    v_and_b32 v63, 1, v5
    v_lshl_add_u32 v60, v63, 1, v60
    v_lshlrev_b32 v60, 5, v60
    v_lshl_add_u32 v60, v62, 7, v60
    v_and_b32 v63, 3, v0
    v_lshl_add_u32 v60, v63, 3, v60
    v_add_u32 v62, s45, v60
    v_xor_b32 v63, 32, v62
    v_xor_b32 v64, 64, v62
    v_xor_b32 v65, 96, v62
    v_lshlrev_b32 v2, 4, v0
    v_lshlrev_b32 v3, 2, v0
    v_and_b32 v7, 15, v0
    v_and_b32 v8, 7, v0
    v_lshlrev_b32 v8, 4, v8
    v_lshl_add_u32 v8, v5, 7, v8
    v_bfe_u32 v9, v0, 3, 1
    v_lshl_add_u32 v4, v9, 11, v8
    v_and_b32 v9, 1, v0
    v_lshlrev_b32 v59, 2, v7
    s_lshl_b32 s76, s32, 4
    s_add_u32 s76, s76, s33
    s_lshl_b32 s77, s76, 3
    s_lshl_b32 s44, s3, 1
    s_add_u32 s77, s77, s44
    v_mov_b32 v12, 0
    v_mov_b32 v13, 0
    v_mov_b32 v14, 0
    v_mov_b32 v15, 0
    s_lshl_b32 s75, s3, 4
    s_add_u32 s75, s75, s33
    s_lshl_b32 s44, s3, 2
    s_add_u32 s44, s44, 159040
    v_mov_b32 v10, s44

    v_mov_b32 v32, 0x3f803f80
    v_mov_b32 v33, 0x3f803f80
    v_mov_b32 v34, 0x3f803f80
    v_mov_b32 v35, 0x3f803f80
    v_mov_b32 v36, 0x3f803f80
    v_mov_b32 v37, 0x3f803f80
    v_mov_b32 v38, 0x3f803f80
    v_mov_b32 v39, 0x3f803f80
    v_mov_b32 v40, 0x3f803f80
    v_mov_b32 v41, 0x3f803f80
    v_mov_b32 v42, 0x3f803f80
    v_mov_b32 v43, 0x3f803f80
    v_mov_b32 v44, 0x3f803f80
    v_mov_b32 v45, 0x3f803f80
    v_mov_b32 v46, 0x3f803f80
    v_mov_b32 v47, 0x3f803f80
    s_waitcnt lgkmcnt(0)
    s_mov_b32 s20, s4
    s_mov_b32 s21, s5
    s_mov_b32 s22, 0x400000
    s_mov_b32 s23, 0x00020000
    s_mov_b32 s19, 0x20000
    s_add_u32 s40, s72, 0x850000
    s_addc_u32 s41, s73, 0
    s_mov_b32 s42, 0xd000
    s_mov_b32 s43, 0x00020000
    s_cmp_lg_u32 s3, 0
    s_cbranch_scc1 F_z0
    s_getpc_b64 s[46:47]
F_pc:
    s_sub_u32 s46, s46, F_pc-parallel_sum__linear_attn_block__moe_arch_mod__prompt_kernel
    s_subb_u32 s47, s47, 0
    s_and_b32 s44, s31, 7
    s_lshl_b32 s44, s44, 13
    v_lshlrev_b32 v67, 7, v0
    v_add_u32 v67, s44, v67
    v_min_u32 v67, F_codeend-parallel_sum__linear_attn_block__moe_arch_mod__prompt_kernel-4, v67
    global_load_dword v61, v67, s[46:47]
    s_cmp_lg_u32 s75, 0
    s_cbranch_scc1 F_z0
    s_lshl_b32 s44, s32, 9
    s_add_u32 s44, s44, 32768
    s_mov_b32 exec_hi, 0
    buffer_store_dwordx4 v[12:15], v2, s[40:43], s44 offen sc0 sc1
    s_mul_i32 s44, s32, 768
    s_add_u32 s44, s44, 40960
    s_mov_b32 exec_hi, 0xffff
    buffer_store_dwordx4 v[12:15], v2, s[40:43], s44 offen sc0 sc1
    s_mov_b64 exec, -1
F_z0:

    s_barrier
    s_bitcmp0_b32 s3, 0
    s_cbranch_scc1 F_cs1
    ds_read_b64_tr_b16 v[72:73], v62 offset:0
    ds_read_b64_tr_b16 v[74:75], v62 offset:512
    ds_read_b64_tr_b16 v[76:77], v62 offset:4096
    ds_read_b64_tr_b16 v[78:79], v62 offset:4608
    ds_read_b64_tr_b16 v[80:81], v63 offset:0
    ds_read_b64_tr_b16 v[82:83], v63 offset:512
    ds_read_b64_tr_b16 v[84:85], v63 offset:4096
    ds_read_b64_tr_b16 v[86:87], v63 offset:4608
    s_waitcnt lgkmcnt(4)
    s_nop 0
    ds_read_b64_tr_b16 v[88:89], v64 offset:0
    ds_read_b64_tr_b16 v[90:91], v64 offset:512
    ds_read_b64_tr_b16 v[92:93], v64 offset:4096
    ds_read_b64_tr_b16 v[94:95], v64 offset:4608
    ds_read_b64_tr_b16 v[96:97], v65 offset:0
    ds_read_b64_tr_b16 v[98:99], v65 offset:512
    ds_read_b64_tr_b16 v[100:101], v65 offset:4096
    ds_read_b64_tr_b16 v[102:103], v65 offset:4608
    s_branch IW_s8
IW_w8:
    s_branch IW_r8
IW_s8:
    s_branch F_cs2
F_cs1:
    v_add_u32 v60, 159040, v3
    s_mov_b32 exec_hi, 0xffff
    ds_write_b32 v60, v12
    s_mov_b64 exec, -1
F_cs2:
    s_add_u32 s24, s72, 0x800000
    s_addc_u32 s25, s73, 0
    s_mov_b32 s26, 0x48000
    s_mov_b32 s27, 0x00020000
    s_mov_b32 s48, s70
    s_mov_b32 s49, s71
    s_mov_b32 s50, 0x100
    s_mov_b32 s51, 0x00020000
    s_lshl_b32 s47, s32, 9
    s_add_u32 s56, s47, 0x858000
    s_add_u32 s56, s72, s56
    s_addc_u32 s57, s73, 0
    s_lshl_b32 s47, s33, 9
    s_add_u32 s58, s47, 0x858100
    s_add_u32 s58, s72, s58
    s_addc_u32 s59, s73, 0
    v_mov_b32 v68, 0x3f803f80
    v_mov_b32 v69, 0x3f803f80
    v_mov_b32 v70, 0x3f803f80
    v_mov_b32 v71, 0x3f803f80
    s_waitcnt lgkmcnt(0)
    s_cmp_lg_u32 s75, 0
    s_cbranch_scc1 F_z4
    s_lshl_b32 s45, s32, 2
    s_add_u32 s44, s70, s45
    s_addc_u32 s45, s71, 0
    s_mov_b32 s46, 1
    s_waitcnt vmcnt(0)
    s_atomic_add s46, s[44:45], 0
F_z4:

    s_barrier
    s_cmp_lg_u32 s3, 2
    s_cbranch_scc1 F_cs3
    ds_read_b64_tr_b16 v[72:73], v62 offset:0
    ds_read_b64_tr_b16 v[74:75], v62 offset:512
    ds_read_b64_tr_b16 v[76:77], v62 offset:4096
    ds_read_b64_tr_b16 v[78:79], v62 offset:4608
    ds_read_b64_tr_b16 v[80:81], v63 offset:0
    ds_read_b64_tr_b16 v[82:83], v63 offset:512
    ds_read_b64_tr_b16 v[84:85], v63 offset:4096
    ds_read_b64_tr_b16 v[86:87], v63 offset:4608
    s_waitcnt lgkmcnt(4)
    s_nop 0
    ds_read_b64_tr_b16 v[88:89], v64 offset:0
    ds_read_b64_tr_b16 v[90:91], v64 offset:512
    ds_read_b64_tr_b16 v[92:93], v64 offset:4096
    ds_read_b64_tr_b16 v[94:95], v64 offset:4608
    ds_read_b64_tr_b16 v[96:97], v65 offset:0
    ds_read_b64_tr_b16 v[98:99], v65 offset:512
    ds_read_b64_tr_b16 v[100:101], v65 offset:4096
    ds_read_b64_tr_b16 v[102:103], v65 offset:4608
    s_waitcnt lgkmcnt(0)
F_cs3:
    s_cmp_lt_u32 s3, 2
    s_mov_b32 s44, 81920
    s_cselect_b32 s44, 81920, s44
    s_lshl_b32 s45, s3, 12
    s_add_u32 s44, s44, s45
    v_add_u32_e64 v4, s44, v4
    v_add_u32 v8, 161792, v8
    ds_read_b128 v[16:19], v4 offset:0
    ds_read_b128 v[20:23], v4 offset:512
    ds_read_b128 v[24:27], v4 offset:1024
    ds_read_b128 v[28:31], v4 offset:1536
    s_mov_b32 exec_lo, 0x00ff00ff
    s_mov_b32 exec_hi, 0x00ff00ff
    ds_read_b128 v[32:35], v8 offset:0
    ds_read_b128 v[36:39], v8 offset:512
    ds_read_b128 v[40:43], v8 offset:1024
    ds_read_b128 v[44:47], v8 offset:1536
    s_mov_b64 exec, -1
    s_waitcnt lgkmcnt(0)
    v_mfma_f32_16x16x32_bf16 v[120:123], v[16:19], v[16:19], 0
    v_mfma_f32_16x16x32_bf16 v[124:127], v[16:19], v[32:35], 0
    v_mfma_f32_16x16x32_bf16 v[128:131], v[32:35], v[32:35], 0
    v_mfma_f32_16x16x32_bf16 v[120:123], v[20:23], v[20:23], v[120:123]
    v_mfma_f32_16x16x32_bf16 v[124:127], v[20:23], v[36:39], v[124:127]
    v_mfma_f32_16x16x32_bf16 v[128:131], v[36:39], v[36:39], v[128:131]
    v_mfma_f32_16x16x32_bf16 v[120:123], v[24:27], v[24:27], v[120:123]
    v_mfma_f32_16x16x32_bf16 v[124:127], v[24:27], v[40:43], v[124:127]
    v_mfma_f32_16x16x32_bf16 v[128:131], v[40:43], v[40:43], v[128:131]
    v_mfma_f32_16x16x32_bf16 v[120:123], v[28:31], v[28:31], v[120:123]
    v_mfma_f32_16x16x32_bf16 v[124:127], v[28:31], v[44:47], v[124:127]
    v_mfma_f32_16x16x32_bf16 v[128:131], v[44:47], v[44:47], v[128:131]
    v_mfma_f32_16x16x32_bf16 v[104:107], v[68:71], v[72:75], 0
    v_mfma_f32_16x16x32_bf16 v[108:111], v[68:71], v[80:83], 0
    v_mfma_f32_16x16x32_bf16 v[112:115], v[68:71], v[88:91], 0
    v_mfma_f32_16x16x32_bf16 v[116:119], v[68:71], v[96:99], 0
    v_mfma_f32_16x16x32_bf16 v[104:107], v[68:71], v[76:79], v[104:107]
    v_mfma_f32_16x16x32_bf16 v[108:111], v[68:71], v[84:87], v[108:111]
    v_mfma_f32_16x16x32_bf16 v[112:115], v[68:71], v[92:95], v[112:115]
    v_mfma_f32_16x16x32_bf16 v[116:119], v[68:71], v[100:103], v[116:119]
    v_cmp_eq_u32 vcc, 1, v5
    s_nop 4
    v_cndmask_b32 v66, v104, v108, vcc
    v_cmp_eq_u32 vcc, 2, v5
    s_nop 1
    v_cndmask_b32 v66, v66, v112, vcc
    v_cmp_eq_u32 vcc, 3, v5
    s_nop 1
    v_cndmask_b32 v66, v66, v116, vcc

    s_cmp_lg_u32 s3, 0
    s_cbranch_scc1 EV_79
    s_branch IW_w8
IW_r8:
EV_79:
    s_cmp_lg_u32 s3, 1
    s_cbranch_scc1 EV_80
    s_branch IW_w0
IW_r0:
EV_80:
    s_cmp_lg_u32 s3, 2
    s_cbranch_scc1 EV_81
    s_branch IW_w1
IW_r1:
EV_81:
    s_cmp_lg_u32 s3, 3
    s_cbranch_scc1 EV_82
    s_branch IW_w3
IW_r3:
EV_82:
    s_barrier
    v_and_b32 v52, 3, v0
    v_cmp_eq_u32 vcc, 1, v52
    s_nop 1
    v_cndmask_b32 v120, v120, v121, vcc
    v_cndmask_b32 v124, v124, v125, vcc
    v_cndmask_b32 v128, v128, v129, vcc
    v_cmp_eq_u32 vcc, 2, v52
    s_nop 1
    v_cndmask_b32 v120, v120, v122, vcc
    v_cndmask_b32 v124, v124, v126, vcc
    v_cndmask_b32 v128, v128, v130, vcc
    v_cmp_eq_u32 vcc, 3, v52
    s_nop 1
    v_cndmask_b32 v120, v120, v123, vcc
    v_cndmask_b32 v124, v124, v127, vcc
    v_cndmask_b32 v128, v128, v131, vcc
    v_add_f32_dpp v120, v120, v120 quad_perm:[1,0,3,2] row_mask:0xf bank_mask:0xf
    v_add_f32_dpp v124, v124, v124 quad_perm:[1,0,3,2] row_mask:0xf bank_mask:0xf
    v_add_f32_dpp v128, v128, v128 quad_perm:[1,0,3,2] row_mask:0xf bank_mask:0xf
    v_add_f32_dpp v120, v120, v120 quad_perm:[2,3,0,1] row_mask:0xf bank_mask:0xf
    v_add_f32_dpp v124, v124, v124 quad_perm:[2,3,0,1] row_mask:0xf bank_mask:0xf
    v_add_f32_dpp v128, v128, v128 quad_perm:[2,3,0,1] row_mask:0xf bank_mask:0xf
    v_readlane_b32 s44, v124, 8
    v_readlane_b32 s45, v124, 24
    v_readlane_b32 s46, v124, 40
    v_readlane_b32 s47, v124, 56
    v_mov_b32 v48, s44
    v_mov_b32 v52, s45
    s_nop 0
    v_writelane_b32 v48, s46, 1
    v_writelane_b32 v52, s47, 1
    v_readlane_b32 s44, v120, 0
    v_readlane_b32 s45, v120, 20
    v_readlane_b32 s46, v120, 40
    v_readlane_b32 s47, v120, 60
    v_mov_b32 v49, s44
    v_mov_b32 v53, s45
    s_nop 0
    v_writelane_b32 v49, s46, 1
    v_writelane_b32 v53, s47, 1
    v_readlane_b32 s44, v124, 0
    v_readlane_b32 s45, v124, 20
    v_readlane_b32 s46, v124, 32
    v_readlane_b32 s47, v124, 52
    v_mov_b32 v50, s44
    v_mov_b32 v54, s45
    s_nop 0
    v_writelane_b32 v50, s46, 1
    v_writelane_b32 v54, s47, 1
    v_readlane_b32 s44, v128, 8
    v_readlane_b32 s45, v128, 24
    v_readlane_b32 s46, v128, 8
    v_readlane_b32 s47, v128, 24
    v_mov_b32 v51, s44
    v_mov_b32 v55, s45
    s_nop 0
    v_writelane_b32 v51, s46, 1
    v_writelane_b32 v55, s47, 1
    s_cmp_lg_u32 s3, 0
    s_cbranch_scc1 F_r1
    buffer_load_dword v11, v59, s[48:51], 0 offen sc0 sc1
F_r1:
    s_cmp_lg_u32 s3, 0
    s_cbranch_scc1 EV_84
    s_branch IW_w4
IW_r4:
EV_84:
    s_cmp_lg_u32 s3, 1
    s_cbranch_scc1 EV_85
    s_branch IW_w9
IW_r9:
EV_85:
    s_cmp_lg_u32 s3, 2
    s_cbranch_scc1 EV_86
    s_branch IW_w10
IW_r10:
EV_86:
    s_cmp_lg_u32 s3, 3
    s_cbranch_scc1 EV_87
    s_nop 0
EV_87:
    s_barrier
    v_add_f32 v48, v48, v52
    v_add_f32 v49, v49, v53
    v_add_f32 v50, v50, v54
    v_add_f32 v51, v51, v55
    v_mul_f32 v48, 0x3a800000, v48
    v_mul_f32 v49, 0x3a800000, v49
    v_fma_f32 v49, -v48, v48, v49
    v_max_f32 v49, 0, v49
    v_cvt_pk_bf16_f32 v52, v48, v49
    v_lshlrev_b32 v48, 16, v52
    v_and_b32 v49, 0xffff0000, v52
    v_add_f32 v49, 0x3727c5ac, v49
    v_cvt_pk_bf16_f32 v49, v49, v49
    v_lshlrev_b32 v49, 16, v49
    v_sqrt_f32 v49, v49
    s_nop 0
    v_cvt_pk_bf16_f32 v49, v49, v49
    v_lshlrev_b32 v49, 16, v49
    v_rcp_f32 v49, v49
    v_xor_b32 v48, 0x80000000, v48
    v_fma_f32 v50, v48, v51, v50
    v_mul_f32 v50, v50, v49
    v_cvt_pk_bf16_f32 v50, v50, v50
    v_and_b32 v50, 0xffff0000, v50
    v_ashrrev_i32 v51, 31, v50
    v_or_b32 v51, 0x80000000, v51
    v_xor_b32 v50, v50, v51
    v_and_b32 v50, 0xffff0000, v50
    s_sub_u32 s44, 2047, s77
    v_sub_u32 v51, s44, v9
    v_or_b32 v50, v50, v51
    s_lshl_b32 s44, s3, 1
    v_add_u32 v52, s44, v9
    v_lshlrev_b32 v53, 3, v52
    v_lshlrev_b32 v52, 2, v52
    v_add_u32 v53, 159744, v53
    v_add_u32 v52, 159808, v52
    s_mov_b64 exec, 3
    ds_write_b64 v53, v[48:49]
    ds_write_b32 v52, v50
    s_mov_b64 exec, -1
    s_waitcnt lgkmcnt(0)

    s_cmp_lg_u32 s3, 0
    s_cbranch_scc1 F_a0r
F_a0p:
    s_waitcnt vmcnt(0)
    v_cmp_eq_u32 vcc, 0, v11
    s_cbranch_vccz F_a0r
    s_sleep 4
    buffer_load_dword v11, v59, s[48:51], 0 offen sc0 sc1
    s_branch F_a0p
F_a0r:
    s_barrier
    s_cmp_eq_u32 s3, 0
    s_cbranch_scc1 F_ax0
    s_mul_i32 s44, s33, 768
    s_add_u32 s44, s44, 40960
    s_add_u32 s45, s3, 1
    s_lshr_b32 s45, s45, 1
    s_cmp_eq_u32 s3, 2
    s_cselect_b32 s45, 0, s45
    s_lshl_b32 s45, s45, 8
    s_add_u32 s44, s44, s45
    buffer_atomic_add_f32 v66, v3, s[40:43], s44 offen
    s_mul_i32 s44, s2, 1152
    s_mul_i32 s45, s3, 384
    s_add_u32 s44, s44, s45
    s_sub_u32 s44, s44, 384
    s_mov_b64 exec, 0xffffff
    buffer_store_dwordx4 v[12:15], v2, s[24:27], s44 offen sc0 sc1
    s_mov_b64 exec, -1
    s_branch F_s1
F_ax0:
    v_add_u32 v60, 159744, v3
    ds_read_b32 v60, v60
    s_lshl_b32 s44, s76, 7
    s_mov_b32 exec_hi, 0
    s_waitcnt lgkmcnt(0)
    buffer_store_dword v60, v3, s[40:43], s44 offen sc0 sc1
    s_mov_b64 exec, -1
F_s1:

    s_barrier
    v_mov_b32 v4, 159144
    v_mov_b32 v8, 1
    s_lshr_b32 s47, s32, 2
    s_lshl_b32 s47, s47, 11
    s_add_u32 s54, s47, 0x858180
    s_add_u32 s54, s72, s54
    s_addc_u32 s55, s73, 0
    s_waitcnt vmcnt(0)
    s_mov_b64 exec, 1
    ds_add_rtn_u32 v9, v4, v8
    s_waitcnt lgkmcnt(0)
    v_readfirstlane_b32 s44, v9
    s_mov_b64 exec, -1
    s_cmp_lg_u32 s44, 3
    s_cbranch_scc1 F_a0s
    s_mov_b32 s74, 1
    s_atomic_add s74, s[54:55], 0
    s_atomic_add s74, s[56:57], 0
    s_atomic_add s74, s[58:59], 0
F_a0s:

    s_barrier
    s_and_b32 s89, s2, 0xdd
    s_bfe_u32 s44, s2, 0x10005
    s_lshl_b32 s44, s44, 1
    s_or_b32 s89, s89, s44
    s_bfe_u32 s44, s2, 0x10001
    s_xor_b32 s44, s44, 1
    s_lshl_b32 s44, s44, 5
    s_or_b32 s89, s89, s44
    s_and_b32 s36, s89, 3
    s_bfe_u32 s37, s89, 0x10002
    s_lshr_b32 s38, s89, 3
    s_cmp_eq_u32 s37, 0
    s_cselect_b32 s16, s62, s64
    s_cselect_b32 s17, s63, s65
    s_cmp_lt_u32 s89, 224
    s_cselect_b32 s18, 7340032, 0
    v_mul_u32_u24 v6, 57344, v5
    v_lshl_add_u32 v6, v7, 4, v6
    s_lshl_b32 s44, s36, 2
    s_add_u32 s44, s44, s3
    s_waitcnt lgkmcnt(0)
    s_mul_i32 s54, s44, 458752
    s_lshl_b32 s45, s38, 8
    s_add_u32 s54, s54, s45
    s_lshl_b32 s55, s44, 7

    s_and_b32 s39, s89, 7
    s_mul_i32 s10, s38, 112
    s_mul_i32 s79, s3, 28
    s_add_u32 s10, s10, s79
    s_lshl_b32 s78, s10, 11
    s_lshl_b32 s79, s39, 8
    s_add_u32 s78, s78, s79
    v_mul_u32_u24 v160, 14336, v5
    v_lshl_add_u32 v160, v7, 4, v160

    s_mov_b32 s80, s66
    s_mov_b32 s81, s67
    s_mov_b32 s82, 0x700000
    s_mov_b32 s83, 0x00020000
    s_mul_i32 s53, s2, 37
    s_and_b32 s53, s53, 255
    s_mul_i32 s53, s53, 4
    s_lshr_b32 s53, s53, 8
    s_branch F_swx
F_sw0:
    s_add_u32 s91, s78, 0
    s_nop 0
    buffer_load_dwordx4 v[16:19], v160, s[80:83], s91 offen nt
    s_add_u32 s91, s78, 2048
    buffer_load_dwordx4 v[20:23], v160, s[80:83], s91 offen nt
    s_add_u32 s91, s78, 4096
    buffer_load_dwordx4 v[24:27], v160, s[80:83], s91 offen nt
    s_add_u32 s91, s78, 6144
    buffer_load_dwordx4 v[28:31], v160, s[80:83], s91 offen nt
    s_add_u32 s91, s78, 8192
    buffer_load_dwordx4 v[144:147], v160, s[80:83], s91 offen nt
    s_add_u32 s91, s78, 10240
    buffer_load_dwordx4 v[148:151], v160, s[80:83], s91 offen nt
    s_add_u32 s91, s78, 12288
    buffer_load_dwordx4 v[152:155], v160, s[80:83], s91 offen nt
    s_setpc_b64 s[34:35]
F_swx:
    s_cmp_eq_u32 s3, 2
    s_cbranch_scc1 F_ax2
    s_cmp_eq_u32 s3, 1
    s_cbranch_scc1 F_ax1
    s_cmp_eq_u32 s3, 0
    s_cbranch_scc1 F_ax0b
    s_barrier
    s_cmp_lg_u32 s53, 0
    s_cbranch_scc1 SW_88
    s_call_b64 s[34:35], F_sw0
SW_88:
    s_branch IW_w5
IW_r5:
    s_barrier
    s_cmp_lg_u32 s53, 1
    s_cbranch_scc1 SW_89
    s_call_b64 s[34:35], F_sw0
SW_89:
    s_branch IW_w7
IW_r7:
    s_barrier
    s_cmp_lg_u32 s53, 2
    s_cbranch_scc1 SW_90
    s_call_b64 s[34:35], F_sw0
SW_90:
    s_nop 0
    s_barrier
    s_cmp_lg_u32 s53, 3
    s_cbranch_scc1 SW_91
    s_call_b64 s[34:35], F_sw0
SW_91:
    s_nop 0
    s_barrier
    s_nop 0
    s_barrier
    s_nop 0
    s_barrier
    s_add_u32 s91, s54, 0
    buffer_load_dwordx4 v[72:75], v6, s[16:19], s91 offen nt
    s_add_u32 s91, s54, 7168
    buffer_load_dwordx4 v[76:79], v6, s[16:19], s91 offen nt
    s_add_u32 s91, s54, 14336
    buffer_load_dwordx4 v[80:83], v6, s[16:19], s91 offen nt
    s_add_u32 s91, s54, 21504
    buffer_load_dwordx4 v[84:87], v6, s[16:19], s91 offen nt
    s_nop 0
    s_load_dword s76, s[56:57], 0 glc
    s_barrier
    s_nop 0
    s_add_u32 s91, s54, 28672
    buffer_load_dwordx4 v[88:91], v6, s[16:19], s91 offen nt
    s_add_u32 s91, s54, 35840
    buffer_load_dwordx4 v[92:95], v6, s[16:19], s91 offen nt
    s_add_u32 s91, s54, 43008
    buffer_load_dwordx4 v[96:99], v6, s[16:19], s91 offen nt
    s_add_u32 s91, s54, 50176
    buffer_load_dwordx4 v[100:103], v6, s[16:19], s91 offen nt
    s_waitcnt lgkmcnt(0)
    s_cmp_ge_u32 s76, 1000
    s_cbranch_scc1 GC_92
SP_93:
    s_load_dword s76, s[56:57], 0 glc
    s_waitcnt lgkmcnt(0)
    s_cmp_ge_u32 s76, 1000
    s_cbranch_scc1 SD_94
    s_sleep 3
    s_branch SP_93
SD_94:
GC_92:
    v_mov_b32 v4, 1
    s_mov_b64 exec, 1
    ds_write_b32 v10, v4 offset:48
    s_mov_b64 exec, -1
    s_barrier
    s_branch F_aj
F_ax1:
    s_barrier
    s_cmp_lg_u32 s53, 0
    s_cbranch_scc1 SW_95
    s_call_b64 s[34:35], F_sw0
SW_95:
    s_branch IW_w6
IW_r6:
    s_barrier
    s_cmp_lg_u32 s53, 1
    s_cbranch_scc1 SW_96
    s_call_b64 s[34:35], F_sw0
SW_96:
    s_nop 0
    s_barrier
    s_cmp_lg_u32 s53, 2
    s_cbranch_scc1 SW_97
    s_call_b64 s[34:35], F_sw0
SW_97:
    s_nop 0
    s_mul_i32 s44, s33, 768
    s_add_u32 s44, s44, 40960
    s_barrier
    s_cmp_lg_u32 s53, 3
    s_cbranch_scc1 SW_98
    s_call_b64 s[34:35], F_sw0
SW_98:
    s_load_dword s76, s[58:59], 0 glc
    s_barrier
    s_waitcnt lgkmcnt(0)
    s_cmp_ge_u32 s76, 16
    s_cbranch_scc1 GC_99
SP_100:
    s_load_dword s76, s[58:59], 0 glc
    s_waitcnt lgkmcnt(0)
    s_cmp_ge_u32 s76, 16
    s_cbranch_scc1 SD_101
    s_sleep 3
    s_branch SP_100
SD_101:
GC_99:
    s_barrier
    s_sleep 4
    s_mov_b32 m0, 158208
    s_mov_b32 exec_hi, 0xffff
    buffer_load_dwordx4 v2, s[40:43], s44 offen sc0 sc1 lds
    s_mov_b64 exec, -1
    s_barrier
    s_add_u32 s91, s54, 0
    buffer_load_dwordx4 v[72:75], v6, s[16:19], s91 offen nt
    s_add_u32 s91, s54, 7168
    buffer_load_dwordx4 v[76:79], v6, s[16:19], s91 offen nt
    s_add_u32 s91, s54, 14336
    buffer_load_dwordx4 v[80:83], v6, s[16:19], s91 offen nt
    s_add_u32 s91, s54, 21504
    buffer_load_dwordx4 v[84:87], v6, s[16:19], s91 offen nt
    s_barrier
    s_nop 0
    s_add_u32 s91, s54, 28672
    buffer_load_dwordx4 v[88:91], v6, s[16:19], s91 offen nt
    s_add_u32 s91, s54, 35840
    buffer_load_dwordx4 v[92:95], v6, s[16:19], s91 offen nt
    s_add_u32 s91, s54, 43008
    buffer_load_dwordx4 v[96:99], v6, s[16:19], s91 offen nt
    s_add_u32 s91, s54, 50176
    buffer_load_dwordx4 v[100:103], v6, s[16:19], s91 offen nt
    s_waitcnt vmcnt(8)
    v_mov_b32 v4, 1
    s_mov_b64 exec, 1
    ds_write_b32 v10, v4 offset:48
    s_mov_b64 exec, -1
    s_barrier
    s_branch F_aj
IW_w9:
    s_branch IW_r9
F_ax0b:
    s_barrier
    s_cmp_lg_u32 s53, 0
    s_cbranch_scc1 SW_102
    s_call_b64 s[34:35], F_sw0
SW_102:
    s_branch IW_w2
IW_r2:
    s_barrier
    s_cmp_lg_u32 s53, 1
    s_cbranch_scc1 SW_103
    s_call_b64 s[34:35], F_sw0
SW_103:
    s_nop 0
    s_barrier
    s_cmp_lg_u32 s53, 2
    s_cbranch_scc1 SW_104
    s_call_b64 s[34:35], F_sw0
SW_104:
    s_nop 0
    s_lshl_b32 s47, s28, 9
    s_add_u32 s58, s47, 0x858000
    s_add_u32 s58, s72, s58
    s_addc_u32 s59, s73, 0
    s_lshl_b32 s44, s32, 11
    s_lshl_b32 s45, s28, 11
    v_lshrrev_b32 v11, 2, v0
    v_and_b32 v9, 3, v0
    v_lshlrev_b32 v9, 4, v9
    v_lshl_add_u32 v11, v11, 7, v9

    s_barrier
    s_cmp_lg_u32 s53, 3
    s_cbranch_scc1 SW_105
    s_call_b64 s[34:35], F_sw0
SW_105:
    s_load_dword s76, s[56:57], 0 glc
    s_load_dword s77, s[58:59], 0 glc
    s_barrier
    s_waitcnt lgkmcnt(0)
    s_cmp_ge_u32 s76, 16
    s_cbranch_scc1 GC_106
SP_107:
    s_load_dword s76, s[56:57], 0 glc
    s_waitcnt lgkmcnt(0)
    s_cmp_ge_u32 s76, 16
    s_cbranch_scc1 SD_108
    s_sleep 3
    s_branch SP_107
SD_108:
GC_106:
    s_cmp_ge_u32 s77, 16
    s_cbranch_scc1 GC_109
SP_110:
    s_load_dword s77, s[58:59], 0 glc
    s_waitcnt lgkmcnt(0)
    s_cmp_ge_u32 s77, 16
    s_cbranch_scc1 SD_111
    s_sleep 3
    s_branch SP_110
SD_111:
GC_109:
    s_barrier
    s_sleep 4
    buffer_load_dwordx4 v[32:35], v11, s[40:43], s44 offen sc0 sc1
    buffer_load_dwordx4 v[36:39], v11, s[40:43], s45 offen sc0 sc1
    v_lshlrev_b32 v9, 3, v0
    v_add_u32 v9, 155648, v9
    s_mov_b32 s44, 0x3fb8aa3b

    s_barrier
    s_add_u32 s91, s54, 0
    buffer_load_dwordx4 v[72:75], v6, s[16:19], s91 offen nt
    s_add_u32 s91, s54, 7168
    buffer_load_dwordx4 v[76:79], v6, s[16:19], s91 offen nt
    s_add_u32 s91, s54, 14336
    buffer_load_dwordx4 v[80:83], v6, s[16:19], s91 offen nt
    s_add_u32 s91, s54, 21504
    buffer_load_dwordx4 v[84:87], v6, s[16:19], s91 offen nt
    s_barrier
    s_add_u32 s91, s54, 28672
    buffer_load_dwordx4 v[88:91], v6, s[16:19], s91 offen nt
    s_add_u32 s91, s54, 35840
    buffer_load_dwordx4 v[92:95], v6, s[16:19], s91 offen nt
    s_add_u32 s91, s54, 43008
    buffer_load_dwordx4 v[96:99], v6, s[16:19], s91 offen nt
    s_add_u32 s91, s54, 50176
    buffer_load_dwordx4 v[100:103], v6, s[16:19], s91 offen nt
    s_waitcnt vmcnt(8)
    v_swap_b32 v33, v34
    v_swap_b32 v37, v38
    v_mul_f32 v40, s44, v34
    v_mul_f32 v41, s44, v35
    ds_write_b64 v9, v[32:33]
    ds_write_b64 v9, v[40:41] offset:1024
    ds_write_b64 v9, v[36:37] offset:1536
    ds_write_b64 v9, v[38:39] offset:2048

    v_mov_b32 v4, 1
    s_mov_b64 exec, 1
    ds_write_b32 v10, v4 offset:48
    s_mov_b64 exec, -1
    s_barrier
    s_branch F_aj
F_ax2:
    s_cmp_lg_u32 s2, 248
    s_cbranch_scc1 F_a2n
    s_waitcnt lgkmcnt(0)
    s_mov_b32 s74, 7
    v_lshrrev_b32 v11, 1, v0
    v_and_b32 v9, 1, v0
    v_lshlrev_b32 v9, 4, v9
    v_lshl_add_u32 v11, v11, 7, v9
    v_lshlrev_b32 v9, 9, v0
    v_mov_b32 v8, 1000
F_a2l:

    s_load_dword s60, s[40:41], 0x8180 glc
    s_load_dword s61, s[40:41], 0x8980 glc
    s_load_dword s62, s[40:41], 0x9180 glc
    s_load_dword s63, s[40:41], 0x9980 glc
    s_waitcnt lgkmcnt(0)
    s_add_u32 s60, s60, s61
    s_add_u32 s62, s62, s63
    s_add_u32 s60, s60, s62
    s_cmp_ge_u32 s60, 256
    s_cbranch_scc1 F_a2t

    s_cmp_ge_u32 s74, 17
    s_cbranch_scc1 DB_112
    s_barrier
    s_add_u32 s74, s74, 1
DB_112:
    s_branch F_a2l
F_a2t:
    s_movk_i32 s44, 0
    buffer_load_dwordx4 v[16:19], v11, s[40:43], s44 offen offset:64 sc0 sc1
    s_movk_i32 s44, 4096
    buffer_load_dwordx4 v[20:23], v11, s[40:43], s44 offen offset:64 sc0 sc1
    s_movk_i32 s44, 8192
    buffer_load_dwordx4 v[24:27], v11, s[40:43], s44 offen offset:64 sc0 sc1
    s_movk_i32 s44, 12288
    buffer_load_dwordx4 v[28:31], v11, s[40:43], s44 offen offset:64 sc0 sc1
    s_movk_i32 s44, 16384
    buffer_load_dwordx4 v[32:35], v11, s[40:43], s44 offen offset:64 sc0 sc1
    s_movk_i32 s44, 20480
    buffer_load_dwordx4 v[36:39], v11, s[40:43], s44 offen offset:64 sc0 sc1
    s_movk_i32 s44, 24576
    buffer_load_dwordx4 v[40:43], v11, s[40:43], s44 offen offset:64 sc0 sc1
    s_movk_i32 s44, 28672
    buffer_load_dwordx4 v[44:47], v11, s[40:43], s44 offen offset:64 sc0 sc1
    s_mov_b32 s44, 32768
    s_mov_b64 exec, 0xffff
    buffer_atomic_add v8, v9, s[40:43], s44 offen
    s_mov_b64 exec, -1

    s_cmp_ge_u32 s74, 17
    s_cbranch_scc1 DB_113
    s_barrier
    s_add_u32 s74, s74, 1
DB_113:
    s_waitcnt vmcnt(1)
    v_max3_u32 v48, v16, v17, v18
    v_med3_u32 v49, v16, v17, v18
    v_min3_u32 v50, v16, v17, v18
    v_med3_u32 v50, v49, v50, v19
    v_med3_u32 v49, v48, v49, v19
    v_max_u32 v48, v48, v19
    v_med3_u32 v50, v49, v50, v20
    v_med3_u32 v49, v48, v49, v20
    v_max_u32 v48, v48, v20
    v_med3_u32 v50, v49, v50, v21
    v_med3_u32 v49, v48, v49, v21
    v_max_u32 v48, v48, v21
    v_med3_u32 v50, v49, v50, v22
    v_med3_u32 v49, v48, v49, v22
    v_max_u32 v48, v48, v22
    v_med3_u32 v50, v49, v50, v23
    v_med3_u32 v49, v48, v49, v23
    v_max_u32 v48, v48, v23
    v_med3_u32 v50, v49, v50, v24
    v_med3_u32 v49, v48, v49, v24
    v_max_u32 v48, v48, v24
    v_med3_u32 v50, v49, v50, v25
    v_med3_u32 v49, v48, v49, v25
    v_max_u32 v48, v48, v25
    v_med3_u32 v50, v49, v50, v26
    v_med3_u32 v49, v48, v49, v26
    v_max_u32 v48, v48, v26
    v_med3_u32 v50, v49, v50, v27
    v_med3_u32 v49, v48, v49, v27
    v_max_u32 v48, v48, v27
    v_med3_u32 v50, v49, v50, v28
    v_med3_u32 v49, v48, v49, v28
    v_max_u32 v48, v48, v28
    v_med3_u32 v50, v49, v50, v29
    v_med3_u32 v49, v48, v49, v29
    v_max_u32 v48, v48, v29
    v_med3_u32 v50, v49, v50, v30
    v_med3_u32 v49, v48, v49, v30
    v_max_u32 v48, v48, v30
    v_med3_u32 v50, v49, v50, v31
    v_med3_u32 v49, v48, v49, v31
    v_max_u32 v48, v48, v31
    v_med3_u32 v50, v49, v50, v32
    v_med3_u32 v49, v48, v49, v32
    v_max_u32 v48, v48, v32
    v_med3_u32 v50, v49, v50, v33
    v_med3_u32 v49, v48, v49, v33
    v_max_u32 v48, v48, v33
    v_med3_u32 v50, v49, v50, v34
    v_med3_u32 v49, v48, v49, v34
    v_max_u32 v48, v48, v34
    v_med3_u32 v50, v49, v50, v35
    v_med3_u32 v49, v48, v49, v35
    v_max_u32 v48, v48, v35
    v_med3_u32 v50, v49, v50, v36
    v_med3_u32 v49, v48, v49, v36
    v_max_u32 v48, v48, v36
    v_med3_u32 v50, v49, v50, v37
    v_med3_u32 v49, v48, v49, v37
    v_max_u32 v48, v48, v37
    v_med3_u32 v50, v49, v50, v38
    v_med3_u32 v49, v48, v49, v38
    v_max_u32 v48, v48, v38
    v_med3_u32 v50, v49, v50, v39
    v_med3_u32 v49, v48, v49, v39
    v_max_u32 v48, v48, v39
    v_med3_u32 v50, v49, v50, v40
    v_med3_u32 v49, v48, v49, v40
    v_max_u32 v48, v48, v40
    v_med3_u32 v50, v49, v50, v41
    v_med3_u32 v49, v48, v49, v41
    v_max_u32 v48, v48, v41
    v_med3_u32 v50, v49, v50, v42
    v_med3_u32 v49, v48, v49, v42
    v_max_u32 v48, v48, v42
    v_med3_u32 v50, v49, v50, v43
    v_med3_u32 v49, v48, v49, v43
    v_max_u32 v48, v48, v43
    v_med3_u32 v50, v49, v50, v44
    v_med3_u32 v49, v48, v49, v44
    v_max_u32 v48, v48, v44
    v_med3_u32 v50, v49, v50, v45
    v_med3_u32 v49, v48, v49, v45
    v_max_u32 v48, v48, v45
    v_med3_u32 v50, v49, v50, v46
    v_med3_u32 v49, v48, v49, v46
    v_max_u32 v48, v48, v46
    v_med3_u32 v50, v49, v50, v47
    v_med3_u32 v49, v48, v49, v47
    v_max_u32 v48, v48, v47
    s_cmp_ge_u32 s74, 17
    s_cbranch_scc1 DB_114
    s_barrier
    s_add_u32 s74, s74, 1
DB_114:
    s_mov_b32 s53, 0
    v_max_u32 v4, v48, v49
    s_nop 1
    v_max_u32_dpp v4, v4, v4 row_shr:1 row_mask:0xf bank_mask:0xf bound_ctrl:0
    s_nop 1
    v_max_u32_dpp v4, v4, v4 row_shr:2 row_mask:0xf bank_mask:0xf bound_ctrl:0
    s_nop 1
    v_max_u32_dpp v4, v4, v4 row_shr:4 row_mask:0xf bank_mask:0xf bound_ctrl:0
    s_nop 1
    v_max_u32_dpp v4, v4, v4 row_shr:8 row_mask:0xf bank_mask:0xf bound_ctrl:0
    s_nop 1
    v_max_u32_dpp v4, v4, v4 row_bcast:15 row_mask:0xa bank_mask:0xf
    s_nop 1
    v_max_u32_dpp v4, v4, v4 row_bcast:31 row_mask:0xc bank_mask:0xf
    s_nop 0
    v_readlane_b32 s52, v4, 63
    s_nop 0
    s_add_u32 s53, s53, s52
    v_writelane_b32 v13, s53, 0
    v_subrev_u32 v48, s52, v48
    v_subrev_u32 v49, s52, v49
    v_max_u32 v4, v48, v49
    s_nop 1
    v_max_u32_dpp v4, v4, v4 row_shr:1 row_mask:0xf bank_mask:0xf bound_ctrl:0
    s_nop 1
    v_max_u32_dpp v4, v4, v4 row_shr:2 row_mask:0xf bank_mask:0xf bound_ctrl:0
    s_nop 1
    v_max_u32_dpp v4, v4, v4 row_shr:4 row_mask:0xf bank_mask:0xf bound_ctrl:0
    s_nop 1
    v_max_u32_dpp v4, v4, v4 row_shr:8 row_mask:0xf bank_mask:0xf bound_ctrl:0
    s_nop 1
    v_max_u32_dpp v4, v4, v4 row_bcast:15 row_mask:0xa bank_mask:0xf
    s_nop 1
    v_max_u32_dpp v4, v4, v4 row_bcast:31 row_mask:0xc bank_mask:0xf
    s_nop 0
    v_readlane_b32 s52, v4, 63
    s_nop 0
    s_add_u32 s53, s53, s52
    v_writelane_b32 v13, s53, 1
    v_subrev_u32 v48, s52, v48
    v_subrev_u32 v49, s52, v49
    v_max_u32 v4, v48, v49
    s_nop 1
    v_max_u32_dpp v4, v4, v4 row_shr:1 row_mask:0xf bank_mask:0xf bound_ctrl:0
    s_nop 1
    v_max_u32_dpp v4, v4, v4 row_shr:2 row_mask:0xf bank_mask:0xf bound_ctrl:0
    s_nop 1
    v_max_u32_dpp v4, v4, v4 row_shr:4 row_mask:0xf bank_mask:0xf bound_ctrl:0
    s_nop 1
    v_max_u32_dpp v4, v4, v4 row_shr:8 row_mask:0xf bank_mask:0xf bound_ctrl:0
    s_nop 1
    v_max_u32_dpp v4, v4, v4 row_bcast:15 row_mask:0xa bank_mask:0xf
    s_nop 1
    v_max_u32_dpp v4, v4, v4 row_bcast:31 row_mask:0xc bank_mask:0xf
    s_nop 0
    v_readlane_b32 s52, v4, 63
    s_nop 0
    s_add_u32 s53, s53, s52
    v_writelane_b32 v13, s53, 2
    v_subrev_u32 v48, s52, v48
    v_subrev_u32 v49, s52, v49
    v_max_u32 v4, v48, v49
    s_nop 1
    v_max_u32_dpp v4, v4, v4 row_shr:1 row_mask:0xf bank_mask:0xf bound_ctrl:0
    s_nop 1
    v_max_u32_dpp v4, v4, v4 row_shr:2 row_mask:0xf bank_mask:0xf bound_ctrl:0
    s_nop 1
    v_max_u32_dpp v4, v4, v4 row_shr:4 row_mask:0xf bank_mask:0xf bound_ctrl:0
    s_nop 1
    v_max_u32_dpp v4, v4, v4 row_shr:8 row_mask:0xf bank_mask:0xf bound_ctrl:0
    s_nop 1
    v_max_u32_dpp v4, v4, v4 row_bcast:15 row_mask:0xa bank_mask:0xf
    s_nop 1
    v_max_u32_dpp v4, v4, v4 row_bcast:31 row_mask:0xc bank_mask:0xf
    s_nop 0
    v_readlane_b32 s52, v4, 63
    s_nop 0
    s_add_u32 s53, s53, s52
    v_writelane_b32 v13, s53, 3
    v_subrev_u32 v48, s52, v48
    v_subrev_u32 v49, s52, v49
    v_max_u32 v4, v48, v49
    s_nop 1
    v_max_u32_dpp v4, v4, v4 row_shr:1 row_mask:0xf bank_mask:0xf bound_ctrl:0
    s_nop 1
    v_max_u32_dpp v4, v4, v4 row_shr:2 row_mask:0xf bank_mask:0xf bound_ctrl:0
    s_nop 1
    v_max_u32_dpp v4, v4, v4 row_shr:4 row_mask:0xf bank_mask:0xf bound_ctrl:0
    s_nop 1
    v_max_u32_dpp v4, v4, v4 row_shr:8 row_mask:0xf bank_mask:0xf bound_ctrl:0
    s_nop 1
    v_max_u32_dpp v4, v4, v4 row_bcast:15 row_mask:0xa bank_mask:0xf
    s_nop 1
    v_max_u32_dpp v4, v4, v4 row_bcast:31 row_mask:0xc bank_mask:0xf
    s_nop 0
    v_readlane_b32 s52, v4, 63
    s_nop 0
    s_add_u32 s53, s53, s52
    v_writelane_b32 v13, s53, 4
    v_subrev_u32 v48, s52, v48
    v_subrev_u32 v49, s52, v49
    v_max_u32 v4, v48, v49
    s_nop 1
    v_max_u32_dpp v4, v4, v4 row_shr:1 row_mask:0xf bank_mask:0xf bound_ctrl:0
    s_nop 1
    v_max_u32_dpp v4, v4, v4 row_shr:2 row_mask:0xf bank_mask:0xf bound_ctrl:0
    s_nop 1
    v_max_u32_dpp v4, v4, v4 row_shr:4 row_mask:0xf bank_mask:0xf bound_ctrl:0
    s_nop 1
    v_max_u32_dpp v4, v4, v4 row_shr:8 row_mask:0xf bank_mask:0xf bound_ctrl:0
    s_nop 1
    v_max_u32_dpp v4, v4, v4 row_bcast:15 row_mask:0xa bank_mask:0xf
    s_nop 1
    v_max_u32_dpp v4, v4, v4 row_bcast:31 row_mask:0xc bank_mask:0xf
    s_nop 0
    v_readlane_b32 s52, v4, 63
    s_nop 0
    s_add_u32 s53, s53, s52
    v_writelane_b32 v13, s53, 5
    v_subrev_u32 v48, s52, v48
    v_subrev_u32 v49, s52, v49
    v_max_u32 v4, v48, v49
    s_nop 1
    v_max_u32_dpp v4, v4, v4 row_shr:1 row_mask:0xf bank_mask:0xf bound_ctrl:0
    s_nop 1
    v_max_u32_dpp v4, v4, v4 row_shr:2 row_mask:0xf bank_mask:0xf bound_ctrl:0
    s_nop 1
    v_max_u32_dpp v4, v4, v4 row_shr:4 row_mask:0xf bank_mask:0xf bound_ctrl:0
    s_nop 1
    v_max_u32_dpp v4, v4, v4 row_shr:8 row_mask:0xf bank_mask:0xf bound_ctrl:0
    s_nop 1
    v_max_u32_dpp v4, v4, v4 row_bcast:15 row_mask:0xa bank_mask:0xf
    s_nop 1
    v_max_u32_dpp v4, v4, v4 row_bcast:31 row_mask:0xc bank_mask:0xf
    s_nop 0
    v_readlane_b32 s52, v4, 63
    s_nop 0
    s_add_u32 s53, s53, s52
    v_writelane_b32 v13, s53, 6
    v_subrev_u32 v48, s52, v48
    v_subrev_u32 v49, s52, v49
    v_max_u32 v4, v48, v49
    s_nop 1
    v_max_u32_dpp v4, v4, v4 row_shr:1 row_mask:0xf bank_mask:0xf bound_ctrl:0
    s_nop 1
    v_max_u32_dpp v4, v4, v4 row_shr:2 row_mask:0xf bank_mask:0xf bound_ctrl:0
    s_nop 1
    v_max_u32_dpp v4, v4, v4 row_shr:4 row_mask:0xf bank_mask:0xf bound_ctrl:0
    s_nop 1
    v_max_u32_dpp v4, v4, v4 row_shr:8 row_mask:0xf bank_mask:0xf bound_ctrl:0
    s_nop 1
    v_max_u32_dpp v4, v4, v4 row_bcast:15 row_mask:0xa bank_mask:0xf
    s_nop 1
    v_max_u32_dpp v4, v4, v4 row_bcast:31 row_mask:0xc bank_mask:0xf
    s_nop 0
    v_readlane_b32 s52, v4, 63
    s_nop 0
    s_add_u32 s53, s53, s52
    v_writelane_b32 v13, s53, 7
    v_cmp_lt_u32 vcc, s53, v50
    s_cbranch_vccz F_a2k
    s_mov_b32 s53, 0
    s_mov_b32 s52, 0
    s_mov_b32 s64, 0
F_a2f:
    v_subrev_u32 v16, s52, v16
    v_subrev_u32 v17, s52, v17
    v_subrev_u32 v18, s52, v18
    v_subrev_u32 v19, s52, v19
    v_subrev_u32 v20, s52, v20
    v_subrev_u32 v21, s52, v21
    v_subrev_u32 v22, s52, v22
    v_subrev_u32 v23, s52, v23
    v_subrev_u32 v24, s52, v24
    v_subrev_u32 v25, s52, v25
    v_subrev_u32 v26, s52, v26
    v_subrev_u32 v27, s52, v27
    v_subrev_u32 v28, s52, v28
    v_subrev_u32 v29, s52, v29
    v_subrev_u32 v30, s52, v30
    v_subrev_u32 v31, s52, v31
    v_subrev_u32 v32, s52, v32
    v_subrev_u32 v33, s52, v33
    v_subrev_u32 v34, s52, v34
    v_subrev_u32 v35, s52, v35
    v_subrev_u32 v36, s52, v36
    v_subrev_u32 v37, s52, v37
    v_subrev_u32 v38, s52, v38
    v_subrev_u32 v39, s52, v39
    v_subrev_u32 v40, s52, v40
    v_subrev_u32 v41, s52, v41
    v_subrev_u32 v42, s52, v42
    v_subrev_u32 v43, s52, v43
    v_subrev_u32 v44, s52, v44
    v_subrev_u32 v45, s52, v45
    v_subrev_u32 v46, s52, v46
    v_subrev_u32 v47, s52, v47
    v_max3_u32 v4, v16, v17, v18
    v_max3_u32 v12, v19, v20, v21
    v_max3_u32 v4, v4, v22, v23
    v_max3_u32 v12, v12, v24, v25
    v_max3_u32 v4, v4, v26, v27
    v_max3_u32 v12, v12, v28, v29
    v_max3_u32 v4, v4, v30, v31
    v_max3_u32 v12, v12, v32, v33
    v_max3_u32 v4, v4, v34, v35
    v_max3_u32 v12, v12, v36, v37
    v_max3_u32 v4, v4, v38, v39
    v_max3_u32 v12, v12, v40, v41
    v_max3_u32 v4, v4, v42, v43
    v_max3_u32 v12, v12, v44, v45
    v_max3_u32 v4, v4, v46, v47
    v_max_u32 v4, v4, v12
    s_nop 1
    v_max_u32_dpp v4, v4, v4 row_shr:1 row_mask:0xf bank_mask:0xf bound_ctrl:0
    s_nop 1
    v_max_u32_dpp v4, v4, v4 row_shr:2 row_mask:0xf bank_mask:0xf bound_ctrl:0
    s_nop 1
    v_max_u32_dpp v4, v4, v4 row_shr:4 row_mask:0xf bank_mask:0xf bound_ctrl:0
    s_nop 1
    v_max_u32_dpp v4, v4, v4 row_shr:8 row_mask:0xf bank_mask:0xf bound_ctrl:0
    s_nop 1
    v_max_u32_dpp v4, v4, v4 row_bcast:15 row_mask:0xa bank_mask:0xf
    s_nop 1
    v_max_u32_dpp v4, v4, v4 row_bcast:31 row_mask:0xc bank_mask:0xf
    s_nop 0
    v_readlane_b32 s52, v4, 63
    s_nop 0
    s_add_u32 s53, s53, s52
    s_mov_b32 m0, s64
    v_writelane_b32 v13, s53, m0
    s_cmp_ge_u32 s74, 17
    s_cbranch_scc1 DB_115
    s_barrier
    s_add_u32 s74, s74, 1
DB_115:
    s_add_u32 s64, s64, 1
    s_cmp_lt_u32 s64, 8
    s_cbranch_scc1 F_a2f
F_a2k:
    v_and_b32 v4, 7, v0
    v_lshlrev_b32 v4, 2, v4
    ds_bpermute_b32 v12, v4, v13
    v_lshrrev_b32 v9, 3, v0
    v_lshl_add_u32 v4, v9, 9, v4
    s_mov_b32 s44, 32896
    s_mov_b32 s45, 36992
    s_waitcnt lgkmcnt(0)
    v_or_b32 v12, 0x8000, v12
    buffer_store_dword v12, v4, s[40:43], s44 offen sc0 sc1
    buffer_store_dword v12, v4, s[40:43], s45 offen sc0 sc1

F_a2m:
    s_cmp_ge_u32 s74, 17
    s_cbranch_scc1 DB_116
    s_barrier
    s_add_u32 s74, s74, 1
DB_116:
    s_cmp_lt_u32 s74, 17
    s_cbranch_scc1 F_a2m
    s_add_u32 s91, s78, 0
    s_nop 0
    buffer_load_dwordx4 v[16:19], v160, s[80:83], s91 offen nt
    s_add_u32 s91, s78, 2048
    buffer_load_dwordx4 v[20:23], v160, s[80:83], s91 offen nt
    s_add_u32 s91, s78, 4096
    buffer_load_dwordx4 v[24:27], v160, s[80:83], s91 offen nt
    s_add_u32 s91, s78, 6144
    buffer_load_dwordx4 v[28:31], v160, s[80:83], s91 offen nt
    s_add_u32 s91, s78, 8192
    buffer_load_dwordx4 v[144:147], v160, s[80:83], s91 offen nt
    s_add_u32 s91, s78, 10240
    buffer_load_dwordx4 v[148:151], v160, s[80:83], s91 offen nt
    s_add_u32 s91, s78, 12288
    buffer_load_dwordx4 v[152:155], v160, s[80:83], s91 offen nt
    s_add_u32 s91, s54, 0
    s_nop 0
    buffer_load_dwordx4 v[72:75], v6, s[16:19], s91 offen nt
    s_add_u32 s91, s54, 7168
    buffer_load_dwordx4 v[76:79], v6, s[16:19], s91 offen nt
    s_add_u32 s91, s54, 14336
    buffer_load_dwordx4 v[80:83], v6, s[16:19], s91 offen nt
    s_add_u32 s91, s54, 21504
    buffer_load_dwordx4 v[84:87], v6, s[16:19], s91 offen nt
    s_add_u32 s91, s54, 28672
    buffer_load_dwordx4 v[88:91], v6, s[16:19], s91 offen nt
    s_add_u32 s91, s54, 35840
    buffer_load_dwordx4 v[92:95], v6, s[16:19], s91 offen nt
    s_add_u32 s91, s54, 43008
    buffer_load_dwordx4 v[96:99], v6, s[16:19], s91 offen nt
    s_add_u32 s91, s54, 50176
    buffer_load_dwordx4 v[100:103], v6, s[16:19], s91 offen nt
    s_branch F_aj2
IW_w10:
    s_branch IW_r10
F_a2n:
    s_barrier
    s_cmp_lg_u32 s53, 0
    s_cbranch_scc1 SW_117
    s_call_b64 s[34:35], F_sw0
SW_117:
    s_branch IW_w11
IW_r11:
    s_barrier
    s_cmp_lg_u32 s53, 1
    s_cbranch_scc1 SW_118
    s_call_b64 s[34:35], F_sw0
SW_118:
    s_nop 0
    s_barrier
    s_cmp_lg_u32 s53, 2
    s_cbranch_scc1 SW_119
    s_call_b64 s[34:35], F_sw0
SW_119:
    s_nop 0
    s_barrier
    s_cmp_lg_u32 s53, 3
    s_cbranch_scc1 SW_120
    s_call_b64 s[34:35], F_sw0
SW_120:
    s_nop 0
    s_barrier
    s_nop 0
    s_barrier
    s_nop 0
    s_barrier
    s_add_u32 s91, s54, 0
    buffer_load_dwordx4 v[72:75], v6, s[16:19], s91 offen nt
    s_add_u32 s91, s54, 7168
    buffer_load_dwordx4 v[76:79], v6, s[16:19], s91 offen nt
    s_add_u32 s91, s54, 14336
    buffer_load_dwordx4 v[80:83], v6, s[16:19], s91 offen nt
    s_add_u32 s91, s54, 21504
    buffer_load_dwordx4 v[84:87], v6, s[16:19], s91 offen nt
    s_nop 0
    s_load_dwordx8 s[60:67], s[56:57], 128 glc
    s_barrier
    s_add_u32 s91, s54, 28672
    buffer_load_dwordx4 v[88:91], v6, s[16:19], s91 offen nt
    s_add_u32 s91, s54, 35840
    buffer_load_dwordx4 v[92:95], v6, s[16:19], s91 offen nt
    s_add_u32 s91, s54, 43008
    buffer_load_dwordx4 v[96:99], v6, s[16:19], s91 offen nt
    s_add_u32 s91, s54, 50176
    buffer_load_dwordx4 v[100:103], v6, s[16:19], s91 offen nt
    s_waitcnt lgkmcnt(0)
    s_and_b64 s[44:45], s[60:61], s[62:63]
    s_and_b64 s[44:45], s[44:45], s[64:65]
    s_and_b64 s[44:45], s[44:45], s[66:67]
    s_and_b32 s44, s44, s45
    s_bitcmp1_b32 s44, 15
    s_cbranch_scc0 F_a2q
    s_nop 0
    s_andn2_b32 s60, s60, 0x8000
    v_writelane_b32 v12, s60, 0
    s_andn2_b32 s61, s61, 0x8000
    v_writelane_b32 v12, s61, 1
    s_andn2_b32 s62, s62, 0x8000
    v_writelane_b32 v12, s62, 2
    s_andn2_b32 s63, s63, 0x8000
    v_writelane_b32 v12, s63, 3
    s_andn2_b32 s64, s64, 0x8000
    v_writelane_b32 v12, s64, 4
    s_andn2_b32 s65, s65, 0x8000
    v_writelane_b32 v12, s65, 5
    s_andn2_b32 s66, s66, 0x8000
    v_writelane_b32 v12, s66, 6
    s_andn2_b32 s67, s67, 0x8000
    v_writelane_b32 v12, s67, 7
    v_add_u32 v4, 158976, v3
    s_mov_b64 exec, 0xff
    ds_write_b32 v4, v12
    s_mov_b64 exec, -1
    v_mov_b32 v4, 1
    s_mov_b64 exec, 1
    ds_write_b32 v10, v4 offset:48
    s_mov_b64 exec, -1
    s_waitcnt lgkmcnt(0)
    s_mov_b32 s88, 1
F_a2q:
    s_barrier
F_aj:
    s_mov_b32 s74, 0
F_aj2:
    v_and_b32 v13, 3, v0
    v_lshlrev_b32 v13, 2, v13
    v_add_u32 v13, 159040, v13

    s_cmp_lt_u32 s3, 2
    s_mov_b32 s75, 8192
    s_cselect_b32 s75, 0, s75
    s_and_b32 s44, s3, 1
    s_lshl_b32 s44, s44, 12
    s_add_u32 s75, s75, s44
    s_add_u32 s12, s72, 0x900000
    s_addc_u32 s13, s73, 0
    s_mov_b32 s14, 0xe0000
    s_mov_b32 s15, 0x00020000
    s_mov_b32 s47, s10
    v_mov_b32 v4, 159096
    ds_read_b32 v9, v4
    s_waitcnt lgkmcnt(0)
    v_readfirstlane_b32 s79, v9
    s_nop 0
    s_cmp_eq_u32 s79, 0
    s_cbranch_scc1 F_xe
    v_and_b32 v4, 7, v0
    v_lshlrev_b32 v4, 2, v4
    v_add_u32 v4, 158976, v4
    ds_read_b32 v4, v4
    s_waitcnt lgkmcnt(0)
    v_and_b32 v4, 0x7ff, v4
    v_sub_u32 v4, 2047, v4
    v_and_b32 v11, 7, v4
    v_lshrrev_b32 v9, 3, v4
    v_lshlrev_b32 v9, 7, v9
    v_lshl_add_u32 v9, v11, 3, v9
    v_lshlrev_b32 v4, 11, v4
    v_lshl_add_u32 v4, v5, 4, v4
    buffer_load_dwordx4 v[64:67], v4, s[20:23], s55 offen
    buffer_load_dwordx4 v[68:71], v4, s[20:23], s55 offen offset:64
    buffer_load_dwordx2 v[14:15], v9, s[40:43], 0 offen sc0 sc1

F_xe:
    s_cmp_lg_u32 s74, 0
    s_cbranch_scc1 JB_121
    s_barrier
JB_121:
    s_setprio 1
    s_cmp_lg_u32 s79, 0
    s_cbranch_scc1 F_xd
    s_cmp_lg_u32 s88, 2
    s_cbranch_scc1 F_se
F_sc:
    s_load_dwordx8 s[60:67], s[56:57], 128 glc
    s_waitcnt lgkmcnt(0)
    s_and_b64 s[44:45], s[60:61], s[62:63]
    s_and_b64 s[44:45], s[44:45], s[64:65]
    s_and_b64 s[44:45], s[44:45], s[66:67]
    s_and_b32 s44, s44, s45
    s_bitcmp1_b32 s44, 15
    s_cbranch_scc1 F_sd
    s_sleep 4
    s_branch F_sc
F_sd:
    s_andn2_b32 s60, s60, 0x8000
    v_writelane_b32 v12, s60, 0
    s_andn2_b32 s61, s61, 0x8000
    v_writelane_b32 v12, s61, 1
    s_andn2_b32 s62, s62, 0x8000
    v_writelane_b32 v12, s62, 2
    s_andn2_b32 s63, s63, 0x8000
    v_writelane_b32 v12, s63, 3
    s_andn2_b32 s64, s64, 0x8000
    v_writelane_b32 v12, s64, 4
    s_andn2_b32 s65, s65, 0x8000
    v_writelane_b32 v12, s65, 5
    s_andn2_b32 s66, s66, 0x8000
    v_writelane_b32 v12, s66, 6
    s_andn2_b32 s67, s67, 0x8000
    v_writelane_b32 v12, s67, 7
    v_add_u32 v4, 158976, v3
    s_mov_b64 exec, 0xff
    ds_write_b32 v4, v12
    s_mov_b64 exec, -1
    v_mov_b32 v4, 1
    s_mov_b64 exec, 1
    ds_write_b32 v10, v4 offset:48
    s_mov_b64 exec, -1
F_se:
    v_mov_b32 v4, 159096
    ds_read_b32 v9, v4 offset:0
FW_122:
    s_waitcnt lgkmcnt(0)
    v_cmp_gt_u32 vcc, 1, v9
    s_cbranch_vccz FO_123
    s_sleep 1
    ds_read_b32 v9, v4 offset:0
    s_branch FW_122
FO_123:
    v_and_b32 v4, 7, v0
    v_lshlrev_b32 v4, 2, v4
    v_add_u32 v4, 158976, v4
    ds_read_b32 v4, v4
    s_waitcnt lgkmcnt(0)
    v_and_b32 v4, 0x7ff, v4
    v_sub_u32 v4, 2047, v4
    v_and_b32 v11, 7, v4
    v_lshrrev_b32 v9, 3, v4
    v_lshlrev_b32 v9, 7, v9
    v_lshl_add_u32 v9, v11, 3, v9
    v_lshlrev_b32 v4, 11, v4
    v_lshl_add_u32 v4, v5, 4, v4
    buffer_load_dwordx4 v[64:67], v4, s[20:23], s55 offen
    buffer_load_dwordx4 v[68:71], v4, s[20:23], s55 offen offset:64
    buffer_load_dwordx2 v[14:15], v9, s[40:43], 0 offen sc0 sc1

F_xd:
    ds_read_b32 v9, v13 offset:32
FW_124:
    s_waitcnt lgkmcnt(0)
    v_cmp_gt_u32 vcc, 2, v9
    s_cbranch_vccz FO_125
    s_sleep 2
    ds_read_b32 v9, v13 offset:32
    s_branch FW_124
FO_125:
    s_nop 0
    s_add_u32 s45, s54, 229376
    buffer_load_dwordx4 v[104:107], v6, s[16:19], s45 offen nt
    s_add_u32 s45, s54, 236544
    buffer_load_dwordx4 v[108:111], v6, s[16:19], s45 offen nt
    s_add_u32 s45, s54, 243712
    buffer_load_dwordx4 v[112:115], v6, s[16:19], s45 offen nt
    s_add_u32 s45, s54, 250880
    buffer_load_dwordx4 v[116:119], v6, s[16:19], s45 offen nt
    s_waitcnt vmcnt(14)
    s_add_u32 s45, s54, 258048
    buffer_load_dwordx4 v[120:123], v6, s[16:19], s45 offen nt
    s_waitcnt vmcnt(14)
    s_add_u32 s45, s54, 265216
    buffer_load_dwordx4 v[124:127], v6, s[16:19], s45 offen nt
    s_waitcnt vmcnt(14)
    s_add_u32 s45, s54, 272384
    buffer_load_dwordx4 v[128:131], v6, s[16:19], s45 offen nt
    s_waitcnt vmcnt(14)
    s_add_u32 s45, s54, 279552
    buffer_load_dwordx4 v[132:135], v6, s[16:19], s45 offen nt
    v_mov_b32 v4, 1
    s_mov_b64 exec, 1
    ds_write_b32 v10, v4 offset:176
    s_mov_b64 exec, -1
    s_mov_b32 s52, 0x05040100
    s_mov_b32 s53, 0x07060302
    s_setprio 2
    s_cmp_ge_u32 s89, 224
    s_cbranch_scc1 F_adown
    s_waitcnt vmcnt(8)
    v_lshlrev_b32 v34, 16, v64
    v_and_b32 v35, 0xffff0000, v64
    v_lshlrev_b32 v36, 16, v65
    v_and_b32 v37, 0xffff0000, v65
    v_lshlrev_b32 v38, 16, v66
    v_and_b32 v39, 0xffff0000, v66
    v_lshlrev_b32 v40, 16, v67
    v_and_b32 v41, 0xffff0000, v67
    v_lshlrev_b32 v42, 16, v68
    v_and_b32 v43, 0xffff0000, v68
    v_lshlrev_b32 v44, 16, v69
    v_and_b32 v45, 0xffff0000, v69
    v_lshlrev_b32 v46, 16, v70
    v_and_b32 v47, 0xffff0000, v70
    v_lshlrev_b32 v48, 16, v71
    v_and_b32 v49, 0xffff0000, v71
    v_add_f32 v34, v34, v14
    v_add_f32 v35, v35, v14
    v_add_f32 v36, v36, v14
    v_add_f32 v37, v37, v14
    v_add_f32 v38, v38, v14
    v_add_f32 v39, v39, v14
    v_add_f32 v40, v40, v14
    v_add_f32 v41, v41, v14
    v_add_f32 v42, v42, v14
    v_add_f32 v43, v43, v14
    v_add_f32 v44, v44, v14
    v_add_f32 v45, v45, v14
    v_add_f32 v46, v46, v14
    v_add_f32 v47, v47, v14
    v_add_f32 v48, v48, v14
    v_add_f32 v49, v49, v14
    v_cvt_pk_bf16_f32 v64, v34, v35
    v_cvt_pk_bf16_f32 v65, v36, v37
    v_cvt_pk_bf16_f32 v66, v38, v39
    v_cvt_pk_bf16_f32 v67, v40, v41
    v_cvt_pk_bf16_f32 v68, v42, v43
    v_cvt_pk_bf16_f32 v69, v44, v45
    v_cvt_pk_bf16_f32 v70, v46, v47
    v_cvt_pk_bf16_f32 v71, v48, v49
    v_lshlrev_b32 v34, 16, v64
    v_and_b32 v35, 0xffff0000, v64
    v_lshlrev_b32 v36, 16, v65
    v_and_b32 v37, 0xffff0000, v65
    v_lshlrev_b32 v38, 16, v66
    v_and_b32 v39, 0xffff0000, v66
    v_lshlrev_b32 v40, 16, v67
    v_and_b32 v41, 0xffff0000, v67
    v_lshlrev_b32 v42, 16, v68
    v_and_b32 v43, 0xffff0000, v68
    v_lshlrev_b32 v44, 16, v69
    v_and_b32 v45, 0xffff0000, v69
    v_lshlrev_b32 v46, 16, v70
    v_and_b32 v47, 0xffff0000, v70
    v_lshlrev_b32 v48, 16, v71
    v_and_b32 v49, 0xffff0000, v71
    v_mul_f32 v34, v34, v15
    v_mul_f32 v35, v35, v15
    v_mul_f32 v36, v36, v15
    v_mul_f32 v37, v37, v15
    v_mul_f32 v38, v38, v15
    v_mul_f32 v39, v39, v15
    v_mul_f32 v40, v40, v15
    v_mul_f32 v41, v41, v15
    v_mul_f32 v42, v42, v15
    v_mul_f32 v43, v43, v15
    v_mul_f32 v44, v44, v15
    v_mul_f32 v45, v45, v15
    v_mul_f32 v46, v46, v15
    v_mul_f32 v47, v47, v15
    v_mul_f32 v48, v48, v15
    v_mul_f32 v49, v49, v15
    v_cvt_pk_bf16_f32 v64, v34, v35
    v_cvt_pk_bf16_f32 v65, v36, v37
    v_cvt_pk_bf16_f32 v66, v38, v39
    v_cvt_pk_bf16_f32 v67, v40, v41
    v_cvt_pk_bf16_f32 v68, v42, v43
    v_cvt_pk_bf16_f32 v69, v44, v45
    v_cvt_pk_bf16_f32 v70, v46, v47
    v_cvt_pk_bf16_f32 v71, v48, v49
    s_waitcnt vmcnt(8)
    v_perm_b32 v136, v76, v72, s52
    v_perm_b32 v137, v84, v80, s52
    v_perm_b32 v138, v92, v88, s52
    v_perm_b32 v139, v100, v96, s52
    s_nop 1
    v_mfma_f32_16x16x32_bf16 v[32:35], v[64:67], v[136:139], 0
    v_perm_b32 v140, v76, v72, s53
    v_perm_b32 v141, v84, v80, s53
    v_perm_b32 v142, v92, v88, s53
    v_perm_b32 v143, v100, v96, s53
    s_nop 1
    v_mfma_f32_16x16x32_bf16 v[36:39], v[64:67], v[140:143], 0
    v_perm_b32 v136, v77, v73, s52
    v_perm_b32 v137, v85, v81, s52
    v_perm_b32 v138, v93, v89, s52
    v_perm_b32 v139, v101, v97, s52
    s_nop 1
    v_mfma_f32_16x16x32_bf16 v[40:43], v[64:67], v[136:139], 0
    v_perm_b32 v140, v77, v73, s53
    v_perm_b32 v141, v85, v81, s53
    v_perm_b32 v142, v93, v89, s53
    v_perm_b32 v143, v101, v97, s53
    s_nop 1
    v_mfma_f32_16x16x32_bf16 v[44:47], v[64:67], v[140:143], 0
    v_perm_b32 v136, v78, v74, s52
    v_perm_b32 v137, v86, v82, s52
    v_perm_b32 v138, v94, v90, s52
    v_perm_b32 v139, v102, v98, s52
    s_nop 1
    v_mfma_f32_16x16x32_bf16 v[48:51], v[64:67], v[136:139], 0
    v_perm_b32 v140, v78, v74, s53
    v_perm_b32 v141, v86, v82, s53
    v_perm_b32 v142, v94, v90, s53
    v_perm_b32 v143, v102, v98, s53
    s_nop 1
    v_mfma_f32_16x16x32_bf16 v[52:55], v[64:67], v[140:143], 0
    v_perm_b32 v136, v79, v75, s52
    v_perm_b32 v137, v87, v83, s52
    v_perm_b32 v138, v95, v91, s52
    v_perm_b32 v139, v103, v99, s52
    s_nop 1
    v_mfma_f32_16x16x32_bf16 v[56:59], v[64:67], v[136:139], 0
    v_perm_b32 v140, v79, v75, s53
    v_perm_b32 v141, v87, v83, s53
    v_perm_b32 v142, v95, v91, s53
    v_perm_b32 v143, v103, v99, s53
    s_nop 1
    v_mfma_f32_16x16x32_bf16 v[60:63], v[64:67], v[140:143], 0
    s_waitcnt vmcnt(0)
    v_perm_b32 v136, v108, v104, s52
    v_perm_b32 v137, v116, v112, s52
    v_perm_b32 v138, v124, v120, s52
    v_perm_b32 v139, v132, v128, s52
    s_nop 1
    v_mfma_f32_16x16x32_bf16 v[32:35], v[68:71], v[136:139], v[32:35]
    v_perm_b32 v140, v108, v104, s53
    v_perm_b32 v141, v116, v112, s53
    v_perm_b32 v142, v124, v120, s53
    v_perm_b32 v143, v132, v128, s53
    s_nop 1
    v_mfma_f32_16x16x32_bf16 v[36:39], v[68:71], v[140:143], v[36:39]
    v_perm_b32 v136, v109, v105, s52
    v_perm_b32 v137, v117, v113, s52
    v_perm_b32 v138, v125, v121, s52
    v_perm_b32 v139, v133, v129, s52
    s_nop 1
    v_mfma_f32_16x16x32_bf16 v[40:43], v[68:71], v[136:139], v[40:43]
    v_perm_b32 v140, v109, v105, s53
    v_perm_b32 v141, v117, v113, s53
    v_perm_b32 v142, v125, v121, s53
    v_perm_b32 v143, v133, v129, s53
    s_nop 1
    v_mfma_f32_16x16x32_bf16 v[44:47], v[68:71], v[140:143], v[44:47]
    v_perm_b32 v136, v110, v106, s52
    v_perm_b32 v137, v118, v114, s52
    v_perm_b32 v138, v126, v122, s52
    v_perm_b32 v139, v134, v130, s52
    s_nop 1
    v_mfma_f32_16x16x32_bf16 v[48:51], v[68:71], v[136:139], v[48:51]
    v_perm_b32 v140, v110, v106, s53
    v_perm_b32 v141, v118, v114, s53
    v_perm_b32 v142, v126, v122, s53
    v_perm_b32 v143, v134, v130, s53
    s_nop 1
    v_mfma_f32_16x16x32_bf16 v[52:55], v[68:71], v[140:143], v[52:55]
    v_perm_b32 v136, v111, v107, s52
    v_perm_b32 v137, v119, v115, s52
    v_perm_b32 v138, v127, v123, s52
    v_perm_b32 v139, v135, v131, s52
    s_nop 1
    v_mfma_f32_16x16x32_bf16 v[56:59], v[68:71], v[136:139], v[56:59]
    v_perm_b32 v140, v111, v107, s53
    s_branch IW_s11
IW_w11:
    s_branch IW_r11
IW_s11:
    v_perm_b32 v141, v119, v115, s53
    v_perm_b32 v142, v127, v123, s53
    v_perm_b32 v143, v135, v131, s53
    s_nop 1
    v_mfma_f32_16x16x32_bf16 v[60:63], v[68:71], v[140:143], v[60:63]
    ds_read_b32 v9, v13 offset:0
FW_126:
    s_waitcnt lgkmcnt(0)
    v_cmp_gt_u32 vcc, 2, v9
    s_cbranch_vccz FO_127
    s_sleep 1
    ds_read_b32 v9, v13 offset:0
    s_branch FW_126
FO_127:
    v_xor_b32 v4, v7, v5
    v_lshlrev_b32 v4, 4, v4
    v_lshl_add_u32 v4, v5, 8, v4
    v_add_u32 v4, s75, v4

    v_xor_b32 v73, 32, v4
    v_xor_b32 v74, 64, v4
    v_xor_b32 v75, 96, v4
    v_xor_b32 v76, 128, v4
    v_xor_b32 v77, 160, v4
    v_xor_b32 v78, 192, v4
    v_xor_b32 v79, 224, v4
    s_mov_b32 exec_hi, 0
    s_nop 0
    ds_write_b128 v4, v[32:35] offset:0
    ds_write_b128 v73, v[36:39] offset:512
    ds_write_b128 v74, v[40:43] offset:1024
    ds_write_b128 v75, v[44:47] offset:1536
    ds_write_b128 v76, v[48:51] offset:2048
    ds_write_b128 v77, v[52:55] offset:2560
    ds_write_b128 v78, v[56:59] offset:3072
    ds_write_b128 v79, v[60:63] offset:3584
    s_mov_b64 exec, -1
    v_mov_b32 v4, 1
    s_mov_b64 exec, 1
    ds_write_b32 v10, v4 offset:64
    s_mov_b64 exec, -1
    ds_read_b32 v12, v13 offset:64
FW_128:
    s_waitcnt lgkmcnt(0)
    v_cmp_gt_u32 vcc, 1, v12
    s_cbranch_vccz FO_129
    s_sleep 1
    ds_read_b32 v12, v13 offset:64
    s_branch FW_128
FO_129:
    s_lshl_b32 s44, s3, 2
    v_add_u32 v4, s44, v5
    v_xor_b32 v4, v4, v7
    v_lshlrev_b32 v4, 4, v4
    v_lshl_add_u32 v4, v7, 8, v4
    v_add_u32 v4, 0, v4
    s_lshl_b32 s44, s3, 10
    s_lshl_b32 s77, s36, 1
    s_add_u32 s77, s77, s37
    s_mul_i32 s77, s77, 114688
    s_lshl_b32 s46, s38, 12
    s_add_u32 s77, s77, s46
    s_add_u32 s77, s77, s44
    s_lshl_b32 s46, s38, 9
    v_mov_b32 v9, 159148
    v_mov_b32 v11, 1

    s_add_u32 s56, s46, 0x829000
    s_add_u32 s56, s72, s56
    s_addc_u32 s57, s73, 0
    ds_read_b128 v[72:75], v4 offset:0
    ds_read_b128 v[76:79], v4 offset:4096
    ds_read_b128 v[80:83], v4 offset:8192
    ds_read_b128 v[84:87], v4 offset:12288
    s_waitcnt lgkmcnt(0)
    v_add_f32 v72, v72, v76
    v_add_f32 v80, v80, v84
    v_add_f32 v73, v73, v77
    v_add_f32 v81, v81, v85
    v_add_f32 v74, v74, v78
    v_add_f32 v82, v82, v86
    v_add_f32 v75, v75, v79
    v_add_f32 v83, v83, v87
    v_add_f32 v72, v72, v80
    v_add_f32 v73, v73, v81
    v_add_f32 v74, v74, v82
    v_add_f32 v75, v75, v83
    buffer_store_dwordx4 v[72:75], v2, s[12:15], s77 offen sc0 sc1
    v_mov_b32 v4, 2
    s_mov_b64 exec, 1
    ds_write_b32 v10, v4 offset:64
    s_mov_b64 exec, -1
    s_waitcnt vmcnt(0)
    s_mov_b64 exec, 1
    ds_add_rtn_u32 v9, v9, v11
    s_waitcnt lgkmcnt(0)
    v_readfirstlane_b32 s44, v9
    s_mov_b64 exec, -1
    s_cmp_lg_u32 s44, 3
    s_cbranch_scc1 F_ad2

    s_mov_b32 s44, 1
    s_atomic_add s44, s[56:57], 0x0
    s_atomic_add s44, s[56:57], 0x80
    s_atomic_add s44, s[56:57], 0x100
    s_atomic_add s44, s[56:57], 0x180
    s_branch F_ad2
F_adown:
    ds_read_b32 v9, v13 offset:0
FW_130:
    s_waitcnt lgkmcnt(0)
    v_cmp_gt_u32 vcc, 2, v9
    s_cbranch_vccz FO_131
    s_sleep 1
    ds_read_b32 v9, v13 offset:0
    s_branch FW_130
FO_131:
    v_mov_b32 v4, 2
    s_mov_b64 exec, 1
    ds_write_b32 v10, v4 offset:64
    s_mov_b64 exec, -1
F_ad2:
    s_setprio 3
    v_min_u32 v4, 55, v0
    v_lshlrev_b32 v4, 4, v4
    s_lshl_b32 s38, s47, 5
    s_and_b32 s46, s39, 3
    s_lshr_b32 s44, s47, 7
    s_lshl_b32 s44, s44, 2
    s_add_u32 s44, s44, s46
    s_lshl_b32 s44, s44, 7
    s_add_u32 s45, s47, 111
    s_lshr_b32 s45, s45, 7
    s_lshl_b32 s45, s45, 2
    s_add_u32 s45, s45, s46
    s_lshl_b32 s45, s45, 7
    s_waitcnt lgkmcnt(0)

    s_add_u32 s56, s44, 0x829000
    s_add_u32 s56, s72, s56
    s_addc_u32 s57, s73, 0
    s_add_u32 s58, s45, 0x829000
    s_add_u32 s58, s72, s58
    s_addc_u32 s59, s73, 0
    v_mov_b32 v156, 0
    v_mov_b32 v157, 0
    v_mov_b32 v158, 0
    v_mov_b32 v159, 0
    s_mov_b32 s48, 0xbfb8aa3b
    ds_read_b32 v12, v13 offset:64
FW_132:
    s_waitcnt lgkmcnt(0)
    v_cmp_gt_u32 vcc, 2, v12
    s_cbranch_vccz FO_133
    s_sleep 1
    ds_read_b32 v12, v13 offset:64
    s_branch FW_132
FO_133:
    s_mov_b32 s44, s75
    v_lshlrev_b32 v9, 3, v0
    v_add_u32 v9, s44, v9
    ds_write_b64 v9, v[156:157]
    v_lshrrev_b32 v11, 1, v0
    v_mul_u32_u24 v9, 37, v11
    v_lshrrev_b32 v9, 8, v9
    v_add_u32 v11, v11, v9
    v_lshlrev_b32 v11, 1, v11
    v_and_b32 v9, 1, v0
    v_lshl_add_u32 v11, v9, 8, v11
    v_add_u32 v11, s44, v11
    v_and_b32 v9, 7, v0
    v_lshlrev_b32 v9, 6, v9
    v_lshl_add_u32 v9, v5, 4, v9
    v_add_u32 v9, s44, v9

    s_cmp_lg_u32 s3, 0
    s_cbranch_scc1 F_pp
SP_134:
    s_load_dword s76, s[56:57], 0 glc
    s_waitcnt lgkmcnt(0)
    s_cmp_ge_u32 s76, 8
    s_cbranch_scc1 SD_135
    s_sleep 2
    s_branch SP_134
SD_135:
SP_136:
    s_load_dword s76, s[58:59], 0 glc
    s_waitcnt lgkmcnt(0)
    s_cmp_ge_u32 s76, 8
    s_cbranch_scc1 SD_137
    s_sleep 2
    s_branch SP_136
SD_137:
    v_mov_b32 v12, 3
    s_mov_b64 exec, 1
    ds_write_b32 v10, v12 offset:64
    s_mov_b64 exec, -1
F_pp:
    v_mov_b32 v8, 159104
    ds_read_b32 v12, v8 offset:0
FW_138:
    s_waitcnt lgkmcnt(0)
    v_cmp_gt_u32 vcc, 3, v12
    s_cbranch_vccz FO_139
    s_sleep 1
    ds_read_b32 v12, v8 offset:0
    s_branch FW_138
FO_139:
    s_add_u32 s45, s38, 0
    buffer_load_dwordx4 v[32:35], v4, s[12:15], s45 offen sc0 sc1
    s_add_u32 s45, s38, 114688
    buffer_load_dwordx4 v[36:39], v4, s[12:15], s45 offen sc0 sc1
    s_add_u32 s45, s38, 229376
    buffer_load_dwordx4 v[40:43], v4, s[12:15], s45 offen sc0 sc1
    s_add_u32 s45, s38, 344064
    buffer_load_dwordx4 v[44:47], v4, s[12:15], s45 offen sc0 sc1
    s_add_u32 s45, s38, 458752
    buffer_load_dwordx4 v[48:51], v4, s[12:15], s45 offen sc0 sc1
    s_add_u32 s45, s38, 573440
    buffer_load_dwordx4 v[52:55], v4, s[12:15], s45 offen sc0 sc1
    s_add_u32 s45, s38, 688128
    buffer_load_dwordx4 v[56:59], v4, s[12:15], s45 offen sc0 sc1
    s_add_u32 s45, s38, 802816
    buffer_load_dwordx4 v[60:63], v4, s[12:15], s45 offen sc0 sc1
    s_waitcnt vmcnt(0)
    v_add_f32 v32, v32, v40
    v_add_f32 v48, v48, v56
    v_add_f32 v33, v33, v41
    v_add_f32 v49, v49, v57
    v_add_f32 v34, v34, v42
    v_add_f32 v50, v50, v58
    v_add_f32 v35, v35, v43
    v_add_f32 v51, v51, v59
    v_add_f32 v32, v32, v48
    v_add_f32 v33, v33, v49
    v_add_f32 v34, v34, v50
    v_add_f32 v35, v35, v51
    v_add_f32 v36, v36, v44
    v_add_f32 v52, v52, v60
    v_add_f32 v37, v37, v45
    v_add_f32 v53, v53, v61
    v_add_f32 v38, v38, v46
    v_add_f32 v54, v54, v62
    v_add_f32 v39, v39, v47
    v_add_f32 v55, v55, v63
    v_add_f32 v36, v36, v52
    v_add_f32 v37, v37, v53
    v_add_f32 v38, v38, v54
    v_add_f32 v39, v39, v55
    v_cvt_pk_bf16_f32 v40, v32, v36
    v_cvt_pk_bf16_f32 v41, v33, v37
    v_cvt_pk_bf16_f32 v42, v34, v38
    v_cvt_pk_bf16_f32 v43, v35, v39
    v_lshlrev_b32 v32, 16, v40
    v_and_b32 v36, 0xffff0000, v40
    v_lshlrev_b32 v33, 16, v41
    v_and_b32 v37, 0xffff0000, v41
    v_lshlrev_b32 v34, 16, v42
    v_and_b32 v38, 0xffff0000, v42
    v_lshlrev_b32 v35, 16, v43
    v_and_b32 v39, 0xffff0000, v43
    v_mul_f32 v40, s48, v32
    v_mul_f32 v41, s48, v33
    v_mul_f32 v42, s48, v34
    v_mul_f32 v43, s48, v35
    v_exp_f32 v40, v40
    v_exp_f32 v41, v41
    v_exp_f32 v42, v42
    v_exp_f32 v43, v43
    v_add_f32 v40, 1.0, v40
    v_add_f32 v41, 1.0, v41
    v_add_f32 v42, 1.0, v42
    v_add_f32 v43, 1.0, v43
    v_rcp_f32 v40, v40
    v_rcp_f32 v41, v41
    v_rcp_f32 v42, v42
    v_rcp_f32 v43, v43
    v_mul_f32 v32, v32, v40
    v_mul_f32 v33, v33, v41
    v_mul_f32 v34, v34, v42
    v_mul_f32 v35, v35, v43
    v_cvt_pk_bf16_f32 v32, v32, v32
    v_cvt_pk_bf16_f32 v33, v33, v33
    v_cvt_pk_bf16_f32 v34, v34, v34
    v_cvt_pk_bf16_f32 v35, v35, v35
    v_lshlrev_b32 v32, 16, v32
    v_lshlrev_b32 v33, 16, v33
    v_lshlrev_b32 v34, 16, v34
    v_lshlrev_b32 v35, 16, v35
    v_mul_f32 v32, v32, v36
    v_mul_f32 v33, v33, v37
    v_mul_f32 v34, v34, v38
    v_mul_f32 v35, v35, v39
    v_cvt_pk_bf16_f32 v32, v32, v32
    v_cvt_pk_bf16_f32 v33, v33, v33
    v_cvt_pk_bf16_f32 v34, v34, v34
    v_cvt_pk_bf16_f32 v35, v35, v35
    v_cmp_gt_u32 vcc, 56, v0
    s_nop 0
    s_and_saveexec_b64 s[44:45], vcc
    ds_write_b16 v11, v32 offset:0
    ds_write_b16 v11, v33 offset:64
    ds_write_b16 v11, v34 offset:128
    ds_write_b16 v11, v35 offset:192
    s_mov_b64 exec, s[44:45]
    ds_read_b128 v[64:67], v9
    s_waitcnt lgkmcnt(0)
    v_perm_b32 v136, v20, v16, s52
    v_perm_b32 v137, v28, v24, s52
    v_perm_b32 v138, v148, v144, s52
    v_perm_b32 v139, v156, v152, s52
    s_nop 1
    v_mfma_f32_16x16x32_bf16 v[104:107], v[64:67], v[136:139], 0
    v_perm_b32 v140, v20, v16, s53
    v_perm_b32 v141, v28, v24, s53
    v_perm_b32 v142, v148, v144, s53
    v_perm_b32 v143, v156, v152, s53
    s_nop 1
    v_mfma_f32_16x16x32_bf16 v[108:111], v[64:67], v[140:143], 0
    v_perm_b32 v136, v21, v17, s52
    v_perm_b32 v137, v29, v25, s52
    v_perm_b32 v138, v149, v145, s52
    v_perm_b32 v139, v157, v153, s52
    s_nop 1
    v_mfma_f32_16x16x32_bf16 v[112:115], v[64:67], v[136:139], 0
    v_perm_b32 v140, v21, v17, s53
    v_perm_b32 v141, v29, v25, s53
    v_perm_b32 v142, v149, v145, s53
    v_perm_b32 v143, v157, v153, s53
    s_nop 1
    v_mfma_f32_16x16x32_bf16 v[116:119], v[64:67], v[140:143], 0
    v_perm_b32 v136, v22, v18, s52
    v_perm_b32 v137, v30, v26, s52
    v_perm_b32 v138, v150, v146, s52
    v_perm_b32 v139, v158, v154, s52
    s_nop 1
    v_mfma_f32_16x16x32_bf16 v[120:123], v[64:67], v[136:139], 0
    v_perm_b32 v140, v22, v18, s53
    v_perm_b32 v141, v30, v26, s53
    v_perm_b32 v142, v150, v146, s53
    v_perm_b32 v143, v158, v154, s53
    s_nop 1
    v_mfma_f32_16x16x32_bf16 v[124:127], v[64:67], v[140:143], 0
    v_perm_b32 v136, v23, v19, s52
    v_perm_b32 v137, v31, v27, s52
    v_perm_b32 v138, v151, v147, s52
    v_perm_b32 v139, v159, v155, s52
    s_nop 1
    v_mfma_f32_16x16x32_bf16 v[128:131], v[64:67], v[136:139], 0
    v_perm_b32 v140, v23, v19, s53
    v_perm_b32 v141, v31, v27, s53
    v_perm_b32 v142, v151, v147, s53
    v_perm_b32 v143, v159, v155, s53
    s_nop 1
    v_mfma_f32_16x16x32_bf16 v[132:135], v[64:67], v[140:143], 0
    s_mov_b32 s44, s75
    v_and_b32 v4, 1, v5
    v_lshlrev_b32 v4, 11, v4
    v_lshl_add_u32 v4, v7, 5, v4
    v_lshrrev_b32 v8, 1, v5
    v_lshl_add_u32 v4, v8, 4, v4
    v_add_u32 v4, s44, v4
    v_cmp_gt_u32 vcc, 32, v0

    s_nop 1
    v_cndmask_b32 v72, v120, v104, vcc
    v_cndmask_b32 v73, v124, v108, vcc
    v_cndmask_b32 v74, v128, v112, vcc
    v_cndmask_b32 v75, v132, v116, vcc
    ds_write_b128 v4, v[72:75] offset:0
    v_cndmask_b32 v76, v121, v105, vcc
    v_cndmask_b32 v77, v125, v109, vcc
    v_cndmask_b32 v78, v129, v113, vcc
    v_cndmask_b32 v79, v133, v117, vcc
    ds_write_b128 v4, v[76:79] offset:512
    v_cndmask_b32 v80, v122, v106, vcc
    v_cndmask_b32 v81, v126, v110, vcc
    v_cndmask_b32 v82, v130, v114, vcc
    v_cndmask_b32 v83, v134, v118, vcc
    ds_write_b128 v4, v[80:83] offset:1024
    v_cndmask_b32 v84, v123, v107, vcc
    v_cndmask_b32 v85, v127, v111, vcc
    v_cndmask_b32 v86, v131, v115, vcc
    v_cndmask_b32 v87, v135, v119, vcc
    ds_write_b128 v4, v[84:87] offset:1536
    v_mov_b32 v4, 1
    s_mov_b64 exec, 1
    ds_write_b32 v10, v4 offset:80
    s_mov_b64 exec, -1
    ds_read_b32 v12, v13 offset:80
FW_140:
    s_waitcnt lgkmcnt(0)
    v_cmp_gt_u32 vcc, 1, v12
    s_cbranch_vccz FO_141
    s_sleep 1
    ds_read_b32 v12, v13 offset:80
    s_branch FW_140
FO_141:
    s_lshl_b32 s44, s3, 10
    s_add_u32 s44, s44, 0
    v_add_u32 v4, s44, v3
    ds_read_b32 v32, v4 offset:0
    ds_read_b32 v33, v4 offset:256
    ds_read_b32 v34, v4 offset:512
    ds_read_b32 v35, v4 offset:768
    ds_read_b32 v36, v4 offset:4096
    ds_read_b32 v37, v4 offset:4352
    ds_read_b32 v38, v4 offset:4608
    ds_read_b32 v39, v4 offset:4864
    ds_read_b32 v40, v4 offset:8192
    ds_read_b32 v41, v4 offset:8448
    ds_read_b32 v42, v4 offset:8704
    ds_read_b32 v43, v4 offset:8960
    ds_read_b32 v44, v4 offset:12288
    ds_read_b32 v45, v4 offset:12544
    ds_read_b32 v46, v4 offset:12800
    s_waitcnt lgkmcnt(8)
    ds_read_b32 v47, v4 offset:13056
    s_lshl_b32 s44, s3, 13
    s_lshl_b32 s45, s39, 9
    s_add_u32 s44, s44, s45
    s_add_u32 s44, s44, 135168
    s_add_u32 s45, s44, 4096
    s_lshl_b32 s46, s39, 9
    s_waitcnt lgkmcnt(0)

    s_add_u32 s56, s46, 0x839000
    s_add_u32 s56, s72, s56
    s_addc_u32 s57, s73, 0
    v_add_f32 v32, v32, v36
    v_add_f32 v40, v40, v44
    v_add_f32 v33, v33, v37
    v_add_f32 v41, v41, v45
    v_add_f32 v34, v34, v38
    v_add_f32 v42, v42, v46
    v_add_f32 v35, v35, v39
    v_add_f32 v43, v43, v47
    v_add_f32 v32, v32, v40
    buffer_atomic_add_f32 v32, v3, s[24:27], s44 offen offset:0
    v_add_f32 v33, v33, v41
    buffer_atomic_add_f32 v33, v3, s[24:27], s44 offen offset:256
    v_add_f32 v34, v34, v42
    buffer_atomic_add_f32 v34, v3, s[24:27], s45 offen offset:0
    v_add_f32 v35, v35, v43
    buffer_atomic_add_f32 v35, v3, s[24:27], s45 offen offset:256
    v_mov_b32 v4, 159140
    v_mov_b32 v8, 1
    s_waitcnt vmcnt(0)
    s_mov_b64 exec, 1
    ds_add_rtn_u32 v9, v4, v8
    s_waitcnt lgkmcnt(0)
    v_readfirstlane_b32 s44, v9
    s_mov_b64 exec, -1
    s_cmp_lg_u32 s44, 3
    s_cbranch_scc1 F_ye
    s_mov_b32 s44, 1
    s_atomic_add s44, s[56:57], 0
    s_atomic_add s44, s[56:57], 0x80
    s_atomic_add s44, s[56:57], 0x100
    s_atomic_add s44, s[56:57], 0x180
F_ye:

    s_endpgm
F_codeend:
.section .rodata,"a"
.p2align 6
.amdhsa_kernel parallel_sum__linear_attn_block__moe_arch_mod__prompt_kernel
  .amdhsa_next_free_vgpr 168
  .amdhsa_next_free_sgpr 98
  .amdhsa_accum_offset 168
  .amdhsa_group_segment_fixed_size 0
  .amdhsa_kernarg_size 88
  .amdhsa_user_sgpr_count 2
  .amdhsa_user_sgpr_kernarg_segment_ptr 1
  .amdhsa_system_sgpr_workgroup_id_x 1
  .amdhsa_float_denorm_mode_32 3
  .amdhsa_float_denorm_mode_16_64 3
.end_amdhsa_kernel
```

```asm
; @launch grid=(256,1,1) block=(768,1,1) lds=163840
.amdgcn_target "amdgcn-amd-amdhsa--gfx950"
.text
.globl parallel_sum__linear_attn_block__moe_arch_mod__prompt_kernel
.p2align 12
.p2align 8
.type parallel_sum__linear_attn_block__moe_arch_mod__prompt_kernel,@function
parallel_sum__linear_attn_block__moe_arch_mod__prompt_kernel:
    s_load_dwordx4 s[4:7], s[0:1], 0
    s_load_dwordx2 s[8:9], s[0:1], 16
    s_load_dwordx8 s[60:67], s[0:1], 32
    s_load_dwordx4 s[68:71], s[0:1], 64
    s_load_dwordx2 s[72:73], s[0:1], 80
    s_cmp_ge_u32 s2, 256
    s_cbranch_scc1 F_end
    v_lshrrev_b32 v1, 6, v0
    v_and_b32 v0, 63, v0
    s_and_b32 s30, s2, 7
    v_readfirstlane_b32 s3, v1
    s_lshr_b32 s31, s2, 3
    s_and_b32 s36, s30, 1
    s_lshl_b32 s32, s36, 3
    s_and_b32 s35, s31, 7
    s_add_u32 s32, s32, s35
    s_lshr_b32 s37, s30, 1
    s_lshl_b32 s33, s37, 2
    s_lshr_b32 s34, s31, 3
    s_add_u32 s33, s33, s34
    s_add_u32 s10, s33, 0
    s_and_b32 s10, s10, 15
    s_add_u32 s11, s35, s34
    s_and_b32 s11, s11, 3
    s_and_b32 s28, s32, 11
    s_and_b32 s29, s37, 1
    s_lshl_b32 s29, s29, 2
    s_add_u32 s28, s28, s29
    s_lshr_b32 s29, s37, 1
    s_lshl_b32 s29, s29, 3
    s_and_b32 s38, s35, 4
    s_add_u32 s29, s29, s38
    s_add_u32 s38, s34, 1
    s_and_b32 s38, s38, 3
    s_add_u32 s29, s29, s38

    s_lshl_b32 s11, s34, 1
    s_add_u32 s11, s11, s35
    s_and_b32 s11, s11, 7
    s_mul_i32 s89, s36, 8
    s_mul_i32 s38, s37, 2
    s_add_u32 s89, s89, s38

    s_mov_b32 s94, 0x53176420
    s_mov_b32 s95, 0xdb9fca8e
    s_cmp_eq_u32 s11, 1
    s_cselect_b32 s94, 0x42067531, s94
    s_cselect_b32 s95, 0xca8edb9f, s95
    s_cmp_eq_u32 s11, 2
    s_cselect_b32 s94, 0x53806412, s94
    s_cselect_b32 s95, 0xfdbeca97, s95
    s_cmp_eq_u32 s11, 3
    s_cselect_b32 s94, 0x42917503, s94
    s_cselect_b32 s95, 0xecafdb86, s95
    s_cmp_eq_u32 s11, 4
    s_cselect_b32 s94, 0x5a120364, s94
    s_cselect_b32 s95, 0xfd9ecb87, s95
    s_cmp_eq_u32 s11, 5
    s_cselect_b32 s94, 0x4b031275, s94
    s_cselect_b32 s95, 0xec8fda96, s95
    s_cmp_eq_u32 s11, 6
    s_cselect_b32 s94, 0xc3145206, s94
    s_cselect_b32 s95, 0xfb9eda87, s95
    s_cmp_eq_u32 s11, 7
    s_cselect_b32 s94, 0xd2054317, s94
    s_cselect_b32 s95, 0xea8fcb96, s95
    s_cmp_ge_u32 s3, 8
    s_cbranch_scc1 F_aux
    s_cmp_ge_u32 s3, 4
    s_cbranch_scc1 F_nl
    v_lshrrev_b32 v2, 3, v0
    v_and_b32 v3, 7, v0
    v_lshrrev_b32 v4, 1, v2
    v_xor_b32 v5, v3, v4
    v_xor_b32 v6, 4, v5
    v_lshlrev_b32 v5, 4, v5
    v_lshlrev_b32 v6, 4, v6
    v_lshlrev_b32 v7, 11, v2
    v_add_u32 v5, v5, v7
    v_add_u32 v6, v6, v7
    v_and_b32 v4, 1, v4
    v_lshlrev_b32 v4, 1, v4
    v_xor_b32 v8, v3, v4
    v_xor_b32 v9, 4, v8
    v_lshlrev_b32 v8, 4, v8
    v_lshlrev_b32 v9, 4, v9
    v_mul_u32_u24 v7, 6144, v2
    v_add_u32 v8, v8, v7
    v_add_u32 v9, v9, v7
    v_add_u32 v9, 49152, v9
    s_lshl_b32 s36, s32, 18
    s_lshl_b32 s37, s3, 16
    s_add_u32 s36, s36, s37
    s_lshl_b32 s38, s33, 7
    s_mul_i32 s37, s3, 98304
    s_add_u32 s38, s38, s37
    s_lshl_b32 s47, s10, 7
    s_add_u32 s47, s47, s37
    s_lshl_b32 s44, s3, 12
    s_lshl_b32 s45, s3, 11
    s_add_u32 s43, s45, 1024
    s_mov_b32 s14, 4194304
    s_mov_b32 s15, 0x20000
    s_mov_b32 s18, 6291456
    s_mov_b32 s19, 0x20000
    s_waitcnt lgkmcnt(0)
    s_mov_b32 s12, s4
    s_mov_b32 s13, s5
    s_mov_b32 s16, s6
    s_mov_b32 s17, s7

    s_setprio 3
    s_bfe_u32 s40, s94, 0x40000
    s_add_u32 s40, s89, s40
    s_and_b32 s40, s40, 15
    s_mul_i32 s41, s40, 393216
    s_lshl_b32 s40, s40, 7
    s_add_u32 s40, s40, s36
    s_add_u32 s42, s41, s47
    s_add_u32 s41, s41, s38
    s_add_u32 m0, s44, 0
    s_add_u32 s46, s40, 0
    s_nop 0
    buffer_load_dwordx4 v5, s[12:15], s46 offen lds
    s_add_u32 m0, s44, 1024
    s_add_u32 s46, s40, 16384
    buffer_load_dwordx4 v6, s[12:15], s46 offen lds
    s_add_u32 m0, s44, 2048
    s_add_u32 s46, s40, 32768
    buffer_load_dwordx4 v5, s[12:15], s46 offen lds
    s_add_u32 m0, s44, 3072
    s_add_u32 s46, s40, 49152
    buffer_load_dwordx4 v6, s[12:15], s46 offen lds
    s_add_u32 m0, s45, 65536
    s_add_u32 s46, s41, 2048
    buffer_load_dwordx4 v8, s[16:19], s46 offen lds
    s_add_u32 m0, s43, 65536
    s_add_u32 s46, s41, 2048
    buffer_load_dwordx4 v9, s[16:19], s46 offen lds
    s_add_u32 m0, s45, 73728
    s_add_u32 s46, s41, 4096
    buffer_load_dwordx4 v8, s[16:19], s46 offen lds
    s_add_u32 m0, s43, 73728
    s_add_u32 s46, s41, 4096
    buffer_load_dwordx4 v9, s[16:19], s46 offen lds
    s_lshl_b32 s51, s32, 4
    s_add_u32 s51, s51, s33
    s_lshl_b32 s51, s51, 14
    s_add_u32 s51, s51, s45
    v_lshlrev_b32 v165, 4, v0
    s_mov_b32 s20, s60
    s_mov_b32 s21, s61
    s_mov_b32 s22, 0x800
    s_mov_b32 s23, 0x00020000
    s_add_u32 m0, s45, 81920
    s_add_u32 s46, s51, 0
    buffer_load_dwordx4 v165, s[12:15], s46 offen lds
    s_add_u32 m0, s45, 82944
    s_add_u32 s46, s51, 1024
    buffer_load_dwordx4 v165, s[12:15], s46 offen lds
    s_and_b32 s46, s3, 1
    s_lshl_b32 s46, s46, 10
    s_add_u32 m0, s46, 161792
    s_nop 0
    s_nop 0
    buffer_load_dwordx4 v165, s[20:23], s46 offen lds
    s_add_u32 m0, s45, 90112
    s_add_u32 s46, s51, 8192
    buffer_load_dwordx4 v165, s[12:15], s46 offen lds
    s_add_u32 m0, s45, 91136
    s_add_u32 s46, s51, 9216
    buffer_load_dwordx4 v165, s[12:15], s46 offen lds
    s_add_u32 m0, s45, 147456
    s_nop 0
    buffer_load_dwordx4 v8, s[16:19], s42 offen lds
    s_add_u32 m0, s43, 147456
    s_nop 0
    buffer_load_dwordx4 v9, s[16:19], s42 offen lds
    v_and_b32 v1, 15, v0
    v_lshrrev_b32 v7, 4, v0
    v_lshrrev_b32 v3, 1, v1
    v_xor_b32 v3, v3, v7
    v_lshlrev_b32 v3, 4, v3
    v_lshlrev_b32 v1, 7, v1
    v_add3_u32 v2, v1, v3, s44
    v_xor_b32 v3, 64, v2
    v_add_u32 v14, 0x10000, v2
    v_add_u32 v15, 0x10000, v3
    v_bfe_u32 v1, v0, 2, 2
    v_lshl_add_u32 v4, v7, 3, v1
    v_lshrrev_b32 v1, 1, v1
    v_and_b32 v7, 1, v7
    v_lshl_add_u32 v1, v7, 1, v1
    v_lshlrev_b32 v1, 5, v1
    v_lshl_add_u32 v1, v4, 7, v1
    v_and_b32 v7, 3, v0
    v_lshl_add_u32 v1, v7, 3, v1
    v_add_u32 v10, 90112, v1
    v_xor_b32 v11, 32, v10
    v_xor_b32 v12, 64, v10
    v_xor_b32 v13, 96, v10
    v_lshlrev_b32 v1, 2, v7
    v_add_u32 v1, 159040, v1
    s_lshl_b32 s50, s3, 2
    s_add_u32 s50, s50, 159040
    v_mov_b32 v4, s50
    v_mov_b32 v164, 1

    s_waitcnt vmcnt(7)
    s_barrier
    s_bfe_u32 s40, s94, 0x40004
    s_add_u32 s40, s89, s40
    s_and_b32 s40, s40, 15
    s_mul_i32 s41, s40, 393216
    s_lshl_b32 s40, s40, 7
    s_add_u32 s40, s40, s36
    s_add_u32 s42, s41, s47
    s_add_u32 s41, s41, s38
    s_add_u32 m0, s44, 16384
    s_add_u32 s46, s40, 0
    buffer_load_dwordx4 v5, s[12:15], s46 offen lds
    ds_read_b128 v[48:51], v2 offset:0
    s_add_u32 m0, s44, 17408
    s_add_u32 s46, s40, 16384
    buffer_load_dwordx4 v6, s[12:15], s46 offen lds
    ds_read_b128 v[52:55], v2 offset:2048
    s_add_u32 m0, s44, 18432
    s_add_u32 s46, s40, 32768
    buffer_load_dwordx4 v5, s[12:15], s46 offen lds
    ds_read_b128 v[56:59], v3 offset:0
    s_add_u32 m0, s44, 19456
    s_add_u32 s46, s40, 49152
    buffer_load_dwordx4 v6, s[12:15], s46 offen lds
    ds_read_b128 v[60:63], v3 offset:2048
    s_add_u32 m0, s45, 98304
    s_add_u32 s46, s41, 2048
    buffer_load_dwordx4 v8, s[16:19], s46 offen lds
    s_add_u32 m0, s43, 98304
    s_add_u32 s46, s41, 2048
    buffer_load_dwordx4 v9, s[16:19], s46 offen lds
    s_add_u32 m0, s45, 106496
    s_add_u32 s46, s41, 4096
    buffer_load_dwordx4 v8, s[16:19], s46 offen lds
    s_add_u32 m0, s43, 106496
    s_add_u32 s46, s41, 4096
    buffer_load_dwordx4 v9, s[16:19], s46 offen lds
    s_bfe_u32 s40, s94, 0x40008
    s_add_u32 s40, s89, s40
    s_and_b32 s40, s40, 15
    s_mul_i32 s41, s40, 393216
    s_lshl_b32 s40, s40, 7
    s_add_u32 s40, s40, s36
    s_add_u32 s42, s41, s47
    s_add_u32 s41, s41, s38
    s_add_u32 m0, s44, 32768
    s_add_u32 s46, s40, 0
    buffer_load_dwordx4 v5, s[12:15], s46 offen lds
    s_add_u32 m0, s44, 33792
    s_add_u32 s46, s40, 16384
    buffer_load_dwordx4 v6, s[12:15], s46 offen lds
    s_add_u32 m0, s44, 34816
    s_add_u32 s46, s40, 32768
    buffer_load_dwordx4 v5, s[12:15], s46 offen lds
    s_waitcnt vmcnt(3) lgkmcnt(0)
    s_barrier
    s_nop 0
    s_add_u32 m0, s44, 35840
    s_add_u32 s46, s40, 49152
    buffer_load_dwordx4 v6, s[12:15], s46 offen lds
    ds_read_b64_tr_b16 v[64:65], v10 offset:57344
    ds_read_b64_tr_b16 v[66:67], v10 offset:57856
    s_add_u32 m0, s45, 114688
    s_add_u32 s46, s41, 2048
    buffer_load_dwordx4 v8, s[16:19], s46 offen lds
    ds_read_b128 v[68:71], v2 offset:16384
    s_add_u32 m0, s43, 114688
    s_add_u32 s46, s41, 2048
    buffer_load_dwordx4 v9, s[16:19], s46 offen lds
    ds_read_b64_tr_b16 v[72:73], v11 offset:57344
    ds_read_b64_tr_b16 v[74:75], v11 offset:57856
    s_add_u32 m0, s45, 122880
    s_add_u32 s46, s41, 4096
    buffer_load_dwordx4 v8, s[16:19], s46 offen lds
    ds_read_b128 v[76:79], v2 offset:18432
    s_add_u32 m0, s43, 122880
    s_add_u32 s46, s41, 4096
    buffer_load_dwordx4 v9, s[16:19], s46 offen lds
    ds_read_b64_tr_b16 v[80:81], v12 offset:57344
    ds_read_b64_tr_b16 v[82:83], v12 offset:57856
    s_bfe_u32 s40, s94, 0x40004
    s_add_u32 s40, s89, s40
    s_and_b32 s40, s40, 15
    s_mul_i32 s41, s40, 393216
    s_lshl_b32 s40, s40, 7
    s_add_u32 s40, s40, s36
    s_add_u32 s42, s41, s47
    s_add_u32 s41, s41, s38
    s_add_u32 m0, s45, 139264
    s_nop 0
    buffer_load_dwordx4 v8, s[16:19], s42 offen lds
    ds_read_b128 v[84:87], v3 offset:16384
    s_add_u32 m0, s43, 139264
    s_nop 0
    buffer_load_dwordx4 v9, s[16:19], s42 offen lds
    ds_read_b64_tr_b16 v[88:89], v13 offset:57344
    ds_read_b64_tr_b16 v[90:91], v13 offset:57856
    s_bfe_u32 s40, s94, 0x4000c
    s_add_u32 s40, s89, s40
    s_and_b32 s40, s40, 15
    s_mul_i32 s41, s40, 393216
    s_lshl_b32 s40, s40, 7
    s_add_u32 s40, s40, s36
    s_add_u32 s42, s41, s47
    s_add_u32 s41, s41, s38
    s_add_u32 m0, s44, 49152
    s_add_u32 s46, s40, 0
    s_nop 0
    buffer_load_dwordx4 v5, s[12:15], s46 offen lds
    ds_read_b128 v[92:95], v3 offset:18432
    s_add_u32 m0, s44, 50176
    s_add_u32 s46, s40, 16384
    buffer_load_dwordx4 v6, s[12:15], s46 offen lds
    s_add_u32 m0, s44, 51200
    s_add_u32 s46, s40, 32768
    buffer_load_dwordx4 v5, s[12:15], s46 offen lds
    s_add_u32 m0, s44, 52224
    s_add_u32 s46, s40, 49152
    buffer_load_dwordx4 v6, s[12:15], s46 offen lds
    s_waitcnt vmcnt(4) lgkmcnt(0)
    s_barrier
    s_add_u32 m0, s45, 131072
    s_add_u32 s46, s41, 2048
    buffer_load_dwordx4 v8, s[16:19], s46 offen lds
    v_mfma_f32_16x16x32_bf16 v[16:19], v[64:67], v[48:51], 0
    ds_read_b64_tr_b16 v[96:97], v10 offset:61440
    ds_read_b64_tr_b16 v[98:99], v10 offset:61952
    s_add_u32 m0, s43, 131072
    s_add_u32 s46, s41, 2048
    buffer_load_dwordx4 v9, s[16:19], s46 offen lds
    v_mfma_f32_16x16x32_bf16 v[32:35], v[64:67], v[52:55], 0
    ds_read_b128 v[100:103], v2 offset:32768
    s_add_u32 m0, s45, 65536
    s_add_u32 s46, s41, 4096
    buffer_load_dwordx4 v8, s[16:19], s46 offen lds
    v_mfma_f32_16x16x32_bf16 v[20:23], v[72:75], v[48:51], 0
    ds_read_b64_tr_b16 v[104:105], v11 offset:61440
    ds_read_b64_tr_b16 v[106:107], v11 offset:61952
    s_add_u32 m0, s43, 65536
    s_add_u32 s46, s41, 4096
    buffer_load_dwordx4 v9, s[16:19], s46 offen lds
    v_mfma_f32_16x16x32_bf16 v[36:39], v[72:75], v[52:55], 0
    ds_read_b128 v[108:111], v2 offset:34816
    s_bfe_u32 s40, s94, 0x40008
    s_add_u32 s40, s89, s40
    s_and_b32 s40, s40, 15
    s_mul_i32 s41, s40, 393216
    s_lshl_b32 s40, s40, 7
    s_add_u32 s40, s40, s36
    s_add_u32 s42, s41, s47
    s_add_u32 s41, s41, s38
    s_add_u32 m0, s45, 106496
    s_nop 0
    buffer_load_dwordx4 v8, s[16:19], s42 offen lds
    v_mfma_f32_16x16x32_bf16 v[24:27], v[80:83], v[48:51], 0
    ds_read_b64_tr_b16 v[112:113], v12 offset:61440
    ds_read_b64_tr_b16 v[114:115], v12 offset:61952
    s_add_u32 m0, s43, 106496
    s_nop 0
    buffer_load_dwordx4 v9, s[16:19], s42 offen lds
    v_mfma_f32_16x16x32_bf16 v[40:43], v[80:83], v[52:55], 0
    ds_read_b128 v[116:119], v3 offset:32768
    s_bfe_u32 s40, s94, 0x40010
    s_add_u32 s40, s89, s40
    s_and_b32 s40, s40, 15
    s_mul_i32 s41, s40, 393216
    s_lshl_b32 s40, s40, 7
    s_add_u32 s40, s40, s36
    s_add_u32 s42, s41, s47
    s_add_u32 s41, s41, s38
    s_add_u32 m0, s44, 0
    s_add_u32 s46, s40, 0
    buffer_load_dwordx4 v5, s[12:15], s46 offen lds
    v_mfma_f32_16x16x32_bf16 v[28:31], v[88:91], v[48:51], 0
    ds_read_b64_tr_b16 v[120:121], v13 offset:61440
    ds_read_b64_tr_b16 v[122:123], v13 offset:61952
    s_add_u32 m0, s44, 1024
    s_add_u32 s46, s40, 16384
    buffer_load_dwordx4 v6, s[12:15], s46 offen lds
    v_mfma_f32_16x16x32_bf16 v[44:47], v[88:91], v[52:55], 0
    ds_read_b128 v[124:127], v3 offset:34816
    s_add_u32 m0, s44, 2048
    s_add_u32 s46, s40, 32768
    buffer_load_dwordx4 v5, s[12:15], s46 offen lds
    ds_read_b64_tr_b16 v[128:129], v10 offset:49152
    ds_read_b64_tr_b16 v[130:131], v10 offset:49664
    s_add_u32 m0, s44, 3072
    s_add_u32 s46, s40, 49152
    buffer_load_dwordx4 v6, s[12:15], s46 offen lds
    ds_read_b64_tr_b16 v[132:133], v11 offset:49152
    s_waitcnt lgkmcnt(8)
    s_nop 0
    ds_read_b64_tr_b16 v[134:135], v11 offset:49664
    s_add_u32 m0, s45, 73728
    s_add_u32 s46, s41, 2048
    buffer_load_dwordx4 v8, s[16:19], s46 offen lds
    ds_read_b64_tr_b16 v[136:137], v12 offset:49152
    ds_read_b64_tr_b16 v[138:139], v12 offset:49664
    ds_read_b64_tr_b16 v[140:141], v13 offset:49152
    ds_read_b64_tr_b16 v[142:143], v13 offset:49664
    s_waitcnt vmcnt(5) lgkmcnt(0)
    s_barrier
    s_add_u32 m0, s43, 73728
    s_add_u32 s46, s41, 2048
    buffer_load_dwordx4 v9, s[16:19], s46 offen lds
    v_mfma_f32_16x16x32_bf16 v[16:19], v[96:99], v[56:59], v[16:19]
    ds_read_b64_tr_b16 v[144:145], v10 offset:53248
    ds_read_b64_tr_b16 v[146:147], v10 offset:53760
    s_add_u32 m0, s45, 81920
    s_add_u32 s46, s41, 4096
    buffer_load_dwordx4 v8, s[16:19], s46 offen lds
    v_mfma_f32_16x16x32_bf16 v[32:35], v[96:99], v[60:63], v[32:35]
    ds_read_b128 v[148:151], v2 offset:49152
    s_add_u32 m0, s43, 81920
    s_add_u32 s46, s41, 4096
    buffer_load_dwordx4 v9, s[16:19], s46 offen lds
    v_mfma_f32_16x16x32_bf16 v[20:23], v[104:107], v[56:59], v[20:23]
    ds_read_b64_tr_b16 v[152:153], v11 offset:53248
    ds_read_b64_tr_b16 v[154:155], v11 offset:53760
    s_bfe_u32 s40, s94, 0x40014
    s_add_u32 s40, s89, s40
    s_and_b32 s40, s40, 15
    s_mul_i32 s41, s40, 393216
    s_lshl_b32 s40, s40, 7
    s_add_u32 s40, s40, s36
    s_add_u32 s42, s41, s47
    s_add_u32 s41, s41, s38
    s_add_u32 m0, s44, 16384
    s_add_u32 s46, s40, 0
    s_nop 0
    buffer_load_dwordx4 v5, s[12:15], s46 offen lds
    v_mfma_f32_16x16x32_bf16 v[36:39], v[104:107], v[60:63], v[36:39]
    ds_read_b128 v[156:159], v2 offset:51200
    s_add_u32 m0, s44, 17408
    s_add_u32 s46, s40, 16384
    buffer_load_dwordx4 v6, s[12:15], s46 offen lds
    v_mfma_f32_16x16x32_bf16 v[24:27], v[112:115], v[56:59], v[24:27]
    ds_read_b64_tr_b16 v[160:161], v12 offset:53248
    ds_read_b64_tr_b16 v[162:163], v12 offset:53760
    s_add_u32 m0, s44, 18432
    s_add_u32 s46, s40, 32768
    buffer_load_dwordx4 v5, s[12:15], s46 offen lds
    v_mfma_f32_16x16x32_bf16 v[40:43], v[112:115], v[60:63], v[40:43]
    ds_read_b128 v[64:67], v3 offset:49152
    s_add_u32 m0, s44, 19456
    s_add_u32 s46, s40, 49152
    buffer_load_dwordx4 v6, s[12:15], s46 offen lds
    v_mfma_f32_16x16x32_bf16 v[28:31], v[120:123], v[56:59], v[28:31]
    ds_read_b64_tr_b16 v[72:73], v13 offset:53248
    ds_read_b64_tr_b16 v[74:75], v13 offset:53760
    s_add_u32 m0, s45, 90112
    s_add_u32 s46, s41, 2048
    buffer_load_dwordx4 v8, s[16:19], s46 offen lds
    v_mfma_f32_16x16x32_bf16 v[44:47], v[120:123], v[60:63], v[44:47]
    ds_read_b128 v[80:83], v3 offset:51200
    s_add_u32 m0, s43, 90112
    s_add_u32 s46, s41, 2048
    buffer_load_dwordx4 v9, s[16:19], s46 offen lds
    v_mfma_f32_16x16x32_bf16 v[16:19], v[128:131], v[68:71], v[16:19]
    ds_read_b64_tr_b16 v[48:49], v10 offset:16384
    ds_read_b64_tr_b16 v[50:51], v10 offset:16896
    s_add_u32 m0, s45, 98304
    s_add_u32 s46, s41, 4096
    buffer_load_dwordx4 v8, s[16:19], s46 offen lds
    v_mfma_f32_16x16x32_bf16 v[32:35], v[128:131], v[76:79], v[32:35]
    ds_read_b64_tr_b16 v[88:89], v11 offset:16384
    s_waitcnt lgkmcnt(8)
    s_nop 0
    ds_read_b64_tr_b16 v[90:91], v11 offset:16896
    s_add_u32 m0, s43, 98304
    s_add_u32 s46, s41, 4096
    buffer_load_dwordx4 v9, s[16:19], s46 offen lds
    v_mfma_f32_16x16x32_bf16 v[20:23], v[132:135], v[68:71], v[20:23]
    ds_read_b64_tr_b16 v[52:53], v12 offset:16384
    ds_read_b64_tr_b16 v[54:55], v12 offset:16896
    v_mfma_f32_16x16x32_bf16 v[36:39], v[132:135], v[76:79], v[36:39]
    ds_read_b64_tr_b16 v[96:97], v13 offset:16384
    ds_read_b64_tr_b16 v[98:99], v13 offset:16896
    v_mfma_f32_16x16x32_bf16 v[24:27], v[136:139], v[68:71], v[24:27]
    v_mfma_f32_16x16x32_bf16 v[40:43], v[136:139], v[76:79], v[40:43]
    v_mfma_f32_16x16x32_bf16 v[28:31], v[140:143], v[68:71], v[28:31]
    v_mfma_f32_16x16x32_bf16 v[44:47], v[140:143], v[76:79], v[44:47]
    s_waitcnt vmcnt(8) lgkmcnt(0)
    s_barrier
    s_bfe_u32 s40, s94, 0x4000c
    s_add_u32 s40, s89, s40
    s_and_b32 s40, s40, 15
    s_mul_i32 s41, s40, 393216
    s_lshl_b32 s40, s40, 7
    s_add_u32 s40, s40, s36
    s_add_u32 s42, s41, s47
    s_add_u32 s41, s41, s38
    s_add_u32 m0, s45, 147456
    s_nop 0
    buffer_load_dwordx4 v8, s[16:19], s42 offen lds
    v_mfma_f32_16x16x32_bf16 v[16:19], v[144:147], v[84:87], v[16:19]
    ds_read_b64_tr_b16 v[104:105], v10 offset:20480
    ds_read_b64_tr_b16 v[106:107], v10 offset:20992
    s_add_u32 m0, s43, 147456
    s_nop 0
    buffer_load_dwordx4 v9, s[16:19], s42 offen lds
    v_mfma_f32_16x16x32_bf16 v[32:35], v[144:147], v[92:95], v[32:35]
    ds_read_b128 v[112:115], v2 offset:0
    s_bfe_u32 s40, s94, 0x40018
    s_add_u32 s40, s89, s40
    s_and_b32 s40, s40, 15
    s_mul_i32 s41, s40, 393216
    s_lshl_b32 s40, s40, 7
    s_add_u32 s40, s40, s36
    s_add_u32 s42, s41, s47
    s_add_u32 s41, s41, s38
    s_add_u32 m0, s44, 32768
    s_branch IW_s0
IW_w0:
    s_branch IW_r0
IW_s0:
    s_add_u32 s46, s40, 0
    s_nop 0
    buffer_load_dwordx4 v5, s[12:15], s46 offen lds
    v_mfma_f32_16x16x32_bf16 v[20:23], v[152:155], v[84:87], v[20:23]
    ds_read_b64_tr_b16 v[56:57], v11 offset:20480
    ds_read_b64_tr_b16 v[58:59], v11 offset:20992
    s_add_u32 m0, s44, 33792
    s_add_u32 s46, s40, 16384
    buffer_load_dwordx4 v6, s[12:15], s46 offen lds
    v_mfma_f32_16x16x32_bf16 v[36:39], v[152:155], v[92:95], v[36:39]
    ds_read_b128 v[120:123], v2 offset:2048
    s_add_u32 m0, s44, 34816
    s_add_u32 s46, s40, 32768
    buffer_load_dwordx4 v5, s[12:15], s46 offen lds
    v_mfma_f32_16x16x32_bf16 v[24:27], v[160:163], v[84:87], v[24:27]
    ds_read_b64_tr_b16 v[60:61], v12 offset:20480
    ds_read_b64_tr_b16 v[62:63], v12 offset:20992
    s_add_u32 m0, s44, 35840
    s_add_u32 s46, s40, 49152
    buffer_load_dwordx4 v6, s[12:15], s46 offen lds
    v_mfma_f32_16x16x32_bf16 v[40:43], v[160:163], v[92:95], v[40:43]
    ds_read_b128 v[128:131], v3 offset:0
    s_add_u32 m0, s45, 114688
    s_add_u32 s46, s41, 2048
    buffer_load_dwordx4 v8, s[16:19], s46 offen lds
    v_mfma_f32_16x16x32_bf16 v[28:31], v[72:75], v[84:87], v[28:31]
    ds_read_b64_tr_b16 v[132:133], v13 offset:20480
    ds_read_b64_tr_b16 v[134:135], v13 offset:20992
    s_add_u32 m0, s43, 114688
    s_add_u32 s46, s41, 2048
    buffer_load_dwordx4 v9, s[16:19], s46 offen lds
    v_mfma_f32_16x16x32_bf16 v[44:47], v[72:75], v[92:95], v[44:47]
    ds_read_b128 v[136:139], v3 offset:2048
    s_add_u32 m0, s45, 122880
    s_add_u32 s46, s41, 4096
    buffer_load_dwordx4 v8, s[16:19], s46 offen lds
    v_mfma_f32_16x16x32_bf16 v[16:19], v[48:51], v[100:103], v[16:19]
    s_add_u32 m0, s43, 122880
    s_add_u32 s46, s41, 4096
    buffer_load_dwordx4 v9, s[16:19], s46 offen lds
    v_mfma_f32_16x16x32_bf16 v[32:35], v[48:51], v[108:111], v[32:35]
    s_bfe_u32 s40, s94, 0x4001c
    s_add_u32 s40, s89, s40
    s_and_b32 s40, s40, 15
    s_mul_i32 s41, s40, 393216
    s_lshl_b32 s40, s40, 7
    s_add_u32 s40, s40, s36
    s_add_u32 s42, s41, s47
    s_add_u32 s41, s41, s38
    s_add_u32 m0, s44, 49152
    s_add_u32 s46, s40, 0
    buffer_load_dwordx4 v5, s[12:15], s46 offen lds
    v_mfma_f32_16x16x32_bf16 v[20:23], v[88:91], v[100:103], v[20:23]
    v_mfma_f32_16x16x32_bf16 v[36:39], v[88:91], v[108:111], v[36:39]
    v_mfma_f32_16x16x32_bf16 v[24:27], v[52:55], v[100:103], v[24:27]
    v_mfma_f32_16x16x32_bf16 v[40:43], v[52:55], v[108:111], v[40:43]
    v_mfma_f32_16x16x32_bf16 v[28:31], v[96:99], v[100:103], v[28:31]
    v_mfma_f32_16x16x32_bf16 v[44:47], v[96:99], v[108:111], v[44:47]
    s_waitcnt vmcnt(9) lgkmcnt(0)
    s_barrier
    s_nop 0
    s_add_u32 m0, s44, 50176
    s_add_u32 s46, s40, 16384
    buffer_load_dwordx4 v6, s[12:15], s46 offen lds
    v_mfma_f32_16x16x32_bf16 v[16:19], v[104:107], v[116:119], v[16:19]
    ds_read_b64_tr_b16 v[68:69], v10 offset:57344
    ds_read_b64_tr_b16 v[70:71], v10 offset:57856
    s_add_u32 m0, s44, 51200
    s_add_u32 s46, s40, 32768
    buffer_load_dwordx4 v5, s[12:15], s46 offen lds
    v_mfma_f32_16x16x32_bf16 v[32:35], v[104:107], v[124:127], v[32:35]
    ds_read_b128 v[140:143], v2 offset:16384
    s_add_u32 m0, s44, 52224
    s_add_u32 s46, s40, 49152
    buffer_load_dwordx4 v6, s[12:15], s46 offen lds
    v_mfma_f32_16x16x32_bf16 v[20:23], v[56:59], v[116:119], v[20:23]
    ds_read_b64_tr_b16 v[76:77], v11 offset:57344
    ds_read_b64_tr_b16 v[78:79], v11 offset:57856
    s_add_u32 m0, s45, 65536
    s_add_u32 s46, s41, 2048
    buffer_load_dwordx4 v8, s[16:19], s46 offen lds
    v_mfma_f32_16x16x32_bf16 v[36:39], v[56:59], v[124:127], v[36:39]
    ds_read_b128 v[144:147], v2 offset:18432
    s_add_u32 m0, s43, 65536
    s_add_u32 s46, s41, 2048
    buffer_load_dwordx4 v9, s[16:19], s46 offen lds
    v_mfma_f32_16x16x32_bf16 v[24:27], v[60:63], v[116:119], v[24:27]
    ds_read_b64_tr_b16 v[152:153], v12 offset:57344
    ds_read_b64_tr_b16 v[154:155], v12 offset:57856
    s_add_u32 m0, s45, 131072
    s_add_u32 s46, s41, 4096
    buffer_load_dwordx4 v8, s[16:19], s46 offen lds
    v_mfma_f32_16x16x32_bf16 v[40:43], v[60:63], v[124:127], v[40:43]
    ds_read_b128 v[160:163], v3 offset:16384
    s_add_u32 m0, s43, 131072
    s_add_u32 s46, s41, 4096
    buffer_load_dwordx4 v9, s[16:19], s46 offen lds
    v_mfma_f32_16x16x32_bf16 v[28:31], v[132:135], v[116:119], v[28:31]
    ds_read_b64_tr_b16 v[84:85], v13 offset:57344
    ds_read_b64_tr_b16 v[86:87], v13 offset:57856
    s_bfe_u32 s40, s94, 0x40010
    s_add_u32 s40, s89, s40
    s_and_b32 s40, s40, 15
    s_mul_i32 s41, s40, 393216
    s_lshl_b32 s40, s40, 7
    s_add_u32 s40, s40, s36
    s_add_u32 s42, s41, s47
    s_add_u32 s41, s41, s38
    s_add_u32 m0, s45, 139264
    s_nop 0
    buffer_load_dwordx4 v8, s[16:19], s42 offen lds
    v_mfma_f32_16x16x32_bf16 v[44:47], v[132:135], v[124:127], v[44:47]
    ds_read_b128 v[72:75], v3 offset:18432
    s_add_u32 m0, s43, 139264
    s_nop 0
    buffer_load_dwordx4 v9, s[16:19], s42 offen lds
    s_bfe_u32 s40, s95, 0x40000
    s_add_u32 s40, s89, s40
    s_and_b32 s40, s40, 15
    s_mul_i32 s41, s40, 393216
    s_lshl_b32 s40, s40, 7
    s_add_u32 s40, s40, s36
    s_add_u32 s42, s41, s47
    s_add_u32 s41, s41, s38
    s_add_u32 m0, s44, 0
    s_add_u32 s46, s40, 0
    buffer_load_dwordx4 v5, s[12:15], s46 offen lds
    s_add_u32 m0, s44, 1024
    s_add_u32 s46, s40, 16384
    buffer_load_dwordx4 v6, s[12:15], s46 offen lds
    s_waitcnt vmcnt(12) lgkmcnt(0)
    s_barrier
    s_add_u32 m0, s44, 2048
    s_add_u32 s46, s40, 32768
    buffer_load_dwordx4 v5, s[12:15], s46 offen lds
    v_mfma_f32_16x16x32_bf16 v[16:19], v[68:71], v[148:151], v[16:19]
    ds_read_b64_tr_b16 v[92:93], v10 offset:61440
    ds_read_b64_tr_b16 v[94:95], v10 offset:61952
    s_add_u32 m0, s44, 3072
    s_add_u32 s46, s40, 49152
    buffer_load_dwordx4 v6, s[12:15], s46 offen lds
    v_mfma_f32_16x16x32_bf16 v[32:35], v[68:71], v[156:159], v[32:35]
    ds_read_b128 v[48:51], v2 offset:32768
    s_add_u32 m0, s45, 73728
    s_add_u32 s46, s41, 2048
    buffer_load_dwordx4 v8, s[16:19], s46 offen lds
    v_mfma_f32_16x16x32_bf16 v[20:23], v[76:79], v[148:151], v[20:23]
    ds_read_b64_tr_b16 v[88:89], v11 offset:61440
    ds_read_b64_tr_b16 v[90:91], v11 offset:61952
    s_add_u32 m0, s43, 73728
    s_add_u32 s46, s41, 2048
    buffer_load_dwordx4 v9, s[16:19], s46 offen lds
    v_mfma_f32_16x16x32_bf16 v[36:39], v[76:79], v[156:159], v[36:39]
    ds_read_b128 v[52:55], v2 offset:34816
    s_add_u32 m0, s45, 81920
    s_add_u32 s46, s41, 4096
    buffer_load_dwordx4 v8, s[16:19], s46 offen lds
    v_mfma_f32_16x16x32_bf16 v[24:27], v[152:155], v[148:151], v[24:27]
    ds_read_b64_tr_b16 v[100:101], v12 offset:61440
    ds_read_b64_tr_b16 v[102:103], v12 offset:61952
    s_add_u32 m0, s43, 81920
    s_add_u32 s46, s41, 4096
    buffer_load_dwordx4 v9, s[16:19], s46 offen lds
    v_mfma_f32_16x16x32_bf16 v[40:43], v[152:155], v[156:159], v[40:43]
    ds_read_b128 v[96:99], v3 offset:32768
    s_bfe_u32 s40, s95, 0x40004
    s_add_u32 s40, s89, s40
    s_and_b32 s40, s40, 15
    s_mul_i32 s41, s40, 393216
    s_lshl_b32 s40, s40, 7
    s_add_u32 s40, s40, s36
    s_add_u32 s42, s41, s47
    s_add_u32 s41, s41, s38
    s_add_u32 m0, s44, 16384
    s_add_u32 s46, s40, 0
    s_nop 0
    buffer_load_dwordx4 v5, s[12:15], s46 offen lds
    v_mfma_f32_16x16x32_bf16 v[28:31], v[84:87], v[148:151], v[28:31]
    ds_read_b64_tr_b16 v[108:109], v13 offset:61440
    ds_read_b64_tr_b16 v[110:111], v13 offset:61952
    s_add_u32 m0, s44, 17408
    s_add_u32 s46, s40, 16384
    buffer_load_dwordx4 v6, s[12:15], s46 offen lds
    v_mfma_f32_16x16x32_bf16 v[44:47], v[84:87], v[156:159], v[44:47]
    ds_read_b128 v[104:107], v3 offset:34816
    s_add_u32 m0, s44, 18432
    s_add_u32 s46, s40, 32768
    buffer_load_dwordx4 v5, s[12:15], s46 offen lds
    s_add_u32 m0, s44, 19456
    s_add_u32 s46, s40, 49152
    buffer_load_dwordx4 v6, s[12:15], s46 offen lds
    s_add_u32 m0, s45, 90112
    s_add_u32 s46, s41, 2048
    buffer_load_dwordx4 v8, s[16:19], s46 offen lds
    s_waitcnt vmcnt(13) lgkmcnt(0)
    s_barrier
    s_add_u32 m0, s43, 90112
    s_add_u32 s46, s41, 2048
    buffer_load_dwordx4 v9, s[16:19], s46 offen lds
    v_mfma_f32_16x16x32_bf16 v[16:19], v[92:95], v[64:67], v[16:19]
    ds_read_b64_tr_b16 v[56:57], v10 offset:49152
    ds_read_b64_tr_b16 v[58:59], v10 offset:49664
    s_add_u32 m0, s45, 98304
    s_add_u32 s46, s41, 4096
    buffer_load_dwordx4 v8, s[16:19], s46 offen lds
    v_mfma_f32_16x16x32_bf16 v[32:35], v[92:95], v[80:83], v[32:35]
    ds_read_b128 v[60:63], v2 offset:49152
    s_add_u32 m0, s43, 98304
    s_add_u32 s46, s41, 4096
    buffer_load_dwordx4 v9, s[16:19], s46 offen lds
    v_mfma_f32_16x16x32_bf16 v[20:23], v[88:91], v[64:67], v[20:23]
    ds_read_b64_tr_b16 v[116:117], v11 offset:49152
    ds_read_b64_tr_b16 v[118:119], v11 offset:49664
    s_bfe_u32 s40, s94, 0x40014
    s_add_u32 s40, s89, s40
    s_and_b32 s40, s40, 15
    s_mul_i32 s41, s40, 393216
    s_lshl_b32 s40, s40, 7
    s_add_u32 s40, s40, s36
    s_add_u32 s42, s41, s47
    s_add_u32 s41, s41, s38
    s_add_u32 m0, s45, 106496
    s_nop 0
    buffer_load_dwordx4 v8, s[16:19], s42 offen lds
    v_mfma_f32_16x16x32_bf16 v[36:39], v[88:91], v[80:83], v[36:39]
    ds_read_b128 v[132:135], v2 offset:51200
    s_add_u32 m0, s43, 106496
    s_nop 0
    buffer_load_dwordx4 v9, s[16:19], s42 offen lds
    v_mfma_f32_16x16x32_bf16 v[24:27], v[100:103], v[64:67], v[24:27]
    ds_read_b64_tr_b16 v[124:125], v12 offset:49152
    ds_read_b64_tr_b16 v[126:127], v12 offset:49664
    s_bfe_u32 s40, s95, 0x40008
    s_add_u32 s40, s89, s40
    s_and_b32 s40, s40, 15
    s_mul_i32 s41, s40, 393216
    s_lshl_b32 s40, s40, 7
    s_add_u32 s40, s40, s36
    s_add_u32 s42, s41, s47
    s_add_u32 s41, s41, s38
    s_add_u32 m0, s44, 32768
    s_add_u32 s46, s40, 0
    s_nop 0
    buffer_load_dwordx4 v5, s[12:15], s46 offen lds
    v_mfma_f32_16x16x32_bf16 v[40:43], v[100:103], v[80:83], v[40:43]
    ds_read_b128 v[68:71], v3 offset:49152
    s_add_u32 m0, s44, 33792
    s_add_u32 s46, s40, 16384
    buffer_load_dwordx4 v6, s[12:15], s46 offen lds
    v_mfma_f32_16x16x32_bf16 v[28:31], v[108:111], v[64:67], v[28:31]
    ds_read_b64_tr_b16 v[76:77], v13 offset:49152
    ds_read_b64_tr_b16 v[78:79], v13 offset:49664
    s_add_u32 m0, s44, 34816
    s_add_u32 s46, s40, 32768
    buffer_load_dwordx4 v5, s[12:15], s46 offen lds
    v_mfma_f32_16x16x32_bf16 v[44:47], v[108:111], v[80:83], v[44:47]
    ds_read_b128 v[152:155], v3 offset:51200
    s_add_u32 m0, s44, 35840
    s_add_u32 s46, s40, 49152
    buffer_load_dwordx4 v6, s[12:15], s46 offen lds
    s_add_u32 m0, s45, 114688
    s_add_u32 s46, s41, 2048
    buffer_load_dwordx4 v8, s[16:19], s46 offen lds
    s_add_u32 m0, s43, 114688
    s_add_u32 s46, s41, 2048
    buffer_load_dwordx4 v9, s[16:19], s46 offen lds
    s_waitcnt vmcnt(16) lgkmcnt(0)
    s_barrier
    s_add_u32 m0, s45, 122880
    s_add_u32 s46, s41, 4096
    buffer_load_dwordx4 v8, s[16:19], s46 offen lds
    v_mfma_f32_16x16x32_bf16 v[16:19], v[56:59], v[112:115], v[16:19]
    ds_read_b64_tr_b16 v[148:149], v10 offset:53248
    ds_read_b64_tr_b16 v[150:151], v10 offset:53760
    s_add_u32 m0, s43, 122880
    s_add_u32 s46, s41, 4096
    buffer_load_dwordx4 v9, s[16:19], s46 offen lds
    v_mfma_f32_16x16x32_bf16 v[32:35], v[56:59], v[120:123], v[32:35]
    ds_read_b128 v[84:87], v2 offset:0
    s_bfe_u32 s40, s95, 0x4000c
    s_add_u32 s40, s89, s40
    s_and_b32 s40, s40, 15
    s_mul_i32 s41, s40, 393216
    s_lshl_b32 s40, s40, 7
    s_add_u32 s40, s40, s36
    s_add_u32 s42, s41, s47
    s_add_u32 s41, s41, s38
    s_add_u32 m0, s44, 49152
    s_add_u32 s46, s40, 0
    s_nop 0
    buffer_load_dwordx4 v5, s[12:15], s46 offen lds
    v_mfma_f32_16x16x32_bf16 v[20:23], v[116:119], v[112:115], v[20:23]
    ds_read_b64_tr_b16 v[156:157], v11 offset:53248
    ds_read_b64_tr_b16 v[158:159], v11 offset:53760
    s_add_u32 m0, s44, 50176
    s_add_u32 s46, s40, 16384
    buffer_load_dwordx4 v6, s[12:15], s46 offen lds
    v_mfma_f32_16x16x32_bf16 v[36:39], v[116:119], v[120:123], v[36:39]
    ds_read_b128 v[92:95], v2 offset:2048
    s_add_u32 m0, s44, 51200
    s_add_u32 s46, s40, 32768
    buffer_load_dwordx4 v5, s[12:15], s46 offen lds
    v_mfma_f32_16x16x32_bf16 v[24:27], v[124:127], v[112:115], v[24:27]
    ds_read_b64_tr_b16 v[88:89], v12 offset:53248
    ds_read_b64_tr_b16 v[90:91], v12 offset:53760
    s_add_u32 m0, s44, 52224
    s_add_u32 s46, s40, 49152
    buffer_load_dwordx4 v6, s[12:15], s46 offen lds
    v_mfma_f32_16x16x32_bf16 v[40:43], v[124:127], v[120:123], v[40:43]
    ds_read_b128 v[100:103], v3 offset:0
    s_add_u32 m0, s45, 65536
    s_add_u32 s46, s41, 2048
    buffer_load_dwordx4 v8, s[16:19], s46 offen lds
    v_mfma_f32_16x16x32_bf16 v[28:31], v[76:79], v[112:115], v[28:31]
    ds_read_b64_tr_b16 v[64:65], v13 offset:53248
    ds_read_b64_tr_b16 v[66:67], v13 offset:53760
    s_add_u32 m0, s43, 65536
    s_add_u32 s46, s41, 2048
    buffer_load_dwordx4 v9, s[16:19], s46 offen lds
    v_mfma_f32_16x16x32_bf16 v[44:47], v[76:79], v[120:123], v[44:47]
    ds_read_b128 v[108:111], v3 offset:2048
    s_add_u32 m0, s45, 131072
    s_add_u32 s46, s41, 4096
    buffer_load_dwordx4 v8, s[16:19], s46 offen lds
    s_add_u32 m0, s43, 131072
    s_add_u32 s46, s41, 4096
    buffer_load_dwordx4 v9, s[16:19], s46 offen lds
    s_waitcnt vmcnt(16) lgkmcnt(0)
    s_barrier
    s_bfe_u32 s40, s95, 0x40010
    s_add_u32 s40, s89, s40
    s_and_b32 s40, s40, 15
    s_mul_i32 s41, s40, 393216
    s_lshl_b32 s40, s40, 7
    s_add_u32 s40, s40, s36
    s_add_u32 s42, s41, s47
    s_add_u32 s41, s41, s38
    s_add_u32 m0, s44, 0
    s_add_u32 s46, s40, 0
    buffer_load_dwordx4 v5, s[12:15], s46 offen lds
    v_mfma_f32_16x16x32_bf16 v[16:19], v[148:151], v[128:131], v[16:19]
    ds_read_b64_tr_b16 v[80:81], v10 offset:16384
    ds_read_b64_tr_b16 v[82:83], v10 offset:16896
    s_add_u32 m0, s44, 1024
    s_add_u32 s46, s40, 16384
    buffer_load_dwordx4 v6, s[12:15], s46 offen lds
    v_mfma_f32_16x16x32_bf16 v[32:35], v[148:151], v[136:139], v[32:35]
    ds_read_b128 v[56:59], v2 offset:16384
    s_add_u32 m0, s44, 2048
    s_add_u32 s46, s40, 32768
    buffer_load_dwordx4 v5, s[12:15], s46 offen lds
    v_mfma_f32_16x16x32_bf16 v[20:23], v[156:159], v[128:131], v[20:23]
    ds_read_b64_tr_b16 v[116:117], v11 offset:16384
    ds_read_b64_tr_b16 v[118:119], v11 offset:16896
    s_add_u32 m0, s44, 3072
    s_add_u32 s46, s40, 49152
    buffer_load_dwordx4 v6, s[12:15], s46 offen lds
    v_mfma_f32_16x16x32_bf16 v[36:39], v[156:159], v[136:139], v[36:39]
    ds_read_b128 v[124:127], v2 offset:18432
    s_add_u32 m0, s45, 73728
    s_add_u32 s46, s41, 2048
    buffer_load_dwordx4 v8, s[16:19], s46 offen lds
    v_mfma_f32_16x16x32_bf16 v[24:27], v[88:91], v[128:131], v[24:27]
    ds_read_b64_tr_b16 v[112:113], v12 offset:16384
    ds_read_b64_tr_b16 v[114:115], v12 offset:16896
    s_add_u32 m0, s43, 73728
    s_add_u32 s46, s41, 2048
    buffer_load_dwordx4 v9, s[16:19], s46 offen lds
    v_mfma_f32_16x16x32_bf16 v[40:43], v[88:91], v[136:139], v[40:43]
    ds_read_b128 v[76:79], v3 offset:16384
    s_add_u32 m0, s45, 81920
    s_add_u32 s46, s41, 4096
    buffer_load_dwordx4 v8, s[16:19], s46 offen lds
    v_mfma_f32_16x16x32_bf16 v[28:31], v[64:67], v[128:131], v[28:31]
    ds_read_b64_tr_b16 v[120:121], v13 offset:16384
    ds_read_b64_tr_b16 v[122:123], v13 offset:16896
    s_add_u32 m0, s43, 81920
    s_add_u32 s46, s41, 4096
    buffer_load_dwordx4 v9, s[16:19], s46 offen lds
    v_mfma_f32_16x16x32_bf16 v[44:47], v[64:67], v[136:139], v[44:47]
    ds_read_b128 v[148:151], v3 offset:18432
    s_waitcnt vmcnt(16) lgkmcnt(0)
    s_barrier
    s_bfe_u32 s40, s95, 0x40014
    s_add_u32 s40, s89, s40
    s_and_b32 s40, s40, 15
    s_mul_i32 s41, s40, 393216
    s_lshl_b32 s40, s40, 7
    s_add_u32 s40, s40, s36
    s_add_u32 s42, s41, s47
    s_add_u32 s41, s41, s38
    s_add_u32 m0, s44, 16384
    s_add_u32 s46, s40, 0
    s_nop 0
    buffer_load_dwordx4 v5, s[12:15], s46 offen lds
    v_mfma_f32_16x16x32_bf16 v[16:19], v[80:83], v[140:143], v[16:19]
    ds_read_b64_tr_b16 v[156:157], v10 offset:20480
    ds_read_b64_tr_b16 v[158:159], v10 offset:20992
    s_add_u32 m0, s44, 17408
    s_add_u32 s46, s40, 16384
    buffer_load_dwordx4 v6, s[12:15], s46 offen lds
    v_mfma_f32_16x16x32_bf16 v[32:35], v[80:83], v[144:147], v[32:35]
    ds_read_b128 v[88:91], v2 offset:32768
    s_add_u32 m0, s44, 18432
    s_add_u32 s46, s40, 32768
    buffer_load_dwordx4 v5, s[12:15], s46 offen lds
    v_mfma_f32_16x16x32_bf16 v[20:23], v[116:119], v[140:143], v[20:23]
    ds_read_b64_tr_b16 v[128:129], v11 offset:20480
    ds_read_b64_tr_b16 v[130:131], v11 offset:20992
    s_add_u32 m0, s44, 19456
    s_add_u32 s46, s40, 49152
    buffer_load_dwordx4 v6, s[12:15], s46 offen lds
    v_mfma_f32_16x16x32_bf16 v[36:39], v[116:119], v[144:147], v[36:39]
    ds_read_b128 v[64:67], v2 offset:34816
    s_add_u32 m0, s45, 90112
    s_add_u32 s46, s41, 2048
    buffer_load_dwordx4 v8, s[16:19], s46 offen lds
    v_mfma_f32_16x16x32_bf16 v[24:27], v[112:115], v[140:143], v[24:27]
    ds_read_b64_tr_b16 v[136:137], v12 offset:20480
    ds_read_b64_tr_b16 v[138:139], v12 offset:20992
    s_add_u32 m0, s43, 90112
    s_add_u32 s46, s41, 2048
    buffer_load_dwordx4 v9, s[16:19], s46 offen lds
    v_mfma_f32_16x16x32_bf16 v[40:43], v[112:115], v[144:147], v[40:43]
    ds_read_b128 v[80:83], v3 offset:32768
    s_add_u32 m0, s45, 98304
    s_add_u32 s46, s41, 4096
    buffer_load_dwordx4 v8, s[16:19], s46 offen lds
    v_mfma_f32_16x16x32_bf16 v[28:31], v[120:123], v[140:143], v[28:31]
    ds_read_b64_tr_b16 v[116:117], v13 offset:20480
    ds_read_b64_tr_b16 v[118:119], v13 offset:20992
    s_add_u32 m0, s43, 98304
    s_add_u32 s46, s41, 4096
    buffer_load_dwordx4 v9, s[16:19], s46 offen lds
    v_mfma_f32_16x16x32_bf16 v[44:47], v[120:123], v[144:147], v[44:47]
    ds_read_b128 v[112:115], v3 offset:34816
    s_waitcnt vmcnt(16) lgkmcnt(0)
    s_barrier
    s_bfe_u32 s40, s95, 0x40018
    s_add_u32 s40, s89, s40
    s_and_b32 s40, s40, 15
    s_mul_i32 s41, s40, 393216
    s_lshl_b32 s40, s40, 7
    s_add_u32 s40, s40, s36
    s_add_u32 s42, s41, s47
    s_add_u32 s41, s41, s38
    s_add_u32 m0, s44, 32768
    s_add_u32 s46, s40, 0
    s_nop 0
    buffer_load_dwordx4 v5, s[12:15], s46 offen lds
    v_mfma_f32_16x16x32_bf16 v[16:19], v[156:159], v[160:163], v[16:19]
    ds_read_b128 v[140:143], v2 offset:49152
    s_add_u32 m0, s44, 33792
    s_add_u32 s46, s40, 16384
    buffer_load_dwordx4 v6, s[12:15], s46 offen lds
    v_mfma_f32_16x16x32_bf16 v[32:35], v[156:159], v[72:75], v[32:35]
    ds_read_b128 v[120:123], v2 offset:51200
    s_add_u32 m0, s44, 34816
    s_add_u32 s46, s40, 32768
    buffer_load_dwordx4 v5, s[12:15], s46 offen lds
    v_mfma_f32_16x16x32_bf16 v[20:23], v[128:131], v[160:163], v[20:23]
    ds_read_b128 v[144:147], v3 offset:49152
    s_add_u32 m0, s44, 35840
    s_add_u32 s46, s40, 49152
    buffer_load_dwordx4 v6, s[12:15], s46 offen lds
    v_mfma_f32_16x16x32_bf16 v[36:39], v[128:131], v[72:75], v[36:39]
    ds_read_b128 v[156:159], v3 offset:51200
    s_add_u32 m0, s45, 106496
    s_add_u32 s46, s41, 2048
    buffer_load_dwordx4 v8, s[16:19], s46 offen lds
    v_mfma_f32_16x16x32_bf16 v[24:27], v[136:139], v[160:163], v[24:27]
    s_add_u32 m0, s43, 106496
    s_add_u32 s46, s41, 2048
    buffer_load_dwordx4 v9, s[16:19], s46 offen lds
    v_mfma_f32_16x16x32_bf16 v[40:43], v[136:139], v[72:75], v[40:43]
    s_add_u32 m0, s45, 114688
    s_add_u32 s46, s41, 4096
    buffer_load_dwordx4 v8, s[16:19], s46 offen lds
    v_mfma_f32_16x16x32_bf16 v[28:31], v[116:119], v[160:163], v[28:31]
    s_add_u32 m0, s43, 114688
    s_add_u32 s46, s41, 4096
    buffer_load_dwordx4 v9, s[16:19], s46 offen lds
    v_mfma_f32_16x16x32_bf16 v[44:47], v[116:119], v[72:75], v[44:47]
    s_waitcnt vmcnt(16) lgkmcnt(0)
    s_barrier
    s_bfe_u32 s40, s95, 0x4001c
    s_add_u32 s40, s89, s40
    s_and_b32 s40, s40, 15
    s_mul_i32 s41, s40, 393216
    s_lshl_b32 s40, s40, 7
    s_add_u32 s40, s40, s36
    s_add_u32 s42, s41, s47
    s_add_u32 s41, s41, s38
    s_add_u32 m0, s44, 49152
    s_add_u32 s46, s40, 0
    s_nop 0
    buffer_load_dwordx4 v5, s[12:15], s46 offen lds
    s_add_u32 m0, s44, 50176
    s_add_u32 s46, s40, 16384
    buffer_load_dwordx4 v6, s[12:15], s46 offen lds
    s_add_u32 m0, s44, 51200
    s_add_u32 s46, s40, 32768
    buffer_load_dwordx4 v5, s[12:15], s46 offen lds
    s_add_u32 m0, s44, 52224
    s_add_u32 s46, s40, 49152
    buffer_load_dwordx4 v6, s[12:15], s46 offen lds
    s_add_u32 m0, s45, 65536
    s_add_u32 s46, s41, 2048
    buffer_load_dwordx4 v8, s[16:19], s46 offen lds
    s_add_u32 m0, s43, 65536
    s_add_u32 s46, s41, 2048
    buffer_load_dwordx4 v9, s[16:19], s46 offen lds
    s_add_u32 m0, s45, 122880
    s_add_u32 s46, s41, 4096
    buffer_load_dwordx4 v8, s[16:19], s46 offen lds
    s_add_u32 m0, s43, 122880
    s_add_u32 s46, s41, 4096
    buffer_load_dwordx4 v9, s[16:19], s46 offen lds
    s_waitcnt vmcnt(16)
    s_barrier
    s_bfe_u32 s40, s94, 0x40018
    s_add_u32 s40, s89, s40
    s_and_b32 s40, s40, 15
    s_mul_i32 s41, s40, 393216
    s_lshl_b32 s40, s40, 7
    s_add_u32 s40, s40, s36
    s_add_u32 s42, s41, s47
    s_add_u32 s41, s41, s38
    s_add_u32 m0, s45, 147456
    s_nop 0
    buffer_load_dwordx4 v8, s[16:19], s42 offen lds
    s_add_u32 m0, s43, 147456
    s_nop 0
    buffer_load_dwordx4 v9, s[16:19], s42 offen lds
    s_waitcnt vmcnt(10)
    s_barrier
    s_bfe_u32 s40, s95, 0x40010
    s_add_u32 s40, s89, s40
    s_and_b32 s40, s40, 15
    s_mul_i32 s41, s40, 393216
    s_lshl_b32 s40, s40, 7
    s_add_u32 s40, s40, s36
    s_add_u32 s42, s41, s47
    s_add_u32 s41, s41, s38
    s_add_u32 m0, s45, 139264
    s_nop 0
    buffer_load_dwordx4 v8, s[16:19], s42 offen lds
    s_add_u32 m0, s43, 139264
    s_nop 0
    buffer_load_dwordx4 v9, s[16:19], s42 offen lds
    s_waitcnt vmcnt(4)
    s_barrier
    s_bfe_u32 s40, s95, 0x40014
    s_add_u32 s40, s89, s40
    s_and_b32 s40, s40, 15
    s_mul_i32 s41, s40, 393216
    s_lshl_b32 s40, s40, 7
    s_add_u32 s40, s40, s36
    s_add_u32 s42, s41, s47
    s_add_u32 s41, s41, s38
    s_add_u32 m0, s45, 131072
    s_nop 0
    buffer_load_dwordx4 v8, s[16:19], s42 offen lds
    s_add_u32 m0, s43, 131072
    s_nop 0
    buffer_load_dwordx4 v9, s[16:19], s42 offen lds
    s_waitcnt vmcnt(6)
    s_barrier
    s_bfe_u32 s40, s95, 0x40018
    s_add_u32 s40, s89, s40
    s_and_b32 s40, s40, 15
    s_mul_i32 s41, s40, 393216
    s_lshl_b32 s40, s40, 7
    s_add_u32 s40, s40, s36
    s_add_u32 s42, s41, s47
    s_add_u32 s41, s41, s38
    s_add_u32 m0, s45, 81920
    s_nop 0
    buffer_load_dwordx4 v8, s[16:19], s42 offen lds
    s_add_u32 m0, s43, 81920
    s_nop 0
    buffer_load_dwordx4 v9, s[16:19], s42 offen lds
    s_bfe_u32 s40, s95, 0x4001c
    s_add_u32 s40, s89, s40
    s_branch IW_s1
IW_w1:
    s_branch IW_r1
IW_s1:
    s_and_b32 s40, s40, 15
    s_mul_i32 s41, s40, 393216
    s_lshl_b32 s40, s40, 7
    s_add_u32 s40, s40, s36
    s_add_u32 s42, s41, s47
    s_add_u32 s41, s41, s38
    s_add_u32 m0, s45, 73728
    s_nop 0
    buffer_load_dwordx4 v8, s[16:19], s42 offen lds
    s_add_u32 m0, s43, 73728
    s_nop 0
    buffer_load_dwordx4 v9, s[16:19], s42 offen lds
    s_bfe_u32 s40, s94, 0x4001c
    s_add_u32 s40, s89, s40
    s_and_b32 s40, s40, 15
    s_mul_i32 s41, s40, 393216
    s_lshl_b32 s40, s40, 7
    s_add_u32 s40, s40, s36
    s_add_u32 s42, s41, s47
    s_add_u32 s41, s41, s38
    s_add_u32 m0, s45, 98304
    s_nop 0
    buffer_load_dwordx4 v8, s[16:19], s42 offen lds
    s_add_u32 m0, s43, 98304
    s_nop 0
    buffer_load_dwordx4 v9, s[16:19], s42 offen lds
    s_bfe_u32 s40, s95, 0x40000
    s_add_u32 s40, s89, s40
    s_and_b32 s40, s40, 15
    s_mul_i32 s41, s40, 393216
    s_lshl_b32 s40, s40, 7
    s_add_u32 s40, s40, s36
    s_add_u32 s42, s41, s47
    s_add_u32 s41, s41, s38
    s_add_u32 m0, s45, 90112
    s_nop 0
    buffer_load_dwordx4 v8, s[16:19], s42 offen lds
    s_add_u32 m0, s43, 90112
    s_nop 0
    buffer_load_dwordx4 v9, s[16:19], s42 offen lds
    s_bfe_u32 s40, s95, 0x40004
    s_add_u32 s40, s89, s40
    s_and_b32 s40, s40, 15
    s_mul_i32 s41, s40, 393216
    s_lshl_b32 s40, s40, 7
    s_add_u32 s40, s40, s36
    s_add_u32 s42, s41, s47
    s_add_u32 s41, s41, s38
    s_add_u32 m0, s45, 114688
    s_nop 0
    buffer_load_dwordx4 v8, s[16:19], s42 offen lds
    s_add_u32 m0, s43, 114688
    s_nop 0
    buffer_load_dwordx4 v9, s[16:19], s42 offen lds
    s_bfe_u32 s40, s95, 0x40008
    s_add_u32 s40, s89, s40
    s_and_b32 s40, s40, 15
    s_mul_i32 s41, s40, 393216
    s_lshl_b32 s40, s40, 7
    s_add_u32 s40, s40, s36
    s_add_u32 s42, s41, s47
    s_add_u32 s41, s41, s38
    s_add_u32 m0, s45, 106496
    s_nop 0
    buffer_load_dwordx4 v8, s[16:19], s42 offen lds
    s_add_u32 m0, s43, 106496
    s_nop 0
    buffer_load_dwordx4 v9, s[16:19], s42 offen lds
    s_bfe_u32 s40, s95, 0x4000c
    s_add_u32 s40, s89, s40
    s_and_b32 s40, s40, 15
    s_mul_i32 s41, s40, 393216
    s_lshl_b32 s40, s40, 7
    s_add_u32 s40, s40, s36
    s_add_u32 s42, s41, s47
    s_add_u32 s41, s41, s38
    s_add_u32 m0, s45, 122880
    s_nop 0
    buffer_load_dwordx4 v8, s[16:19], s42 offen lds
    s_add_u32 m0, s43, 122880
    s_nop 0
    buffer_load_dwordx4 v9, s[16:19], s42 offen lds
    s_setprio 1
    v_subrev_u32 v5, 24576, v10
    v_subrev_u32 v6, 24576, v11
    v_subrev_u32 v8, 24576, v12
    v_subrev_u32 v9, 24576, v13
    s_add_u32 s16, s72, 0x400000
    s_addc_u32 s17, s73, 0
    s_mov_b32 s18, 0x400000
    s_mov_b32 s19, 0x00020000
    s_add_u32 s24, s72, 0x800000
    s_addc_u32 s25, s73, 0
    s_mov_b32 s26, 0x48000
    s_mov_b32 s27, 0x00020000
    s_waitcnt vmcnt(8)
    s_mov_b64 exec, 1
    ds_add_u32 v4, v164 offset:112
    s_mov_b64 exec, -1
    ds_read_b32 v7, v1 offset:32
FW_1:
    s_waitcnt lgkmcnt(0)
    v_cmp_gt_u32 vcc, 1, v7
    s_cbranch_vccz FO_2
    s_sleep 2
    ds_read_b32 v7, v1 offset:32
    s_branch FW_1
FO_2:
    ds_read_b32 v7, v1 offset:112
FW_3:
    s_waitcnt lgkmcnt(0)
    v_cmp_gt_u32 vcc, 1, v7
    s_cbranch_vccz FO_4
    ds_read_b32 v7, v1 offset:112
    s_branch FW_3
FO_4:
    s_nop 0
    ds_read_b64_tr_b16 v[128:129], v10 offset:57344
    ds_read_b64_tr_b16 v[130:131], v10 offset:57856
    ds_read_b64_tr_b16 v[136:137], v11 offset:57344
    ds_read_b64_tr_b16 v[138:139], v11 offset:57856
    ds_read_b64_tr_b16 v[160:161], v12 offset:57344
    ds_read_b64_tr_b16 v[162:163], v12 offset:57856
    ds_read_b64_tr_b16 v[116:117], v13 offset:57344
    ds_read_b64_tr_b16 v[118:119], v13 offset:57856
    ds_read_b64_tr_b16 v[72:73], v10 offset:61440
    ds_read_b64_tr_b16 v[74:75], v10 offset:61952
    s_waitcnt lgkmcnt(8)
    v_mfma_f32_16x16x32_bf16 v[16:19], v[128:131], v[48:51], v[16:19]
    v_mfma_f32_16x16x32_bf16 v[32:35], v[128:131], v[52:55], v[32:35]
    ds_read_b64_tr_b16 v[128:129], v11 offset:61440
    ds_read_b64_tr_b16 v[130:131], v11 offset:61952
    s_waitcnt lgkmcnt(8)
    v_mfma_f32_16x16x32_bf16 v[20:23], v[136:139], v[48:51], v[20:23]
    v_mfma_f32_16x16x32_bf16 v[36:39], v[136:139], v[52:55], v[36:39]
    ds_read_b64_tr_b16 v[136:137], v12 offset:61440
    ds_read_b64_tr_b16 v[138:139], v12 offset:61952
    s_waitcnt lgkmcnt(8)
    v_mfma_f32_16x16x32_bf16 v[24:27], v[160:163], v[48:51], v[24:27]
    v_mfma_f32_16x16x32_bf16 v[40:43], v[160:163], v[52:55], v[40:43]
    ds_read_b64_tr_b16 v[160:161], v13 offset:61440
    ds_read_b64_tr_b16 v[162:163], v13 offset:61952
    s_waitcnt lgkmcnt(8)
    v_mfma_f32_16x16x32_bf16 v[28:31], v[116:119], v[48:51], v[28:31]
    ds_read_b128 v[48:51], v2 offset:0
    v_mfma_f32_16x16x32_bf16 v[44:47], v[116:119], v[52:55], v[44:47]
    ds_read_b64_tr_b16 v[116:117], v10 offset:49152
    ds_read_b64_tr_b16 v[118:119], v10 offset:49664
    s_waitcnt lgkmcnt(9)
    v_mfma_f32_16x16x32_bf16 v[16:19], v[72:75], v[96:99], v[16:19]
    ds_read_b128 v[52:55], v2 offset:2048
    v_mfma_f32_16x16x32_bf16 v[32:35], v[72:75], v[104:107], v[32:35]
    ds_read_b64_tr_b16 v[72:73], v11 offset:49152
    ds_read_b64_tr_b16 v[74:75], v11 offset:49664
    s_waitcnt lgkmcnt(10)
    v_mfma_f32_16x16x32_bf16 v[20:23], v[128:131], v[96:99], v[20:23]
    v_mfma_f32_16x16x32_bf16 v[36:39], v[128:131], v[104:107], v[36:39]
    ds_read_b64_tr_b16 v[128:129], v12 offset:49152
    ds_read_b64_tr_b16 v[130:131], v12 offset:49664
    s_waitcnt lgkmcnt(10)
    v_mfma_f32_16x16x32_bf16 v[24:27], v[136:139], v[96:99], v[24:27]
    v_mfma_f32_16x16x32_bf16 v[40:43], v[136:139], v[104:107], v[40:43]
    ds_read_b64_tr_b16 v[136:137], v13 offset:49152
    ds_read_b64_tr_b16 v[138:139], v13 offset:49664
    s_waitcnt lgkmcnt(10)
    v_mfma_f32_16x16x32_bf16 v[28:31], v[160:163], v[96:99], v[28:31]
    ds_read_b128 v[96:99], v3 offset:0
    v_mfma_f32_16x16x32_bf16 v[44:47], v[160:163], v[104:107], v[44:47]
    ds_read_b64_tr_b16 v[160:161], v10 offset:53248
    ds_read_b64_tr_b16 v[162:163], v10 offset:53760
    s_waitcnt lgkmcnt(10)
    v_mfma_f32_16x16x32_bf16 v[16:19], v[116:119], v[48:51], v[16:19]
    ds_read_b128 v[104:107], v3 offset:2048
    s_waitcnt lgkmcnt(10)
    v_mfma_f32_16x16x32_bf16 v[32:35], v[116:119], v[52:55], v[32:35]
    ds_read_b64_tr_b16 v[116:117], v11 offset:53248
    ds_read_b64_tr_b16 v[118:119], v11 offset:53760
    s_waitcnt lgkmcnt(10)
    v_mfma_f32_16x16x32_bf16 v[20:23], v[72:75], v[48:51], v[20:23]
    v_mfma_f32_16x16x32_bf16 v[36:39], v[72:75], v[52:55], v[36:39]
    ds_read_b64_tr_b16 v[72:73], v12 offset:53248
    ds_read_b64_tr_b16 v[74:75], v12 offset:53760
    s_waitcnt lgkmcnt(10)
    v_mfma_f32_16x16x32_bf16 v[24:27], v[128:131], v[48:51], v[24:27]
    v_mfma_f32_16x16x32_bf16 v[40:43], v[128:131], v[52:55], v[40:43]
    ds_read_b64_tr_b16 v[128:129], v13 offset:53248
    ds_read_b64_tr_b16 v[130:131], v13 offset:53760
    s_waitcnt lgkmcnt(10)
    v_mfma_f32_16x16x32_bf16 v[28:31], v[136:139], v[48:51], v[28:31]
    ds_read_b128 v[48:51], v2 offset:16384
    v_mfma_f32_16x16x32_bf16 v[44:47], v[136:139], v[52:55], v[44:47]
    ds_read_b64_tr_b16 v[136:137], v10 offset:40960
    ds_read_b64_tr_b16 v[138:139], v10 offset:41472
    s_waitcnt lgkmcnt(10)
    v_mfma_f32_16x16x32_bf16 v[16:19], v[160:163], v[96:99], v[16:19]
    ds_read_b128 v[52:55], v2 offset:18432
    s_waitcnt lgkmcnt(10)
    v_mfma_f32_16x16x32_bf16 v[32:35], v[160:163], v[104:107], v[32:35]
    ds_read_b64_tr_b16 v[160:161], v11 offset:40960
    ds_read_b64_tr_b16 v[162:163], v11 offset:41472
    s_waitcnt lgkmcnt(10)
    v_mfma_f32_16x16x32_bf16 v[20:23], v[116:119], v[96:99], v[20:23]
    v_mfma_f32_16x16x32_bf16 v[36:39], v[116:119], v[104:107], v[36:39]
    ds_read_b64_tr_b16 v[116:117], v12 offset:40960
    ds_read_b64_tr_b16 v[118:119], v12 offset:41472
    s_waitcnt lgkmcnt(10)
    v_mfma_f32_16x16x32_bf16 v[24:27], v[72:75], v[96:99], v[24:27]
    v_mfma_f32_16x16x32_bf16 v[40:43], v[72:75], v[104:107], v[40:43]
    ds_read_b64_tr_b16 v[72:73], v13 offset:40960
    ds_read_b64_tr_b16 v[74:75], v13 offset:41472
    s_waitcnt lgkmcnt(10)
    v_mfma_f32_16x16x32_bf16 v[28:31], v[128:131], v[96:99], v[28:31]
    ds_read_b128 v[96:99], v3 offset:16384
    v_mfma_f32_16x16x32_bf16 v[44:47], v[128:131], v[104:107], v[44:47]
    ds_read_b64_tr_b16 v[128:129], v10 offset:45056
    ds_read_b64_tr_b16 v[130:131], v10 offset:45568
    s_waitcnt lgkmcnt(10)
    v_mfma_f32_16x16x32_bf16 v[16:19], v[136:139], v[48:51], v[16:19]
    ds_read_b128 v[104:107], v3 offset:18432
    s_waitcnt lgkmcnt(10)
    v_mfma_f32_16x16x32_bf16 v[32:35], v[136:139], v[52:55], v[32:35]
    ds_read_b64_tr_b16 v[136:137], v11 offset:45056
    ds_read_b64_tr_b16 v[138:139], v11 offset:45568
    s_waitcnt lgkmcnt(10)
    v_mfma_f32_16x16x32_bf16 v[20:23], v[160:163], v[48:51], v[20:23]
    v_mfma_f32_16x16x32_bf16 v[36:39], v[160:163], v[52:55], v[36:39]
    ds_read_b64_tr_b16 v[160:161], v12 offset:45056
    ds_read_b64_tr_b16 v[162:163], v12 offset:45568
    s_waitcnt lgkmcnt(10)
    v_mfma_f32_16x16x32_bf16 v[24:27], v[116:119], v[48:51], v[24:27]
    v_mfma_f32_16x16x32_bf16 v[40:43], v[116:119], v[52:55], v[40:43]
    ds_read_b64_tr_b16 v[116:117], v13 offset:45056
    ds_read_b64_tr_b16 v[118:119], v13 offset:45568
    s_waitcnt lgkmcnt(10)
    v_mfma_f32_16x16x32_bf16 v[28:31], v[72:75], v[48:51], v[28:31]
    ds_read_b128 v[48:51], v2 offset:32768
    v_mfma_f32_16x16x32_bf16 v[44:47], v[72:75], v[52:55], v[44:47]
    ds_read_b64_tr_b16 v[72:73], v5 offset:16384
    ds_read_b64_tr_b16 v[74:75], v5 offset:16896
    s_waitcnt lgkmcnt(10)
    v_mfma_f32_16x16x32_bf16 v[16:19], v[128:131], v[96:99], v[16:19]
    ds_read_b128 v[52:55], v2 offset:34816
    s_waitcnt lgkmcnt(10)
    v_mfma_f32_16x16x32_bf16 v[32:35], v[128:131], v[104:107], v[32:35]
    ds_read_b64_tr_b16 v[128:129], v6 offset:16384
    ds_read_b64_tr_b16 v[130:131], v6 offset:16896
    s_waitcnt lgkmcnt(10)
    v_mfma_f32_16x16x32_bf16 v[20:23], v[136:139], v[96:99], v[20:23]
    v_mfma_f32_16x16x32_bf16 v[36:39], v[136:139], v[104:107], v[36:39]
    ds_read_b64_tr_b16 v[136:137], v8 offset:16384
    ds_read_b64_tr_b16 v[138:139], v8 offset:16896
    s_waitcnt lgkmcnt(10)
    v_mfma_f32_16x16x32_bf16 v[24:27], v[160:163], v[96:99], v[24:27]
    v_mfma_f32_16x16x32_bf16 v[40:43], v[160:163], v[104:107], v[40:43]
    ds_read_b64_tr_b16 v[160:161], v9 offset:16384
    ds_read_b64_tr_b16 v[162:163], v9 offset:16896
    s_waitcnt lgkmcnt(10)
    v_mfma_f32_16x16x32_bf16 v[28:31], v[116:119], v[96:99], v[28:31]
    ds_read_b128 v[96:99], v3 offset:32768
    v_mfma_f32_16x16x32_bf16 v[44:47], v[116:119], v[104:107], v[44:47]
    ds_read_b64_tr_b16 v[116:117], v5 offset:20480
    ds_read_b64_tr_b16 v[118:119], v5 offset:20992
    s_waitcnt lgkmcnt(10)
    v_mfma_f32_16x16x32_bf16 v[16:19], v[72:75], v[48:51], v[16:19]
    ds_read_b128 v[104:107], v3 offset:34816
    s_waitcnt lgkmcnt(10)
    v_mfma_f32_16x16x32_bf16 v[32:35], v[72:75], v[52:55], v[32:35]
    ds_read_b64_tr_b16 v[72:73], v6 offset:20480
    ds_read_b64_tr_b16 v[74:75], v6 offset:20992
    s_waitcnt lgkmcnt(10)
    v_mfma_f32_16x16x32_bf16 v[20:23], v[128:131], v[48:51], v[20:23]
    v_mfma_f32_16x16x32_bf16 v[36:39], v[128:131], v[52:55], v[36:39]
    ds_read_b64_tr_b16 v[128:129], v8 offset:20480
    ds_read_b64_tr_b16 v[130:131], v8 offset:20992
    s_waitcnt lgkmcnt(10)
    v_mfma_f32_16x16x32_bf16 v[24:27], v[136:139], v[48:51], v[24:27]
    v_mfma_f32_16x16x32_bf16 v[40:43], v[136:139], v[52:55], v[40:43]
    ds_read_b64_tr_b16 v[136:137], v9 offset:20480
    ds_read_b64_tr_b16 v[138:139], v9 offset:20992
    s_waitcnt lgkmcnt(10)
    v_mfma_f32_16x16x32_bf16 v[28:31], v[160:163], v[48:51], v[28:31]
    s_waitcnt vmcnt(0)
    s_mov_b64 exec, 1
    ds_add_u32 v4, v164 offset:112
    s_mov_b64 exec, -1
    ds_read_b128 v[48:51], v2 offset:49152
    v_mfma_f32_16x16x32_bf16 v[44:47], v[160:163], v[52:55], v[44:47]
    ds_read_b64_tr_b16 v[160:161], v5 offset:8192
    ds_read_b64_tr_b16 v[162:163], v5 offset:8704
    s_waitcnt lgkmcnt(11)
    v_mfma_f32_16x16x32_bf16 v[16:19], v[116:119], v[96:99], v[16:19]
    ds_read_b128 v[52:55], v2 offset:51200
    s_waitcnt lgkmcnt(11)
    v_mfma_f32_16x16x32_bf16 v[32:35], v[116:119], v[104:107], v[32:35]
    ds_read_b64_tr_b16 v[116:117], v6 offset:8192
    ds_read_b64_tr_b16 v[118:119], v6 offset:8704
    s_waitcnt lgkmcnt(11)
    v_mfma_f32_16x16x32_bf16 v[20:23], v[72:75], v[96:99], v[20:23]
    v_mfma_f32_16x16x32_bf16 v[36:39], v[72:75], v[104:107], v[36:39]
    ds_read_b64_tr_b16 v[72:73], v8 offset:8192
    ds_read_b64_tr_b16 v[74:75], v8 offset:8704
    s_waitcnt lgkmcnt(9)
    v_mov_b32 v165, 4
    s_mov_b64 exec, 1
    ds_write_b32 v4, v165 offset:0
    s_mov_b64 exec, -1
    s_nop 0
    v_mfma_f32_16x16x32_bf16 v[24:27], v[128:131], v[96:99], v[24:27]
    v_mfma_f32_16x16x32_bf16 v[40:43], v[128:131], v[104:107], v[40:43]
    ds_read_b64_tr_b16 v[128:129], v9 offset:8192
    ds_read_b64_tr_b16 v[130:131], v9 offset:8704
    v_mfma_f32_16x16x32_bf16 v[28:31], v[136:139], v[96:99], v[28:31]
    ds_read_b128 v[96:99], v3 offset:49152
    v_mfma_f32_16x16x32_bf16 v[44:47], v[136:139], v[104:107], v[44:47]
    ds_read_b64_tr_b16 v[136:137], v5 offset:12288
    ds_read_b64_tr_b16 v[138:139], v5 offset:12800
    s_waitcnt lgkmcnt(11)
    v_mfma_f32_16x16x32_bf16 v[16:19], v[160:163], v[48:51], v[16:19]
    ds_read_b128 v[104:107], v3 offset:51200
    s_waitcnt lgkmcnt(11)
    v_mfma_f32_16x16x32_bf16 v[32:35], v[160:163], v[52:55], v[32:35]
    ds_read_b64_tr_b16 v[160:161], v6 offset:12288
    ds_read_b64_tr_b16 v[162:163], v6 offset:12800
    s_waitcnt lgkmcnt(11)
    v_mfma_f32_16x16x32_bf16 v[20:23], v[116:119], v[48:51], v[20:23]
    v_mfma_f32_16x16x32_bf16 v[36:39], v[116:119], v[52:55], v[36:39]
    ds_read_b64_tr_b16 v[116:117], v8 offset:12288
    ds_read_b64_tr_b16 v[118:119], v8 offset:12800
    s_waitcnt lgkmcnt(11)
    v_mfma_f32_16x16x32_bf16 v[24:27], v[72:75], v[48:51], v[24:27]
    v_mfma_f32_16x16x32_bf16 v[40:43], v[72:75], v[52:55], v[40:43]
    ds_read_b64_tr_b16 v[72:73], v9 offset:12288
    ds_read_b64_tr_b16 v[74:75], v9 offset:12800
    s_waitcnt lgkmcnt(10)
    v_mfma_f32_16x16x32_bf16 v[28:31], v[128:131], v[48:51], v[28:31]
    ds_read_b64_tr_b16 v[48:49], v10 offset:8192
    v_mfma_f32_16x16x32_bf16 v[44:47], v[128:131], v[52:55], v[44:47]
    ds_read_b64_tr_b16 v[50:51], v10 offset:8704
    ds_read_b64_tr_b16 v[128:129], v11 offset:8192
    s_waitcnt lgkmcnt(10)
    v_mfma_f32_16x16x32_bf16 v[16:19], v[136:139], v[96:99], v[16:19]
    ds_read_b64_tr_b16 v[130:131], v11 offset:8704
    s_waitcnt lgkmcnt(10)
    v_mfma_f32_16x16x32_bf16 v[32:35], v[136:139], v[104:107], v[32:35]
    ds_read_b64_tr_b16 v[52:53], v12 offset:8192
    ds_read_b64_tr_b16 v[54:55], v12 offset:8704
    s_waitcnt lgkmcnt(10)
    v_mfma_f32_16x16x32_bf16 v[20:23], v[160:163], v[96:99], v[20:23]
    ds_read_b64_tr_b16 v[136:137], v13 offset:8192
    v_mfma_f32_16x16x32_bf16 v[36:39], v[160:163], v[104:107], v[36:39]
    ds_read_b64_tr_b16 v[138:139], v13 offset:8704
    ds_read_b64_tr_b16 v[160:161], v10 offset:12288
    s_waitcnt lgkmcnt(11)
    v_mfma_f32_16x16x32_bf16 v[24:27], v[116:119], v[96:99], v[24:27]
    ds_read_b64_tr_b16 v[162:163], v10 offset:12800
    v_mfma_f32_16x16x32_bf16 v[40:43], v[116:119], v[104:107], v[40:43]
    ds_read_b64_tr_b16 v[116:117], v11 offset:12288
    ds_read_b64_tr_b16 v[118:119], v11 offset:12800
    s_waitcnt lgkmcnt(12)
    v_mfma_f32_16x16x32_bf16 v[28:31], v[72:75], v[96:99], v[28:31]
    ds_read_b64_tr_b16 v[96:97], v12 offset:12288
    v_mfma_f32_16x16x32_bf16 v[44:47], v[72:75], v[104:107], v[44:47]
    ds_read_b64_tr_b16 v[98:99], v12 offset:12800
    ds_read_b64_tr_b16 v[72:73], v13 offset:12288
    s_waitcnt lgkmcnt(13)
    v_mfma_f32_16x16x32_bf16 v[16:19], v[48:51], v[60:63], v[16:19]
    ds_read_b64_tr_b16 v[74:75], v13 offset:12800
    v_mfma_f32_16x16x32_bf16 v[32:35], v[48:51], v[132:135], v[32:35]
    ds_read_b32 v7, v1 offset:112
FW_5:
    s_waitcnt lgkmcnt(0)
    v_cmp_gt_u32 vcc, 2, v7
    s_cbranch_vccz FO_6
    ds_read_b32 v7, v1 offset:112
    s_branch FW_5
FO_6:
    s_nop 0
    ds_read_b64_tr_b16 v[104:105], v10 offset:0
    ds_read_b64_tr_b16 v[106:107], v10 offset:512
    v_mfma_f32_16x16x32_bf16 v[20:23], v[128:131], v[60:63], v[20:23]
    ds_read_b64_tr_b16 v[48:49], v11 offset:0
    v_mfma_f32_16x16x32_bf16 v[36:39], v[128:131], v[132:135], v[36:39]
    ds_read_b64_tr_b16 v[50:51], v11 offset:512
    ds_read_b64_tr_b16 v[128:129], v12 offset:0
    v_mfma_f32_16x16x32_bf16 v[24:27], v[52:55], v[60:63], v[24:27]
    ds_read_b64_tr_b16 v[130:131], v12 offset:512
    v_mfma_f32_16x16x32_bf16 v[40:43], v[52:55], v[132:135], v[40:43]
    ds_read_b64_tr_b16 v[52:53], v13 offset:0
    ds_read_b64_tr_b16 v[54:55], v13 offset:512
    v_mfma_f32_16x16x32_bf16 v[28:31], v[136:139], v[60:63], v[28:31]
    v_mfma_f32_16x16x32_bf16 v[44:47], v[136:139], v[132:135], v[44:47]
    v_mfma_f32_16x16x32_bf16 v[16:19], v[160:163], v[68:71], v[16:19]
    ds_read_b64_tr_b16 v[60:61], v10 offset:4096
    v_mfma_f32_16x16x32_bf16 v[32:35], v[160:163], v[152:155], v[32:35]
    ds_read_b64_tr_b16 v[62:63], v10 offset:4608
    ds_read_b64_tr_b16 v[136:137], v11 offset:4096
    v_mfma_f32_16x16x32_bf16 v[20:23], v[116:119], v[68:71], v[20:23]
    ds_read_b64_tr_b16 v[138:139], v11 offset:4608
    v_mfma_f32_16x16x32_bf16 v[36:39], v[116:119], v[152:155], v[36:39]
    ds_read_b64_tr_b16 v[132:133], v12 offset:4096
    ds_read_b64_tr_b16 v[134:135], v12 offset:4608
    v_mfma_f32_16x16x32_bf16 v[24:27], v[96:99], v[68:71], v[24:27]
    ds_read_b64_tr_b16 v[160:161], v13 offset:4096
    v_mfma_f32_16x16x32_bf16 v[40:43], v[96:99], v[152:155], v[40:43]
    s_waitcnt lgkmcnt(8)
    ds_read_b64_tr_b16 v[162:163], v13 offset:4608
    v_mfma_f32_16x16x32_bf16 v[28:31], v[72:75], v[68:71], v[28:31]
    v_mfma_f32_16x16x32_bf16 v[44:47], v[72:75], v[152:155], v[44:47]
    s_waitcnt lgkmcnt(14)
    v_mfma_f32_16x16x32_bf16 v[16:19], v[104:107], v[84:87], v[16:19]
    ds_read_b64_tr_b16 v[116:117], v10 offset:24576
    v_mfma_f32_16x16x32_bf16 v[32:35], v[104:107], v[92:95], v[32:35]
    ds_read_b64_tr_b16 v[118:119], v10 offset:25088
    ds_read_b64_tr_b16 v[96:97], v11 offset:24576
    s_waitcnt lgkmcnt(15)
    v_mfma_f32_16x16x32_bf16 v[20:23], v[48:51], v[84:87], v[20:23]
    ds_read_b64_tr_b16 v[98:99], v11 offset:25088
    v_mfma_f32_16x16x32_bf16 v[36:39], v[48:51], v[92:95], v[36:39]
    ds_read_b64_tr_b16 v[68:69], v12 offset:24576
    ds_read_b64_tr_b16 v[70:71], v12 offset:25088
    s_waitcnt lgkmcnt(15)
    v_mfma_f32_16x16x32_bf16 v[24:27], v[128:131], v[84:87], v[24:27]
    s_waitcnt lgkmcnt(8)
    ds_read_b64_tr_b16 v[72:73], v13 offset:24576
    v_mfma_f32_16x16x32_bf16 v[40:43], v[128:131], v[92:95], v[40:43]
    ds_read_b64_tr_b16 v[74:75], v13 offset:25088
    s_waitcnt lgkmcnt(15)
    v_mfma_f32_16x16x32_bf16 v[28:31], v[52:55], v[84:87], v[28:31]
    v_mfma_f32_16x16x32_bf16 v[44:47], v[52:55], v[92:95], v[44:47]
    s_waitcnt lgkmcnt(14)
    v_mfma_f32_16x16x32_bf16 v[16:19], v[60:63], v[100:103], v[16:19]
    ds_read_b64_tr_b16 v[152:153], v10 offset:28672
    v_mfma_f32_16x16x32_bf16 v[32:35], v[60:63], v[108:111], v[32:35]
    ds_read_b64_tr_b16 v[154:155], v10 offset:29184
    ds_read_b64_tr_b16 v[104:105], v11 offset:28672
    s_waitcnt lgkmcnt(15)
    v_mfma_f32_16x16x32_bf16 v[20:23], v[136:139], v[100:103], v[20:23]
    ds_read_b64_tr_b16 v[106:107], v11 offset:29184
    v_mfma_f32_16x16x32_bf16 v[36:39], v[136:139], v[108:111], v[36:39]
    ds_read_b64_tr_b16 v[48:49], v12 offset:28672
    s_waitcnt lgkmcnt(8)
    ds_read_b64_tr_b16 v[50:51], v12 offset:29184
    s_waitcnt lgkmcnt(15)
    v_mfma_f32_16x16x32_bf16 v[24:27], v[132:135], v[100:103], v[24:27]
    ds_read_b64_tr_b16 v[128:129], v13 offset:28672
    v_mfma_f32_16x16x32_bf16 v[40:43], v[132:135], v[108:111], v[40:43]
    ds_read_b64_tr_b16 v[130:131], v13 offset:29184
    s_waitcnt lgkmcnt(15)
    v_mfma_f32_16x16x32_bf16 v[28:31], v[160:163], v[100:103], v[28:31]
    v_mfma_f32_16x16x32_bf16 v[44:47], v[160:163], v[108:111], v[44:47]
    s_waitcnt lgkmcnt(14)
    v_mfma_f32_16x16x32_bf16 v[16:19], v[116:119], v[56:59], v[16:19]
    ds_read_b64_tr_b16 v[84:85], v10 offset:16384
    v_mfma_f32_16x16x32_bf16 v[32:35], v[116:119], v[124:127], v[32:35]
    ds_read_b64_tr_b16 v[86:87], v10 offset:16896
    ds_read_b64_tr_b16 v[52:53], v11 offset:16384
    s_waitcnt lgkmcnt(15)
    v_mfma_f32_16x16x32_bf16 v[20:23], v[96:99], v[56:59], v[20:23]
    ds_read_b64_tr_b16 v[54:55], v11 offset:16896
    v_mfma_f32_16x16x32_bf16 v[36:39], v[96:99], v[124:127], v[36:39]
    s_waitcnt lgkmcnt(8)
    ds_read_b64_tr_b16 v[92:93], v12 offset:16384
    ds_read_b64_tr_b16 v[94:95], v12 offset:16896
    s_waitcnt lgkmcnt(15)
    v_mfma_f32_16x16x32_bf16 v[24:27], v[68:71], v[56:59], v[24:27]
    ds_read_b64_tr_b16 v[60:61], v13 offset:16384
    v_mfma_f32_16x16x32_bf16 v[40:43], v[68:71], v[124:127], v[40:43]
    ds_read_b64_tr_b16 v[62:63], v13 offset:16896
    s_waitcnt lgkmcnt(15)
    v_mfma_f32_16x16x32_bf16 v[28:31], v[72:75], v[56:59], v[28:31]
    v_mfma_f32_16x16x32_bf16 v[44:47], v[72:75], v[124:127], v[44:47]
    s_waitcnt lgkmcnt(14)
    v_mfma_f32_16x16x32_bf16 v[16:19], v[152:155], v[76:79], v[16:19]
    ds_read_b64_tr_b16 v[136:137], v10 offset:20480
    v_mfma_f32_16x16x32_bf16 v[32:35], v[152:155], v[148:151], v[32:35]
    ds_read_b64_tr_b16 v[138:139], v10 offset:20992
    ds_read_b64_tr_b16 v[132:133], v11 offset:20480
    s_waitcnt lgkmcnt(15)
    v_mfma_f32_16x16x32_bf16 v[20:23], v[104:107], v[76:79], v[20:23]
    s_waitcnt lgkmcnt(8)
    ds_read_b64_tr_b16 v[134:135], v11 offset:20992
    v_mfma_f32_16x16x32_bf16 v[36:39], v[104:107], v[148:151], v[36:39]
    ds_read_b64_tr_b16 v[100:101], v12 offset:20480
    ds_read_b64_tr_b16 v[102:103], v12 offset:20992
    s_waitcnt lgkmcnt(15)
    v_mfma_f32_16x16x32_bf16 v[24:27], v[48:51], v[76:79], v[24:27]
    ds_read_b64_tr_b16 v[160:161], v13 offset:20480
    v_mfma_f32_16x16x32_bf16 v[40:43], v[48:51], v[148:151], v[40:43]
    ds_read_b64_tr_b16 v[162:163], v13 offset:20992
    s_waitcnt lgkmcnt(15)
    v_mfma_f32_16x16x32_bf16 v[28:31], v[128:131], v[76:79], v[28:31]
    v_mfma_f32_16x16x32_bf16 v[44:47], v[128:131], v[148:151], v[44:47]
    s_waitcnt lgkmcnt(14)
    v_mfma_f32_16x16x32_bf16 v[16:19], v[84:87], v[88:91], v[16:19]
    ds_read_b64_tr_b16 v[108:109], v10 offset:32768
    v_mfma_f32_16x16x32_bf16 v[32:35], v[84:87], v[64:67], v[32:35]
    ds_read_b64_tr_b16 v[110:111], v10 offset:33280
    s_waitcnt lgkmcnt(8)
    ds_read_b64_tr_b16 v[116:117], v11 offset:32768
    s_waitcnt lgkmcnt(15)
    v_mfma_f32_16x16x32_bf16 v[20:23], v[52:55], v[88:91], v[20:23]
    ds_read_b64_tr_b16 v[118:119], v11 offset:33280
    v_mfma_f32_16x16x32_bf16 v[36:39], v[52:55], v[64:67], v[36:39]
    ds_read_b64_tr_b16 v[96:97], v12 offset:32768
    ds_read_b64_tr_b16 v[98:99], v12 offset:33280
    s_waitcnt lgkmcnt(15)
    v_mfma_f32_16x16x32_bf16 v[24:27], v[92:95], v[88:91], v[24:27]
    ds_read_b64_tr_b16 v[68:69], v13 offset:32768
    v_mfma_f32_16x16x32_bf16 v[40:43], v[92:95], v[64:67], v[40:43]
    ds_read_b64_tr_b16 v[70:71], v13 offset:33280
    s_waitcnt lgkmcnt(15)
    v_mfma_f32_16x16x32_bf16 v[28:31], v[60:63], v[88:91], v[28:31]
    v_mfma_f32_16x16x32_bf16 v[44:47], v[60:63], v[64:67], v[44:47]
    s_waitcnt lgkmcnt(14)
    v_mfma_f32_16x16x32_bf16 v[16:19], v[136:139], v[80:83], v[16:19]
    ds_read_b64_tr_b16 v[56:57], v10 offset:36864
    v_mfma_f32_16x16x32_bf16 v[32:35], v[136:139], v[112:115], v[32:35]
    s_waitcnt lgkmcnt(8)
    ds_read_b64_tr_b16 v[58:59], v10 offset:37376
    ds_read_b64_tr_b16 v[72:73], v11 offset:36864
    s_waitcnt lgkmcnt(15)
    v_mfma_f32_16x16x32_bf16 v[20:23], v[132:135], v[80:83], v[20:23]
    ds_read_b64_tr_b16 v[74:75], v11 offset:37376
    v_mfma_f32_16x16x32_bf16 v[36:39], v[132:135], v[112:115], v[36:39]
    ds_read_b64_tr_b16 v[124:125], v12 offset:36864
    ds_read_b64_tr_b16 v[126:127], v12 offset:37376
    s_waitcnt lgkmcnt(15)
    v_mfma_f32_16x16x32_bf16 v[24:27], v[100:103], v[80:83], v[24:27]
    ds_read_b64_tr_b16 v[152:153], v13 offset:36864
    v_mfma_f32_16x16x32_bf16 v[40:43], v[100:103], v[112:115], v[40:43]
    ds_read_b64_tr_b16 v[154:155], v13 offset:37376
    s_waitcnt lgkmcnt(15)
    v_mfma_f32_16x16x32_bf16 v[28:31], v[160:163], v[80:83], v[28:31]
    v_mfma_f32_16x16x32_bf16 v[44:47], v[160:163], v[112:115], v[44:47]
    s_waitcnt lgkmcnt(14)
    v_mfma_f32_16x16x32_bf16 v[16:19], v[108:111], v[140:143], v[16:19]
    v_mfma_f32_16x16x32_bf16 v[32:35], v[108:111], v[120:123], v[32:35]
    s_waitcnt lgkmcnt(12)
    v_mfma_f32_16x16x32_bf16 v[20:23], v[116:119], v[140:143], v[20:23]
    s_waitcnt lgkmcnt(0)
    v_mov_b32 v165, 10
    s_mov_b64 exec, 1
    ds_write_b32 v4, v165 offset:0
    s_mov_b64 exec, -1
    s_nop 0
    v_mfma_f32_16x16x32_bf16 v[36:39], v[116:119], v[120:123], v[36:39]
    v_mfma_f32_16x16x32_bf16 v[24:27], v[96:99], v[140:143], v[24:27]
    v_mfma_f32_16x16x32_bf16 v[40:43], v[96:99], v[120:123], v[40:43]
    v_mfma_f32_16x16x32_bf16 v[28:31], v[68:71], v[140:143], v[28:31]
    v_mfma_f32_16x16x32_bf16 v[44:47], v[68:71], v[120:123], v[44:47]
    v_mfma_f32_16x16x32_bf16 v[16:19], v[56:59], v[144:147], v[16:19]
    v_mfma_f32_16x16x32_bf16 v[32:35], v[56:59], v[156:159], v[32:35]
    v_mfma_f32_16x16x32_bf16 v[20:23], v[72:75], v[144:147], v[20:23]
    v_mfma_f32_16x16x32_bf16 v[36:39], v[72:75], v[156:159], v[36:39]
    v_mfma_f32_16x16x32_bf16 v[24:27], v[124:127], v[144:147], v[24:27]
    v_mfma_f32_16x16x32_bf16 v[40:43], v[124:127], v[156:159], v[40:43]
    v_mfma_f32_16x16x32_bf16 v[28:31], v[152:155], v[144:147], v[28:31]
    v_mfma_f32_16x16x32_bf16 v[44:47], v[152:155], v[156:159], v[44:47]
    s_setprio 3
    s_mov_b32 s40, 0x21317218
    s_mov_b32 s41, s40
    s_mov_b32 s74, 0x358637bd
    s_mov_b32 s75, s74
    s_mov_b32 s76, 0x5d800000
    s_mov_b32 s77, s76
    v_and_b32 v2, 15, v0
    v_lshlrev_b32 v2, 2, v2
    s_lshl_b32 s42, s3, 7
    s_add_u32 s42, s42, 155648
    v_add_u32 v2, s42, v2
    v_add_u32 v3, 1024, v2
    v_and_b32_e64 v5, 0x30, v0
    v_add_u32 v5, 158208, v5

    ds_read2_b32 v[48:49], v2 offset0:0 offset1:0
    ds_read2_b32 v[50:51], v2 offset0:16 offset1:16
    ds_read_b128 v[56:59], v5 offset:0
    ds_read_b128 v[60:63], v5 offset:64
    ds_read_b128 v[64:67], v5 offset:128
    ds_read_b128 v[68:71], v5 offset:192
    ds_read2_b32 v[52:53], v3 offset0:0 offset1:0
    ds_read2_b32 v[54:55], v3 offset0:16 offset1:16
    v_lshlrev_b32 v6, 4, v0
    v_lshlrev_b32 v8, 2, v0
    v_add_u32 v8, 65536, v8
    s_lshl_b32 s79, s32, 18
    s_lshl_b32 s80, s3, 16
    s_add_u32 s79, s79, s80
    s_lshl_b32 s80, s10, 11
    s_add_u32 s79, s79, s80
    s_add_u32 s80, s79, 0x8000
    s_lshl_b32 s45, s32, 2
    s_add_u32 s45, s45, s3
    s_lshl_b32 s45, s45, 9
    s_mov_b32 s46, 0x3fb8aa3b
    v_mov_b32 v11, 0x35c1a2a0

    s_add_u32 s54, s45, 0x831000
    s_add_u32 s54, s72, s54
    s_addc_u32 s55, s73, 0
    s_waitcnt lgkmcnt(5)
    v_pk_fma_f32 v[16:17], v[56:57], v[48:49], v[16:17]
    v_pk_fma_f32 v[18:19], v[58:59], v[48:49], v[18:19]
    v_pk_fma_f32 v[32:33], v[56:57], v[50:51], v[32:33]
    v_pk_fma_f32 v[34:35], v[58:59], v[50:51], v[34:35]
    s_waitcnt lgkmcnt(4)
    v_pk_fma_f32 v[20:21], v[60:61], v[48:49], v[20:21]
    v_pk_fma_f32 v[22:23], v[62:63], v[48:49], v[22:23]
    v_pk_fma_f32 v[36:37], v[60:61], v[50:51], v[36:37]
    v_pk_fma_f32 v[38:39], v[62:63], v[50:51], v[38:39]
    s_waitcnt lgkmcnt(3)
    s_branch IW_s2
IW_w2:
    s_branch IW_r2
IW_s2:
    v_pk_fma_f32 v[24:25], v[64:65], v[48:49], v[24:25]
    v_pk_fma_f32 v[26:27], v[66:67], v[48:49], v[26:27]
    v_pk_fma_f32 v[40:41], v[64:65], v[50:51], v[40:41]
    v_pk_fma_f32 v[42:43], v[66:67], v[50:51], v[42:43]
    s_waitcnt lgkmcnt(2)
    v_pk_fma_f32 v[28:29], v[68:69], v[48:49], v[28:29]
    v_pk_fma_f32 v[30:31], v[70:71], v[48:49], v[30:31]
    v_pk_fma_f32 v[44:45], v[68:69], v[50:51], v[44:45]
    v_pk_fma_f32 v[46:47], v[70:71], v[50:51], v[46:47]
    s_waitcnt lgkmcnt(1)
    s_nop 0
    v_pk_mul_f32 v[16:17], v[16:17], v[52:53]
    v_pk_mul_f32 v[18:19], v[18:19], v[52:53]
    v_pk_mul_f32 v[20:21], v[20:21], v[52:53]
    v_pk_mul_f32 v[22:23], v[22:23], v[52:53]
    v_pk_mul_f32 v[24:25], v[24:25], v[52:53]
    v_pk_mul_f32 v[26:27], v[26:27], v[52:53]
    v_pk_mul_f32 v[28:29], v[28:29], v[52:53]
    v_pk_mul_f32 v[30:31], v[30:31], v[52:53]
    s_waitcnt lgkmcnt(0)
    s_nop 0
    v_pk_mul_f32 v[32:33], v[32:33], v[54:55]
    v_pk_mul_f32 v[34:35], v[34:35], v[54:55]
    v_pk_mul_f32 v[36:37], v[36:37], v[54:55]
    v_pk_mul_f32 v[38:39], v[38:39], v[54:55]
    v_pk_mul_f32 v[40:41], v[40:41], v[54:55]
    v_pk_mul_f32 v[42:43], v[42:43], v[54:55]
    v_pk_mul_f32 v[44:45], v[44:45], v[54:55]
    v_pk_mul_f32 v[46:47], v[46:47], v[54:55]
    v_exp_f32 v80, v16 clamp
    v_exp_f32 v81, v17 clamp
    v_exp_f32 v82, v18 clamp
    v_exp_f32 v83, v19 clamp
    v_exp_f32 v84, v20 clamp
    v_exp_f32 v85, v21 clamp
    v_exp_f32 v86, v22 clamp
    v_exp_f32 v87, v23 clamp
    v_exp_f32 v88, v24 clamp
    v_exp_f32 v89, v25 clamp
    v_exp_f32 v90, v26 clamp
    v_exp_f32 v91, v27 clamp
    v_exp_f32 v92, v28 clamp
    v_exp_f32 v93, v29 clamp
    v_exp_f32 v94, v30 clamp
    v_exp_f32 v95, v31 clamp
    v_exp_f32 v96, v32 clamp
    v_exp_f32 v97, v33 clamp
    v_exp_f32 v98, v34 clamp
    v_exp_f32 v99, v35 clamp
    v_exp_f32 v100, v36 clamp
    v_exp_f32 v101, v37 clamp
    v_exp_f32 v102, v38 clamp
    v_exp_f32 v103, v39 clamp
    v_exp_f32 v104, v40 clamp
    v_exp_f32 v105, v41 clamp
    v_exp_f32 v106, v42 clamp
    v_exp_f32 v107, v43 clamp
    v_exp_f32 v108, v44 clamp
    v_exp_f32 v109, v45 clamp
    v_exp_f32 v110, v46 clamp
    v_exp_f32 v111, v47 clamp
    v_pk_mul_f32 v[16:17], v[16:17], s[40:41] clamp
    v_pk_mul_f32 v[18:19], v[18:19], s[40:41] clamp
    v_pk_mul_f32 v[20:21], v[20:21], s[40:41] clamp
    v_pk_mul_f32 v[22:23], v[22:23], s[40:41] clamp
    v_pk_mul_f32 v[24:25], v[24:25], s[40:41] clamp
    v_pk_mul_f32 v[26:27], v[26:27], s[40:41] clamp
    v_pk_mul_f32 v[28:29], v[28:29], s[40:41] clamp
    v_pk_mul_f32 v[30:31], v[30:31], s[40:41] clamp
    v_pk_mul_f32 v[32:33], v[32:33], s[40:41] clamp
    v_pk_mul_f32 v[34:35], v[34:35], s[40:41] clamp
    v_pk_mul_f32 v[36:37], v[36:37], s[40:41] clamp
    v_pk_mul_f32 v[38:39], v[38:39], s[40:41] clamp
    v_pk_mul_f32 v[40:41], v[40:41], s[40:41] clamp
    v_pk_mul_f32 v[42:43], v[42:43], s[40:41] clamp
    v_pk_mul_f32 v[44:45], v[44:45], s[40:41] clamp
    v_pk_mul_f32 v[46:47], v[46:47], s[40:41] clamp
    v_pk_add_f32 v[80:81], v[80:81], s[74:75]
    v_pk_add_f32 v[82:83], v[82:83], s[74:75]
    v_pk_add_f32 v[84:85], v[84:85], s[74:75]
    v_pk_add_f32 v[86:87], v[86:87], s[74:75]
    v_pk_add_f32 v[88:89], v[88:89], s[74:75]
    v_pk_add_f32 v[90:91], v[90:91], s[74:75]
    v_pk_add_f32 v[92:93], v[92:93], s[74:75]
    v_pk_add_f32 v[94:95], v[94:95], s[74:75]
    v_pk_add_f32 v[96:97], v[96:97], s[74:75]
    v_pk_add_f32 v[98:99], v[98:99], s[74:75]
    v_pk_add_f32 v[100:101], v[100:101], s[74:75]
    v_pk_add_f32 v[102:103], v[102:103], s[74:75]
    v_pk_add_f32 v[104:105], v[104:105], s[74:75]
    v_pk_add_f32 v[106:107], v[106:107], s[74:75]
    v_pk_add_f32 v[108:109], v[108:109], s[74:75]
    v_pk_add_f32 v[110:111], v[110:111], s[74:75]
    v_pk_fma_f32 v[16:17], v[16:17], s[76:77], v[80:81]
    v_pk_fma_f32 v[18:19], v[18:19], s[76:77], v[82:83]
    v_pk_fma_f32 v[20:21], v[20:21], s[76:77], v[84:85]
    v_pk_fma_f32 v[22:23], v[22:23], s[76:77], v[86:87]
    v_pk_fma_f32 v[24:25], v[24:25], s[76:77], v[88:89]
    v_pk_fma_f32 v[26:27], v[26:27], s[76:77], v[90:91]
    v_pk_fma_f32 v[28:29], v[28:29], s[76:77], v[92:93]
    v_pk_fma_f32 v[30:31], v[30:31], s[76:77], v[94:95]
    v_pk_fma_f32 v[32:33], v[32:33], s[76:77], v[96:97]
    v_pk_fma_f32 v[34:35], v[34:35], s[76:77], v[98:99]
    v_pk_fma_f32 v[36:37], v[36:37], s[76:77], v[100:101]
    v_pk_fma_f32 v[38:39], v[38:39], s[76:77], v[102:103]
    v_pk_fma_f32 v[40:41], v[40:41], s[76:77], v[104:105]
    v_pk_fma_f32 v[42:43], v[42:43], s[76:77], v[106:107]
    v_pk_fma_f32 v[44:45], v[44:45], s[76:77], v[108:109]
    v_pk_fma_f32 v[46:47], v[46:47], s[76:77], v[110:111]
    v_cvt_pk_bf16_f32 v112, v16, v17
    v_cvt_pk_bf16_f32 v113, v18, v19
    v_cvt_pk_bf16_f32 v114, v20, v21
    v_cvt_pk_bf16_f32 v115, v22, v23
    v_cvt_pk_bf16_f32 v116, v24, v25
    v_cvt_pk_bf16_f32 v117, v26, v27
    v_cvt_pk_bf16_f32 v118, v28, v29
    v_cvt_pk_bf16_f32 v119, v30, v31
    v_cvt_pk_bf16_f32 v120, v32, v33
    v_cvt_pk_bf16_f32 v121, v34, v35
    v_cvt_pk_bf16_f32 v122, v36, v37
    v_cvt_pk_bf16_f32 v123, v38, v39
    v_cvt_pk_bf16_f32 v124, v40, v41
    v_cvt_pk_bf16_f32 v125, v42, v43
    v_cvt_pk_bf16_f32 v126, v44, v45
    v_cvt_pk_bf16_f32 v127, v46, v47
    v_and_b32 v9, 0xfffffff7, v1
    v_and_b32 v5, 0x30, v0
    v_add_u32 v5, 159232, v5
    ds_read_b32 v7, v9 offset:128
FW_7:
    s_waitcnt lgkmcnt(0)
    v_cmp_gt_u32 vcc, 1, v7
    s_cbranch_vccz FO_8
    s_sleep 1
    ds_read_b32 v7, v9 offset:128
    s_branch FW_7
FO_8:
    ds_read_b32 v7, v9 offset:128
FW_9:
    s_waitcnt lgkmcnt(0)
    v_cmp_gt_u32 vcc, 2, v7
    s_cbranch_vccz FO_10
    ds_read_b32 v7, v9 offset:128
    s_branch FW_9
FO_10:
    s_nop 0
    ds_read_b128 v[32:35], v5 offset:0
    ds_read_b128 v[36:39], v5 offset:64
    ds_read2st64_b32 v[16:17], v8 offset0:0 offset1:1
    ds_read2st64_b32 v[18:19], v8 offset0:2 offset1:3
    ds_read2st64_b32 v[20:21], v8 offset0:4 offset1:5
    ds_read2st64_b32 v[22:23], v8 offset0:6 offset1:7
    ds_read2st64_b32 v[24:25], v8 offset0:16 offset1:17
    ds_read2st64_b32 v[26:27], v8 offset0:18 offset1:19
    ds_read2st64_b32 v[28:29], v8 offset0:20 offset1:21
    ds_read2st64_b32 v[30:31], v8 offset0:22 offset1:23
    s_waitcnt lgkmcnt(5)
    s_nop 0
    ds_read_b128 v[56:59], v5 offset:128
    ds_read_b128 v[60:63], v5 offset:192
    ds_read2st64_b32 v[40:41], v8 offset0:8 offset1:9
    ds_read2st64_b32 v[42:43], v8 offset0:10 offset1:11
    ds_read2st64_b32 v[44:45], v8 offset0:12 offset1:13
    ds_read2st64_b32 v[46:47], v8 offset0:14 offset1:15
    ds_read2st64_b32 v[48:49], v8 offset0:24 offset1:25
    ds_read2st64_b32 v[50:51], v8 offset0:26 offset1:27
    ds_read2st64_b32 v[52:53], v8 offset0:28 offset1:29
    ds_read2st64_b32 v[54:55], v8 offset0:30 offset1:31
    s_waitcnt lgkmcnt(10)
    v_cvt_pk_bf16_f32 v136, v32, v33
    v_cvt_pk_bf16_f32 v137, v34, v35
    v_cvt_pk_bf16_f32 v138, v36, v37
    v_cvt_pk_bf16_f32 v139, v38, v39
    s_nop 1
    v_mfma_f32_16x16x32_bf16 v[72:75], v[136:139], v[112:115], 0
    v_mfma_f32_16x16x32_bf16 v[84:87], v[136:139], v[120:123], 0
    v_cvt_pk_bf16_f32 v128, v16, v17
    v_cvt_pk_bf16_f32 v129, v18, v19
    v_cvt_pk_bf16_f32 v130, v20, v21
    v_cvt_pk_bf16_f32 v131, v22, v23
    s_nop 1
    v_mfma_f32_16x16x32_bf16 v[64:67], v[128:131], v[112:115], 0
    v_mfma_f32_16x16x32_bf16 v[76:79], v[128:131], v[120:123], 0
    v_cvt_pk_bf16_f32 v132, v24, v25
    v_cvt_pk_bf16_f32 v133, v26, v27
    v_cvt_pk_bf16_f32 v134, v28, v29
    v_cvt_pk_bf16_f32 v135, v30, v31
    s_nop 1
    v_mfma_f32_16x16x32_bf16 v[68:71], v[132:135], v[112:115], 0
    v_mfma_f32_16x16x32_bf16 v[80:83], v[132:135], v[120:123], 0
    s_waitcnt lgkmcnt(0)
    v_cvt_pk_bf16_f32 v148, v56, v57
    v_cvt_pk_bf16_f32 v149, v58, v59
    v_cvt_pk_bf16_f32 v150, v60, v61
    v_cvt_pk_bf16_f32 v151, v62, v63
    v_fma_f32 v72, v72, s46, v11
    v_rcp_f32 v72, v72
    v_fma_f32 v84, v84, s46, v11
    v_rcp_f32 v84, v84
    v_mfma_f32_16x16x32_bf16 v[96:99], v[148:151], v[116:119], 0
    v_mfma_f32_16x16x32_bf16 v[108:111], v[148:151], v[124:127], 0
    v_cvt_pk_bf16_f32 v140, v40, v41
    v_cvt_pk_bf16_f32 v141, v42, v43
    v_cvt_pk_bf16_f32 v142, v44, v45
    v_cvt_pk_bf16_f32 v143, v46, v47
    s_nop 1
    v_mfma_f32_16x16x32_bf16 v[88:91], v[140:143], v[116:119], 0
    v_mfma_f32_16x16x32_bf16 v[100:103], v[140:143], v[124:127], 0
    v_mul_f32 v64, v64, v72
    v_mul_f32 v65, v65, v72
    v_mul_f32 v66, v66, v72
    v_mul_f32 v67, v67, v72
    v_mul_f32 v68, v68, v72
    v_mul_f32 v69, v69, v72
    v_mul_f32 v70, v70, v72
    v_mul_f32 v71, v71, v72
    v_cvt_pk_bf16_f32 v16, v64, v65
    v_cvt_pk_bf16_f32 v17, v66, v67
    v_cvt_pk_bf16_f32 v18, v68, v69
    v_cvt_pk_bf16_f32 v19, v70, v71
    buffer_store_dwordx4 v[16:19], v6, s[16:19], s79 offen offset:0 sc0 sc1
    v_cvt_pk_bf16_f32 v144, v48, v49
    v_cvt_pk_bf16_f32 v145, v50, v51
    v_cvt_pk_bf16_f32 v146, v52, v53
    v_cvt_pk_bf16_f32 v147, v54, v55
    s_nop 1
    v_mfma_f32_16x16x32_bf16 v[92:95], v[144:147], v[116:119], 0
    v_mfma_f32_16x16x32_bf16 v[104:107], v[144:147], v[124:127], 0
    v_mul_f32 v76, v76, v84
    v_mul_f32 v77, v77, v84
    v_mul_f32 v78, v78, v84
    v_mul_f32 v79, v79, v84
    v_mul_f32 v80, v80, v84
    v_mul_f32 v81, v81, v84
    v_mul_f32 v82, v82, v84
    v_mul_f32 v83, v83, v84
    v_cvt_pk_bf16_f32 v20, v76, v77
    v_cvt_pk_bf16_f32 v21, v78, v79
    v_cvt_pk_bf16_f32 v22, v80, v81
    v_cvt_pk_bf16_f32 v23, v82, v83
    buffer_store_dwordx4 v[20:23], v6, s[16:19], s80 offen offset:0 sc0 sc1
    v_fma_f32 v96, v96, s46, v11
    v_rcp_f32 v96, v96
    v_fma_f32 v108, v108, s46, v11
    v_rcp_f32 v108, v108
    v_mul_f32 v88, v88, v96
    v_mul_f32 v89, v89, v96
    v_mul_f32 v90, v90, v96
    v_mul_f32 v91, v91, v96
    v_mul_f32 v92, v92, v96
    v_mul_f32 v93, v93, v96
    v_mul_f32 v94, v94, v96
    v_mul_f32 v95, v95, v96
    v_cvt_pk_bf16_f32 v24, v88, v89
    v_cvt_pk_bf16_f32 v25, v90, v91
    v_cvt_pk_bf16_f32 v26, v92, v93
    v_cvt_pk_bf16_f32 v27, v94, v95
    buffer_store_dwordx4 v[24:27], v6, s[16:19], s79 offen offset:1024 sc0 sc1
    v_mul_f32 v100, v100, v108
    v_mul_f32 v101, v101, v108
    v_mul_f32 v102, v102, v108
    v_mul_f32 v103, v103, v108
    v_mul_f32 v104, v104, v108
    v_mul_f32 v105, v105, v108
    v_mul_f32 v106, v106, v108
    v_mul_f32 v107, v107, v108
    v_cvt_pk_bf16_f32 v28, v100, v101
    v_cvt_pk_bf16_f32 v29, v102, v103
    v_cvt_pk_bf16_f32 v30, v104, v105
    v_cvt_pk_bf16_f32 v31, v106, v107
    buffer_store_dwordx4 v[28:31], v6, s[16:19], s80 offen offset:1024 sc0 sc1
    s_mov_b64 exec, 1
    ds_write_b32 v4, v164 offset:144
    s_waitcnt vmcnt(0)
    s_mov_b32 s45, 1
    s_atomic_add s45, s[54:55], 0x0
    s_atomic_add s45, s[54:55], 0x80
    s_atomic_add s45, s[54:55], 0x100
    s_atomic_add s45, s[54:55], 0x180
    ds_add_u32 v4, v164 offset:144
    s_mov_b64 exec, -1
    s_cmp_lg_u32 s3, 0
    s_cbranch_scc1 F_end
    s_setprio 3
    s_lshr_b32 s50, s29, 1
    s_lshl_b32 s50, s50, 2
    s_and_b32 s51, s28, 3
    s_add_u32 s50, s50, s51
    s_lshl_b32 s50, s50, 7
    s_add_u32 s56, s50, 0x839000
    s_add_u32 s56, s72, s56
    s_addc_u32 s57, s73, 0
    v_mov_b32 v2, 159096
    ds_read_b32 v7, v2 offset:0
FW_11:
    s_waitcnt lgkmcnt(0)
    v_cmp_gt_u32 vcc, 1, v7
    s_cbranch_vccz FO_12
    s_sleep 2
    ds_read_b32 v7, v2 offset:0
    s_branch FW_11
FO_12:
    v_and_b32 v2, 7, v0
    v_lshlrev_b32 v2, 2, v2
    v_add_u32 v2, 158976, v2
    ds_read_b32 v2, v2
    s_sub_u32 s51, 15, s28
    s_waitcnt lgkmcnt(0)
    v_bfe_u32 v2, v2, 7, 4
    v_cmp_eq_u32 vcc, s51, v2
    s_cbranch_vccz F_ny

    v_lshrrev_b32 v2, 4, v0
    v_and_b32 v6, 15, v0
    v_lshlrev_b32 v6, 4, v6
    v_lshl_add_u32 v2, v2, 12, v6
    s_lshl_b32 s50, s29, 8
    s_add_u32 s50, s50, 135168

SP_13:
    s_load_dword s58, s[56:57], 0 glc
    s_waitcnt lgkmcnt(0)
    s_cmp_ge_u32 s58, 32
    s_cbranch_scc1 SD_14
    s_sleep 2
    s_branch SP_13
SD_14:
    s_mov_b32 m0, 159744
    s_nop 0
    buffer_load_dwordx4 v2, s[24:27], s50 offen sc0 sc1 lds
    s_add_u32 s50, s50, 16384
    s_add_u32 m0, m0, 1024
    s_nop 0
    buffer_load_dwordx4 v2, s[24:27], s50 offen sc0 sc1 lds
    s_waitcnt vmcnt(0)
    v_mov_b32 v7, 1
    s_mov_b64 exec, 1
    ds_write_b32 v4, v7 offset:96
    s_mov_b64 exec, -1
F_ny:
F_end:
    s_endpgm
F_nl:
    s_sub_u32 s3, s3, 4
    s_setprio 2
    s_lshr_b32 s36, s3, 1
    s_and_b32 s37, s3, 1
    v_and_b32 v1, 15, v0
    v_lshrrev_b32 v2, 4, v0
    v_lshrrev_b32 v3, 1, v1
    v_xor_b32 v3, v3, v2
    v_lshlrev_b32 v3, 4, v3
    v_lshlrev_b32 v1, 7, v1
    s_lshl_b32 s38, s36, 13
    v_add3_u32 v4, v1, v3, s38
    v_xor_b32 v5, 64, v4
    v_add_u32 v6, 0x10000, v4
    v_add_u32 v7, 0x10000, v5
    v_bfe_u32 v1, v0, 2, 2
    v_lshl_add_u32 v3, v2, 3, v1
    v_lshrrev_b32 v1, 1, v1
    v_and_b32 v2, 1, v2
    v_lshl_add_u32 v1, v2, 1, v1
    s_lshl_b32 s38, s37, 1
    s_add_u32 s38, s38, s36
    v_xor_b32 v1, s38, v1
    v_lshlrev_b32 v1, 5, v1
    v_lshl_add_u32 v1, v3, 7, v1
    v_and_b32 v2, 3, v0
    v_lshl_add_u32 v1, v2, 3, v1
    v_add_u32 v8, 0x10000, v1
    v_xor_b32 v9, 32, v8
    v_add_u32 v10, 0x8000, v8
    v_add_u32 v11, 0x8000, v9
    s_mov_b32 s40, 0x21317218
    s_mov_b32 s41, s40
    s_mov_b32 s74, 0x358637bd
    s_mov_b32 s75, s74
    s_mov_b32 s76, 0x5d800000
    s_mov_b32 s77, s76
    v_and_b32 v164, 0x30, v0
    s_lshl_b32 s42, s36, 8
    s_add_u32 s42, s42, 155648
    v_add_u32 v164, s42, v164
    v_and_b32 v165, 15, v0
    v_lshlrev_b32 v165, 2, v165
    s_lshl_b32 s42, s38, 6
    s_add_u32 s42, s42, 158208
    v_add_u32 v165, s42, v165
    s_lshl_b32 s42, s3, 2
    s_add_u32 s42, s42, 159040
    v_mov_b32 v3, s42
    v_lshlrev_b32 v1, 2, v2
    v_add_u32 v1, 159040, v1
    v_xor_b32 v2, 64, v165
    s_lshl_b32 s44, s33, 1
    s_add_u32 s44, s44, s37
    s_mul_i32 s45, s44, 4224
    s_mul_i32 s46, s36, 3072
    s_add_u32 s46, s46, s45
    s_lshl_b32 s47, s36, 10
    s_add_u32 s47, s47, 1024
    s_add_u32 s47, s47, s45
    s_lshl_b32 s48, s36, 6
    s_add_u32 s48, s48, 4096
    s_add_u32 s48, s48, s45
    s_lshl_b32 s49, s44, 9
    s_lshl_b32 s52, s3, 11
    s_add_u32 s52, s52, 65536
    s_lshl_b32 s53, s3, 7
    s_lshl_b32 s43, s36, 6
    s_add_u32 s53, s53, s43
    s_add_u32 s53, s53, 159232
    s_mov_b32 s50, 159068
    s_waitcnt lgkmcnt(0)
    s_lshl_b32 s64, s28, 7
    s_lshl_b32 s65, s3, 5
    s_add_u32 s64, s64, s65
    s_lshl_b32 s42, s64, 11
    s_lshl_b32 s65, s29, 7
    s_add_u32 s42, s42, s65
    s_add_u32 s43, s42, 0x8000
    s_lshl_b32 s66, s44, 1
    s_add_u32 s66, s66, s36
    s_lshl_b32 s66, s66, 4
    s_add_u32 s66, s66, s32
    s_lshl_b32 s66, s66, 10

    s_mov_b32 s12, s4
    s_mov_b32 s13, s5
    s_mov_b32 s14, 0x400000
    s_mov_b32 s15, 0x00020000
    s_mov_b32 s16, s6
    s_mov_b32 s17, s7
    s_mov_b32 s18, 0x600000
    s_mov_b32 s19, 0x00020000
    s_mov_b32 s20, s8
    s_mov_b32 s21, s9
    s_mov_b32 s22, 0x200000
    s_mov_b32 s23, 0x00020000
    s_add_u32 s24, s72, 0x800000
    s_addc_u32 s25, s73, 0
    s_mov_b32 s26, 0x48000
    s_mov_b32 s27, 0x00020000
    s_add_u32 s84, s72, 0xa00000
    s_addc_u32 s85, s73, 0
    s_mov_b32 s86, 0x100000
    s_mov_b32 s87, 0x00020000
    s_barrier
    s_nop 0
    ds_read_b128 v[12:15], v4 offset:0
    ds_read_b64_tr_b16 v[44:45], v8 offset:0
    ds_read_b64_tr_b16 v[46:47], v8 offset:512
    ds_read_b128 v[16:19], v4 offset:2048
    ds_read_b128 v[20:23], v4 offset:4096
    ds_read_b128 v[24:27], v4 offset:6144
    ds_read_b64_tr_b16 v[48:49], v9 offset:0
    ds_read_b64_tr_b16 v[50:51], v9 offset:512
    ds_read_b64_tr_b16 v[52:53], v8 offset:8192
    ds_read_b64_tr_b16 v[54:55], v8 offset:8704
    ds_read_b64_tr_b16 v[56:57], v9 offset:8192
    ds_read_b64_tr_b16 v[58:59], v9 offset:8704
    s_waitcnt lgkmcnt(9)
    v_mfma_f32_16x16x32_bf16 v[100:103], v[12:15], v[44:47], 0
    ds_read_b128 v[28:31], v5 offset:0
    s_waitcnt lgkmcnt(9)
    v_mfma_f32_16x16x32_bf16 v[104:107], v[16:19], v[44:47], 0
    ds_read_b64_tr_b16 v[60:61], v8 offset:4096
    s_waitcnt lgkmcnt(9)
    v_mfma_f32_16x16x32_bf16 v[108:111], v[20:23], v[44:47], 0
    ds_read_b64_tr_b16 v[62:63], v8 offset:4608
    s_waitcnt lgkmcnt(9)
    v_mfma_f32_16x16x32_bf16 v[112:115], v[24:27], v[44:47], 0
    ds_read_b128 v[32:35], v5 offset:2048
    s_waitcnt lgkmcnt(8)
    s_nop 0
    v_mfma_f32_16x16x32_bf16 v[116:119], v[12:15], v[48:51], 0
    ds_read_b128 v[36:39], v5 offset:4096
    v_mfma_f32_16x16x32_bf16 v[120:123], v[16:19], v[48:51], 0
    ds_read_b128 v[40:43], v5 offset:6144
    v_mfma_f32_16x16x32_bf16 v[124:127], v[20:23], v[48:51], 0
    ds_read_b64_tr_b16 v[64:65], v9 offset:4096
    v_mfma_f32_16x16x32_bf16 v[128:131], v[24:27], v[48:51], 0
    ds_read_b64_tr_b16 v[66:67], v9 offset:4608
    s_waitcnt lgkmcnt(10)
    s_nop 0
    v_mfma_f32_16x16x32_bf16 v[132:135], v[12:15], v[52:55], 0
    ds_read_b64_tr_b16 v[44:45], v8 offset:12288
    v_mfma_f32_16x16x32_bf16 v[136:139], v[16:19], v[52:55], 0
    ds_read_b64_tr_b16 v[46:47], v8 offset:12800
    v_mfma_f32_16x16x32_bf16 v[140:143], v[20:23], v[52:55], 0
    ds_read_b64_tr_b16 v[48:49], v9 offset:12288
    v_mfma_f32_16x16x32_bf16 v[144:147], v[24:27], v[52:55], 0
    ds_read_b64_tr_b16 v[50:51], v9 offset:12800
    s_waitcnt lgkmcnt(12)
    v_mfma_f32_16x16x32_bf16 v[148:151], v[12:15], v[56:59], 0
    v_mfma_f32_16x16x32_bf16 v[152:155], v[16:19], v[56:59], 0
    v_mfma_f32_16x16x32_bf16 v[156:159], v[20:23], v[56:59], 0
    v_mfma_f32_16x16x32_bf16 v[160:163], v[24:27], v[56:59], 0
    s_waitcnt lgkmcnt(9)
    v_mfma_f32_16x16x32_bf16 v[100:103], v[28:31], v[60:63], v[100:103]
    s_waitcnt lgkmcnt(8)
    v_mfma_f32_16x16x32_bf16 v[104:107], v[32:35], v[60:63], v[104:107]
    s_waitcnt lgkmcnt(0)
    s_barrier
    s_nop 0
    v_mfma_f32_16x16x32_bf16 v[108:111], v[36:39], v[60:63], v[108:111]
    ds_read_b128 v[12:15], v4 offset:16384
    v_mfma_f32_16x16x32_bf16 v[112:115], v[40:43], v[60:63], v[112:115]
    ds_read_b64_tr_b16 v[52:53], v10 offset:0
    v_mfma_f32_16x16x32_bf16 v[116:119], v[28:31], v[64:67], v[116:119]
    ds_read_b64_tr_b16 v[54:55], v10 offset:512
    v_mfma_f32_16x16x32_bf16 v[120:123], v[32:35], v[64:67], v[120:123]
    ds_read_b128 v[16:19], v4 offset:18432
    v_mfma_f32_16x16x32_bf16 v[124:127], v[36:39], v[64:67], v[124:127]
    ds_read_b128 v[20:23], v4 offset:20480
    v_mfma_f32_16x16x32_bf16 v[128:131], v[40:43], v[64:67], v[128:131]
    ds_read_b128 v[24:27], v4 offset:22528
    v_mfma_f32_16x16x32_bf16 v[132:135], v[28:31], v[44:47], v[132:135]
    ds_read_b64_tr_b16 v[56:57], v11 offset:0
    v_mfma_f32_16x16x32_bf16 v[136:139], v[32:35], v[44:47], v[136:139]
    ds_read_b64_tr_b16 v[58:59], v11 offset:512
    v_mfma_f32_16x16x32_bf16 v[140:143], v[36:39], v[44:47], v[140:143]
    ds_read_b64_tr_b16 v[60:61], v10 offset:8192
    v_mfma_f32_16x16x32_bf16 v[144:147], v[40:43], v[44:47], v[144:147]
    ds_read_b64_tr_b16 v[62:63], v10 offset:8704
    v_mfma_f32_16x16x32_bf16 v[148:151], v[28:31], v[48:51], v[148:151]
    ds_read_b64_tr_b16 v[64:65], v11 offset:8192
    v_mfma_f32_16x16x32_bf16 v[152:155], v[32:35], v[48:51], v[152:155]
    ds_read_b64_tr_b16 v[66:67], v11 offset:8704
    v_mfma_f32_16x16x32_bf16 v[156:159], v[36:39], v[48:51], v[156:159]
    v_mfma_f32_16x16x32_bf16 v[160:163], v[40:43], v[48:51], v[160:163]
    s_waitcnt lgkmcnt(9)
    v_mfma_f32_16x16x32_bf16 v[100:103], v[12:15], v[52:55], v[100:103]
    ds_read_b128 v[28:31], v5 offset:16384
    s_waitcnt lgkmcnt(9)
    v_mfma_f32_16x16x32_bf16 v[104:107], v[16:19], v[52:55], v[104:107]
    ds_read_b64_tr_b16 v[44:45], v10 offset:4096
    s_waitcnt lgkmcnt(9)
    v_mfma_f32_16x16x32_bf16 v[108:111], v[20:23], v[52:55], v[108:111]
    ds_read_b64_tr_b16 v[46:47], v10 offset:4608
    s_waitcnt lgkmcnt(9)
    v_mfma_f32_16x16x32_bf16 v[112:115], v[24:27], v[52:55], v[112:115]
    ds_read_b128 v[32:35], v5 offset:18432
    s_waitcnt lgkmcnt(8)
    s_nop 0
    v_mfma_f32_16x16x32_bf16 v[116:119], v[12:15], v[56:59], v[116:119]
    ds_read_b128 v[36:39], v5 offset:20480
    v_mfma_f32_16x16x32_bf16 v[120:123], v[16:19], v[56:59], v[120:123]
    ds_read_b128 v[40:43], v5 offset:22528
    v_mfma_f32_16x16x32_bf16 v[124:127], v[20:23], v[56:59], v[124:127]
    ds_read_b64_tr_b16 v[48:49], v11 offset:4096
    v_mfma_f32_16x16x32_bf16 v[128:131], v[24:27], v[56:59], v[128:131]
    ds_read_b64_tr_b16 v[50:51], v11 offset:4608
    s_waitcnt lgkmcnt(10)
    s_nop 0
    v_mfma_f32_16x16x32_bf16 v[132:135], v[12:15], v[60:63], v[132:135]
    ds_read_b64_tr_b16 v[52:53], v10 offset:12288
    v_mfma_f32_16x16x32_bf16 v[136:139], v[16:19], v[60:63], v[136:139]
    ds_read_b64_tr_b16 v[54:55], v10 offset:12800
    v_mfma_f32_16x16x32_bf16 v[140:143], v[20:23], v[60:63], v[140:143]
    ds_read_b64_tr_b16 v[56:57], v11 offset:12288
    v_mfma_f32_16x16x32_bf16 v[144:147], v[24:27], v[60:63], v[144:147]
    ds_read_b64_tr_b16 v[58:59], v11 offset:12800
    s_waitcnt lgkmcnt(12)
    v_mfma_f32_16x16x32_bf16 v[148:151], v[12:15], v[64:67], v[148:151]
    v_mfma_f32_16x16x32_bf16 v[152:155], v[16:19], v[64:67], v[152:155]
    v_mfma_f32_16x16x32_bf16 v[156:159], v[20:23], v[64:67], v[156:159]
    v_mfma_f32_16x16x32_bf16 v[160:163], v[24:27], v[64:67], v[160:163]
    s_waitcnt lgkmcnt(9)
    v_mfma_f32_16x16x32_bf16 v[100:103], v[28:31], v[44:47], v[100:103]
    s_waitcnt lgkmcnt(8)
    v_mfma_f32_16x16x32_bf16 v[104:107], v[32:35], v[44:47], v[104:107]
    s_waitcnt lgkmcnt(0)
    s_barrier
    s_nop 0
    v_mfma_f32_16x16x32_bf16 v[108:111], v[36:39], v[44:47], v[108:111]
    ds_read_b128 v[12:15], v4 offset:32768
    v_mfma_f32_16x16x32_bf16 v[112:115], v[40:43], v[44:47], v[112:115]
    ds_read_b64_tr_b16 v[60:61], v10 offset:16384
    v_mfma_f32_16x16x32_bf16 v[116:119], v[28:31], v[48:51], v[116:119]
    ds_read_b64_tr_b16 v[62:63], v10 offset:16896
    v_mfma_f32_16x16x32_bf16 v[120:123], v[32:35], v[48:51], v[120:123]
    ds_read_b128 v[16:19], v4 offset:34816
    v_mfma_f32_16x16x32_bf16 v[124:127], v[36:39], v[48:51], v[124:127]
    ds_read_b128 v[20:23], v4 offset:36864
    v_mfma_f32_16x16x32_bf16 v[128:131], v[40:43], v[48:51], v[128:131]
    ds_read_b128 v[24:27], v4 offset:38912
    v_mfma_f32_16x16x32_bf16 v[132:135], v[28:31], v[52:55], v[132:135]
    ds_read_b64_tr_b16 v[64:65], v11 offset:16384
    v_mfma_f32_16x16x32_bf16 v[136:139], v[32:35], v[52:55], v[136:139]
    ds_read_b64_tr_b16 v[66:67], v11 offset:16896
    v_mfma_f32_16x16x32_bf16 v[140:143], v[36:39], v[52:55], v[140:143]
    ds_read_b64_tr_b16 v[44:45], v10 offset:24576
    v_mfma_f32_16x16x32_bf16 v[144:147], v[40:43], v[52:55], v[144:147]
    ds_read_b64_tr_b16 v[46:47], v10 offset:25088
    v_mfma_f32_16x16x32_bf16 v[148:151], v[28:31], v[56:59], v[148:151]
    ds_read_b64_tr_b16 v[48:49], v11 offset:24576
    v_mfma_f32_16x16x32_bf16 v[152:155], v[32:35], v[56:59], v[152:155]
    ds_read_b64_tr_b16 v[50:51], v11 offset:25088
    v_mfma_f32_16x16x32_bf16 v[156:159], v[36:39], v[56:59], v[156:159]
    v_mfma_f32_16x16x32_bf16 v[160:163], v[40:43], v[56:59], v[160:163]
    s_waitcnt lgkmcnt(9)
    v_mfma_f32_16x16x32_bf16 v[100:103], v[12:15], v[60:63], v[100:103]
    ds_read_b128 v[28:31], v5 offset:32768
    s_waitcnt lgkmcnt(9)
    v_mfma_f32_16x16x32_bf16 v[104:107], v[16:19], v[60:63], v[104:107]
    ds_read_b64_tr_b16 v[52:53], v10 offset:20480
    s_waitcnt lgkmcnt(9)
    v_mfma_f32_16x16x32_bf16 v[108:111], v[20:23], v[60:63], v[108:111]
    ds_read_b64_tr_b16 v[54:55], v10 offset:20992
    s_waitcnt lgkmcnt(9)
    v_mfma_f32_16x16x32_bf16 v[112:115], v[24:27], v[60:63], v[112:115]
    ds_read_b128 v[32:35], v5 offset:34816
    s_waitcnt lgkmcnt(8)
    s_nop 0
    v_mfma_f32_16x16x32_bf16 v[116:119], v[12:15], v[64:67], v[116:119]
    ds_read_b128 v[36:39], v5 offset:36864
    v_mfma_f32_16x16x32_bf16 v[120:123], v[16:19], v[64:67], v[120:123]
    ds_read_b128 v[40:43], v5 offset:38912
    v_mfma_f32_16x16x32_bf16 v[124:127], v[20:23], v[64:67], v[124:127]
    ds_read_b64_tr_b16 v[56:57], v11 offset:20480
    v_mfma_f32_16x16x32_bf16 v[128:131], v[24:27], v[64:67], v[128:131]
    ds_read_b64_tr_b16 v[58:59], v11 offset:20992
    s_waitcnt lgkmcnt(10)
    s_nop 0
    v_mfma_f32_16x16x32_bf16 v[132:135], v[12:15], v[44:47], v[132:135]
    ds_read_b64_tr_b16 v[60:61], v10 offset:28672
    v_mfma_f32_16x16x32_bf16 v[136:139], v[16:19], v[44:47], v[136:139]
    s_branch IW_s3
IW_w3:
    s_branch IW_r3
IW_s3:
    ds_read_b64_tr_b16 v[62:63], v10 offset:29184
    v_mfma_f32_16x16x32_bf16 v[140:143], v[20:23], v[44:47], v[140:143]
    ds_read_b64_tr_b16 v[64:65], v11 offset:28672
    v_mfma_f32_16x16x32_bf16 v[144:147], v[24:27], v[44:47], v[144:147]
    ds_read_b64_tr_b16 v[66:67], v11 offset:29184
    s_waitcnt lgkmcnt(12)
    v_mfma_f32_16x16x32_bf16 v[148:151], v[12:15], v[48:51], v[148:151]
    v_mfma_f32_16x16x32_bf16 v[152:155], v[16:19], v[48:51], v[152:155]
    v_mfma_f32_16x16x32_bf16 v[156:159], v[20:23], v[48:51], v[156:159]
    v_mfma_f32_16x16x32_bf16 v[160:163], v[24:27], v[48:51], v[160:163]
    s_waitcnt lgkmcnt(9)
    v_mfma_f32_16x16x32_bf16 v[100:103], v[28:31], v[52:55], v[100:103]
    s_waitcnt lgkmcnt(8)
    v_mfma_f32_16x16x32_bf16 v[104:107], v[32:35], v[52:55], v[104:107]
    s_waitcnt lgkmcnt(0)
    s_barrier
    s_nop 0
    v_mfma_f32_16x16x32_bf16 v[108:111], v[36:39], v[52:55], v[108:111]
    ds_read_b128 v[12:15], v4 offset:49152
    v_mfma_f32_16x16x32_bf16 v[112:115], v[40:43], v[52:55], v[112:115]
    ds_read_b64_tr_b16 v[44:45], v10 offset:32768
    v_mfma_f32_16x16x32_bf16 v[116:119], v[28:31], v[56:59], v[116:119]
    ds_read_b64_tr_b16 v[46:47], v10 offset:33280
    v_mfma_f32_16x16x32_bf16 v[120:123], v[32:35], v[56:59], v[120:123]
    ds_read_b128 v[16:19], v4 offset:51200
    v_mfma_f32_16x16x32_bf16 v[124:127], v[36:39], v[56:59], v[124:127]
    ds_read_b128 v[20:23], v4 offset:53248
    v_mfma_f32_16x16x32_bf16 v[128:131], v[40:43], v[56:59], v[128:131]
    ds_read_b128 v[24:27], v4 offset:55296
    v_mfma_f32_16x16x32_bf16 v[132:135], v[28:31], v[60:63], v[132:135]
    ds_read_b64_tr_b16 v[48:49], v11 offset:32768
    v_mfma_f32_16x16x32_bf16 v[136:139], v[32:35], v[60:63], v[136:139]
    ds_read_b64_tr_b16 v[50:51], v11 offset:33280
    v_mfma_f32_16x16x32_bf16 v[140:143], v[36:39], v[60:63], v[140:143]
    ds_read_b64_tr_b16 v[52:53], v8 offset:0
    v_mfma_f32_16x16x32_bf16 v[144:147], v[40:43], v[60:63], v[144:147]
    ds_read_b64_tr_b16 v[54:55], v8 offset:512
    v_mfma_f32_16x16x32_bf16 v[148:151], v[28:31], v[64:67], v[148:151]
    ds_read_b64_tr_b16 v[56:57], v9 offset:0
    v_mfma_f32_16x16x32_bf16 v[152:155], v[32:35], v[64:67], v[152:155]
    ds_read_b64_tr_b16 v[58:59], v9 offset:512
    v_mfma_f32_16x16x32_bf16 v[156:159], v[36:39], v[64:67], v[156:159]
    v_mfma_f32_16x16x32_bf16 v[160:163], v[40:43], v[64:67], v[160:163]
    s_waitcnt lgkmcnt(9)
    v_mfma_f32_16x16x32_bf16 v[100:103], v[12:15], v[44:47], v[100:103]
    ds_read_b128 v[28:31], v5 offset:49152
    s_waitcnt lgkmcnt(9)
    v_mfma_f32_16x16x32_bf16 v[104:107], v[16:19], v[44:47], v[104:107]
    ds_read_b64_tr_b16 v[60:61], v10 offset:36864
    s_waitcnt lgkmcnt(9)
    v_mfma_f32_16x16x32_bf16 v[108:111], v[20:23], v[44:47], v[108:111]
    ds_read_b64_tr_b16 v[62:63], v10 offset:37376
    s_waitcnt lgkmcnt(9)
    v_mfma_f32_16x16x32_bf16 v[112:115], v[24:27], v[44:47], v[112:115]
    ds_read_b128 v[32:35], v5 offset:51200
    s_waitcnt lgkmcnt(8)
    s_nop 0
    v_mfma_f32_16x16x32_bf16 v[116:119], v[12:15], v[48:51], v[116:119]
    ds_read_b128 v[36:39], v5 offset:53248
    v_mfma_f32_16x16x32_bf16 v[120:123], v[16:19], v[48:51], v[120:123]
    ds_read_b128 v[40:43], v5 offset:55296
    v_mfma_f32_16x16x32_bf16 v[124:127], v[20:23], v[48:51], v[124:127]
    ds_read_b64_tr_b16 v[64:65], v11 offset:36864
    v_mfma_f32_16x16x32_bf16 v[128:131], v[24:27], v[48:51], v[128:131]
    ds_read_b64_tr_b16 v[66:67], v11 offset:37376
    s_waitcnt lgkmcnt(10)
    s_nop 0
    v_mfma_f32_16x16x32_bf16 v[132:135], v[12:15], v[52:55], v[132:135]
    ds_read_b64_tr_b16 v[44:45], v8 offset:4096
    v_mfma_f32_16x16x32_bf16 v[136:139], v[16:19], v[52:55], v[136:139]
    ds_read_b64_tr_b16 v[46:47], v8 offset:4608
    v_mfma_f32_16x16x32_bf16 v[140:143], v[20:23], v[52:55], v[140:143]
    ds_read_b64_tr_b16 v[48:49], v9 offset:4096
    v_mfma_f32_16x16x32_bf16 v[144:147], v[24:27], v[52:55], v[144:147]
    ds_read_b64_tr_b16 v[50:51], v9 offset:4608
    s_waitcnt lgkmcnt(12)
    v_mfma_f32_16x16x32_bf16 v[148:151], v[12:15], v[56:59], v[148:151]
    v_mfma_f32_16x16x32_bf16 v[152:155], v[16:19], v[56:59], v[152:155]
    v_mfma_f32_16x16x32_bf16 v[156:159], v[20:23], v[56:59], v[156:159]
    v_mfma_f32_16x16x32_bf16 v[160:163], v[24:27], v[56:59], v[160:163]
    s_waitcnt lgkmcnt(9)
    v_mfma_f32_16x16x32_bf16 v[100:103], v[28:31], v[60:63], v[100:103]
    s_waitcnt lgkmcnt(8)
    v_mfma_f32_16x16x32_bf16 v[104:107], v[32:35], v[60:63], v[104:107]
    s_waitcnt lgkmcnt(0)
    s_barrier
    s_nop 0
    v_mfma_f32_16x16x32_bf16 v[108:111], v[36:39], v[60:63], v[108:111]
    ds_read_b128 v[12:15], v4 offset:0
    v_mfma_f32_16x16x32_bf16 v[112:115], v[40:43], v[60:63], v[112:115]
    ds_read_b64_tr_b16 v[52:53], v8 offset:8192
    v_mfma_f32_16x16x32_bf16 v[116:119], v[28:31], v[64:67], v[116:119]
    ds_read_b64_tr_b16 v[54:55], v8 offset:8704
    v_mfma_f32_16x16x32_bf16 v[120:123], v[32:35], v[64:67], v[120:123]
    ds_read_b128 v[16:19], v4 offset:2048
    v_mfma_f32_16x16x32_bf16 v[124:127], v[36:39], v[64:67], v[124:127]
    ds_read_b128 v[20:23], v4 offset:4096
    v_mfma_f32_16x16x32_bf16 v[128:131], v[40:43], v[64:67], v[128:131]
    ds_read_b128 v[24:27], v4 offset:6144
    v_mfma_f32_16x16x32_bf16 v[132:135], v[28:31], v[44:47], v[132:135]
    ds_read_b64_tr_b16 v[56:57], v9 offset:8192
    v_mfma_f32_16x16x32_bf16 v[136:139], v[32:35], v[44:47], v[136:139]
    ds_read_b64_tr_b16 v[58:59], v9 offset:8704
    v_mfma_f32_16x16x32_bf16 v[140:143], v[36:39], v[44:47], v[140:143]
    ds_read_b64_tr_b16 v[60:61], v8 offset:16384
    v_mfma_f32_16x16x32_bf16 v[144:147], v[40:43], v[44:47], v[144:147]
    ds_read_b64_tr_b16 v[62:63], v8 offset:16896
    v_mfma_f32_16x16x32_bf16 v[148:151], v[28:31], v[48:51], v[148:151]
    ds_read_b64_tr_b16 v[64:65], v9 offset:16384
    v_mfma_f32_16x16x32_bf16 v[152:155], v[32:35], v[48:51], v[152:155]
    ds_read_b64_tr_b16 v[66:67], v9 offset:16896
    v_mfma_f32_16x16x32_bf16 v[156:159], v[36:39], v[48:51], v[156:159]
    v_mfma_f32_16x16x32_bf16 v[160:163], v[40:43], v[48:51], v[160:163]
    s_waitcnt lgkmcnt(9)
    v_mfma_f32_16x16x32_bf16 v[100:103], v[12:15], v[52:55], v[100:103]
    ds_read_b128 v[28:31], v5 offset:0
    s_waitcnt lgkmcnt(9)
    v_mfma_f32_16x16x32_bf16 v[104:107], v[16:19], v[52:55], v[104:107]
    ds_read_b64_tr_b16 v[44:45], v8 offset:12288
    s_waitcnt lgkmcnt(9)
    v_mfma_f32_16x16x32_bf16 v[108:111], v[20:23], v[52:55], v[108:111]
    ds_read_b64_tr_b16 v[46:47], v8 offset:12800
    s_waitcnt lgkmcnt(9)
    v_mfma_f32_16x16x32_bf16 v[112:115], v[24:27], v[52:55], v[112:115]
    ds_read_b128 v[32:35], v5 offset:2048
    s_waitcnt lgkmcnt(8)
    s_nop 0
    v_mfma_f32_16x16x32_bf16 v[116:119], v[12:15], v[56:59], v[116:119]
    ds_read_b128 v[36:39], v5 offset:4096
    v_mfma_f32_16x16x32_bf16 v[120:123], v[16:19], v[56:59], v[120:123]
    ds_read_b128 v[40:43], v5 offset:6144
    v_mfma_f32_16x16x32_bf16 v[124:127], v[20:23], v[56:59], v[124:127]
    ds_read_b64_tr_b16 v[48:49], v9 offset:12288
    v_mfma_f32_16x16x32_bf16 v[128:131], v[24:27], v[56:59], v[128:131]
    ds_read_b64_tr_b16 v[50:51], v9 offset:12800
    s_waitcnt lgkmcnt(10)
    s_nop 0
    v_mfma_f32_16x16x32_bf16 v[132:135], v[12:15], v[60:63], v[132:135]
    ds_read_b64_tr_b16 v[52:53], v8 offset:20480
    v_mfma_f32_16x16x32_bf16 v[136:139], v[16:19], v[60:63], v[136:139]
    ds_read_b64_tr_b16 v[54:55], v8 offset:20992
    v_mfma_f32_16x16x32_bf16 v[140:143], v[20:23], v[60:63], v[140:143]
    ds_read_b64_tr_b16 v[56:57], v9 offset:20480
    v_mfma_f32_16x16x32_bf16 v[144:147], v[24:27], v[60:63], v[144:147]
    ds_read_b64_tr_b16 v[58:59], v9 offset:20992
    s_waitcnt lgkmcnt(12)
    v_mfma_f32_16x16x32_bf16 v[148:151], v[12:15], v[64:67], v[148:151]
    v_mfma_f32_16x16x32_bf16 v[152:155], v[16:19], v[64:67], v[152:155]
    v_mfma_f32_16x16x32_bf16 v[156:159], v[20:23], v[64:67], v[156:159]
    v_mfma_f32_16x16x32_bf16 v[160:163], v[24:27], v[64:67], v[160:163]
    s_waitcnt lgkmcnt(9)
    v_mfma_f32_16x16x32_bf16 v[100:103], v[28:31], v[44:47], v[100:103]
    s_waitcnt lgkmcnt(8)
    v_mfma_f32_16x16x32_bf16 v[104:107], v[32:35], v[44:47], v[104:107]
    s_waitcnt lgkmcnt(0)
    s_barrier
    s_nop 0
    v_mfma_f32_16x16x32_bf16 v[108:111], v[36:39], v[44:47], v[108:111]
    ds_read_b128 v[12:15], v4 offset:16384
    v_mfma_f32_16x16x32_bf16 v[112:115], v[40:43], v[44:47], v[112:115]
    ds_read_b64_tr_b16 v[60:61], v8 offset:24576
    v_mfma_f32_16x16x32_bf16 v[116:119], v[28:31], v[48:51], v[116:119]
    ds_read_b64_tr_b16 v[62:63], v8 offset:25088
    v_mfma_f32_16x16x32_bf16 v[120:123], v[32:35], v[48:51], v[120:123]
    ds_read_b128 v[16:19], v4 offset:18432
    v_mfma_f32_16x16x32_bf16 v[124:127], v[36:39], v[48:51], v[124:127]
    ds_read_b128 v[20:23], v4 offset:20480
    v_mfma_f32_16x16x32_bf16 v[128:131], v[40:43], v[48:51], v[128:131]
    ds_read_b128 v[24:27], v4 offset:22528
    v_mfma_f32_16x16x32_bf16 v[132:135], v[28:31], v[52:55], v[132:135]
    ds_read_b64_tr_b16 v[64:65], v9 offset:24576
    v_mfma_f32_16x16x32_bf16 v[136:139], v[32:35], v[52:55], v[136:139]
    ds_read_b64_tr_b16 v[66:67], v9 offset:25088
    v_mfma_f32_16x16x32_bf16 v[140:143], v[36:39], v[52:55], v[140:143]
    ds_read_b64_tr_b16 v[44:45], v10 offset:0
    v_mfma_f32_16x16x32_bf16 v[144:147], v[40:43], v[52:55], v[144:147]
    ds_read_b64_tr_b16 v[46:47], v10 offset:512
    v_mfma_f32_16x16x32_bf16 v[148:151], v[28:31], v[56:59], v[148:151]
    ds_read_b64_tr_b16 v[48:49], v11 offset:0
    v_mfma_f32_16x16x32_bf16 v[152:155], v[32:35], v[56:59], v[152:155]
    ds_read_b64_tr_b16 v[50:51], v11 offset:512
    v_mfma_f32_16x16x32_bf16 v[156:159], v[36:39], v[56:59], v[156:159]
    v_mfma_f32_16x16x32_bf16 v[160:163], v[40:43], v[56:59], v[160:163]
    s_waitcnt lgkmcnt(9)
    v_mfma_f32_16x16x32_bf16 v[100:103], v[12:15], v[60:63], v[100:103]
    ds_read_b128 v[28:31], v5 offset:16384
    s_waitcnt lgkmcnt(9)
    v_mfma_f32_16x16x32_bf16 v[104:107], v[16:19], v[60:63], v[104:107]
    ds_read_b64_tr_b16 v[52:53], v8 offset:28672
    s_waitcnt lgkmcnt(9)
    v_mfma_f32_16x16x32_bf16 v[108:111], v[20:23], v[60:63], v[108:111]
    ds_read_b64_tr_b16 v[54:55], v8 offset:29184
    s_waitcnt lgkmcnt(9)
    v_mfma_f32_16x16x32_bf16 v[112:115], v[24:27], v[60:63], v[112:115]
    ds_read_b128 v[32:35], v5 offset:18432
    s_waitcnt lgkmcnt(8)
    s_nop 0
    v_mfma_f32_16x16x32_bf16 v[116:119], v[12:15], v[64:67], v[116:119]
    ds_read_b128 v[36:39], v5 offset:20480
    v_mfma_f32_16x16x32_bf16 v[120:123], v[16:19], v[64:67], v[120:123]
    ds_read_b128 v[40:43], v5 offset:22528
    v_mfma_f32_16x16x32_bf16 v[124:127], v[20:23], v[64:67], v[124:127]
    ds_read_b64_tr_b16 v[56:57], v9 offset:28672
    v_mfma_f32_16x16x32_bf16 v[128:131], v[24:27], v[64:67], v[128:131]
    ds_read_b64_tr_b16 v[58:59], v9 offset:29184
    s_waitcnt lgkmcnt(10)
    s_nop 0
    v_mfma_f32_16x16x32_bf16 v[132:135], v[12:15], v[44:47], v[132:135]
    ds_read_b64_tr_b16 v[60:61], v10 offset:4096
    v_mfma_f32_16x16x32_bf16 v[136:139], v[16:19], v[44:47], v[136:139]
    ds_read_b64_tr_b16 v[62:63], v10 offset:4608
    v_mfma_f32_16x16x32_bf16 v[140:143], v[20:23], v[44:47], v[140:143]
    ds_read_b64_tr_b16 v[64:65], v11 offset:4096
    v_mfma_f32_16x16x32_bf16 v[144:147], v[24:27], v[44:47], v[144:147]
    ds_read_b64_tr_b16 v[66:67], v11 offset:4608
    s_waitcnt lgkmcnt(12)
    v_mfma_f32_16x16x32_bf16 v[148:151], v[12:15], v[48:51], v[148:151]
    v_mfma_f32_16x16x32_bf16 v[152:155], v[16:19], v[48:51], v[152:155]
    v_mfma_f32_16x16x32_bf16 v[156:159], v[20:23], v[48:51], v[156:159]
    v_mfma_f32_16x16x32_bf16 v[160:163], v[24:27], v[48:51], v[160:163]
    s_waitcnt lgkmcnt(9)
    v_mfma_f32_16x16x32_bf16 v[100:103], v[28:31], v[52:55], v[100:103]
    s_waitcnt lgkmcnt(8)
    v_mfma_f32_16x16x32_bf16 v[104:107], v[32:35], v[52:55], v[104:107]
    s_waitcnt lgkmcnt(0)
    s_barrier
    s_nop 0
    v_mfma_f32_16x16x32_bf16 v[108:111], v[36:39], v[52:55], v[108:111]
    ds_read_b128 v[12:15], v4 offset:32768
    v_mfma_f32_16x16x32_bf16 v[112:115], v[40:43], v[52:55], v[112:115]
    ds_read_b64_tr_b16 v[44:45], v10 offset:16384
    v_mfma_f32_16x16x32_bf16 v[116:119], v[28:31], v[56:59], v[116:119]
    ds_read_b64_tr_b16 v[46:47], v10 offset:16896
    v_mfma_f32_16x16x32_bf16 v[120:123], v[32:35], v[56:59], v[120:123]
    ds_read_b128 v[16:19], v4 offset:34816
    v_mfma_f32_16x16x32_bf16 v[124:127], v[36:39], v[56:59], v[124:127]
    ds_read_b128 v[20:23], v4 offset:36864
    v_mfma_f32_16x16x32_bf16 v[128:131], v[40:43], v[56:59], v[128:131]
    ds_read_b128 v[24:27], v4 offset:38912
    v_mfma_f32_16x16x32_bf16 v[132:135], v[28:31], v[60:63], v[132:135]
    ds_read_b64_tr_b16 v[48:49], v11 offset:16384
    v_mfma_f32_16x16x32_bf16 v[136:139], v[32:35], v[60:63], v[136:139]
    ds_read_b64_tr_b16 v[50:51], v11 offset:16896
    v_mfma_f32_16x16x32_bf16 v[140:143], v[36:39], v[60:63], v[140:143]
    ds_read_b64_tr_b16 v[52:53], v10 offset:24576
    v_mfma_f32_16x16x32_bf16 v[144:147], v[40:43], v[60:63], v[144:147]
    ds_read_b64_tr_b16 v[54:55], v10 offset:25088
    v_mfma_f32_16x16x32_bf16 v[148:151], v[28:31], v[64:67], v[148:151]
    ds_read_b64_tr_b16 v[56:57], v11 offset:24576
    v_mfma_f32_16x16x32_bf16 v[152:155], v[32:35], v[64:67], v[152:155]
    ds_read_b64_tr_b16 v[58:59], v11 offset:25088
    v_mfma_f32_16x16x32_bf16 v[156:159], v[36:39], v[64:67], v[156:159]
    v_mfma_f32_16x16x32_bf16 v[160:163], v[40:43], v[64:67], v[160:163]
    s_waitcnt lgkmcnt(9)
    v_mfma_f32_16x16x32_bf16 v[100:103], v[12:15], v[44:47], v[100:103]
    ds_read_b128 v[28:31], v5 offset:32768
    s_waitcnt lgkmcnt(9)
    v_mfma_f32_16x16x32_bf16 v[104:107], v[16:19], v[44:47], v[104:107]
    ds_read_b64_tr_b16 v[60:61], v10 offset:20480
    s_waitcnt lgkmcnt(9)
    v_mfma_f32_16x16x32_bf16 v[108:111], v[20:23], v[44:47], v[108:111]
    ds_read_b64_tr_b16 v[62:63], v10 offset:20992
    s_waitcnt lgkmcnt(9)
    v_mfma_f32_16x16x32_bf16 v[112:115], v[24:27], v[44:47], v[112:115]
    ds_read_b128 v[32:35], v5 offset:34816
    s_waitcnt lgkmcnt(8)
    s_nop 0
    v_mfma_f32_16x16x32_bf16 v[116:119], v[12:15], v[48:51], v[116:119]
    ds_read_b128 v[36:39], v5 offset:36864
    v_mfma_f32_16x16x32_bf16 v[120:123], v[16:19], v[48:51], v[120:123]
    ds_read_b128 v[40:43], v5 offset:38912
    v_mfma_f32_16x16x32_bf16 v[124:127], v[20:23], v[48:51], v[124:127]
    ds_read_b64_tr_b16 v[64:65], v11 offset:20480
    v_mfma_f32_16x16x32_bf16 v[128:131], v[24:27], v[48:51], v[128:131]
    ds_read_b64_tr_b16 v[66:67], v11 offset:20992
    s_waitcnt lgkmcnt(10)
    s_nop 0
    v_mfma_f32_16x16x32_bf16 v[132:135], v[12:15], v[52:55], v[132:135]
    ds_read_b64_tr_b16 v[44:45], v10 offset:28672
    v_mfma_f32_16x16x32_bf16 v[136:139], v[16:19], v[52:55], v[136:139]
    ds_read_b64_tr_b16 v[46:47], v10 offset:29184
    v_mfma_f32_16x16x32_bf16 v[140:143], v[20:23], v[52:55], v[140:143]
    ds_read_b64_tr_b16 v[48:49], v11 offset:28672
    v_mfma_f32_16x16x32_bf16 v[144:147], v[24:27], v[52:55], v[144:147]
    ds_read_b64_tr_b16 v[50:51], v11 offset:29184
    s_waitcnt lgkmcnt(12)
    v_mfma_f32_16x16x32_bf16 v[148:151], v[12:15], v[56:59], v[148:151]
    v_mfma_f32_16x16x32_bf16 v[152:155], v[16:19], v[56:59], v[152:155]
    v_mfma_f32_16x16x32_bf16 v[156:159], v[20:23], v[56:59], v[156:159]
    v_mfma_f32_16x16x32_bf16 v[160:163], v[24:27], v[56:59], v[160:163]
    s_waitcnt lgkmcnt(9)
    v_mfma_f32_16x16x32_bf16 v[100:103], v[28:31], v[60:63], v[100:103]
    s_waitcnt lgkmcnt(8)
    v_mfma_f32_16x16x32_bf16 v[104:107], v[32:35], v[60:63], v[104:107]
    s_waitcnt lgkmcnt(0)
    s_barrier
    s_nop 0
    v_mfma_f32_16x16x32_bf16 v[108:111], v[36:39], v[60:63], v[108:111]
    ds_read_b128 v[12:15], v4 offset:49152
    v_mfma_f32_16x16x32_bf16 v[112:115], v[40:43], v[60:63], v[112:115]
    ds_read_b64_tr_b16 v[52:53], v8 offset:0
    v_mfma_f32_16x16x32_bf16 v[116:119], v[28:31], v[64:67], v[116:119]
    ds_read_b64_tr_b16 v[54:55], v8 offset:512
    v_mfma_f32_16x16x32_bf16 v[120:123], v[32:35], v[64:67], v[120:123]
    ds_read_b128 v[16:19], v4 offset:51200
    v_mfma_f32_16x16x32_bf16 v[124:127], v[36:39], v[64:67], v[124:127]
    ds_read_b128 v[20:23], v4 offset:53248
    v_mfma_f32_16x16x32_bf16 v[128:131], v[40:43], v[64:67], v[128:131]
    ds_read_b128 v[24:27], v4 offset:55296
    v_mfma_f32_16x16x32_bf16 v[132:135], v[28:31], v[44:47], v[132:135]
    ds_read_b64_tr_b16 v[56:57], v9 offset:0
    v_mfma_f32_16x16x32_bf16 v[136:139], v[32:35], v[44:47], v[136:139]
    ds_read_b64_tr_b16 v[58:59], v9 offset:512
    v_mfma_f32_16x16x32_bf16 v[140:143], v[36:39], v[44:47], v[140:143]
    ds_read_b64_tr_b16 v[60:61], v10 offset:32768
    v_mfma_f32_16x16x32_bf16 v[144:147], v[40:43], v[44:47], v[144:147]
    ds_read_b64_tr_b16 v[62:63], v10 offset:33280
    v_mfma_f32_16x16x32_bf16 v[148:151], v[28:31], v[48:51], v[148:151]
    ds_read_b64_tr_b16 v[64:65], v11 offset:32768
    v_mfma_f32_16x16x32_bf16 v[152:155], v[32:35], v[48:51], v[152:155]
    ds_read_b64_tr_b16 v[66:67], v11 offset:33280
    v_mfma_f32_16x16x32_bf16 v[156:159], v[36:39], v[48:51], v[156:159]
    v_mfma_f32_16x16x32_bf16 v[160:163], v[40:43], v[48:51], v[160:163]
    s_waitcnt lgkmcnt(9)
    v_mfma_f32_16x16x32_bf16 v[100:103], v[12:15], v[52:55], v[100:103]
    ds_read_b128 v[28:31], v5 offset:49152
    s_waitcnt lgkmcnt(9)
    v_mfma_f32_16x16x32_bf16 v[104:107], v[16:19], v[52:55], v[104:107]
    ds_read_b64_tr_b16 v[44:45], v8 offset:4096
    s_waitcnt lgkmcnt(9)
    v_mfma_f32_16x16x32_bf16 v[108:111], v[20:23], v[52:55], v[108:111]
    ds_read_b64_tr_b16 v[46:47], v8 offset:4608
    s_waitcnt lgkmcnt(9)
    v_mfma_f32_16x16x32_bf16 v[112:115], v[24:27], v[52:55], v[112:115]
    ds_read_b128 v[32:35], v5 offset:51200
    s_waitcnt lgkmcnt(8)
    s_nop 0
    v_mfma_f32_16x16x32_bf16 v[116:119], v[12:15], v[56:59], v[116:119]
    ds_read_b128 v[36:39], v5 offset:53248
    v_mfma_f32_16x16x32_bf16 v[120:123], v[16:19], v[56:59], v[120:123]
    ds_read_b128 v[40:43], v5 offset:55296
    v_mfma_f32_16x16x32_bf16 v[124:127], v[20:23], v[56:59], v[124:127]
    ds_read_b64_tr_b16 v[48:49], v9 offset:4096
    v_mfma_f32_16x16x32_bf16 v[128:131], v[24:27], v[56:59], v[128:131]
    ds_read_b64_tr_b16 v[50:51], v9 offset:4608
    s_waitcnt lgkmcnt(10)
    s_nop 0
    v_mfma_f32_16x16x32_bf16 v[132:135], v[12:15], v[60:63], v[132:135]
    ds_read_b64_tr_b16 v[52:53], v10 offset:36864
    v_mfma_f32_16x16x32_bf16 v[136:139], v[16:19], v[60:63], v[136:139]
    ds_read_b64_tr_b16 v[54:55], v10 offset:37376
    v_mfma_f32_16x16x32_bf16 v[140:143], v[20:23], v[60:63], v[140:143]
    ds_read_b64_tr_b16 v[56:57], v11 offset:36864
    v_mfma_f32_16x16x32_bf16 v[144:147], v[24:27], v[60:63], v[144:147]
    ds_read_b64_tr_b16 v[58:59], v11 offset:37376
    s_waitcnt lgkmcnt(12)
    v_mfma_f32_16x16x32_bf16 v[148:151], v[12:15], v[64:67], v[148:151]
    v_mfma_f32_16x16x32_bf16 v[152:155], v[16:19], v[64:67], v[152:155]
    v_mfma_f32_16x16x32_bf16 v[156:159], v[20:23], v[64:67], v[156:159]
    v_mfma_f32_16x16x32_bf16 v[160:163], v[24:27], v[64:67], v[160:163]
    s_waitcnt lgkmcnt(9)
    v_mfma_f32_16x16x32_bf16 v[100:103], v[28:31], v[44:47], v[100:103]
    s_waitcnt lgkmcnt(8)
    v_mfma_f32_16x16x32_bf16 v[104:107], v[32:35], v[44:47], v[104:107]
    s_waitcnt lgkmcnt(0)
    s_barrier
    s_nop 0
    v_mfma_f32_16x16x32_bf16 v[108:111], v[36:39], v[44:47], v[108:111]
    ds_read_b128 v[12:15], v4 offset:0
    v_mfma_f32_16x16x32_bf16 v[112:115], v[40:43], v[44:47], v[112:115]
    ds_read_b64_tr_b16 v[60:61], v8 offset:8192
    v_mfma_f32_16x16x32_bf16 v[116:119], v[28:31], v[48:51], v[116:119]
    ds_read_b64_tr_b16 v[62:63], v8 offset:8704
    v_mfma_f32_16x16x32_bf16 v[120:123], v[32:35], v[48:51], v[120:123]
    ds_read_b128 v[16:19], v4 offset:2048
    v_mfma_f32_16x16x32_bf16 v[124:127], v[36:39], v[48:51], v[124:127]
    ds_read_b128 v[20:23], v4 offset:4096
    v_mfma_f32_16x16x32_bf16 v[128:131], v[40:43], v[48:51], v[128:131]
    ds_read_b128 v[24:27], v4 offset:6144
    v_mfma_f32_16x16x32_bf16 v[132:135], v[28:31], v[52:55], v[132:135]
    ds_read_b64_tr_b16 v[64:65], v9 offset:8192
    v_mfma_f32_16x16x32_bf16 v[136:139], v[32:35], v[52:55], v[136:139]
    ds_read_b64_tr_b16 v[66:67], v9 offset:8704
    v_mfma_f32_16x16x32_bf16 v[140:143], v[36:39], v[52:55], v[140:143]
    ds_read_b64_tr_b16 v[44:45], v8 offset:16384
    v_mfma_f32_16x16x32_bf16 v[144:147], v[40:43], v[52:55], v[144:147]
    ds_read_b64_tr_b16 v[46:47], v8 offset:16896
    v_mfma_f32_16x16x32_bf16 v[148:151], v[28:31], v[56:59], v[148:151]
    ds_read_b64_tr_b16 v[48:49], v9 offset:16384
    v_mfma_f32_16x16x32_bf16 v[152:155], v[32:35], v[56:59], v[152:155]
    ds_read_b64_tr_b16 v[50:51], v9 offset:16896
    v_mfma_f32_16x16x32_bf16 v[156:159], v[36:39], v[56:59], v[156:159]
    v_mfma_f32_16x16x32_bf16 v[160:163], v[40:43], v[56:59], v[160:163]
    s_waitcnt lgkmcnt(9)
    v_mfma_f32_16x16x32_bf16 v[100:103], v[12:15], v[60:63], v[100:103]
    ds_read_b128 v[28:31], v5 offset:0
    s_waitcnt lgkmcnt(9)
    v_mfma_f32_16x16x32_bf16 v[104:107], v[16:19], v[60:63], v[104:107]
    ds_read_b64_tr_b16 v[52:53], v8 offset:12288
    s_waitcnt lgkmcnt(9)
    v_mfma_f32_16x16x32_bf16 v[108:111], v[20:23], v[60:63], v[108:111]
    ds_read_b64_tr_b16 v[54:55], v8 offset:12800
    s_waitcnt lgkmcnt(9)
    v_mfma_f32_16x16x32_bf16 v[112:115], v[24:27], v[60:63], v[112:115]
    ds_read_b128 v[32:35], v5 offset:2048
    s_waitcnt lgkmcnt(8)
    s_nop 0
    v_mfma_f32_16x16x32_bf16 v[116:119], v[12:15], v[64:67], v[116:119]
    ds_read_b128 v[36:39], v5 offset:4096
    v_mfma_f32_16x16x32_bf16 v[120:123], v[16:19], v[64:67], v[120:123]
    ds_read_b128 v[40:43], v5 offset:6144
    v_mfma_f32_16x16x32_bf16 v[124:127], v[20:23], v[64:67], v[124:127]
    ds_read_b64_tr_b16 v[56:57], v9 offset:12288
    v_mfma_f32_16x16x32_bf16 v[128:131], v[24:27], v[64:67], v[128:131]
    ds_read_b64_tr_b16 v[58:59], v9 offset:12800
    s_waitcnt lgkmcnt(10)
    s_nop 0
    v_mfma_f32_16x16x32_bf16 v[132:135], v[12:15], v[44:47], v[132:135]
    ds_read_b64_tr_b16 v[60:61], v8 offset:20480
    v_mfma_f32_16x16x32_bf16 v[136:139], v[16:19], v[44:47], v[136:139]
    ds_read_b64_tr_b16 v[62:63], v8 offset:20992
    v_mfma_f32_16x16x32_bf16 v[140:143], v[20:23], v[44:47], v[140:143]
    ds_read_b64_tr_b16 v[64:65], v9 offset:20480
    v_mfma_f32_16x16x32_bf16 v[144:147], v[24:27], v[44:47], v[144:147]
    ds_read_b64_tr_b16 v[66:67], v9 offset:20992
    s_waitcnt lgkmcnt(12)
    v_mfma_f32_16x16x32_bf16 v[148:151], v[12:15], v[48:51], v[148:151]
    v_mfma_f32_16x16x32_bf16 v[152:155], v[16:19], v[48:51], v[152:155]
    v_mfma_f32_16x16x32_bf16 v[156:159], v[20:23], v[48:51], v[156:159]
    v_mfma_f32_16x16x32_bf16 v[160:163], v[24:27], v[48:51], v[160:163]
    s_waitcnt lgkmcnt(9)
    v_mfma_f32_16x16x32_bf16 v[100:103], v[28:31], v[52:55], v[100:103]
    s_waitcnt lgkmcnt(8)
    v_mfma_f32_16x16x32_bf16 v[104:107], v[32:35], v[52:55], v[104:107]
    s_waitcnt lgkmcnt(0)
    s_barrier
    s_nop 0
    v_mfma_f32_16x16x32_bf16 v[108:111], v[36:39], v[52:55], v[108:111]
    ds_read_b128 v[12:15], v4 offset:16384
    v_mfma_f32_16x16x32_bf16 v[112:115], v[40:43], v[52:55], v[112:115]
    ds_read_b64_tr_b16 v[44:45], v8 offset:24576
    v_mfma_f32_16x16x32_bf16 v[116:119], v[28:31], v[56:59], v[116:119]
    ds_read_b64_tr_b16 v[46:47], v8 offset:25088
    v_mfma_f32_16x16x32_bf16 v[120:123], v[32:35], v[56:59], v[120:123]
    ds_read_b128 v[16:19], v4 offset:18432
    v_mfma_f32_16x16x32_bf16 v[124:127], v[36:39], v[56:59], v[124:127]
    ds_read_b128 v[20:23], v4 offset:20480
    v_mfma_f32_16x16x32_bf16 v[128:131], v[40:43], v[56:59], v[128:131]
    ds_read_b128 v[24:27], v4 offset:22528
    v_mfma_f32_16x16x32_bf16 v[132:135], v[28:31], v[60:63], v[132:135]
    ds_read_b64_tr_b16 v[48:49], v9 offset:24576
    v_mfma_f32_16x16x32_bf16 v[136:139], v[32:35], v[60:63], v[136:139]
    ds_read_b64_tr_b16 v[50:51], v9 offset:25088
    v_mfma_f32_16x16x32_bf16 v[140:143], v[36:39], v[60:63], v[140:143]
    ds_read_b64_tr_b16 v[52:53], v10 offset:0
    v_mfma_f32_16x16x32_bf16 v[144:147], v[40:43], v[60:63], v[144:147]
    ds_read_b64_tr_b16 v[54:55], v10 offset:512
    v_mfma_f32_16x16x32_bf16 v[148:151], v[28:31], v[64:67], v[148:151]
    ds_read_b64_tr_b16 v[56:57], v11 offset:0
    v_mfma_f32_16x16x32_bf16 v[152:155], v[32:35], v[64:67], v[152:155]
    ds_read_b64_tr_b16 v[58:59], v11 offset:512
    v_mfma_f32_16x16x32_bf16 v[156:159], v[36:39], v[64:67], v[156:159]
    v_mfma_f32_16x16x32_bf16 v[160:163], v[40:43], v[64:67], v[160:163]
    s_waitcnt lgkmcnt(9)
    v_mfma_f32_16x16x32_bf16 v[100:103], v[12:15], v[44:47], v[100:103]
    ds_read_b128 v[28:31], v5 offset:16384
    s_waitcnt lgkmcnt(9)
    v_mfma_f32_16x16x32_bf16 v[104:107], v[16:19], v[44:47], v[104:107]
    ds_read_b64_tr_b16 v[60:61], v8 offset:28672
    s_waitcnt lgkmcnt(9)
    v_mfma_f32_16x16x32_bf16 v[108:111], v[20:23], v[44:47], v[108:111]
    ds_read_b64_tr_b16 v[62:63], v8 offset:29184
    s_waitcnt lgkmcnt(9)
    v_mfma_f32_16x16x32_bf16 v[112:115], v[24:27], v[44:47], v[112:115]
    ds_read_b128 v[32:35], v5 offset:18432
    s_waitcnt lgkmcnt(8)
    s_nop 0
    v_mfma_f32_16x16x32_bf16 v[116:119], v[12:15], v[48:51], v[116:119]
    ds_read_b128 v[36:39], v5 offset:20480
    v_mfma_f32_16x16x32_bf16 v[120:123], v[16:19], v[48:51], v[120:123]
    ds_read_b128 v[40:43], v5 offset:22528
    v_mfma_f32_16x16x32_bf16 v[124:127], v[20:23], v[48:51], v[124:127]
    ds_read_b64_tr_b16 v[64:65], v9 offset:28672
    v_mfma_f32_16x16x32_bf16 v[128:131], v[24:27], v[48:51], v[128:131]
    ds_read_b64_tr_b16 v[66:67], v9 offset:29184
    s_waitcnt lgkmcnt(10)
    s_nop 0
    v_mfma_f32_16x16x32_bf16 v[132:135], v[12:15], v[52:55], v[132:135]
    ds_read_b64_tr_b16 v[44:45], v10 offset:4096
    v_mfma_f32_16x16x32_bf16 v[136:139], v[16:19], v[52:55], v[136:139]
    ds_read_b64_tr_b16 v[46:47], v10 offset:4608
    v_mfma_f32_16x16x32_bf16 v[140:143], v[20:23], v[52:55], v[140:143]
    ds_read_b64_tr_b16 v[48:49], v11 offset:4096
    v_mfma_f32_16x16x32_bf16 v[144:147], v[24:27], v[52:55], v[144:147]
    ds_read_b64_tr_b16 v[50:51], v11 offset:4608
    s_waitcnt lgkmcnt(12)
    v_mfma_f32_16x16x32_bf16 v[148:151], v[12:15], v[56:59], v[148:151]
    v_mfma_f32_16x16x32_bf16 v[152:155], v[16:19], v[56:59], v[152:155]
    v_mfma_f32_16x16x32_bf16 v[156:159], v[20:23], v[56:59], v[156:159]
    v_mfma_f32_16x16x32_bf16 v[160:163], v[24:27], v[56:59], v[160:163]
    s_waitcnt lgkmcnt(9)
    v_mfma_f32_16x16x32_bf16 v[100:103], v[28:31], v[60:63], v[100:103]
    s_waitcnt lgkmcnt(8)
    v_mfma_f32_16x16x32_bf16 v[104:107], v[32:35], v[60:63], v[104:107]
    s_waitcnt lgkmcnt(0)
    s_barrier
    s_nop 0
    v_mfma_f32_16x16x32_bf16 v[108:111], v[36:39], v[60:63], v[108:111]
    ds_read_b128 v[12:15], v4 offset:32768
    v_mfma_f32_16x16x32_bf16 v[112:115], v[40:43], v[60:63], v[112:115]
    ds_read_b64_tr_b16 v[52:53], v10 offset:16384
    v_mfma_f32_16x16x32_bf16 v[116:119], v[28:31], v[64:67], v[116:119]
    ds_read_b64_tr_b16 v[54:55], v10 offset:16896
    v_mfma_f32_16x16x32_bf16 v[120:123], v[32:35], v[64:67], v[120:123]
    ds_read_b128 v[16:19], v4 offset:34816
    v_mfma_f32_16x16x32_bf16 v[124:127], v[36:39], v[64:67], v[124:127]
    ds_read_b128 v[20:23], v4 offset:36864
    v_mfma_f32_16x16x32_bf16 v[128:131], v[40:43], v[64:67], v[128:131]
    ds_read_b128 v[24:27], v4 offset:38912
    v_mfma_f32_16x16x32_bf16 v[132:135], v[28:31], v[44:47], v[132:135]
    ds_read_b64_tr_b16 v[56:57], v11 offset:16384
    v_mfma_f32_16x16x32_bf16 v[136:139], v[32:35], v[44:47], v[136:139]
    ds_read_b64_tr_b16 v[58:59], v11 offset:16896
    v_mfma_f32_16x16x32_bf16 v[140:143], v[36:39], v[44:47], v[140:143]
    ds_read_b64_tr_b16 v[60:61], v10 offset:24576
    v_mfma_f32_16x16x32_bf16 v[144:147], v[40:43], v[44:47], v[144:147]
    ds_read_b64_tr_b16 v[62:63], v10 offset:25088
    v_mfma_f32_16x16x32_bf16 v[148:151], v[28:31], v[48:51], v[148:151]
    ds_read_b64_tr_b16 v[64:65], v11 offset:24576
    v_mfma_f32_16x16x32_bf16 v[152:155], v[32:35], v[48:51], v[152:155]
    ds_read_b64_tr_b16 v[66:67], v11 offset:25088
    v_mfma_f32_16x16x32_bf16 v[156:159], v[36:39], v[48:51], v[156:159]
    v_mfma_f32_16x16x32_bf16 v[160:163], v[40:43], v[48:51], v[160:163]
    s_waitcnt lgkmcnt(9)
    v_mfma_f32_16x16x32_bf16 v[100:103], v[12:15], v[52:55], v[100:103]
    ds_read_b128 v[28:31], v5 offset:32768
    s_waitcnt lgkmcnt(9)
    v_mfma_f32_16x16x32_bf16 v[104:107], v[16:19], v[52:55], v[104:107]
    ds_read_b64_tr_b16 v[44:45], v10 offset:20480
    s_waitcnt lgkmcnt(9)
    v_mfma_f32_16x16x32_bf16 v[108:111], v[20:23], v[52:55], v[108:111]
    ds_read_b64_tr_b16 v[46:47], v10 offset:20992
    s_waitcnt lgkmcnt(9)
    v_mfma_f32_16x16x32_bf16 v[112:115], v[24:27], v[52:55], v[112:115]
    ds_read_b128 v[32:35], v5 offset:34816
    s_waitcnt lgkmcnt(8)
    s_nop 0
    v_mfma_f32_16x16x32_bf16 v[116:119], v[12:15], v[56:59], v[116:119]
    ds_read_b128 v[36:39], v5 offset:36864
    v_mfma_f32_16x16x32_bf16 v[120:123], v[16:19], v[56:59], v[120:123]
    ds_read_b128 v[40:43], v5 offset:38912
    v_mfma_f32_16x16x32_bf16 v[124:127], v[20:23], v[56:59], v[124:127]
    ds_read_b64_tr_b16 v[48:49], v11 offset:20480
    v_mfma_f32_16x16x32_bf16 v[128:131], v[24:27], v[56:59], v[128:131]
    ds_read_b64_tr_b16 v[50:51], v11 offset:20992
    s_waitcnt lgkmcnt(10)
    s_nop 0
    v_mfma_f32_16x16x32_bf16 v[132:135], v[12:15], v[60:63], v[132:135]
    ds_read_b64_tr_b16 v[52:53], v10 offset:28672
    v_mfma_f32_16x16x32_bf16 v[136:139], v[16:19], v[60:63], v[136:139]
    ds_read_b64_tr_b16 v[54:55], v10 offset:29184
    v_mfma_f32_16x16x32_bf16 v[140:143], v[20:23], v[60:63], v[140:143]
    ds_read_b64_tr_b16 v[56:57], v11 offset:28672
    v_mfma_f32_16x16x32_bf16 v[144:147], v[24:27], v[60:63], v[144:147]
    ds_read_b64_tr_b16 v[58:59], v11 offset:29184
    s_waitcnt lgkmcnt(12)
    v_mfma_f32_16x16x32_bf16 v[148:151], v[12:15], v[64:67], v[148:151]
    s_branch IW_s4
IW_w4:
    s_branch IW_r4
IW_s4:
    v_mfma_f32_16x16x32_bf16 v[152:155], v[16:19], v[64:67], v[152:155]
    v_mfma_f32_16x16x32_bf16 v[156:159], v[20:23], v[64:67], v[156:159]
    v_mfma_f32_16x16x32_bf16 v[160:163], v[24:27], v[64:67], v[160:163]
    s_waitcnt lgkmcnt(9)
    v_mfma_f32_16x16x32_bf16 v[100:103], v[28:31], v[44:47], v[100:103]
    s_waitcnt lgkmcnt(8)
    v_mfma_f32_16x16x32_bf16 v[104:107], v[32:35], v[44:47], v[104:107]
    s_waitcnt lgkmcnt(0)
    s_barrier
    s_nop 0
    v_mfma_f32_16x16x32_bf16 v[108:111], v[36:39], v[44:47], v[108:111]
    ds_read_b128 v[12:15], v4 offset:49152
    v_mfma_f32_16x16x32_bf16 v[112:115], v[40:43], v[44:47], v[112:115]
    ds_read_b64_tr_b16 v[60:61], v8 offset:0
    v_mfma_f32_16x16x32_bf16 v[116:119], v[28:31], v[48:51], v[116:119]
    ds_read_b64_tr_b16 v[62:63], v8 offset:512
    v_mfma_f32_16x16x32_bf16 v[120:123], v[32:35], v[48:51], v[120:123]
    ds_read_b128 v[16:19], v4 offset:51200
    v_mfma_f32_16x16x32_bf16 v[124:127], v[36:39], v[48:51], v[124:127]
    ds_read_b128 v[20:23], v4 offset:53248
    v_mfma_f32_16x16x32_bf16 v[128:131], v[40:43], v[48:51], v[128:131]
    ds_read_b128 v[24:27], v4 offset:55296
    v_mfma_f32_16x16x32_bf16 v[132:135], v[28:31], v[52:55], v[132:135]
    ds_read_b64_tr_b16 v[64:65], v9 offset:0
    v_mfma_f32_16x16x32_bf16 v[136:139], v[32:35], v[52:55], v[136:139]
    ds_read_b64_tr_b16 v[66:67], v9 offset:512
    v_mfma_f32_16x16x32_bf16 v[140:143], v[36:39], v[52:55], v[140:143]
    ds_read_b64_tr_b16 v[44:45], v10 offset:32768
    v_mfma_f32_16x16x32_bf16 v[144:147], v[40:43], v[52:55], v[144:147]
    ds_read_b64_tr_b16 v[46:47], v10 offset:33280
    v_mfma_f32_16x16x32_bf16 v[148:151], v[28:31], v[56:59], v[148:151]
    ds_read_b64_tr_b16 v[48:49], v11 offset:32768
    v_mfma_f32_16x16x32_bf16 v[152:155], v[32:35], v[56:59], v[152:155]
    ds_read_b64_tr_b16 v[50:51], v11 offset:33280
    v_mfma_f32_16x16x32_bf16 v[156:159], v[36:39], v[56:59], v[156:159]
    v_mfma_f32_16x16x32_bf16 v[160:163], v[40:43], v[56:59], v[160:163]
    s_waitcnt lgkmcnt(9)
    v_mfma_f32_16x16x32_bf16 v[100:103], v[12:15], v[60:63], v[100:103]
    ds_read_b128 v[28:31], v5 offset:49152
    s_waitcnt lgkmcnt(9)
    v_mfma_f32_16x16x32_bf16 v[104:107], v[16:19], v[60:63], v[104:107]
    ds_read_b64_tr_b16 v[52:53], v8 offset:4096
    s_waitcnt lgkmcnt(9)
    v_mfma_f32_16x16x32_bf16 v[108:111], v[20:23], v[60:63], v[108:111]
    ds_read_b64_tr_b16 v[54:55], v8 offset:4608
    s_waitcnt lgkmcnt(9)
    v_mfma_f32_16x16x32_bf16 v[112:115], v[24:27], v[60:63], v[112:115]
    ds_read_b128 v[32:35], v5 offset:51200
    s_waitcnt lgkmcnt(8)
    s_nop 0
    v_mfma_f32_16x16x32_bf16 v[116:119], v[12:15], v[64:67], v[116:119]
    ds_read_b128 v[36:39], v5 offset:53248
    v_mfma_f32_16x16x32_bf16 v[120:123], v[16:19], v[64:67], v[120:123]
    ds_read_b128 v[40:43], v5 offset:55296
    v_mfma_f32_16x16x32_bf16 v[124:127], v[20:23], v[64:67], v[124:127]
    ds_read_b64_tr_b16 v[56:57], v9 offset:4096
    v_mfma_f32_16x16x32_bf16 v[128:131], v[24:27], v[64:67], v[128:131]
    ds_read_b64_tr_b16 v[58:59], v9 offset:4608
    s_waitcnt lgkmcnt(10)
    s_nop 0
    v_mfma_f32_16x16x32_bf16 v[132:135], v[12:15], v[44:47], v[132:135]
    ds_read_b64_tr_b16 v[60:61], v10 offset:36864
    v_mfma_f32_16x16x32_bf16 v[136:139], v[16:19], v[44:47], v[136:139]
    ds_read_b64_tr_b16 v[62:63], v10 offset:37376
    v_mfma_f32_16x16x32_bf16 v[140:143], v[20:23], v[44:47], v[140:143]
    ds_read_b64_tr_b16 v[64:65], v11 offset:36864
    v_mfma_f32_16x16x32_bf16 v[144:147], v[24:27], v[44:47], v[144:147]
    ds_read_b64_tr_b16 v[66:67], v11 offset:37376
    s_waitcnt lgkmcnt(12)
    v_mfma_f32_16x16x32_bf16 v[148:151], v[12:15], v[48:51], v[148:151]
    v_mfma_f32_16x16x32_bf16 v[152:155], v[16:19], v[48:51], v[152:155]
    v_mfma_f32_16x16x32_bf16 v[156:159], v[20:23], v[48:51], v[156:159]
    v_mfma_f32_16x16x32_bf16 v[160:163], v[24:27], v[48:51], v[160:163]
    s_waitcnt lgkmcnt(9)
    v_mfma_f32_16x16x32_bf16 v[100:103], v[28:31], v[52:55], v[100:103]
    s_waitcnt lgkmcnt(8)
    v_mfma_f32_16x16x32_bf16 v[104:107], v[32:35], v[52:55], v[104:107]
    s_waitcnt lgkmcnt(0)
    s_barrier
    s_nop 0
    v_mfma_f32_16x16x32_bf16 v[108:111], v[36:39], v[52:55], v[108:111]
    ds_read_b128 v[12:15], v4 offset:0
    v_mfma_f32_16x16x32_bf16 v[112:115], v[40:43], v[52:55], v[112:115]
    ds_read_b64_tr_b16 v[44:45], v8 offset:8192
    v_mfma_f32_16x16x32_bf16 v[116:119], v[28:31], v[56:59], v[116:119]
    ds_read_b64_tr_b16 v[46:47], v8 offset:8704
    v_mfma_f32_16x16x32_bf16 v[120:123], v[32:35], v[56:59], v[120:123]
    ds_read_b128 v[16:19], v4 offset:2048
    v_mfma_f32_16x16x32_bf16 v[124:127], v[36:39], v[56:59], v[124:127]
    ds_read_b128 v[20:23], v4 offset:4096
    v_mfma_f32_16x16x32_bf16 v[128:131], v[40:43], v[56:59], v[128:131]
    ds_read_b128 v[24:27], v4 offset:6144
    v_mfma_f32_16x16x32_bf16 v[132:135], v[28:31], v[60:63], v[132:135]
    ds_read_b64_tr_b16 v[48:49], v9 offset:8192
    v_mfma_f32_16x16x32_bf16 v[136:139], v[32:35], v[60:63], v[136:139]
    ds_read_b64_tr_b16 v[50:51], v9 offset:8704
    v_mfma_f32_16x16x32_bf16 v[140:143], v[36:39], v[60:63], v[140:143]
    ds_read_b64_tr_b16 v[52:53], v8 offset:16384
    v_mfma_f32_16x16x32_bf16 v[144:147], v[40:43], v[60:63], v[144:147]
    ds_read_b64_tr_b16 v[54:55], v8 offset:16896
    v_mfma_f32_16x16x32_bf16 v[148:151], v[28:31], v[64:67], v[148:151]
    ds_read_b64_tr_b16 v[56:57], v9 offset:16384
    v_mfma_f32_16x16x32_bf16 v[152:155], v[32:35], v[64:67], v[152:155]
    ds_read_b64_tr_b16 v[58:59], v9 offset:16896
    v_mfma_f32_16x16x32_bf16 v[156:159], v[36:39], v[64:67], v[156:159]
    v_mfma_f32_16x16x32_bf16 v[160:163], v[40:43], v[64:67], v[160:163]
    s_waitcnt lgkmcnt(9)
    v_mfma_f32_16x16x32_bf16 v[100:103], v[12:15], v[44:47], v[100:103]
    ds_read_b128 v[28:31], v5 offset:0
    s_waitcnt lgkmcnt(9)
    v_mfma_f32_16x16x32_bf16 v[104:107], v[16:19], v[44:47], v[104:107]
    ds_read_b64_tr_b16 v[60:61], v8 offset:12288
    s_waitcnt lgkmcnt(9)
    v_mfma_f32_16x16x32_bf16 v[108:111], v[20:23], v[44:47], v[108:111]
    ds_read_b64_tr_b16 v[62:63], v8 offset:12800
    s_waitcnt lgkmcnt(9)
    v_mfma_f32_16x16x32_bf16 v[112:115], v[24:27], v[44:47], v[112:115]
    ds_read_b128 v[32:35], v5 offset:2048
    s_waitcnt lgkmcnt(8)
    s_nop 0
    v_mfma_f32_16x16x32_bf16 v[116:119], v[12:15], v[48:51], v[116:119]
    ds_read_b128 v[36:39], v5 offset:4096
    v_mfma_f32_16x16x32_bf16 v[120:123], v[16:19], v[48:51], v[120:123]
    ds_read_b128 v[40:43], v5 offset:6144
    v_mfma_f32_16x16x32_bf16 v[124:127], v[20:23], v[48:51], v[124:127]
    ds_read_b64_tr_b16 v[64:65], v9 offset:12288
    v_mfma_f32_16x16x32_bf16 v[128:131], v[24:27], v[48:51], v[128:131]
    ds_read_b64_tr_b16 v[66:67], v9 offset:12800
    s_waitcnt lgkmcnt(10)
    s_nop 0
    v_mfma_f32_16x16x32_bf16 v[132:135], v[12:15], v[52:55], v[132:135]
    ds_read_b64_tr_b16 v[44:45], v8 offset:20480
    v_mfma_f32_16x16x32_bf16 v[136:139], v[16:19], v[52:55], v[136:139]
    ds_read_b64_tr_b16 v[46:47], v8 offset:20992
    v_mfma_f32_16x16x32_bf16 v[140:143], v[20:23], v[52:55], v[140:143]
    ds_read_b64_tr_b16 v[48:49], v9 offset:20480
    v_mfma_f32_16x16x32_bf16 v[144:147], v[24:27], v[52:55], v[144:147]
    ds_read_b64_tr_b16 v[50:51], v9 offset:20992
    s_waitcnt lgkmcnt(12)
    v_mfma_f32_16x16x32_bf16 v[148:151], v[12:15], v[56:59], v[148:151]
    v_mfma_f32_16x16x32_bf16 v[152:155], v[16:19], v[56:59], v[152:155]
    v_mfma_f32_16x16x32_bf16 v[156:159], v[20:23], v[56:59], v[156:159]
    v_mfma_f32_16x16x32_bf16 v[160:163], v[24:27], v[56:59], v[160:163]
    s_waitcnt lgkmcnt(9)
    v_mfma_f32_16x16x32_bf16 v[100:103], v[28:31], v[60:63], v[100:103]
    s_waitcnt lgkmcnt(8)
    v_mfma_f32_16x16x32_bf16 v[104:107], v[32:35], v[60:63], v[104:107]
    s_waitcnt lgkmcnt(0)
    s_barrier
    s_nop 0
    v_mfma_f32_16x16x32_bf16 v[108:111], v[36:39], v[60:63], v[108:111]
    ds_read_b128 v[12:15], v4 offset:16384
    v_mfma_f32_16x16x32_bf16 v[112:115], v[40:43], v[60:63], v[112:115]
    ds_read_b64_tr_b16 v[52:53], v8 offset:24576
    v_mfma_f32_16x16x32_bf16 v[116:119], v[28:31], v[64:67], v[116:119]
    ds_read_b64_tr_b16 v[54:55], v8 offset:25088
    v_mfma_f32_16x16x32_bf16 v[120:123], v[32:35], v[64:67], v[120:123]
    ds_read_b128 v[16:19], v4 offset:18432
    v_mfma_f32_16x16x32_bf16 v[124:127], v[36:39], v[64:67], v[124:127]
    ds_read_b128 v[20:23], v4 offset:20480
    v_mfma_f32_16x16x32_bf16 v[128:131], v[40:43], v[64:67], v[128:131]
    ds_read_b128 v[24:27], v4 offset:22528
    v_mfma_f32_16x16x32_bf16 v[132:135], v[28:31], v[44:47], v[132:135]
    ds_read_b64_tr_b16 v[56:57], v9 offset:24576
    v_mfma_f32_16x16x32_bf16 v[136:139], v[32:35], v[44:47], v[136:139]
    ds_read_b64_tr_b16 v[58:59], v9 offset:25088
    v_mfma_f32_16x16x32_bf16 v[140:143], v[36:39], v[44:47], v[140:143]
    ds_read_b64_tr_b16 v[60:61], v10 offset:0
    v_mfma_f32_16x16x32_bf16 v[144:147], v[40:43], v[44:47], v[144:147]
    ds_read_b64_tr_b16 v[62:63], v10 offset:512
    v_mfma_f32_16x16x32_bf16 v[148:151], v[28:31], v[48:51], v[148:151]
    ds_read_b64_tr_b16 v[64:65], v11 offset:0
    v_mfma_f32_16x16x32_bf16 v[152:155], v[32:35], v[48:51], v[152:155]
    ds_read_b64_tr_b16 v[66:67], v11 offset:512
    v_mfma_f32_16x16x32_bf16 v[156:159], v[36:39], v[48:51], v[156:159]
    v_mfma_f32_16x16x32_bf16 v[160:163], v[40:43], v[48:51], v[160:163]
    s_waitcnt lgkmcnt(9)
    v_mfma_f32_16x16x32_bf16 v[100:103], v[12:15], v[52:55], v[100:103]
    ds_read_b128 v[28:31], v5 offset:16384
    s_waitcnt lgkmcnt(9)
    v_mfma_f32_16x16x32_bf16 v[104:107], v[16:19], v[52:55], v[104:107]
    ds_read_b64_tr_b16 v[44:45], v8 offset:28672
    s_waitcnt lgkmcnt(9)
    v_mfma_f32_16x16x32_bf16 v[108:111], v[20:23], v[52:55], v[108:111]
    ds_read_b64_tr_b16 v[46:47], v8 offset:29184
    s_waitcnt lgkmcnt(9)
    v_mfma_f32_16x16x32_bf16 v[112:115], v[24:27], v[52:55], v[112:115]
    ds_read_b128 v[32:35], v5 offset:18432
    s_waitcnt lgkmcnt(8)
    s_nop 0
    v_mfma_f32_16x16x32_bf16 v[116:119], v[12:15], v[56:59], v[116:119]
    ds_read_b128 v[36:39], v5 offset:20480
    v_mfma_f32_16x16x32_bf16 v[120:123], v[16:19], v[56:59], v[120:123]
    ds_read_b128 v[40:43], v5 offset:22528
    v_mfma_f32_16x16x32_bf16 v[124:127], v[20:23], v[56:59], v[124:127]
    ds_read_b64_tr_b16 v[48:49], v9 offset:28672
    v_mfma_f32_16x16x32_bf16 v[128:131], v[24:27], v[56:59], v[128:131]
    ds_read_b64_tr_b16 v[50:51], v9 offset:29184
    s_waitcnt lgkmcnt(10)
    s_nop 0
    v_mfma_f32_16x16x32_bf16 v[132:135], v[12:15], v[60:63], v[132:135]
    ds_read_b64_tr_b16 v[52:53], v10 offset:4096
    v_mfma_f32_16x16x32_bf16 v[136:139], v[16:19], v[60:63], v[136:139]
    ds_read_b64_tr_b16 v[54:55], v10 offset:4608
    v_mfma_f32_16x16x32_bf16 v[140:143], v[20:23], v[60:63], v[140:143]
    ds_read_b64_tr_b16 v[56:57], v11 offset:4096
    v_mfma_f32_16x16x32_bf16 v[144:147], v[24:27], v[60:63], v[144:147]
    ds_read_b64_tr_b16 v[58:59], v11 offset:4608
    s_waitcnt lgkmcnt(12)
    v_mfma_f32_16x16x32_bf16 v[148:151], v[12:15], v[64:67], v[148:151]
    v_mfma_f32_16x16x32_bf16 v[152:155], v[16:19], v[64:67], v[152:155]
    v_mfma_f32_16x16x32_bf16 v[156:159], v[20:23], v[64:67], v[156:159]
    v_mfma_f32_16x16x32_bf16 v[160:163], v[24:27], v[64:67], v[160:163]
    s_waitcnt lgkmcnt(9)
    v_mfma_f32_16x16x32_bf16 v[100:103], v[28:31], v[44:47], v[100:103]
    s_waitcnt lgkmcnt(8)
    v_mfma_f32_16x16x32_bf16 v[104:107], v[32:35], v[44:47], v[104:107]
    s_waitcnt lgkmcnt(0)
    s_barrier
    s_nop 0
    v_mfma_f32_16x16x32_bf16 v[108:111], v[36:39], v[44:47], v[108:111]
    ds_read_b128 v[12:15], v4 offset:32768
    v_mfma_f32_16x16x32_bf16 v[112:115], v[40:43], v[44:47], v[112:115]
    ds_read_b64_tr_b16 v[60:61], v10 offset:8192
    v_mfma_f32_16x16x32_bf16 v[116:119], v[28:31], v[48:51], v[116:119]
    ds_read_b64_tr_b16 v[62:63], v10 offset:8704
    v_mfma_f32_16x16x32_bf16 v[120:123], v[32:35], v[48:51], v[120:123]
    ds_read_b128 v[16:19], v4 offset:34816
    v_mfma_f32_16x16x32_bf16 v[124:127], v[36:39], v[48:51], v[124:127]
    ds_read_b128 v[20:23], v4 offset:36864
    v_mfma_f32_16x16x32_bf16 v[128:131], v[40:43], v[48:51], v[128:131]
    ds_read_b128 v[24:27], v4 offset:38912
    v_mfma_f32_16x16x32_bf16 v[132:135], v[28:31], v[52:55], v[132:135]
    ds_read_b64_tr_b16 v[64:65], v11 offset:8192
    v_mfma_f32_16x16x32_bf16 v[136:139], v[32:35], v[52:55], v[136:139]
    ds_read_b64_tr_b16 v[66:67], v11 offset:8704
    v_mfma_f32_16x16x32_bf16 v[140:143], v[36:39], v[52:55], v[140:143]
    ds_read_b64_tr_b16 v[44:45], v10 offset:16384
    v_mfma_f32_16x16x32_bf16 v[144:147], v[40:43], v[52:55], v[144:147]
    ds_read_b64_tr_b16 v[46:47], v10 offset:16896
    v_mfma_f32_16x16x32_bf16 v[148:151], v[28:31], v[56:59], v[148:151]
    ds_read_b64_tr_b16 v[48:49], v11 offset:16384
    v_mfma_f32_16x16x32_bf16 v[152:155], v[32:35], v[56:59], v[152:155]
    ds_read_b64_tr_b16 v[50:51], v11 offset:16896
    v_mfma_f32_16x16x32_bf16 v[156:159], v[36:39], v[56:59], v[156:159]
    v_mfma_f32_16x16x32_bf16 v[160:163], v[40:43], v[56:59], v[160:163]
    s_waitcnt lgkmcnt(9)
    v_mfma_f32_16x16x32_bf16 v[100:103], v[12:15], v[60:63], v[100:103]
    ds_read_b128 v[28:31], v5 offset:32768
    s_waitcnt lgkmcnt(9)
    v_mfma_f32_16x16x32_bf16 v[104:107], v[16:19], v[60:63], v[104:107]
    ds_read_b64_tr_b16 v[52:53], v10 offset:12288
    s_waitcnt lgkmcnt(9)
    v_mfma_f32_16x16x32_bf16 v[108:111], v[20:23], v[60:63], v[108:111]
    ds_read_b64_tr_b16 v[54:55], v10 offset:12800
    s_waitcnt lgkmcnt(9)
    v_mfma_f32_16x16x32_bf16 v[112:115], v[24:27], v[60:63], v[112:115]
    ds_read_b128 v[32:35], v5 offset:34816
    s_waitcnt lgkmcnt(8)
    s_nop 0
    v_mfma_f32_16x16x32_bf16 v[116:119], v[12:15], v[64:67], v[116:119]
    ds_read_b128 v[36:39], v5 offset:36864
    v_mfma_f32_16x16x32_bf16 v[120:123], v[16:19], v[64:67], v[120:123]
    ds_read_b128 v[40:43], v5 offset:38912
    v_mfma_f32_16x16x32_bf16 v[124:127], v[20:23], v[64:67], v[124:127]
    ds_read_b64_tr_b16 v[56:57], v11 offset:12288
    v_mfma_f32_16x16x32_bf16 v[128:131], v[24:27], v[64:67], v[128:131]
    ds_read_b64_tr_b16 v[58:59], v11 offset:12800
    s_waitcnt lgkmcnt(10)
    s_nop 0
    v_mfma_f32_16x16x32_bf16 v[132:135], v[12:15], v[44:47], v[132:135]
    ds_read_b64_tr_b16 v[60:61], v10 offset:20480
    v_mfma_f32_16x16x32_bf16 v[136:139], v[16:19], v[44:47], v[136:139]
    ds_read_b64_tr_b16 v[62:63], v10 offset:20992
    v_mfma_f32_16x16x32_bf16 v[140:143], v[20:23], v[44:47], v[140:143]
    ds_read_b64_tr_b16 v[64:65], v11 offset:20480
    v_mfma_f32_16x16x32_bf16 v[144:147], v[24:27], v[44:47], v[144:147]
    ds_read_b64_tr_b16 v[66:67], v11 offset:20992
    s_waitcnt lgkmcnt(12)
    v_mfma_f32_16x16x32_bf16 v[148:151], v[12:15], v[48:51], v[148:151]
    v_mfma_f32_16x16x32_bf16 v[152:155], v[16:19], v[48:51], v[152:155]
    v_mfma_f32_16x16x32_bf16 v[156:159], v[20:23], v[48:51], v[156:159]
    v_mfma_f32_16x16x32_bf16 v[160:163], v[24:27], v[48:51], v[160:163]
    s_waitcnt lgkmcnt(9)
    v_mfma_f32_16x16x32_bf16 v[100:103], v[28:31], v[52:55], v[100:103]
    s_waitcnt lgkmcnt(8)
    v_mfma_f32_16x16x32_bf16 v[104:107], v[32:35], v[52:55], v[104:107]
    s_waitcnt lgkmcnt(0)
    s_barrier
    s_nop 0
    v_mfma_f32_16x16x32_bf16 v[108:111], v[36:39], v[52:55], v[108:111]
    ds_read_b128 v[12:15], v4 offset:49152
    v_mfma_f32_16x16x32_bf16 v[112:115], v[40:43], v[52:55], v[112:115]
    ds_read_b64_tr_b16 v[44:45], v8 offset:0
    v_mfma_f32_16x16x32_bf16 v[116:119], v[28:31], v[56:59], v[116:119]
    ds_read_b64_tr_b16 v[46:47], v8 offset:512
    v_mfma_f32_16x16x32_bf16 v[120:123], v[32:35], v[56:59], v[120:123]
    ds_read_b128 v[16:19], v4 offset:51200
    v_mfma_f32_16x16x32_bf16 v[124:127], v[36:39], v[56:59], v[124:127]
    ds_read_b128 v[20:23], v4 offset:53248
    v_mfma_f32_16x16x32_bf16 v[128:131], v[40:43], v[56:59], v[128:131]
    ds_read_b128 v[24:27], v4 offset:55296
    v_mfma_f32_16x16x32_bf16 v[132:135], v[28:31], v[60:63], v[132:135]
    ds_read_b64_tr_b16 v[48:49], v9 offset:0
    v_mfma_f32_16x16x32_bf16 v[136:139], v[32:35], v[60:63], v[136:139]
    ds_read_b64_tr_b16 v[50:51], v9 offset:512
    v_mfma_f32_16x16x32_bf16 v[140:143], v[36:39], v[60:63], v[140:143]
    ds_read_b64_tr_b16 v[52:53], v10 offset:24576
    v_mfma_f32_16x16x32_bf16 v[144:147], v[40:43], v[60:63], v[144:147]
    ds_read_b64_tr_b16 v[54:55], v10 offset:25088
    v_mfma_f32_16x16x32_bf16 v[148:151], v[28:31], v[64:67], v[148:151]
    ds_read_b64_tr_b16 v[56:57], v11 offset:24576
    v_mfma_f32_16x16x32_bf16 v[152:155], v[32:35], v[64:67], v[152:155]
    ds_read_b64_tr_b16 v[58:59], v11 offset:25088
    v_mfma_f32_16x16x32_bf16 v[156:159], v[36:39], v[64:67], v[156:159]
    v_mfma_f32_16x16x32_bf16 v[160:163], v[40:43], v[64:67], v[160:163]
    ds_read_b32 v68, v1 offset:48
    s_waitcnt lgkmcnt(10)
    v_mfma_f32_16x16x32_bf16 v[100:103], v[12:15], v[44:47], v[100:103]
    ds_read_b128 v[28:31], v5 offset:49152
    s_waitcnt lgkmcnt(10)
    v_mfma_f32_16x16x32_bf16 v[104:107], v[16:19], v[44:47], v[104:107]
    ds_read_b64_tr_b16 v[60:61], v8 offset:4096
    s_waitcnt lgkmcnt(10)
    v_mfma_f32_16x16x32_bf16 v[108:111], v[20:23], v[44:47], v[108:111]
    ds_read_b64_tr_b16 v[62:63], v8 offset:4608
    s_waitcnt lgkmcnt(10)
    v_mfma_f32_16x16x32_bf16 v[112:115], v[24:27], v[44:47], v[112:115]
    ds_read_b128 v[32:35], v5 offset:51200
    s_waitcnt lgkmcnt(9)
    s_nop 0
    v_mfma_f32_16x16x32_bf16 v[116:119], v[12:15], v[48:51], v[116:119]
    ds_read_b128 v[36:39], v5 offset:53248
    v_mfma_f32_16x16x32_bf16 v[120:123], v[16:19], v[48:51], v[120:123]
    ds_read_b128 v[40:43], v5 offset:55296
    v_mfma_f32_16x16x32_bf16 v[124:127], v[20:23], v[48:51], v[124:127]
    ds_read_b64_tr_b16 v[64:65], v9 offset:4096
    v_mfma_f32_16x16x32_bf16 v[128:131], v[24:27], v[48:51], v[128:131]
    ds_read_b64_tr_b16 v[66:67], v9 offset:4608
    s_waitcnt lgkmcnt(11)
    s_nop 0
    v_mfma_f32_16x16x32_bf16 v[132:135], v[12:15], v[52:55], v[132:135]
    ds_read_b64_tr_b16 v[44:45], v10 offset:28672
    v_mfma_f32_16x16x32_bf16 v[136:139], v[16:19], v[52:55], v[136:139]
    ds_read_b64_tr_b16 v[46:47], v10 offset:29184
    v_mfma_f32_16x16x32_bf16 v[140:143], v[20:23], v[52:55], v[140:143]
    ds_read_b64_tr_b16 v[48:49], v11 offset:28672
    v_mfma_f32_16x16x32_bf16 v[144:147], v[24:27], v[52:55], v[144:147]
    ds_read_b64_tr_b16 v[50:51], v11 offset:29184
    s_waitcnt lgkmcnt(13)
    v_mfma_f32_16x16x32_bf16 v[148:151], v[12:15], v[56:59], v[148:151]
    v_mfma_f32_16x16x32_bf16 v[152:155], v[16:19], v[56:59], v[152:155]
    v_mfma_f32_16x16x32_bf16 v[156:159], v[20:23], v[56:59], v[156:159]
    v_mfma_f32_16x16x32_bf16 v[160:163], v[24:27], v[56:59], v[160:163]
    s_waitcnt lgkmcnt(9)
    v_mfma_f32_16x16x32_bf16 v[100:103], v[28:31], v[60:63], v[100:103]
    v_lshlrev_b32 v18, 4, v0
    v_add_u32 v12, s52, v18
    s_waitcnt lgkmcnt(8)
    v_mfma_f32_16x16x32_bf16 v[104:107], v[32:35], v[60:63], v[104:107]
    v_xor_b32 v13, 4096, v12
    v_and_b32 v14, 0x30, v0
    s_waitcnt lgkmcnt(0)
    s_barrier
    v_cmp_gt_u32 vcc, 1, v68
    s_nop 0
    s_and_b32 vcc_lo, vcc_lo, 3
    s_cbranch_scc0 SCK_15
    v_and_b32 v69, 1, v0
    v_lshlrev_b32 v69, 2, v69
    v_add_u32 v69, 159088, v69
    ds_read_b32 v68, v69 offset:0
FW_16:
    s_waitcnt lgkmcnt(0)
    v_cmp_gt_u32 vcc, 1, v68
    s_cbranch_vccz FO_17
    ds_read_b32 v68, v69 offset:0
    s_branch FW_16
FO_17:
SCK_15:
    v_mfma_f32_16x16x32_bf16 v[108:111], v[36:39], v[60:63], v[108:111]
    ds_read_b128 v[68:71], v164 offset:0
    v_add_u32 v14, s53, v14
    v_mfma_f32_16x16x32_bf16 v[112:115], v[40:43], v[60:63], v[112:115]
    ds_read2_b32 v[52:53], v165 offset0:64 offset1:64
    v_xor_b32 v15, 64, v14
    v_mfma_f32_16x16x32_bf16 v[116:119], v[28:31], v[64:67], v[116:119]
    ds_read2_b32 v[54:55], v2 offset0:64 offset1:64
    v_lshlrev_b32 v19, 2, v0
    v_mfma_f32_16x16x32_bf16 v[120:123], v[32:35], v[64:67], v[120:123]
    ds_read2_b32 v[56:57], v165 offset0:128 offset1:128
    v_add_u32 v16, s53, v19
    v_mfma_f32_16x16x32_bf16 v[124:127], v[36:39], v[64:67], v[124:127]
    ds_read2_b32 v[58:59], v2 offset0:128 offset1:128
    v_xor_b32 v17, 256, v16
    v_mfma_f32_16x16x32_bf16 v[128:131], v[40:43], v[64:67], v[128:131]
    ds_read_b128 v[72:75], v164 offset:1024
    v_xor_b32_e64 v18, 8, v3
    v_mfma_f32_16x16x32_bf16 v[132:135], v[28:31], v[44:47], v[132:135]
    ds_read_b128 v[76:79], v164 offset:64
    v_writelane_b32 v18, s50, 1
    v_mfma_f32_16x16x32_bf16 v[136:139], v[32:35], v[44:47], v[136:139]
    ds_read_b128 v[80:83], v164 offset:1088
    v_mov_b32 v20, 0x3f803f80
    v_mfma_f32_16x16x32_bf16 v[140:143], v[36:39], v[44:47], v[140:143]
    ds_read_b128 v[84:87], v164 offset:128
    v_mov_b32 v21, 0x3f803f80
    v_mfma_f32_16x16x32_bf16 v[144:147], v[40:43], v[44:47], v[144:147]
    ds_read_b128 v[88:91], v164 offset:1152
    v_mov_b32 v22, 0x3f803f80
    v_mfma_f32_16x16x32_bf16 v[148:151], v[28:31], v[48:51], v[148:151]
    ds_read_b128 v[92:95], v164 offset:192
    v_mov_b32 v23, 0x3f803f80
    v_mfma_f32_16x16x32_bf16 v[152:155], v[32:35], v[48:51], v[152:155]
    ds_read_b128 v[96:99], v164 offset:1216
    v_mov_b32 v24, 1
    v_and_b32 v4, 15, v0
    v_mfma_f32_16x16x32_bf16 v[156:159], v[36:39], v[48:51], v[156:159]
    v_bfe_u32 v5, v0, 4, 1
    v_lshlrev_b32 v5, 5, v5
    v_mfma_f32_16x16x32_bf16 v[160:163], v[40:43], v[48:51], v[160:163]
    v_lshrrev_b32 v6, 5, v0
    v_lshl_add_u32 v5, v6, 4, v5
    v_lshl_add_u32 v7, v4, 11, v5
    v_lshlrev_b32 v6, 4, v0
    s_waitcnt lgkmcnt(10)
    v_pk_fma_f32 v[100:101], v[68:69], v[52:53], v[100:101]
    v_pk_fma_f32 v[102:103], v[70:71], v[52:53], v[102:103]
    s_waitcnt lgkmcnt(9)
    v_pk_fma_f32 v[116:117], v[68:69], v[54:55], v[116:117]
    v_pk_fma_f32 v[118:119], v[70:71], v[54:55], v[118:119]
    s_waitcnt lgkmcnt(8)
    v_pk_fma_f32 v[132:133], v[68:69], v[56:57], v[132:133]
    v_pk_fma_f32 v[134:135], v[70:71], v[56:57], v[134:135]
    s_waitcnt lgkmcnt(7)
    v_pk_fma_f32 v[148:149], v[68:69], v[58:59], v[148:149]
    v_pk_fma_f32 v[150:151], v[70:71], v[58:59], v[150:151]
    s_waitcnt lgkmcnt(6)
    v_pk_mul_f32 v[100:101], v[100:101], v[72:73]
    v_pk_mul_f32 v[102:103], v[102:103], v[74:75]
    v_pk_mul_f32 v[116:117], v[116:117], v[72:73]
    v_pk_mul_f32 v[118:119], v[118:119], v[74:75]
    v_pk_mul_f32 v[132:133], v[132:133], v[72:73]
    v_pk_mul_f32 v[134:135], v[134:135], v[74:75]
    v_pk_mul_f32 v[148:149], v[148:149], v[72:73]
    v_pk_mul_f32 v[150:151], v[150:151], v[74:75]
    v_exp_f32 v28, v100 clamp
    v_exp_f32 v29, v101 clamp
    v_exp_f32 v30, v102 clamp
    v_exp_f32 v31, v103 clamp
    v_exp_f32 v32, v116 clamp
    v_exp_f32 v33, v117 clamp
    v_exp_f32 v34, v118 clamp
    v_exp_f32 v35, v119 clamp
    v_cvt_pk_bf16_f32 v132, v132, v133
    v_cvt_pk_bf16_f32 v133, v134, v135
    v_cvt_pk_bf16_f32 v148, v148, v149
    v_cvt_pk_bf16_f32 v149, v150, v151
    v_pk_mul_f32 v[100:101], v[100:101], s[40:41] clamp
    v_pk_mul_f32 v[102:103], v[102:103], s[40:41] clamp
    v_pk_mul_f32 v[116:117], v[116:117], s[40:41] clamp
    v_pk_mul_f32 v[118:119], v[118:119], s[40:41] clamp
    v_pk_add_f32 v[28:29], v[28:29], s[74:75]
    v_pk_add_f32 v[30:31], v[30:31], s[74:75]
    v_pk_add_f32 v[32:33], v[32:33], s[74:75]
    v_pk_add_f32 v[34:35], v[34:35], s[74:75]
    v_pk_fma_f32 v[100:101], v[100:101], s[76:77], v[28:29]
    v_pk_fma_f32 v[102:103], v[102:103], s[76:77], v[30:31]
    v_pk_fma_f32 v[116:117], v[116:117], s[76:77], v[32:33]
    v_pk_fma_f32 v[118:119], v[118:119], s[76:77], v[34:35]
    v_cvt_pk_bf16_f32 v100, v100, v101
    v_cvt_pk_bf16_f32 v101, v102, v103
    v_cvt_pk_bf16_f32 v116, v116, v117
    v_cvt_pk_bf16_f32 v117, v118, v119
    s_waitcnt lgkmcnt(5)
    s_nop 0
    v_pk_fma_f32 v[104:105], v[76:77], v[52:53], v[104:105]
    v_pk_fma_f32 v[106:107], v[78:79], v[52:53], v[106:107]
    v_pk_fma_f32 v[120:121], v[76:77], v[54:55], v[120:121]
    v_pk_fma_f32 v[122:123], v[78:79], v[54:55], v[122:123]
    v_pk_fma_f32 v[136:137], v[76:77], v[56:57], v[136:137]
    v_pk_fma_f32 v[138:139], v[78:79], v[56:57], v[138:139]
    v_pk_fma_f32 v[152:153], v[76:77], v[58:59], v[152:153]
    v_pk_fma_f32 v[154:155], v[78:79], v[58:59], v[154:155]
    s_waitcnt lgkmcnt(4)
    s_nop 0
    v_pk_mul_f32 v[104:105], v[104:105], v[80:81]
    v_pk_mul_f32 v[106:107], v[106:107], v[82:83]
    v_pk_mul_f32 v[120:121], v[120:121], v[80:81]
    v_pk_mul_f32 v[122:123], v[122:123], v[82:83]
    v_pk_mul_f32 v[136:137], v[136:137], v[80:81]
    v_pk_mul_f32 v[138:139], v[138:139], v[82:83]
    v_pk_mul_f32 v[152:153], v[152:153], v[80:81]
    v_pk_mul_f32 v[154:155], v[154:155], v[82:83]
    v_exp_f32 v36, v104 clamp
    v_exp_f32 v37, v105 clamp
    v_exp_f32 v38, v106 clamp
    v_exp_f32 v39, v107 clamp
    v_exp_f32 v40, v120 clamp
    v_exp_f32 v41, v121 clamp
    v_exp_f32 v42, v122 clamp
    v_exp_f32 v43, v123 clamp
    v_cvt_pk_bf16_f32 v134, v136, v137
    v_cvt_pk_bf16_f32 v135, v138, v139
    v_cvt_pk_bf16_f32 v150, v152, v153
    v_cvt_pk_bf16_f32 v151, v154, v155
    v_pk_mul_f32 v[104:105], v[104:105], s[40:41] clamp
    v_pk_mul_f32 v[106:107], v[106:107], s[40:41] clamp
    v_pk_mul_f32 v[120:121], v[120:121], s[40:41] clamp
    v_pk_mul_f32 v[122:123], v[122:123], s[40:41] clamp
    v_pk_add_f32 v[36:37], v[36:37], s[74:75]
    v_pk_add_f32 v[38:39], v[38:39], s[74:75]
    v_pk_add_f32 v[40:41], v[40:41], s[74:75]
    v_pk_add_f32 v[42:43], v[42:43], s[74:75]
    v_pk_fma_f32 v[104:105], v[104:105], s[76:77], v[36:37]
    v_pk_fma_f32 v[106:107], v[106:107], s[76:77], v[38:39]
    v_pk_fma_f32 v[120:121], v[120:121], s[76:77], v[40:41]
    v_pk_fma_f32 v[122:123], v[122:123], s[76:77], v[42:43]
    v_cvt_pk_bf16_f32 v102, v104, v105
    v_cvt_pk_bf16_f32 v103, v106, v107
    v_cvt_pk_bf16_f32 v118, v120, v121
    v_cvt_pk_bf16_f32 v119, v122, v123
    s_waitcnt lgkmcnt(3)
    s_nop 0
    v_pk_fma_f32 v[108:109], v[84:85], v[52:53], v[108:109]
    v_pk_fma_f32 v[110:111], v[86:87], v[52:53], v[110:111]
    v_pk_fma_f32 v[124:125], v[84:85], v[54:55], v[124:125]
    v_pk_fma_f32 v[126:127], v[86:87], v[54:55], v[126:127]
    v_pk_fma_f32 v[140:141], v[84:85], v[56:57], v[140:141]
    v_pk_fma_f32 v[142:143], v[86:87], v[56:57], v[142:143]
    v_pk_fma_f32 v[156:157], v[84:85], v[58:59], v[156:157]
    v_pk_fma_f32 v[158:159], v[86:87], v[58:59], v[158:159]
    s_waitcnt lgkmcnt(2)
    s_nop 0
    v_pk_mul_f32 v[108:109], v[108:109], v[88:89]
    v_pk_mul_f32 v[110:111], v[110:111], v[90:91]
    v_pk_mul_f32 v[124:125], v[124:125], v[88:89]
    v_pk_mul_f32 v[126:127], v[126:127], v[90:91]
    v_pk_mul_f32 v[140:141], v[140:141], v[88:89]
    v_pk_mul_f32 v[142:143], v[142:143], v[90:91]
    v_pk_mul_f32 v[156:157], v[156:157], v[88:89]
    v_pk_mul_f32 v[158:159], v[158:159], v[90:91]
    v_mfma_f32_16x16x32_bf16 v[60:63], v[100:103], v[148:151], 0
    v_exp_f32 v28, v108 clamp
    v_exp_f32 v29, v109 clamp
    v_mfma_f32_16x16x32_bf16 v[64:67], v[116:119], v[148:151], 0
    v_exp_f32 v30, v110 clamp
    v_exp_f32 v31, v111 clamp
    v_mfma_f32_16x16x32_bf16 v[68:71], v[100:103], v[20:23], 0
    v_exp_f32 v32, v124 clamp
    v_exp_f32 v33, v125 clamp
    v_exp_f32 v34, v126 clamp
    v_exp_f32 v35, v127 clamp
    v_cvt_pk_bf16_f32 v136, v140, v141
    v_cvt_pk_bf16_f32 v137, v142, v143
    v_cvt_pk_bf16_f32 v152, v156, v157
    v_cvt_pk_bf16_f32 v153, v158, v159
    v_pk_mul_f32 v[108:109], v[108:109], s[40:41] clamp
    v_pk_mul_f32 v[110:111], v[110:111], s[40:41] clamp
    v_pk_mul_f32 v[124:125], v[124:125], s[40:41] clamp
    v_pk_mul_f32 v[126:127], v[126:127], s[40:41] clamp
    v_pk_add_f32 v[28:29], v[28:29], s[74:75]
    v_pk_add_f32 v[30:31], v[30:31], s[74:75]
    v_pk_add_f32 v[32:33], v[32:33], s[74:75]
    v_pk_add_f32 v[34:35], v[34:35], s[74:75]
    v_pk_fma_f32 v[108:109], v[108:109], s[76:77], v[28:29]
    v_pk_fma_f32 v[110:111], v[110:111], s[76:77], v[30:31]
    v_pk_fma_f32 v[124:125], v[124:125], s[76:77], v[32:33]
    v_pk_fma_f32 v[126:127], v[126:127], s[76:77], v[34:35]
    s_branch IW_s5
IW_w5:
    s_branch IW_r5
IW_s5:
    v_cvt_pk_bf16_f32 v104, v108, v109
    v_cvt_pk_bf16_f32 v105, v110, v111
    v_cvt_pk_bf16_f32 v120, v124, v125
    v_cvt_pk_bf16_f32 v121, v126, v127
    s_waitcnt lgkmcnt(1)
    s_nop 0
    v_pk_fma_f32 v[112:113], v[92:93], v[52:53], v[112:113]
    v_pk_fma_f32 v[114:115], v[94:95], v[52:53], v[114:115]
    v_pk_fma_f32 v[128:129], v[92:93], v[54:55], v[128:129]
    v_pk_fma_f32 v[130:131], v[94:95], v[54:55], v[130:131]
    v_pk_fma_f32 v[144:145], v[92:93], v[56:57], v[144:145]
    v_pk_fma_f32 v[146:147], v[94:95], v[56:57], v[146:147]
    v_pk_fma_f32 v[160:161], v[92:93], v[58:59], v[160:161]
    v_pk_fma_f32 v[162:163], v[94:95], v[58:59], v[162:163]
    s_waitcnt lgkmcnt(0)
    s_nop 0
    v_pk_mul_f32 v[112:113], v[112:113], v[96:97]
    v_pk_mul_f32 v[114:115], v[114:115], v[98:99]
    v_pk_mul_f32 v[128:129], v[128:129], v[96:97]
    v_pk_mul_f32 v[130:131], v[130:131], v[98:99]
    v_pk_mul_f32 v[144:145], v[144:145], v[96:97]
    v_pk_mul_f32 v[146:147], v[146:147], v[98:99]
    v_pk_mul_f32 v[160:161], v[160:161], v[96:97]
    v_pk_mul_f32 v[162:163], v[162:163], v[98:99]
    v_mfma_f32_16x16x32_bf16 v[72:75], v[116:119], v[20:23], 0
    v_exp_f32 v36, v112 clamp
    v_exp_f32 v37, v113 clamp
    v_mfma_f32_16x16x32_bf16 v[44:47], v[100:103], v[132:135], 0
    v_exp_f32 v38, v114 clamp
    v_exp_f32 v39, v115 clamp
    v_mfma_f32_16x16x32_bf16 v[48:51], v[116:119], v[132:135], 0
    v_exp_f32 v40, v128 clamp
    v_exp_f32 v41, v129 clamp
    v_exp_f32 v42, v130 clamp
    v_exp_f32 v43, v131 clamp
    v_cvt_pk_bf16_f32 v138, v144, v145
    v_cvt_pk_bf16_f32 v139, v146, v147
    v_cvt_pk_bf16_f32 v154, v160, v161
    v_cvt_pk_bf16_f32 v155, v162, v163
    v_pk_mul_f32 v[112:113], v[112:113], s[40:41] clamp
    v_pk_mul_f32 v[114:115], v[114:115], s[40:41] clamp
    v_pk_mul_f32 v[128:129], v[128:129], s[40:41] clamp
    v_pk_mul_f32 v[130:131], v[130:131], s[40:41] clamp
    v_pk_add_f32 v[36:37], v[36:37], s[74:75]
    v_pk_add_f32 v[38:39], v[38:39], s[74:75]
    v_pk_add_f32 v[40:41], v[40:41], s[74:75]
    v_pk_add_f32 v[42:43], v[42:43], s[74:75]
    v_pk_fma_f32 v[112:113], v[112:113], s[76:77], v[36:37]
    v_pk_fma_f32 v[114:115], v[114:115], s[76:77], v[38:39]
    v_pk_fma_f32 v[128:129], v[128:129], s[76:77], v[40:41]
    v_pk_fma_f32 v[130:131], v[130:131], s[76:77], v[42:43]
    v_cvt_pk_bf16_f32 v106, v112, v113
    v_cvt_pk_bf16_f32 v107, v114, v115
    v_cvt_pk_bf16_f32 v122, v128, v129
    v_cvt_pk_bf16_f32 v123, v130, v131
    v_mfma_f32_16x16x32_bf16 v[60:63], v[104:107], v[152:155], v[60:63]
    s_nop 0
    s_nop 0
    v_mfma_f32_16x16x32_bf16 v[64:67], v[120:123], v[152:155], v[64:67]
    v_mfma_f32_16x16x32_bf16 v[68:71], v[104:107], v[20:23], v[68:71]
    v_mfma_f32_16x16x32_bf16 v[72:75], v[120:123], v[20:23], v[72:75]
    v_mfma_f32_16x16x32_bf16 v[44:47], v[104:107], v[136:139], v[44:47]
    v_mfma_f32_16x16x32_bf16 v[48:51], v[120:123], v[136:139], v[48:51]
    buffer_load_dwordx4 v[140:143], v7, s[12:15], s42 offen offset:0
    buffer_load_dwordx4 v[144:147], v7, s[12:15], s42 offen offset:64
    buffer_load_dwordx4 v[156:159], v7, s[12:15], s43 offen offset:0
    buffer_load_dwordx4 v[160:163], v7, s[12:15], s43 offen offset:64
    ds_write_b128 v12, v[60:63] offset:0
    ds_write_b128 v12, v[64:67] offset:1024
    s_mov_b32 exec_lo, 0x10001
    s_mov_b32 exec_hi, 0x10001
    ds_write_b128 v14, v[68:71]
    ds_write_b128 v15, v[72:75]
    s_mov_b64 exec, 1
    ds_write_b32 v3, v24 offset:32
    s_mov_b64 exec, -1
F_xw:
    ds_read_b32 v25, v18 offset:32
    ds_read_b128 v[28:31], v13 offset:1024
    ds_read_b128 v[32:35], v13
    ds_read_b32 v26, v16
    ds_read_b32 v27, v17
    s_waitcnt lgkmcnt(4)
    v_cmp_eq_u32 vcc, 0, v25
    s_cbranch_vccz F_xx
    s_waitcnt lgkmcnt(0)
    s_branch F_xw
F_xx:
    s_waitcnt lgkmcnt(3)
    v_add_f32 v44, v44, v28
    v_add_f32 v45, v45, v29
    v_add_f32 v46, v46, v30
    v_add_f32 v47, v47, v31
    buffer_atomic_add_f32 v44, v19, s[24:27], s46 offen offset:0
    buffer_atomic_add_f32 v45, v19, s[24:27], s46 offen offset:256
    buffer_atomic_add_f32 v46, v19, s[24:27], s46 offen offset:512
    buffer_atomic_add_f32 v47, v19, s[24:27], s46 offen offset:768
    s_waitcnt lgkmcnt(2)
    v_add_f32 v48, v48, v32
    v_add_f32 v49, v49, v33
    v_add_f32 v50, v50, v34
    v_add_f32 v51, v51, v35
    buffer_atomic_add_f32 v48, v19, s[24:27], s47 offen offset:0
    buffer_atomic_add_f32 v49, v19, s[24:27], s47 offen offset:256
    buffer_atomic_add_f32 v50, v19, s[24:27], s47 offen offset:512
    buffer_atomic_add_f32 v51, v19, s[24:27], s47 offen offset:768
    s_waitcnt lgkmcnt(0)
    v_add_f32 v26, v26, v27
    s_mov_b64 exec, 0xffff
    buffer_atomic_add_f32 v26, v19, s[24:27], s48 offen
    s_mov_b64 exec, 1
    ds_add_u32 v3, v24 offset:32
    s_mov_b64 exec, -1
    s_setprio 2
    v_mov_b32 v2, v7
    s_lshl_b32 s47, s3, 7
    s_add_u32 s47, s47, 157184
    v_lshlrev_b32 v5, 2, v4
    v_add_u32 v5, s47, v5
    ds_read2_b32 v[76:77], v5 offset0:0 offset1:128
    ds_read2_b32 v[78:79], v5 offset0:16 offset1:144
    v_lshrrev_b32 v4, 3, v0
    v_and_b32 v5, 7, v0
    v_lshrrev_b32 v6, 1, v4
    v_lshlrev_b32 v7, 1, v6
    v_xor_b32 v7, v5, v7
    v_lshlrev_b32 v7, 4, v7
    v_lshl_add_u32 v40, v4, 11, v7
    v_and_b32 v6, 1, v6
    v_lshlrev_b32 v6, 1, v6
    v_xor_b32 v41, v5, v6
    v_xor_b32 v42, 4, v41
    v_lshlrev_b32 v41, 4, v41
    v_lshlrev_b32 v42, 4, v42
    v_mul_u32_u24 v7, 6144, v4
    v_add_u32 v41, v41, v7
    v_add_u32 v42, v42, v7
    v_add_u32 v42, 49152, v42
    s_mul_i32 s56, s3, 98304
    s_lshl_b32 s47, s10, 7
    s_add_u32 s56, s56, s47
    s_lshl_b32 s57, s29, 7
    s_lshl_b32 s47, s3, 15
    s_add_u32 s57, s57, s47
    s_and_b32 s81, s28, 3
    s_mul_i32 s81, s81, 4
    s_lshr_b32 s47, s28, 2
    s_mul_i32 s47, s47, 1
    s_add_u32 s81, s81, s47
    s_lshl_b32 s78, s3, 11
    s_lshl_b32 s44, s10, 1
    s_add_u32 s44, s44, s37
    s_mul_i32 s45, s44, 4224
    s_mov_b32 s52, s45
    s_add_u32 s53, s45, 4096
    s_lshl_b32 s51, s44, 2
    s_and_b32 s47, s32, 3
    s_add_u32 s51, s51, s47
    s_lshl_b32 s51, s51, 7
    v_xor_b32 v18, 8, v3
    v_mov_b32 v25, 0

    s_add_u32 s54, s51, 0x82d000
    s_add_u32 s54, s72, s54
    s_addc_u32 s55, s73, 0
    s_add_u32 s82, s49, 0x82d000
    s_add_u32 s82, s72, s82
    s_addc_u32 s83, s73, 0
    s_lshl_b32 s57, s29, 7
    s_and_b32 s47, s3, 1
    s_lshl_b32 s79, s47, 12
    s_lshl_b32 s47, s47, 16
    s_add_u32 s57, s57, s47

    s_setprio 2
    s_waitcnt lgkmcnt(0)
    v_mul_f32 v76, v76, v77
    v_add_f32 v77, 1.0, v77
    v_mul_f32 v78, v78, v79
    v_add_f32 v79, 1.0, v79
    s_waitcnt vmcnt(9)
    v_lshlrev_b32 v100, 16, v140
    v_and_b32 v101, 0xffff0000, v140
    v_lshlrev_b32 v102, 16, v141
    v_and_b32 v103, 0xffff0000, v141
    v_lshlrev_b32 v104, 16, v142
    v_and_b32 v105, 0xffff0000, v142
    v_lshlrev_b32 v106, 16, v143
    v_and_b32 v107, 0xffff0000, v143
    v_fma_f32 v100, v100, v77, v76
    v_fma_f32 v101, v101, v77, v76
    v_fma_f32 v102, v102, v77, v76
    v_fma_f32 v103, v103, v77, v76
    v_fma_f32 v104, v104, v77, v76
    v_fma_f32 v105, v105, v77, v76
    v_fma_f32 v106, v106, v77, v76
    v_fma_f32 v107, v107, v77, v76
    v_lshlrev_b32 v108, 16, v144
    v_and_b32 v109, 0xffff0000, v144
    v_lshlrev_b32 v110, 16, v145
    v_and_b32 v111, 0xffff0000, v145
    v_lshlrev_b32 v112, 16, v146
    v_and_b32 v113, 0xffff0000, v146
    v_lshlrev_b32 v114, 16, v147
    v_and_b32 v115, 0xffff0000, v147
    v_fma_f32 v108, v108, v77, v76
    v_fma_f32 v109, v109, v77, v76
    v_fma_f32 v110, v110, v77, v76
    v_fma_f32 v111, v111, v77, v76
    v_fma_f32 v112, v112, v77, v76
    v_fma_f32 v113, v113, v77, v76
    v_fma_f32 v114, v114, v77, v76
    v_fma_f32 v115, v115, v77, v76
    v_lshlrev_b32 v116, 16, v156
    v_and_b32 v117, 0xffff0000, v156
    v_lshlrev_b32 v118, 16, v157
    v_and_b32 v119, 0xffff0000, v157
    v_lshlrev_b32 v120, 16, v158
    v_and_b32 v121, 0xffff0000, v158
    v_lshlrev_b32 v122, 16, v159
    v_and_b32 v123, 0xffff0000, v159
    v_fma_f32 v116, v116, v79, v78
    v_fma_f32 v117, v117, v79, v78
    v_fma_f32 v118, v118, v79, v78
    v_fma_f32 v119, v119, v79, v78
    v_fma_f32 v120, v120, v79, v78
    v_fma_f32 v121, v121, v79, v78
    v_fma_f32 v122, v122, v79, v78
    v_fma_f32 v123, v123, v79, v78
    v_lshlrev_b32 v124, 16, v160
    v_and_b32 v125, 0xffff0000, v160
    v_lshlrev_b32 v126, 16, v161
    v_and_b32 v127, 0xffff0000, v161
    v_lshlrev_b32 v128, 16, v162
    v_and_b32 v129, 0xffff0000, v162
    v_lshlrev_b32 v130, 16, v163
    v_and_b32 v131, 0xffff0000, v163
    v_fma_f32 v124, v124, v79, v78
    v_fma_f32 v125, v125, v79, v78
    v_fma_f32 v126, v126, v79, v78
    v_fma_f32 v127, v127, v79, v78
    v_fma_f32 v128, v128, v79, v78
    v_fma_f32 v129, v129, v79, v78
    v_fma_f32 v130, v130, v79, v78
    v_fma_f32 v131, v131, v79, v78
    v_permlane16_swap_b32 v100, v104
    v_permlane16_swap_b32 v101, v105
    v_permlane16_swap_b32 v102, v106
    v_permlane16_swap_b32 v103, v107
    v_permlane16_swap_b32 v108, v112
    v_permlane16_swap_b32 v109, v113
    v_permlane16_swap_b32 v110, v114
    v_permlane16_swap_b32 v111, v115
    v_permlane16_swap_b32 v116, v120
    v_permlane16_swap_b32 v117, v121
    v_permlane16_swap_b32 v118, v122
    v_permlane16_swap_b32 v119, v123
    v_permlane16_swap_b32 v124, v128
    v_permlane16_swap_b32 v125, v129
    v_permlane16_swap_b32 v126, v130
    v_permlane16_swap_b32 v127, v131
    s_setprio 2
    s_waitcnt vmcnt(0)
F_w1:
    s_mov_b32 s49, 1
    s_atomic_add s49, s[82:83], 0x0
    s_atomic_add s49, s[82:83], 0x80
    s_atomic_add s49, s[82:83], 0x100
    s_atomic_add s49, s[82:83], 0x180
    v_mov_b32 v26, 3
    s_mov_b64 exec, 1
    ds_write_b32 v3, v26 offset:32
    s_mov_b64 exec, -1
    s_cmp_ge_u32 s3, 2
    s_cbranch_scc1 F_wo
    ds_read_b32 v26, v18 offset:32
FW_18:
    s_waitcnt lgkmcnt(0)
    v_cmp_gt_u32 vcc, 2, v26
    s_cbranch_vccz FO_19
    ds_read_b32 v26, v18 offset:32
    s_branch FW_18
FO_19:
    ds_read_b32 v26, v1 offset:64
FW_20:
    s_waitcnt lgkmcnt(0)
    v_cmp_gt_u32 vcc, 2, v26
    s_cbranch_vccz FO_21
    s_sleep 1
    ds_read_b32 v26, v1 offset:64
    s_branch FW_20
FO_21:
    v_lshlrev_b32 v9, 4, v0
    s_lshl_b32 s50, s3, 7
    s_add_u32 s50, s50, 159232
    s_add_u32 m0, s78, 65536
SP_22:
    s_load_dword s58, s[54:55], 0 glc
    s_waitcnt lgkmcnt(0)
    s_cmp_ge_u32 s58, 32
    s_cbranch_scc1 SD_23
    s_sleep 1
    s_branch SP_22
SD_23:
    buffer_load_dwordx4 v9, s[24:27], s52 offen offset:0 sc1 lds
    buffer_load_dwordx4 v9, s[24:27], s52 offen offset:1024 sc1 lds
    s_add_u32 m0, m0, 2048
    s_nop 0
    buffer_load_dwordx4 v9, s[24:27], s52 offen offset:2048 sc1 lds
    buffer_load_dwordx4 v9, s[24:27], s52 offen offset:3072 sc1 lds
    s_mov_b32 m0, s50
    s_mov_b32 exec_hi, 0
    buffer_load_dword v19, s[24:27], s53 offen sc1 lds
    s_mov_b64 exec, 1
    s_lshl_b32 s50, s3, 2
    s_add_u32 m0, s50, 159168
    s_add_u32 s51, s51, 184320
    buffer_load_dword v19, s[24:27], s51 offen sc1 lds
    s_waitcnt vmcnt(0)
    s_mov_b64 exec, 1
    s_mov_b64 exec, -1
    s_branch F_wj
F_wo:
    v_cmp_gt_u32 vcc, 1, v25
    s_cbranch_vccz CW_24
    ds_read_b32 v25, v1 offset:0
FW_25:
    s_waitcnt lgkmcnt(0)
    v_cmp_gt_u32 vcc, 1, v25
    s_cbranch_vccz FO_26
    s_sleep 2
    ds_read_b32 v25, v1 offset:0
    s_branch FW_25
FO_26:
CW_24:
    s_add_u32 s47, s81, 0
    s_and_b32 s47, s47, 15
    s_lshl_b32 s47, s47, 17
    s_add_u32 m0, s79, 147456
    s_add_u32 s47, s47, s57
    buffer_load_dwordx4 v40, s[20:23], s47 offen lds
    s_add_u32 m0, m0, 1024
    s_add_u32 s47, s47, 16384
    buffer_load_dwordx4 v40, s[20:23], s47 offen lds
    s_add_u32 m0, m0, 1024
    s_add_u32 s47, s47, 16384
    buffer_load_dwordx4 v40, s[20:23], s47 offen lds
    s_add_u32 m0, m0, 1024
    s_add_u32 s47, s47, 16384
    buffer_load_dwordx4 v40, s[20:23], s47 offen lds
    v_cmp_gt_u32 vcc, 2, v25
    s_cbranch_vccz CW_27
    ds_read_b32 v25, v1 offset:0
FW_28:
    s_waitcnt lgkmcnt(0)
    v_cmp_gt_u32 vcc, 2, v25
    s_cbranch_vccz FO_29
    s_sleep 2
    ds_read_b32 v25, v1 offset:0
    s_branch FW_28
FO_29:
CW_27:
    s_add_u32 s47, s81, 1
    s_and_b32 s47, s47, 15
    s_lshl_b32 s47, s47, 17
    s_add_u32 m0, s79, 0
    s_add_u32 s47, s47, s57
    buffer_load_dwordx4 v40, s[20:23], s47 offen lds
    s_add_u32 m0, m0, 1024
    s_add_u32 s47, s47, 16384
    buffer_load_dwordx4 v40, s[20:23], s47 offen lds
    s_add_u32 m0, m0, 1024
    s_add_u32 s47, s47, 16384
    buffer_load_dwordx4 v40, s[20:23], s47 offen lds
    s_add_u32 m0, m0, 1024
    s_add_u32 s47, s47, 16384
    buffer_load_dwordx4 v40, s[20:23], s47 offen lds
    v_cmp_gt_u32 vcc, 2, v25
    s_cbranch_vccz CW_30
    ds_read_b32 v25, v1 offset:0
FW_31:
    s_waitcnt lgkmcnt(0)
    v_cmp_gt_u32 vcc, 2, v25
    s_cbranch_vccz FO_32
    s_sleep 2
    ds_read_b32 v25, v1 offset:0
    s_branch FW_31
FO_32:
CW_30:
    s_add_u32 s47, s81, 2
    s_and_b32 s47, s47, 15
    s_lshl_b32 s47, s47, 17
    s_add_u32 m0, s79, 8192
    s_add_u32 s47, s47, s57
    s_nop 0
    buffer_load_dwordx4 v40, s[20:23], s47 offen lds
    s_add_u32 m0, m0, 1024
    s_add_u32 s47, s47, 16384
    buffer_load_dwordx4 v40, s[20:23], s47 offen lds
    s_add_u32 m0, m0, 1024
    s_add_u32 s47, s47, 16384
    buffer_load_dwordx4 v40, s[20:23], s47 offen lds
    s_add_u32 m0, m0, 1024
    s_add_u32 s47, s47, 16384
    buffer_load_dwordx4 v40, s[20:23], s47 offen lds
    v_cmp_gt_u32 vcc, 2, v25
    s_cbranch_vccz CW_33
    ds_read_b32 v25, v1 offset:0
FW_34:
    s_waitcnt lgkmcnt(0)
    v_cmp_gt_u32 vcc, 2, v25
    s_cbranch_vccz FO_35
    s_sleep 2
    ds_read_b32 v25, v1 offset:0
    s_branch FW_34
FO_35:
CW_33:
    s_add_u32 s47, s81, 3
    s_and_b32 s47, s47, 15
    s_lshl_b32 s47, s47, 17
    s_add_u32 m0, s79, 139264
    s_add_u32 s47, s47, s57
    s_nop 0
    buffer_load_dwordx4 v40, s[20:23], s47 offen lds
    s_add_u32 m0, m0, 1024
    s_add_u32 s47, s47, 16384
    buffer_load_dwordx4 v40, s[20:23], s47 offen lds
    s_add_u32 m0, m0, 1024
    s_add_u32 s47, s47, 16384
    buffer_load_dwordx4 v40, s[20:23], s47 offen lds
    s_add_u32 m0, m0, 1024
    s_add_u32 s47, s47, 16384
    buffer_load_dwordx4 v40, s[20:23], s47 offen lds
    v_cmp_gt_u32 vcc, 3, v25
    s_cbranch_vccz CW_36
    ds_read_b32 v25, v1 offset:0
FW_37:
    s_waitcnt lgkmcnt(0)
    v_cmp_gt_u32 vcc, 3, v25
    s_cbranch_vccz FO_38
    s_sleep 2
    ds_read_b32 v25, v1 offset:0
    s_branch FW_37
FO_38:
CW_36:
    s_waitcnt vmcnt(12)
    s_add_u32 s47, s81, 4
    s_and_b32 s47, s47, 15
    s_lshl_b32 s47, s47, 17
    s_add_u32 m0, s79, 16384
    s_add_u32 s47, s47, s57
    buffer_load_dwordx4 v40, s[20:23], s47 offen lds
    s_add_u32 m0, m0, 1024
    s_add_u32 s47, s47, 16384
    buffer_load_dwordx4 v40, s[20:23], s47 offen lds
    s_add_u32 m0, m0, 1024
    s_add_u32 s47, s47, 16384
    buffer_load_dwordx4 v40, s[20:23], s47 offen lds
    s_add_u32 m0, m0, 1024
    s_add_u32 s47, s47, 16384
    buffer_load_dwordx4 v40, s[20:23], s47 offen lds
    v_cmp_gt_u32 vcc, 3, v25
    s_cbranch_vccz CW_39
    ds_read_b32 v25, v1 offset:0
FW_40:
    s_waitcnt lgkmcnt(0)
    v_cmp_gt_u32 vcc, 3, v25
    s_cbranch_vccz FO_41
    s_sleep 2
    ds_read_b32 v25, v1 offset:0
    s_branch FW_40
FO_41:
CW_39:
    s_waitcnt vmcnt(12)
    s_add_u32 s47, s81, 5
    s_and_b32 s47, s47, 15
    s_lshl_b32 s47, s47, 17
    s_add_u32 m0, s79, 24576
    s_add_u32 s47, s47, s57
    buffer_load_dwordx4 v40, s[20:23], s47 offen lds
    s_add_u32 m0, m0, 1024
    s_add_u32 s47, s47, 16384
    buffer_load_dwordx4 v40, s[20:23], s47 offen lds
    s_add_u32 m0, m0, 1024
    s_add_u32 s47, s47, 16384
    buffer_load_dwordx4 v40, s[20:23], s47 offen lds
    s_add_u32 m0, m0, 1024
    s_add_u32 s47, s47, 16384
    buffer_load_dwordx4 v40, s[20:23], s47 offen lds
    v_cmp_gt_u32 vcc, 3, v25
    s_cbranch_vccz CW_42
    ds_read_b32 v25, v1 offset:0
FW_43:
    s_waitcnt lgkmcnt(0)
    v_cmp_gt_u32 vcc, 3, v25
    s_cbranch_vccz FO_44
    s_sleep 2
    ds_read_b32 v25, v1 offset:0
    s_branch FW_43
FO_44:
CW_42:
    s_waitcnt vmcnt(12)
    s_add_u32 s47, s81, 6
    s_and_b32 s47, s47, 15
    s_lshl_b32 s47, s47, 17
    s_add_u32 m0, s79, 131072
    s_add_u32 s47, s47, s57
    buffer_load_dwordx4 v40, s[20:23], s47 offen lds
    s_add_u32 m0, m0, 1024
    s_add_u32 s47, s47, 16384
    buffer_load_dwordx4 v40, s[20:23], s47 offen lds
    s_add_u32 m0, m0, 1024
    s_add_u32 s47, s47, 16384
    buffer_load_dwordx4 v40, s[20:23], s47 offen lds
    s_add_u32 m0, m0, 1024
    s_add_u32 s47, s47, 16384
    buffer_load_dwordx4 v40, s[20:23], s47 offen lds
    v_cmp_gt_u32 vcc, 4, v25
    s_cbranch_vccz CW_45
    ds_read_b32 v25, v1 offset:0
FW_46:
    s_waitcnt lgkmcnt(0)
    v_cmp_gt_u32 vcc, 4, v25
    s_cbranch_vccz FO_47
    s_sleep 2
    ds_read_b32 v25, v1 offset:0
    s_branch FW_46
FO_47:
CW_45:
    s_waitcnt vmcnt(12)
    s_add_u32 s47, s81, 7
    s_and_b32 s47, s47, 15
    s_lshl_b32 s47, s47, 17
    s_add_u32 m0, s79, 32768
    s_add_u32 s47, s47, s57
    buffer_load_dwordx4 v40, s[20:23], s47 offen lds
    s_add_u32 m0, m0, 1024
    s_add_u32 s47, s47, 16384
    buffer_load_dwordx4 v40, s[20:23], s47 offen lds
    s_add_u32 m0, m0, 1024
    s_add_u32 s47, s47, 16384
    buffer_load_dwordx4 v40, s[20:23], s47 offen lds
    s_add_u32 m0, m0, 1024
    s_add_u32 s47, s47, 16384
    buffer_load_dwordx4 v40, s[20:23], s47 offen lds
    v_cmp_gt_u32 vcc, 4, v25
    s_cbranch_vccz CW_48
    ds_read_b32 v25, v1 offset:0
FW_49:
    s_waitcnt lgkmcnt(0)
    v_cmp_gt_u32 vcc, 4, v25
    s_cbranch_vccz FO_50
    s_sleep 2
    ds_read_b32 v25, v1 offset:0
    s_branch FW_49
FO_50:
CW_48:
    s_waitcnt vmcnt(12)
    s_add_u32 s47, s81, 8
    s_and_b32 s47, s47, 15
    s_lshl_b32 s47, s47, 17
    s_add_u32 m0, s79, 40960
    s_add_u32 s47, s47, s57
    buffer_load_dwordx4 v40, s[20:23], s47 offen lds
    s_add_u32 m0, m0, 1024
    s_add_u32 s47, s47, 16384
    buffer_load_dwordx4 v40, s[20:23], s47 offen lds
    s_add_u32 m0, m0, 1024
    s_add_u32 s47, s47, 16384
    buffer_load_dwordx4 v40, s[20:23], s47 offen lds
    s_add_u32 m0, m0, 1024
    s_add_u32 s47, s47, 16384
    buffer_load_dwordx4 v40, s[20:23], s47 offen lds
    v_cmp_gt_u32 vcc, 4, v25
    s_cbranch_vccz CW_51
    ds_read_b32 v25, v1 offset:0
FW_52:
    s_waitcnt lgkmcnt(0)
    v_cmp_gt_u32 vcc, 4, v25
    s_cbranch_vccz FO_53
    s_sleep 2
    ds_read_b32 v25, v1 offset:0
    s_branch FW_52
FO_53:
CW_51:
    s_waitcnt vmcnt(12)
    s_add_u32 s47, s81, 9
    s_and_b32 s47, s47, 15
    s_lshl_b32 s47, s47, 17
    s_add_u32 m0, s79, 81920
    s_add_u32 s47, s47, s57
    buffer_load_dwordx4 v40, s[20:23], s47 offen lds
    s_add_u32 m0, m0, 1024
    s_add_u32 s47, s47, 16384
    buffer_load_dwordx4 v40, s[20:23], s47 offen lds
    s_add_u32 m0, m0, 1024
    s_add_u32 s47, s47, 16384
    buffer_load_dwordx4 v40, s[20:23], s47 offen lds
    s_add_u32 m0, m0, 1024
    s_add_u32 s47, s47, 16384
    buffer_load_dwordx4 v40, s[20:23], s47 offen lds
    v_cmp_gt_u32 vcc, 5, v25
    s_cbranch_vccz CW_54
    ds_read_b32 v25, v1 offset:0
FW_55:
    s_waitcnt lgkmcnt(0)
    v_cmp_gt_u32 vcc, 5, v25
    s_cbranch_vccz FO_56
    s_sleep 2
    ds_read_b32 v25, v1 offset:0
    s_branch FW_55
FO_56:
CW_54:
    s_waitcnt vmcnt(12)
    s_add_u32 s47, s81, 10
    s_and_b32 s47, s47, 15
    s_lshl_b32 s47, s47, 17
    s_add_u32 m0, s79, 73728
    s_add_u32 s47, s47, s57
    buffer_load_dwordx4 v40, s[20:23], s47 offen lds
    s_add_u32 m0, m0, 1024
    s_add_u32 s47, s47, 16384
    buffer_load_dwordx4 v40, s[20:23], s47 offen lds
    s_add_u32 m0, m0, 1024
    s_add_u32 s47, s47, 16384
    buffer_load_dwordx4 v40, s[20:23], s47 offen lds
    s_add_u32 m0, m0, 1024
    s_add_u32 s47, s47, 16384
    buffer_load_dwordx4 v40, s[20:23], s47 offen lds
    v_cmp_gt_u32 vcc, 6, v25
    s_cbranch_vccz CW_57
    ds_read_b32 v25, v1 offset:0
FW_58:
    s_waitcnt lgkmcnt(0)
    v_cmp_gt_u32 vcc, 6, v25
    s_cbranch_vccz FO_59
    s_sleep 2
    ds_read_b32 v25, v1 offset:0
    s_branch FW_58
FO_59:
CW_57:
    s_waitcnt vmcnt(12)
    s_add_u32 s47, s81, 11
    s_and_b32 s47, s47, 15
    s_lshl_b32 s47, s47, 17
    s_add_u32 m0, s79, 98304
    s_add_u32 s47, s47, s57
    buffer_load_dwordx4 v40, s[20:23], s47 offen lds
    s_add_u32 m0, m0, 1024
    s_add_u32 s47, s47, 16384
    buffer_load_dwordx4 v40, s[20:23], s47 offen lds
    s_add_u32 m0, m0, 1024
    s_add_u32 s47, s47, 16384
    buffer_load_dwordx4 v40, s[20:23], s47 offen lds
    s_add_u32 m0, m0, 1024
    s_add_u32 s47, s47, 16384
    buffer_load_dwordx4 v40, s[20:23], s47 offen lds
    v_cmp_gt_u32 vcc, 7, v25
    s_cbranch_vccz CW_60
    ds_read_b32 v25, v1 offset:0
FW_61:
    s_waitcnt lgkmcnt(0)
    v_cmp_gt_u32 vcc, 7, v25
    s_cbranch_vccz FO_62
    s_sleep 2
    ds_read_b32 v25, v1 offset:0
    s_branch FW_61
FO_62:
CW_60:
    s_waitcnt vmcnt(12)
    s_add_u32 s47, s81, 12
    s_and_b32 s47, s47, 15
    s_lshl_b32 s47, s47, 17
    s_add_u32 m0, s79, 90112
    s_add_u32 s47, s47, s57
    buffer_load_dwordx4 v40, s[20:23], s47 offen lds
    s_add_u32 m0, m0, 1024
    s_add_u32 s47, s47, 16384
    buffer_load_dwordx4 v40, s[20:23], s47 offen lds
    s_add_u32 m0, m0, 1024
    s_add_u32 s47, s47, 16384
    buffer_load_dwordx4 v40, s[20:23], s47 offen lds
    s_add_u32 m0, m0, 1024
    s_add_u32 s47, s47, 16384
    buffer_load_dwordx4 v40, s[20:23], s47 offen lds
    v_cmp_gt_u32 vcc, 8, v25
    s_cbranch_vccz CW_63
    ds_read_b32 v25, v1 offset:0
FW_64:
    s_waitcnt lgkmcnt(0)
    v_cmp_gt_u32 vcc, 8, v25
    s_cbranch_vccz FO_65
    s_sleep 2
    ds_read_b32 v25, v1 offset:0
    s_branch FW_64
FO_65:
CW_63:
    s_waitcnt vmcnt(12)
    s_add_u32 s47, s81, 13
    s_and_b32 s47, s47, 15
    s_lshl_b32 s47, s47, 17
    s_add_u32 m0, s79, 114688
    s_add_u32 s47, s47, s57
    buffer_load_dwordx4 v40, s[20:23], s47 offen lds
    s_add_u32 m0, m0, 1024
    s_add_u32 s47, s47, 16384
    buffer_load_dwordx4 v40, s[20:23], s47 offen lds
    s_add_u32 m0, m0, 1024
    s_add_u32 s47, s47, 16384
    buffer_load_dwordx4 v40, s[20:23], s47 offen lds
    s_add_u32 m0, m0, 1024
    s_add_u32 s47, s47, 16384
    buffer_load_dwordx4 v40, s[20:23], s47 offen lds
    v_cmp_gt_u32 vcc, 9, v25
    s_cbranch_vccz CW_66
    ds_read_b32 v25, v1 offset:0
FW_67:
    s_waitcnt lgkmcnt(0)
    v_cmp_gt_u32 vcc, 9, v25
    s_cbranch_vccz FO_68
    s_sleep 2
    ds_read_b32 v25, v1 offset:0
    s_branch FW_67
FO_68:
CW_66:
    s_waitcnt vmcnt(12)
    s_add_u32 s47, s81, 14
    s_and_b32 s47, s47, 15
    s_lshl_b32 s47, s47, 17
    s_add_u32 m0, s79, 106496
    s_branch IW_s6
IW_w6:
    s_branch IW_r6
IW_s6:
    s_add_u32 s47, s47, s57
    buffer_load_dwordx4 v40, s[20:23], s47 offen lds
    s_add_u32 m0, m0, 1024
    s_add_u32 s47, s47, 16384
    buffer_load_dwordx4 v40, s[20:23], s47 offen lds
    s_add_u32 m0, m0, 1024
    s_add_u32 s47, s47, 16384
    buffer_load_dwordx4 v40, s[20:23], s47 offen lds
    s_add_u32 m0, m0, 1024
    s_add_u32 s47, s47, 16384
    buffer_load_dwordx4 v40, s[20:23], s47 offen lds
    v_cmp_gt_u32 vcc, 10, v25
    s_cbranch_vccz CW_69
    ds_read_b32 v25, v1 offset:0
FW_70:
    s_waitcnt lgkmcnt(0)
    v_cmp_gt_u32 vcc, 10, v25
    s_cbranch_vccz FO_71
    s_sleep 2
    ds_read_b32 v25, v1 offset:0
    s_branch FW_70
FO_71:
CW_69:
    s_waitcnt vmcnt(12)
    s_add_u32 s47, s81, 15
    s_and_b32 s47, s47, 15
    s_lshl_b32 s47, s47, 17
    s_add_u32 m0, s79, 122880
    s_add_u32 s47, s47, s57
    buffer_load_dwordx4 v40, s[20:23], s47 offen lds
    s_add_u32 m0, m0, 1024
    s_add_u32 s47, s47, 16384
    buffer_load_dwordx4 v40, s[20:23], s47 offen lds
    s_add_u32 m0, m0, 1024
    s_add_u32 s47, s47, 16384
    buffer_load_dwordx4 v40, s[20:23], s47 offen lds
    s_add_u32 m0, m0, 1024
    s_add_u32 s47, s47, 16384
    buffer_load_dwordx4 v40, s[20:23], s47 offen lds
F_wj:
    v_mov_b32 v5, 159096
    ds_read_b32 v6, v5 offset:0
FW_72:
    s_waitcnt lgkmcnt(0)
    v_cmp_gt_u32 vcc, 1, v6
    s_cbranch_vccz FO_73
    s_sleep 1
    ds_read_b32 v6, v5 offset:0
    s_branch FW_72
FO_73:
    v_and_b32 v5, 7, v0
    v_lshlrev_b32 v5, 2, v5
    v_add_u32 v5, 158976, v5
    ds_read_b32 v5, v5
    s_lshr_b32 s47, s64, 5
    s_sub_u32 s47, 63, s47
    s_mov_b64 s[60:61], 0
    s_waitcnt lgkmcnt(0)
    v_bfe_u32 v5, v5, 5, 6
    v_cmp_eq_u32 vcc, s47, v5
    s_cbranch_vccz F_ns

    v_mov_b32 v5, 158976
    ds_read_b128 v[44:47], v5
    ds_read_b128 v[48:51], v5 offset:16
    v_and_b32 v6, 15, v0
    v_add_u32 v6, s64, v6
    v_sub_u32 v6, 2047, v6
    v_subrev_u32 v7, 16, v6
    v_mov_b32 v164, 0
    v_mov_b32 v165, 0
    s_waitcnt lgkmcnt(0)
    v_and_b32 v5, 0x7ff, v44
    v_or_b32 v44, 0x4000, v44
    v_cmp_eq_u32 vcc, v5, v6
    v_cmp_eq_u32 s[62:63], v5, v7
    s_nop 0
    v_cndmask_b32 v164, v164, v44, vcc
    v_cndmask_b32 v165, v165, v44, s[62:63]
    v_and_b32 v5, 0x7ff, v45
    v_or_b32 v45, 0x4800, v45
    v_cmp_eq_u32 vcc, v5, v6
    v_cmp_eq_u32 s[62:63], v5, v7
    s_nop 0
    v_cndmask_b32 v164, v164, v45, vcc
    v_cndmask_b32 v165, v165, v45, s[62:63]
    v_and_b32 v5, 0x7ff, v46
    v_or_b32 v46, 0x5000, v46
    v_cmp_eq_u32 vcc, v5, v6
    v_cmp_eq_u32 s[62:63], v5, v7
    s_nop 0
    v_cndmask_b32 v164, v164, v46, vcc
    v_cndmask_b32 v165, v165, v46, s[62:63]
    v_and_b32 v5, 0x7ff, v47
    v_or_b32 v47, 0x5800, v47
    v_cmp_eq_u32 vcc, v5, v6
    v_cmp_eq_u32 s[62:63], v5, v7
    s_nop 0
    v_cndmask_b32 v164, v164, v47, vcc
    v_cndmask_b32 v165, v165, v47, s[62:63]
    v_and_b32 v5, 0x7ff, v48
    v_or_b32 v48, 0x6000, v48
    v_cmp_eq_u32 vcc, v5, v6
    v_cmp_eq_u32 s[62:63], v5, v7
    s_nop 0
    v_cndmask_b32 v164, v164, v48, vcc
    v_cndmask_b32 v165, v165, v48, s[62:63]
    v_and_b32 v5, 0x7ff, v49
    v_or_b32 v49, 0x6800, v49
    v_cmp_eq_u32 vcc, v5, v6
    v_cmp_eq_u32 s[62:63], v5, v7
    s_nop 0
    v_cndmask_b32 v164, v164, v49, vcc
    v_cndmask_b32 v165, v165, v49, s[62:63]
    v_and_b32 v5, 0x7ff, v50
    v_or_b32 v50, 0x7000, v50
    v_cmp_eq_u32 vcc, v5, v6
    v_cmp_eq_u32 s[62:63], v5, v7
    s_nop 0
    v_cndmask_b32 v164, v164, v50, vcc
    v_cndmask_b32 v165, v165, v50, s[62:63]
    v_and_b32 v5, 0x7ff, v51
    v_or_b32 v51, 0x7800, v51
    v_cmp_eq_u32 vcc, v5, v6
    v_cmp_eq_u32 s[62:63], v5, v7
    s_nop 0
    v_cndmask_b32 v164, v164, v51, vcc
    v_cndmask_b32 v165, v165, v51, s[62:63]
    s_mov_b64 s[60:61], 1
F_ns:
    s_lshl_b32 s51, s28, 2
    s_add_u32 s51, s51, s3
    s_lshl_b32 s51, s51, 2
    s_and_b32 s47, s29, 3
    s_add_u32 s51, s51, s47
    s_lshl_b32 s51, s51, 7

    s_add_u32 s54, s51, 0x831000
    s_add_u32 s54, s72, s54
    s_addc_u32 s55, s73, 0
    v_lshlrev_b32 v98, 4, v0
    v_lshrrev_b32 v16, 4, v0
    v_bfe_u32 v17, v0, 2, 2
    v_lshl_add_u32 v17, v16, 2, v17
    v_bfe_u32 v16, v17, 1, 2
    v_lshlrev_b32 v16, 5, v16
    v_lshl_add_u32 v16, v17, 7, v16
    v_and_b32 v17, 3, v0
    v_lshl_add_u32 v4, v17, 3, v16
    v_xor_b32 v5, 32, v4
    v_xor_b32 v6, 64, v4
    v_xor_b32 v7, 96, v4
    s_lshl_b32 s79, s28, 18
    s_lshl_b32 s80, s3, 16
    s_add_u32 s79, s79, s80
    s_lshl_b32 s81, s81, 11
    v_mov_b32_e64 v99, 1

    v_add_u32 v8, 57344, v4
    v_add_u32 v9, 57344, v5
    v_add_u32 v10, 57344, v6
    v_add_u32 v11, 57344, v7
    v_add_u32 v12, 114688, v4
    v_add_u32 v13, 114688, v5
    v_add_u32 v14, 114688, v6
    v_add_u32 v15, 114688, v7
    s_add_u32 s16, s72, 0x400000
    s_addc_u32 s17, s73, 0
    s_mov_b32 s18, 0x400000
    s_mov_b32 s19, 0x00020000
    s_mov_b32 s12, s68
    s_mov_b32 s13, s69
    s_mov_b32 s14, 0x400000
    s_mov_b32 s15, 0x00020000
    s_add_u32 s80, s81, 0
    s_and_b32 s80, s80, 0x7fff
    s_add_u32 s4, s80, s79
    s_add_u32 s80, s81, 2048
    s_and_b32 s80, s80, 0x7fff
    s_add_u32 s5, s80, s79
    s_add_u32 s80, s81, 4096
    s_and_b32 s80, s80, 0x7fff
    s_add_u32 s6, s80, s79
    s_add_u32 s80, s81, 6144
    s_and_b32 s80, s80, 0x7fff
    s_add_u32 s7, s80, s79
    s_add_u32 s80, s81, 8192
    s_and_b32 s80, s80, 0x7fff
    s_add_u32 s8, s80, s79
    s_add_u32 s80, s81, 10240
    s_and_b32 s80, s80, 0x7fff
    s_add_u32 s9, s80, s79
    s_add_u32 s80, s81, 12288
    s_and_b32 s80, s80, 0x7fff
    s_add_u32 s10, s80, s79
    s_add_u32 s80, s81, 14336
    s_and_b32 s80, s80, 0x7fff
    s_add_u32 s11, s80, s79
    s_add_u32 s80, s81, 16384
    s_and_b32 s80, s80, 0x7fff
    s_add_u32 s30, s80, s79
    s_add_u32 s80, s81, 18432
    s_and_b32 s80, s80, 0x7fff
    s_add_u32 s31, s80, s79
    s_add_u32 s80, s81, 20480
    s_and_b32 s80, s80, 0x7fff
    s_add_u32 s32, s80, s79
    s_add_u32 s80, s81, 22528
    s_and_b32 s80, s80, 0x7fff
    s_add_u32 s33, s80, s79
    s_add_u32 s80, s81, 24576
    s_and_b32 s80, s80, 0x7fff
    s_add_u32 s34, s80, s79
    s_add_u32 s80, s81, 26624
    s_and_b32 s80, s80, 0x7fff
    s_add_u32 s35, s80, s79
    s_add_u32 s80, s81, 28672
    s_and_b32 s80, s80, 0x7fff
    s_add_u32 s36, s80, s79
    s_add_u32 s80, s81, 30720
    s_and_b32 s80, s80, 0x7fff
    s_add_u32 s37, s80, s79
    v_add_u32 v97, 0x8000, v98
    s_setprio 2
    s_mov_b32 s50, 0
F_op:
    s_load_dword s47, s[54:55], 0 glc
    s_getreg_b32 s51, hwreg(HW_REG_IB_STS)
    s_and_b32 s51, s51, 0xc0000f
    s_or_b32 s51, s51, s50
    s_cbranch_scc1 F_oq
    s_mov_b64 exec, 1
    ds_write_b32 v3, v99 offset:160
    s_mov_b64 exec, -1
    s_mov_b32 s50, 1
F_oq:
    s_waitcnt lgkmcnt(0)
    s_cmp_lt_u32 s47, 16
    s_cbranch_scc1 F_op
    s_nop 0
    buffer_load_dwordx4 v[48:51], v98, s[16:19], s4 offen offset:0 sc1
    buffer_load_dwordx4 v[52:55], v97, s[16:19], s4 offen offset:0 sc1
    buffer_load_dwordx4 v[56:59], v98, s[16:19], s4 offen offset:1024 sc1
    buffer_load_dwordx4 v[60:63], v97, s[16:19], s4 offen offset:1024 sc1
    buffer_load_dwordx4 v[64:67], v98, s[16:19], s5 offen offset:0 sc1
    buffer_load_dwordx4 v[68:71], v97, s[16:19], s5 offen offset:0 sc1
    buffer_load_dwordx4 v[72:75], v98, s[16:19], s5 offen offset:1024 sc1
    buffer_load_dwordx4 v[76:79], v97, s[16:19], s5 offen offset:1024 sc1
    buffer_load_dwordx4 v[80:83], v98, s[16:19], s6 offen offset:0 sc1
    buffer_load_dwordx4 v[84:87], v97, s[16:19], s6 offen offset:0 sc1
    buffer_load_dwordx4 v[88:91], v98, s[16:19], s6 offen offset:1024 sc1
    buffer_load_dwordx4 v[92:95], v97, s[16:19], s6 offen offset:1024 sc1
    s_cmp_lg_u32 s50, 0
    s_cbranch_scc1 F_or
    s_waitcnt vmcnt(12)
    s_mov_b64 exec, 1
    ds_write_b32 v3, v99 offset:160
    s_mov_b64 exec, -1
F_or:
    v_or_b32 v17, 8, v1
    ds_read_b32 v16, v17 offset:160
FW_74:
    s_waitcnt lgkmcnt(0)
    v_cmp_gt_u32 vcc, 1, v16
    s_cbranch_vccz FO_75
    ds_read_b32 v16, v17 offset:160
    s_branch FW_74
FO_75:
    ds_read_b64_tr_b16 v[16:17], v12 offset:32768
    ds_read_b64_tr_b16 v[18:19], v12 offset:34816
    ds_read_b64_tr_b16 v[20:21], v13 offset:32768
    ds_read_b64_tr_b16 v[22:23], v13 offset:34816
    ds_read_b64_tr_b16 v[24:25], v14 offset:32768
    ds_read_b64_tr_b16 v[26:27], v14 offset:34816
    ds_read_b64_tr_b16 v[28:29], v15 offset:32768
    ds_read_b64_tr_b16 v[30:31], v15 offset:34816
    s_waitcnt vmcnt(10) lgkmcnt(0)
    s_nop 0
    v_mfma_f32_16x16x32_bf16 v[100:103], v[16:19], v[48:51], v[100:103]
    ds_read_b64_tr_b16 v[32:33], v12 offset:36864
    ds_read_b64_tr_b16 v[34:35], v12 offset:38912
    v_mfma_f32_16x16x32_bf16 v[116:119], v[16:19], v[52:55], v[116:119]
    ds_read_b64_tr_b16 v[36:37], v13 offset:36864
    ds_read_b64_tr_b16 v[38:39], v13 offset:38912
    v_mfma_f32_16x16x32_bf16 v[104:107], v[20:23], v[48:51], v[104:107]
    ds_read_b64_tr_b16 v[40:41], v14 offset:36864
    ds_read_b64_tr_b16 v[42:43], v14 offset:38912
    v_mfma_f32_16x16x32_bf16 v[120:123], v[20:23], v[52:55], v[120:123]
    ds_read_b64_tr_b16 v[44:45], v15 offset:36864
    ds_read_b64_tr_b16 v[46:47], v15 offset:38912
    v_mfma_f32_16x16x32_bf16 v[108:111], v[24:27], v[48:51], v[108:111]
    buffer_load_dwordx4 v[132:135], v98, s[16:19], s7 offen offset:0 sc1
    v_mfma_f32_16x16x32_bf16 v[124:127], v[24:27], v[52:55], v[124:127]
    v_mfma_f32_16x16x32_bf16 v[112:115], v[28:31], v[48:51], v[112:115]
    buffer_load_dwordx4 v[136:139], v97, s[16:19], s7 offen offset:0 sc1
    v_mfma_f32_16x16x32_bf16 v[128:131], v[28:31], v[52:55], v[128:131]
    s_waitcnt vmcnt(10) lgkmcnt(0)
    s_nop 0
    v_mfma_f32_16x16x32_bf16 v[100:103], v[32:35], v[56:59], v[100:103]
    ds_read_b64_tr_b16 v[16:17], v4 offset:0
    ds_read_b64_tr_b16 v[18:19], v4 offset:2048
    v_mfma_f32_16x16x32_bf16 v[116:119], v[32:35], v[60:63], v[116:119]
    ds_read_b64_tr_b16 v[20:21], v5 offset:0
    ds_read_b64_tr_b16 v[22:23], v5 offset:2048
    v_mfma_f32_16x16x32_bf16 v[104:107], v[36:39], v[56:59], v[104:107]
    ds_read_b64_tr_b16 v[24:25], v6 offset:0
    ds_read_b64_tr_b16 v[26:27], v6 offset:2048
    v_mfma_f32_16x16x32_bf16 v[120:123], v[36:39], v[60:63], v[120:123]
    ds_read_b64_tr_b16 v[28:29], v7 offset:0
    ds_read_b64_tr_b16 v[30:31], v7 offset:2048
    v_mfma_f32_16x16x32_bf16 v[108:111], v[40:43], v[56:59], v[108:111]
    buffer_load_dwordx4 v[48:51], v98, s[16:19], s7 offen offset:1024 sc1
    v_mfma_f32_16x16x32_bf16 v[124:127], v[40:43], v[60:63], v[124:127]
    v_mfma_f32_16x16x32_bf16 v[112:115], v[44:47], v[56:59], v[112:115]
    buffer_load_dwordx4 v[52:55], v97, s[16:19], s7 offen offset:1024 sc1
    v_mfma_f32_16x16x32_bf16 v[128:131], v[44:47], v[60:63], v[128:131]
    s_waitcnt vmcnt(10) lgkmcnt(0)
    s_nop 0
    v_mfma_f32_16x16x32_bf16 v[100:103], v[16:19], v[64:67], v[100:103]
    ds_read_b64_tr_b16 v[32:33], v4 offset:4096
    ds_read_b64_tr_b16 v[34:35], v4 offset:6144
    v_mfma_f32_16x16x32_bf16 v[116:119], v[16:19], v[68:71], v[116:119]
    ds_read_b64_tr_b16 v[36:37], v5 offset:4096
    ds_read_b64_tr_b16 v[38:39], v5 offset:6144
    v_mfma_f32_16x16x32_bf16 v[104:107], v[20:23], v[64:67], v[104:107]
    ds_read_b64_tr_b16 v[40:41], v6 offset:4096
    ds_read_b64_tr_b16 v[42:43], v6 offset:6144
    v_mfma_f32_16x16x32_bf16 v[120:123], v[20:23], v[68:71], v[120:123]
    ds_read_b64_tr_b16 v[44:45], v7 offset:4096
    ds_read_b64_tr_b16 v[46:47], v7 offset:6144
    v_mfma_f32_16x16x32_bf16 v[108:111], v[24:27], v[64:67], v[108:111]
    buffer_load_dwordx4 v[56:59], v98, s[16:19], s8 offen offset:0 sc1
    v_mfma_f32_16x16x32_bf16 v[124:127], v[24:27], v[68:71], v[124:127]
    v_mfma_f32_16x16x32_bf16 v[112:115], v[28:31], v[64:67], v[112:115]
    buffer_load_dwordx4 v[60:63], v97, s[16:19], s8 offen offset:0 sc1
    v_mfma_f32_16x16x32_bf16 v[128:131], v[28:31], v[68:71], v[128:131]
    s_waitcnt vmcnt(10) lgkmcnt(0)
    s_nop 0
    v_mfma_f32_16x16x32_bf16 v[100:103], v[32:35], v[72:75], v[100:103]
    ds_read_b64_tr_b16 v[16:17], v4 offset:8192
    ds_read_b64_tr_b16 v[18:19], v4 offset:10240
    v_mfma_f32_16x16x32_bf16 v[116:119], v[32:35], v[76:79], v[116:119]
    ds_read_b64_tr_b16 v[20:21], v5 offset:8192
    ds_read_b64_tr_b16 v[22:23], v5 offset:10240
    v_mfma_f32_16x16x32_bf16 v[104:107], v[36:39], v[72:75], v[104:107]
    ds_read_b64_tr_b16 v[24:25], v6 offset:8192
    ds_read_b64_tr_b16 v[26:27], v6 offset:10240
    v_mfma_f32_16x16x32_bf16 v[120:123], v[36:39], v[76:79], v[120:123]
    ds_read_b64_tr_b16 v[28:29], v7 offset:8192
    ds_read_b64_tr_b16 v[30:31], v7 offset:10240
    v_mfma_f32_16x16x32_bf16 v[108:111], v[40:43], v[72:75], v[108:111]
    buffer_load_dwordx4 v[64:67], v98, s[16:19], s8 offen offset:1024 sc1
    v_mfma_f32_16x16x32_bf16 v[124:127], v[40:43], v[76:79], v[124:127]
    v_mfma_f32_16x16x32_bf16 v[112:115], v[44:47], v[72:75], v[112:115]
    buffer_load_dwordx4 v[68:71], v97, s[16:19], s8 offen offset:1024 sc1
    v_mfma_f32_16x16x32_bf16 v[128:131], v[44:47], v[76:79], v[128:131]
    s_waitcnt vmcnt(10) lgkmcnt(0)
    s_nop 0
    v_mfma_f32_16x16x32_bf16 v[100:103], v[16:19], v[80:83], v[100:103]
    ds_read_b64_tr_b16 v[32:33], v4 offset:12288
    ds_read_b64_tr_b16 v[34:35], v4 offset:14336
    v_mfma_f32_16x16x32_bf16 v[116:119], v[16:19], v[84:87], v[116:119]
    ds_read_b64_tr_b16 v[36:37], v5 offset:12288
    ds_read_b64_tr_b16 v[38:39], v5 offset:14336
    v_mfma_f32_16x16x32_bf16 v[104:107], v[20:23], v[80:83], v[104:107]
    ds_read_b64_tr_b16 v[40:41], v6 offset:12288
    ds_read_b64_tr_b16 v[42:43], v6 offset:14336
    v_mfma_f32_16x16x32_bf16 v[120:123], v[20:23], v[84:87], v[120:123]
    ds_read_b64_tr_b16 v[44:45], v7 offset:12288
    ds_read_b64_tr_b16 v[46:47], v7 offset:14336
    v_mfma_f32_16x16x32_bf16 v[108:111], v[24:27], v[80:83], v[108:111]
    buffer_load_dwordx4 v[72:75], v98, s[16:19], s9 offen offset:0 sc1
    v_mfma_f32_16x16x32_bf16 v[124:127], v[24:27], v[84:87], v[124:127]
    v_mfma_f32_16x16x32_bf16 v[112:115], v[28:31], v[80:83], v[112:115]
    buffer_load_dwordx4 v[76:79], v97, s[16:19], s9 offen offset:0 sc1
    v_mfma_f32_16x16x32_bf16 v[128:131], v[28:31], v[84:87], v[128:131]
    s_waitcnt vmcnt(10) lgkmcnt(0)
    s_nop 0
    v_mfma_f32_16x16x32_bf16 v[100:103], v[32:35], v[88:91], v[100:103]
    ds_read_b64_tr_b16 v[16:17], v12 offset:24576
    ds_read_b64_tr_b16 v[18:19], v12 offset:26624
    v_mfma_f32_16x16x32_bf16 v[116:119], v[32:35], v[92:95], v[116:119]
    ds_read_b64_tr_b16 v[20:21], v13 offset:24576
    ds_read_b64_tr_b16 v[22:23], v13 offset:26624
    v_mfma_f32_16x16x32_bf16 v[104:107], v[36:39], v[88:91], v[104:107]
    ds_read_b64_tr_b16 v[24:25], v14 offset:24576
    ds_read_b64_tr_b16 v[26:27], v14 offset:26624
    v_mfma_f32_16x16x32_bf16 v[120:123], v[36:39], v[92:95], v[120:123]
    ds_read_b64_tr_b16 v[28:29], v15 offset:24576
    ds_read_b64_tr_b16 v[30:31], v15 offset:26624
    v_mfma_f32_16x16x32_bf16 v[108:111], v[40:43], v[88:91], v[108:111]
    buffer_load_dwordx4 v[80:83], v98, s[16:19], s9 offen offset:1024 sc1
    v_mfma_f32_16x16x32_bf16 v[124:127], v[40:43], v[92:95], v[124:127]
    v_mfma_f32_16x16x32_bf16 v[112:115], v[44:47], v[88:91], v[112:115]
    buffer_load_dwordx4 v[84:87], v97, s[16:19], s9 offen offset:1024 sc1
    v_mfma_f32_16x16x32_bf16 v[128:131], v[44:47], v[92:95], v[128:131]
    s_waitcnt vmcnt(10) lgkmcnt(0)
    s_nop 0
    v_mfma_f32_16x16x32_bf16 v[100:103], v[16:19], v[132:135], v[100:103]
    ds_read_b64_tr_b16 v[32:33], v12 offset:28672
    ds_read_b64_tr_b16 v[34:35], v12 offset:30720
    v_mfma_f32_16x16x32_bf16 v[116:119], v[16:19], v[136:139], v[116:119]
    ds_read_b64_tr_b16 v[36:37], v13 offset:28672
    ds_read_b64_tr_b16 v[38:39], v13 offset:30720
    v_mfma_f32_16x16x32_bf16 v[104:107], v[20:23], v[132:135], v[104:107]
    ds_read_b64_tr_b16 v[40:41], v14 offset:28672
    ds_read_b64_tr_b16 v[42:43], v14 offset:30720
    v_mfma_f32_16x16x32_bf16 v[120:123], v[20:23], v[136:139], v[120:123]
    ds_read_b64_tr_b16 v[44:45], v15 offset:28672
    ds_read_b64_tr_b16 v[46:47], v15 offset:30720
    v_mfma_f32_16x16x32_bf16 v[108:111], v[24:27], v[132:135], v[108:111]
    buffer_load_dwordx4 v[88:91], v98, s[16:19], s10 offen offset:0 sc1
    v_mfma_f32_16x16x32_bf16 v[124:127], v[24:27], v[136:139], v[124:127]
    v_mfma_f32_16x16x32_bf16 v[112:115], v[28:31], v[132:135], v[112:115]
    buffer_load_dwordx4 v[92:95], v97, s[16:19], s10 offen offset:0 sc1
    v_mfma_f32_16x16x32_bf16 v[128:131], v[28:31], v[136:139], v[128:131]
    s_waitcnt vmcnt(10) lgkmcnt(0)
    s_nop 0
    v_mfma_f32_16x16x32_bf16 v[100:103], v[32:35], v[48:51], v[100:103]
    ds_read_b64_tr_b16 v[16:17], v4 offset:16384
    ds_read_b64_tr_b16 v[18:19], v4 offset:18432
    v_mfma_f32_16x16x32_bf16 v[116:119], v[32:35], v[52:55], v[116:119]
    ds_read_b64_tr_b16 v[20:21], v5 offset:16384
    ds_read_b64_tr_b16 v[22:23], v5 offset:18432
    v_mfma_f32_16x16x32_bf16 v[104:107], v[36:39], v[48:51], v[104:107]
    ds_read_b64_tr_b16 v[24:25], v6 offset:16384
    ds_read_b64_tr_b16 v[26:27], v6 offset:18432
    v_mfma_f32_16x16x32_bf16 v[120:123], v[36:39], v[52:55], v[120:123]
    ds_read_b64_tr_b16 v[28:29], v7 offset:16384
    ds_read_b64_tr_b16 v[30:31], v7 offset:18432
    v_mfma_f32_16x16x32_bf16 v[108:111], v[40:43], v[48:51], v[108:111]
    buffer_load_dwordx4 v[132:135], v98, s[16:19], s10 offen offset:1024 sc1
    v_mfma_f32_16x16x32_bf16 v[124:127], v[40:43], v[52:55], v[124:127]
    v_mfma_f32_16x16x32_bf16 v[112:115], v[44:47], v[48:51], v[112:115]
    buffer_load_dwordx4 v[136:139], v97, s[16:19], s10 offen offset:1024 sc1
    v_mfma_f32_16x16x32_bf16 v[128:131], v[44:47], v[52:55], v[128:131]
    s_waitcnt vmcnt(10) lgkmcnt(0)
    s_nop 0
    v_mfma_f32_16x16x32_bf16 v[100:103], v[16:19], v[56:59], v[100:103]
    ds_read_b64_tr_b16 v[32:33], v4 offset:20480
    ds_read_b64_tr_b16 v[34:35], v4 offset:22528
    v_mfma_f32_16x16x32_bf16 v[116:119], v[16:19], v[60:63], v[116:119]
    ds_read_b64_tr_b16 v[36:37], v5 offset:20480
    ds_read_b64_tr_b16 v[38:39], v5 offset:22528
    v_mfma_f32_16x16x32_bf16 v[104:107], v[20:23], v[56:59], v[104:107]
    ds_read_b64_tr_b16 v[40:41], v6 offset:20480
    ds_read_b64_tr_b16 v[42:43], v6 offset:22528
    v_mfma_f32_16x16x32_bf16 v[120:123], v[20:23], v[60:63], v[120:123]
    ds_read_b64_tr_b16 v[44:45], v7 offset:20480
    ds_read_b64_tr_b16 v[46:47], v7 offset:22528
    v_mfma_f32_16x16x32_bf16 v[108:111], v[24:27], v[56:59], v[108:111]
    buffer_load_dwordx4 v[48:51], v98, s[16:19], s11 offen offset:0 sc1
    v_mfma_f32_16x16x32_bf16 v[124:127], v[24:27], v[60:63], v[124:127]
    v_mfma_f32_16x16x32_bf16 v[112:115], v[28:31], v[56:59], v[112:115]
    buffer_load_dwordx4 v[52:55], v97, s[16:19], s11 offen offset:0 sc1
    v_mfma_f32_16x16x32_bf16 v[128:131], v[28:31], v[60:63], v[128:131]
    s_waitcnt vmcnt(10) lgkmcnt(0)
    s_nop 0
    v_mfma_f32_16x16x32_bf16 v[100:103], v[32:35], v[64:67], v[100:103]
    ds_read_b64_tr_b16 v[16:17], v4 offset:24576
    ds_read_b64_tr_b16 v[18:19], v4 offset:26624
    v_mfma_f32_16x16x32_bf16 v[116:119], v[32:35], v[68:71], v[116:119]
    ds_read_b64_tr_b16 v[20:21], v5 offset:24576
    ds_read_b64_tr_b16 v[22:23], v5 offset:26624
    v_mfma_f32_16x16x32_bf16 v[104:107], v[36:39], v[64:67], v[104:107]
    ds_read_b64_tr_b16 v[24:25], v6 offset:24576
    ds_read_b64_tr_b16 v[26:27], v6 offset:26624
    v_mfma_f32_16x16x32_bf16 v[120:123], v[36:39], v[68:71], v[120:123]
    ds_read_b64_tr_b16 v[28:29], v7 offset:24576
    ds_read_b64_tr_b16 v[30:31], v7 offset:26624
    v_mfma_f32_16x16x32_bf16 v[108:111], v[40:43], v[64:67], v[108:111]
    buffer_load_dwordx4 v[56:59], v98, s[16:19], s11 offen offset:1024 sc1
    v_mfma_f32_16x16x32_bf16 v[124:127], v[40:43], v[68:71], v[124:127]
    v_mfma_f32_16x16x32_bf16 v[112:115], v[44:47], v[64:67], v[112:115]
    buffer_load_dwordx4 v[60:63], v97, s[16:19], s11 offen offset:1024 sc1
    v_mfma_f32_16x16x32_bf16 v[128:131], v[44:47], v[68:71], v[128:131]
    s_waitcnt vmcnt(10) lgkmcnt(0)
    s_nop 0
    v_mfma_f32_16x16x32_bf16 v[100:103], v[16:19], v[72:75], v[100:103]
    ds_read_b64_tr_b16 v[32:33], v4 offset:28672
    ds_read_b64_tr_b16 v[34:35], v4 offset:30720
    v_mfma_f32_16x16x32_bf16 v[116:119], v[16:19], v[76:79], v[116:119]
    ds_read_b64_tr_b16 v[36:37], v5 offset:28672
    ds_read_b64_tr_b16 v[38:39], v5 offset:30720
    v_mfma_f32_16x16x32_bf16 v[104:107], v[20:23], v[72:75], v[104:107]
    ds_read_b64_tr_b16 v[40:41], v6 offset:28672
    ds_read_b64_tr_b16 v[42:43], v6 offset:30720
    v_mfma_f32_16x16x32_bf16 v[120:123], v[20:23], v[76:79], v[120:123]
    ds_read_b64_tr_b16 v[44:45], v7 offset:28672
    ds_read_b64_tr_b16 v[46:47], v7 offset:30720
    v_mfma_f32_16x16x32_bf16 v[108:111], v[24:27], v[72:75], v[108:111]
    buffer_load_dwordx4 v[64:67], v98, s[16:19], s30 offen offset:0 sc1
    v_mfma_f32_16x16x32_bf16 v[124:127], v[24:27], v[76:79], v[124:127]
    v_mfma_f32_16x16x32_bf16 v[112:115], v[28:31], v[72:75], v[112:115]
    buffer_load_dwordx4 v[68:71], v97, s[16:19], s30 offen offset:0 sc1
    v_mfma_f32_16x16x32_bf16 v[128:131], v[28:31], v[76:79], v[128:131]
    s_waitcnt vmcnt(10) lgkmcnt(0)
    s_nop 0
    v_mfma_f32_16x16x32_bf16 v[100:103], v[32:35], v[80:83], v[100:103]
    ds_read_b64_tr_b16 v[16:17], v12 offset:16384
    ds_read_b64_tr_b16 v[18:19], v12 offset:18432
    v_mfma_f32_16x16x32_bf16 v[116:119], v[32:35], v[84:87], v[116:119]
    ds_read_b64_tr_b16 v[20:21], v13 offset:16384
    ds_read_b64_tr_b16 v[22:23], v13 offset:18432
    v_mfma_f32_16x16x32_bf16 v[104:107], v[36:39], v[80:83], v[104:107]
    ds_read_b64_tr_b16 v[24:25], v14 offset:16384
    ds_read_b64_tr_b16 v[26:27], v14 offset:18432
    v_mfma_f32_16x16x32_bf16 v[120:123], v[36:39], v[84:87], v[120:123]
    ds_read_b64_tr_b16 v[28:29], v15 offset:16384
    ds_read_b64_tr_b16 v[30:31], v15 offset:18432
    v_mfma_f32_16x16x32_bf16 v[108:111], v[40:43], v[80:83], v[108:111]
    buffer_load_dwordx4 v[72:75], v98, s[16:19], s30 offen offset:1024 sc1
    v_mfma_f32_16x16x32_bf16 v[124:127], v[40:43], v[84:87], v[124:127]
    v_mfma_f32_16x16x32_bf16 v[112:115], v[44:47], v[80:83], v[112:115]
    buffer_load_dwordx4 v[76:79], v97, s[16:19], s30 offen offset:1024 sc1
    v_mfma_f32_16x16x32_bf16 v[128:131], v[44:47], v[84:87], v[128:131]
    s_waitcnt vmcnt(10) lgkmcnt(0)
    s_nop 0
    v_mfma_f32_16x16x32_bf16 v[100:103], v[16:19], v[88:91], v[100:103]
    ds_read_b64_tr_b16 v[32:33], v12 offset:20480
    ds_read_b64_tr_b16 v[34:35], v12 offset:22528
    v_mfma_f32_16x16x32_bf16 v[116:119], v[16:19], v[92:95], v[116:119]
    ds_read_b64_tr_b16 v[36:37], v13 offset:20480
    ds_read_b64_tr_b16 v[38:39], v13 offset:22528
    v_mfma_f32_16x16x32_bf16 v[104:107], v[20:23], v[88:91], v[104:107]
    ds_read_b64_tr_b16 v[40:41], v14 offset:20480
    ds_read_b64_tr_b16 v[42:43], v14 offset:22528
    v_mfma_f32_16x16x32_bf16 v[120:123], v[20:23], v[92:95], v[120:123]
    ds_read_b64_tr_b16 v[44:45], v15 offset:20480
    ds_read_b64_tr_b16 v[46:47], v15 offset:22528
    v_mfma_f32_16x16x32_bf16 v[108:111], v[24:27], v[88:91], v[108:111]
    buffer_load_dwordx4 v[80:83], v98, s[16:19], s31 offen offset:0 sc1
    v_mfma_f32_16x16x32_bf16 v[124:127], v[24:27], v[92:95], v[124:127]
    v_mfma_f32_16x16x32_bf16 v[112:115], v[28:31], v[88:91], v[112:115]
    buffer_load_dwordx4 v[84:87], v97, s[16:19], s31 offen offset:0 sc1
    v_mfma_f32_16x16x32_bf16 v[128:131], v[28:31], v[92:95], v[128:131]
    s_waitcnt vmcnt(10) lgkmcnt(0)
    s_nop 0
    v_mfma_f32_16x16x32_bf16 v[100:103], v[32:35], v[132:135], v[100:103]
    ds_read_b64_tr_b16 v[16:17], v4 offset:32768
    ds_read_b64_tr_b16 v[18:19], v4 offset:34816
    v_mfma_f32_16x16x32_bf16 v[116:119], v[32:35], v[136:139], v[116:119]
    ds_read_b64_tr_b16 v[20:21], v5 offset:32768
    ds_read_b64_tr_b16 v[22:23], v5 offset:34816
    v_mfma_f32_16x16x32_bf16 v[104:107], v[36:39], v[132:135], v[104:107]
    ds_read_b64_tr_b16 v[24:25], v6 offset:32768
    ds_read_b64_tr_b16 v[26:27], v6 offset:34816
    v_mfma_f32_16x16x32_bf16 v[120:123], v[36:39], v[136:139], v[120:123]
    ds_read_b64_tr_b16 v[28:29], v7 offset:32768
    ds_read_b64_tr_b16 v[30:31], v7 offset:34816
    v_mfma_f32_16x16x32_bf16 v[108:111], v[40:43], v[132:135], v[108:111]
    buffer_load_dwordx4 v[88:91], v98, s[16:19], s31 offen offset:1024 sc1
    v_mfma_f32_16x16x32_bf16 v[124:127], v[40:43], v[136:139], v[124:127]
    v_mfma_f32_16x16x32_bf16 v[112:115], v[44:47], v[132:135], v[112:115]
    buffer_load_dwordx4 v[92:95], v97, s[16:19], s31 offen offset:1024 sc1
    v_mfma_f32_16x16x32_bf16 v[128:131], v[44:47], v[136:139], v[128:131]
    s_waitcnt vmcnt(10) lgkmcnt(0)
    s_nop 0
    v_mfma_f32_16x16x32_bf16 v[100:103], v[16:19], v[48:51], v[100:103]
    ds_read_b64_tr_b16 v[32:33], v4 offset:36864
    ds_read_b64_tr_b16 v[34:35], v4 offset:38912
    v_mfma_f32_16x16x32_bf16 v[116:119], v[16:19], v[52:55], v[116:119]
    ds_read_b64_tr_b16 v[36:37], v5 offset:36864
    ds_read_b64_tr_b16 v[38:39], v5 offset:38912
    v_mfma_f32_16x16x32_bf16 v[104:107], v[20:23], v[48:51], v[104:107]
    ds_read_b64_tr_b16 v[40:41], v6 offset:36864
    ds_read_b64_tr_b16 v[42:43], v6 offset:38912
    v_mfma_f32_16x16x32_bf16 v[120:123], v[20:23], v[52:55], v[120:123]
    ds_read_b64_tr_b16 v[44:45], v7 offset:36864
    ds_read_b64_tr_b16 v[46:47], v7 offset:38912
    v_mfma_f32_16x16x32_bf16 v[108:111], v[24:27], v[48:51], v[108:111]
    buffer_load_dwordx4 v[132:135], v98, s[16:19], s32 offen offset:0 sc1
    v_mfma_f32_16x16x32_bf16 v[124:127], v[24:27], v[52:55], v[124:127]
    v_mfma_f32_16x16x32_bf16 v[112:115], v[28:31], v[48:51], v[112:115]
    buffer_load_dwordx4 v[136:139], v97, s[16:19], s32 offen offset:0 sc1
    v_mfma_f32_16x16x32_bf16 v[128:131], v[28:31], v[52:55], v[128:131]
    s_waitcnt vmcnt(10) lgkmcnt(0)
    s_nop 0
    v_mfma_f32_16x16x32_bf16 v[100:103], v[32:35], v[56:59], v[100:103]
    ds_read_b64_tr_b16 v[16:17], v4 offset:40960
    ds_read_b64_tr_b16 v[18:19], v4 offset:43008
    v_mfma_f32_16x16x32_bf16 v[116:119], v[32:35], v[60:63], v[116:119]
    ds_read_b64_tr_b16 v[20:21], v5 offset:40960
    ds_read_b64_tr_b16 v[22:23], v5 offset:43008
    v_mfma_f32_16x16x32_bf16 v[104:107], v[36:39], v[56:59], v[104:107]
    ds_read_b64_tr_b16 v[24:25], v6 offset:40960
    ds_read_b64_tr_b16 v[26:27], v6 offset:43008
    v_mfma_f32_16x16x32_bf16 v[120:123], v[36:39], v[60:63], v[120:123]
    ds_read_b64_tr_b16 v[28:29], v7 offset:40960
    ds_read_b64_tr_b16 v[30:31], v7 offset:43008
    v_mfma_f32_16x16x32_bf16 v[108:111], v[40:43], v[56:59], v[108:111]
    buffer_load_dwordx4 v[48:51], v98, s[16:19], s32 offen offset:1024 sc1
    v_mfma_f32_16x16x32_bf16 v[124:127], v[40:43], v[60:63], v[124:127]
    v_mfma_f32_16x16x32_bf16 v[112:115], v[44:47], v[56:59], v[112:115]
    buffer_load_dwordx4 v[52:55], v97, s[16:19], s32 offen offset:1024 sc1
    v_mfma_f32_16x16x32_bf16 v[128:131], v[44:47], v[60:63], v[128:131]
    s_waitcnt vmcnt(10) lgkmcnt(0)
    s_nop 0
    v_mfma_f32_16x16x32_bf16 v[100:103], v[16:19], v[64:67], v[100:103]
    ds_read_b64_tr_b16 v[32:33], v4 offset:45056
    ds_read_b64_tr_b16 v[34:35], v4 offset:47104
    v_mfma_f32_16x16x32_bf16 v[116:119], v[16:19], v[68:71], v[116:119]
    s_branch IW_s7
IW_w7:
    s_branch IW_r7
IW_s7:
    ds_read_b64_tr_b16 v[36:37], v5 offset:45056
    ds_read_b64_tr_b16 v[38:39], v5 offset:47104
    v_mfma_f32_16x16x32_bf16 v[104:107], v[20:23], v[64:67], v[104:107]
    ds_read_b64_tr_b16 v[40:41], v6 offset:45056
    ds_read_b64_tr_b16 v[42:43], v6 offset:47104
    v_mfma_f32_16x16x32_bf16 v[120:123], v[20:23], v[68:71], v[120:123]
    ds_read_b64_tr_b16 v[44:45], v7 offset:45056
    ds_read_b64_tr_b16 v[46:47], v7 offset:47104
    v_mfma_f32_16x16x32_bf16 v[108:111], v[24:27], v[64:67], v[108:111]
    buffer_load_dwordx4 v[56:59], v98, s[16:19], s33 offen offset:0 sc1
    v_mfma_f32_16x16x32_bf16 v[124:127], v[24:27], v[68:71], v[124:127]
    v_mfma_f32_16x16x32_bf16 v[112:115], v[28:31], v[64:67], v[112:115]
    buffer_load_dwordx4 v[60:63], v97, s[16:19], s33 offen offset:0 sc1
    v_mfma_f32_16x16x32_bf16 v[128:131], v[28:31], v[68:71], v[128:131]
    s_waitcnt vmcnt(10) lgkmcnt(0)
    s_nop 0
    v_mfma_f32_16x16x32_bf16 v[100:103], v[32:35], v[72:75], v[100:103]
    ds_read_b64_tr_b16 v[16:17], v8 offset:24576
    ds_read_b64_tr_b16 v[18:19], v8 offset:26624
    v_mfma_f32_16x16x32_bf16 v[116:119], v[32:35], v[76:79], v[116:119]
    ds_read_b64_tr_b16 v[20:21], v9 offset:24576
    ds_read_b64_tr_b16 v[22:23], v9 offset:26624
    v_mfma_f32_16x16x32_bf16 v[104:107], v[36:39], v[72:75], v[104:107]
    ds_read_b64_tr_b16 v[24:25], v10 offset:24576
    ds_read_b64_tr_b16 v[26:27], v10 offset:26624
    v_mfma_f32_16x16x32_bf16 v[120:123], v[36:39], v[76:79], v[120:123]
    ds_read_b64_tr_b16 v[28:29], v11 offset:24576
    ds_read_b64_tr_b16 v[30:31], v11 offset:26624
    v_mfma_f32_16x16x32_bf16 v[108:111], v[40:43], v[72:75], v[108:111]
    buffer_load_dwordx4 v[64:67], v98, s[16:19], s33 offen offset:1024 sc1
    v_mfma_f32_16x16x32_bf16 v[124:127], v[40:43], v[76:79], v[124:127]
    v_mfma_f32_16x16x32_bf16 v[112:115], v[44:47], v[72:75], v[112:115]
    buffer_load_dwordx4 v[68:71], v97, s[16:19], s33 offen offset:1024 sc1
    v_mfma_f32_16x16x32_bf16 v[128:131], v[44:47], v[76:79], v[128:131]
    s_waitcnt vmcnt(10) lgkmcnt(0)
    s_nop 0
    v_mfma_f32_16x16x32_bf16 v[100:103], v[16:19], v[80:83], v[100:103]
    ds_read_b64_tr_b16 v[32:33], v8 offset:28672
    ds_read_b64_tr_b16 v[34:35], v8 offset:30720
    v_mfma_f32_16x16x32_bf16 v[116:119], v[16:19], v[84:87], v[116:119]
    ds_read_b64_tr_b16 v[36:37], v9 offset:28672
    ds_read_b64_tr_b16 v[38:39], v9 offset:30720
    v_mfma_f32_16x16x32_bf16 v[104:107], v[20:23], v[80:83], v[104:107]
    ds_read_b64_tr_b16 v[40:41], v10 offset:28672
    ds_read_b64_tr_b16 v[42:43], v10 offset:30720
    v_mfma_f32_16x16x32_bf16 v[120:123], v[20:23], v[84:87], v[120:123]
    ds_read_b64_tr_b16 v[44:45], v11 offset:28672
    ds_read_b64_tr_b16 v[46:47], v11 offset:30720
    v_mfma_f32_16x16x32_bf16 v[108:111], v[24:27], v[80:83], v[108:111]
    buffer_load_dwordx4 v[72:75], v98, s[16:19], s34 offen offset:0 sc1
    v_mfma_f32_16x16x32_bf16 v[124:127], v[24:27], v[84:87], v[124:127]
    v_mfma_f32_16x16x32_bf16 v[112:115], v[28:31], v[80:83], v[112:115]
    buffer_load_dwordx4 v[76:79], v97, s[16:19], s34 offen offset:0 sc1
    v_mfma_f32_16x16x32_bf16 v[128:131], v[28:31], v[84:87], v[128:131]
    s_waitcnt vmcnt(10) lgkmcnt(0)
    s_nop 0
    v_mfma_f32_16x16x32_bf16 v[100:103], v[32:35], v[88:91], v[100:103]
    ds_read_b64_tr_b16 v[16:17], v8 offset:16384
    ds_read_b64_tr_b16 v[18:19], v8 offset:18432
    v_mfma_f32_16x16x32_bf16 v[116:119], v[32:35], v[92:95], v[116:119]
    ds_read_b64_tr_b16 v[20:21], v9 offset:16384
    ds_read_b64_tr_b16 v[22:23], v9 offset:18432
    v_mfma_f32_16x16x32_bf16 v[104:107], v[36:39], v[88:91], v[104:107]
    ds_read_b64_tr_b16 v[24:25], v10 offset:16384
    ds_read_b64_tr_b16 v[26:27], v10 offset:18432
    v_mfma_f32_16x16x32_bf16 v[120:123], v[36:39], v[92:95], v[120:123]
    ds_read_b64_tr_b16 v[28:29], v11 offset:16384
    ds_read_b64_tr_b16 v[30:31], v11 offset:18432
    v_mfma_f32_16x16x32_bf16 v[108:111], v[40:43], v[88:91], v[108:111]
    buffer_load_dwordx4 v[80:83], v98, s[16:19], s34 offen offset:1024 sc1
    v_mfma_f32_16x16x32_bf16 v[124:127], v[40:43], v[92:95], v[124:127]
    v_mfma_f32_16x16x32_bf16 v[112:115], v[44:47], v[88:91], v[112:115]
    buffer_load_dwordx4 v[84:87], v97, s[16:19], s34 offen offset:1024 sc1
    v_mfma_f32_16x16x32_bf16 v[128:131], v[44:47], v[92:95], v[128:131]
    s_waitcnt vmcnt(10) lgkmcnt(0)
    s_nop 0
    v_mfma_f32_16x16x32_bf16 v[100:103], v[16:19], v[132:135], v[100:103]
    ds_read_b64_tr_b16 v[32:33], v8 offset:20480
    ds_read_b64_tr_b16 v[34:35], v8 offset:22528
    v_mfma_f32_16x16x32_bf16 v[116:119], v[16:19], v[136:139], v[116:119]
    ds_read_b64_tr_b16 v[36:37], v9 offset:20480
    ds_read_b64_tr_b16 v[38:39], v9 offset:22528
    v_mfma_f32_16x16x32_bf16 v[104:107], v[20:23], v[132:135], v[104:107]
    ds_read_b64_tr_b16 v[40:41], v10 offset:20480
    ds_read_b64_tr_b16 v[42:43], v10 offset:22528
    v_mfma_f32_16x16x32_bf16 v[120:123], v[20:23], v[136:139], v[120:123]
    ds_read_b64_tr_b16 v[44:45], v11 offset:20480
    ds_read_b64_tr_b16 v[46:47], v11 offset:22528
    v_mfma_f32_16x16x32_bf16 v[108:111], v[24:27], v[132:135], v[108:111]
    buffer_load_dwordx4 v[88:91], v98, s[16:19], s35 offen offset:0 sc1
    v_mfma_f32_16x16x32_bf16 v[124:127], v[24:27], v[136:139], v[124:127]
    v_mfma_f32_16x16x32_bf16 v[112:115], v[28:31], v[132:135], v[112:115]
    buffer_load_dwordx4 v[92:95], v97, s[16:19], s35 offen offset:0 sc1
    v_mfma_f32_16x16x32_bf16 v[128:131], v[28:31], v[136:139], v[128:131]
    s_waitcnt vmcnt(10) lgkmcnt(0)
    s_nop 0
    v_mfma_f32_16x16x32_bf16 v[100:103], v[32:35], v[48:51], v[100:103]
    ds_read_b64_tr_b16 v[16:17], v8 offset:40960
    ds_read_b64_tr_b16 v[18:19], v8 offset:43008
    v_mfma_f32_16x16x32_bf16 v[116:119], v[32:35], v[52:55], v[116:119]
    ds_read_b64_tr_b16 v[20:21], v9 offset:40960
    ds_read_b64_tr_b16 v[22:23], v9 offset:43008
    v_mfma_f32_16x16x32_bf16 v[104:107], v[36:39], v[48:51], v[104:107]
    ds_read_b64_tr_b16 v[24:25], v10 offset:40960
    ds_read_b64_tr_b16 v[26:27], v10 offset:43008
    v_mfma_f32_16x16x32_bf16 v[120:123], v[36:39], v[52:55], v[120:123]
    ds_read_b64_tr_b16 v[28:29], v11 offset:40960
    ds_read_b64_tr_b16 v[30:31], v11 offset:43008
    v_mfma_f32_16x16x32_bf16 v[108:111], v[40:43], v[48:51], v[108:111]
    buffer_load_dwordx4 v[132:135], v98, s[16:19], s35 offen offset:1024 sc1
    v_mfma_f32_16x16x32_bf16 v[124:127], v[40:43], v[52:55], v[124:127]
    v_mfma_f32_16x16x32_bf16 v[112:115], v[44:47], v[48:51], v[112:115]
    buffer_load_dwordx4 v[136:139], v97, s[16:19], s35 offen offset:1024 sc1
    v_mfma_f32_16x16x32_bf16 v[128:131], v[44:47], v[52:55], v[128:131]
    s_waitcnt vmcnt(10) lgkmcnt(0)
    s_nop 0
    v_mfma_f32_16x16x32_bf16 v[100:103], v[16:19], v[56:59], v[100:103]
    ds_read_b64_tr_b16 v[32:33], v8 offset:45056
    ds_read_b64_tr_b16 v[34:35], v8 offset:47104
    v_mfma_f32_16x16x32_bf16 v[116:119], v[16:19], v[60:63], v[116:119]
    ds_read_b64_tr_b16 v[36:37], v9 offset:45056
    ds_read_b64_tr_b16 v[38:39], v9 offset:47104
    v_mfma_f32_16x16x32_bf16 v[104:107], v[20:23], v[56:59], v[104:107]
    ds_read_b64_tr_b16 v[40:41], v10 offset:45056
    ds_read_b64_tr_b16 v[42:43], v10 offset:47104
    v_mfma_f32_16x16x32_bf16 v[120:123], v[20:23], v[60:63], v[120:123]
    ds_read_b64_tr_b16 v[44:45], v11 offset:45056
    ds_read_b64_tr_b16 v[46:47], v11 offset:47104
    v_mfma_f32_16x16x32_bf16 v[108:111], v[24:27], v[56:59], v[108:111]
    buffer_load_dwordx4 v[48:51], v98, s[16:19], s36 offen offset:0 sc1
    v_mfma_f32_16x16x32_bf16 v[124:127], v[24:27], v[60:63], v[124:127]
    v_mfma_f32_16x16x32_bf16 v[112:115], v[28:31], v[56:59], v[112:115]
    buffer_load_dwordx4 v[52:55], v97, s[16:19], s36 offen offset:0 sc1
    v_mfma_f32_16x16x32_bf16 v[128:131], v[28:31], v[60:63], v[128:131]
    s_waitcnt vmcnt(10) lgkmcnt(0)
    s_nop 0
    v_mfma_f32_16x16x32_bf16 v[100:103], v[32:35], v[64:67], v[100:103]
    ds_read_b64_tr_b16 v[16:17], v8 offset:32768
    ds_read_b64_tr_b16 v[18:19], v8 offset:34816
    v_mfma_f32_16x16x32_bf16 v[116:119], v[32:35], v[68:71], v[116:119]
    ds_read_b64_tr_b16 v[20:21], v9 offset:32768
    ds_read_b64_tr_b16 v[22:23], v9 offset:34816
    v_mfma_f32_16x16x32_bf16 v[104:107], v[36:39], v[64:67], v[104:107]
    ds_read_b64_tr_b16 v[24:25], v10 offset:32768
    ds_read_b64_tr_b16 v[26:27], v10 offset:34816
    v_mfma_f32_16x16x32_bf16 v[120:123], v[36:39], v[68:71], v[120:123]
    ds_read_b64_tr_b16 v[28:29], v11 offset:32768
    ds_read_b64_tr_b16 v[30:31], v11 offset:34816
    v_mfma_f32_16x16x32_bf16 v[108:111], v[40:43], v[64:67], v[108:111]
    buffer_load_dwordx4 v[56:59], v98, s[16:19], s36 offen offset:1024 sc1
    v_mfma_f32_16x16x32_bf16 v[124:127], v[40:43], v[68:71], v[124:127]
    v_mfma_f32_16x16x32_bf16 v[112:115], v[44:47], v[64:67], v[112:115]
    buffer_load_dwordx4 v[60:63], v97, s[16:19], s36 offen offset:1024 sc1
    v_mfma_f32_16x16x32_bf16 v[128:131], v[44:47], v[68:71], v[128:131]
    s_waitcnt vmcnt(10) lgkmcnt(0)
    s_nop 0
    v_mfma_f32_16x16x32_bf16 v[100:103], v[16:19], v[72:75], v[100:103]
    ds_read_b64_tr_b16 v[32:33], v8 offset:36864
    ds_read_b64_tr_b16 v[34:35], v8 offset:38912
    v_mfma_f32_16x16x32_bf16 v[116:119], v[16:19], v[76:79], v[116:119]
    ds_read_b64_tr_b16 v[36:37], v9 offset:36864
    ds_read_b64_tr_b16 v[38:39], v9 offset:38912
    v_mfma_f32_16x16x32_bf16 v[104:107], v[20:23], v[72:75], v[104:107]
    ds_read_b64_tr_b16 v[40:41], v10 offset:36864
    ds_read_b64_tr_b16 v[42:43], v10 offset:38912
    v_mfma_f32_16x16x32_bf16 v[120:123], v[20:23], v[76:79], v[120:123]
    ds_read_b64_tr_b16 v[44:45], v11 offset:36864
    ds_read_b64_tr_b16 v[46:47], v11 offset:38912
    v_mfma_f32_16x16x32_bf16 v[108:111], v[24:27], v[72:75], v[108:111]
    buffer_load_dwordx4 v[64:67], v98, s[16:19], s37 offen offset:0 sc1
    v_mfma_f32_16x16x32_bf16 v[124:127], v[24:27], v[76:79], v[124:127]
    v_mfma_f32_16x16x32_bf16 v[112:115], v[28:31], v[72:75], v[112:115]
    buffer_load_dwordx4 v[68:71], v97, s[16:19], s37 offen offset:0 sc1
    v_mfma_f32_16x16x32_bf16 v[128:131], v[28:31], v[76:79], v[128:131]
    s_waitcnt vmcnt(10) lgkmcnt(0)
    s_nop 0
    v_mfma_f32_16x16x32_bf16 v[100:103], v[32:35], v[80:83], v[100:103]
    ds_read_b64_tr_b16 v[16:17], v12 offset:0
    ds_read_b64_tr_b16 v[18:19], v12 offset:2048
    v_mfma_f32_16x16x32_bf16 v[116:119], v[32:35], v[84:87], v[116:119]
    ds_read_b64_tr_b16 v[20:21], v13 offset:0
    ds_read_b64_tr_b16 v[22:23], v13 offset:2048
    v_mfma_f32_16x16x32_bf16 v[104:107], v[36:39], v[80:83], v[104:107]
    ds_read_b64_tr_b16 v[24:25], v14 offset:0
    ds_read_b64_tr_b16 v[26:27], v14 offset:2048
    v_mfma_f32_16x16x32_bf16 v[120:123], v[36:39], v[84:87], v[120:123]
    ds_read_b64_tr_b16 v[28:29], v15 offset:0
    ds_read_b64_tr_b16 v[30:31], v15 offset:2048
    v_mfma_f32_16x16x32_bf16 v[108:111], v[40:43], v[80:83], v[108:111]
    buffer_load_dwordx4 v[72:75], v98, s[16:19], s37 offen offset:1024 sc1
    v_mfma_f32_16x16x32_bf16 v[124:127], v[40:43], v[84:87], v[124:127]
    v_mfma_f32_16x16x32_bf16 v[112:115], v[44:47], v[80:83], v[112:115]
    buffer_load_dwordx4 v[76:79], v97, s[16:19], s37 offen offset:1024 sc1
    v_mfma_f32_16x16x32_bf16 v[128:131], v[44:47], v[84:87], v[128:131]
    s_waitcnt vmcnt(10) lgkmcnt(0)
    s_nop 0
    v_mfma_f32_16x16x32_bf16 v[100:103], v[16:19], v[88:91], v[100:103]
    ds_read_b64_tr_b16 v[32:33], v12 offset:4096
    ds_read_b64_tr_b16 v[34:35], v12 offset:6144
    v_mfma_f32_16x16x32_bf16 v[116:119], v[16:19], v[92:95], v[116:119]
    ds_read_b64_tr_b16 v[36:37], v13 offset:4096
    ds_read_b64_tr_b16 v[38:39], v13 offset:6144
    v_mfma_f32_16x16x32_bf16 v[104:107], v[20:23], v[88:91], v[104:107]
    ds_read_b64_tr_b16 v[40:41], v14 offset:4096
    ds_read_b64_tr_b16 v[42:43], v14 offset:6144
    v_mfma_f32_16x16x32_bf16 v[120:123], v[20:23], v[92:95], v[120:123]
    ds_read_b64_tr_b16 v[44:45], v15 offset:4096
    ds_read_b64_tr_b16 v[46:47], v15 offset:6144
    v_mfma_f32_16x16x32_bf16 v[108:111], v[24:27], v[88:91], v[108:111]
    v_mfma_f32_16x16x32_bf16 v[124:127], v[24:27], v[92:95], v[124:127]
    v_mfma_f32_16x16x32_bf16 v[112:115], v[28:31], v[88:91], v[112:115]
    v_mfma_f32_16x16x32_bf16 v[128:131], v[28:31], v[92:95], v[128:131]
    s_waitcnt vmcnt(8) lgkmcnt(0)
    s_nop 0
    v_mfma_f32_16x16x32_bf16 v[100:103], v[32:35], v[132:135], v[100:103]
    ds_read_b64_tr_b16 v[16:17], v8 offset:49152
    ds_read_b64_tr_b16 v[18:19], v8 offset:51200
    v_mfma_f32_16x16x32_bf16 v[116:119], v[32:35], v[136:139], v[116:119]
    ds_read_b64_tr_b16 v[20:21], v9 offset:49152
    ds_read_b64_tr_b16 v[22:23], v9 offset:51200
    v_mfma_f32_16x16x32_bf16 v[104:107], v[36:39], v[132:135], v[104:107]
    ds_read_b64_tr_b16 v[24:25], v10 offset:49152
    ds_read_b64_tr_b16 v[26:27], v10 offset:51200
    v_mfma_f32_16x16x32_bf16 v[120:123], v[36:39], v[136:139], v[120:123]
    ds_read_b64_tr_b16 v[28:29], v11 offset:49152
    ds_read_b64_tr_b16 v[30:31], v11 offset:51200
    v_mfma_f32_16x16x32_bf16 v[108:111], v[40:43], v[132:135], v[108:111]
    v_mfma_f32_16x16x32_bf16 v[124:127], v[40:43], v[136:139], v[124:127]
    v_mfma_f32_16x16x32_bf16 v[112:115], v[44:47], v[132:135], v[112:115]
    v_mfma_f32_16x16x32_bf16 v[128:131], v[44:47], v[136:139], v[128:131]
    s_waitcnt vmcnt(6) lgkmcnt(0)
    s_nop 0
    v_mfma_f32_16x16x32_bf16 v[100:103], v[16:19], v[48:51], v[100:103]
    ds_read_b64_tr_b16 v[32:33], v8 offset:53248
    ds_read_b64_tr_b16 v[34:35], v8 offset:55296
    v_mfma_f32_16x16x32_bf16 v[116:119], v[16:19], v[52:55], v[116:119]
    ds_read_b64_tr_b16 v[36:37], v9 offset:53248
    ds_read_b64_tr_b16 v[38:39], v9 offset:55296
    v_mfma_f32_16x16x32_bf16 v[104:107], v[20:23], v[48:51], v[104:107]
    ds_read_b64_tr_b16 v[40:41], v10 offset:53248
    ds_read_b64_tr_b16 v[42:43], v10 offset:55296
    v_mfma_f32_16x16x32_bf16 v[120:123], v[20:23], v[52:55], v[120:123]
    ds_read_b64_tr_b16 v[44:45], v11 offset:53248
    ds_read_b64_tr_b16 v[46:47], v11 offset:55296
    v_mfma_f32_16x16x32_bf16 v[108:111], v[24:27], v[48:51], v[108:111]
    v_mfma_f32_16x16x32_bf16 v[124:127], v[24:27], v[52:55], v[124:127]
    v_mfma_f32_16x16x32_bf16 v[112:115], v[28:31], v[48:51], v[112:115]
    v_mfma_f32_16x16x32_bf16 v[128:131], v[28:31], v[52:55], v[128:131]
    s_waitcnt vmcnt(4) lgkmcnt(0)
    s_nop 0
    v_mfma_f32_16x16x32_bf16 v[100:103], v[32:35], v[56:59], v[100:103]
    ds_read_b64_tr_b16 v[16:17], v12 offset:8192
    ds_read_b64_tr_b16 v[18:19], v12 offset:10240
    v_mfma_f32_16x16x32_bf16 v[116:119], v[32:35], v[60:63], v[116:119]
    ds_read_b64_tr_b16 v[20:21], v13 offset:8192
    ds_read_b64_tr_b16 v[22:23], v13 offset:10240
    v_mfma_f32_16x16x32_bf16 v[104:107], v[36:39], v[56:59], v[104:107]
    ds_read_b64_tr_b16 v[24:25], v14 offset:8192
    ds_read_b64_tr_b16 v[26:27], v14 offset:10240
    v_mfma_f32_16x16x32_bf16 v[120:123], v[36:39], v[60:63], v[120:123]
    ds_read_b64_tr_b16 v[28:29], v15 offset:8192
    ds_read_b64_tr_b16 v[30:31], v15 offset:10240
    v_mfma_f32_16x16x32_bf16 v[108:111], v[40:43], v[56:59], v[108:111]
    v_mfma_f32_16x16x32_bf16 v[124:127], v[40:43], v[60:63], v[124:127]
    v_mfma_f32_16x16x32_bf16 v[112:115], v[44:47], v[56:59], v[112:115]
    v_mfma_f32_16x16x32_bf16 v[128:131], v[44:47], v[60:63], v[128:131]
    s_waitcnt vmcnt(2) lgkmcnt(0)
    s_nop 0
    v_mfma_f32_16x16x32_bf16 v[100:103], v[16:19], v[64:67], v[100:103]
    ds_read_b64_tr_b16 v[32:33], v12 offset:12288
    ds_read_b64_tr_b16 v[34:35], v12 offset:14336
    v_mfma_f32_16x16x32_bf16 v[116:119], v[16:19], v[68:71], v[116:119]
    ds_read_b64_tr_b16 v[36:37], v13 offset:12288
    ds_read_b64_tr_b16 v[38:39], v13 offset:14336
    v_mfma_f32_16x16x32_bf16 v[104:107], v[20:23], v[64:67], v[104:107]
    ds_read_b64_tr_b16 v[40:41], v14 offset:12288
    ds_read_b64_tr_b16 v[42:43], v14 offset:14336
    v_mfma_f32_16x16x32_bf16 v[120:123], v[20:23], v[68:71], v[120:123]
    ds_read_b64_tr_b16 v[44:45], v15 offset:12288
    ds_read_b64_tr_b16 v[46:47], v15 offset:14336
    v_mfma_f32_16x16x32_bf16 v[108:111], v[24:27], v[64:67], v[108:111]
    v_mfma_f32_16x16x32_bf16 v[124:127], v[24:27], v[68:71], v[124:127]
    v_mfma_f32_16x16x32_bf16 v[112:115], v[28:31], v[64:67], v[112:115]
    v_mfma_f32_16x16x32_bf16 v[128:131], v[28:31], v[68:71], v[128:131]
    s_waitcnt vmcnt(0) lgkmcnt(0)
    s_nop 0
    v_mfma_f32_16x16x32_bf16 v[100:103], v[32:35], v[72:75], v[100:103]
    v_mfma_f32_16x16x32_bf16 v[116:119], v[32:35], v[76:79], v[116:119]
    v_mfma_f32_16x16x32_bf16 v[104:107], v[36:39], v[72:75], v[104:107]
    v_mfma_f32_16x16x32_bf16 v[120:123], v[36:39], v[76:79], v[120:123]
    v_mfma_f32_16x16x32_bf16 v[108:111], v[40:43], v[72:75], v[108:111]
    v_mfma_f32_16x16x32_bf16 v[124:127], v[40:43], v[76:79], v[124:127]
    v_mfma_f32_16x16x32_bf16 v[112:115], v[44:47], v[72:75], v[112:115]
    v_mfma_f32_16x16x32_bf16 v[128:131], v[44:47], v[76:79], v[128:131]
    s_nop 2
    v_permlane16_swap_b32 v100, v104
    v_permlane16_swap_b32 v101, v105
    v_permlane16_swap_b32 v102, v106
    v_permlane16_swap_b32 v103, v107
    v_permlane16_swap_b32 v108, v112
    v_permlane16_swap_b32 v109, v113
    v_permlane16_swap_b32 v110, v114
    v_permlane16_swap_b32 v111, v115
    v_permlane16_swap_b32 v116, v120
    v_permlane16_swap_b32 v117, v121
    v_permlane16_swap_b32 v118, v122
    v_permlane16_swap_b32 v119, v123
    v_permlane16_swap_b32 v124, v128
    v_permlane16_swap_b32 v125, v129
    v_permlane16_swap_b32 v126, v130
    v_permlane16_swap_b32 v127, v131
    s_cmp_eq_u64 s[60:61], 0
    s_cbranch_scc1 F_fin
    s_mov_b32 s48, 0xbfb8aa3b
    v_and_b32 v7, 0x3f, v2
    v_lshlrev_b32 v7, 1, v7
    v_add_u32 v7, 159744, v7
    v_mov_b32 v6, 159136

    ds_read_b32 v5, v6 offset:0
FW_76:
    s_waitcnt lgkmcnt(0)
    v_cmp_gt_u32 vcc, 1, v5
    s_cbranch_vccz FO_77
    ds_read_b32 v5, v6 offset:0
    s_branch FW_76
FO_77:
    v_bfe_u32 v4, v164, 11, 3
    v_lshl_add_u32 v4, v4, 8, v7
    v_cmp_ne_u32 vcc, 0, v164
    s_nop 0
    s_and_saveexec_b64 s[50:51], vcc
    s_cbranch_execz F_rb_78
    ds_read_b128 v[16:19], v4 offset:0
    ds_read_b128 v[20:23], v4 offset:16
    ds_read_b128 v[24:27], v4 offset:128
    ds_read_b128 v[28:31], v4 offset:144
    v_and_b32 v5, 0xffff0000, v164
    v_ashrrev_i32 v6, 31, v5
    v_not_b32 v6, v6
    v_or_b32 v6, 0x80000000, v6
    v_xor_b32 v5, v5, v6
    v_and_b32 v5, 0xffff0000, v5
    v_mul_f32 v5, s48, v5
    v_exp_f32 v5, v5
    s_nop 0
    v_add_f32 v5, 1.0, v5
    v_rcp_f32 v5, v5
    s_nop 0
    v_cvt_pk_bf16_f32 v5, v5, v5
    v_lshlrev_b32 v5, 16, v5
    s_waitcnt lgkmcnt(0)
    v_fmac_f32 v100, v16, v5
    v_fmac_f32 v101, v17, v5
    v_fmac_f32 v102, v18, v5
    v_fmac_f32 v103, v19, v5
    v_fmac_f32 v104, v20, v5
    v_fmac_f32 v105, v21, v5
    v_fmac_f32 v106, v22, v5
    v_fmac_f32 v107, v23, v5
    v_fmac_f32 v108, v24, v5
    v_fmac_f32 v109, v25, v5
    v_fmac_f32 v110, v26, v5
    v_fmac_f32 v111, v27, v5
    v_fmac_f32 v112, v28, v5
    v_fmac_f32 v113, v29, v5
    v_fmac_f32 v114, v30, v5
    v_fmac_f32 v115, v31, v5
F_rb_78:
    s_mov_b64 exec, s[50:51]
    v_bfe_u32 v4, v165, 11, 3
    v_lshl_add_u32 v4, v4, 8, v7
    v_cmp_ne_u32 vcc, 0, v165
    s_nop 0
    s_and_saveexec_b64 s[50:51], vcc
    s_cbranch_execz F_rb_79
    ds_read_b128 v[16:19], v4 offset:0
    ds_read_b128 v[20:23], v4 offset:16
    ds_read_b128 v[24:27], v4 offset:128
    ds_read_b128 v[28:31], v4 offset:144
    v_and_b32 v5, 0xffff0000, v165
    v_ashrrev_i32 v6, 31, v5
    v_not_b32 v6, v6
    v_or_b32 v6, 0x80000000, v6
    v_xor_b32 v5, v5, v6
    v_and_b32 v5, 0xffff0000, v5
    v_mul_f32 v5, s48, v5
    v_exp_f32 v5, v5
    s_nop 0
    v_add_f32 v5, 1.0, v5
    v_rcp_f32 v5, v5
    s_nop 0
    v_cvt_pk_bf16_f32 v5, v5, v5
    v_lshlrev_b32 v5, 16, v5
    s_waitcnt lgkmcnt(0)
    v_fmac_f32 v116, v16, v5
    v_fmac_f32 v117, v17, v5
    v_fmac_f32 v118, v18, v5
    v_fmac_f32 v119, v19, v5
    v_fmac_f32 v120, v20, v5
    v_fmac_f32 v121, v21, v5
    v_fmac_f32 v122, v22, v5
    v_fmac_f32 v123, v23, v5
    v_fmac_f32 v124, v24, v5
    v_fmac_f32 v125, v25, v5
    v_fmac_f32 v126, v26, v5
    v_fmac_f32 v127, v27, v5
    v_fmac_f32 v128, v28, v5
    v_fmac_f32 v129, v29, v5
    v_fmac_f32 v130, v30, v5
    v_fmac_f32 v131, v31, v5
F_rb_79:
    s_mov_b64 exec, s[50:51]
F_fin:
    s_nop 0
    v_cvt_pk_bf16_f32 v48, v100, v101
    v_cvt_pk_bf16_f32 v49, v102, v103
    v_cvt_pk_bf16_f32 v50, v104, v105
    v_cvt_pk_bf16_f32 v51, v106, v107
    buffer_store_dwordx4 v[48:51], v2, s[12:15], s42 offen offset:0 sc1
    v_cvt_pk_bf16_f32 v52, v108, v109
    v_cvt_pk_bf16_f32 v53, v110, v111
    v_cvt_pk_bf16_f32 v54, v112, v113
    v_cvt_pk_bf16_f32 v55, v114, v115
    buffer_store_dwordx4 v[52:55], v2, s[12:15], s42 offen offset:64 sc1
    v_cvt_pk_bf16_f32 v56, v116, v117
    v_cvt_pk_bf16_f32 v57, v118, v119
    v_cvt_pk_bf16_f32 v58, v120, v121
    v_cvt_pk_bf16_f32 v59, v122, v123
    buffer_store_dwordx4 v[56:59], v2, s[12:15], s43 offen offset:0 sc1
    v_cvt_pk_bf16_f32 v60, v124, v125
    v_cvt_pk_bf16_f32 v61, v126, v127
    v_cvt_pk_bf16_f32 v62, v128, v129
    v_cvt_pk_bf16_f32 v63, v130, v131
    buffer_store_dwordx4 v[60:63], v2, s[12:15], s43 offen offset:64 sc1
    s_endpgm
F_aux:
    s_setprio 3
    s_sub_u32 s3, s3, 8
    s_mov_b32 s88, s3
    v_lshrrev_b32 v5, 4, v0
    s_cmp_eq_u32 s3, 1
    s_mov_b32 s45, 73728
    s_cselect_b32 s45, 65536, s45
    s_cmp_eq_u32 s3, 2
    s_cselect_b32 s45, 147456, s45
    v_bfe_u32 v60, v0, 2, 2
    v_lshl_add_u32 v62, v5, 3, v60
    v_lshrrev_b32 v60, 1, v60
    v_and_b32 v63, 1, v5
    v_lshl_add_u32 v60, v63, 1, v60
    v_lshlrev_b32 v60, 5, v60
    v_lshl_add_u32 v60, v62, 7, v60
    v_and_b32 v63, 3, v0
    v_lshl_add_u32 v60, v63, 3, v60
    v_add_u32 v62, s45, v60
    v_xor_b32 v63, 32, v62
    v_xor_b32 v64, 64, v62
    v_xor_b32 v65, 96, v62
    v_lshlrev_b32 v2, 4, v0
    v_lshlrev_b32 v3, 2, v0
    v_and_b32 v7, 15, v0
    v_and_b32 v8, 7, v0
    v_lshlrev_b32 v8, 4, v8
    v_lshl_add_u32 v8, v5, 7, v8
    v_bfe_u32 v9, v0, 3, 1
    v_lshl_add_u32 v4, v9, 11, v8
    v_and_b32 v9, 1, v0
    v_lshlrev_b32 v59, 2, v7
    s_lshl_b32 s76, s32, 4
    s_add_u32 s76, s76, s33
    s_lshl_b32 s77, s76, 3
    s_lshl_b32 s44, s3, 1
    s_add_u32 s77, s77, s44
    v_mov_b32 v12, 0
    v_mov_b32 v13, 0
    v_mov_b32 v14, 0
    v_mov_b32 v15, 0
    s_lshl_b32 s75, s3, 4
    s_add_u32 s75, s75, s33
    s_lshl_b32 s44, s3, 2
    s_add_u32 s44, s44, 159040
    v_mov_b32 v10, s44

    v_mov_b32 v32, 0x3f803f80
    v_mov_b32 v33, 0x3f803f80
    v_mov_b32 v34, 0x3f803f80
    v_mov_b32 v35, 0x3f803f80
    v_mov_b32 v36, 0x3f803f80
    v_mov_b32 v37, 0x3f803f80
    v_mov_b32 v38, 0x3f803f80
    v_mov_b32 v39, 0x3f803f80
    v_mov_b32 v40, 0x3f803f80
    v_mov_b32 v41, 0x3f803f80
    v_mov_b32 v42, 0x3f803f80
    v_mov_b32 v43, 0x3f803f80
    v_mov_b32 v44, 0x3f803f80
    v_mov_b32 v45, 0x3f803f80
    v_mov_b32 v46, 0x3f803f80
    v_mov_b32 v47, 0x3f803f80
    s_waitcnt lgkmcnt(0)
    s_mov_b32 s20, s4
    s_mov_b32 s21, s5
    s_mov_b32 s22, 0x400000
    s_mov_b32 s23, 0x00020000
    s_mov_b32 s19, 0x20000
    s_add_u32 s40, s72, 0x850000
    s_addc_u32 s41, s73, 0
    s_mov_b32 s42, 0xd000
    s_mov_b32 s43, 0x00020000
    s_cmp_lg_u32 s3, 0
    s_cbranch_scc1 F_z0
    s_getpc_b64 s[46:47]
F_pc:
    s_sub_u32 s46, s46, F_pc-parallel_sum__linear_attn_block__moe_arch_mod__prompt_kernel
    s_subb_u32 s47, s47, 0
    s_and_b32 s44, s31, 7
    s_lshl_b32 s44, s44, 13
    v_lshlrev_b32 v67, 7, v0
    v_add_u32 v67, s44, v67
    v_min_u32 v67, F_codeend-parallel_sum__linear_attn_block__moe_arch_mod__prompt_kernel-4, v67
    global_load_dword v61, v67, s[46:47]
    s_cmp_lg_u32 s75, 0
    s_cbranch_scc1 F_z0
    s_lshl_b32 s44, s32, 9
    s_add_u32 s44, s44, 32768
    s_mov_b32 exec_hi, 0
    buffer_store_dwordx4 v[12:15], v2, s[40:43], s44 offen sc0 sc1
    s_mul_i32 s44, s32, 768
    s_add_u32 s44, s44, 40960
    s_mov_b32 exec_hi, 0xffff
    buffer_store_dwordx4 v[12:15], v2, s[40:43], s44 offen sc0 sc1
    s_mov_b64 exec, -1
F_z0:

    s_barrier
    s_bitcmp0_b32 s3, 0
    s_cbranch_scc1 F_cs1
    ds_read_b64_tr_b16 v[72:73], v62 offset:0
    ds_read_b64_tr_b16 v[74:75], v62 offset:512
    ds_read_b64_tr_b16 v[76:77], v62 offset:4096
    ds_read_b64_tr_b16 v[78:79], v62 offset:4608
    ds_read_b64_tr_b16 v[80:81], v63 offset:0
    ds_read_b64_tr_b16 v[82:83], v63 offset:512
    ds_read_b64_tr_b16 v[84:85], v63 offset:4096
    ds_read_b64_tr_b16 v[86:87], v63 offset:4608
    s_waitcnt lgkmcnt(4)
    s_nop 0
    ds_read_b64_tr_b16 v[88:89], v64 offset:0
    ds_read_b64_tr_b16 v[90:91], v64 offset:512
    ds_read_b64_tr_b16 v[92:93], v64 offset:4096
    ds_read_b64_tr_b16 v[94:95], v64 offset:4608
    ds_read_b64_tr_b16 v[96:97], v65 offset:0
    ds_read_b64_tr_b16 v[98:99], v65 offset:512
    ds_read_b64_tr_b16 v[100:101], v65 offset:4096
    ds_read_b64_tr_b16 v[102:103], v65 offset:4608
    s_branch F_cs2
F_cs1:
    v_add_u32 v60, 159040, v3
    s_mov_b32 exec_hi, 0xffff
    ds_write_b32 v60, v12
    s_mov_b64 exec, -1
F_cs2:
    s_add_u32 s24, s72, 0x800000
    s_addc_u32 s25, s73, 0
    s_mov_b32 s26, 0x48000
    s_mov_b32 s27, 0x00020000
    s_mov_b32 s48, s70
    s_mov_b32 s49, s71
    s_mov_b32 s50, 0x100
    s_mov_b32 s51, 0x00020000
    s_lshl_b32 s47, s32, 9
    s_add_u32 s56, s47, 0x858000
    s_add_u32 s56, s72, s56
    s_addc_u32 s57, s73, 0
    s_lshl_b32 s47, s33, 9
    s_add_u32 s58, s47, 0x858100
    s_add_u32 s58, s72, s58
    s_addc_u32 s59, s73, 0
    v_mov_b32 v68, 0x3f803f80
    v_mov_b32 v69, 0x3f803f80
    v_mov_b32 v70, 0x3f803f80
    v_mov_b32 v71, 0x3f803f80
    s_waitcnt lgkmcnt(0)
    s_cmp_lg_u32 s75, 0
    s_cbranch_scc1 F_z4
    s_lshl_b32 s45, s32, 2
    s_add_u32 s44, s70, s45
    s_addc_u32 s45, s71, 0
    s_mov_b32 s46, 1
    s_waitcnt vmcnt(0)
    s_atomic_add s46, s[44:45], 0
F_z4:

    s_barrier
    s_cmp_lg_u32 s3, 2
    s_cbranch_scc1 F_cs3
    ds_read_b64_tr_b16 v[72:73], v62 offset:0
    ds_read_b64_tr_b16 v[74:75], v62 offset:512
    ds_read_b64_tr_b16 v[76:77], v62 offset:4096
    ds_read_b64_tr_b16 v[78:79], v62 offset:4608
    ds_read_b64_tr_b16 v[80:81], v63 offset:0
    ds_read_b64_tr_b16 v[82:83], v63 offset:512
    ds_read_b64_tr_b16 v[84:85], v63 offset:4096
    ds_read_b64_tr_b16 v[86:87], v63 offset:4608
    s_waitcnt lgkmcnt(4)
    s_nop 0
    ds_read_b64_tr_b16 v[88:89], v64 offset:0
    ds_read_b64_tr_b16 v[90:91], v64 offset:512
    ds_read_b64_tr_b16 v[92:93], v64 offset:4096
    ds_read_b64_tr_b16 v[94:95], v64 offset:4608
    ds_read_b64_tr_b16 v[96:97], v65 offset:0
    ds_read_b64_tr_b16 v[98:99], v65 offset:512
    ds_read_b64_tr_b16 v[100:101], v65 offset:4096
    ds_read_b64_tr_b16 v[102:103], v65 offset:4608
    s_waitcnt lgkmcnt(0)
F_cs3:
    s_cmp_lt_u32 s3, 2
    s_mov_b32 s44, 81920
    s_cselect_b32 s44, 81920, s44
    s_lshl_b32 s45, s3, 12
    s_add_u32 s44, s44, s45
    v_add_u32_e64 v4, s44, v4
    v_add_u32 v8, 161792, v8
    ds_read_b128 v[16:19], v4 offset:0
    ds_read_b128 v[20:23], v4 offset:512
    ds_read_b128 v[24:27], v4 offset:1024
    ds_read_b128 v[28:31], v4 offset:1536
    s_mov_b32 exec_lo, 0x00ff00ff
    s_branch IW_s8
IW_w8:
    s_branch IW_r8
IW_s8:
    s_mov_b32 exec_hi, 0x00ff00ff
    ds_read_b128 v[32:35], v8 offset:0
    ds_read_b128 v[36:39], v8 offset:512
    ds_read_b128 v[40:43], v8 offset:1024
    ds_read_b128 v[44:47], v8 offset:1536
    s_mov_b64 exec, -1
    s_waitcnt lgkmcnt(0)
    v_mfma_f32_16x16x32_bf16 v[120:123], v[16:19], v[16:19], 0
    v_mfma_f32_16x16x32_bf16 v[124:127], v[16:19], v[32:35], 0
    v_mfma_f32_16x16x32_bf16 v[128:131], v[32:35], v[32:35], 0
    v_mfma_f32_16x16x32_bf16 v[120:123], v[20:23], v[20:23], v[120:123]
    v_mfma_f32_16x16x32_bf16 v[124:127], v[20:23], v[36:39], v[124:127]
    v_mfma_f32_16x16x32_bf16 v[128:131], v[36:39], v[36:39], v[128:131]
    v_mfma_f32_16x16x32_bf16 v[120:123], v[24:27], v[24:27], v[120:123]
    v_mfma_f32_16x16x32_bf16 v[124:127], v[24:27], v[40:43], v[124:127]
    v_mfma_f32_16x16x32_bf16 v[128:131], v[40:43], v[40:43], v[128:131]
    v_mfma_f32_16x16x32_bf16 v[120:123], v[28:31], v[28:31], v[120:123]
    v_mfma_f32_16x16x32_bf16 v[124:127], v[28:31], v[44:47], v[124:127]
    v_mfma_f32_16x16x32_bf16 v[128:131], v[44:47], v[44:47], v[128:131]
    v_mfma_f32_16x16x32_bf16 v[104:107], v[68:71], v[72:75], 0
    v_mfma_f32_16x16x32_bf16 v[108:111], v[68:71], v[80:83], 0
    v_mfma_f32_16x16x32_bf16 v[112:115], v[68:71], v[88:91], 0
    v_mfma_f32_16x16x32_bf16 v[116:119], v[68:71], v[96:99], 0
    v_mfma_f32_16x16x32_bf16 v[104:107], v[68:71], v[76:79], v[104:107]
    v_mfma_f32_16x16x32_bf16 v[108:111], v[68:71], v[84:87], v[108:111]
    v_mfma_f32_16x16x32_bf16 v[112:115], v[68:71], v[92:95], v[112:115]
    v_mfma_f32_16x16x32_bf16 v[116:119], v[68:71], v[100:103], v[116:119]
    v_cmp_eq_u32 vcc, 1, v5
    s_nop 4
    v_cndmask_b32 v66, v104, v108, vcc
    v_cmp_eq_u32 vcc, 2, v5
    s_nop 1
    v_cndmask_b32 v66, v66, v112, vcc
    v_cmp_eq_u32 vcc, 3, v5
    s_nop 1
    v_cndmask_b32 v66, v66, v116, vcc

    s_cmp_lg_u32 s3, 0
    s_cbranch_scc1 EV_81
    s_branch IW_w8
IW_r8:
EV_81:
    s_cmp_lg_u32 s3, 1
    s_cbranch_scc1 EV_82
    s_branch IW_w0
IW_r0:
EV_82:
    s_cmp_lg_u32 s3, 2
    s_cbranch_scc1 EV_83
    s_branch IW_w1
IW_r1:
EV_83:
    s_cmp_lg_u32 s3, 3
    s_cbranch_scc1 EV_84
    s_branch IW_w3
IW_r3:
EV_84:
    s_barrier
    v_and_b32 v52, 3, v0
    v_cmp_eq_u32 vcc, 1, v52
    s_nop 1
    v_cndmask_b32 v120, v120, v121, vcc
    v_cndmask_b32 v124, v124, v125, vcc
    v_cndmask_b32 v128, v128, v129, vcc
    v_cmp_eq_u32 vcc, 2, v52
    s_nop 1
    v_cndmask_b32 v120, v120, v122, vcc
    v_cndmask_b32 v124, v124, v126, vcc
    v_cndmask_b32 v128, v128, v130, vcc
    v_cmp_eq_u32 vcc, 3, v52
    s_nop 1
    v_cndmask_b32 v120, v120, v123, vcc
    v_cndmask_b32 v124, v124, v127, vcc
    v_cndmask_b32 v128, v128, v131, vcc
    v_add_f32_dpp v120, v120, v120 quad_perm:[1,0,3,2] row_mask:0xf bank_mask:0xf
    v_add_f32_dpp v124, v124, v124 quad_perm:[1,0,3,2] row_mask:0xf bank_mask:0xf
    v_add_f32_dpp v128, v128, v128 quad_perm:[1,0,3,2] row_mask:0xf bank_mask:0xf
    v_add_f32_dpp v120, v120, v120 quad_perm:[2,3,0,1] row_mask:0xf bank_mask:0xf
    v_add_f32_dpp v124, v124, v124 quad_perm:[2,3,0,1] row_mask:0xf bank_mask:0xf
    v_add_f32_dpp v128, v128, v128 quad_perm:[2,3,0,1] row_mask:0xf bank_mask:0xf
    v_readlane_b32 s44, v124, 8
    v_readlane_b32 s45, v124, 24
    v_readlane_b32 s46, v124, 40
    v_readlane_b32 s47, v124, 56
    v_mov_b32 v48, s44
    v_mov_b32 v52, s45
    s_nop 0
    v_writelane_b32 v48, s46, 1
    v_writelane_b32 v52, s47, 1
    v_readlane_b32 s44, v120, 0
    v_readlane_b32 s45, v120, 20
    v_readlane_b32 s46, v120, 40
    v_readlane_b32 s47, v120, 60
    v_mov_b32 v49, s44
    v_mov_b32 v53, s45
    s_nop 0
    v_writelane_b32 v49, s46, 1
    v_writelane_b32 v53, s47, 1
    v_readlane_b32 s44, v124, 0
    v_readlane_b32 s45, v124, 20
    v_readlane_b32 s46, v124, 32
    v_readlane_b32 s47, v124, 52
    v_mov_b32 v50, s44
    v_mov_b32 v54, s45
    s_nop 0
    v_writelane_b32 v50, s46, 1
    v_writelane_b32 v54, s47, 1
    v_readlane_b32 s44, v128, 8
    v_readlane_b32 s45, v128, 24
    v_readlane_b32 s46, v128, 8
    v_readlane_b32 s47, v128, 24
    v_mov_b32 v51, s44
    v_mov_b32 v55, s45
    s_nop 0
    v_writelane_b32 v51, s46, 1
    v_writelane_b32 v55, s47, 1
    s_cmp_lg_u32 s3, 0
    s_cbranch_scc1 F_r1
    buffer_load_dword v11, v59, s[48:51], 0 offen sc0 sc1
F_r1:
    s_cmp_lg_u32 s3, 0
    s_cbranch_scc1 EV_86
    s_branch IW_w4
IW_r4:
EV_86:
    s_cmp_lg_u32 s3, 1
    s_cbranch_scc1 EV_87
    s_branch IW_w9
IW_r9:
EV_87:
    s_cmp_lg_u32 s3, 2
    s_cbranch_scc1 EV_88
    s_branch IW_w10
IW_r10:
EV_88:
    s_cmp_lg_u32 s3, 3
    s_cbranch_scc1 EV_89
    s_nop 0
EV_89:
    s_barrier
    v_add_f32 v48, v48, v52
    v_add_f32 v49, v49, v53
    v_add_f32 v50, v50, v54
    v_add_f32 v51, v51, v55
    v_mul_f32 v48, 0x3a800000, v48
    v_mul_f32 v49, 0x3a800000, v49
    v_fma_f32 v49, -v48, v48, v49
    v_max_f32 v49, 0, v49
    v_cvt_pk_bf16_f32 v52, v48, v49
    v_lshlrev_b32 v48, 16, v52
    v_and_b32 v49, 0xffff0000, v52
    v_add_f32 v49, 0x3727c5ac, v49
    v_cvt_pk_bf16_f32 v49, v49, v49
    v_lshlrev_b32 v49, 16, v49
    v_sqrt_f32 v49, v49
    s_nop 0
    v_cvt_pk_bf16_f32 v49, v49, v49
    v_lshlrev_b32 v49, 16, v49
    v_rcp_f32 v49, v49
    v_xor_b32 v48, 0x80000000, v48
    v_fma_f32 v50, v48, v51, v50
    v_mul_f32 v50, v50, v49
    v_cvt_pk_bf16_f32 v50, v50, v50
    v_and_b32 v50, 0xffff0000, v50
    v_ashrrev_i32 v51, 31, v50
    v_or_b32 v51, 0x80000000, v51
    v_xor_b32 v50, v50, v51
    v_and_b32 v50, 0xffff0000, v50
    s_sub_u32 s44, 2047, s77
    v_sub_u32 v51, s44, v9
    v_or_b32 v50, v50, v51
    s_lshl_b32 s44, s3, 1
    v_add_u32 v52, s44, v9
    v_lshlrev_b32 v53, 3, v52
    v_lshlrev_b32 v52, 2, v52
    v_add_u32 v53, 159744, v53
    v_add_u32 v52, 159808, v52
    s_mov_b64 exec, 3
    ds_write_b64 v53, v[48:49]
    ds_write_b32 v52, v50
    s_mov_b64 exec, -1
    s_waitcnt lgkmcnt(0)

    s_cmp_lg_u32 s3, 0
    s_cbranch_scc1 F_a0r
F_a0p:
    s_waitcnt vmcnt(0)
    v_cmp_eq_u32 vcc, 0, v11
    s_cbranch_vccz F_a0r
    s_sleep 4
    buffer_load_dword v11, v59, s[48:51], 0 offen sc0 sc1
    s_branch F_a0p
F_a0r:
    s_barrier
    s_cmp_eq_u32 s3, 0
    s_cbranch_scc1 F_ax0
    s_mul_i32 s44, s33, 768
    s_add_u32 s44, s44, 40960
    s_add_u32 s45, s3, 1
    s_lshr_b32 s45, s45, 1
    s_cmp_eq_u32 s3, 2
    s_cselect_b32 s45, 0, s45
    s_lshl_b32 s45, s45, 8
    s_add_u32 s44, s44, s45
    buffer_atomic_add_f32 v66, v3, s[40:43], s44 offen
    s_mul_i32 s44, s2, 1152
    s_mul_i32 s45, s3, 384
    s_add_u32 s44, s44, s45
    s_sub_u32 s44, s44, 384
    s_mov_b64 exec, 0xffffff
    buffer_store_dwordx4 v[12:15], v2, s[24:27], s44 offen sc0 sc1
    s_mov_b64 exec, -1
    s_branch F_s1
F_ax0:
    v_add_u32 v60, 159744, v3
    ds_read_b32 v60, v60
    s_lshl_b32 s44, s76, 7
    s_mov_b32 exec_hi, 0
    s_waitcnt lgkmcnt(0)
    buffer_store_dword v60, v3, s[40:43], s44 offen sc0 sc1
    s_mov_b64 exec, -1
F_s1:

    s_barrier
    v_mov_b32 v4, 159144
    v_mov_b32 v8, 1
    s_lshr_b32 s47, s32, 2
    s_lshl_b32 s47, s47, 11
    s_add_u32 s54, s47, 0x858180
    s_add_u32 s54, s72, s54
    s_addc_u32 s55, s73, 0
    s_waitcnt vmcnt(0)
    s_mov_b64 exec, 1
    ds_add_rtn_u32 v9, v4, v8
    s_waitcnt lgkmcnt(0)
    v_readfirstlane_b32 s44, v9
    s_mov_b64 exec, -1
    s_cmp_lg_u32 s44, 3
    s_cbranch_scc1 F_a0s
    s_mov_b32 s74, 1
    s_atomic_add s74, s[54:55], 0
    s_atomic_add s74, s[56:57], 0
    s_atomic_add s74, s[58:59], 0
F_a0s:

    s_barrier
    s_and_b32 s89, s2, 0xdd
    s_bfe_u32 s44, s2, 0x10005
    s_lshl_b32 s44, s44, 1
    s_or_b32 s89, s89, s44
    s_bfe_u32 s44, s2, 0x10001
    s_xor_b32 s44, s44, 1
    s_lshl_b32 s44, s44, 5
    s_or_b32 s89, s89, s44
    s_and_b32 s36, s89, 3
    s_bfe_u32 s37, s89, 0x10002
    s_lshr_b32 s38, s89, 3
    s_cmp_eq_u32 s37, 0
    s_cselect_b32 s16, s62, s64
    s_cselect_b32 s17, s63, s65
    s_cmp_lt_u32 s89, 224
    s_cselect_b32 s18, 7340032, 0
    v_mul_u32_u24 v6, 57344, v5
    v_lshl_add_u32 v6, v7, 4, v6
    s_lshl_b32 s44, s36, 2
    s_add_u32 s44, s44, s3
    s_waitcnt lgkmcnt(0)
    s_mul_i32 s54, s44, 458752
    s_lshl_b32 s45, s38, 8
    s_add_u32 s54, s54, s45
    s_lshl_b32 s55, s44, 7

    s_and_b32 s39, s89, 7
    s_mul_i32 s10, s38, 112
    s_mul_i32 s79, s3, 28
    s_add_u32 s10, s10, s79
    s_lshl_b32 s78, s10, 11
    s_lshl_b32 s79, s39, 8
    s_add_u32 s78, s78, s79
    v_mul_u32_u24 v160, 14336, v5
    v_lshl_add_u32 v160, v7, 4, v160

    s_mov_b32 s80, s66
    s_mov_b32 s81, s67
    s_mov_b32 s82, 0x700000
    s_mov_b32 s83, 0x00020000
    s_mul_i32 s53, s2, 37
    s_and_b32 s53, s53, 255
    s_mul_i32 s53, s53, 4
    s_lshr_b32 s53, s53, 8
    s_branch F_swx
F_sw0:
    s_add_u32 s91, s54, 0
    s_nop 0
    buffer_load_dwordx4 v[72:75], v6, s[16:19], s91 offen nt
    s_add_u32 s91, s54, 7168
    buffer_load_dwordx4 v[76:79], v6, s[16:19], s91 offen nt
    s_add_u32 s91, s54, 14336
    buffer_load_dwordx4 v[80:83], v6, s[16:19], s91 offen nt
    s_add_u32 s91, s54, 21504
    buffer_load_dwordx4 v[84:87], v6, s[16:19], s91 offen nt
    s_add_u32 s91, s54, 28672
    buffer_load_dwordx4 v[88:91], v6, s[16:19], s91 offen nt
    s_add_u32 s91, s54, 35840
    buffer_load_dwordx4 v[92:95], v6, s[16:19], s91 offen nt
    s_add_u32 s91, s54, 43008
    buffer_load_dwordx4 v[96:99], v6, s[16:19], s91 offen nt
    s_add_u32 s91, s54, 50176
    buffer_load_dwordx4 v[100:103], v6, s[16:19], s91 offen nt
    s_setpc_b64 s[34:35]
F_swx:
    s_cmp_eq_u32 s3, 2
    s_cbranch_scc1 F_ax2
    s_cmp_eq_u32 s3, 1
    s_cbranch_scc1 F_ax1
    s_cmp_eq_u32 s3, 0
    s_cbranch_scc1 F_ax0b
    s_barrier
    s_cmp_lg_u32 s53, 0
    s_cbranch_scc1 SW_90
    s_call_b64 s[34:35], F_sw0
SW_90:
    s_branch IW_w5
IW_r5:
    s_barrier
    s_cmp_lg_u32 s53, 1
    s_cbranch_scc1 SW_91
    s_call_b64 s[34:35], F_sw0
SW_91:
    s_branch IW_w7
IW_r7:
    s_barrier
    s_cmp_lg_u32 s53, 2
    s_cbranch_scc1 SW_92
    s_call_b64 s[34:35], F_sw0
SW_92:
    s_nop 0
    s_barrier
    s_cmp_lg_u32 s53, 3
    s_cbranch_scc1 SW_93
    s_call_b64 s[34:35], F_sw0
SW_93:
    s_nop 0
    s_barrier
    s_nop 0
    s_barrier
    s_nop 0
    s_barrier
    s_add_u32 s91, s54, 229376
    buffer_load_dwordx4 v[104:107], v6, s[16:19], s91 offen nt
    s_add_u32 s91, s54, 236544
    buffer_load_dwordx4 v[108:111], v6, s[16:19], s91 offen nt
    s_add_u32 s91, s54, 243712
    buffer_load_dwordx4 v[112:115], v6, s[16:19], s91 offen nt
    s_add_u32 s91, s54, 250880
    buffer_load_dwordx4 v[116:119], v6, s[16:19], s91 offen nt
    s_nop 0
    s_load_dword s76, s[56:57], 0 glc
    s_barrier
    s_add_u32 s91, s54, 258048
    buffer_load_dwordx4 v[120:123], v6, s[16:19], s91 offen nt
    s_add_u32 s91, s54, 265216
    buffer_load_dwordx4 v[124:127], v6, s[16:19], s91 offen nt
    s_add_u32 s91, s54, 272384
    buffer_load_dwordx4 v[128:131], v6, s[16:19], s91 offen nt
    s_add_u32 s91, s54, 279552
    buffer_load_dwordx4 v[132:135], v6, s[16:19], s91 offen nt
    s_waitcnt lgkmcnt(0)
    s_cmp_ge_u32 s76, 1000
    s_cbranch_scc1 GC_94
SP_95:
    s_load_dword s76, s[56:57], 0 glc
    s_waitcnt lgkmcnt(0)
    s_cmp_ge_u32 s76, 1000
    s_cbranch_scc1 SD_96
    s_sleep 3
    s_branch SP_95
SD_96:
GC_94:
    v_mov_b32 v4, 1
    s_mov_b64 exec, 1
    ds_write_b32 v10, v4 offset:48
    s_mov_b64 exec, -1
    s_barrier
    s_branch F_aj
F_ax1:
    s_barrier
    s_cmp_lg_u32 s53, 0
    s_cbranch_scc1 SW_97
    s_call_b64 s[34:35], F_sw0
SW_97:
    s_branch IW_w6
IW_r6:
    s_barrier
    s_cmp_lg_u32 s53, 1
    s_cbranch_scc1 SW_98
    s_call_b64 s[34:35], F_sw0
SW_98:
    s_nop 0
    s_barrier
    s_cmp_lg_u32 s53, 2
    s_cbranch_scc1 SW_99
    s_call_b64 s[34:35], F_sw0
SW_99:
    s_nop 0
    s_mul_i32 s44, s33, 768
    s_add_u32 s44, s44, 40960
    s_barrier
    s_cmp_lg_u32 s53, 3
    s_cbranch_scc1 SW_100
    s_call_b64 s[34:35], F_sw0
SW_100:
    s_load_dword s76, s[58:59], 0 glc
    s_barrier
    s_waitcnt lgkmcnt(0)
    s_cmp_ge_u32 s76, 16
    s_cbranch_scc1 GC_101
SP_102:
    s_load_dword s76, s[58:59], 0 glc
    s_waitcnt lgkmcnt(0)
    s_cmp_ge_u32 s76, 16
    s_cbranch_scc1 SD_103
    s_sleep 3
    s_branch SP_102
SD_103:
GC_101:
    s_barrier
    s_sleep 4
    s_mov_b32 m0, 158208
    s_mov_b32 exec_hi, 0xffff
    buffer_load_dwordx4 v2, s[40:43], s44 offen sc0 sc1 lds
    s_mov_b64 exec, -1
    s_barrier
    s_nop 0
    s_add_u32 s91, s54, 229376
    buffer_load_dwordx4 v[104:107], v6, s[16:19], s91 offen nt
    s_add_u32 s91, s54, 236544
    buffer_load_dwordx4 v[108:111], v6, s[16:19], s91 offen nt
    s_add_u32 s91, s54, 243712
    buffer_load_dwordx4 v[112:115], v6, s[16:19], s91 offen nt
    s_add_u32 s91, s54, 250880
    buffer_load_dwordx4 v[116:119], v6, s[16:19], s91 offen nt
    s_barrier
    s_nop 0
    s_add_u32 s91, s54, 258048
    buffer_load_dwordx4 v[120:123], v6, s[16:19], s91 offen nt
    s_add_u32 s91, s54, 265216
    buffer_load_dwordx4 v[124:127], v6, s[16:19], s91 offen nt
    s_add_u32 s91, s54, 272384
    buffer_load_dwordx4 v[128:131], v6, s[16:19], s91 offen nt
    s_add_u32 s91, s54, 279552
    buffer_load_dwordx4 v[132:135], v6, s[16:19], s91 offen nt
    s_waitcnt vmcnt(8)
    v_mov_b32 v4, 1
    s_mov_b64 exec, 1
    ds_write_b32 v10, v4 offset:48
    s_mov_b64 exec, -1
    s_barrier
    s_branch F_aj
IW_w9:
    s_branch IW_r9
F_ax0b:
    s_barrier
    s_cmp_lg_u32 s53, 0
    s_cbranch_scc1 SW_104
    s_call_b64 s[34:35], F_sw0
SW_104:
    s_branch IW_w2
IW_r2:
    s_barrier
    s_cmp_lg_u32 s53, 1
    s_cbranch_scc1 SW_105
    s_call_b64 s[34:35], F_sw0
SW_105:
    s_nop 0
    s_barrier
    s_cmp_lg_u32 s53, 2
    s_cbranch_scc1 SW_106
    s_call_b64 s[34:35], F_sw0
SW_106:
    s_nop 0
    s_lshl_b32 s47, s28, 9
    s_add_u32 s58, s47, 0x858000
    s_add_u32 s58, s72, s58
    s_addc_u32 s59, s73, 0
    s_lshl_b32 s44, s32, 11
    s_lshl_b32 s45, s28, 11
    v_lshrrev_b32 v11, 2, v0
    v_and_b32 v9, 3, v0
    v_lshlrev_b32 v9, 4, v9
    v_lshl_add_u32 v11, v11, 7, v9

    s_barrier
    s_cmp_lg_u32 s53, 3
    s_cbranch_scc1 SW_107
    s_call_b64 s[34:35], F_sw0
SW_107:
    s_load_dword s76, s[56:57], 0 glc
    s_load_dword s77, s[58:59], 0 glc
    s_barrier
    s_waitcnt lgkmcnt(0)
    s_cmp_ge_u32 s76, 16
    s_cbranch_scc1 GC_108
SP_109:
    s_load_dword s76, s[56:57], 0 glc
    s_waitcnt lgkmcnt(0)
    s_cmp_ge_u32 s76, 16
    s_cbranch_scc1 SD_110
    s_sleep 3
    s_branch SP_109
SD_110:
GC_108:
    s_cmp_ge_u32 s77, 16
    s_cbranch_scc1 GC_111
SP_112:
    s_load_dword s77, s[58:59], 0 glc
    s_waitcnt lgkmcnt(0)
    s_cmp_ge_u32 s77, 16
    s_cbranch_scc1 SD_113
    s_sleep 3
    s_branch SP_112
SD_113:
GC_111:
    s_barrier
    s_sleep 4
    buffer_load_dwordx4 v[32:35], v11, s[40:43], s44 offen sc0 sc1
    buffer_load_dwordx4 v[36:39], v11, s[40:43], s45 offen sc0 sc1
    v_lshlrev_b32 v9, 3, v0
    v_add_u32 v9, 155648, v9
    s_mov_b32 s44, 0x3fb8aa3b

    s_barrier
    s_add_u32 s91, s54, 229376
    buffer_load_dwordx4 v[104:107], v6, s[16:19], s91 offen nt
    s_add_u32 s91, s54, 236544
    buffer_load_dwordx4 v[108:111], v6, s[16:19], s91 offen nt
    s_add_u32 s91, s54, 243712
    buffer_load_dwordx4 v[112:115], v6, s[16:19], s91 offen nt
    s_add_u32 s91, s54, 250880
    buffer_load_dwordx4 v[116:119], v6, s[16:19], s91 offen nt
    s_barrier
    s_nop 0
    s_add_u32 s91, s54, 258048
    buffer_load_dwordx4 v[120:123], v6, s[16:19], s91 offen nt
    s_add_u32 s91, s54, 265216
    buffer_load_dwordx4 v[124:127], v6, s[16:19], s91 offen nt
    s_add_u32 s91, s54, 272384
    buffer_load_dwordx4 v[128:131], v6, s[16:19], s91 offen nt
    s_add_u32 s91, s54, 279552
    buffer_load_dwordx4 v[132:135], v6, s[16:19], s91 offen nt
    s_waitcnt vmcnt(8)
    v_swap_b32 v33, v34
    v_swap_b32 v37, v38
    v_mul_f32 v40, s44, v34
    v_mul_f32 v41, s44, v35
    ds_write_b64 v9, v[32:33]
    ds_write_b64 v9, v[40:41] offset:1024
    ds_write_b64 v9, v[36:37] offset:1536
    ds_write_b64 v9, v[38:39] offset:2048

    v_mov_b32 v4, 1
    s_mov_b64 exec, 1
    ds_write_b32 v10, v4 offset:48
    s_mov_b64 exec, -1
    s_barrier
    s_branch F_aj
F_ax2:
    s_cmp_lg_u32 s2, 248
    s_cbranch_scc1 F_a2n
    s_waitcnt lgkmcnt(0)
    s_mov_b32 s74, 7
    v_lshrrev_b32 v11, 1, v0
    v_and_b32 v9, 1, v0
    v_lshlrev_b32 v9, 4, v9
    v_lshl_add_u32 v11, v11, 7, v9
    v_lshlrev_b32 v9, 9, v0
    v_mov_b32 v8, 1000
F_a2l:

    s_load_dword s60, s[40:41], 0x8180 glc
    s_load_dword s61, s[40:41], 0x8980 glc
    s_load_dword s62, s[40:41], 0x9180 glc
    s_load_dword s63, s[40:41], 0x9980 glc
    s_waitcnt lgkmcnt(0)
    s_add_u32 s60, s60, s61
    s_add_u32 s62, s62, s63
    s_add_u32 s60, s60, s62
    s_cmp_ge_u32 s60, 256
    s_cbranch_scc1 F_a2t

    s_cmp_ge_u32 s74, 17
    s_cbranch_scc1 DB_114
    s_barrier
    s_add_u32 s74, s74, 1
DB_114:
    s_branch F_a2l
F_a2t:
    s_movk_i32 s44, 0
    buffer_load_dwordx4 v[16:19], v11, s[40:43], s44 offen offset:64 sc0 sc1
    s_movk_i32 s44, 4096
    buffer_load_dwordx4 v[20:23], v11, s[40:43], s44 offen offset:64 sc0 sc1
    s_movk_i32 s44, 8192
    buffer_load_dwordx4 v[24:27], v11, s[40:43], s44 offen offset:64 sc0 sc1
    s_movk_i32 s44, 12288
    buffer_load_dwordx4 v[28:31], v11, s[40:43], s44 offen offset:64 sc0 sc1
    s_movk_i32 s44, 16384
    buffer_load_dwordx4 v[32:35], v11, s[40:43], s44 offen offset:64 sc0 sc1
    s_movk_i32 s44, 20480
    buffer_load_dwordx4 v[36:39], v11, s[40:43], s44 offen offset:64 sc0 sc1
    s_movk_i32 s44, 24576
    buffer_load_dwordx4 v[40:43], v11, s[40:43], s44 offen offset:64 sc0 sc1
    s_movk_i32 s44, 28672
    buffer_load_dwordx4 v[44:47], v11, s[40:43], s44 offen offset:64 sc0 sc1
    s_mov_b32 s44, 32768
    s_mov_b64 exec, 0xffff
    buffer_atomic_add v8, v9, s[40:43], s44 offen
    s_mov_b64 exec, -1

    s_cmp_ge_u32 s74, 17
    s_cbranch_scc1 DB_115
    s_barrier
    s_add_u32 s74, s74, 1
DB_115:
    s_waitcnt vmcnt(1)
    v_max3_u32 v48, v16, v17, v18
    v_med3_u32 v49, v16, v17, v18
    v_min3_u32 v50, v16, v17, v18
    v_med3_u32 v50, v49, v50, v19
    v_med3_u32 v49, v48, v49, v19
    v_max_u32 v48, v48, v19
    v_med3_u32 v50, v49, v50, v20
    v_med3_u32 v49, v48, v49, v20
    v_max_u32 v48, v48, v20
    v_med3_u32 v50, v49, v50, v21
    v_med3_u32 v49, v48, v49, v21
    v_max_u32 v48, v48, v21
    v_med3_u32 v50, v49, v50, v22
    v_med3_u32 v49, v48, v49, v22
    v_max_u32 v48, v48, v22
    v_med3_u32 v50, v49, v50, v23
    v_med3_u32 v49, v48, v49, v23
    v_max_u32 v48, v48, v23
    v_med3_u32 v50, v49, v50, v24
    v_med3_u32 v49, v48, v49, v24
    v_max_u32 v48, v48, v24
    v_med3_u32 v50, v49, v50, v25
    v_med3_u32 v49, v48, v49, v25
    v_max_u32 v48, v48, v25
    v_med3_u32 v50, v49, v50, v26
    v_med3_u32 v49, v48, v49, v26
    v_max_u32 v48, v48, v26
    v_med3_u32 v50, v49, v50, v27
    v_med3_u32 v49, v48, v49, v27
    v_max_u32 v48, v48, v27
    v_med3_u32 v50, v49, v50, v28
    v_med3_u32 v49, v48, v49, v28
    v_max_u32 v48, v48, v28
    v_med3_u32 v50, v49, v50, v29
    v_med3_u32 v49, v48, v49, v29
    v_max_u32 v48, v48, v29
    v_med3_u32 v50, v49, v50, v30
    v_med3_u32 v49, v48, v49, v30
    v_max_u32 v48, v48, v30
    v_med3_u32 v50, v49, v50, v31
    v_med3_u32 v49, v48, v49, v31
    v_max_u32 v48, v48, v31
    v_med3_u32 v50, v49, v50, v32
    v_med3_u32 v49, v48, v49, v32
    v_max_u32 v48, v48, v32
    v_med3_u32 v50, v49, v50, v33
    v_med3_u32 v49, v48, v49, v33
    v_max_u32 v48, v48, v33
    v_med3_u32 v50, v49, v50, v34
    v_med3_u32 v49, v48, v49, v34
    v_max_u32 v48, v48, v34
    v_med3_u32 v50, v49, v50, v35
    v_med3_u32 v49, v48, v49, v35
    v_max_u32 v48, v48, v35
    v_med3_u32 v50, v49, v50, v36
    v_med3_u32 v49, v48, v49, v36
    v_max_u32 v48, v48, v36
    v_med3_u32 v50, v49, v50, v37
    v_med3_u32 v49, v48, v49, v37
    v_max_u32 v48, v48, v37
    v_med3_u32 v50, v49, v50, v38
    v_med3_u32 v49, v48, v49, v38
    v_max_u32 v48, v48, v38
    v_med3_u32 v50, v49, v50, v39
    v_med3_u32 v49, v48, v49, v39
    v_max_u32 v48, v48, v39
    v_med3_u32 v50, v49, v50, v40
    v_med3_u32 v49, v48, v49, v40
    v_max_u32 v48, v48, v40
    v_med3_u32 v50, v49, v50, v41
    v_med3_u32 v49, v48, v49, v41
    v_max_u32 v48, v48, v41
    v_med3_u32 v50, v49, v50, v42
    v_med3_u32 v49, v48, v49, v42
    v_max_u32 v48, v48, v42
    v_med3_u32 v50, v49, v50, v43
    v_med3_u32 v49, v48, v49, v43
    v_max_u32 v48, v48, v43
    v_med3_u32 v50, v49, v50, v44
    v_med3_u32 v49, v48, v49, v44
    v_max_u32 v48, v48, v44
    v_med3_u32 v50, v49, v50, v45
    v_med3_u32 v49, v48, v49, v45
    v_max_u32 v48, v48, v45
    v_med3_u32 v50, v49, v50, v46
    v_med3_u32 v49, v48, v49, v46
    v_max_u32 v48, v48, v46
    v_med3_u32 v50, v49, v50, v47
    v_med3_u32 v49, v48, v49, v47
    v_max_u32 v48, v48, v47
    s_cmp_ge_u32 s74, 17
    s_cbranch_scc1 DB_116
    s_barrier
    s_add_u32 s74, s74, 1
DB_116:
    s_mov_b32 s53, 0
    v_max_u32 v4, v48, v49
    s_nop 1
    v_max_u32_dpp v4, v4, v4 row_shr:1 row_mask:0xf bank_mask:0xf bound_ctrl:0
    s_nop 1
    v_max_u32_dpp v4, v4, v4 row_shr:2 row_mask:0xf bank_mask:0xf bound_ctrl:0
    s_nop 1
    v_max_u32_dpp v4, v4, v4 row_shr:4 row_mask:0xf bank_mask:0xf bound_ctrl:0
    s_nop 1
    v_max_u32_dpp v4, v4, v4 row_shr:8 row_mask:0xf bank_mask:0xf bound_ctrl:0
    s_nop 1
    v_max_u32_dpp v4, v4, v4 row_bcast:15 row_mask:0xa bank_mask:0xf
    s_nop 1
    v_max_u32_dpp v4, v4, v4 row_bcast:31 row_mask:0xc bank_mask:0xf
    s_nop 0
    v_readlane_b32 s52, v4, 63
    s_nop 0
    s_add_u32 s53, s53, s52
    v_writelane_b32 v13, s53, 0
    v_subrev_u32 v48, s52, v48
    v_subrev_u32 v49, s52, v49
    v_max_u32 v4, v48, v49
    s_nop 1
    v_max_u32_dpp v4, v4, v4 row_shr:1 row_mask:0xf bank_mask:0xf bound_ctrl:0
    s_nop 1
    v_max_u32_dpp v4, v4, v4 row_shr:2 row_mask:0xf bank_mask:0xf bound_ctrl:0
    s_nop 1
    v_max_u32_dpp v4, v4, v4 row_shr:4 row_mask:0xf bank_mask:0xf bound_ctrl:0
    s_nop 1
    v_max_u32_dpp v4, v4, v4 row_shr:8 row_mask:0xf bank_mask:0xf bound_ctrl:0
    s_nop 1
    v_max_u32_dpp v4, v4, v4 row_bcast:15 row_mask:0xa bank_mask:0xf
    s_nop 1
    v_max_u32_dpp v4, v4, v4 row_bcast:31 row_mask:0xc bank_mask:0xf
    s_nop 0
    v_readlane_b32 s52, v4, 63
    s_nop 0
    s_add_u32 s53, s53, s52
    v_writelane_b32 v13, s53, 1
    v_subrev_u32 v48, s52, v48
    v_subrev_u32 v49, s52, v49
    v_max_u32 v4, v48, v49
    s_nop 1
    v_max_u32_dpp v4, v4, v4 row_shr:1 row_mask:0xf bank_mask:0xf bound_ctrl:0
    s_nop 1
    v_max_u32_dpp v4, v4, v4 row_shr:2 row_mask:0xf bank_mask:0xf bound_ctrl:0
    s_nop 1
    v_max_u32_dpp v4, v4, v4 row_shr:4 row_mask:0xf bank_mask:0xf bound_ctrl:0
    s_nop 1
    v_max_u32_dpp v4, v4, v4 row_shr:8 row_mask:0xf bank_mask:0xf bound_ctrl:0
    s_nop 1
    v_max_u32_dpp v4, v4, v4 row_bcast:15 row_mask:0xa bank_mask:0xf
    s_nop 1
    v_max_u32_dpp v4, v4, v4 row_bcast:31 row_mask:0xc bank_mask:0xf
    s_nop 0
    v_readlane_b32 s52, v4, 63
    s_nop 0
    s_add_u32 s53, s53, s52
    v_writelane_b32 v13, s53, 2
    v_subrev_u32 v48, s52, v48
    v_subrev_u32 v49, s52, v49
    v_max_u32 v4, v48, v49
    s_nop 1
    v_max_u32_dpp v4, v4, v4 row_shr:1 row_mask:0xf bank_mask:0xf bound_ctrl:0
    s_nop 1
    v_max_u32_dpp v4, v4, v4 row_shr:2 row_mask:0xf bank_mask:0xf bound_ctrl:0
    s_nop 1
    v_max_u32_dpp v4, v4, v4 row_shr:4 row_mask:0xf bank_mask:0xf bound_ctrl:0
    s_nop 1
    v_max_u32_dpp v4, v4, v4 row_shr:8 row_mask:0xf bank_mask:0xf bound_ctrl:0
    s_nop 1
    v_max_u32_dpp v4, v4, v4 row_bcast:15 row_mask:0xa bank_mask:0xf
    s_nop 1
    v_max_u32_dpp v4, v4, v4 row_bcast:31 row_mask:0xc bank_mask:0xf
    s_nop 0
    v_readlane_b32 s52, v4, 63
    s_nop 0
    s_add_u32 s53, s53, s52
    v_writelane_b32 v13, s53, 3
    v_subrev_u32 v48, s52, v48
    v_subrev_u32 v49, s52, v49
    v_max_u32 v4, v48, v49
    s_nop 1
    v_max_u32_dpp v4, v4, v4 row_shr:1 row_mask:0xf bank_mask:0xf bound_ctrl:0
    s_nop 1
    v_max_u32_dpp v4, v4, v4 row_shr:2 row_mask:0xf bank_mask:0xf bound_ctrl:0
    s_nop 1
    v_max_u32_dpp v4, v4, v4 row_shr:4 row_mask:0xf bank_mask:0xf bound_ctrl:0
    s_nop 1
    v_max_u32_dpp v4, v4, v4 row_shr:8 row_mask:0xf bank_mask:0xf bound_ctrl:0
    s_nop 1
    v_max_u32_dpp v4, v4, v4 row_bcast:15 row_mask:0xa bank_mask:0xf
    s_nop 1
    v_max_u32_dpp v4, v4, v4 row_bcast:31 row_mask:0xc bank_mask:0xf
    s_nop 0
    v_readlane_b32 s52, v4, 63
    s_nop 0
    s_add_u32 s53, s53, s52
    v_writelane_b32 v13, s53, 4
    v_subrev_u32 v48, s52, v48
    v_subrev_u32 v49, s52, v49
    v_max_u32 v4, v48, v49
    s_nop 1
    v_max_u32_dpp v4, v4, v4 row_shr:1 row_mask:0xf bank_mask:0xf bound_ctrl:0
    s_nop 1
    v_max_u32_dpp v4, v4, v4 row_shr:2 row_mask:0xf bank_mask:0xf bound_ctrl:0
    s_nop 1
    v_max_u32_dpp v4, v4, v4 row_shr:4 row_mask:0xf bank_mask:0xf bound_ctrl:0
    s_nop 1
    v_max_u32_dpp v4, v4, v4 row_shr:8 row_mask:0xf bank_mask:0xf bound_ctrl:0
    s_nop 1
    v_max_u32_dpp v4, v4, v4 row_bcast:15 row_mask:0xa bank_mask:0xf
    s_nop 1
    v_max_u32_dpp v4, v4, v4 row_bcast:31 row_mask:0xc bank_mask:0xf
    s_nop 0
    v_readlane_b32 s52, v4, 63
    s_nop 0
    s_add_u32 s53, s53, s52
    v_writelane_b32 v13, s53, 5
    v_subrev_u32 v48, s52, v48
    v_subrev_u32 v49, s52, v49
    v_max_u32 v4, v48, v49
    s_nop 1
    v_max_u32_dpp v4, v4, v4 row_shr:1 row_mask:0xf bank_mask:0xf bound_ctrl:0
    s_nop 1
    v_max_u32_dpp v4, v4, v4 row_shr:2 row_mask:0xf bank_mask:0xf bound_ctrl:0
    s_nop 1
    v_max_u32_dpp v4, v4, v4 row_shr:4 row_mask:0xf bank_mask:0xf bound_ctrl:0
    s_nop 1
    v_max_u32_dpp v4, v4, v4 row_shr:8 row_mask:0xf bank_mask:0xf bound_ctrl:0
    s_nop 1
    v_max_u32_dpp v4, v4, v4 row_bcast:15 row_mask:0xa bank_mask:0xf
    s_nop 1
    v_max_u32_dpp v4, v4, v4 row_bcast:31 row_mask:0xc bank_mask:0xf
    s_nop 0
    v_readlane_b32 s52, v4, 63
    s_nop 0
    s_add_u32 s53, s53, s52
    v_writelane_b32 v13, s53, 6
    v_subrev_u32 v48, s52, v48
    v_subrev_u32 v49, s52, v49
    v_max_u32 v4, v48, v49
    s_nop 1
    v_max_u32_dpp v4, v4, v4 row_shr:1 row_mask:0xf bank_mask:0xf bound_ctrl:0
    s_nop 1
    v_max_u32_dpp v4, v4, v4 row_shr:2 row_mask:0xf bank_mask:0xf bound_ctrl:0
    s_nop 1
    v_max_u32_dpp v4, v4, v4 row_shr:4 row_mask:0xf bank_mask:0xf bound_ctrl:0
    s_nop 1
    v_max_u32_dpp v4, v4, v4 row_shr:8 row_mask:0xf bank_mask:0xf bound_ctrl:0
    s_nop 1
    v_max_u32_dpp v4, v4, v4 row_bcast:15 row_mask:0xa bank_mask:0xf
    s_nop 1
    v_max_u32_dpp v4, v4, v4 row_bcast:31 row_mask:0xc bank_mask:0xf
    s_nop 0
    v_readlane_b32 s52, v4, 63
    s_nop 0
    s_add_u32 s53, s53, s52
    v_writelane_b32 v13, s53, 7
    v_cmp_lt_u32 vcc, s53, v50
    s_cbranch_vccz F_a2k
    s_mov_b32 s53, 0
    s_mov_b32 s52, 0
    s_mov_b32 s64, 0
F_a2f:
    v_subrev_u32 v16, s52, v16
    v_subrev_u32 v17, s52, v17
    v_subrev_u32 v18, s52, v18
    v_subrev_u32 v19, s52, v19
    v_subrev_u32 v20, s52, v20
    v_subrev_u32 v21, s52, v21
    v_subrev_u32 v22, s52, v22
    v_subrev_u32 v23, s52, v23
    v_subrev_u32 v24, s52, v24
    v_subrev_u32 v25, s52, v25
    v_subrev_u32 v26, s52, v26
    v_subrev_u32 v27, s52, v27
    v_subrev_u32 v28, s52, v28
    v_subrev_u32 v29, s52, v29
    v_subrev_u32 v30, s52, v30
    v_subrev_u32 v31, s52, v31
    v_subrev_u32 v32, s52, v32
    v_subrev_u32 v33, s52, v33
    v_subrev_u32 v34, s52, v34
    v_subrev_u32 v35, s52, v35
    v_subrev_u32 v36, s52, v36
    v_subrev_u32 v37, s52, v37
    v_subrev_u32 v38, s52, v38
    v_subrev_u32 v39, s52, v39
    v_subrev_u32 v40, s52, v40
    v_subrev_u32 v41, s52, v41
    v_subrev_u32 v42, s52, v42
    v_subrev_u32 v43, s52, v43
    v_subrev_u32 v44, s52, v44
    v_subrev_u32 v45, s52, v45
    v_subrev_u32 v46, s52, v46
    v_subrev_u32 v47, s52, v47
    v_max3_u32 v4, v16, v17, v18
    v_max3_u32 v12, v19, v20, v21
    v_max3_u32 v4, v4, v22, v23
    v_max3_u32 v12, v12, v24, v25
    v_max3_u32 v4, v4, v26, v27
    v_max3_u32 v12, v12, v28, v29
    v_max3_u32 v4, v4, v30, v31
    v_max3_u32 v12, v12, v32, v33
    v_max3_u32 v4, v4, v34, v35
    v_max3_u32 v12, v12, v36, v37
    v_max3_u32 v4, v4, v38, v39
    v_max3_u32 v12, v12, v40, v41
    v_max3_u32 v4, v4, v42, v43
    v_max3_u32 v12, v12, v44, v45
    v_max3_u32 v4, v4, v46, v47
    v_max_u32 v4, v4, v12
    s_nop 1
    v_max_u32_dpp v4, v4, v4 row_shr:1 row_mask:0xf bank_mask:0xf bound_ctrl:0
    s_nop 1
    v_max_u32_dpp v4, v4, v4 row_shr:2 row_mask:0xf bank_mask:0xf bound_ctrl:0
    s_nop 1
    v_max_u32_dpp v4, v4, v4 row_shr:4 row_mask:0xf bank_mask:0xf bound_ctrl:0
    s_nop 1
    v_max_u32_dpp v4, v4, v4 row_shr:8 row_mask:0xf bank_mask:0xf bound_ctrl:0
    s_nop 1
    v_max_u32_dpp v4, v4, v4 row_bcast:15 row_mask:0xa bank_mask:0xf
    s_nop 1
    v_max_u32_dpp v4, v4, v4 row_bcast:31 row_mask:0xc bank_mask:0xf
    s_nop 0
    v_readlane_b32 s52, v4, 63
    s_nop 0
    s_add_u32 s53, s53, s52
    s_mov_b32 m0, s64
    v_writelane_b32 v13, s53, m0
    s_cmp_ge_u32 s74, 17
    s_cbranch_scc1 DB_117
    s_barrier
    s_add_u32 s74, s74, 1
DB_117:
    s_add_u32 s64, s64, 1
    s_cmp_lt_u32 s64, 8
    s_cbranch_scc1 F_a2f
F_a2k:
    v_and_b32 v4, 7, v0
    v_lshlrev_b32 v4, 2, v4
    ds_bpermute_b32 v12, v4, v13
    v_lshrrev_b32 v9, 3, v0
    v_lshl_add_u32 v4, v9, 9, v4
    s_mov_b32 s44, 32896
    s_mov_b32 s45, 36992
    s_waitcnt lgkmcnt(0)
    v_or_b32 v12, 0x8000, v12
    buffer_store_dword v12, v4, s[40:43], s44 offen sc0 sc1
    buffer_store_dword v12, v4, s[40:43], s45 offen sc0 sc1

F_a2m:
    s_cmp_ge_u32 s74, 17
    s_cbranch_scc1 DB_118
    s_barrier
    s_add_u32 s74, s74, 1
DB_118:
    s_cmp_lt_u32 s74, 17
    s_cbranch_scc1 F_a2m
    s_add_u32 s91, s54, 0
    s_nop 0
    buffer_load_dwordx4 v[72:75], v6, s[16:19], s91 offen nt
    s_add_u32 s91, s54, 7168
    buffer_load_dwordx4 v[76:79], v6, s[16:19], s91 offen nt
    s_add_u32 s91, s54, 14336
    buffer_load_dwordx4 v[80:83], v6, s[16:19], s91 offen nt
    s_add_u32 s91, s54, 21504
    buffer_load_dwordx4 v[84:87], v6, s[16:19], s91 offen nt
    s_add_u32 s91, s54, 28672
    buffer_load_dwordx4 v[88:91], v6, s[16:19], s91 offen nt
    s_add_u32 s91, s54, 35840
    buffer_load_dwordx4 v[92:95], v6, s[16:19], s91 offen nt
    s_add_u32 s91, s54, 43008
    buffer_load_dwordx4 v[96:99], v6, s[16:19], s91 offen nt
    s_add_u32 s91, s54, 50176
    buffer_load_dwordx4 v[100:103], v6, s[16:19], s91 offen nt
    s_add_u32 s91, s54, 229376
    buffer_load_dwordx4 v[104:107], v6, s[16:19], s91 offen nt
    s_add_u32 s91, s54, 236544
    buffer_load_dwordx4 v[108:111], v6, s[16:19], s91 offen nt
    s_add_u32 s91, s54, 243712
    buffer_load_dwordx4 v[112:115], v6, s[16:19], s91 offen nt
    s_add_u32 s91, s54, 250880
    buffer_load_dwordx4 v[116:119], v6, s[16:19], s91 offen nt
    s_add_u32 s91, s54, 258048
    buffer_load_dwordx4 v[120:123], v6, s[16:19], s91 offen nt
    s_add_u32 s91, s54, 265216
    buffer_load_dwordx4 v[124:127], v6, s[16:19], s91 offen nt
    s_add_u32 s91, s54, 272384
    buffer_load_dwordx4 v[128:131], v6, s[16:19], s91 offen nt
    s_add_u32 s91, s54, 279552
    buffer_load_dwordx4 v[132:135], v6, s[16:19], s91 offen nt
    s_branch F_aj2
IW_w10:
    s_branch IW_r10
F_a2n:
    s_barrier
    s_cmp_lg_u32 s53, 0
    s_cbranch_scc1 SW_119
    s_call_b64 s[34:35], F_sw0
SW_119:
    s_branch IW_w11
IW_r11:
    s_barrier
    s_cmp_lg_u32 s53, 1
    s_cbranch_scc1 SW_120
    s_call_b64 s[34:35], F_sw0
SW_120:
    s_nop 0
    s_barrier
    s_cmp_lg_u32 s53, 2
    s_cbranch_scc1 SW_121
    s_call_b64 s[34:35], F_sw0
SW_121:
    s_nop 0
    s_barrier
    s_cmp_lg_u32 s53, 3
    s_cbranch_scc1 SW_122
    s_call_b64 s[34:35], F_sw0
SW_122:
    s_nop 0
    s_barrier
    s_nop 0
    s_barrier
    s_nop 0
    s_barrier
    s_nop 0
    s_add_u32 s91, s54, 229376
    buffer_load_dwordx4 v[104:107], v6, s[16:19], s91 offen nt
    s_add_u32 s91, s54, 236544
    buffer_load_dwordx4 v[108:111], v6, s[16:19], s91 offen nt
    s_add_u32 s91, s54, 243712
    buffer_load_dwordx4 v[112:115], v6, s[16:19], s91 offen nt
    s_add_u32 s91, s54, 250880
    buffer_load_dwordx4 v[116:119], v6, s[16:19], s91 offen nt
    s_nop 0
    s_load_dwordx8 s[60:67], s[56:57], 128 glc
    s_barrier
    s_add_u32 s91, s54, 258048
    buffer_load_dwordx4 v[120:123], v6, s[16:19], s91 offen nt
    s_add_u32 s91, s54, 265216
    buffer_load_dwordx4 v[124:127], v6, s[16:19], s91 offen nt
    s_add_u32 s91, s54, 272384
    buffer_load_dwordx4 v[128:131], v6, s[16:19], s91 offen nt
    s_add_u32 s91, s54, 279552
    buffer_load_dwordx4 v[132:135], v6, s[16:19], s91 offen nt
    s_waitcnt lgkmcnt(0)
    s_and_b64 s[44:45], s[60:61], s[62:63]
    s_and_b64 s[44:45], s[44:45], s[64:65]
    s_and_b64 s[44:45], s[44:45], s[66:67]
    s_and_b32 s44, s44, s45
    s_bitcmp1_b32 s44, 15
    s_cbranch_scc0 F_a2q
    s_nop 0
    s_andn2_b32 s60, s60, 0x8000
    v_writelane_b32 v12, s60, 0
    s_andn2_b32 s61, s61, 0x8000
    v_writelane_b32 v12, s61, 1
    s_andn2_b32 s62, s62, 0x8000
    v_writelane_b32 v12, s62, 2
    s_andn2_b32 s63, s63, 0x8000
    v_writelane_b32 v12, s63, 3
    s_andn2_b32 s64, s64, 0x8000
    v_writelane_b32 v12, s64, 4
    s_andn2_b32 s65, s65, 0x8000
    v_writelane_b32 v12, s65, 5
    s_andn2_b32 s66, s66, 0x8000
    v_writelane_b32 v12, s66, 6
    s_andn2_b32 s67, s67, 0x8000
    v_writelane_b32 v12, s67, 7
    v_add_u32 v4, 158976, v3
    s_mov_b64 exec, 0xff
    ds_write_b32 v4, v12
    s_mov_b64 exec, -1
    v_mov_b32 v4, 1
    s_mov_b64 exec, 1
    ds_write_b32 v10, v4 offset:48
    s_mov_b64 exec, -1
    s_waitcnt lgkmcnt(0)
    s_mov_b32 s88, 1
F_a2q:
    s_barrier
F_aj:
    s_mov_b32 s74, 0
F_aj2:
    v_and_b32 v13, 3, v0
    v_lshlrev_b32 v13, 2, v13
    v_add_u32 v13, 159040, v13

    s_cmp_lt_u32 s3, 2
    s_mov_b32 s75, 57344
    s_cselect_b32 s75, 49152, s75
    s_and_b32 s44, s3, 1
    s_lshl_b32 s44, s44, 12
    s_add_u32 s75, s75, s44
    s_add_u32 s12, s72, 0x900000
    s_addc_u32 s13, s73, 0
    s_mov_b32 s14, 0xe0000
    s_mov_b32 s15, 0x00020000
    s_mov_b32 s47, s10
    v_mov_b32 v4, 159096
    ds_read_b32 v9, v4
    s_waitcnt lgkmcnt(0)
    v_readfirstlane_b32 s79, v9
    s_nop 0
    s_cmp_eq_u32 s79, 0
    s_cbranch_scc1 F_xe
    v_and_b32 v4, 7, v0
    v_lshlrev_b32 v4, 2, v4
    v_add_u32 v4, 158976, v4
    ds_read_b32 v4, v4
    s_waitcnt lgkmcnt(0)
    v_and_b32 v4, 0x7ff, v4
    v_sub_u32 v4, 2047, v4
    v_and_b32 v11, 7, v4
    v_lshrrev_b32 v9, 3, v4
    v_lshlrev_b32 v9, 7, v9
    v_lshl_add_u32 v9, v11, 3, v9
    v_lshlrev_b32 v4, 11, v4
    v_lshl_add_u32 v4, v5, 4, v4
    buffer_load_dwordx4 v[64:67], v4, s[20:23], s55 offen
    buffer_load_dwordx4 v[68:71], v4, s[20:23], s55 offen offset:64
    buffer_load_dwordx2 v[14:15], v9, s[40:43], 0 offen sc0 sc1

F_xe:
    s_cmp_lg_u32 s74, 0
    s_cbranch_scc1 JB_123
    s_barrier
JB_123:
    s_setprio 1
    s_cmp_lg_u32 s79, 0
    s_cbranch_scc1 F_xd
    s_cmp_lg_u32 s88, 2
    s_cbranch_scc1 F_se
F_sc:
    s_load_dwordx8 s[60:67], s[56:57], 128 glc
    s_waitcnt lgkmcnt(0)
    s_and_b64 s[44:45], s[60:61], s[62:63]
    s_and_b64 s[44:45], s[44:45], s[64:65]
    s_and_b64 s[44:45], s[44:45], s[66:67]
    s_and_b32 s44, s44, s45
    s_bitcmp1_b32 s44, 15
    s_cbranch_scc1 F_sd
    s_sleep 4
    s_branch F_sc
F_sd:
    s_nop 0
    s_andn2_b32 s60, s60, 0x8000
    v_writelane_b32 v12, s60, 0
    s_andn2_b32 s61, s61, 0x8000
    v_writelane_b32 v12, s61, 1
    s_andn2_b32 s62, s62, 0x8000
    v_writelane_b32 v12, s62, 2
    s_andn2_b32 s63, s63, 0x8000
    v_writelane_b32 v12, s63, 3
    s_andn2_b32 s64, s64, 0x8000
    v_writelane_b32 v12, s64, 4
    s_andn2_b32 s65, s65, 0x8000
    v_writelane_b32 v12, s65, 5
    s_andn2_b32 s66, s66, 0x8000
    v_writelane_b32 v12, s66, 6
    s_andn2_b32 s67, s67, 0x8000
    v_writelane_b32 v12, s67, 7
    v_add_u32 v4, 158976, v3
    s_mov_b64 exec, 0xff
    ds_write_b32 v4, v12
    s_mov_b64 exec, -1
    v_mov_b32 v4, 1
    s_mov_b64 exec, 1
    ds_write_b32 v10, v4 offset:48
    s_mov_b64 exec, -1
F_se:
    v_mov_b32 v4, 159096
    ds_read_b32 v9, v4 offset:0
FW_124:
    s_waitcnt lgkmcnt(0)
    v_cmp_gt_u32 vcc, 1, v9
    s_cbranch_vccz FO_125
    s_sleep 1
    ds_read_b32 v9, v4 offset:0
    s_branch FW_124
FO_125:
    v_and_b32 v4, 7, v0
    v_lshlrev_b32 v4, 2, v4
    v_add_u32 v4, 158976, v4
    ds_read_b32 v4, v4
    s_waitcnt lgkmcnt(0)
    v_and_b32 v4, 0x7ff, v4
    v_sub_u32 v4, 2047, v4
    v_and_b32 v11, 7, v4
    v_lshrrev_b32 v9, 3, v4
    v_lshlrev_b32 v9, 7, v9
    v_lshl_add_u32 v9, v11, 3, v9
    v_lshlrev_b32 v4, 11, v4
    v_lshl_add_u32 v4, v5, 4, v4
    buffer_load_dwordx4 v[64:67], v4, s[20:23], s55 offen
    buffer_load_dwordx4 v[68:71], v4, s[20:23], s55 offen offset:64
    buffer_load_dwordx2 v[14:15], v9, s[40:43], 0 offen sc0 sc1

F_xd:
    s_mov_b32 s52, 0x05040100
    s_mov_b32 s53, 0x07060302
    s_setprio 1
    s_cmp_ge_u32 s89, 224
    s_cbranch_scc1 F_adown
    s_waitcnt vmcnt(0)
    v_lshlrev_b32 v34, 16, v64
    v_and_b32 v35, 0xffff0000, v64
    v_lshlrev_b32 v36, 16, v65
    v_and_b32 v37, 0xffff0000, v65
    v_lshlrev_b32 v38, 16, v66
    v_and_b32 v39, 0xffff0000, v66
    v_lshlrev_b32 v40, 16, v67
    v_and_b32 v41, 0xffff0000, v67
    v_lshlrev_b32 v42, 16, v68
    v_and_b32 v43, 0xffff0000, v68
    v_lshlrev_b32 v44, 16, v69
    v_and_b32 v45, 0xffff0000, v69
    v_lshlrev_b32 v46, 16, v70
    v_and_b32 v47, 0xffff0000, v70
    v_lshlrev_b32 v48, 16, v71
    v_and_b32 v49, 0xffff0000, v71
    v_add_f32 v34, v34, v14
    v_add_f32 v35, v35, v14
    v_add_f32 v36, v36, v14
    v_add_f32 v37, v37, v14
    v_add_f32 v38, v38, v14
    v_add_f32 v39, v39, v14
    v_add_f32 v40, v40, v14
    v_add_f32 v41, v41, v14
    v_add_f32 v42, v42, v14
    v_add_f32 v43, v43, v14
    v_add_f32 v44, v44, v14
    v_add_f32 v45, v45, v14
    v_add_f32 v46, v46, v14
    v_add_f32 v47, v47, v14
    v_add_f32 v48, v48, v14
    v_add_f32_e64 v49, v49, v14
    v_cvt_pk_bf16_f32 v64, v34, v35
    v_cvt_pk_bf16_f32 v65, v36, v37
    v_cvt_pk_bf16_f32 v66, v38, v39
    v_cvt_pk_bf16_f32 v67, v40, v41
    v_cvt_pk_bf16_f32 v68, v42, v43
    v_cvt_pk_bf16_f32 v69, v44, v45
    v_cvt_pk_bf16_f32 v70, v46, v47
    v_cvt_pk_bf16_f32 v71, v48, v49
    v_lshlrev_b32 v34, 16, v64
    v_and_b32 v35, 0xffff0000, v64
    v_lshlrev_b32 v36, 16, v65
    v_and_b32 v37, 0xffff0000, v65
    v_lshlrev_b32 v38, 16, v66
    v_and_b32 v39, 0xffff0000, v66
    v_lshlrev_b32 v40, 16, v67
    v_and_b32 v41, 0xffff0000, v67
    v_lshlrev_b32 v42, 16, v68
    v_and_b32 v43, 0xffff0000, v68
    v_lshlrev_b32 v44, 16, v69
    v_and_b32 v45, 0xffff0000, v69
    v_lshlrev_b32 v46, 16, v70
    v_and_b32 v47, 0xffff0000, v70
    v_lshlrev_b32 v48, 16, v71
    v_and_b32 v49, 0xffff0000, v71
    v_mul_f32 v34, v34, v15
    v_mul_f32 v35, v35, v15
    v_mul_f32 v36, v36, v15
    v_mul_f32 v37, v37, v15
    v_mul_f32 v38, v38, v15
    v_mul_f32 v39, v39, v15
    v_mul_f32 v40, v40, v15
    v_mul_f32 v41, v41, v15
    v_mul_f32 v42, v42, v15
    v_mul_f32 v43, v43, v15
    v_mul_f32 v44, v44, v15
    v_mul_f32 v45, v45, v15
    v_mul_f32 v46, v46, v15
    v_mul_f32 v47, v47, v15
    v_mul_f32 v48, v48, v15
    v_mul_f32 v49, v49, v15
    v_cvt_pk_bf16_f32 v64, v34, v35
    v_cvt_pk_bf16_f32 v65, v36, v37
    v_cvt_pk_bf16_f32 v66, v38, v39
    v_cvt_pk_bf16_f32 v67, v40, v41
    v_cvt_pk_bf16_f32 v68, v42, v43
    v_cvt_pk_bf16_f32 v69, v44, v45
    v_cvt_pk_bf16_f32 v70, v46, v47
    v_cvt_pk_bf16_f32 v71, v48, v49
    s_waitcnt vmcnt(0)
    v_perm_b32 v136, v76, v72, s52
    v_perm_b32 v137, v84, v80, s52
    v_perm_b32 v138, v92, v88, s52
    v_perm_b32 v139, v100, v96, s52
    s_nop 1
    v_mfma_f32_16x16x32_bf16 v[32:35], v[64:67], v[136:139], 0
    v_perm_b32 v140, v76, v72, s53
    v_perm_b32 v141, v84, v80, s53
    v_perm_b32 v142, v92, v88, s53
    v_perm_b32 v143, v100, v96, s53
    s_nop 1
    v_mfma_f32_16x16x32_bf16 v[36:39], v[64:67], v[140:143], 0
    v_perm_b32 v136, v77, v73, s52
    v_perm_b32 v137, v85, v81, s52
    v_perm_b32 v138, v93, v89, s52
    v_perm_b32 v139, v101, v97, s52
    s_nop 1
    v_mfma_f32_16x16x32_bf16 v[40:43], v[64:67], v[136:139], 0
    v_perm_b32 v140, v77, v73, s53
    v_perm_b32 v141, v85, v81, s53
    v_perm_b32 v142, v93, v89, s53
    v_perm_b32 v143, v101, v97, s53
    s_nop 1
    v_mfma_f32_16x16x32_bf16 v[44:47], v[64:67], v[140:143], 0
    v_perm_b32 v136, v78, v74, s52
    v_perm_b32 v137, v86, v82, s52
    v_perm_b32 v138, v94, v90, s52
    v_perm_b32 v139, v102, v98, s52
    s_nop 1
    v_mfma_f32_16x16x32_bf16 v[48:51], v[64:67], v[136:139], 0
    v_perm_b32 v140, v78, v74, s53
    v_perm_b32 v141, v86, v82, s53
    v_perm_b32 v142, v94, v90, s53
    v_perm_b32 v143, v102, v98, s53
    s_nop 1
    v_mfma_f32_16x16x32_bf16 v[52:55], v[64:67], v[140:143], 0
    v_perm_b32 v136, v79, v75, s52
    v_perm_b32 v137, v87, v83, s52
    v_perm_b32 v138, v95, v91, s52
    v_perm_b32 v139, v103, v99, s52
    s_nop 1
    v_mfma_f32_16x16x32_bf16 v[56:59], v[64:67], v[136:139], 0
    v_perm_b32 v140, v79, v75, s53
    v_perm_b32 v141, v87, v83, s53
    v_perm_b32 v142, v95, v91, s53
    v_perm_b32 v143, v103, v99, s53
    s_nop 1
    v_mfma_f32_16x16x32_bf16 v[60:63], v[64:67], v[140:143], 0
    s_waitcnt vmcnt(0)
    v_perm_b32 v136, v108, v104, s52
    v_perm_b32 v137, v116, v112, s52
    v_perm_b32 v138, v124, v120, s52
    v_perm_b32 v139, v132, v128, s52
    s_nop 1
    v_mfma_f32_16x16x32_bf16 v[32:35], v[68:71], v[136:139], v[32:35]
    v_perm_b32 v140, v108, v104, s53
    v_perm_b32 v141, v116, v112, s53
    v_perm_b32 v142, v124, v120, s53
    v_perm_b32 v143, v132, v128, s53
    s_nop 1
    v_mfma_f32_16x16x32_bf16 v[36:39], v[68:71], v[140:143], v[36:39]
    v_perm_b32 v136, v109, v105, s52
    v_perm_b32 v137, v117, v113, s52
    v_perm_b32 v138, v125, v121, s52
    v_perm_b32 v139, v133, v129, s52
    s_nop 1
    v_mfma_f32_16x16x32_bf16 v[40:43], v[68:71], v[136:139], v[40:43]
    v_perm_b32 v140, v109, v105, s53
    v_perm_b32 v141, v117, v113, s53
    v_perm_b32 v142, v125, v121, s53
    v_perm_b32 v143, v133, v129, s53
    s_nop 1
    v_mfma_f32_16x16x32_bf16 v[44:47], v[68:71], v[140:143], v[44:47]
    v_perm_b32 v136, v110, v106, s52
    v_perm_b32 v137, v118, v114, s52
    v_perm_b32 v138, v126, v122, s52
    v_perm_b32 v139, v134, v130, s52
    s_nop 1
    v_mfma_f32_16x16x32_bf16 v[48:51], v[68:71], v[136:139], v[48:51]
    v_perm_b32 v140, v110, v106, s53
    v_perm_b32 v141, v118, v114, s53
    v_perm_b32 v142, v126, v122, s53
    v_perm_b32 v143, v134, v130, s53
    s_nop 1
    v_mfma_f32_16x16x32_bf16 v[52:55], v[68:71], v[140:143], v[52:55]
    v_perm_b32 v136, v111, v107, s52
    v_perm_b32 v137, v119, v115, s52
    v_perm_b32 v138, v127, v123, s52
    v_perm_b32 v139, v135, v131, s52
    s_nop 1
    v_mfma_f32_16x16x32_bf16 v[56:59], v[68:71], v[136:139], v[56:59]
    v_perm_b32 v140, v111, v107, s53
    v_perm_b32 v141, v119, v115, s53
    v_perm_b32 v142, v127, v123, s53
    v_perm_b32 v143, v135, v131, s53
    s_nop 1
    v_mfma_f32_16x16x32_bf16 v[60:63], v[68:71], v[140:143], v[60:63]
    s_setprio 3
    s_and_b32 s44, s3, 1
    s_lshl_b32 s44, s44, 12
    s_add_u32 s44, s44, 65536
    v_xor_b32 v4, v7, v5
    v_lshlrev_b32 v4, 4, v4
    v_lshl_add_u32 v4, v5, 8, v4
    v_add_u32 v72, s44, v4
    v_add_u32 v8, 8, v10

    v_xor_b32 v73, 32, v72
    v_xor_b32 v74, 64, v72
    v_xor_b32 v75, 96, v72
    v_xor_b32 v76, 128, v72
    v_xor_b32 v77, 160, v72
    v_xor_b32 v78, 192, v72
    v_xor_b32 v79, 224, v72
    ds_read_b32 v12, v13 offset:32
FW_126:
    s_waitcnt lgkmcnt(0)
    v_cmp_gt_u32 vcc, 2, v12
    s_cbranch_vccz FO_127
    s_sleep 1
    ds_read_b32 v12, v13 offset:32
    s_branch FW_126
FO_127:
    s_add_u32 s45, s78, 0
    s_nop 0
    buffer_load_dwordx4 v[16:19], v160, s[80:83], s45 offen nt
    s_add_u32 s45, s78, 2048
    buffer_load_dwordx4 v[20:23], v160, s[80:83], s45 offen nt
    s_add_u32 s45, s78, 4096
    buffer_load_dwordx4 v[24:27], v160, s[80:83], s45 offen nt
    s_add_u32 s45, s78, 6144
    buffer_load_dwordx4 v[28:31], v160, s[80:83], s45 offen nt
    s_add_u32 s45, s78, 8192
    buffer_load_dwordx4 v[144:147], v160, s[80:83], s45 offen nt
    s_add_u32 s45, s78, 10240
    buffer_load_dwordx4 v[148:151], v160, s[80:83], s45 offen nt
    s_add_u32 s45, s78, 12288
    buffer_load_dwordx4 v[152:155], v160, s[80:83], s45 offen nt
    s_cmp_lt_u32 s3, 2
    s_cbranch_scc1 F_t1
    ds_read_b32 v12, v13 offset:32
FW_128:
    s_waitcnt lgkmcnt(0)
    v_cmp_gt_u32 vcc, 2, v12
    s_cbranch_vccz FO_129
    s_sleep 1
    ds_read_b32 v12, v13 offset:32
    s_branch FW_128
FO_129:
    s_branch F_t2
F_t1:
    ds_read_b32 v12, v8 offset:64
FW_130:
    s_waitcnt lgkmcnt(0)
    v_cmp_gt_u32 vcc, 1, v12
    s_cbranch_vccz FO_131
    s_sleep 1
    ds_read_b32 v12, v8 offset:64
    s_branch FW_130
FO_131:
    s_nop 0
    ds_read_b128 v[80:83], v72 offset:0
    ds_read_b128 v[84:87], v73 offset:512
    ds_read_b128 v[88:91], v74 offset:1024
    ds_read_b128 v[92:95], v75 offset:1536
    ds_read_b128 v[96:99], v76 offset:2048
    ds_read_b128 v[100:103], v77 offset:2560
    ds_read_b128 v[104:107], v78 offset:3072
    ds_read_b128 v[108:111], v79 offset:3584
    s_waitcnt lgkmcnt(7)
    v_add_f32 v32, v32, v80
    v_add_f32 v33, v33, v81
    v_add_f32 v34, v34, v82
    v_add_f32 v35, v35, v83
    s_waitcnt lgkmcnt(6)
    v_add_f32 v36, v36, v84
    v_add_f32 v37, v37, v85
    v_add_f32 v38, v38, v86
    v_add_f32 v39, v39, v87
    s_waitcnt lgkmcnt(5)
    v_add_f32 v40, v40, v88
    v_add_f32 v41, v41, v89
    v_add_f32 v42, v42, v90
    v_add_f32 v43, v43, v91
    s_waitcnt lgkmcnt(4)
    v_add_f32 v44, v44, v92
    v_add_f32 v45, v45, v93
    v_add_f32 v46, v46, v94
    v_add_f32 v47, v47, v95
    s_waitcnt lgkmcnt(3)
    v_add_f32 v48, v48, v96
    v_add_f32 v49, v49, v97
    v_add_f32 v50, v50, v98
    v_add_f32 v51, v51, v99
    s_waitcnt lgkmcnt(2)
    v_add_f32 v52, v52, v100
    v_add_f32 v53, v53, v101
    v_add_f32 v54, v54, v102
    v_add_f32 v55, v55, v103
    s_waitcnt lgkmcnt(1)
    v_add_f32 v56, v56, v104
    v_add_f32 v57, v57, v105
    v_add_f32 v58, v58, v106
    v_add_f32 v59, v59, v107
    s_branch IW_s11
IW_w11:
    s_branch IW_r11
IW_s11:
    s_waitcnt lgkmcnt(0)
    v_add_f32 v60, v60, v108
    v_add_f32 v61, v61, v109
    v_add_f32 v62, v62, v110
    v_add_f32 v63, v63, v111
F_t2:
    s_mov_b32 exec_hi, 0
    s_nop 0
    ds_write_b128 v72, v[32:35] offset:0
    ds_write_b128 v73, v[36:39] offset:512
    ds_write_b128 v74, v[40:43] offset:1024
    ds_write_b128 v75, v[44:47] offset:1536
    ds_write_b128 v76, v[48:51] offset:2048
    ds_write_b128 v77, v[52:55] offset:2560
    ds_write_b128 v78, v[56:59] offset:3072
    ds_write_b128 v79, v[60:63] offset:3584
    s_mov_b64 exec, -1
    v_mov_b32 v4, 1
    s_mov_b64 exec, 1
    ds_write_b32 v10, v4 offset:64
    s_mov_b64 exec, -1
    s_lshl_b32 s44, s3, 2
    v_add_u32 v4, s44, v5
    v_xor_b32 v4, v4, v7
    v_lshlrev_b32 v4, 4, v4
    v_lshl_add_u32 v4, v7, 8, v4
    v_add_u32 v4, 65536, v4
    s_lshl_b32 s44, s3, 10
    s_lshl_b32 s77, s36, 1
    s_add_u32 s77, s77, s37
    s_mul_i32 s77, s77, 114688
    s_lshl_b32 s46, s38, 12
    s_add_u32 s77, s77, s46
    s_add_u32 s77, s77, s44
    s_lshl_b32 s46, s38, 9
    v_mov_b32 v9, 159148
    v_mov_b32 v11, 1

    s_add_u32 s56, s46, 0x829000
    s_add_u32 s56, s72, s56
    s_addc_u32 s57, s73, 0
    ds_read_b32 v12, v13 offset:64
FW_132:
    s_waitcnt lgkmcnt(0)
    v_cmp_gt_u32 vcc, 1, v12
    s_cbranch_vccz FO_133
    ds_read_b32 v12, v13 offset:64
    s_branch FW_132
FO_133:
    ds_read_b128 v[72:75], v4
    ds_read_b128 v[76:79], v4 offset:4096
    s_waitcnt lgkmcnt(0)
    v_add_f32 v72, v72, v76
    v_add_f32 v73, v73, v77
    v_add_f32 v74, v74, v78
    v_add_f32 v75, v75, v79
    buffer_store_dwordx4 v[72:75], v2, s[12:15], s77 offen sc0 sc1
    v_mov_b32 v4, 2
    s_mov_b64 exec, 1
    ds_write_b32 v10, v4 offset:64
    s_mov_b64 exec, -1
    s_waitcnt vmcnt(0)
    s_mov_b64 exec, 1
    ds_add_rtn_u32 v9, v9, v11
    s_waitcnt lgkmcnt(0)
    v_readfirstlane_b32 s44, v9
    s_mov_b64 exec, -1
    s_cmp_lg_u32 s44, 3
    s_cbranch_scc1 F_ad2

    s_mov_b32 s44, 1
    s_atomic_add s44, s[56:57], 0x0
    s_atomic_add s44, s[56:57], 0x80
    s_atomic_add s44, s[56:57], 0x100
    s_atomic_add s44, s[56:57], 0x180
    s_branch F_ad2
F_adown:
    s_add_u32 s45, s78, 0
    buffer_load_dwordx4 v[16:19], v160, s[80:83], s45 offen nt
    s_add_u32 s45, s78, 2048
    buffer_load_dwordx4 v[20:23], v160, s[80:83], s45 offen nt
    s_add_u32 s45, s78, 4096
    buffer_load_dwordx4 v[24:27], v160, s[80:83], s45 offen nt
    s_add_u32 s45, s78, 6144
    buffer_load_dwordx4 v[28:31], v160, s[80:83], s45 offen nt
    s_add_u32 s45, s78, 8192
    buffer_load_dwordx4 v[144:147], v160, s[80:83], s45 offen nt
    s_add_u32 s45, s78, 10240
    buffer_load_dwordx4 v[148:151], v160, s[80:83], s45 offen nt
    s_add_u32 s45, s78, 12288
    buffer_load_dwordx4 v[152:155], v160, s[80:83], s45 offen nt
    v_mov_b32 v4, 2
    s_mov_b64 exec, 1
    ds_write_b32 v10, v4 offset:64
    s_mov_b64 exec, -1
F_ad2:
    s_setprio 3
    v_min_u32 v4, 55, v0
    v_lshlrev_b32 v4, 4, v4
    s_lshl_b32 s38, s47, 5
    s_and_b32 s46, s39, 3
    s_lshr_b32 s44, s47, 7
    s_lshl_b32 s44, s44, 2
    s_add_u32 s44, s44, s46
    s_lshl_b32 s44, s44, 7
    s_add_u32 s45, s47, 111
    s_lshr_b32 s45, s45, 7
    s_lshl_b32 s45, s45, 2
    s_add_u32 s45, s45, s46
    s_lshl_b32 s45, s45, 7
    s_waitcnt lgkmcnt(0)

    s_add_u32 s56, s44, 0x829000
    s_add_u32 s56, s72, s56
    s_addc_u32 s57, s73, 0
    s_add_u32 s58, s45, 0x829000
    s_add_u32 s58, s72, s58
    s_addc_u32 s59, s73, 0
    v_mov_b32 v156, 0
    v_mov_b32 v157, 0
    v_mov_b32 v158, 0
    v_mov_b32 v159, 0
    s_mov_b32 s48, 0xbfb8aa3b
    ds_read_b32 v12, v13 offset:0
FW_134:
    s_waitcnt lgkmcnt(0)
    v_cmp_gt_u32 vcc, 5, v12
    s_cbranch_vccz FO_135
    s_sleep 1
    ds_read_b32 v12, v13 offset:0
    s_branch FW_134
FO_135:
    s_mov_b32 s44, s75
    v_lshlrev_b32 v9, 3, v0
    v_add_u32 v9, s44, v9
    ds_write_b64 v9, v[156:157]
    v_lshrrev_b32 v11, 1, v0
    v_mul_u32_u24 v9, 37, v11
    v_lshrrev_b32 v9, 8, v9
    v_add_u32 v11, v11, v9
    v_lshlrev_b32 v11, 1, v11
    v_and_b32 v9, 1, v0
    v_lshl_add_u32 v11, v9, 8, v11
    v_add_u32 v11, s44, v11
    v_and_b32 v9, 7, v0
    v_lshlrev_b32 v9, 6, v9
    v_lshl_add_u32 v9, v5, 4, v9
    v_add_u32 v9, s44, v9

    s_cmp_lg_u32 s3, 0
    s_cbranch_scc1 F_pp
SP_136:
    s_load_dword s76, s[56:57], 0 glc
    s_waitcnt lgkmcnt(0)
    s_cmp_ge_u32 s76, 8
    s_cbranch_scc1 SD_137
    s_sleep 2
    s_branch SP_136
SD_137:
SP_138:
    s_load_dword s76, s[58:59], 0 glc
    s_waitcnt lgkmcnt(0)
    s_cmp_ge_u32 s76, 8
    s_cbranch_scc1 SD_139
    s_sleep 2
    s_branch SP_138
SD_139:
    v_mov_b32 v12, 3
    s_mov_b64 exec, 1
    ds_write_b32 v10, v12 offset:64
    s_mov_b64 exec, -1
F_pp:
    v_mov_b32 v8, 159104
    ds_read_b32 v12, v8 offset:0
FW_140:
    s_waitcnt lgkmcnt(0)
    v_cmp_gt_u32 vcc, 3, v12
    s_cbranch_vccz FO_141
    s_sleep 1
    ds_read_b32 v12, v8 offset:0
    s_branch FW_140
FO_141:
    s_add_u32 s45, s38, 0
    buffer_load_dwordx4 v[32:35], v4, s[12:15], s45 offen sc0 sc1
    s_add_u32 s45, s38, 114688
    buffer_load_dwordx4 v[36:39], v4, s[12:15], s45 offen sc0 sc1
    s_add_u32 s45, s38, 229376
    buffer_load_dwordx4 v[40:43], v4, s[12:15], s45 offen sc0 sc1
    s_add_u32 s45, s38, 344064
    buffer_load_dwordx4 v[44:47], v4, s[12:15], s45 offen sc0 sc1
    s_add_u32 s45, s38, 458752
    buffer_load_dwordx4 v[48:51], v4, s[12:15], s45 offen sc0 sc1
    s_add_u32 s45, s38, 573440
    buffer_load_dwordx4 v[52:55], v4, s[12:15], s45 offen sc0 sc1
    s_add_u32 s45, s38, 688128
    buffer_load_dwordx4 v[56:59], v4, s[12:15], s45 offen sc0 sc1
    s_add_u32 s45, s38, 802816
    buffer_load_dwordx4 v[60:63], v4, s[12:15], s45 offen sc0 sc1
    s_waitcnt vmcnt(0)
    v_add_f32 v32, v32, v40
    v_add_f32 v48, v48, v56
    v_add_f32 v33, v33, v41
    v_add_f32 v49, v49, v57
    v_add_f32 v34, v34, v42
    v_add_f32 v50, v50, v58
    v_add_f32 v35, v35, v43
    v_add_f32 v51, v51, v59
    v_add_f32 v32, v32, v48
    v_add_f32 v33, v33, v49
    v_add_f32 v34, v34, v50
    v_add_f32 v35, v35, v51
    v_add_f32 v36, v36, v44
    v_add_f32 v52, v52, v60
    v_add_f32 v37, v37, v45
    v_add_f32 v53, v53, v61
    v_add_f32 v38, v38, v46
    v_add_f32 v54, v54, v62
    v_add_f32 v39, v39, v47
    v_add_f32 v55, v55, v63
    v_add_f32 v36, v36, v52
    v_add_f32 v37, v37, v53
    v_add_f32 v38, v38, v54
    v_add_f32 v39, v39, v55
    v_cvt_pk_bf16_f32 v40, v32, v36
    v_cvt_pk_bf16_f32 v41, v33, v37
    v_cvt_pk_bf16_f32 v42, v34, v38
    v_cvt_pk_bf16_f32 v43, v35, v39
    v_lshlrev_b32 v32, 16, v40
    v_and_b32 v36, 0xffff0000, v40
    v_lshlrev_b32 v33, 16, v41
    v_and_b32 v37, 0xffff0000, v41
    v_lshlrev_b32 v34, 16, v42
    v_and_b32 v38, 0xffff0000, v42
    v_lshlrev_b32 v35, 16, v43
    v_and_b32 v39, 0xffff0000, v43
    v_mul_f32 v40, s48, v32
    v_mul_f32 v41, s48, v33
    v_mul_f32 v42, s48, v34
    v_mul_f32 v43, s48, v35
    v_exp_f32 v40, v40
    v_exp_f32 v41, v41
    v_exp_f32 v42, v42
    v_exp_f32 v43, v43
    v_add_f32 v40, 1.0, v40
    v_add_f32 v41, 1.0, v41
    v_add_f32 v42, 1.0, v42
    v_add_f32 v43, 1.0, v43
    v_rcp_f32 v40, v40
    v_rcp_f32 v41, v41
    v_rcp_f32 v42, v42
    v_rcp_f32 v43, v43
    v_mul_f32 v32, v32, v40
    v_mul_f32 v33, v33, v41
    v_mul_f32 v34, v34, v42
    v_mul_f32 v35, v35, v43
    v_cvt_pk_bf16_f32 v32, v32, v32
    v_cvt_pk_bf16_f32 v33, v33, v33
    v_cvt_pk_bf16_f32 v34, v34, v34
    v_cvt_pk_bf16_f32 v35, v35, v35
    v_lshlrev_b32 v32, 16, v32
    v_lshlrev_b32 v33, 16, v33
    v_lshlrev_b32 v34, 16, v34
    v_lshlrev_b32 v35, 16, v35
    v_mul_f32 v32, v32, v36
    v_mul_f32 v33, v33, v37
    v_mul_f32 v34, v34, v38
    v_mul_f32 v35, v35, v39
    v_cvt_pk_bf16_f32 v32, v32, v32
    v_cvt_pk_bf16_f32 v33, v33, v33
    v_cvt_pk_bf16_f32 v34, v34, v34
    v_cvt_pk_bf16_f32 v35, v35, v35
    v_cmp_gt_u32 vcc, 56, v0
    s_nop 0
    s_and_saveexec_b64 s[44:45], vcc
    ds_write_b16 v11, v32 offset:0
    ds_write_b16 v11, v33 offset:64
    ds_write_b16 v11, v34 offset:128
    ds_write_b16 v11, v35 offset:192
    s_mov_b64 exec, s[44:45]
    ds_read_b128 v[64:67], v9
    s_waitcnt lgkmcnt(0)
    v_perm_b32 v136, v20, v16, s52
    v_perm_b32 v137, v28, v24, s52
    v_perm_b32 v138, v148, v144, s52
    v_perm_b32 v139, v156, v152, s52
    s_nop 1
    v_mfma_f32_16x16x32_bf16 v[104:107], v[64:67], v[136:139], 0
    v_perm_b32 v140, v20, v16, s53
    v_perm_b32 v141, v28, v24, s53
    v_perm_b32 v142, v148, v144, s53
    v_perm_b32 v143, v156, v152, s53
    s_nop 1
    v_mfma_f32_16x16x32_bf16 v[108:111], v[64:67], v[140:143], 0
    v_perm_b32 v136, v21, v17, s52
    v_perm_b32 v137, v29, v25, s52
    v_perm_b32 v138, v149, v145, s52
    v_perm_b32 v139, v157, v153, s52
    s_nop 1
    v_mfma_f32_16x16x32_bf16 v[112:115], v[64:67], v[136:139], 0
    v_perm_b32 v140, v21, v17, s53
    v_perm_b32 v141, v29, v25, s53
    v_perm_b32 v142, v149, v145, s53
    v_perm_b32 v143, v157, v153, s53
    s_nop 1
    v_mfma_f32_16x16x32_bf16 v[116:119], v[64:67], v[140:143], 0
    v_perm_b32 v136, v22, v18, s52
    v_perm_b32 v137, v30, v26, s52
    v_perm_b32 v138, v150, v146, s52
    v_perm_b32 v139, v158, v154, s52
    s_nop 1
    v_mfma_f32_16x16x32_bf16 v[120:123], v[64:67], v[136:139], 0
    v_perm_b32 v140, v22, v18, s53
    v_perm_b32 v141, v30, v26, s53
    v_perm_b32 v142, v150, v146, s53
    v_perm_b32 v143, v158, v154, s53
    s_nop 1
    v_mfma_f32_16x16x32_bf16 v[124:127], v[64:67], v[140:143], 0
    v_perm_b32 v136, v23, v19, s52
    v_perm_b32 v137, v31, v27, s52
    v_perm_b32 v138, v151, v147, s52
    v_perm_b32 v139, v159, v155, s52
    s_nop 1
    v_mfma_f32_16x16x32_bf16 v[128:131], v[64:67], v[136:139], 0
    v_perm_b32 v140, v23, v19, s53
    v_perm_b32 v141, v31, v27, s53
    v_perm_b32 v142, v151, v147, s53
    v_perm_b32 v143, v159, v155, s53
    s_nop 1
    v_mfma_f32_16x16x32_bf16 v[132:135], v[64:67], v[140:143], 0
    s_mov_b32 s44, s75
    v_and_b32 v4, 1, v5
    v_lshlrev_b32 v4, 11, v4
    v_lshl_add_u32 v4, v7, 5, v4
    v_lshrrev_b32 v8, 1, v5
    v_lshl_add_u32 v4, v8, 4, v4
    v_add_u32 v4, s44, v4
    v_cmp_gt_u32 vcc, 32, v0

    s_nop 1
    v_cndmask_b32 v72, v120, v104, vcc
    v_cndmask_b32 v73, v124, v108, vcc
    v_cndmask_b32 v74, v128, v112, vcc
    v_cndmask_b32 v75, v132, v116, vcc
    ds_write_b128 v4, v[72:75] offset:0
    v_cndmask_b32 v76, v121, v105, vcc
    v_cndmask_b32 v77, v125, v109, vcc
    v_cndmask_b32 v78, v129, v113, vcc
    v_cndmask_b32 v79, v133, v117, vcc
    ds_write_b128 v4, v[76:79] offset:512
    v_cndmask_b32 v80, v122, v106, vcc
    v_cndmask_b32 v81, v126, v110, vcc
    v_cndmask_b32 v82, v130, v114, vcc
    v_cndmask_b32 v83, v134, v118, vcc
    ds_write_b128 v4, v[80:83] offset:1024
    v_cndmask_b32 v84, v123, v107, vcc
    v_cndmask_b32 v85, v127, v111, vcc
    v_cndmask_b32 v86, v131, v115, vcc
    v_cndmask_b32 v87, v135, v119, vcc
    ds_write_b128 v4, v[84:87] offset:1536
    v_mov_b32 v4, 1
    s_mov_b64 exec, 1
    ds_write_b32 v10, v4 offset:80
    s_mov_b64 exec, -1
    ds_read_b32 v12, v13 offset:80
FW_142:
    s_waitcnt lgkmcnt(0)
    v_cmp_gt_u32 vcc, 1, v12
    s_cbranch_vccz FO_143
    s_sleep 1
    ds_read_b32 v12, v13 offset:80
    s_branch FW_142
FO_143:
    s_lshl_b32 s44, s3, 10
    s_add_u32 s44, s44, 49152
    v_add_u32_e64 v4, s44, v3
    ds_read_b32 v32, v4 offset:0
    ds_read_b32 v33, v4 offset:256
    ds_read_b32 v34, v4 offset:512
    ds_read_b32 v35, v4 offset:768
    ds_read_b32 v36, v4 offset:4096
    ds_read_b32 v37, v4 offset:4352
    ds_read_b32 v38, v4 offset:4608
    ds_read_b32 v39, v4 offset:4864
    ds_read_b32 v40, v4 offset:8192
    ds_read_b32 v41, v4 offset:8448
    ds_read_b32 v42, v4 offset:8704
    ds_read_b32 v43, v4 offset:8960
    ds_read_b32 v44, v4 offset:12288
    ds_read_b32 v45, v4 offset:12544
    ds_read_b32 v46, v4 offset:12800
    s_waitcnt lgkmcnt(8)
    ds_read_b32 v47, v4 offset:13056
    s_lshl_b32 s44, s3, 13
    s_lshl_b32 s45, s39, 9
    s_add_u32 s44, s44, s45
    s_add_u32 s44, s44, 135168
    s_add_u32 s45, s44, 4096
    s_lshl_b32 s46, s39, 9
    s_waitcnt lgkmcnt(0)

    s_add_u32 s56, s46, 0x839000
    s_add_u32 s56, s72, s56
    s_addc_u32 s57, s73, 0
    v_add_f32 v32, v32, v36
    v_add_f32 v40, v40, v44
    v_add_f32 v33, v33, v37
    v_add_f32 v41, v41, v45
    v_add_f32 v34, v34, v38
    v_add_f32 v42, v42, v46
    v_add_f32 v35, v35, v39
    v_add_f32 v43, v43, v47
    v_add_f32 v32, v32, v40
    buffer_atomic_add_f32 v32, v3, s[24:27], s44 offen offset:0
    v_add_f32 v33, v33, v41
    buffer_atomic_add_f32 v33, v3, s[24:27], s44 offen offset:256
    v_add_f32 v34, v34, v42
    buffer_atomic_add_f32 v34, v3, s[24:27], s45 offen offset:0
    v_add_f32 v35, v35, v43
    buffer_atomic_add_f32 v35, v3, s[24:27], s45 offen offset:256
    v_mov_b32 v4, 159140
    v_mov_b32 v8, 1
    s_waitcnt vmcnt(0)
    s_mov_b64 exec, 1
    ds_add_rtn_u32 v9, v4, v8
    s_waitcnt lgkmcnt(0)
    v_readfirstlane_b32 s44, v9
    s_mov_b64 exec, -1
    s_cmp_lg_u32 s44, 3
    s_cbranch_scc1 F_ye
    s_mov_b32 s44, 1
    s_atomic_add s44, s[56:57], 0
    s_atomic_add s44, s[56:57], 0x80
    s_atomic_add s44, s[56:57], 0x100
    s_atomic_add s44, s[56:57], 0x180
F_ye:

    s_endpgm
F_codeend:
.section .rodata,"a"
.p2align 6
.amdhsa_kernel parallel_sum__linear_attn_block__moe_arch_mod__prompt_kernel
  .amdhsa_next_free_vgpr 168
  .amdhsa_next_free_sgpr 98
  .amdhsa_accum_offset 168
  .amdhsa_group_segment_fixed_size 0
  .amdhsa_kernarg_size 88
  .amdhsa_user_sgpr_count 2
  .amdhsa_user_sgpr_kernarg_segment_ptr 1
  .amdhsa_system_sgpr_workgroup_id_x 1
  .amdhsa_float_denorm_mode_32 3
  .amdhsa_float_denorm_mode_16_64 3
.end_amdhsa_kernel
```

```asm
; @launch grid=(256,1,1) block=(768,1,1) lds=163840
.amdgcn_target "amdgcn-amd-amdhsa--gfx950"
.text
.globl parallel_sum__linear_attn_block__moe_arch_mod__prompt_kernel
.p2align 12
.p2align 8
.type parallel_sum__linear_attn_block__moe_arch_mod__prompt_kernel,@function
parallel_sum__linear_attn_block__moe_arch_mod__prompt_kernel:
    s_load_dwordx4 s[4:7], s[0:1], 0
    s_load_dwordx2 s[8:9], s[0:1], 16
    s_load_dwordx8 s[60:67], s[0:1], 32
    s_load_dwordx4 s[68:71], s[0:1], 64
    s_load_dwordx2 s[72:73], s[0:1], 80
    s_cmp_ge_u32 s2, 256
    s_cbranch_scc1 F_end
    v_lshrrev_b32 v1, 6, v0
    v_and_b32 v0, 63, v0
    s_and_b32 s30, s2, 7
    v_readfirstlane_b32 s3, v1
    s_lshr_b32 s31, s2, 3
    s_and_b32 s36, s30, 1
    s_lshl_b32 s32, s36, 3
    s_and_b32 s35, s31, 7
    s_add_u32 s32, s32, s35
    s_lshr_b32 s37, s30, 1
    s_lshl_b32 s33, s37, 2
    s_lshr_b32 s34, s31, 3
    s_add_u32 s33, s33, s34
    s_add_u32 s10, s33, 0
    s_and_b32 s10, s10, 15
    s_add_u32 s11, s35, s34
    s_and_b32 s11, s11, 3
    s_and_b32 s28, s32, 11
    s_and_b32 s29, s37, 1
    s_lshl_b32 s29, s29, 2
    s_add_u32 s28, s28, s29
    s_lshr_b32 s29, s37, 1
    s_lshl_b32 s29, s29, 3
    s_and_b32 s38, s35, 4
    s_add_u32 s29, s29, s38
    s_add_u32 s38, s34, 1
    s_and_b32 s38, s38, 3
    s_add_u32 s29, s29, s38

    s_lshl_b32 s11, s34, 1
    s_add_u32 s11, s11, s35
    s_and_b32 s11, s11, 7
    s_mul_i32 s89, s36, 8
    s_mul_i32 s38, s37, 2
    s_add_u32 s89, s89, s38

    s_mov_b32 s94, 0x53176420
    s_mov_b32 s95, 0xdb9fca8e
    s_cmp_eq_u32 s11, 1
    s_cselect_b32 s94, 0x42067531, s94
    s_cselect_b32 s95, 0xca8edb9f, s95
    s_cmp_eq_u32 s11, 2
    s_cselect_b32 s94, 0x53806412, s94
    s_cselect_b32 s95, 0xfdbeca97, s95
    s_cmp_eq_u32 s11, 3
    s_cselect_b32 s94, 0x42917503, s94
    s_cselect_b32 s95, 0xecafdb86, s95
    s_cmp_eq_u32 s11, 4
    s_cselect_b32 s94, 0x5a120364, s94
    s_cselect_b32 s95, 0xfd9ecb87, s95
    s_cmp_eq_u32 s11, 5
    s_cselect_b32 s94, 0x4b031275, s94
    s_cselect_b32 s95, 0xec8fda96, s95
    s_cmp_eq_u32 s11, 6
    s_cselect_b32 s94, 0xc3145206, s94
    s_cselect_b32 s95, 0xfb9eda87, s95
    s_cmp_eq_u32 s11, 7
    s_cselect_b32 s94, 0xd2054317, s94
    s_cselect_b32 s95, 0xea8fcb96, s95
    s_cmp_ge_u32 s3, 8
    s_cbranch_scc1 F_aux
    s_cmp_ge_u32 s3, 4
    s_cbranch_scc1 F_nl
    v_lshrrev_b32 v2, 3, v0
    v_and_b32 v3, 7, v0
    v_lshrrev_b32 v4, 1, v2
    v_xor_b32 v5, v3, v4
    v_xor_b32 v6, 4, v5
    v_lshlrev_b32 v5, 4, v5
    v_lshlrev_b32 v6, 4, v6
    v_lshlrev_b32 v7, 11, v2
    v_add_u32 v5, v5, v7
    v_add_u32 v6, v6, v7
    v_and_b32 v4, 1, v4
    v_lshlrev_b32 v4, 1, v4
    v_xor_b32 v8, v3, v4
    v_xor_b32 v9, 4, v8
    v_lshlrev_b32 v8, 4, v8
    v_lshlrev_b32 v9, 4, v9
    v_mul_u32_u24 v7, 6144, v2
    v_add_u32 v8, v8, v7
    v_add_u32 v9, v9, v7
    v_add_u32 v9, 49152, v9
    s_lshl_b32 s36, s32, 18
    s_lshl_b32 s37, s3, 16
    s_add_u32 s36, s36, s37
    s_lshl_b32 s38, s33, 7
    s_mul_i32 s37, s3, 98304
    s_add_u32 s38, s38, s37
    s_lshl_b32 s47, s10, 7
    s_add_u32 s47, s47, s37
    s_lshl_b32 s44, s3, 12
    s_lshl_b32 s45, s3, 11
    s_add_u32 s43, s45, 1024
    s_mov_b32 s14, 4194304
    s_mov_b32 s15, 0x20000
    s_mov_b32 s18, 6291456
    s_mov_b32 s19, 0x20000
    s_waitcnt lgkmcnt(0)
    s_mov_b32 s12, s4
    s_mov_b32 s13, s5
    s_mov_b32 s16, s6
    s_mov_b32 s17, s7

    s_setprio 3
    s_bfe_u32 s40, s94, 0x40000
    s_add_u32 s40, s89, s40
    s_and_b32 s40, s40, 15
    s_mul_i32 s41, s40, 393216
    s_lshl_b32 s40, s40, 7
    s_add_u32 s40, s40, s36
    s_add_u32 s42, s41, s47
    s_add_u32 s41, s41, s38
    s_add_u32 m0, s44, 0
    s_add_u32 s46, s40, 0
    s_nop 0
    buffer_load_dwordx4 v5, s[12:15], s46 offen lds
    s_add_u32 m0, s44, 1024
    s_add_u32 s46, s40, 16384
    buffer_load_dwordx4 v6, s[12:15], s46 offen lds
    s_add_u32 m0, s44, 2048
    s_add_u32 s46, s40, 32768
    buffer_load_dwordx4 v5, s[12:15], s46 offen lds
    s_add_u32 m0, s44, 3072
    s_add_u32 s46, s40, 49152
    buffer_load_dwordx4 v6, s[12:15], s46 offen lds
    s_add_u32 m0, s45, 65536
    s_add_u32 s46, s41, 2048
    buffer_load_dwordx4 v8, s[16:19], s46 offen lds
    s_add_u32 m0, s43, 65536
    s_add_u32 s46, s41, 2048
    buffer_load_dwordx4 v9, s[16:19], s46 offen lds
    s_add_u32 m0, s45, 73728
    s_add_u32 s46, s41, 4096
    buffer_load_dwordx4 v8, s[16:19], s46 offen lds
    s_add_u32 m0, s43, 73728
    s_add_u32 s46, s41, 4096
    buffer_load_dwordx4 v9, s[16:19], s46 offen lds
    s_lshl_b32 s51, s32, 4
    s_add_u32 s51, s51, s33
    s_lshl_b32 s51, s51, 14
    s_add_u32 s51, s51, s45
    v_lshlrev_b32 v165, 4, v0
    s_mov_b32 s20, s60
    s_mov_b32 s21, s61
    s_mov_b32 s22, 0x800
    s_mov_b32 s23, 0x00020000
    s_add_u32 m0, s45, 81920
    s_add_u32 s46, s51, 0
    buffer_load_dwordx4 v165, s[12:15], s46 offen lds
    s_add_u32 m0, s45, 82944
    s_add_u32 s46, s51, 1024
    buffer_load_dwordx4 v165, s[12:15], s46 offen lds
    s_and_b32 s46, s3, 1
    s_lshl_b32 s46, s46, 10
    s_add_u32 m0, s46, 161792
    s_nop 0
    s_nop 0
    buffer_load_dwordx4 v165, s[20:23], s46 offen lds
    s_add_u32 m0, s45, 90112
    s_add_u32 s46, s51, 8192
    buffer_load_dwordx4 v165, s[12:15], s46 offen lds
    s_add_u32 m0, s45, 91136
    s_add_u32 s46, s51, 9216
    buffer_load_dwordx4 v165, s[12:15], s46 offen lds
    s_add_u32 m0, s45, 147456
    s_nop 0
    buffer_load_dwordx4 v8, s[16:19], s42 offen lds
    s_add_u32 m0, s43, 147456
    s_nop 0
    buffer_load_dwordx4 v9, s[16:19], s42 offen lds
    v_and_b32 v1, 15, v0
    v_lshrrev_b32 v7, 4, v0
    v_lshrrev_b32 v3, 1, v1
    v_xor_b32 v3, v3, v7
    v_lshlrev_b32 v3, 4, v3
    v_lshlrev_b32 v1, 7, v1
    v_add3_u32 v2, v1, v3, s44
    v_xor_b32 v3, 64, v2
    v_add_u32 v14, 0x10000, v2
    v_add_u32 v15, 0x10000, v3
    v_bfe_u32 v1, v0, 2, 2
    v_lshl_add_u32 v4, v7, 3, v1
    v_lshrrev_b32 v1, 1, v1
    v_and_b32 v7, 1, v7
    v_lshl_add_u32 v1, v7, 1, v1
    v_lshlrev_b32 v1, 5, v1
    v_lshl_add_u32 v1, v4, 7, v1
    v_and_b32 v7, 3, v0
    v_lshl_add_u32 v1, v7, 3, v1
    v_add_u32 v10, 90112, v1
    v_xor_b32 v11, 32, v10
    v_xor_b32 v12, 64, v10
    v_xor_b32 v13, 96, v10
    v_lshlrev_b32 v1, 2, v7
    v_add_u32 v1, 159040, v1
    s_lshl_b32 s50, s3, 2
    s_add_u32 s50, s50, 159040
    v_mov_b32 v4, s50
    v_mov_b32 v164, 1

    s_waitcnt vmcnt(7)
    s_barrier
    s_bfe_u32 s40, s94, 0x40004
    s_add_u32 s40, s89, s40
    s_and_b32 s40, s40, 15
    s_mul_i32 s41, s40, 393216
    s_lshl_b32 s40, s40, 7
    s_add_u32 s40, s40, s36
    s_add_u32 s42, s41, s47
    s_add_u32 s41, s41, s38
    s_add_u32 m0, s44, 16384
    s_add_u32 s46, s40, 0
    buffer_load_dwordx4 v5, s[12:15], s46 offen lds
    ds_read_b128 v[48:51], v2 offset:0
    s_add_u32 m0, s44, 17408
    s_add_u32 s46, s40, 16384
    buffer_load_dwordx4 v6, s[12:15], s46 offen lds
    ds_read_b128 v[52:55], v2 offset:2048
    s_add_u32 m0, s44, 18432
    s_add_u32 s46, s40, 32768
    buffer_load_dwordx4 v5, s[12:15], s46 offen lds
    ds_read_b128 v[56:59], v3 offset:0
    s_add_u32 m0, s44, 19456
    s_add_u32 s46, s40, 49152
    buffer_load_dwordx4 v6, s[12:15], s46 offen lds
    ds_read_b128 v[60:63], v3 offset:2048
    s_add_u32 m0, s45, 98304
    s_add_u32 s46, s41, 2048
    buffer_load_dwordx4 v8, s[16:19], s46 offen lds
    s_add_u32 m0, s43, 98304
    s_add_u32 s46, s41, 2048
    buffer_load_dwordx4 v9, s[16:19], s46 offen lds
    s_add_u32 m0, s45, 106496
    s_add_u32 s46, s41, 4096
    buffer_load_dwordx4 v8, s[16:19], s46 offen lds
    s_add_u32 m0, s43, 106496
    s_add_u32 s46, s41, 4096
    buffer_load_dwordx4 v9, s[16:19], s46 offen lds
    s_bfe_u32 s40, s94, 0x40008
    s_add_u32 s40, s89, s40
    s_and_b32 s40, s40, 15
    s_mul_i32 s41, s40, 393216
    s_lshl_b32 s40, s40, 7
    s_add_u32 s40, s40, s36
    s_add_u32 s42, s41, s47
    s_add_u32 s41, s41, s38
    s_add_u32 m0, s44, 32768
    s_add_u32 s46, s40, 0
    buffer_load_dwordx4 v5, s[12:15], s46 offen lds
    s_add_u32 m0, s44, 33792
    s_add_u32 s46, s40, 16384
    buffer_load_dwordx4 v6, s[12:15], s46 offen lds
    s_add_u32 m0, s44, 34816
    s_add_u32 s46, s40, 32768
    buffer_load_dwordx4 v5, s[12:15], s46 offen lds
    s_waitcnt vmcnt(3) lgkmcnt(0)
    s_barrier
    s_nop 0
    s_add_u32 m0, s44, 35840
    s_add_u32 s46, s40, 49152
    buffer_load_dwordx4 v6, s[12:15], s46 offen lds
    ds_read_b64_tr_b16 v[64:65], v10 offset:57344
    ds_read_b64_tr_b16 v[66:67], v10 offset:57856
    s_add_u32 m0, s45, 114688
    s_add_u32 s46, s41, 2048
    buffer_load_dwordx4 v8, s[16:19], s46 offen lds
    ds_read_b128 v[68:71], v2 offset:16384
    s_add_u32 m0, s43, 114688
    s_add_u32 s46, s41, 2048
    buffer_load_dwordx4 v9, s[16:19], s46 offen lds
    ds_read_b64_tr_b16 v[72:73], v11 offset:57344
    ds_read_b64_tr_b16 v[74:75], v11 offset:57856
    s_add_u32 m0, s45, 122880
    s_add_u32 s46, s41, 4096
    buffer_load_dwordx4 v8, s[16:19], s46 offen lds
    ds_read_b128 v[76:79], v2 offset:18432
    s_add_u32 m0, s43, 122880
    s_add_u32 s46, s41, 4096
    buffer_load_dwordx4 v9, s[16:19], s46 offen lds
    ds_read_b64_tr_b16 v[80:81], v12 offset:57344
    ds_read_b64_tr_b16 v[82:83], v12 offset:57856
    s_bfe_u32 s40, s94, 0x40004
    s_add_u32 s40, s89, s40
    s_and_b32 s40, s40, 15
    s_mul_i32 s41, s40, 393216
    s_lshl_b32 s40, s40, 7
    s_add_u32 s40, s40, s36
    s_add_u32 s42, s41, s47
    s_add_u32 s41, s41, s38
    s_add_u32 m0, s45, 139264
    s_nop 0
    buffer_load_dwordx4 v8, s[16:19], s42 offen lds
    ds_read_b128 v[84:87], v3 offset:16384
    s_add_u32 m0, s43, 139264
    s_nop 0
    buffer_load_dwordx4 v9, s[16:19], s42 offen lds
    ds_read_b64_tr_b16 v[88:89], v13 offset:57344
    ds_read_b64_tr_b16 v[90:91], v13 offset:57856
    s_bfe_u32 s40, s94, 0x4000c
    s_add_u32 s40, s89, s40
    s_and_b32 s40, s40, 15
    s_mul_i32 s41, s40, 393216
    s_lshl_b32 s40, s40, 7
    s_add_u32 s40, s40, s36
    s_add_u32 s42, s41, s47
    s_add_u32 s41, s41, s38
    s_add_u32 m0, s44, 49152
    s_add_u32 s46, s40, 0
    s_nop 0
    buffer_load_dwordx4 v5, s[12:15], s46 offen lds
    ds_read_b128 v[92:95], v3 offset:18432
    s_add_u32 m0, s44, 50176
    s_add_u32 s46, s40, 16384
    buffer_load_dwordx4 v6, s[12:15], s46 offen lds
    s_add_u32 m0, s44, 51200
    s_add_u32 s46, s40, 32768
    buffer_load_dwordx4 v5, s[12:15], s46 offen lds
    s_add_u32 m0, s44, 52224
    s_add_u32 s46, s40, 49152
    buffer_load_dwordx4 v6, s[12:15], s46 offen lds
    s_waitcnt vmcnt(4) lgkmcnt(0)
    s_barrier
    s_add_u32 m0, s45, 131072
    s_add_u32 s46, s41, 2048
    buffer_load_dwordx4 v8, s[16:19], s46 offen lds
    v_mfma_f32_16x16x32_bf16 v[16:19], v[64:67], v[48:51], 0
    ds_read_b64_tr_b16 v[96:97], v10 offset:61440
    ds_read_b64_tr_b16 v[98:99], v10 offset:61952
    s_add_u32 m0, s43, 131072
    s_add_u32 s46, s41, 2048
    buffer_load_dwordx4 v9, s[16:19], s46 offen lds
    v_mfma_f32_16x16x32_bf16 v[32:35], v[64:67], v[52:55], 0
    ds_read_b128 v[100:103], v2 offset:32768
    s_add_u32 m0, s45, 65536
    s_add_u32 s46, s41, 4096
    buffer_load_dwordx4 v8, s[16:19], s46 offen lds
    v_mfma_f32_16x16x32_bf16 v[20:23], v[72:75], v[48:51], 0
    ds_read_b64_tr_b16 v[104:105], v11 offset:61440
    ds_read_b64_tr_b16 v[106:107], v11 offset:61952
    s_add_u32 m0, s43, 65536
    s_add_u32 s46, s41, 4096
    buffer_load_dwordx4 v9, s[16:19], s46 offen lds
    v_mfma_f32_16x16x32_bf16 v[36:39], v[72:75], v[52:55], 0
    ds_read_b128 v[108:111], v2 offset:34816
    s_bfe_u32 s40, s94, 0x40008
    s_add_u32 s40, s89, s40
    s_and_b32 s40, s40, 15
    s_mul_i32 s41, s40, 393216
    s_lshl_b32 s40, s40, 7
    s_add_u32 s40, s40, s36
    s_add_u32 s42, s41, s47
    s_add_u32 s41, s41, s38
    s_add_u32 m0, s45, 106496
    s_nop 0
    buffer_load_dwordx4 v8, s[16:19], s42 offen lds
    v_mfma_f32_16x16x32_bf16 v[24:27], v[80:83], v[48:51], 0
    ds_read_b64_tr_b16 v[112:113], v12 offset:61440
    ds_read_b64_tr_b16 v[114:115], v12 offset:61952
    s_add_u32 m0, s43, 106496
    s_nop 0
    buffer_load_dwordx4 v9, s[16:19], s42 offen lds
    v_mfma_f32_16x16x32_bf16 v[40:43], v[80:83], v[52:55], 0
    ds_read_b128 v[116:119], v3 offset:32768
    s_bfe_u32 s40, s94, 0x40010
    s_add_u32 s40, s89, s40
    s_and_b32 s40, s40, 15
    s_mul_i32 s41, s40, 393216
    s_lshl_b32 s40, s40, 7
    s_add_u32 s40, s40, s36
    s_add_u32 s42, s41, s47
    s_add_u32 s41, s41, s38
    s_add_u32 m0, s44, 0
    s_add_u32 s46, s40, 0
    buffer_load_dwordx4 v5, s[12:15], s46 offen lds
    v_mfma_f32_16x16x32_bf16 v[28:31], v[88:91], v[48:51], 0
    ds_read_b64_tr_b16 v[120:121], v13 offset:61440
    ds_read_b64_tr_b16 v[122:123], v13 offset:61952
    s_add_u32 m0, s44, 1024
    s_add_u32 s46, s40, 16384
    buffer_load_dwordx4 v6, s[12:15], s46 offen lds
    v_mfma_f32_16x16x32_bf16 v[44:47], v[88:91], v[52:55], 0
    ds_read_b128 v[124:127], v3 offset:34816
    s_add_u32 m0, s44, 2048
    s_add_u32 s46, s40, 32768
    buffer_load_dwordx4 v5, s[12:15], s46 offen lds
    ds_read_b64_tr_b16 v[128:129], v10 offset:49152
    ds_read_b64_tr_b16 v[130:131], v10 offset:49664
    s_add_u32 m0, s44, 3072
    s_add_u32 s46, s40, 49152
    buffer_load_dwordx4 v6, s[12:15], s46 offen lds
    ds_read_b64_tr_b16 v[132:133], v11 offset:49152
    s_waitcnt lgkmcnt(8)
    s_nop 0
    ds_read_b64_tr_b16 v[134:135], v11 offset:49664
    s_add_u32 m0, s45, 73728
    s_add_u32 s46, s41, 2048
    buffer_load_dwordx4 v8, s[16:19], s46 offen lds
    ds_read_b64_tr_b16 v[136:137], v12 offset:49152
    ds_read_b64_tr_b16 v[138:139], v12 offset:49664
    ds_read_b64_tr_b16 v[140:141], v13 offset:49152
    ds_read_b64_tr_b16 v[142:143], v13 offset:49664
    s_waitcnt vmcnt(5) lgkmcnt(0)
    s_barrier
    s_add_u32 m0, s43, 73728
    s_add_u32 s46, s41, 2048
    buffer_load_dwordx4 v9, s[16:19], s46 offen lds
    v_mfma_f32_16x16x32_bf16 v[16:19], v[96:99], v[56:59], v[16:19]
    ds_read_b64_tr_b16 v[144:145], v10 offset:53248
    ds_read_b64_tr_b16 v[146:147], v10 offset:53760
    s_add_u32 m0, s45, 81920
    s_add_u32 s46, s41, 4096
    buffer_load_dwordx4 v8, s[16:19], s46 offen lds
    v_mfma_f32_16x16x32_bf16 v[32:35], v[96:99], v[60:63], v[32:35]
    ds_read_b128 v[148:151], v2 offset:49152
    s_add_u32 m0, s43, 81920
    s_add_u32 s46, s41, 4096
    buffer_load_dwordx4 v9, s[16:19], s46 offen lds
    v_mfma_f32_16x16x32_bf16 v[20:23], v[104:107], v[56:59], v[20:23]
    ds_read_b64_tr_b16 v[152:153], v11 offset:53248
    ds_read_b64_tr_b16 v[154:155], v11 offset:53760
    s_bfe_u32 s40, s94, 0x40014
    s_add_u32 s40, s89, s40
    s_and_b32 s40, s40, 15
    s_mul_i32 s41, s40, 393216
    s_lshl_b32 s40, s40, 7
    s_add_u32 s40, s40, s36
    s_add_u32 s42, s41, s47
    s_add_u32 s41, s41, s38
    s_add_u32 m0, s44, 16384
    s_add_u32 s46, s40, 0
    s_nop 0
    buffer_load_dwordx4 v5, s[12:15], s46 offen lds
    v_mfma_f32_16x16x32_bf16 v[36:39], v[104:107], v[60:63], v[36:39]
    ds_read_b128 v[156:159], v2 offset:51200
    s_add_u32 m0, s44, 17408
    s_add_u32 s46, s40, 16384
    buffer_load_dwordx4 v6, s[12:15], s46 offen lds
    v_mfma_f32_16x16x32_bf16 v[24:27], v[112:115], v[56:59], v[24:27]
    ds_read_b64_tr_b16 v[160:161], v12 offset:53248
    ds_read_b64_tr_b16 v[162:163], v12 offset:53760
    s_add_u32 m0, s44, 18432
    s_add_u32 s46, s40, 32768
    buffer_load_dwordx4 v5, s[12:15], s46 offen lds
    v_mfma_f32_16x16x32_bf16 v[40:43], v[112:115], v[60:63], v[40:43]
    ds_read_b128 v[64:67], v3 offset:49152
    s_add_u32 m0, s44, 19456
    s_add_u32 s46, s40, 49152
    buffer_load_dwordx4 v6, s[12:15], s46 offen lds
    v_mfma_f32_16x16x32_bf16 v[28:31], v[120:123], v[56:59], v[28:31]
    ds_read_b64_tr_b16 v[72:73], v13 offset:53248
    ds_read_b64_tr_b16 v[74:75], v13 offset:53760
    s_add_u32 m0, s45, 90112
    s_add_u32 s46, s41, 2048
    buffer_load_dwordx4 v8, s[16:19], s46 offen lds
    v_mfma_f32_16x16x32_bf16 v[44:47], v[120:123], v[60:63], v[44:47]
    ds_read_b128 v[80:83], v3 offset:51200
    s_add_u32 m0, s43, 90112
    s_add_u32 s46, s41, 2048
    buffer_load_dwordx4 v9, s[16:19], s46 offen lds
    v_mfma_f32_16x16x32_bf16 v[16:19], v[128:131], v[68:71], v[16:19]
    ds_read_b64_tr_b16 v[48:49], v10 offset:16384
    ds_read_b64_tr_b16 v[50:51], v10 offset:16896
    s_add_u32 m0, s45, 98304
    s_add_u32 s46, s41, 4096
    buffer_load_dwordx4 v8, s[16:19], s46 offen lds
    v_mfma_f32_16x16x32_bf16 v[32:35], v[128:131], v[76:79], v[32:35]
    ds_read_b64_tr_b16 v[88:89], v11 offset:16384
    s_waitcnt lgkmcnt(8)
    s_nop 0
    ds_read_b64_tr_b16 v[90:91], v11 offset:16896
    s_add_u32 m0, s43, 98304
    s_add_u32 s46, s41, 4096
    buffer_load_dwordx4 v9, s[16:19], s46 offen lds
    v_mfma_f32_16x16x32_bf16 v[20:23], v[132:135], v[68:71], v[20:23]
    ds_read_b64_tr_b16 v[52:53], v12 offset:16384
    ds_read_b64_tr_b16 v[54:55], v12 offset:16896
    v_mfma_f32_16x16x32_bf16 v[36:39], v[132:135], v[76:79], v[36:39]
    ds_read_b64_tr_b16 v[96:97], v13 offset:16384
    ds_read_b64_tr_b16 v[98:99], v13 offset:16896
    v_mfma_f32_16x16x32_bf16 v[24:27], v[136:139], v[68:71], v[24:27]
    v_mfma_f32_16x16x32_bf16 v[40:43], v[136:139], v[76:79], v[40:43]
    v_mfma_f32_16x16x32_bf16 v[28:31], v[140:143], v[68:71], v[28:31]
    v_mfma_f32_16x16x32_bf16 v[44:47], v[140:143], v[76:79], v[44:47]
    s_waitcnt vmcnt(8) lgkmcnt(0)
    s_barrier
    s_bfe_u32 s40, s94, 0x4000c
    s_add_u32 s40, s89, s40
    s_and_b32 s40, s40, 15
    s_mul_i32 s41, s40, 393216
    s_lshl_b32 s40, s40, 7
    s_add_u32 s40, s40, s36
    s_add_u32 s42, s41, s47
    s_add_u32 s41, s41, s38
    s_add_u32 m0, s45, 147456
    s_nop 0
    buffer_load_dwordx4 v8, s[16:19], s42 offen lds
    v_mfma_f32_16x16x32_bf16 v[16:19], v[144:147], v[84:87], v[16:19]
    ds_read_b64_tr_b16 v[104:105], v10 offset:20480
    ds_read_b64_tr_b16 v[106:107], v10 offset:20992
    s_add_u32 m0, s43, 147456
    s_nop 0
    buffer_load_dwordx4 v9, s[16:19], s42 offen lds
    v_mfma_f32_16x16x32_bf16 v[32:35], v[144:147], v[92:95], v[32:35]
    ds_read_b128 v[112:115], v2 offset:0
    s_bfe_u32 s40, s94, 0x40018
    s_add_u32 s40, s89, s40
    s_and_b32 s40, s40, 15
    s_mul_i32 s41, s40, 393216
    s_lshl_b32 s40, s40, 7
    s_add_u32 s40, s40, s36
    s_add_u32 s42, s41, s47
    s_add_u32 s41, s41, s38
    s_add_u32 m0, s44, 32768
    s_branch IW_s0
IW_w0:
    s_branch IW_r0
IW_s0:
    s_add_u32 s46, s40, 0
    s_nop 0
    buffer_load_dwordx4 v5, s[12:15], s46 offen lds
    v_mfma_f32_16x16x32_bf16 v[20:23], v[152:155], v[84:87], v[20:23]
    ds_read_b64_tr_b16 v[56:57], v11 offset:20480
    ds_read_b64_tr_b16 v[58:59], v11 offset:20992
    s_add_u32 m0, s44, 33792
    s_add_u32 s46, s40, 16384
    buffer_load_dwordx4 v6, s[12:15], s46 offen lds
    v_mfma_f32_16x16x32_bf16 v[36:39], v[152:155], v[92:95], v[36:39]
    ds_read_b128 v[120:123], v2 offset:2048
    s_add_u32 m0, s44, 34816
    s_add_u32 s46, s40, 32768
    buffer_load_dwordx4 v5, s[12:15], s46 offen lds
    v_mfma_f32_16x16x32_bf16 v[24:27], v[160:163], v[84:87], v[24:27]
    ds_read_b64_tr_b16 v[60:61], v12 offset:20480
    ds_read_b64_tr_b16 v[62:63], v12 offset:20992
    s_add_u32 m0, s44, 35840
    s_add_u32 s46, s40, 49152
    buffer_load_dwordx4 v6, s[12:15], s46 offen lds
    v_mfma_f32_16x16x32_bf16 v[40:43], v[160:163], v[92:95], v[40:43]
    ds_read_b128 v[128:131], v3 offset:0
    s_add_u32 m0, s45, 114688
    s_add_u32 s46, s41, 2048
    buffer_load_dwordx4 v8, s[16:19], s46 offen lds
    v_mfma_f32_16x16x32_bf16 v[28:31], v[72:75], v[84:87], v[28:31]
    ds_read_b64_tr_b16 v[132:133], v13 offset:20480
    ds_read_b64_tr_b16 v[134:135], v13 offset:20992
    s_add_u32 m0, s43, 114688
    s_add_u32 s46, s41, 2048
    buffer_load_dwordx4 v9, s[16:19], s46 offen lds
    v_mfma_f32_16x16x32_bf16 v[44:47], v[72:75], v[92:95], v[44:47]
    ds_read_b128 v[136:139], v3 offset:2048
    s_add_u32 m0, s45, 122880
    s_add_u32 s46, s41, 4096
    buffer_load_dwordx4 v8, s[16:19], s46 offen lds
    v_mfma_f32_16x16x32_bf16 v[16:19], v[48:51], v[100:103], v[16:19]
    s_add_u32 m0, s43, 122880
    s_add_u32 s46, s41, 4096
    buffer_load_dwordx4 v9, s[16:19], s46 offen lds
    v_mfma_f32_16x16x32_bf16 v[32:35], v[48:51], v[108:111], v[32:35]
    s_bfe_u32 s40, s94, 0x4001c
    s_add_u32 s40, s89, s40
    s_and_b32 s40, s40, 15
    s_mul_i32 s41, s40, 393216
    s_lshl_b32 s40, s40, 7
    s_add_u32 s40, s40, s36
    s_add_u32 s42, s41, s47
    s_add_u32 s41, s41, s38
    s_add_u32 m0, s44, 49152
    s_add_u32 s46, s40, 0
    buffer_load_dwordx4 v5, s[12:15], s46 offen lds
    v_mfma_f32_16x16x32_bf16 v[20:23], v[88:91], v[100:103], v[20:23]
    v_mfma_f32_16x16x32_bf16 v[36:39], v[88:91], v[108:111], v[36:39]
    v_mfma_f32_16x16x32_bf16 v[24:27], v[52:55], v[100:103], v[24:27]
    v_mfma_f32_16x16x32_bf16 v[40:43], v[52:55], v[108:111], v[40:43]
    v_mfma_f32_16x16x32_bf16 v[28:31], v[96:99], v[100:103], v[28:31]
    v_mfma_f32_16x16x32_bf16 v[44:47], v[96:99], v[108:111], v[44:47]
    s_waitcnt vmcnt(9) lgkmcnt(0)
    s_barrier
    s_nop 0
    s_add_u32 m0, s44, 50176
    s_add_u32 s46, s40, 16384
    buffer_load_dwordx4 v6, s[12:15], s46 offen lds
    v_mfma_f32_16x16x32_bf16 v[16:19], v[104:107], v[116:119], v[16:19]
    ds_read_b64_tr_b16 v[68:69], v10 offset:57344
    ds_read_b64_tr_b16 v[70:71], v10 offset:57856
    s_add_u32 m0, s44, 51200
    s_add_u32 s46, s40, 32768
    buffer_load_dwordx4 v5, s[12:15], s46 offen lds
    v_mfma_f32_16x16x32_bf16 v[32:35], v[104:107], v[124:127], v[32:35]
    ds_read_b128 v[140:143], v2 offset:16384
    s_add_u32 m0, s44, 52224
    s_add_u32 s46, s40, 49152
    buffer_load_dwordx4 v6, s[12:15], s46 offen lds
    v_mfma_f32_16x16x32_bf16 v[20:23], v[56:59], v[116:119], v[20:23]
    ds_read_b64_tr_b16 v[76:77], v11 offset:57344
    ds_read_b64_tr_b16 v[78:79], v11 offset:57856
    s_add_u32 m0, s45, 65536
    s_add_u32 s46, s41, 2048
    buffer_load_dwordx4 v8, s[16:19], s46 offen lds
    v_mfma_f32_16x16x32_bf16 v[36:39], v[56:59], v[124:127], v[36:39]
    ds_read_b128 v[144:147], v2 offset:18432
    s_add_u32 m0, s43, 65536
    s_add_u32 s46, s41, 2048
    buffer_load_dwordx4 v9, s[16:19], s46 offen lds
    v_mfma_f32_16x16x32_bf16 v[24:27], v[60:63], v[116:119], v[24:27]
    ds_read_b64_tr_b16 v[152:153], v12 offset:57344
    ds_read_b64_tr_b16 v[154:155], v12 offset:57856
    s_add_u32 m0, s45, 131072
    s_add_u32 s46, s41, 4096
    buffer_load_dwordx4 v8, s[16:19], s46 offen lds
    v_mfma_f32_16x16x32_bf16 v[40:43], v[60:63], v[124:127], v[40:43]
    ds_read_b128 v[160:163], v3 offset:16384
    s_add_u32 m0, s43, 131072
    s_add_u32 s46, s41, 4096
    buffer_load_dwordx4 v9, s[16:19], s46 offen lds
    v_mfma_f32_16x16x32_bf16 v[28:31], v[132:135], v[116:119], v[28:31]
    ds_read_b64_tr_b16 v[84:85], v13 offset:57344
    ds_read_b64_tr_b16 v[86:87], v13 offset:57856
    s_bfe_u32 s40, s94, 0x40010
    s_add_u32 s40, s89, s40
    s_and_b32 s40, s40, 15
    s_mul_i32 s41, s40, 393216
    s_lshl_b32 s40, s40, 7
    s_add_u32 s40, s40, s36
    s_add_u32 s42, s41, s47
    s_add_u32 s41, s41, s38
    s_add_u32 m0, s45, 139264
    s_nop 0
    buffer_load_dwordx4 v8, s[16:19], s42 offen lds
    v_mfma_f32_16x16x32_bf16 v[44:47], v[132:135], v[124:127], v[44:47]
    ds_read_b128 v[72:75], v3 offset:18432
    s_add_u32 m0, s43, 139264
    s_nop 0
    buffer_load_dwordx4 v9, s[16:19], s42 offen lds
    s_bfe_u32 s40, s95, 0x40000
    s_add_u32 s40, s89, s40
    s_and_b32 s40, s40, 15
    s_mul_i32 s41, s40, 393216
    s_lshl_b32 s40, s40, 7
    s_add_u32 s40, s40, s36
    s_add_u32 s42, s41, s47
    s_add_u32 s41, s41, s38
    s_add_u32 m0, s44, 0
    s_add_u32 s46, s40, 0
    buffer_load_dwordx4 v5, s[12:15], s46 offen lds
    s_add_u32 m0, s44, 1024
    s_add_u32 s46, s40, 16384
    buffer_load_dwordx4 v6, s[12:15], s46 offen lds
    s_waitcnt vmcnt(12) lgkmcnt(0)
    s_barrier
    s_add_u32 m0, s44, 2048
    s_add_u32 s46, s40, 32768
    buffer_load_dwordx4 v5, s[12:15], s46 offen lds
    v_mfma_f32_16x16x32_bf16 v[16:19], v[68:71], v[148:151], v[16:19]
    ds_read_b64_tr_b16 v[92:93], v10 offset:61440
    ds_read_b64_tr_b16 v[94:95], v10 offset:61952
    s_add_u32 m0, s44, 3072
    s_add_u32 s46, s40, 49152
    buffer_load_dwordx4 v6, s[12:15], s46 offen lds
    v_mfma_f32_16x16x32_bf16 v[32:35], v[68:71], v[156:159], v[32:35]
    ds_read_b128 v[48:51], v2 offset:32768
    s_add_u32 m0, s45, 73728
    s_add_u32 s46, s41, 2048
    buffer_load_dwordx4 v8, s[16:19], s46 offen lds
    v_mfma_f32_16x16x32_bf16 v[20:23], v[76:79], v[148:151], v[20:23]
    ds_read_b64_tr_b16 v[88:89], v11 offset:61440
    ds_read_b64_tr_b16 v[90:91], v11 offset:61952
    s_add_u32 m0, s43, 73728
    s_add_u32 s46, s41, 2048
    buffer_load_dwordx4 v9, s[16:19], s46 offen lds
    v_mfma_f32_16x16x32_bf16 v[36:39], v[76:79], v[156:159], v[36:39]
    ds_read_b128 v[52:55], v2 offset:34816
    s_add_u32 m0, s45, 81920
    s_add_u32 s46, s41, 4096
    buffer_load_dwordx4 v8, s[16:19], s46 offen lds
    v_mfma_f32_16x16x32_bf16 v[24:27], v[152:155], v[148:151], v[24:27]
    ds_read_b64_tr_b16 v[100:101], v12 offset:61440
    ds_read_b64_tr_b16 v[102:103], v12 offset:61952
    s_add_u32 m0, s43, 81920
    s_add_u32 s46, s41, 4096
    buffer_load_dwordx4 v9, s[16:19], s46 offen lds
    v_mfma_f32_16x16x32_bf16 v[40:43], v[152:155], v[156:159], v[40:43]
    ds_read_b128 v[96:99], v3 offset:32768
    s_bfe_u32 s40, s95, 0x40004
    s_add_u32 s40, s89, s40
    s_and_b32 s40, s40, 15
    s_mul_i32 s41, s40, 393216
    s_lshl_b32 s40, s40, 7
    s_add_u32 s40, s40, s36
    s_add_u32 s42, s41, s47
    s_add_u32 s41, s41, s38
    s_add_u32 m0, s44, 16384
    s_add_u32 s46, s40, 0
    s_nop 0
    buffer_load_dwordx4 v5, s[12:15], s46 offen lds
    v_mfma_f32_16x16x32_bf16 v[28:31], v[84:87], v[148:151], v[28:31]
    ds_read_b64_tr_b16 v[108:109], v13 offset:61440
    ds_read_b64_tr_b16 v[110:111], v13 offset:61952
    s_add_u32 m0, s44, 17408
    s_add_u32 s46, s40, 16384
    buffer_load_dwordx4 v6, s[12:15], s46 offen lds
    v_mfma_f32_16x16x32_bf16 v[44:47], v[84:87], v[156:159], v[44:47]
    ds_read_b128 v[104:107], v3 offset:34816
    s_add_u32 m0, s44, 18432
    s_add_u32 s46, s40, 32768
    buffer_load_dwordx4 v5, s[12:15], s46 offen lds
    s_add_u32 m0, s44, 19456
    s_add_u32 s46, s40, 49152
    buffer_load_dwordx4 v6, s[12:15], s46 offen lds
    s_add_u32 m0, s45, 90112
    s_add_u32 s46, s41, 2048
    buffer_load_dwordx4 v8, s[16:19], s46 offen lds
    s_waitcnt vmcnt(13) lgkmcnt(0)
    s_barrier
    s_add_u32 m0, s43, 90112
    s_add_u32 s46, s41, 2048
    buffer_load_dwordx4 v9, s[16:19], s46 offen lds
    v_mfma_f32_16x16x32_bf16 v[16:19], v[92:95], v[64:67], v[16:19]
    ds_read_b64_tr_b16 v[56:57], v10 offset:49152
    ds_read_b64_tr_b16 v[58:59], v10 offset:49664
    s_add_u32 m0, s45, 98304
    s_add_u32 s46, s41, 4096
    buffer_load_dwordx4 v8, s[16:19], s46 offen lds
    v_mfma_f32_16x16x32_bf16 v[32:35], v[92:95], v[80:83], v[32:35]
    ds_read_b128 v[60:63], v2 offset:49152
    s_add_u32 m0, s43, 98304
    s_add_u32 s46, s41, 4096
    buffer_load_dwordx4 v9, s[16:19], s46 offen lds
    v_mfma_f32_16x16x32_bf16 v[20:23], v[88:91], v[64:67], v[20:23]
    ds_read_b64_tr_b16 v[116:117], v11 offset:49152
    ds_read_b64_tr_b16 v[118:119], v11 offset:49664
    s_bfe_u32 s40, s94, 0x40014
    s_add_u32 s40, s89, s40
    s_and_b32 s40, s40, 15
    s_mul_i32 s41, s40, 393216
    s_lshl_b32 s40, s40, 7
    s_add_u32 s40, s40, s36
    s_add_u32 s42, s41, s47
    s_add_u32 s41, s41, s38
    s_add_u32 m0, s45, 106496
    s_nop 0
    buffer_load_dwordx4 v8, s[16:19], s42 offen lds
    v_mfma_f32_16x16x32_bf16 v[36:39], v[88:91], v[80:83], v[36:39]
    ds_read_b128 v[132:135], v2 offset:51200
    s_add_u32 m0, s43, 106496
    s_nop 0
    buffer_load_dwordx4 v9, s[16:19], s42 offen lds
    v_mfma_f32_16x16x32_bf16 v[24:27], v[100:103], v[64:67], v[24:27]
    ds_read_b64_tr_b16 v[124:125], v12 offset:49152
    ds_read_b64_tr_b16 v[126:127], v12 offset:49664
    s_bfe_u32 s40, s95, 0x40008
    s_add_u32 s40, s89, s40
    s_and_b32 s40, s40, 15
    s_mul_i32 s41, s40, 393216
    s_lshl_b32 s40, s40, 7
    s_add_u32 s40, s40, s36
    s_add_u32 s42, s41, s47
    s_add_u32 s41, s41, s38
    s_add_u32 m0, s44, 32768
    s_add_u32 s46, s40, 0
    s_nop 0
    buffer_load_dwordx4 v5, s[12:15], s46 offen lds
    v_mfma_f32_16x16x32_bf16 v[40:43], v[100:103], v[80:83], v[40:43]
    ds_read_b128 v[68:71], v3 offset:49152
    s_add_u32 m0, s44, 33792
    s_add_u32 s46, s40, 16384
    buffer_load_dwordx4 v6, s[12:15], s46 offen lds
    v_mfma_f32_16x16x32_bf16 v[28:31], v[108:111], v[64:67], v[28:31]
    ds_read_b64_tr_b16 v[76:77], v13 offset:49152
    ds_read_b64_tr_b16 v[78:79], v13 offset:49664
    s_add_u32 m0, s44, 34816
    s_add_u32 s46, s40, 32768
    buffer_load_dwordx4 v5, s[12:15], s46 offen lds
    v_mfma_f32_16x16x32_bf16 v[44:47], v[108:111], v[80:83], v[44:47]
    ds_read_b128 v[152:155], v3 offset:51200
    s_add_u32 m0, s44, 35840
    s_add_u32 s46, s40, 49152
    buffer_load_dwordx4 v6, s[12:15], s46 offen lds
    s_add_u32 m0, s45, 114688
    s_add_u32 s46, s41, 2048
    buffer_load_dwordx4 v8, s[16:19], s46 offen lds
    s_add_u32 m0, s43, 114688
    s_add_u32 s46, s41, 2048
    buffer_load_dwordx4 v9, s[16:19], s46 offen lds
    s_waitcnt vmcnt(16) lgkmcnt(0)
    s_barrier
    s_add_u32 m0, s45, 122880
    s_add_u32 s46, s41, 4096
    buffer_load_dwordx4 v8, s[16:19], s46 offen lds
    v_mfma_f32_16x16x32_bf16 v[16:19], v[56:59], v[112:115], v[16:19]
    ds_read_b64_tr_b16 v[148:149], v10 offset:53248
    ds_read_b64_tr_b16 v[150:151], v10 offset:53760
    s_add_u32 m0, s43, 122880
    s_add_u32 s46, s41, 4096
    buffer_load_dwordx4 v9, s[16:19], s46 offen lds
    v_mfma_f32_16x16x32_bf16 v[32:35], v[56:59], v[120:123], v[32:35]
    ds_read_b128 v[84:87], v2 offset:0
    s_bfe_u32 s40, s95, 0x4000c
    s_add_u32 s40, s89, s40
    s_and_b32 s40, s40, 15
    s_mul_i32 s41, s40, 393216
    s_lshl_b32 s40, s40, 7
    s_add_u32 s40, s40, s36
    s_add_u32 s42, s41, s47
    s_add_u32 s41, s41, s38
    s_add_u32 m0, s44, 49152
    s_add_u32 s46, s40, 0
    s_nop 0
    buffer_load_dwordx4 v5, s[12:15], s46 offen lds
    v_mfma_f32_16x16x32_bf16 v[20:23], v[116:119], v[112:115], v[20:23]
    ds_read_b64_tr_b16 v[156:157], v11 offset:53248
    ds_read_b64_tr_b16 v[158:159], v11 offset:53760
    s_add_u32 m0, s44, 50176
    s_add_u32 s46, s40, 16384
    buffer_load_dwordx4 v6, s[12:15], s46 offen lds
    v_mfma_f32_16x16x32_bf16 v[36:39], v[116:119], v[120:123], v[36:39]
    ds_read_b128 v[92:95], v2 offset:2048
    s_add_u32 m0, s44, 51200
    s_add_u32 s46, s40, 32768
    buffer_load_dwordx4 v5, s[12:15], s46 offen lds
    v_mfma_f32_16x16x32_bf16 v[24:27], v[124:127], v[112:115], v[24:27]
    ds_read_b64_tr_b16 v[88:89], v12 offset:53248
    ds_read_b64_tr_b16 v[90:91], v12 offset:53760
    s_add_u32 m0, s44, 52224
    s_add_u32 s46, s40, 49152
    buffer_load_dwordx4 v6, s[12:15], s46 offen lds
    v_mfma_f32_16x16x32_bf16 v[40:43], v[124:127], v[120:123], v[40:43]
    ds_read_b128 v[100:103], v3 offset:0
    s_add_u32 m0, s45, 65536
    s_add_u32 s46, s41, 2048
    buffer_load_dwordx4 v8, s[16:19], s46 offen lds
    v_mfma_f32_16x16x32_bf16 v[28:31], v[76:79], v[112:115], v[28:31]
    ds_read_b64_tr_b16 v[64:65], v13 offset:53248
    ds_read_b64_tr_b16 v[66:67], v13 offset:53760
    s_add_u32 m0, s43, 65536
    s_add_u32 s46, s41, 2048
    buffer_load_dwordx4 v9, s[16:19], s46 offen lds
    v_mfma_f32_16x16x32_bf16 v[44:47], v[76:79], v[120:123], v[44:47]
    ds_read_b128 v[108:111], v3 offset:2048
    s_add_u32 m0, s45, 131072
    s_add_u32 s46, s41, 4096
    buffer_load_dwordx4 v8, s[16:19], s46 offen lds
    s_add_u32 m0, s43, 131072
    s_add_u32 s46, s41, 4096
    buffer_load_dwordx4 v9, s[16:19], s46 offen lds
    s_waitcnt vmcnt(16) lgkmcnt(0)
    s_barrier
    s_bfe_u32 s40, s95, 0x40010
    s_add_u32 s40, s89, s40
    s_and_b32 s40, s40, 15
    s_mul_i32 s41, s40, 393216
    s_lshl_b32 s40, s40, 7
    s_add_u32 s40, s40, s36
    s_add_u32 s42, s41, s47
    s_add_u32 s41, s41, s38
    s_add_u32 m0, s44, 0
    s_add_u32 s46, s40, 0
    buffer_load_dwordx4 v5, s[12:15], s46 offen lds
    v_mfma_f32_16x16x32_bf16 v[16:19], v[148:151], v[128:131], v[16:19]
    ds_read_b64_tr_b16 v[80:81], v10 offset:16384
    ds_read_b64_tr_b16 v[82:83], v10 offset:16896
    s_add_u32 m0, s44, 1024
    s_add_u32 s46, s40, 16384
    buffer_load_dwordx4 v6, s[12:15], s46 offen lds
    v_mfma_f32_16x16x32_bf16 v[32:35], v[148:151], v[136:139], v[32:35]
    ds_read_b128 v[56:59], v2 offset:16384
    s_add_u32 m0, s44, 2048
    s_add_u32 s46, s40, 32768
    buffer_load_dwordx4 v5, s[12:15], s46 offen lds
    v_mfma_f32_16x16x32_bf16 v[20:23], v[156:159], v[128:131], v[20:23]
    ds_read_b64_tr_b16 v[116:117], v11 offset:16384
    ds_read_b64_tr_b16 v[118:119], v11 offset:16896
    s_add_u32 m0, s44, 3072
    s_add_u32 s46, s40, 49152
    buffer_load_dwordx4 v6, s[12:15], s46 offen lds
    v_mfma_f32_16x16x32_bf16 v[36:39], v[156:159], v[136:139], v[36:39]
    ds_read_b128 v[124:127], v2 offset:18432
    s_add_u32 m0, s45, 73728
    s_add_u32 s46, s41, 2048
    buffer_load_dwordx4 v8, s[16:19], s46 offen lds
    v_mfma_f32_16x16x32_bf16 v[24:27], v[88:91], v[128:131], v[24:27]
    ds_read_b64_tr_b16 v[112:113], v12 offset:16384
    ds_read_b64_tr_b16 v[114:115], v12 offset:16896
    s_add_u32 m0, s43, 73728
    s_add_u32 s46, s41, 2048
    buffer_load_dwordx4 v9, s[16:19], s46 offen lds
    v_mfma_f32_16x16x32_bf16 v[40:43], v[88:91], v[136:139], v[40:43]
    ds_read_b128 v[76:79], v3 offset:16384
    s_add_u32 m0, s45, 81920
    s_add_u32 s46, s41, 4096
    buffer_load_dwordx4 v8, s[16:19], s46 offen lds
    v_mfma_f32_16x16x32_bf16 v[28:31], v[64:67], v[128:131], v[28:31]
    ds_read_b64_tr_b16 v[120:121], v13 offset:16384
    ds_read_b64_tr_b16 v[122:123], v13 offset:16896
    s_add_u32 m0, s43, 81920
    s_add_u32 s46, s41, 4096
    buffer_load_dwordx4 v9, s[16:19], s46 offen lds
    v_mfma_f32_16x16x32_bf16 v[44:47], v[64:67], v[136:139], v[44:47]
    ds_read_b128 v[148:151], v3 offset:18432
    s_waitcnt vmcnt(16) lgkmcnt(0)
    s_barrier
    s_bfe_u32 s40, s95, 0x40014
    s_add_u32 s40, s89, s40
    s_and_b32 s40, s40, 15
    s_mul_i32 s41, s40, 393216
    s_lshl_b32 s40, s40, 7
    s_add_u32 s40, s40, s36
    s_add_u32 s42, s41, s47
    s_add_u32 s41, s41, s38
    s_add_u32 m0, s44, 16384
    s_add_u32 s46, s40, 0
    s_nop 0
    buffer_load_dwordx4 v5, s[12:15], s46 offen lds
    v_mfma_f32_16x16x32_bf16 v[16:19], v[80:83], v[140:143], v[16:19]
    ds_read_b64_tr_b16 v[156:157], v10 offset:20480
    ds_read_b64_tr_b16 v[158:159], v10 offset:20992
    s_add_u32 m0, s44, 17408
    s_add_u32 s46, s40, 16384
    buffer_load_dwordx4 v6, s[12:15], s46 offen lds
    v_mfma_f32_16x16x32_bf16 v[32:35], v[80:83], v[144:147], v[32:35]
    ds_read_b128 v[88:91], v2 offset:32768
    s_add_u32 m0, s44, 18432
    s_add_u32 s46, s40, 32768
    buffer_load_dwordx4 v5, s[12:15], s46 offen lds
    v_mfma_f32_16x16x32_bf16 v[20:23], v[116:119], v[140:143], v[20:23]
    ds_read_b64_tr_b16 v[128:129], v11 offset:20480
    ds_read_b64_tr_b16 v[130:131], v11 offset:20992
    s_add_u32 m0, s44, 19456
    s_add_u32 s46, s40, 49152
    buffer_load_dwordx4 v6, s[12:15], s46 offen lds
    v_mfma_f32_16x16x32_bf16 v[36:39], v[116:119], v[144:147], v[36:39]
    ds_read_b128 v[64:67], v2 offset:34816
    s_add_u32 m0, s45, 90112
    s_add_u32 s46, s41, 2048
    buffer_load_dwordx4 v8, s[16:19], s46 offen lds
    v_mfma_f32_16x16x32_bf16 v[24:27], v[112:115], v[140:143], v[24:27]
    ds_read_b64_tr_b16 v[136:137], v12 offset:20480
    ds_read_b64_tr_b16 v[138:139], v12 offset:20992
    s_add_u32 m0, s43, 90112
    s_add_u32 s46, s41, 2048
    buffer_load_dwordx4 v9, s[16:19], s46 offen lds
    v_mfma_f32_16x16x32_bf16 v[40:43], v[112:115], v[144:147], v[40:43]
    ds_read_b128 v[80:83], v3 offset:32768
    s_add_u32 m0, s45, 98304
    s_add_u32 s46, s41, 4096
    buffer_load_dwordx4 v8, s[16:19], s46 offen lds
    v_mfma_f32_16x16x32_bf16 v[28:31], v[120:123], v[140:143], v[28:31]
    ds_read_b64_tr_b16 v[116:117], v13 offset:20480
    ds_read_b64_tr_b16 v[118:119], v13 offset:20992
    s_add_u32 m0, s43, 98304
    s_add_u32 s46, s41, 4096
    buffer_load_dwordx4 v9, s[16:19], s46 offen lds
    v_mfma_f32_16x16x32_bf16 v[44:47], v[120:123], v[144:147], v[44:47]
    ds_read_b128 v[112:115], v3 offset:34816
    s_waitcnt vmcnt(16) lgkmcnt(0)
    s_barrier
    s_bfe_u32 s40, s95, 0x40018
    s_add_u32 s40, s89, s40
    s_and_b32 s40, s40, 15
    s_mul_i32 s41, s40, 393216
    s_lshl_b32 s40, s40, 7
    s_add_u32 s40, s40, s36
    s_add_u32 s42, s41, s47
    s_add_u32 s41, s41, s38
    s_add_u32 m0, s44, 32768
    s_add_u32 s46, s40, 0
    s_nop 0
    buffer_load_dwordx4 v5, s[12:15], s46 offen lds
    v_mfma_f32_16x16x32_bf16 v[16:19], v[156:159], v[160:163], v[16:19]
    ds_read_b128 v[140:143], v2 offset:49152
    s_add_u32 m0, s44, 33792
    s_add_u32 s46, s40, 16384
    buffer_load_dwordx4 v6, s[12:15], s46 offen lds
    v_mfma_f32_16x16x32_bf16 v[32:35], v[156:159], v[72:75], v[32:35]
    ds_read_b128 v[120:123], v2 offset:51200
    s_add_u32 m0, s44, 34816
    s_add_u32 s46, s40, 32768
    buffer_load_dwordx4 v5, s[12:15], s46 offen lds
    v_mfma_f32_16x16x32_bf16 v[20:23], v[128:131], v[160:163], v[20:23]
    ds_read_b128 v[144:147], v3 offset:49152
    s_add_u32 m0, s44, 35840
    s_add_u32 s46, s40, 49152
    buffer_load_dwordx4 v6, s[12:15], s46 offen lds
    v_mfma_f32_16x16x32_bf16 v[36:39], v[128:131], v[72:75], v[36:39]
    ds_read_b128 v[156:159], v3 offset:51200
    s_add_u32 m0, s45, 106496
    s_add_u32 s46, s41, 2048
    buffer_load_dwordx4 v8, s[16:19], s46 offen lds
    v_mfma_f32_16x16x32_bf16 v[24:27], v[136:139], v[160:163], v[24:27]
    s_add_u32 m0, s43, 106496
    s_add_u32 s46, s41, 2048
    buffer_load_dwordx4 v9, s[16:19], s46 offen lds
    v_mfma_f32_16x16x32_bf16 v[40:43], v[136:139], v[72:75], v[40:43]
    s_add_u32 m0, s45, 114688
    s_add_u32 s46, s41, 4096
    buffer_load_dwordx4 v8, s[16:19], s46 offen lds
    v_mfma_f32_16x16x32_bf16 v[28:31], v[116:119], v[160:163], v[28:31]
    s_add_u32 m0, s43, 114688
    s_add_u32 s46, s41, 4096
    buffer_load_dwordx4 v9, s[16:19], s46 offen lds
    v_mfma_f32_16x16x32_bf16 v[44:47], v[116:119], v[72:75], v[44:47]
    s_waitcnt vmcnt(16) lgkmcnt(0)
    s_barrier
    s_bfe_u32 s40, s95, 0x4001c
    s_add_u32 s40, s89, s40
    s_and_b32 s40, s40, 15
    s_mul_i32 s41, s40, 393216
    s_lshl_b32 s40, s40, 7
    s_add_u32 s40, s40, s36
    s_add_u32 s42, s41, s47
    s_add_u32 s41, s41, s38
    s_add_u32 m0, s44, 49152
    s_add_u32 s46, s40, 0
    s_nop 0
    buffer_load_dwordx4 v5, s[12:15], s46 offen lds
    s_add_u32 m0, s44, 50176
    s_add_u32 s46, s40, 16384
    buffer_load_dwordx4 v6, s[12:15], s46 offen lds
    s_add_u32 m0, s44, 51200
    s_add_u32 s46, s40, 32768
    buffer_load_dwordx4 v5, s[12:15], s46 offen lds
    s_add_u32 m0, s44, 52224
    s_add_u32 s46, s40, 49152
    buffer_load_dwordx4 v6, s[12:15], s46 offen lds
    s_add_u32 m0, s45, 65536
    s_add_u32 s46, s41, 2048
    buffer_load_dwordx4 v8, s[16:19], s46 offen lds
    s_add_u32 m0, s43, 65536
    s_add_u32 s46, s41, 2048
    buffer_load_dwordx4 v9, s[16:19], s46 offen lds
    s_add_u32 m0, s45, 122880
    s_add_u32 s46, s41, 4096
    buffer_load_dwordx4 v8, s[16:19], s46 offen lds
    s_add_u32 m0, s43, 122880
    s_add_u32 s46, s41, 4096
    buffer_load_dwordx4 v9, s[16:19], s46 offen lds
    s_waitcnt vmcnt(16)
    s_barrier
    s_bfe_u32 s40, s94, 0x40018
    s_add_u32 s40, s89, s40
    s_and_b32 s40, s40, 15
    s_mul_i32 s41, s40, 393216
    s_lshl_b32 s40, s40, 7
    s_add_u32 s40, s40, s36
    s_add_u32 s42, s41, s47
    s_add_u32 s41, s41, s38
    s_add_u32 m0, s45, 147456
    s_nop 0
    buffer_load_dwordx4 v8, s[16:19], s42 offen lds
    s_add_u32 m0, s43, 147456
    s_nop 0
    buffer_load_dwordx4 v9, s[16:19], s42 offen lds
    s_waitcnt vmcnt(10)
    s_barrier
    s_bfe_u32 s40, s95, 0x40010
    s_add_u32 s40, s89, s40
    s_and_b32 s40, s40, 15
    s_mul_i32 s41, s40, 393216
    s_lshl_b32 s40, s40, 7
    s_add_u32 s40, s40, s36
    s_add_u32 s42, s41, s47
    s_add_u32 s41, s41, s38
    s_add_u32 m0, s45, 139264
    s_nop 0
    buffer_load_dwordx4 v8, s[16:19], s42 offen lds
    s_add_u32 m0, s43, 139264
    s_nop 0
    buffer_load_dwordx4 v9, s[16:19], s42 offen lds
    s_waitcnt vmcnt(4)
    s_barrier
    s_bfe_u32 s40, s95, 0x40014
    s_add_u32 s40, s89, s40
    s_and_b32 s40, s40, 15
    s_mul_i32 s41, s40, 393216
    s_lshl_b32 s40, s40, 7
    s_add_u32 s40, s40, s36
    s_add_u32 s42, s41, s47
    s_add_u32 s41, s41, s38
    s_add_u32 m0, s45, 131072
    s_nop 0
    buffer_load_dwordx4 v8, s[16:19], s42 offen lds
    s_add_u32 m0, s43, 131072
    s_nop 0
    buffer_load_dwordx4 v9, s[16:19], s42 offen lds
    s_waitcnt vmcnt(6)
    s_barrier
    s_bfe_u32 s40, s95, 0x40018
    s_add_u32 s40, s89, s40
    s_and_b32 s40, s40, 15
    s_mul_i32 s41, s40, 393216
    s_lshl_b32 s40, s40, 7
    s_add_u32 s40, s40, s36
    s_add_u32 s42, s41, s47
    s_add_u32 s41, s41, s38
    s_add_u32 m0, s45, 81920
    s_nop 0
    buffer_load_dwordx4 v8, s[16:19], s42 offen lds
    s_add_u32 m0, s43, 81920
    s_nop 0
    buffer_load_dwordx4 v9, s[16:19], s42 offen lds
    s_bfe_u32 s40, s95, 0x4001c
    s_add_u32 s40, s89, s40
    s_branch IW_s1
IW_w1:
    s_branch IW_r1
IW_s1:
    s_and_b32 s40, s40, 15
    s_mul_i32 s41, s40, 393216
    s_lshl_b32 s40, s40, 7
    s_add_u32 s40, s40, s36
    s_add_u32 s42, s41, s47
    s_add_u32 s41, s41, s38
    s_add_u32 m0, s45, 73728
    s_nop 0
    buffer_load_dwordx4 v8, s[16:19], s42 offen lds
    s_add_u32 m0, s43, 73728
    s_nop 0
    buffer_load_dwordx4 v9, s[16:19], s42 offen lds
    s_bfe_u32 s40, s94, 0x4001c
    s_add_u32 s40, s89, s40
    s_and_b32 s40, s40, 15
    s_mul_i32 s41, s40, 393216
    s_lshl_b32 s40, s40, 7
    s_add_u32 s40, s40, s36
    s_add_u32 s42, s41, s47
    s_add_u32 s41, s41, s38
    s_add_u32 m0, s45, 98304
    s_nop 0
    buffer_load_dwordx4 v8, s[16:19], s42 offen lds
    s_add_u32 m0, s43, 98304
    s_nop 0
    buffer_load_dwordx4 v9, s[16:19], s42 offen lds
    s_bfe_u32 s40, s95, 0x40000
    s_add_u32 s40, s89, s40
    s_and_b32 s40, s40, 15
    s_mul_i32 s41, s40, 393216
    s_lshl_b32 s40, s40, 7
    s_add_u32 s40, s40, s36
    s_add_u32 s42, s41, s47
    s_add_u32 s41, s41, s38
    s_add_u32 m0, s45, 90112
    s_nop 0
    buffer_load_dwordx4 v8, s[16:19], s42 offen lds
    s_add_u32 m0, s43, 90112
    s_nop 0
    buffer_load_dwordx4 v9, s[16:19], s42 offen lds
    s_bfe_u32 s40, s95, 0x40004
    s_add_u32 s40, s89, s40
    s_and_b32 s40, s40, 15
    s_mul_i32 s41, s40, 393216
    s_lshl_b32 s40, s40, 7
    s_add_u32 s40, s40, s36
    s_add_u32 s42, s41, s47
    s_add_u32 s41, s41, s38
    s_add_u32 m0, s45, 114688
    s_nop 0
    buffer_load_dwordx4 v8, s[16:19], s42 offen lds
    s_add_u32 m0, s43, 114688
    s_nop 0
    buffer_load_dwordx4 v9, s[16:19], s42 offen lds
    s_bfe_u32 s40, s95, 0x40008
    s_add_u32 s40, s89, s40
    s_and_b32 s40, s40, 15
    s_mul_i32 s41, s40, 393216
    s_lshl_b32 s40, s40, 7
    s_add_u32 s40, s40, s36
    s_add_u32 s42, s41, s47
    s_add_u32 s41, s41, s38
    s_add_u32 m0, s45, 106496
    s_nop 0
    buffer_load_dwordx4 v8, s[16:19], s42 offen lds
    s_add_u32 m0, s43, 106496
    s_nop 0
    buffer_load_dwordx4 v9, s[16:19], s42 offen lds
    s_bfe_u32 s40, s95, 0x4000c
    s_add_u32 s40, s89, s40
    s_and_b32 s40, s40, 15
    s_mul_i32 s41, s40, 393216
    s_lshl_b32 s40, s40, 7
    s_add_u32 s40, s40, s36
    s_add_u32 s42, s41, s47
    s_add_u32 s41, s41, s38
    s_add_u32 m0, s45, 122880
    s_nop 0
    buffer_load_dwordx4 v8, s[16:19], s42 offen lds
    s_add_u32 m0, s43, 122880
    s_nop 0
    buffer_load_dwordx4 v9, s[16:19], s42 offen lds
    s_setprio 1
    v_subrev_u32 v5, 24576, v10
    v_subrev_u32 v6, 24576, v11
    v_subrev_u32 v8, 24576, v12
    v_subrev_u32 v9, 24576, v13
    s_add_u32 s16, s72, 0x400000
    s_addc_u32 s17, s73, 0
    s_mov_b32 s18, 0x400000
    s_mov_b32 s19, 0x00020000
    s_add_u32 s24, s72, 0x800000
    s_addc_u32 s25, s73, 0
    s_mov_b32 s26, 0x48000
    s_mov_b32 s27, 0x00020000
    s_waitcnt vmcnt(8)
    s_mov_b64 exec, 1
    ds_add_u32 v4, v164 offset:112
    s_mov_b64 exec, -1
    ds_read_b32 v7, v1 offset:32
FW_1:
    s_waitcnt lgkmcnt(0)
    v_cmp_gt_u32 vcc, 1, v7
    s_cbranch_vccz FO_2
    s_sleep 2
    ds_read_b32 v7, v1 offset:32
    s_branch FW_1
FO_2:
    ds_read_b32 v7, v1 offset:112
FW_3:
    s_waitcnt lgkmcnt(0)
    v_cmp_gt_u32 vcc, 1, v7
    s_cbranch_vccz FO_4
    ds_read_b32 v7, v1 offset:112
    s_branch FW_3
FO_4:
    s_nop 0
    ds_read_b64_tr_b16 v[128:129], v10 offset:57344
    ds_read_b64_tr_b16 v[130:131], v10 offset:57856
    ds_read_b64_tr_b16 v[136:137], v11 offset:57344
    ds_read_b64_tr_b16 v[138:139], v11 offset:57856
    ds_read_b64_tr_b16 v[160:161], v12 offset:57344
    ds_read_b64_tr_b16 v[162:163], v12 offset:57856
    ds_read_b64_tr_b16 v[116:117], v13 offset:57344
    ds_read_b64_tr_b16 v[118:119], v13 offset:57856
    ds_read_b64_tr_b16 v[72:73], v10 offset:61440
    ds_read_b64_tr_b16 v[74:75], v10 offset:61952
    s_waitcnt lgkmcnt(8)
    v_mfma_f32_16x16x32_bf16 v[16:19], v[128:131], v[48:51], v[16:19]
    v_mfma_f32_16x16x32_bf16 v[32:35], v[128:131], v[52:55], v[32:35]
    ds_read_b64_tr_b16 v[128:129], v11 offset:61440
    ds_read_b64_tr_b16 v[130:131], v11 offset:61952
    s_waitcnt lgkmcnt(8)
    v_mfma_f32_16x16x32_bf16 v[20:23], v[136:139], v[48:51], v[20:23]
    v_mfma_f32_16x16x32_bf16 v[36:39], v[136:139], v[52:55], v[36:39]
    ds_read_b64_tr_b16 v[136:137], v12 offset:61440
    ds_read_b64_tr_b16 v[138:139], v12 offset:61952
    s_waitcnt lgkmcnt(8)
    v_mfma_f32_16x16x32_bf16 v[24:27], v[160:163], v[48:51], v[24:27]
    v_mfma_f32_16x16x32_bf16 v[40:43], v[160:163], v[52:55], v[40:43]
    ds_read_b64_tr_b16 v[160:161], v13 offset:61440
    ds_read_b64_tr_b16 v[162:163], v13 offset:61952
    s_waitcnt lgkmcnt(8)
    v_mfma_f32_16x16x32_bf16 v[28:31], v[116:119], v[48:51], v[28:31]
    ds_read_b128 v[48:51], v2 offset:0
    v_mfma_f32_16x16x32_bf16 v[44:47], v[116:119], v[52:55], v[44:47]
    ds_read_b64_tr_b16 v[116:117], v10 offset:49152
    ds_read_b64_tr_b16 v[118:119], v10 offset:49664
    s_waitcnt lgkmcnt(9)
    v_mfma_f32_16x16x32_bf16 v[16:19], v[72:75], v[96:99], v[16:19]
    ds_read_b128 v[52:55], v2 offset:2048
    v_mfma_f32_16x16x32_bf16 v[32:35], v[72:75], v[104:107], v[32:35]
    ds_read_b64_tr_b16 v[72:73], v11 offset:49152
    ds_read_b64_tr_b16 v[74:75], v11 offset:49664
    s_waitcnt lgkmcnt(10)
    v_mfma_f32_16x16x32_bf16 v[20:23], v[128:131], v[96:99], v[20:23]
    v_mfma_f32_16x16x32_bf16 v[36:39], v[128:131], v[104:107], v[36:39]
    ds_read_b64_tr_b16 v[128:129], v12 offset:49152
    ds_read_b64_tr_b16 v[130:131], v12 offset:49664
    s_waitcnt lgkmcnt(10)
    v_mfma_f32_16x16x32_bf16 v[24:27], v[136:139], v[96:99], v[24:27]
    v_mfma_f32_16x16x32_bf16 v[40:43], v[136:139], v[104:107], v[40:43]
    ds_read_b64_tr_b16 v[136:137], v13 offset:49152
    ds_read_b64_tr_b16 v[138:139], v13 offset:49664
    s_waitcnt lgkmcnt(10)
    v_mfma_f32_16x16x32_bf16 v[28:31], v[160:163], v[96:99], v[28:31]
    ds_read_b128 v[96:99], v3 offset:0
    v_mfma_f32_16x16x32_bf16 v[44:47], v[160:163], v[104:107], v[44:47]
    ds_read_b64_tr_b16 v[160:161], v10 offset:53248
    ds_read_b64_tr_b16 v[162:163], v10 offset:53760
    s_waitcnt lgkmcnt(10)
    v_mfma_f32_16x16x32_bf16 v[16:19], v[116:119], v[48:51], v[16:19]
    ds_read_b128 v[104:107], v3 offset:2048
    s_waitcnt lgkmcnt(10)
    v_mfma_f32_16x16x32_bf16 v[32:35], v[116:119], v[52:55], v[32:35]
    ds_read_b64_tr_b16 v[116:117], v11 offset:53248
    ds_read_b64_tr_b16 v[118:119], v11 offset:53760
    s_waitcnt lgkmcnt(10)
    v_mfma_f32_16x16x32_bf16 v[20:23], v[72:75], v[48:51], v[20:23]
    v_mfma_f32_16x16x32_bf16 v[36:39], v[72:75], v[52:55], v[36:39]
    ds_read_b64_tr_b16 v[72:73], v12 offset:53248
    ds_read_b64_tr_b16 v[74:75], v12 offset:53760
    s_waitcnt lgkmcnt(10)
    v_mfma_f32_16x16x32_bf16 v[24:27], v[128:131], v[48:51], v[24:27]
    v_mfma_f32_16x16x32_bf16 v[40:43], v[128:131], v[52:55], v[40:43]
    ds_read_b64_tr_b16 v[128:129], v13 offset:53248
    ds_read_b64_tr_b16 v[130:131], v13 offset:53760
    s_waitcnt lgkmcnt(10)
    v_mfma_f32_16x16x32_bf16 v[28:31], v[136:139], v[48:51], v[28:31]
    ds_read_b128 v[48:51], v2 offset:16384
    v_mfma_f32_16x16x32_bf16 v[44:47], v[136:139], v[52:55], v[44:47]
    ds_read_b64_tr_b16 v[136:137], v10 offset:40960
    ds_read_b64_tr_b16 v[138:139], v10 offset:41472
    s_waitcnt lgkmcnt(10)
    v_mfma_f32_16x16x32_bf16 v[16:19], v[160:163], v[96:99], v[16:19]
    ds_read_b128 v[52:55], v2 offset:18432
    s_waitcnt lgkmcnt(10)
    v_mfma_f32_16x16x32_bf16 v[32:35], v[160:163], v[104:107], v[32:35]
    ds_read_b64_tr_b16 v[160:161], v11 offset:40960
    ds_read_b64_tr_b16 v[162:163], v11 offset:41472
    s_waitcnt lgkmcnt(10)
    v_mfma_f32_16x16x32_bf16 v[20:23], v[116:119], v[96:99], v[20:23]
    v_mfma_f32_16x16x32_bf16 v[36:39], v[116:119], v[104:107], v[36:39]
    ds_read_b64_tr_b16 v[116:117], v12 offset:40960
    ds_read_b64_tr_b16 v[118:119], v12 offset:41472
    s_waitcnt lgkmcnt(10)
    v_mfma_f32_16x16x32_bf16 v[24:27], v[72:75], v[96:99], v[24:27]
    v_mfma_f32_16x16x32_bf16 v[40:43], v[72:75], v[104:107], v[40:43]
    ds_read_b64_tr_b16 v[72:73], v13 offset:40960
    ds_read_b64_tr_b16 v[74:75], v13 offset:41472
    s_waitcnt lgkmcnt(10)
    v_mfma_f32_16x16x32_bf16 v[28:31], v[128:131], v[96:99], v[28:31]
    ds_read_b128 v[96:99], v3 offset:16384
    v_mfma_f32_16x16x32_bf16 v[44:47], v[128:131], v[104:107], v[44:47]
    ds_read_b64_tr_b16 v[128:129], v10 offset:45056
    ds_read_b64_tr_b16 v[130:131], v10 offset:45568
    s_waitcnt lgkmcnt(10)
    v_mfma_f32_16x16x32_bf16 v[16:19], v[136:139], v[48:51], v[16:19]
    ds_read_b128 v[104:107], v3 offset:18432
    s_waitcnt lgkmcnt(10)
    v_mfma_f32_16x16x32_bf16 v[32:35], v[136:139], v[52:55], v[32:35]
    ds_read_b64_tr_b16 v[136:137], v11 offset:45056
    ds_read_b64_tr_b16 v[138:139], v11 offset:45568
    s_waitcnt lgkmcnt(10)
    v_mfma_f32_16x16x32_bf16 v[20:23], v[160:163], v[48:51], v[20:23]
    v_mfma_f32_16x16x32_bf16 v[36:39], v[160:163], v[52:55], v[36:39]
    ds_read_b64_tr_b16 v[160:161], v12 offset:45056
    ds_read_b64_tr_b16 v[162:163], v12 offset:45568
    s_waitcnt lgkmcnt(10)
    v_mfma_f32_16x16x32_bf16 v[24:27], v[116:119], v[48:51], v[24:27]
    v_mfma_f32_16x16x32_bf16 v[40:43], v[116:119], v[52:55], v[40:43]
    ds_read_b64_tr_b16 v[116:117], v13 offset:45056
    ds_read_b64_tr_b16 v[118:119], v13 offset:45568
    s_waitcnt lgkmcnt(10)
    v_mfma_f32_16x16x32_bf16 v[28:31], v[72:75], v[48:51], v[28:31]
    ds_read_b128 v[48:51], v2 offset:32768
    v_mfma_f32_16x16x32_bf16 v[44:47], v[72:75], v[52:55], v[44:47]
    ds_read_b64_tr_b16 v[72:73], v5 offset:16384
    ds_read_b64_tr_b16 v[74:75], v5 offset:16896
    s_waitcnt lgkmcnt(10)
    v_mfma_f32_16x16x32_bf16 v[16:19], v[128:131], v[96:99], v[16:19]
    ds_read_b128 v[52:55], v2 offset:34816
    s_waitcnt lgkmcnt(10)
    v_mfma_f32_16x16x32_bf16 v[32:35], v[128:131], v[104:107], v[32:35]
    ds_read_b64_tr_b16 v[128:129], v6 offset:16384
    ds_read_b64_tr_b16 v[130:131], v6 offset:16896
    s_waitcnt lgkmcnt(10)
    v_mfma_f32_16x16x32_bf16 v[20:23], v[136:139], v[96:99], v[20:23]
    v_mfma_f32_16x16x32_bf16 v[36:39], v[136:139], v[104:107], v[36:39]
    ds_read_b64_tr_b16 v[136:137], v8 offset:16384
    ds_read_b64_tr_b16 v[138:139], v8 offset:16896
    s_waitcnt lgkmcnt(10)
    v_mfma_f32_16x16x32_bf16 v[24:27], v[160:163], v[96:99], v[24:27]
    v_mfma_f32_16x16x32_bf16 v[40:43], v[160:163], v[104:107], v[40:43]
    ds_read_b64_tr_b16 v[160:161], v9 offset:16384
    ds_read_b64_tr_b16 v[162:163], v9 offset:16896
    s_waitcnt lgkmcnt(10)
    v_mfma_f32_16x16x32_bf16 v[28:31], v[116:119], v[96:99], v[28:31]
    ds_read_b128 v[96:99], v3 offset:32768
    v_mfma_f32_16x16x32_bf16 v[44:47], v[116:119], v[104:107], v[44:47]
    ds_read_b64_tr_b16 v[116:117], v5 offset:20480
    ds_read_b64_tr_b16 v[118:119], v5 offset:20992
    s_waitcnt lgkmcnt(10)
    v_mfma_f32_16x16x32_bf16 v[16:19], v[72:75], v[48:51], v[16:19]
    ds_read_b128 v[104:107], v3 offset:34816
    s_waitcnt lgkmcnt(10)
    v_mfma_f32_16x16x32_bf16 v[32:35], v[72:75], v[52:55], v[32:35]
    ds_read_b64_tr_b16 v[72:73], v6 offset:20480
    ds_read_b64_tr_b16 v[74:75], v6 offset:20992
    s_waitcnt lgkmcnt(10)
    v_mfma_f32_16x16x32_bf16 v[20:23], v[128:131], v[48:51], v[20:23]
    v_mfma_f32_16x16x32_bf16 v[36:39], v[128:131], v[52:55], v[36:39]
    ds_read_b64_tr_b16 v[128:129], v8 offset:20480
    ds_read_b64_tr_b16 v[130:131], v8 offset:20992
    s_waitcnt lgkmcnt(10)
    v_mfma_f32_16x16x32_bf16 v[24:27], v[136:139], v[48:51], v[24:27]
    v_mfma_f32_16x16x32_bf16 v[40:43], v[136:139], v[52:55], v[40:43]
    ds_read_b64_tr_b16 v[136:137], v9 offset:20480
    ds_read_b64_tr_b16 v[138:139], v9 offset:20992
    s_waitcnt lgkmcnt(10)
    v_mfma_f32_16x16x32_bf16 v[28:31], v[160:163], v[48:51], v[28:31]
    s_waitcnt vmcnt(0)
    s_mov_b64 exec, 1
    ds_add_u32 v4, v164 offset:112
    s_mov_b64 exec, -1
    ds_read_b128 v[48:51], v2 offset:49152
    v_mfma_f32_16x16x32_bf16 v[44:47], v[160:163], v[52:55], v[44:47]
    ds_read_b64_tr_b16 v[160:161], v5 offset:8192
    ds_read_b64_tr_b16 v[162:163], v5 offset:8704
    s_waitcnt lgkmcnt(11)
    v_mfma_f32_16x16x32_bf16 v[16:19], v[116:119], v[96:99], v[16:19]
    ds_read_b128 v[52:55], v2 offset:51200
    s_waitcnt lgkmcnt(11)
    v_mfma_f32_16x16x32_bf16 v[32:35], v[116:119], v[104:107], v[32:35]
    ds_read_b64_tr_b16 v[116:117], v6 offset:8192
    ds_read_b64_tr_b16 v[118:119], v6 offset:8704
    s_waitcnt lgkmcnt(11)
    v_mfma_f32_16x16x32_bf16 v[20:23], v[72:75], v[96:99], v[20:23]
    v_mfma_f32_16x16x32_bf16 v[36:39], v[72:75], v[104:107], v[36:39]
    ds_read_b64_tr_b16 v[72:73], v8 offset:8192
    ds_read_b64_tr_b16 v[74:75], v8 offset:8704
    s_waitcnt lgkmcnt(9)
    v_mov_b32 v165, 4
    s_mov_b64 exec, 1
    ds_write_b32 v4, v165 offset:0
    s_mov_b64 exec, -1
    s_nop 0
    v_mfma_f32_16x16x32_bf16 v[24:27], v[128:131], v[96:99], v[24:27]
    v_mfma_f32_16x16x32_bf16 v[40:43], v[128:131], v[104:107], v[40:43]
    ds_read_b64_tr_b16 v[128:129], v9 offset:8192
    ds_read_b64_tr_b16 v[130:131], v9 offset:8704
    v_mfma_f32_16x16x32_bf16 v[28:31], v[136:139], v[96:99], v[28:31]
    ds_read_b128 v[96:99], v3 offset:49152
    v_mfma_f32_16x16x32_bf16 v[44:47], v[136:139], v[104:107], v[44:47]
    ds_read_b64_tr_b16 v[136:137], v5 offset:12288
    ds_read_b64_tr_b16 v[138:139], v5 offset:12800
    s_waitcnt lgkmcnt(11)
    v_mfma_f32_16x16x32_bf16 v[16:19], v[160:163], v[48:51], v[16:19]
    ds_read_b128 v[104:107], v3 offset:51200
    s_waitcnt lgkmcnt(11)
    v_mfma_f32_16x16x32_bf16 v[32:35], v[160:163], v[52:55], v[32:35]
    ds_read_b64_tr_b16 v[160:161], v6 offset:12288
    ds_read_b64_tr_b16 v[162:163], v6 offset:12800
    s_waitcnt lgkmcnt(11)
    v_mfma_f32_16x16x32_bf16 v[20:23], v[116:119], v[48:51], v[20:23]
    v_mfma_f32_16x16x32_bf16 v[36:39], v[116:119], v[52:55], v[36:39]
    ds_read_b64_tr_b16 v[116:117], v8 offset:12288
    ds_read_b64_tr_b16 v[118:119], v8 offset:12800
    s_waitcnt lgkmcnt(11)
    v_mfma_f32_16x16x32_bf16 v[24:27], v[72:75], v[48:51], v[24:27]
    v_mfma_f32_16x16x32_bf16 v[40:43], v[72:75], v[52:55], v[40:43]
    ds_read_b64_tr_b16 v[72:73], v9 offset:12288
    ds_read_b64_tr_b16 v[74:75], v9 offset:12800
    s_waitcnt lgkmcnt(10)
    v_mfma_f32_16x16x32_bf16 v[28:31], v[128:131], v[48:51], v[28:31]
    ds_read_b64_tr_b16 v[48:49], v10 offset:8192
    v_mfma_f32_16x16x32_bf16 v[44:47], v[128:131], v[52:55], v[44:47]
    ds_read_b64_tr_b16 v[50:51], v10 offset:8704
    ds_read_b64_tr_b16 v[128:129], v11 offset:8192
    s_waitcnt lgkmcnt(10)
    v_mfma_f32_16x16x32_bf16 v[16:19], v[136:139], v[96:99], v[16:19]
    ds_read_b64_tr_b16 v[130:131], v11 offset:8704
    s_waitcnt lgkmcnt(10)
    v_mfma_f32_16x16x32_bf16 v[32:35], v[136:139], v[104:107], v[32:35]
    ds_read_b64_tr_b16 v[52:53], v12 offset:8192
    ds_read_b64_tr_b16 v[54:55], v12 offset:8704
    s_waitcnt lgkmcnt(10)
    v_mfma_f32_16x16x32_bf16 v[20:23], v[160:163], v[96:99], v[20:23]
    ds_read_b64_tr_b16 v[136:137], v13 offset:8192
    v_mfma_f32_16x16x32_bf16 v[36:39], v[160:163], v[104:107], v[36:39]
    ds_read_b64_tr_b16 v[138:139], v13 offset:8704
    ds_read_b64_tr_b16 v[160:161], v10 offset:12288
    s_waitcnt lgkmcnt(11)
    v_mfma_f32_16x16x32_bf16 v[24:27], v[116:119], v[96:99], v[24:27]
    ds_read_b64_tr_b16 v[162:163], v10 offset:12800
    v_mfma_f32_16x16x32_bf16 v[40:43], v[116:119], v[104:107], v[40:43]
    ds_read_b64_tr_b16 v[116:117], v11 offset:12288
    ds_read_b64_tr_b16 v[118:119], v11 offset:12800
    s_waitcnt lgkmcnt(12)
    v_mfma_f32_16x16x32_bf16 v[28:31], v[72:75], v[96:99], v[28:31]
    ds_read_b64_tr_b16 v[96:97], v12 offset:12288
    v_mfma_f32_16x16x32_bf16 v[44:47], v[72:75], v[104:107], v[44:47]
    ds_read_b64_tr_b16 v[98:99], v12 offset:12800
    ds_read_b64_tr_b16 v[72:73], v13 offset:12288
    s_waitcnt lgkmcnt(13)
    v_mfma_f32_16x16x32_bf16 v[16:19], v[48:51], v[60:63], v[16:19]
    ds_read_b64_tr_b16 v[74:75], v13 offset:12800
    v_mfma_f32_16x16x32_bf16 v[32:35], v[48:51], v[132:135], v[32:35]
    ds_read_b32 v7, v1 offset:112
FW_5:
    s_waitcnt lgkmcnt(0)
    v_cmp_gt_u32 vcc, 2, v7
    s_cbranch_vccz FO_6
    ds_read_b32 v7, v1 offset:112
    s_branch FW_5
FO_6:
    s_nop 0
    ds_read_b64_tr_b16 v[104:105], v10 offset:0
    ds_read_b64_tr_b16 v[106:107], v10 offset:512
    v_mfma_f32_16x16x32_bf16 v[20:23], v[128:131], v[60:63], v[20:23]
    ds_read_b64_tr_b16 v[48:49], v11 offset:0
    v_mfma_f32_16x16x32_bf16 v[36:39], v[128:131], v[132:135], v[36:39]
    ds_read_b64_tr_b16 v[50:51], v11 offset:512
    ds_read_b64_tr_b16 v[128:129], v12 offset:0
    v_mfma_f32_16x16x32_bf16 v[24:27], v[52:55], v[60:63], v[24:27]
    ds_read_b64_tr_b16 v[130:131], v12 offset:512
    v_mfma_f32_16x16x32_bf16 v[40:43], v[52:55], v[132:135], v[40:43]
    ds_read_b64_tr_b16 v[52:53], v13 offset:0
    ds_read_b64_tr_b16 v[54:55], v13 offset:512
    v_mfma_f32_16x16x32_bf16 v[28:31], v[136:139], v[60:63], v[28:31]
    v_mfma_f32_16x16x32_bf16 v[44:47], v[136:139], v[132:135], v[44:47]
    v_mfma_f32_16x16x32_bf16 v[16:19], v[160:163], v[68:71], v[16:19]
    ds_read_b64_tr_b16 v[60:61], v10 offset:4096
    v_mfma_f32_16x16x32_bf16 v[32:35], v[160:163], v[152:155], v[32:35]
    ds_read_b64_tr_b16 v[62:63], v10 offset:4608
    ds_read_b64_tr_b16 v[136:137], v11 offset:4096
    v_mfma_f32_16x16x32_bf16 v[20:23], v[116:119], v[68:71], v[20:23]
    ds_read_b64_tr_b16 v[138:139], v11 offset:4608
    v_mfma_f32_16x16x32_bf16 v[36:39], v[116:119], v[152:155], v[36:39]
    ds_read_b64_tr_b16 v[132:133], v12 offset:4096
    ds_read_b64_tr_b16 v[134:135], v12 offset:4608
    v_mfma_f32_16x16x32_bf16 v[24:27], v[96:99], v[68:71], v[24:27]
    ds_read_b64_tr_b16 v[160:161], v13 offset:4096
    v_mfma_f32_16x16x32_bf16 v[40:43], v[96:99], v[152:155], v[40:43]
    s_waitcnt lgkmcnt(8)
    ds_read_b64_tr_b16 v[162:163], v13 offset:4608
    v_mfma_f32_16x16x32_bf16 v[28:31], v[72:75], v[68:71], v[28:31]
    v_mfma_f32_16x16x32_bf16 v[44:47], v[72:75], v[152:155], v[44:47]
    s_waitcnt lgkmcnt(14)
    v_mfma_f32_16x16x32_bf16 v[16:19], v[104:107], v[84:87], v[16:19]
    ds_read_b64_tr_b16 v[116:117], v10 offset:24576
    v_mfma_f32_16x16x32_bf16 v[32:35], v[104:107], v[92:95], v[32:35]
    ds_read_b64_tr_b16 v[118:119], v10 offset:25088
    ds_read_b64_tr_b16 v[96:97], v11 offset:24576
    s_waitcnt lgkmcnt(15)
    v_mfma_f32_16x16x32_bf16 v[20:23], v[48:51], v[84:87], v[20:23]
    ds_read_b64_tr_b16 v[98:99], v11 offset:25088
    v_mfma_f32_16x16x32_bf16 v[36:39], v[48:51], v[92:95], v[36:39]
    ds_read_b64_tr_b16 v[68:69], v12 offset:24576
    ds_read_b64_tr_b16 v[70:71], v12 offset:25088
    s_waitcnt lgkmcnt(15)
    v_mfma_f32_16x16x32_bf16 v[24:27], v[128:131], v[84:87], v[24:27]
    s_waitcnt lgkmcnt(8)
    ds_read_b64_tr_b16 v[72:73], v13 offset:24576
    v_mfma_f32_16x16x32_bf16 v[40:43], v[128:131], v[92:95], v[40:43]
    ds_read_b64_tr_b16 v[74:75], v13 offset:25088
    s_waitcnt lgkmcnt(15)
    v_mfma_f32_16x16x32_bf16 v[28:31], v[52:55], v[84:87], v[28:31]
    v_mfma_f32_16x16x32_bf16 v[44:47], v[52:55], v[92:95], v[44:47]
    s_waitcnt lgkmcnt(14)
    v_mfma_f32_16x16x32_bf16 v[16:19], v[60:63], v[100:103], v[16:19]
    ds_read_b64_tr_b16 v[152:153], v10 offset:28672
    v_mfma_f32_16x16x32_bf16 v[32:35], v[60:63], v[108:111], v[32:35]
    ds_read_b64_tr_b16 v[154:155], v10 offset:29184
    ds_read_b64_tr_b16 v[104:105], v11 offset:28672
    s_waitcnt lgkmcnt(15)
    v_mfma_f32_16x16x32_bf16 v[20:23], v[136:139], v[100:103], v[20:23]
    ds_read_b64_tr_b16 v[106:107], v11 offset:29184
    v_mfma_f32_16x16x32_bf16 v[36:39], v[136:139], v[108:111], v[36:39]
    ds_read_b64_tr_b16 v[48:49], v12 offset:28672
    s_waitcnt lgkmcnt(8)
    ds_read_b64_tr_b16 v[50:51], v12 offset:29184
    s_waitcnt lgkmcnt(15)
    v_mfma_f32_16x16x32_bf16 v[24:27], v[132:135], v[100:103], v[24:27]
    ds_read_b64_tr_b16 v[128:129], v13 offset:28672
    v_mfma_f32_16x16x32_bf16 v[40:43], v[132:135], v[108:111], v[40:43]
    ds_read_b64_tr_b16 v[130:131], v13 offset:29184
    s_waitcnt lgkmcnt(15)
    v_mfma_f32_16x16x32_bf16 v[28:31], v[160:163], v[100:103], v[28:31]
    v_mfma_f32_16x16x32_bf16 v[44:47], v[160:163], v[108:111], v[44:47]
    s_waitcnt lgkmcnt(14)
    v_mfma_f32_16x16x32_bf16 v[16:19], v[116:119], v[56:59], v[16:19]
    ds_read_b64_tr_b16 v[84:85], v10 offset:16384
    v_mfma_f32_16x16x32_bf16 v[32:35], v[116:119], v[124:127], v[32:35]
    ds_read_b64_tr_b16 v[86:87], v10 offset:16896
    ds_read_b64_tr_b16 v[52:53], v11 offset:16384
    s_waitcnt lgkmcnt(15)
    v_mfma_f32_16x16x32_bf16 v[20:23], v[96:99], v[56:59], v[20:23]
    ds_read_b64_tr_b16 v[54:55], v11 offset:16896
    v_mfma_f32_16x16x32_bf16 v[36:39], v[96:99], v[124:127], v[36:39]
    s_waitcnt lgkmcnt(8)
    ds_read_b64_tr_b16 v[92:93], v12 offset:16384
    ds_read_b64_tr_b16 v[94:95], v12 offset:16896
    s_waitcnt lgkmcnt(15)
    v_mfma_f32_16x16x32_bf16 v[24:27], v[68:71], v[56:59], v[24:27]
    ds_read_b64_tr_b16 v[60:61], v13 offset:16384
    v_mfma_f32_16x16x32_bf16 v[40:43], v[68:71], v[124:127], v[40:43]
    ds_read_b64_tr_b16 v[62:63], v13 offset:16896
    s_waitcnt lgkmcnt(15)
    v_mfma_f32_16x16x32_bf16 v[28:31], v[72:75], v[56:59], v[28:31]
    v_mfma_f32_16x16x32_bf16 v[44:47], v[72:75], v[124:127], v[44:47]
    s_waitcnt lgkmcnt(14)
    v_mfma_f32_16x16x32_bf16 v[16:19], v[152:155], v[76:79], v[16:19]
    ds_read_b64_tr_b16 v[136:137], v10 offset:20480
    v_mfma_f32_16x16x32_bf16 v[32:35], v[152:155], v[148:151], v[32:35]
    ds_read_b64_tr_b16 v[138:139], v10 offset:20992
    ds_read_b64_tr_b16 v[132:133], v11 offset:20480
    s_waitcnt lgkmcnt(15)
    v_mfma_f32_16x16x32_bf16 v[20:23], v[104:107], v[76:79], v[20:23]
    s_waitcnt lgkmcnt(8)
    ds_read_b64_tr_b16 v[134:135], v11 offset:20992
    v_mfma_f32_16x16x32_bf16 v[36:39], v[104:107], v[148:151], v[36:39]
    ds_read_b64_tr_b16 v[100:101], v12 offset:20480
    ds_read_b64_tr_b16 v[102:103], v12 offset:20992
    s_waitcnt lgkmcnt(15)
    v_mfma_f32_16x16x32_bf16 v[24:27], v[48:51], v[76:79], v[24:27]
    ds_read_b64_tr_b16 v[160:161], v13 offset:20480
    v_mfma_f32_16x16x32_bf16 v[40:43], v[48:51], v[148:151], v[40:43]
    ds_read_b64_tr_b16 v[162:163], v13 offset:20992
    s_waitcnt lgkmcnt(15)
    v_mfma_f32_16x16x32_bf16 v[28:31], v[128:131], v[76:79], v[28:31]
    v_mfma_f32_16x16x32_bf16 v[44:47], v[128:131], v[148:151], v[44:47]
    s_waitcnt lgkmcnt(14)
    v_mfma_f32_16x16x32_bf16 v[16:19], v[84:87], v[88:91], v[16:19]
    ds_read_b64_tr_b16 v[108:109], v10 offset:32768
    v_mfma_f32_16x16x32_bf16 v[32:35], v[84:87], v[64:67], v[32:35]
    ds_read_b64_tr_b16 v[110:111], v10 offset:33280
    s_waitcnt lgkmcnt(8)
    ds_read_b64_tr_b16 v[116:117], v11 offset:32768
    s_waitcnt lgkmcnt(15)
    v_mfma_f32_16x16x32_bf16 v[20:23], v[52:55], v[88:91], v[20:23]
    ds_read_b64_tr_b16 v[118:119], v11 offset:33280
    v_mfma_f32_16x16x32_bf16 v[36:39], v[52:55], v[64:67], v[36:39]
    ds_read_b64_tr_b16 v[96:97], v12 offset:32768
    ds_read_b64_tr_b16 v[98:99], v12 offset:33280
    s_waitcnt lgkmcnt(15)
    v_mfma_f32_16x16x32_bf16 v[24:27], v[92:95], v[88:91], v[24:27]
    ds_read_b64_tr_b16 v[68:69], v13 offset:32768
    v_mfma_f32_16x16x32_bf16 v[40:43], v[92:95], v[64:67], v[40:43]
    ds_read_b64_tr_b16 v[70:71], v13 offset:33280
    s_waitcnt lgkmcnt(15)
    v_mfma_f32_16x16x32_bf16 v[28:31], v[60:63], v[88:91], v[28:31]
    v_mfma_f32_16x16x32_bf16 v[44:47], v[60:63], v[64:67], v[44:47]
    s_waitcnt lgkmcnt(14)
    v_mfma_f32_16x16x32_bf16 v[16:19], v[136:139], v[80:83], v[16:19]
    ds_read_b64_tr_b16 v[56:57], v10 offset:36864
    v_mfma_f32_16x16x32_bf16 v[32:35], v[136:139], v[112:115], v[32:35]
    s_waitcnt lgkmcnt(8)
    ds_read_b64_tr_b16 v[58:59], v10 offset:37376
    ds_read_b64_tr_b16 v[72:73], v11 offset:36864
    s_waitcnt lgkmcnt(15)
    v_mfma_f32_16x16x32_bf16 v[20:23], v[132:135], v[80:83], v[20:23]
    ds_read_b64_tr_b16 v[74:75], v11 offset:37376
    v_mfma_f32_16x16x32_bf16 v[36:39], v[132:135], v[112:115], v[36:39]
    ds_read_b64_tr_b16 v[124:125], v12 offset:36864
    ds_read_b64_tr_b16 v[126:127], v12 offset:37376
    s_waitcnt lgkmcnt(15)
    v_mfma_f32_16x16x32_bf16 v[24:27], v[100:103], v[80:83], v[24:27]
    ds_read_b64_tr_b16 v[152:153], v13 offset:36864
    v_mfma_f32_16x16x32_bf16 v[40:43], v[100:103], v[112:115], v[40:43]
    ds_read_b64_tr_b16 v[154:155], v13 offset:37376
    s_waitcnt lgkmcnt(15)
    v_mfma_f32_16x16x32_bf16 v[28:31], v[160:163], v[80:83], v[28:31]
    v_mfma_f32_16x16x32_bf16 v[44:47], v[160:163], v[112:115], v[44:47]
    s_waitcnt lgkmcnt(14)
    v_mfma_f32_16x16x32_bf16 v[16:19], v[108:111], v[140:143], v[16:19]
    v_mfma_f32_16x16x32_bf16 v[32:35], v[108:111], v[120:123], v[32:35]
    s_waitcnt lgkmcnt(12)
    v_mfma_f32_16x16x32_bf16 v[20:23], v[116:119], v[140:143], v[20:23]
    s_waitcnt lgkmcnt(0)
    v_mov_b32 v165, 10
    s_mov_b64 exec, 1
    ds_write_b32 v4, v165 offset:0
    s_mov_b64 exec, -1
    s_nop 0
    v_mfma_f32_16x16x32_bf16 v[36:39], v[116:119], v[120:123], v[36:39]
    v_mfma_f32_16x16x32_bf16 v[24:27], v[96:99], v[140:143], v[24:27]
    v_mfma_f32_16x16x32_bf16 v[40:43], v[96:99], v[120:123], v[40:43]
    v_mfma_f32_16x16x32_bf16 v[28:31], v[68:71], v[140:143], v[28:31]
    v_mfma_f32_16x16x32_bf16 v[44:47], v[68:71], v[120:123], v[44:47]
    v_mfma_f32_16x16x32_bf16 v[16:19], v[56:59], v[144:147], v[16:19]
    v_mfma_f32_16x16x32_bf16 v[32:35], v[56:59], v[156:159], v[32:35]
    v_mfma_f32_16x16x32_bf16 v[20:23], v[72:75], v[144:147], v[20:23]
    v_mfma_f32_16x16x32_bf16 v[36:39], v[72:75], v[156:159], v[36:39]
    v_mfma_f32_16x16x32_bf16 v[24:27], v[124:127], v[144:147], v[24:27]
    v_mfma_f32_16x16x32_bf16 v[40:43], v[124:127], v[156:159], v[40:43]
    v_mfma_f32_16x16x32_bf16 v[28:31], v[152:155], v[144:147], v[28:31]
    v_mfma_f32_16x16x32_bf16 v[44:47], v[152:155], v[156:159], v[44:47]
    s_setprio 3
    s_mov_b32 s40, 0x21317218
    s_mov_b32 s41, s40
    s_mov_b32 s74, 0x358637bd
    s_mov_b32 s75, s74
    s_mov_b32 s76, 0x5d800000
    s_mov_b32 s77, s76
    v_and_b32 v2, 15, v0
    v_lshlrev_b32 v2, 2, v2
    s_lshl_b32 s42, s3, 7
    s_add_u32 s42, s42, 155648
    v_add_u32 v2, s42, v2
    v_add_u32 v3, 1024, v2
    v_and_b32_e64 v5, 0x30, v0
    v_add_u32 v5, 158208, v5

    ds_read2_b32 v[48:49], v2 offset0:0 offset1:0
    ds_read2_b32 v[50:51], v2 offset0:16 offset1:16
    ds_read_b128 v[56:59], v5 offset:0
    ds_read_b128 v[60:63], v5 offset:64
    ds_read_b128 v[64:67], v5 offset:128
    ds_read_b128 v[68:71], v5 offset:192
    ds_read2_b32 v[52:53], v3 offset0:0 offset1:0
    ds_read2_b32 v[54:55], v3 offset0:16 offset1:16
    v_lshlrev_b32 v6, 4, v0
    v_lshlrev_b32 v8, 2, v0
    v_add_u32 v8, 40960, v8
    s_lshl_b32 s79, s32, 18
    s_lshl_b32 s80, s3, 16
    s_add_u32 s79, s79, s80
    s_lshl_b32 s80, s10, 11
    s_add_u32 s79, s79, s80
    s_add_u32 s80, s79, 0x8000
    s_lshl_b32 s45, s32, 2
    s_add_u32 s45, s45, s3
    s_lshl_b32 s45, s45, 10
    s_mov_b32 s46, 0x3fb8aa3b
    v_mov_b32 v11, 0x35c1a2a0

    s_add_u32 s54, s45, 0x835000
    s_add_u32 s54, s72, s54
    s_addc_u32 s55, s73, 0
    s_waitcnt lgkmcnt(5)
    v_pk_fma_f32 v[16:17], v[56:57], v[48:49], v[16:17]
    v_pk_fma_f32 v[18:19], v[58:59], v[48:49], v[18:19]
    v_pk_fma_f32 v[32:33], v[56:57], v[50:51], v[32:33]
    v_pk_fma_f32 v[34:35], v[58:59], v[50:51], v[34:35]
    s_waitcnt lgkmcnt(4)
    v_pk_fma_f32 v[20:21], v[60:61], v[48:49], v[20:21]
    v_pk_fma_f32 v[22:23], v[62:63], v[48:49], v[22:23]
    v_pk_fma_f32 v[36:37], v[60:61], v[50:51], v[36:37]
    v_pk_fma_f32 v[38:39], v[62:63], v[50:51], v[38:39]
    s_waitcnt lgkmcnt(3)
    s_branch IW_s2
IW_w2:
    s_branch IW_r2
IW_s2:
    v_pk_fma_f32 v[24:25], v[64:65], v[48:49], v[24:25]
    v_pk_fma_f32 v[26:27], v[66:67], v[48:49], v[26:27]
    v_pk_fma_f32 v[40:41], v[64:65], v[50:51], v[40:41]
    v_pk_fma_f32 v[42:43], v[66:67], v[50:51], v[42:43]
    s_waitcnt lgkmcnt(2)
    v_pk_fma_f32 v[28:29], v[68:69], v[48:49], v[28:29]
    v_pk_fma_f32 v[30:31], v[70:71], v[48:49], v[30:31]
    v_pk_fma_f32 v[44:45], v[68:69], v[50:51], v[44:45]
    v_pk_fma_f32 v[46:47], v[70:71], v[50:51], v[46:47]
    s_waitcnt lgkmcnt(1)
    s_nop 0
    v_pk_mul_f32 v[16:17], v[16:17], v[52:53]
    v_pk_mul_f32 v[18:19], v[18:19], v[52:53]
    v_pk_mul_f32 v[20:21], v[20:21], v[52:53]
    v_pk_mul_f32 v[22:23], v[22:23], v[52:53]
    v_pk_mul_f32 v[24:25], v[24:25], v[52:53]
    v_pk_mul_f32 v[26:27], v[26:27], v[52:53]
    v_pk_mul_f32 v[28:29], v[28:29], v[52:53]
    v_pk_mul_f32 v[30:31], v[30:31], v[52:53]
    s_waitcnt lgkmcnt(0)
    s_nop 0
    v_pk_mul_f32 v[32:33], v[32:33], v[54:55]
    v_pk_mul_f32 v[34:35], v[34:35], v[54:55]
    v_pk_mul_f32 v[36:37], v[36:37], v[54:55]
    v_pk_mul_f32 v[38:39], v[38:39], v[54:55]
    v_pk_mul_f32 v[40:41], v[40:41], v[54:55]
    v_pk_mul_f32 v[42:43], v[42:43], v[54:55]
    v_pk_mul_f32 v[44:45], v[44:45], v[54:55]
    v_pk_mul_f32 v[46:47], v[46:47], v[54:55]
    v_exp_f32 v80, v16 clamp
    v_exp_f32 v81, v17 clamp
    v_exp_f32 v82, v18 clamp
    v_exp_f32 v83, v19 clamp
    v_exp_f32 v84, v20 clamp
    v_exp_f32 v85, v21 clamp
    v_exp_f32 v86, v22 clamp
    v_exp_f32 v87, v23 clamp
    v_exp_f32 v88, v24 clamp
    v_exp_f32 v89, v25 clamp
    v_exp_f32 v90, v26 clamp
    v_exp_f32 v91, v27 clamp
    v_exp_f32 v92, v28 clamp
    v_exp_f32 v93, v29 clamp
    v_exp_f32 v94, v30 clamp
    v_exp_f32 v95, v31 clamp
    v_exp_f32 v96, v32 clamp
    v_exp_f32 v97, v33 clamp
    v_exp_f32 v98, v34 clamp
    v_exp_f32 v99, v35 clamp
    v_exp_f32 v100, v36 clamp
    v_exp_f32 v101, v37 clamp
    v_exp_f32 v102, v38 clamp
    v_exp_f32 v103, v39 clamp
    v_exp_f32 v104, v40 clamp
    v_exp_f32 v105, v41 clamp
    v_exp_f32 v106, v42 clamp
    v_exp_f32 v107, v43 clamp
    v_exp_f32 v108, v44 clamp
    v_exp_f32 v109, v45 clamp
    v_exp_f32 v110, v46 clamp
    v_exp_f32 v111, v47 clamp
    v_pk_mul_f32 v[16:17], v[16:17], s[40:41] clamp
    v_pk_mul_f32 v[18:19], v[18:19], s[40:41] clamp
    v_pk_mul_f32 v[20:21], v[20:21], s[40:41] clamp
    v_pk_mul_f32 v[22:23], v[22:23], s[40:41] clamp
    v_pk_mul_f32 v[24:25], v[24:25], s[40:41] clamp
    v_pk_mul_f32 v[26:27], v[26:27], s[40:41] clamp
    v_pk_mul_f32 v[28:29], v[28:29], s[40:41] clamp
    v_pk_mul_f32 v[30:31], v[30:31], s[40:41] clamp
    v_pk_mul_f32 v[32:33], v[32:33], s[40:41] clamp
    v_pk_mul_f32 v[34:35], v[34:35], s[40:41] clamp
    v_pk_mul_f32 v[36:37], v[36:37], s[40:41] clamp
    v_pk_mul_f32 v[38:39], v[38:39], s[40:41] clamp
    v_pk_mul_f32 v[40:41], v[40:41], s[40:41] clamp
    v_pk_mul_f32 v[42:43], v[42:43], s[40:41] clamp
    v_pk_mul_f32 v[44:45], v[44:45], s[40:41] clamp
    v_pk_mul_f32 v[46:47], v[46:47], s[40:41] clamp
    v_pk_add_f32 v[80:81], v[80:81], s[74:75]
    v_pk_add_f32 v[82:83], v[82:83], s[74:75]
    v_pk_add_f32 v[84:85], v[84:85], s[74:75]
    v_pk_add_f32 v[86:87], v[86:87], s[74:75]
    v_pk_add_f32 v[88:89], v[88:89], s[74:75]
    v_pk_add_f32 v[90:91], v[90:91], s[74:75]
    v_pk_add_f32 v[92:93], v[92:93], s[74:75]
    v_pk_add_f32 v[94:95], v[94:95], s[74:75]
    v_pk_add_f32 v[96:97], v[96:97], s[74:75]
    v_pk_add_f32 v[98:99], v[98:99], s[74:75]
    v_pk_add_f32 v[100:101], v[100:101], s[74:75]
    v_pk_add_f32 v[102:103], v[102:103], s[74:75]
    v_pk_add_f32 v[104:105], v[104:105], s[74:75]
    v_pk_add_f32 v[106:107], v[106:107], s[74:75]
    v_pk_add_f32 v[108:109], v[108:109], s[74:75]
    v_pk_add_f32 v[110:111], v[110:111], s[74:75]
    v_pk_fma_f32 v[16:17], v[16:17], s[76:77], v[80:81]
    v_pk_fma_f32 v[18:19], v[18:19], s[76:77], v[82:83]
    v_pk_fma_f32 v[20:21], v[20:21], s[76:77], v[84:85]
    v_pk_fma_f32 v[22:23], v[22:23], s[76:77], v[86:87]
    v_pk_fma_f32 v[24:25], v[24:25], s[76:77], v[88:89]
    v_pk_fma_f32 v[26:27], v[26:27], s[76:77], v[90:91]
    v_pk_fma_f32 v[28:29], v[28:29], s[76:77], v[92:93]
    v_pk_fma_f32 v[30:31], v[30:31], s[76:77], v[94:95]
    v_pk_fma_f32 v[32:33], v[32:33], s[76:77], v[96:97]
    v_pk_fma_f32 v[34:35], v[34:35], s[76:77], v[98:99]
    v_pk_fma_f32 v[36:37], v[36:37], s[76:77], v[100:101]
    v_pk_fma_f32 v[38:39], v[38:39], s[76:77], v[102:103]
    v_pk_fma_f32 v[40:41], v[40:41], s[76:77], v[104:105]
    v_pk_fma_f32 v[42:43], v[42:43], s[76:77], v[106:107]
    v_pk_fma_f32 v[44:45], v[44:45], s[76:77], v[108:109]
    v_pk_fma_f32 v[46:47], v[46:47], s[76:77], v[110:111]
    v_cvt_pk_bf16_f32 v112, v16, v17
    v_cvt_pk_bf16_f32 v113, v18, v19
    v_cvt_pk_bf16_f32 v114, v20, v21
    v_cvt_pk_bf16_f32 v115, v22, v23
    v_cvt_pk_bf16_f32 v116, v24, v25
    v_cvt_pk_bf16_f32 v117, v26, v27
    v_cvt_pk_bf16_f32 v118, v28, v29
    v_cvt_pk_bf16_f32 v119, v30, v31
    v_cvt_pk_bf16_f32 v120, v32, v33
    v_cvt_pk_bf16_f32 v121, v34, v35
    v_cvt_pk_bf16_f32 v122, v36, v37
    v_cvt_pk_bf16_f32 v123, v38, v39
    v_cvt_pk_bf16_f32 v124, v40, v41
    v_cvt_pk_bf16_f32 v125, v42, v43
    v_cvt_pk_bf16_f32 v126, v44, v45
    v_cvt_pk_bf16_f32 v127, v46, v47
    v_and_b32 v9, 0xfffffff7, v1
    v_and_b32 v5, 0x30, v0
    v_add_u32 v5, 159232, v5
    ds_read_b32 v7, v9 offset:128
FW_7:
    s_waitcnt lgkmcnt(0)
    v_cmp_gt_u32 vcc, 1, v7
    s_cbranch_vccz FO_8
    s_sleep 1
    ds_read_b32 v7, v9 offset:128
    s_branch FW_7
FO_8:
    ds_read_b32 v7, v9 offset:128
FW_9:
    s_waitcnt lgkmcnt(0)
    v_cmp_gt_u32 vcc, 2, v7
    s_cbranch_vccz FO_10
    ds_read_b32 v7, v9 offset:128
    s_branch FW_9
FO_10:
    s_nop 0
    ds_read_b128 v[32:35], v5 offset:0
    ds_read_b128 v[36:39], v5 offset:64
    ds_read2st64_b32 v[16:17], v8 offset0:0 offset1:1
    ds_read2st64_b32 v[18:19], v8 offset0:2 offset1:3
    ds_read2st64_b32 v[20:21], v8 offset0:4 offset1:5
    ds_read2st64_b32 v[22:23], v8 offset0:6 offset1:7
    ds_read2st64_b32 v[24:25], v8 offset0:16 offset1:17
    ds_read2st64_b32 v[26:27], v8 offset0:18 offset1:19
    ds_read2st64_b32 v[28:29], v8 offset0:20 offset1:21
    ds_read2st64_b32 v[30:31], v8 offset0:22 offset1:23
    s_waitcnt lgkmcnt(5)
    s_nop 0
    ds_read_b128 v[56:59], v5 offset:128
    ds_read_b128 v[60:63], v5 offset:192
    ds_read2st64_b32 v[40:41], v8 offset0:8 offset1:9
    ds_read2st64_b32 v[42:43], v8 offset0:10 offset1:11
    ds_read2st64_b32 v[44:45], v8 offset0:12 offset1:13
    ds_read2st64_b32 v[46:47], v8 offset0:14 offset1:15
    ds_read2st64_b32 v[48:49], v8 offset0:24 offset1:25
    ds_read2st64_b32 v[50:51], v8 offset0:26 offset1:27
    ds_read2st64_b32 v[52:53], v8 offset0:28 offset1:29
    ds_read2st64_b32 v[54:55], v8 offset0:30 offset1:31
    s_waitcnt lgkmcnt(10)
    v_cvt_pk_bf16_f32 v136, v32, v33
    v_cvt_pk_bf16_f32 v137, v34, v35
    v_cvt_pk_bf16_f32 v138, v36, v37
    v_cvt_pk_bf16_f32 v139, v38, v39
    s_nop 1
    v_mfma_f32_16x16x32_bf16 v[72:75], v[136:139], v[112:115], 0
    v_mfma_f32_16x16x32_bf16 v[84:87], v[136:139], v[120:123], 0
    v_cvt_pk_bf16_f32 v128, v16, v17
    v_cvt_pk_bf16_f32 v129, v18, v19
    v_cvt_pk_bf16_f32 v130, v20, v21
    v_cvt_pk_bf16_f32 v131, v22, v23
    s_nop 1
    v_mfma_f32_16x16x32_bf16 v[64:67], v[128:131], v[112:115], 0
    v_mfma_f32_16x16x32_bf16 v[76:79], v[128:131], v[120:123], 0
    v_cvt_pk_bf16_f32 v132, v24, v25
    v_cvt_pk_bf16_f32 v133, v26, v27
    v_cvt_pk_bf16_f32 v134, v28, v29
    v_cvt_pk_bf16_f32 v135, v30, v31
    s_nop 1
    v_mfma_f32_16x16x32_bf16 v[68:71], v[132:135], v[112:115], 0
    v_mfma_f32_16x16x32_bf16 v[80:83], v[132:135], v[120:123], 0
    s_waitcnt lgkmcnt(0)
    v_cvt_pk_bf16_f32 v148, v56, v57
    v_cvt_pk_bf16_f32 v149, v58, v59
    v_cvt_pk_bf16_f32 v150, v60, v61
    v_cvt_pk_bf16_f32 v151, v62, v63
    v_fma_f32 v72, v72, s46, v11
    v_rcp_f32 v72, v72
    v_fma_f32 v84, v84, s46, v11
    v_rcp_f32 v84, v84
    v_mfma_f32_16x16x32_bf16 v[96:99], v[148:151], v[116:119], 0
    v_mfma_f32_16x16x32_bf16 v[108:111], v[148:151], v[124:127], 0
    v_cvt_pk_bf16_f32 v140, v40, v41
    v_cvt_pk_bf16_f32 v141, v42, v43
    v_cvt_pk_bf16_f32 v142, v44, v45
    v_cvt_pk_bf16_f32 v143, v46, v47
    s_nop 1
    v_mfma_f32_16x16x32_bf16 v[88:91], v[140:143], v[116:119], 0
    v_mfma_f32_16x16x32_bf16 v[100:103], v[140:143], v[124:127], 0
    v_mul_f32 v64, v64, v72
    v_mul_f32 v65, v65, v72
    v_mul_f32 v66, v66, v72
    v_mul_f32 v67, v67, v72
    v_mul_f32 v68, v68, v72
    v_mul_f32 v69, v69, v72
    v_mul_f32 v70, v70, v72
    v_mul_f32 v71, v71, v72
    v_cvt_pk_bf16_f32 v16, v64, v65
    v_cvt_pk_bf16_f32 v17, v66, v67
    v_cvt_pk_bf16_f32 v18, v68, v69
    v_cvt_pk_bf16_f32 v19, v70, v71
    buffer_store_dwordx4 v[16:19], v6, s[16:19], s79 offen offset:0 sc0 sc1
    v_cvt_pk_bf16_f32 v144, v48, v49
    v_cvt_pk_bf16_f32 v145, v50, v51
    v_cvt_pk_bf16_f32 v146, v52, v53
    v_cvt_pk_bf16_f32 v147, v54, v55
    s_nop 1
    v_mfma_f32_16x16x32_bf16 v[92:95], v[144:147], v[116:119], 0
    v_mfma_f32_16x16x32_bf16 v[104:107], v[144:147], v[124:127], 0
    v_mul_f32 v76, v76, v84
    v_mul_f32 v77, v77, v84
    v_mul_f32 v78, v78, v84
    v_mul_f32 v79, v79, v84
    v_mul_f32 v80, v80, v84
    v_mul_f32 v81, v81, v84
    v_mul_f32 v82, v82, v84
    v_mul_f32 v83, v83, v84
    v_cvt_pk_bf16_f32 v20, v76, v77
    v_cvt_pk_bf16_f32 v21, v78, v79
    v_cvt_pk_bf16_f32 v22, v80, v81
    v_cvt_pk_bf16_f32 v23, v82, v83
    buffer_store_dwordx4 v[20:23], v6, s[16:19], s80 offen offset:0 sc0 sc1
    v_fma_f32 v96, v96, s46, v11
    v_rcp_f32 v96, v96
    v_fma_f32 v108, v108, s46, v11
    v_rcp_f32 v108, v108
    v_mul_f32 v88, v88, v96
    v_mul_f32 v89, v89, v96
    v_mul_f32 v90, v90, v96
    v_mul_f32 v91, v91, v96
    v_mul_f32 v92, v92, v96
    v_mul_f32 v93, v93, v96
    v_mul_f32 v94, v94, v96
    v_mul_f32 v95, v95, v96
    v_cvt_pk_bf16_f32 v24, v88, v89
    v_cvt_pk_bf16_f32 v25, v90, v91
    v_cvt_pk_bf16_f32 v26, v92, v93
    v_cvt_pk_bf16_f32 v27, v94, v95
    buffer_store_dwordx4 v[24:27], v6, s[16:19], s79 offen offset:1024 sc0 sc1
    v_mul_f32 v100, v100, v108
    v_mul_f32 v101, v101, v108
    v_mul_f32 v102, v102, v108
    v_mul_f32 v103, v103, v108
    v_mul_f32 v104, v104, v108
    v_mul_f32 v105, v105, v108
    v_mul_f32 v106, v106, v108
    v_mul_f32 v107, v107, v108
    v_cvt_pk_bf16_f32 v28, v100, v101
    v_cvt_pk_bf16_f32 v29, v102, v103
    v_cvt_pk_bf16_f32 v30, v104, v105
    v_cvt_pk_bf16_f32 v31, v106, v107
    buffer_store_dwordx4 v[28:31], v6, s[16:19], s80 offen offset:1024 sc0 sc1
    s_mov_b64 exec, 1
    ds_write_b32 v4, v164 offset:144
    s_waitcnt vmcnt(0)
    s_mov_b32 s45, 1
    s_atomic_add s45, s[54:55], 0x0
    s_atomic_add s45, s[54:55], 0x80
    s_atomic_add s45, s[54:55], 0x100
    s_atomic_add s45, s[54:55], 0x180
    ds_add_u32 v4, v164 offset:144
    s_mov_b64 exec, -1
    s_cmp_lg_u32 s3, 0
    s_cbranch_scc1 F_end
    s_setprio 3
    s_lshr_b32 s50, s29, 1
    s_lshl_b32 s50, s50, 2
    s_and_b32 s51, s28, 3
    s_add_u32 s50, s50, s51
    s_lshl_b32 s50, s50, 7
    s_add_u32 s56, s50, 0x845000
    s_add_u32 s56, s72, s56
    s_addc_u32 s57, s73, 0
    v_mov_b32 v2, 159096
    ds_read_b32 v7, v2 offset:0
FW_11:
    s_waitcnt lgkmcnt(0)
    v_cmp_gt_u32 vcc, 1, v7
    s_cbranch_vccz FO_12
    s_sleep 2
    ds_read_b32 v7, v2 offset:0
    s_branch FW_11
FO_12:
    v_and_b32 v2, 7, v0
    v_lshlrev_b32 v2, 2, v2
    v_add_u32 v2, 158976, v2
    ds_read_b32 v2, v2
    s_sub_u32 s51, 15, s28
    s_waitcnt lgkmcnt(0)
    v_bfe_u32 v2, v2, 7, 4
    v_cmp_eq_u32 vcc, s51, v2
    s_cbranch_vccz F_ny

    v_lshrrev_b32 v2, 4, v0
    v_and_b32 v6, 15, v0
    v_lshlrev_b32 v6, 4, v6
    v_lshl_add_u32 v2, v2, 12, v6
    s_lshl_b32 s50, s29, 8
    s_add_u32 s50, s50, 135168

SP_13:
    s_load_dword s58, s[56:57], 0 glc
    s_waitcnt lgkmcnt(0)
    s_cmp_ge_u32 s58, 32
    s_cbranch_scc1 SD_14
    s_sleep 2
    s_branch SP_13
SD_14:
    s_mov_b32 m0, 159744
    s_nop 0
    buffer_load_dwordx4 v2, s[24:27], s50 offen sc0 sc1 lds
    s_add_u32 s50, s50, 16384
    s_add_u32 m0, m0, 1024
    s_nop 0
    buffer_load_dwordx4 v2, s[24:27], s50 offen sc0 sc1 lds
    s_waitcnt vmcnt(0)
    v_mov_b32 v7, 1
    s_mov_b64 exec, 1
    ds_write_b32 v4, v7 offset:96
    s_mov_b64 exec, -1
F_ny:
F_end:
    s_endpgm
F_nl:
    s_sub_u32 s3, s3, 4
    s_setprio 2
    s_lshr_b32 s36, s3, 1
    s_and_b32 s37, s3, 1
    v_and_b32 v1, 15, v0
    v_lshrrev_b32 v2, 4, v0
    v_lshrrev_b32 v3, 1, v1
    v_xor_b32 v3, v3, v2
    v_lshlrev_b32 v3, 4, v3
    v_lshlrev_b32 v1, 7, v1
    s_lshl_b32 s38, s36, 13
    v_add3_u32 v4, v1, v3, s38
    v_xor_b32 v5, 64, v4
    v_add_u32 v6, 0x10000, v4
    v_add_u32 v7, 0x10000, v5
    v_bfe_u32 v1, v0, 2, 2
    v_lshl_add_u32 v3, v2, 3, v1
    v_lshrrev_b32 v1, 1, v1
    v_and_b32 v2, 1, v2
    v_lshl_add_u32 v1, v2, 1, v1
    s_lshl_b32 s38, s37, 1
    s_add_u32 s38, s38, s36
    v_xor_b32 v1, s38, v1
    v_lshlrev_b32 v1, 5, v1
    v_lshl_add_u32 v1, v3, 7, v1
    v_and_b32 v2, 3, v0
    v_lshl_add_u32 v1, v2, 3, v1
    v_add_u32 v8, 0x10000, v1
    v_xor_b32 v9, 32, v8
    v_add_u32 v10, 0x8000, v8
    v_add_u32 v11, 0x8000, v9
    s_mov_b32 s40, 0x21317218
    s_mov_b32 s41, s40
    s_mov_b32 s74, 0x358637bd
    s_mov_b32 s75, s74
    s_mov_b32 s76, 0x5d800000
    s_mov_b32 s77, s76
    v_and_b32 v164, 0x30, v0
    s_lshl_b32 s42, s36, 8
    s_add_u32 s42, s42, 155648
    v_add_u32 v164, s42, v164
    v_and_b32 v165, 15, v0
    v_lshlrev_b32 v165, 2, v165
    s_lshl_b32 s42, s38, 6
    s_add_u32 s42, s42, 158208
    v_add_u32 v165, s42, v165
    s_lshl_b32 s42, s3, 2
    s_add_u32 s42, s42, 159040
    v_mov_b32 v3, s42
    v_lshlrev_b32 v1, 2, v2
    v_add_u32 v1, 159040, v1
    v_xor_b32 v2, 64, v165
    s_lshl_b32 s44, s33, 1
    s_add_u32 s44, s44, s37
    s_mul_i32 s45, s44, 4224
    s_mul_i32 s46, s36, 3072
    s_add_u32 s46, s46, s45
    s_lshl_b32 s47, s36, 10
    s_add_u32 s47, s47, 1024
    s_add_u32 s47, s47, s45
    s_lshl_b32 s48, s36, 6
    s_add_u32 s48, s48, 4096
    s_add_u32 s48, s48, s45
    s_lshl_b32 s49, s44, 10
    s_lshl_b32 s52, s3, 11
    s_add_u32 s52, s52, 65536
    s_lshl_b32 s53, s3, 7
    s_lshl_b32 s43, s36, 6
    s_add_u32 s53, s53, s43
    s_add_u32 s53, s53, 159232
    s_mov_b32 s50, 159068
    s_waitcnt lgkmcnt(0)
    s_lshl_b32 s64, s28, 7
    s_lshl_b32 s65, s3, 5
    s_add_u32 s64, s64, s65
    s_lshl_b32 s42, s64, 11
    s_lshl_b32 s65, s29, 7
    s_add_u32 s42, s42, s65
    s_add_u32 s43, s42, 0x8000
    s_lshl_b32 s66, s44, 1
    s_add_u32 s66, s66, s36
    s_lshl_b32 s66, s66, 4
    s_add_u32 s66, s66, s32
    s_lshl_b32 s66, s66, 10

    s_mov_b32 s12, s4
    s_mov_b32 s13, s5
    s_mov_b32 s14, 0x400000
    s_mov_b32 s15, 0x00020000
    s_mov_b32 s16, s6
    s_mov_b32 s17, s7
    s_mov_b32 s18, 0x600000
    s_mov_b32 s19, 0x00020000
    s_mov_b32 s20, s8
    s_mov_b32 s21, s9
    s_mov_b32 s22, 0x200000
    s_mov_b32 s23, 0x00020000
    s_add_u32 s24, s72, 0x800000
    s_addc_u32 s25, s73, 0
    s_mov_b32 s26, 0x48000
    s_mov_b32 s27, 0x00020000
    s_add_u32 s84, s72, 0xa00000
    s_addc_u32 s85, s73, 0
    s_mov_b32 s86, 0x100000
    s_mov_b32 s87, 0x00020000
    s_barrier
    s_nop 0
    ds_read_b128 v[12:15], v4 offset:0
    ds_read_b64_tr_b16 v[44:45], v8 offset:0
    ds_read_b64_tr_b16 v[46:47], v8 offset:512
    ds_read_b128 v[16:19], v4 offset:2048
    ds_read_b128 v[20:23], v4 offset:4096
    ds_read_b128 v[24:27], v4 offset:6144
    ds_read_b64_tr_b16 v[48:49], v9 offset:0
    ds_read_b64_tr_b16 v[50:51], v9 offset:512
    ds_read_b64_tr_b16 v[52:53], v8 offset:8192
    ds_read_b64_tr_b16 v[54:55], v8 offset:8704
    ds_read_b64_tr_b16 v[56:57], v9 offset:8192
    ds_read_b64_tr_b16 v[58:59], v9 offset:8704
    s_waitcnt lgkmcnt(9)
    v_mfma_f32_16x16x32_bf16 v[100:103], v[12:15], v[44:47], 0
    ds_read_b128 v[28:31], v5 offset:0
    s_waitcnt lgkmcnt(9)
    v_mfma_f32_16x16x32_bf16 v[104:107], v[16:19], v[44:47], 0
    ds_read_b64_tr_b16 v[60:61], v8 offset:4096
    s_waitcnt lgkmcnt(9)
    v_mfma_f32_16x16x32_bf16 v[108:111], v[20:23], v[44:47], 0
    ds_read_b64_tr_b16 v[62:63], v8 offset:4608
    s_waitcnt lgkmcnt(9)
    v_mfma_f32_16x16x32_bf16 v[112:115], v[24:27], v[44:47], 0
    ds_read_b128 v[32:35], v5 offset:2048
    s_waitcnt lgkmcnt(8)
    s_nop 0
    v_mfma_f32_16x16x32_bf16 v[116:119], v[12:15], v[48:51], 0
    ds_read_b128 v[36:39], v5 offset:4096
    v_mfma_f32_16x16x32_bf16 v[120:123], v[16:19], v[48:51], 0
    ds_read_b128 v[40:43], v5 offset:6144
    v_mfma_f32_16x16x32_bf16 v[124:127], v[20:23], v[48:51], 0
    ds_read_b64_tr_b16 v[64:65], v9 offset:4096
    v_mfma_f32_16x16x32_bf16 v[128:131], v[24:27], v[48:51], 0
    ds_read_b64_tr_b16 v[66:67], v9 offset:4608
    s_waitcnt lgkmcnt(10)
    s_nop 0
    v_mfma_f32_16x16x32_bf16 v[132:135], v[12:15], v[52:55], 0
    ds_read_b64_tr_b16 v[44:45], v8 offset:12288
    v_mfma_f32_16x16x32_bf16 v[136:139], v[16:19], v[52:55], 0
    ds_read_b64_tr_b16 v[46:47], v8 offset:12800
    v_mfma_f32_16x16x32_bf16 v[140:143], v[20:23], v[52:55], 0
    ds_read_b64_tr_b16 v[48:49], v9 offset:12288
    v_mfma_f32_16x16x32_bf16 v[144:147], v[24:27], v[52:55], 0
    ds_read_b64_tr_b16 v[50:51], v9 offset:12800
    s_waitcnt lgkmcnt(12)
    v_mfma_f32_16x16x32_bf16 v[148:151], v[12:15], v[56:59], 0
    v_mfma_f32_16x16x32_bf16 v[152:155], v[16:19], v[56:59], 0
    v_mfma_f32_16x16x32_bf16 v[156:159], v[20:23], v[56:59], 0
    v_mfma_f32_16x16x32_bf16 v[160:163], v[24:27], v[56:59], 0
    s_waitcnt lgkmcnt(9)
    v_mfma_f32_16x16x32_bf16 v[100:103], v[28:31], v[60:63], v[100:103]
    s_waitcnt lgkmcnt(8)
    v_mfma_f32_16x16x32_bf16 v[104:107], v[32:35], v[60:63], v[104:107]
    s_waitcnt lgkmcnt(0)
    s_barrier
    s_nop 0
    v_mfma_f32_16x16x32_bf16 v[108:111], v[36:39], v[60:63], v[108:111]
    ds_read_b128 v[12:15], v4 offset:16384
    v_mfma_f32_16x16x32_bf16 v[112:115], v[40:43], v[60:63], v[112:115]
    ds_read_b64_tr_b16 v[52:53], v10 offset:0
    v_mfma_f32_16x16x32_bf16 v[116:119], v[28:31], v[64:67], v[116:119]
    ds_read_b64_tr_b16 v[54:55], v10 offset:512
    v_mfma_f32_16x16x32_bf16 v[120:123], v[32:35], v[64:67], v[120:123]
    ds_read_b128 v[16:19], v4 offset:18432
    v_mfma_f32_16x16x32_bf16 v[124:127], v[36:39], v[64:67], v[124:127]
    ds_read_b128 v[20:23], v4 offset:20480
    v_mfma_f32_16x16x32_bf16 v[128:131], v[40:43], v[64:67], v[128:131]
    ds_read_b128 v[24:27], v4 offset:22528
    v_mfma_f32_16x16x32_bf16 v[132:135], v[28:31], v[44:47], v[132:135]
    ds_read_b64_tr_b16 v[56:57], v11 offset:0
    v_mfma_f32_16x16x32_bf16 v[136:139], v[32:35], v[44:47], v[136:139]
    ds_read_b64_tr_b16 v[58:59], v11 offset:512
    v_mfma_f32_16x16x32_bf16 v[140:143], v[36:39], v[44:47], v[140:143]
    ds_read_b64_tr_b16 v[60:61], v10 offset:8192
    v_mfma_f32_16x16x32_bf16 v[144:147], v[40:43], v[44:47], v[144:147]
    ds_read_b64_tr_b16 v[62:63], v10 offset:8704
    v_mfma_f32_16x16x32_bf16 v[148:151], v[28:31], v[48:51], v[148:151]
    ds_read_b64_tr_b16 v[64:65], v11 offset:8192
    v_mfma_f32_16x16x32_bf16 v[152:155], v[32:35], v[48:51], v[152:155]
    ds_read_b64_tr_b16 v[66:67], v11 offset:8704
    v_mfma_f32_16x16x32_bf16 v[156:159], v[36:39], v[48:51], v[156:159]
    v_mfma_f32_16x16x32_bf16 v[160:163], v[40:43], v[48:51], v[160:163]
    s_waitcnt lgkmcnt(9)
    v_mfma_f32_16x16x32_bf16 v[100:103], v[12:15], v[52:55], v[100:103]
    ds_read_b128 v[28:31], v5 offset:16384
    s_waitcnt lgkmcnt(9)
    v_mfma_f32_16x16x32_bf16 v[104:107], v[16:19], v[52:55], v[104:107]
    ds_read_b64_tr_b16 v[44:45], v10 offset:4096
    s_waitcnt lgkmcnt(9)
    v_mfma_f32_16x16x32_bf16 v[108:111], v[20:23], v[52:55], v[108:111]
    ds_read_b64_tr_b16 v[46:47], v10 offset:4608
    s_waitcnt lgkmcnt(9)
    v_mfma_f32_16x16x32_bf16 v[112:115], v[24:27], v[52:55], v[112:115]
    ds_read_b128 v[32:35], v5 offset:18432
    s_waitcnt lgkmcnt(8)
    s_nop 0
    v_mfma_f32_16x16x32_bf16 v[116:119], v[12:15], v[56:59], v[116:119]
    ds_read_b128 v[36:39], v5 offset:20480
    v_mfma_f32_16x16x32_bf16 v[120:123], v[16:19], v[56:59], v[120:123]
    ds_read_b128 v[40:43], v5 offset:22528
    v_mfma_f32_16x16x32_bf16 v[124:127], v[20:23], v[56:59], v[124:127]
    ds_read_b64_tr_b16 v[48:49], v11 offset:4096
    v_mfma_f32_16x16x32_bf16 v[128:131], v[24:27], v[56:59], v[128:131]
    ds_read_b64_tr_b16 v[50:51], v11 offset:4608
    s_waitcnt lgkmcnt(10)
    s_nop 0
    v_mfma_f32_16x16x32_bf16 v[132:135], v[12:15], v[60:63], v[132:135]
    ds_read_b64_tr_b16 v[52:53], v10 offset:12288
    v_mfma_f32_16x16x32_bf16 v[136:139], v[16:19], v[60:63], v[136:139]
    ds_read_b64_tr_b16 v[54:55], v10 offset:12800
    v_mfma_f32_16x16x32_bf16 v[140:143], v[20:23], v[60:63], v[140:143]
    ds_read_b64_tr_b16 v[56:57], v11 offset:12288
    v_mfma_f32_16x16x32_bf16 v[144:147], v[24:27], v[60:63], v[144:147]
    ds_read_b64_tr_b16 v[58:59], v11 offset:12800
    s_waitcnt lgkmcnt(12)
    v_mfma_f32_16x16x32_bf16 v[148:151], v[12:15], v[64:67], v[148:151]
    v_mfma_f32_16x16x32_bf16 v[152:155], v[16:19], v[64:67], v[152:155]
    v_mfma_f32_16x16x32_bf16 v[156:159], v[20:23], v[64:67], v[156:159]
    v_mfma_f32_16x16x32_bf16 v[160:163], v[24:27], v[64:67], v[160:163]
    s_waitcnt lgkmcnt(9)
    v_mfma_f32_16x16x32_bf16 v[100:103], v[28:31], v[44:47], v[100:103]
    s_waitcnt lgkmcnt(8)
    v_mfma_f32_16x16x32_bf16 v[104:107], v[32:35], v[44:47], v[104:107]
    s_waitcnt lgkmcnt(0)
    s_barrier
    s_nop 0
    v_mfma_f32_16x16x32_bf16 v[108:111], v[36:39], v[44:47], v[108:111]
    ds_read_b128 v[12:15], v4 offset:32768
    v_mfma_f32_16x16x32_bf16 v[112:115], v[40:43], v[44:47], v[112:115]
    ds_read_b64_tr_b16 v[60:61], v10 offset:16384
    v_mfma_f32_16x16x32_bf16 v[116:119], v[28:31], v[48:51], v[116:119]
    ds_read_b64_tr_b16 v[62:63], v10 offset:16896
    v_mfma_f32_16x16x32_bf16 v[120:123], v[32:35], v[48:51], v[120:123]
    ds_read_b128 v[16:19], v4 offset:34816
    v_mfma_f32_16x16x32_bf16 v[124:127], v[36:39], v[48:51], v[124:127]
    ds_read_b128 v[20:23], v4 offset:36864
    v_mfma_f32_16x16x32_bf16 v[128:131], v[40:43], v[48:51], v[128:131]
    ds_read_b128 v[24:27], v4 offset:38912
    v_mfma_f32_16x16x32_bf16 v[132:135], v[28:31], v[52:55], v[132:135]
    ds_read_b64_tr_b16 v[64:65], v11 offset:16384
    v_mfma_f32_16x16x32_bf16 v[136:139], v[32:35], v[52:55], v[136:139]
    ds_read_b64_tr_b16 v[66:67], v11 offset:16896
    v_mfma_f32_16x16x32_bf16 v[140:143], v[36:39], v[52:55], v[140:143]
    ds_read_b64_tr_b16 v[44:45], v10 offset:24576
    v_mfma_f32_16x16x32_bf16 v[144:147], v[40:43], v[52:55], v[144:147]
    ds_read_b64_tr_b16 v[46:47], v10 offset:25088
    v_mfma_f32_16x16x32_bf16 v[148:151], v[28:31], v[56:59], v[148:151]
    ds_read_b64_tr_b16 v[48:49], v11 offset:24576
    v_mfma_f32_16x16x32_bf16 v[152:155], v[32:35], v[56:59], v[152:155]
    ds_read_b64_tr_b16 v[50:51], v11 offset:25088
    v_mfma_f32_16x16x32_bf16 v[156:159], v[36:39], v[56:59], v[156:159]
    v_mfma_f32_16x16x32_bf16 v[160:163], v[40:43], v[56:59], v[160:163]
    s_waitcnt lgkmcnt(9)
    v_mfma_f32_16x16x32_bf16 v[100:103], v[12:15], v[60:63], v[100:103]
    ds_read_b128 v[28:31], v5 offset:32768
    s_waitcnt lgkmcnt(9)
    v_mfma_f32_16x16x32_bf16 v[104:107], v[16:19], v[60:63], v[104:107]
    ds_read_b64_tr_b16 v[52:53], v10 offset:20480
    s_waitcnt lgkmcnt(9)
    v_mfma_f32_16x16x32_bf16 v[108:111], v[20:23], v[60:63], v[108:111]
    ds_read_b64_tr_b16 v[54:55], v10 offset:20992
    s_waitcnt lgkmcnt(9)
    v_mfma_f32_16x16x32_bf16 v[112:115], v[24:27], v[60:63], v[112:115]
    ds_read_b128 v[32:35], v5 offset:34816
    s_waitcnt lgkmcnt(8)
    s_nop 0
    v_mfma_f32_16x16x32_bf16 v[116:119], v[12:15], v[64:67], v[116:119]
    ds_read_b128 v[36:39], v5 offset:36864
    v_mfma_f32_16x16x32_bf16 v[120:123], v[16:19], v[64:67], v[120:123]
    ds_read_b128 v[40:43], v5 offset:38912
    v_mfma_f32_16x16x32_bf16 v[124:127], v[20:23], v[64:67], v[124:127]
    ds_read_b64_tr_b16 v[56:57], v11 offset:20480
    v_mfma_f32_16x16x32_bf16 v[128:131], v[24:27], v[64:67], v[128:131]
    ds_read_b64_tr_b16 v[58:59], v11 offset:20992
    s_waitcnt lgkmcnt(10)
    s_nop 0
    v_mfma_f32_16x16x32_bf16 v[132:135], v[12:15], v[44:47], v[132:135]
    ds_read_b64_tr_b16 v[60:61], v10 offset:28672
    v_mfma_f32_16x16x32_bf16 v[136:139], v[16:19], v[44:47], v[136:139]
    s_branch IW_s3
IW_w3:
    s_branch IW_r3
IW_s3:
    ds_read_b64_tr_b16 v[62:63], v10 offset:29184
    v_mfma_f32_16x16x32_bf16 v[140:143], v[20:23], v[44:47], v[140:143]
    ds_read_b64_tr_b16 v[64:65], v11 offset:28672
    v_mfma_f32_16x16x32_bf16 v[144:147], v[24:27], v[44:47], v[144:147]
    ds_read_b64_tr_b16 v[66:67], v11 offset:29184
    s_waitcnt lgkmcnt(12)
    v_mfma_f32_16x16x32_bf16 v[148:151], v[12:15], v[48:51], v[148:151]
    v_mfma_f32_16x16x32_bf16 v[152:155], v[16:19], v[48:51], v[152:155]
    v_mfma_f32_16x16x32_bf16 v[156:159], v[20:23], v[48:51], v[156:159]
    v_mfma_f32_16x16x32_bf16 v[160:163], v[24:27], v[48:51], v[160:163]
    s_waitcnt lgkmcnt(9)
    v_mfma_f32_16x16x32_bf16 v[100:103], v[28:31], v[52:55], v[100:103]
    s_waitcnt lgkmcnt(8)
    v_mfma_f32_16x16x32_bf16 v[104:107], v[32:35], v[52:55], v[104:107]
    s_waitcnt lgkmcnt(0)
    s_barrier
    s_nop 0
    v_mfma_f32_16x16x32_bf16 v[108:111], v[36:39], v[52:55], v[108:111]
    ds_read_b128 v[12:15], v4 offset:49152
    v_mfma_f32_16x16x32_bf16 v[112:115], v[40:43], v[52:55], v[112:115]
    ds_read_b64_tr_b16 v[44:45], v10 offset:32768
    v_mfma_f32_16x16x32_bf16 v[116:119], v[28:31], v[56:59], v[116:119]
    ds_read_b64_tr_b16 v[46:47], v10 offset:33280
    v_mfma_f32_16x16x32_bf16 v[120:123], v[32:35], v[56:59], v[120:123]
    ds_read_b128 v[16:19], v4 offset:51200
    v_mfma_f32_16x16x32_bf16 v[124:127], v[36:39], v[56:59], v[124:127]
    ds_read_b128 v[20:23], v4 offset:53248
    v_mfma_f32_16x16x32_bf16 v[128:131], v[40:43], v[56:59], v[128:131]
    ds_read_b128 v[24:27], v4 offset:55296
    v_mfma_f32_16x16x32_bf16 v[132:135], v[28:31], v[60:63], v[132:135]
    ds_read_b64_tr_b16 v[48:49], v11 offset:32768
    v_mfma_f32_16x16x32_bf16 v[136:139], v[32:35], v[60:63], v[136:139]
    ds_read_b64_tr_b16 v[50:51], v11 offset:33280
    v_mfma_f32_16x16x32_bf16 v[140:143], v[36:39], v[60:63], v[140:143]
    ds_read_b64_tr_b16 v[52:53], v8 offset:0
    v_mfma_f32_16x16x32_bf16 v[144:147], v[40:43], v[60:63], v[144:147]
    ds_read_b64_tr_b16 v[54:55], v8 offset:512
    v_mfma_f32_16x16x32_bf16 v[148:151], v[28:31], v[64:67], v[148:151]
    ds_read_b64_tr_b16 v[56:57], v9 offset:0
    v_mfma_f32_16x16x32_bf16 v[152:155], v[32:35], v[64:67], v[152:155]
    ds_read_b64_tr_b16 v[58:59], v9 offset:512
    v_mfma_f32_16x16x32_bf16 v[156:159], v[36:39], v[64:67], v[156:159]
    v_mfma_f32_16x16x32_bf16 v[160:163], v[40:43], v[64:67], v[160:163]
    s_waitcnt lgkmcnt(9)
    v_mfma_f32_16x16x32_bf16 v[100:103], v[12:15], v[44:47], v[100:103]
    ds_read_b128 v[28:31], v5 offset:49152
    s_waitcnt lgkmcnt(9)
    v_mfma_f32_16x16x32_bf16 v[104:107], v[16:19], v[44:47], v[104:107]
    ds_read_b64_tr_b16 v[60:61], v10 offset:36864
    s_waitcnt lgkmcnt(9)
    v_mfma_f32_16x16x32_bf16 v[108:111], v[20:23], v[44:47], v[108:111]
    ds_read_b64_tr_b16 v[62:63], v10 offset:37376
    s_waitcnt lgkmcnt(9)
    v_mfma_f32_16x16x32_bf16 v[112:115], v[24:27], v[44:47], v[112:115]
    ds_read_b128 v[32:35], v5 offset:51200
    s_waitcnt lgkmcnt(8)
    s_nop 0
    v_mfma_f32_16x16x32_bf16 v[116:119], v[12:15], v[48:51], v[116:119]
    ds_read_b128 v[36:39], v5 offset:53248
    v_mfma_f32_16x16x32_bf16 v[120:123], v[16:19], v[48:51], v[120:123]
    ds_read_b128 v[40:43], v5 offset:55296
    v_mfma_f32_16x16x32_bf16 v[124:127], v[20:23], v[48:51], v[124:127]
    ds_read_b64_tr_b16 v[64:65], v11 offset:36864
    v_mfma_f32_16x16x32_bf16 v[128:131], v[24:27], v[48:51], v[128:131]
    ds_read_b64_tr_b16 v[66:67], v11 offset:37376
    s_waitcnt lgkmcnt(10)
    s_nop 0
    v_mfma_f32_16x16x32_bf16 v[132:135], v[12:15], v[52:55], v[132:135]
    ds_read_b64_tr_b16 v[44:45], v8 offset:4096
    v_mfma_f32_16x16x32_bf16 v[136:139], v[16:19], v[52:55], v[136:139]
    ds_read_b64_tr_b16 v[46:47], v8 offset:4608
    v_mfma_f32_16x16x32_bf16 v[140:143], v[20:23], v[52:55], v[140:143]
    ds_read_b64_tr_b16 v[48:49], v9 offset:4096
    v_mfma_f32_16x16x32_bf16 v[144:147], v[24:27], v[52:55], v[144:147]
    ds_read_b64_tr_b16 v[50:51], v9 offset:4608
    s_waitcnt lgkmcnt(12)
    v_mfma_f32_16x16x32_bf16 v[148:151], v[12:15], v[56:59], v[148:151]
    v_mfma_f32_16x16x32_bf16 v[152:155], v[16:19], v[56:59], v[152:155]
    v_mfma_f32_16x16x32_bf16 v[156:159], v[20:23], v[56:59], v[156:159]
    v_mfma_f32_16x16x32_bf16 v[160:163], v[24:27], v[56:59], v[160:163]
    s_waitcnt lgkmcnt(9)
    v_mfma_f32_16x16x32_bf16 v[100:103], v[28:31], v[60:63], v[100:103]
    s_waitcnt lgkmcnt(8)
    v_mfma_f32_16x16x32_bf16 v[104:107], v[32:35], v[60:63], v[104:107]
    s_waitcnt lgkmcnt(0)
    s_barrier
    s_nop 0
    v_mfma_f32_16x16x32_bf16 v[108:111], v[36:39], v[60:63], v[108:111]
    ds_read_b128 v[12:15], v4 offset:0
    v_mfma_f32_16x16x32_bf16 v[112:115], v[40:43], v[60:63], v[112:115]
    ds_read_b64_tr_b16 v[52:53], v8 offset:8192
    v_mfma_f32_16x16x32_bf16 v[116:119], v[28:31], v[64:67], v[116:119]
    ds_read_b64_tr_b16 v[54:55], v8 offset:8704
    v_mfma_f32_16x16x32_bf16 v[120:123], v[32:35], v[64:67], v[120:123]
    ds_read_b128 v[16:19], v4 offset:2048
    v_mfma_f32_16x16x32_bf16 v[124:127], v[36:39], v[64:67], v[124:127]
    ds_read_b128 v[20:23], v4 offset:4096
    v_mfma_f32_16x16x32_bf16 v[128:131], v[40:43], v[64:67], v[128:131]
    ds_read_b128 v[24:27], v4 offset:6144
    v_mfma_f32_16x16x32_bf16 v[132:135], v[28:31], v[44:47], v[132:135]
    ds_read_b64_tr_b16 v[56:57], v9 offset:8192
    v_mfma_f32_16x16x32_bf16 v[136:139], v[32:35], v[44:47], v[136:139]
    ds_read_b64_tr_b16 v[58:59], v9 offset:8704
    v_mfma_f32_16x16x32_bf16 v[140:143], v[36:39], v[44:47], v[140:143]
    ds_read_b64_tr_b16 v[60:61], v8 offset:16384
    v_mfma_f32_16x16x32_bf16 v[144:147], v[40:43], v[44:47], v[144:147]
    ds_read_b64_tr_b16 v[62:63], v8 offset:16896
    v_mfma_f32_16x16x32_bf16 v[148:151], v[28:31], v[48:51], v[148:151]
    ds_read_b64_tr_b16 v[64:65], v9 offset:16384
    v_mfma_f32_16x16x32_bf16 v[152:155], v[32:35], v[48:51], v[152:155]
    ds_read_b64_tr_b16 v[66:67], v9 offset:16896
    v_mfma_f32_16x16x32_bf16 v[156:159], v[36:39], v[48:51], v[156:159]
    v_mfma_f32_16x16x32_bf16 v[160:163], v[40:43], v[48:51], v[160:163]
    s_waitcnt lgkmcnt(9)
    v_mfma_f32_16x16x32_bf16 v[100:103], v[12:15], v[52:55], v[100:103]
    ds_read_b128 v[28:31], v5 offset:0
    s_waitcnt lgkmcnt(9)
    v_mfma_f32_16x16x32_bf16 v[104:107], v[16:19], v[52:55], v[104:107]
    ds_read_b64_tr_b16 v[44:45], v8 offset:12288
    s_waitcnt lgkmcnt(9)
    v_mfma_f32_16x16x32_bf16 v[108:111], v[20:23], v[52:55], v[108:111]
    ds_read_b64_tr_b16 v[46:47], v8 offset:12800
    s_waitcnt lgkmcnt(9)
    v_mfma_f32_16x16x32_bf16 v[112:115], v[24:27], v[52:55], v[112:115]
    ds_read_b128 v[32:35], v5 offset:2048
    s_waitcnt lgkmcnt(8)
    s_nop 0
    v_mfma_f32_16x16x32_bf16 v[116:119], v[12:15], v[56:59], v[116:119]
    ds_read_b128 v[36:39], v5 offset:4096
    v_mfma_f32_16x16x32_bf16 v[120:123], v[16:19], v[56:59], v[120:123]
    ds_read_b128 v[40:43], v5 offset:6144
    v_mfma_f32_16x16x32_bf16 v[124:127], v[20:23], v[56:59], v[124:127]
    ds_read_b64_tr_b16 v[48:49], v9 offset:12288
    v_mfma_f32_16x16x32_bf16 v[128:131], v[24:27], v[56:59], v[128:131]
    ds_read_b64_tr_b16 v[50:51], v9 offset:12800
    s_waitcnt lgkmcnt(10)
    s_nop 0
    v_mfma_f32_16x16x32_bf16 v[132:135], v[12:15], v[60:63], v[132:135]
    ds_read_b64_tr_b16 v[52:53], v8 offset:20480
    v_mfma_f32_16x16x32_bf16 v[136:139], v[16:19], v[60:63], v[136:139]
    ds_read_b64_tr_b16 v[54:55], v8 offset:20992
    v_mfma_f32_16x16x32_bf16 v[140:143], v[20:23], v[60:63], v[140:143]
    ds_read_b64_tr_b16 v[56:57], v9 offset:20480
    v_mfma_f32_16x16x32_bf16 v[144:147], v[24:27], v[60:63], v[144:147]
    ds_read_b64_tr_b16 v[58:59], v9 offset:20992
    s_waitcnt lgkmcnt(12)
    v_mfma_f32_16x16x32_bf16 v[148:151], v[12:15], v[64:67], v[148:151]
    v_mfma_f32_16x16x32_bf16 v[152:155], v[16:19], v[64:67], v[152:155]
    v_mfma_f32_16x16x32_bf16 v[156:159], v[20:23], v[64:67], v[156:159]
    v_mfma_f32_16x16x32_bf16 v[160:163], v[24:27], v[64:67], v[160:163]
    s_waitcnt lgkmcnt(9)
    v_mfma_f32_16x16x32_bf16 v[100:103], v[28:31], v[44:47], v[100:103]
    s_waitcnt lgkmcnt(8)
    v_mfma_f32_16x16x32_bf16 v[104:107], v[32:35], v[44:47], v[104:107]
    s_waitcnt lgkmcnt(0)
    s_barrier
    s_nop 0
    v_mfma_f32_16x16x32_bf16 v[108:111], v[36:39], v[44:47], v[108:111]
    ds_read_b128 v[12:15], v4 offset:16384
    v_mfma_f32_16x16x32_bf16 v[112:115], v[40:43], v[44:47], v[112:115]
    ds_read_b64_tr_b16 v[60:61], v8 offset:24576
    v_mfma_f32_16x16x32_bf16 v[116:119], v[28:31], v[48:51], v[116:119]
    ds_read_b64_tr_b16 v[62:63], v8 offset:25088
    v_mfma_f32_16x16x32_bf16 v[120:123], v[32:35], v[48:51], v[120:123]
    ds_read_b128 v[16:19], v4 offset:18432
    v_mfma_f32_16x16x32_bf16 v[124:127], v[36:39], v[48:51], v[124:127]
    ds_read_b128 v[20:23], v4 offset:20480
    v_mfma_f32_16x16x32_bf16 v[128:131], v[40:43], v[48:51], v[128:131]
    ds_read_b128 v[24:27], v4 offset:22528
    v_mfma_f32_16x16x32_bf16 v[132:135], v[28:31], v[52:55], v[132:135]
    ds_read_b64_tr_b16 v[64:65], v9 offset:24576
    v_mfma_f32_16x16x32_bf16 v[136:139], v[32:35], v[52:55], v[136:139]
    ds_read_b64_tr_b16 v[66:67], v9 offset:25088
    v_mfma_f32_16x16x32_bf16 v[140:143], v[36:39], v[52:55], v[140:143]
    ds_read_b64_tr_b16 v[44:45], v10 offset:0
    v_mfma_f32_16x16x32_bf16 v[144:147], v[40:43], v[52:55], v[144:147]
    ds_read_b64_tr_b16 v[46:47], v10 offset:512
    v_mfma_f32_16x16x32_bf16 v[148:151], v[28:31], v[56:59], v[148:151]
    ds_read_b64_tr_b16 v[48:49], v11 offset:0
    v_mfma_f32_16x16x32_bf16 v[152:155], v[32:35], v[56:59], v[152:155]
    ds_read_b64_tr_b16 v[50:51], v11 offset:512
    v_mfma_f32_16x16x32_bf16 v[156:159], v[36:39], v[56:59], v[156:159]
    v_mfma_f32_16x16x32_bf16 v[160:163], v[40:43], v[56:59], v[160:163]
    s_waitcnt lgkmcnt(9)
    v_mfma_f32_16x16x32_bf16 v[100:103], v[12:15], v[60:63], v[100:103]
    ds_read_b128 v[28:31], v5 offset:16384
    s_waitcnt lgkmcnt(9)
    v_mfma_f32_16x16x32_bf16 v[104:107], v[16:19], v[60:63], v[104:107]
    ds_read_b64_tr_b16 v[52:53], v8 offset:28672
    s_waitcnt lgkmcnt(9)
    v_mfma_f32_16x16x32_bf16 v[108:111], v[20:23], v[60:63], v[108:111]
    ds_read_b64_tr_b16 v[54:55], v8 offset:29184
    s_waitcnt lgkmcnt(9)
    v_mfma_f32_16x16x32_bf16 v[112:115], v[24:27], v[60:63], v[112:115]
    ds_read_b128 v[32:35], v5 offset:18432
    s_waitcnt lgkmcnt(8)
    s_nop 0
    v_mfma_f32_16x16x32_bf16 v[116:119], v[12:15], v[64:67], v[116:119]
    ds_read_b128 v[36:39], v5 offset:20480
    v_mfma_f32_16x16x32_bf16 v[120:123], v[16:19], v[64:67], v[120:123]
    ds_read_b128 v[40:43], v5 offset:22528
    v_mfma_f32_16x16x32_bf16 v[124:127], v[20:23], v[64:67], v[124:127]
    ds_read_b64_tr_b16 v[56:57], v9 offset:28672
    v_mfma_f32_16x16x32_bf16 v[128:131], v[24:27], v[64:67], v[128:131]
    ds_read_b64_tr_b16 v[58:59], v9 offset:29184
    s_waitcnt lgkmcnt(10)
    s_nop 0
    v_mfma_f32_16x16x32_bf16 v[132:135], v[12:15], v[44:47], v[132:135]
    ds_read_b64_tr_b16 v[60:61], v10 offset:4096
    v_mfma_f32_16x16x32_bf16 v[136:139], v[16:19], v[44:47], v[136:139]
    ds_read_b64_tr_b16 v[62:63], v10 offset:4608
    v_mfma_f32_16x16x32_bf16 v[140:143], v[20:23], v[44:47], v[140:143]
    ds_read_b64_tr_b16 v[64:65], v11 offset:4096
    v_mfma_f32_16x16x32_bf16 v[144:147], v[24:27], v[44:47], v[144:147]
    ds_read_b64_tr_b16 v[66:67], v11 offset:4608
    s_waitcnt lgkmcnt(12)
    v_mfma_f32_16x16x32_bf16 v[148:151], v[12:15], v[48:51], v[148:151]
    v_mfma_f32_16x16x32_bf16 v[152:155], v[16:19], v[48:51], v[152:155]
    v_mfma_f32_16x16x32_bf16 v[156:159], v[20:23], v[48:51], v[156:159]
    v_mfma_f32_16x16x32_bf16 v[160:163], v[24:27], v[48:51], v[160:163]
    s_waitcnt lgkmcnt(9)
    v_mfma_f32_16x16x32_bf16 v[100:103], v[28:31], v[52:55], v[100:103]
    s_waitcnt lgkmcnt(8)
    v_mfma_f32_16x16x32_bf16 v[104:107], v[32:35], v[52:55], v[104:107]
    s_waitcnt lgkmcnt(0)
    s_barrier
    s_nop 0
    v_mfma_f32_16x16x32_bf16 v[108:111], v[36:39], v[52:55], v[108:111]
    ds_read_b128 v[12:15], v4 offset:32768
    v_mfma_f32_16x16x32_bf16 v[112:115], v[40:43], v[52:55], v[112:115]
    ds_read_b64_tr_b16 v[44:45], v10 offset:16384
    v_mfma_f32_16x16x32_bf16 v[116:119], v[28:31], v[56:59], v[116:119]
    ds_read_b64_tr_b16 v[46:47], v10 offset:16896
    v_mfma_f32_16x16x32_bf16 v[120:123], v[32:35], v[56:59], v[120:123]
    ds_read_b128 v[16:19], v4 offset:34816
    v_mfma_f32_16x16x32_bf16 v[124:127], v[36:39], v[56:59], v[124:127]
    ds_read_b128 v[20:23], v4 offset:36864
    v_mfma_f32_16x16x32_bf16 v[128:131], v[40:43], v[56:59], v[128:131]
    ds_read_b128 v[24:27], v4 offset:38912
    v_mfma_f32_16x16x32_bf16 v[132:135], v[28:31], v[60:63], v[132:135]
    ds_read_b64_tr_b16 v[48:49], v11 offset:16384
    v_mfma_f32_16x16x32_bf16 v[136:139], v[32:35], v[60:63], v[136:139]
    ds_read_b64_tr_b16 v[50:51], v11 offset:16896
    v_mfma_f32_16x16x32_bf16 v[140:143], v[36:39], v[60:63], v[140:143]
    ds_read_b64_tr_b16 v[52:53], v10 offset:24576
    v_mfma_f32_16x16x32_bf16 v[144:147], v[40:43], v[60:63], v[144:147]
    ds_read_b64_tr_b16 v[54:55], v10 offset:25088
    v_mfma_f32_16x16x32_bf16 v[148:151], v[28:31], v[64:67], v[148:151]
    ds_read_b64_tr_b16 v[56:57], v11 offset:24576
    v_mfma_f32_16x16x32_bf16 v[152:155], v[32:35], v[64:67], v[152:155]
    ds_read_b64_tr_b16 v[58:59], v11 offset:25088
    v_mfma_f32_16x16x32_bf16 v[156:159], v[36:39], v[64:67], v[156:159]
    v_mfma_f32_16x16x32_bf16 v[160:163], v[40:43], v[64:67], v[160:163]
    s_waitcnt lgkmcnt(9)
    v_mfma_f32_16x16x32_bf16 v[100:103], v[12:15], v[44:47], v[100:103]
    ds_read_b128 v[28:31], v5 offset:32768
    s_waitcnt lgkmcnt(9)
    v_mfma_f32_16x16x32_bf16 v[104:107], v[16:19], v[44:47], v[104:107]
    ds_read_b64_tr_b16 v[60:61], v10 offset:20480
    s_waitcnt lgkmcnt(9)
    v_mfma_f32_16x16x32_bf16 v[108:111], v[20:23], v[44:47], v[108:111]
    ds_read_b64_tr_b16 v[62:63], v10 offset:20992
    s_waitcnt lgkmcnt(9)
    v_mfma_f32_16x16x32_bf16 v[112:115], v[24:27], v[44:47], v[112:115]
    ds_read_b128 v[32:35], v5 offset:34816
    s_waitcnt lgkmcnt(8)
    s_nop 0
    v_mfma_f32_16x16x32_bf16 v[116:119], v[12:15], v[48:51], v[116:119]
    ds_read_b128 v[36:39], v5 offset:36864
    v_mfma_f32_16x16x32_bf16 v[120:123], v[16:19], v[48:51], v[120:123]
    ds_read_b128 v[40:43], v5 offset:38912
    v_mfma_f32_16x16x32_bf16 v[124:127], v[20:23], v[48:51], v[124:127]
    ds_read_b64_tr_b16 v[64:65], v11 offset:20480
    v_mfma_f32_16x16x32_bf16 v[128:131], v[24:27], v[48:51], v[128:131]
    ds_read_b64_tr_b16 v[66:67], v11 offset:20992
    s_waitcnt lgkmcnt(10)
    s_nop 0
    v_mfma_f32_16x16x32_bf16 v[132:135], v[12:15], v[52:55], v[132:135]
    ds_read_b64_tr_b16 v[44:45], v10 offset:28672
    v_mfma_f32_16x16x32_bf16 v[136:139], v[16:19], v[52:55], v[136:139]
    ds_read_b64_tr_b16 v[46:47], v10 offset:29184
    v_mfma_f32_16x16x32_bf16 v[140:143], v[20:23], v[52:55], v[140:143]
    ds_read_b64_tr_b16 v[48:49], v11 offset:28672
    v_mfma_f32_16x16x32_bf16 v[144:147], v[24:27], v[52:55], v[144:147]
    ds_read_b64_tr_b16 v[50:51], v11 offset:29184
    s_waitcnt lgkmcnt(12)
    v_mfma_f32_16x16x32_bf16 v[148:151], v[12:15], v[56:59], v[148:151]
    v_mfma_f32_16x16x32_bf16 v[152:155], v[16:19], v[56:59], v[152:155]
    v_mfma_f32_16x16x32_bf16 v[156:159], v[20:23], v[56:59], v[156:159]
    v_mfma_f32_16x16x32_bf16 v[160:163], v[24:27], v[56:59], v[160:163]
    s_waitcnt lgkmcnt(9)
    v_mfma_f32_16x16x32_bf16 v[100:103], v[28:31], v[60:63], v[100:103]
    s_waitcnt lgkmcnt(8)
    v_mfma_f32_16x16x32_bf16 v[104:107], v[32:35], v[60:63], v[104:107]
    s_waitcnt lgkmcnt(0)
    s_barrier
    s_nop 0
    v_mfma_f32_16x16x32_bf16 v[108:111], v[36:39], v[60:63], v[108:111]
    ds_read_b128 v[12:15], v4 offset:49152
    v_mfma_f32_16x16x32_bf16 v[112:115], v[40:43], v[60:63], v[112:115]
    ds_read_b64_tr_b16 v[52:53], v8 offset:0
    v_mfma_f32_16x16x32_bf16 v[116:119], v[28:31], v[64:67], v[116:119]
    ds_read_b64_tr_b16 v[54:55], v8 offset:512
    v_mfma_f32_16x16x32_bf16 v[120:123], v[32:35], v[64:67], v[120:123]
    ds_read_b128 v[16:19], v4 offset:51200
    v_mfma_f32_16x16x32_bf16 v[124:127], v[36:39], v[64:67], v[124:127]
    ds_read_b128 v[20:23], v4 offset:53248
    v_mfma_f32_16x16x32_bf16 v[128:131], v[40:43], v[64:67], v[128:131]
    ds_read_b128 v[24:27], v4 offset:55296
    v_mfma_f32_16x16x32_bf16 v[132:135], v[28:31], v[44:47], v[132:135]
    ds_read_b64_tr_b16 v[56:57], v9 offset:0
    v_mfma_f32_16x16x32_bf16 v[136:139], v[32:35], v[44:47], v[136:139]
    ds_read_b64_tr_b16 v[58:59], v9 offset:512
    v_mfma_f32_16x16x32_bf16 v[140:143], v[36:39], v[44:47], v[140:143]
    ds_read_b64_tr_b16 v[60:61], v10 offset:32768
    v_mfma_f32_16x16x32_bf16 v[144:147], v[40:43], v[44:47], v[144:147]
    ds_read_b64_tr_b16 v[62:63], v10 offset:33280
    v_mfma_f32_16x16x32_bf16 v[148:151], v[28:31], v[48:51], v[148:151]
    ds_read_b64_tr_b16 v[64:65], v11 offset:32768
    v_mfma_f32_16x16x32_bf16 v[152:155], v[32:35], v[48:51], v[152:155]
    ds_read_b64_tr_b16 v[66:67], v11 offset:33280
    v_mfma_f32_16x16x32_bf16 v[156:159], v[36:39], v[48:51], v[156:159]
    v_mfma_f32_16x16x32_bf16 v[160:163], v[40:43], v[48:51], v[160:163]
    s_waitcnt lgkmcnt(9)
    v_mfma_f32_16x16x32_bf16 v[100:103], v[12:15], v[52:55], v[100:103]
    ds_read_b128 v[28:31], v5 offset:49152
    s_waitcnt lgkmcnt(9)
    v_mfma_f32_16x16x32_bf16 v[104:107], v[16:19], v[52:55], v[104:107]
    ds_read_b64_tr_b16 v[44:45], v8 offset:4096
    s_waitcnt lgkmcnt(9)
    v_mfma_f32_16x16x32_bf16 v[108:111], v[20:23], v[52:55], v[108:111]
    ds_read_b64_tr_b16 v[46:47], v8 offset:4608
    s_waitcnt lgkmcnt(9)
    v_mfma_f32_16x16x32_bf16 v[112:115], v[24:27], v[52:55], v[112:115]
    ds_read_b128 v[32:35], v5 offset:51200
    s_waitcnt lgkmcnt(8)
    s_nop 0
    v_mfma_f32_16x16x32_bf16 v[116:119], v[12:15], v[56:59], v[116:119]
    ds_read_b128 v[36:39], v5 offset:53248
    v_mfma_f32_16x16x32_bf16 v[120:123], v[16:19], v[56:59], v[120:123]
    ds_read_b128 v[40:43], v5 offset:55296
    v_mfma_f32_16x16x32_bf16 v[124:127], v[20:23], v[56:59], v[124:127]
    ds_read_b64_tr_b16 v[48:49], v9 offset:4096
    v_mfma_f32_16x16x32_bf16 v[128:131], v[24:27], v[56:59], v[128:131]
    ds_read_b64_tr_b16 v[50:51], v9 offset:4608
    s_waitcnt lgkmcnt(10)
    s_nop 0
    v_mfma_f32_16x16x32_bf16 v[132:135], v[12:15], v[60:63], v[132:135]
    ds_read_b64_tr_b16 v[52:53], v10 offset:36864
    v_mfma_f32_16x16x32_bf16 v[136:139], v[16:19], v[60:63], v[136:139]
    ds_read_b64_tr_b16 v[54:55], v10 offset:37376
    v_mfma_f32_16x16x32_bf16 v[140:143], v[20:23], v[60:63], v[140:143]
    ds_read_b64_tr_b16 v[56:57], v11 offset:36864
    v_mfma_f32_16x16x32_bf16 v[144:147], v[24:27], v[60:63], v[144:147]
    ds_read_b64_tr_b16 v[58:59], v11 offset:37376
    s_waitcnt lgkmcnt(12)
    v_mfma_f32_16x16x32_bf16 v[148:151], v[12:15], v[64:67], v[148:151]
    v_mfma_f32_16x16x32_bf16 v[152:155], v[16:19], v[64:67], v[152:155]
    v_mfma_f32_16x16x32_bf16 v[156:159], v[20:23], v[64:67], v[156:159]
    v_mfma_f32_16x16x32_bf16 v[160:163], v[24:27], v[64:67], v[160:163]
    s_waitcnt lgkmcnt(9)
    v_mfma_f32_16x16x32_bf16 v[100:103], v[28:31], v[44:47], v[100:103]
    s_waitcnt lgkmcnt(8)
    v_mfma_f32_16x16x32_bf16 v[104:107], v[32:35], v[44:47], v[104:107]
    s_waitcnt lgkmcnt(0)
    s_barrier
    s_nop 0
    v_mfma_f32_16x16x32_bf16 v[108:111], v[36:39], v[44:47], v[108:111]
    ds_read_b128 v[12:15], v4 offset:0
    v_mfma_f32_16x16x32_bf16 v[112:115], v[40:43], v[44:47], v[112:115]
    ds_read_b64_tr_b16 v[60:61], v8 offset:8192
    v_mfma_f32_16x16x32_bf16 v[116:119], v[28:31], v[48:51], v[116:119]
    ds_read_b64_tr_b16 v[62:63], v8 offset:8704
    v_mfma_f32_16x16x32_bf16 v[120:123], v[32:35], v[48:51], v[120:123]
    ds_read_b128 v[16:19], v4 offset:2048
    v_mfma_f32_16x16x32_bf16 v[124:127], v[36:39], v[48:51], v[124:127]
    ds_read_b128 v[20:23], v4 offset:4096
    v_mfma_f32_16x16x32_bf16 v[128:131], v[40:43], v[48:51], v[128:131]
    ds_read_b128 v[24:27], v4 offset:6144
    v_mfma_f32_16x16x32_bf16 v[132:135], v[28:31], v[52:55], v[132:135]
    ds_read_b64_tr_b16 v[64:65], v9 offset:8192
    v_mfma_f32_16x16x32_bf16 v[136:139], v[32:35], v[52:55], v[136:139]
    ds_read_b64_tr_b16 v[66:67], v9 offset:8704
    v_mfma_f32_16x16x32_bf16 v[140:143], v[36:39], v[52:55], v[140:143]
    ds_read_b64_tr_b16 v[44:45], v8 offset:16384
    v_mfma_f32_16x16x32_bf16 v[144:147], v[40:43], v[52:55], v[144:147]
    ds_read_b64_tr_b16 v[46:47], v8 offset:16896
    v_mfma_f32_16x16x32_bf16 v[148:151], v[28:31], v[56:59], v[148:151]
    ds_read_b64_tr_b16 v[48:49], v9 offset:16384
    v_mfma_f32_16x16x32_bf16 v[152:155], v[32:35], v[56:59], v[152:155]
    ds_read_b64_tr_b16 v[50:51], v9 offset:16896
    v_mfma_f32_16x16x32_bf16 v[156:159], v[36:39], v[56:59], v[156:159]
    v_mfma_f32_16x16x32_bf16 v[160:163], v[40:43], v[56:59], v[160:163]
    s_waitcnt lgkmcnt(9)
    v_mfma_f32_16x16x32_bf16 v[100:103], v[12:15], v[60:63], v[100:103]
    ds_read_b128 v[28:31], v5 offset:0
    s_waitcnt lgkmcnt(9)
    v_mfma_f32_16x16x32_bf16 v[104:107], v[16:19], v[60:63], v[104:107]
    ds_read_b64_tr_b16 v[52:53], v8 offset:12288
    s_waitcnt lgkmcnt(9)
    v_mfma_f32_16x16x32_bf16 v[108:111], v[20:23], v[60:63], v[108:111]
    ds_read_b64_tr_b16 v[54:55], v8 offset:12800
    s_waitcnt lgkmcnt(9)
    v_mfma_f32_16x16x32_bf16 v[112:115], v[24:27], v[60:63], v[112:115]
    ds_read_b128 v[32:35], v5 offset:2048
    s_waitcnt lgkmcnt(8)
    s_nop 0
    v_mfma_f32_16x16x32_bf16 v[116:119], v[12:15], v[64:67], v[116:119]
    ds_read_b128 v[36:39], v5 offset:4096
    v_mfma_f32_16x16x32_bf16 v[120:123], v[16:19], v[64:67], v[120:123]
    ds_read_b128 v[40:43], v5 offset:6144
    v_mfma_f32_16x16x32_bf16 v[124:127], v[20:23], v[64:67], v[124:127]
    ds_read_b64_tr_b16 v[56:57], v9 offset:12288
    v_mfma_f32_16x16x32_bf16 v[128:131], v[24:27], v[64:67], v[128:131]
    ds_read_b64_tr_b16 v[58:59], v9 offset:12800
    s_waitcnt lgkmcnt(10)
    s_nop 0
    v_mfma_f32_16x16x32_bf16 v[132:135], v[12:15], v[44:47], v[132:135]
    ds_read_b64_tr_b16 v[60:61], v8 offset:20480
    v_mfma_f32_16x16x32_bf16 v[136:139], v[16:19], v[44:47], v[136:139]
    ds_read_b64_tr_b16 v[62:63], v8 offset:20992
    v_mfma_f32_16x16x32_bf16 v[140:143], v[20:23], v[44:47], v[140:143]
    ds_read_b64_tr_b16 v[64:65], v9 offset:20480
    v_mfma_f32_16x16x32_bf16 v[144:147], v[24:27], v[44:47], v[144:147]
    ds_read_b64_tr_b16 v[66:67], v9 offset:20992
    s_waitcnt lgkmcnt(12)
    v_mfma_f32_16x16x32_bf16 v[148:151], v[12:15], v[48:51], v[148:151]
    v_mfma_f32_16x16x32_bf16 v[152:155], v[16:19], v[48:51], v[152:155]
    v_mfma_f32_16x16x32_bf16 v[156:159], v[20:23], v[48:51], v[156:159]
    v_mfma_f32_16x16x32_bf16 v[160:163], v[24:27], v[48:51], v[160:163]
    s_waitcnt lgkmcnt(9)
    v_mfma_f32_16x16x32_bf16 v[100:103], v[28:31], v[52:55], v[100:103]
    s_waitcnt lgkmcnt(8)
    v_mfma_f32_16x16x32_bf16 v[104:107], v[32:35], v[52:55], v[104:107]
    s_waitcnt lgkmcnt(0)
    s_barrier
    s_nop 0
    v_mfma_f32_16x16x32_bf16 v[108:111], v[36:39], v[52:55], v[108:111]
    ds_read_b128 v[12:15], v4 offset:16384
    v_mfma_f32_16x16x32_bf16 v[112:115], v[40:43], v[52:55], v[112:115]
    ds_read_b64_tr_b16 v[44:45], v8 offset:24576
    v_mfma_f32_16x16x32_bf16 v[116:119], v[28:31], v[56:59], v[116:119]
    ds_read_b64_tr_b16 v[46:47], v8 offset:25088
    v_mfma_f32_16x16x32_bf16 v[120:123], v[32:35], v[56:59], v[120:123]
    ds_read_b128 v[16:19], v4 offset:18432
    v_mfma_f32_16x16x32_bf16 v[124:127], v[36:39], v[56:59], v[124:127]
    ds_read_b128 v[20:23], v4 offset:20480
    v_mfma_f32_16x16x32_bf16 v[128:131], v[40:43], v[56:59], v[128:131]
    ds_read_b128 v[24:27], v4 offset:22528
    v_mfma_f32_16x16x32_bf16 v[132:135], v[28:31], v[60:63], v[132:135]
    ds_read_b64_tr_b16 v[48:49], v9 offset:24576
    v_mfma_f32_16x16x32_bf16 v[136:139], v[32:35], v[60:63], v[136:139]
    ds_read_b64_tr_b16 v[50:51], v9 offset:25088
    v_mfma_f32_16x16x32_bf16 v[140:143], v[36:39], v[60:63], v[140:143]
    ds_read_b64_tr_b16 v[52:53], v10 offset:0
    v_mfma_f32_16x16x32_bf16 v[144:147], v[40:43], v[60:63], v[144:147]
    ds_read_b64_tr_b16 v[54:55], v10 offset:512
    v_mfma_f32_16x16x32_bf16 v[148:151], v[28:31], v[64:67], v[148:151]
    ds_read_b64_tr_b16 v[56:57], v11 offset:0
    v_mfma_f32_16x16x32_bf16 v[152:155], v[32:35], v[64:67], v[152:155]
    ds_read_b64_tr_b16 v[58:59], v11 offset:512
    v_mfma_f32_16x16x32_bf16 v[156:159], v[36:39], v[64:67], v[156:159]
    v_mfma_f32_16x16x32_bf16 v[160:163], v[40:43], v[64:67], v[160:163]
    s_waitcnt lgkmcnt(9)
    v_mfma_f32_16x16x32_bf16 v[100:103], v[12:15], v[44:47], v[100:103]
    ds_read_b128 v[28:31], v5 offset:16384
    s_waitcnt lgkmcnt(9)
    v_mfma_f32_16x16x32_bf16 v[104:107], v[16:19], v[44:47], v[104:107]
    ds_read_b64_tr_b16 v[60:61], v8 offset:28672
    s_waitcnt lgkmcnt(9)
    v_mfma_f32_16x16x32_bf16 v[108:111], v[20:23], v[44:47], v[108:111]
    ds_read_b64_tr_b16 v[62:63], v8 offset:29184
    s_waitcnt lgkmcnt(9)
    v_mfma_f32_16x16x32_bf16 v[112:115], v[24:27], v[44:47], v[112:115]
    ds_read_b128 v[32:35], v5 offset:18432
    s_waitcnt lgkmcnt(8)
    s_nop 0
    v_mfma_f32_16x16x32_bf16 v[116:119], v[12:15], v[48:51], v[116:119]
    ds_read_b128 v[36:39], v5 offset:20480
    v_mfma_f32_16x16x32_bf16 v[120:123], v[16:19], v[48:51], v[120:123]
    ds_read_b128 v[40:43], v5 offset:22528
    v_mfma_f32_16x16x32_bf16 v[124:127], v[20:23], v[48:51], v[124:127]
    ds_read_b64_tr_b16 v[64:65], v9 offset:28672
    v_mfma_f32_16x16x32_bf16 v[128:131], v[24:27], v[48:51], v[128:131]
    ds_read_b64_tr_b16 v[66:67], v9 offset:29184
    s_waitcnt lgkmcnt(10)
    s_nop 0
    v_mfma_f32_16x16x32_bf16 v[132:135], v[12:15], v[52:55], v[132:135]
    ds_read_b64_tr_b16 v[44:45], v10 offset:4096
    v_mfma_f32_16x16x32_bf16 v[136:139], v[16:19], v[52:55], v[136:139]
    ds_read_b64_tr_b16 v[46:47], v10 offset:4608
    v_mfma_f32_16x16x32_bf16 v[140:143], v[20:23], v[52:55], v[140:143]
    ds_read_b64_tr_b16 v[48:49], v11 offset:4096
    v_mfma_f32_16x16x32_bf16 v[144:147], v[24:27], v[52:55], v[144:147]
    ds_read_b64_tr_b16 v[50:51], v11 offset:4608
    s_waitcnt lgkmcnt(12)
    v_mfma_f32_16x16x32_bf16 v[148:151], v[12:15], v[56:59], v[148:151]
    v_mfma_f32_16x16x32_bf16 v[152:155], v[16:19], v[56:59], v[152:155]
    v_mfma_f32_16x16x32_bf16 v[156:159], v[20:23], v[56:59], v[156:159]
    v_mfma_f32_16x16x32_bf16 v[160:163], v[24:27], v[56:59], v[160:163]
    s_waitcnt lgkmcnt(9)
    v_mfma_f32_16x16x32_bf16 v[100:103], v[28:31], v[60:63], v[100:103]
    s_waitcnt lgkmcnt(8)
    v_mfma_f32_16x16x32_bf16 v[104:107], v[32:35], v[60:63], v[104:107]
    s_waitcnt lgkmcnt(0)
    s_barrier
    s_nop 0
    v_mfma_f32_16x16x32_bf16 v[108:111], v[36:39], v[60:63], v[108:111]
    ds_read_b128 v[12:15], v4 offset:32768
    v_mfma_f32_16x16x32_bf16 v[112:115], v[40:43], v[60:63], v[112:115]
    ds_read_b64_tr_b16 v[52:53], v10 offset:16384
    v_mfma_f32_16x16x32_bf16 v[116:119], v[28:31], v[64:67], v[116:119]
    ds_read_b64_tr_b16 v[54:55], v10 offset:16896
    v_mfma_f32_16x16x32_bf16 v[120:123], v[32:35], v[64:67], v[120:123]
    ds_read_b128 v[16:19], v4 offset:34816
    v_mfma_f32_16x16x32_bf16 v[124:127], v[36:39], v[64:67], v[124:127]
    ds_read_b128 v[20:23], v4 offset:36864
    v_mfma_f32_16x16x32_bf16 v[128:131], v[40:43], v[64:67], v[128:131]
    ds_read_b128 v[24:27], v4 offset:38912
    v_mfma_f32_16x16x32_bf16 v[132:135], v[28:31], v[44:47], v[132:135]
    ds_read_b64_tr_b16 v[56:57], v11 offset:16384
    v_mfma_f32_16x16x32_bf16 v[136:139], v[32:35], v[44:47], v[136:139]
    ds_read_b64_tr_b16 v[58:59], v11 offset:16896
    v_mfma_f32_16x16x32_bf16 v[140:143], v[36:39], v[44:47], v[140:143]
    ds_read_b64_tr_b16 v[60:61], v10 offset:24576
    v_mfma_f32_16x16x32_bf16 v[144:147], v[40:43], v[44:47], v[144:147]
    ds_read_b64_tr_b16 v[62:63], v10 offset:25088
    v_mfma_f32_16x16x32_bf16 v[148:151], v[28:31], v[48:51], v[148:151]
    ds_read_b64_tr_b16 v[64:65], v11 offset:24576
    v_mfma_f32_16x16x32_bf16 v[152:155], v[32:35], v[48:51], v[152:155]
    ds_read_b64_tr_b16 v[66:67], v11 offset:25088
    v_mfma_f32_16x16x32_bf16 v[156:159], v[36:39], v[48:51], v[156:159]
    v_mfma_f32_16x16x32_bf16 v[160:163], v[40:43], v[48:51], v[160:163]
    s_waitcnt lgkmcnt(9)
    v_mfma_f32_16x16x32_bf16 v[100:103], v[12:15], v[52:55], v[100:103]
    ds_read_b128 v[28:31], v5 offset:32768
    s_waitcnt lgkmcnt(9)
    v_mfma_f32_16x16x32_bf16 v[104:107], v[16:19], v[52:55], v[104:107]
    ds_read_b64_tr_b16 v[44:45], v10 offset:20480
    s_waitcnt lgkmcnt(9)
    v_mfma_f32_16x16x32_bf16 v[108:111], v[20:23], v[52:55], v[108:111]
    ds_read_b64_tr_b16 v[46:47], v10 offset:20992
    s_waitcnt lgkmcnt(9)
    v_mfma_f32_16x16x32_bf16 v[112:115], v[24:27], v[52:55], v[112:115]
    ds_read_b128 v[32:35], v5 offset:34816
    s_waitcnt lgkmcnt(8)
    s_nop 0
    v_mfma_f32_16x16x32_bf16 v[116:119], v[12:15], v[56:59], v[116:119]
    ds_read_b128 v[36:39], v5 offset:36864
    v_mfma_f32_16x16x32_bf16 v[120:123], v[16:19], v[56:59], v[120:123]
    ds_read_b128 v[40:43], v5 offset:38912
    v_mfma_f32_16x16x32_bf16 v[124:127], v[20:23], v[56:59], v[124:127]
    ds_read_b64_tr_b16 v[48:49], v11 offset:20480
    v_mfma_f32_16x16x32_bf16 v[128:131], v[24:27], v[56:59], v[128:131]
    ds_read_b64_tr_b16 v[50:51], v11 offset:20992
    s_waitcnt lgkmcnt(10)
    s_nop 0
    v_mfma_f32_16x16x32_bf16 v[132:135], v[12:15], v[60:63], v[132:135]
    ds_read_b64_tr_b16 v[52:53], v10 offset:28672
    v_mfma_f32_16x16x32_bf16 v[136:139], v[16:19], v[60:63], v[136:139]
    ds_read_b64_tr_b16 v[54:55], v10 offset:29184
    v_mfma_f32_16x16x32_bf16 v[140:143], v[20:23], v[60:63], v[140:143]
    ds_read_b64_tr_b16 v[56:57], v11 offset:28672
    v_mfma_f32_16x16x32_bf16 v[144:147], v[24:27], v[60:63], v[144:147]
    ds_read_b64_tr_b16 v[58:59], v11 offset:29184
    s_waitcnt lgkmcnt(12)
    v_mfma_f32_16x16x32_bf16 v[148:151], v[12:15], v[64:67], v[148:151]
    s_branch IW_s4
IW_w4:
    s_branch IW_r4
IW_s4:
    v_mfma_f32_16x16x32_bf16 v[152:155], v[16:19], v[64:67], v[152:155]
    v_mfma_f32_16x16x32_bf16 v[156:159], v[20:23], v[64:67], v[156:159]
    v_mfma_f32_16x16x32_bf16 v[160:163], v[24:27], v[64:67], v[160:163]
    s_waitcnt lgkmcnt(9)
    v_mfma_f32_16x16x32_bf16 v[100:103], v[28:31], v[44:47], v[100:103]
    s_waitcnt lgkmcnt(8)
    v_mfma_f32_16x16x32_bf16 v[104:107], v[32:35], v[44:47], v[104:107]
    s_waitcnt lgkmcnt(0)
    s_barrier
    s_nop 0
    v_mfma_f32_16x16x32_bf16 v[108:111], v[36:39], v[44:47], v[108:111]
    ds_read_b128 v[12:15], v4 offset:49152
    v_mfma_f32_16x16x32_bf16 v[112:115], v[40:43], v[44:47], v[112:115]
    ds_read_b64_tr_b16 v[60:61], v8 offset:0
    v_mfma_f32_16x16x32_bf16 v[116:119], v[28:31], v[48:51], v[116:119]
    ds_read_b64_tr_b16 v[62:63], v8 offset:512
    v_mfma_f32_16x16x32_bf16 v[120:123], v[32:35], v[48:51], v[120:123]
    ds_read_b128 v[16:19], v4 offset:51200
    v_mfma_f32_16x16x32_bf16 v[124:127], v[36:39], v[48:51], v[124:127]
    ds_read_b128 v[20:23], v4 offset:53248
    v_mfma_f32_16x16x32_bf16 v[128:131], v[40:43], v[48:51], v[128:131]
    ds_read_b128 v[24:27], v4 offset:55296
    v_mfma_f32_16x16x32_bf16 v[132:135], v[28:31], v[52:55], v[132:135]
    ds_read_b64_tr_b16 v[64:65], v9 offset:0
    v_mfma_f32_16x16x32_bf16 v[136:139], v[32:35], v[52:55], v[136:139]
    ds_read_b64_tr_b16 v[66:67], v9 offset:512
    v_mfma_f32_16x16x32_bf16 v[140:143], v[36:39], v[52:55], v[140:143]
    ds_read_b64_tr_b16 v[44:45], v10 offset:32768
    v_mfma_f32_16x16x32_bf16 v[144:147], v[40:43], v[52:55], v[144:147]
    ds_read_b64_tr_b16 v[46:47], v10 offset:33280
    v_mfma_f32_16x16x32_bf16 v[148:151], v[28:31], v[56:59], v[148:151]
    ds_read_b64_tr_b16 v[48:49], v11 offset:32768
    v_mfma_f32_16x16x32_bf16 v[152:155], v[32:35], v[56:59], v[152:155]
    ds_read_b64_tr_b16 v[50:51], v11 offset:33280
    v_mfma_f32_16x16x32_bf16 v[156:159], v[36:39], v[56:59], v[156:159]
    v_mfma_f32_16x16x32_bf16 v[160:163], v[40:43], v[56:59], v[160:163]
    s_waitcnt lgkmcnt(9)
    v_mfma_f32_16x16x32_bf16 v[100:103], v[12:15], v[60:63], v[100:103]
    ds_read_b128 v[28:31], v5 offset:49152
    s_waitcnt lgkmcnt(9)
    v_mfma_f32_16x16x32_bf16 v[104:107], v[16:19], v[60:63], v[104:107]
    ds_read_b64_tr_b16 v[52:53], v8 offset:4096
    s_waitcnt lgkmcnt(9)
    v_mfma_f32_16x16x32_bf16 v[108:111], v[20:23], v[60:63], v[108:111]
    ds_read_b64_tr_b16 v[54:55], v8 offset:4608
    s_waitcnt lgkmcnt(9)
    v_mfma_f32_16x16x32_bf16 v[112:115], v[24:27], v[60:63], v[112:115]
    ds_read_b128 v[32:35], v5 offset:51200
    s_waitcnt lgkmcnt(8)
    s_nop 0
    v_mfma_f32_16x16x32_bf16 v[116:119], v[12:15], v[64:67], v[116:119]
    ds_read_b128 v[36:39], v5 offset:53248
    v_mfma_f32_16x16x32_bf16 v[120:123], v[16:19], v[64:67], v[120:123]
    ds_read_b128 v[40:43], v5 offset:55296
    v_mfma_f32_16x16x32_bf16 v[124:127], v[20:23], v[64:67], v[124:127]
    ds_read_b64_tr_b16 v[56:57], v9 offset:4096
    v_mfma_f32_16x16x32_bf16 v[128:131], v[24:27], v[64:67], v[128:131]
    ds_read_b64_tr_b16 v[58:59], v9 offset:4608
    s_waitcnt lgkmcnt(10)
    s_nop 0
    v_mfma_f32_16x16x32_bf16 v[132:135], v[12:15], v[44:47], v[132:135]
    ds_read_b64_tr_b16 v[60:61], v10 offset:36864
    v_mfma_f32_16x16x32_bf16 v[136:139], v[16:19], v[44:47], v[136:139]
    ds_read_b64_tr_b16 v[62:63], v10 offset:37376
    v_mfma_f32_16x16x32_bf16 v[140:143], v[20:23], v[44:47], v[140:143]
    ds_read_b64_tr_b16 v[64:65], v11 offset:36864
    v_mfma_f32_16x16x32_bf16 v[144:147], v[24:27], v[44:47], v[144:147]
    ds_read_b64_tr_b16 v[66:67], v11 offset:37376
    s_waitcnt lgkmcnt(12)
    v_mfma_f32_16x16x32_bf16 v[148:151], v[12:15], v[48:51], v[148:151]
    v_mfma_f32_16x16x32_bf16 v[152:155], v[16:19], v[48:51], v[152:155]
    v_mfma_f32_16x16x32_bf16 v[156:159], v[20:23], v[48:51], v[156:159]
    v_mfma_f32_16x16x32_bf16 v[160:163], v[24:27], v[48:51], v[160:163]
    s_waitcnt lgkmcnt(9)
    v_mfma_f32_16x16x32_bf16 v[100:103], v[28:31], v[52:55], v[100:103]
    s_waitcnt lgkmcnt(8)
    v_mfma_f32_16x16x32_bf16 v[104:107], v[32:35], v[52:55], v[104:107]
    s_waitcnt lgkmcnt(0)
    s_barrier
    s_nop 0
    v_mfma_f32_16x16x32_bf16 v[108:111], v[36:39], v[52:55], v[108:111]
    ds_read_b128 v[12:15], v4 offset:0
    v_mfma_f32_16x16x32_bf16 v[112:115], v[40:43], v[52:55], v[112:115]
    ds_read_b64_tr_b16 v[44:45], v8 offset:8192
    v_mfma_f32_16x16x32_bf16 v[116:119], v[28:31], v[56:59], v[116:119]
    ds_read_b64_tr_b16 v[46:47], v8 offset:8704
    v_mfma_f32_16x16x32_bf16 v[120:123], v[32:35], v[56:59], v[120:123]
    ds_read_b128 v[16:19], v4 offset:2048
    v_mfma_f32_16x16x32_bf16 v[124:127], v[36:39], v[56:59], v[124:127]
    ds_read_b128 v[20:23], v4 offset:4096
    v_mfma_f32_16x16x32_bf16 v[128:131], v[40:43], v[56:59], v[128:131]
    ds_read_b128 v[24:27], v4 offset:6144
    v_mfma_f32_16x16x32_bf16 v[132:135], v[28:31], v[60:63], v[132:135]
    ds_read_b64_tr_b16 v[48:49], v9 offset:8192
    v_mfma_f32_16x16x32_bf16 v[136:139], v[32:35], v[60:63], v[136:139]
    ds_read_b64_tr_b16 v[50:51], v9 offset:8704
    v_mfma_f32_16x16x32_bf16 v[140:143], v[36:39], v[60:63], v[140:143]
    ds_read_b64_tr_b16 v[52:53], v8 offset:16384
    v_mfma_f32_16x16x32_bf16 v[144:147], v[40:43], v[60:63], v[144:147]
    ds_read_b64_tr_b16 v[54:55], v8 offset:16896
    v_mfma_f32_16x16x32_bf16 v[148:151], v[28:31], v[64:67], v[148:151]
    ds_read_b64_tr_b16 v[56:57], v9 offset:16384
    v_mfma_f32_16x16x32_bf16 v[152:155], v[32:35], v[64:67], v[152:155]
    ds_read_b64_tr_b16 v[58:59], v9 offset:16896
    v_mfma_f32_16x16x32_bf16 v[156:159], v[36:39], v[64:67], v[156:159]
    v_mfma_f32_16x16x32_bf16 v[160:163], v[40:43], v[64:67], v[160:163]
    s_waitcnt lgkmcnt(9)
    v_mfma_f32_16x16x32_bf16 v[100:103], v[12:15], v[44:47], v[100:103]
    ds_read_b128 v[28:31], v5 offset:0
    s_waitcnt lgkmcnt(9)
    v_mfma_f32_16x16x32_bf16 v[104:107], v[16:19], v[44:47], v[104:107]
    ds_read_b64_tr_b16 v[60:61], v8 offset:12288
    s_waitcnt lgkmcnt(9)
    v_mfma_f32_16x16x32_bf16 v[108:111], v[20:23], v[44:47], v[108:111]
    ds_read_b64_tr_b16 v[62:63], v8 offset:12800
    s_waitcnt lgkmcnt(9)
    v_mfma_f32_16x16x32_bf16 v[112:115], v[24:27], v[44:47], v[112:115]
    ds_read_b128 v[32:35], v5 offset:2048
    s_waitcnt lgkmcnt(8)
    s_nop 0
    v_mfma_f32_16x16x32_bf16 v[116:119], v[12:15], v[48:51], v[116:119]
    ds_read_b128 v[36:39], v5 offset:4096
    v_mfma_f32_16x16x32_bf16 v[120:123], v[16:19], v[48:51], v[120:123]
    ds_read_b128 v[40:43], v5 offset:6144
    v_mfma_f32_16x16x32_bf16 v[124:127], v[20:23], v[48:51], v[124:127]
    ds_read_b64_tr_b16 v[64:65], v9 offset:12288
    v_mfma_f32_16x16x32_bf16 v[128:131], v[24:27], v[48:51], v[128:131]
    ds_read_b64_tr_b16 v[66:67], v9 offset:12800
    s_waitcnt lgkmcnt(10)
    s_nop 0
    v_mfma_f32_16x16x32_bf16 v[132:135], v[12:15], v[52:55], v[132:135]
    ds_read_b64_tr_b16 v[44:45], v8 offset:20480
    v_mfma_f32_16x16x32_bf16 v[136:139], v[16:19], v[52:55], v[136:139]
    ds_read_b64_tr_b16 v[46:47], v8 offset:20992
    v_mfma_f32_16x16x32_bf16 v[140:143], v[20:23], v[52:55], v[140:143]
    ds_read_b64_tr_b16 v[48:49], v9 offset:20480
    v_mfma_f32_16x16x32_bf16 v[144:147], v[24:27], v[52:55], v[144:147]
    ds_read_b64_tr_b16 v[50:51], v9 offset:20992
    s_waitcnt lgkmcnt(12)
    v_mfma_f32_16x16x32_bf16 v[148:151], v[12:15], v[56:59], v[148:151]
    v_mfma_f32_16x16x32_bf16 v[152:155], v[16:19], v[56:59], v[152:155]
    v_mfma_f32_16x16x32_bf16 v[156:159], v[20:23], v[56:59], v[156:159]
    v_mfma_f32_16x16x32_bf16 v[160:163], v[24:27], v[56:59], v[160:163]
    s_waitcnt lgkmcnt(9)
    v_mfma_f32_16x16x32_bf16 v[100:103], v[28:31], v[60:63], v[100:103]
    s_waitcnt lgkmcnt(8)
    v_mfma_f32_16x16x32_bf16 v[104:107], v[32:35], v[60:63], v[104:107]
    s_waitcnt lgkmcnt(0)
    s_barrier
    s_nop 0
    v_mfma_f32_16x16x32_bf16 v[108:111], v[36:39], v[60:63], v[108:111]
    ds_read_b128 v[12:15], v4 offset:16384
    v_mfma_f32_16x16x32_bf16 v[112:115], v[40:43], v[60:63], v[112:115]
    ds_read_b64_tr_b16 v[52:53], v8 offset:24576
    v_mfma_f32_16x16x32_bf16 v[116:119], v[28:31], v[64:67], v[116:119]
    ds_read_b64_tr_b16 v[54:55], v8 offset:25088
    v_mfma_f32_16x16x32_bf16 v[120:123], v[32:35], v[64:67], v[120:123]
    ds_read_b128 v[16:19], v4 offset:18432
    v_mfma_f32_16x16x32_bf16 v[124:127], v[36:39], v[64:67], v[124:127]
    ds_read_b128 v[20:23], v4 offset:20480
    v_mfma_f32_16x16x32_bf16 v[128:131], v[40:43], v[64:67], v[128:131]
    ds_read_b128 v[24:27], v4 offset:22528
    v_mfma_f32_16x16x32_bf16 v[132:135], v[28:31], v[44:47], v[132:135]
    ds_read_b64_tr_b16 v[56:57], v9 offset:24576
    v_mfma_f32_16x16x32_bf16 v[136:139], v[32:35], v[44:47], v[136:139]
    ds_read_b64_tr_b16 v[58:59], v9 offset:25088
    v_mfma_f32_16x16x32_bf16 v[140:143], v[36:39], v[44:47], v[140:143]
    ds_read_b64_tr_b16 v[60:61], v10 offset:0
    v_mfma_f32_16x16x32_bf16 v[144:147], v[40:43], v[44:47], v[144:147]
    ds_read_b64_tr_b16 v[62:63], v10 offset:512
    v_mfma_f32_16x16x32_bf16 v[148:151], v[28:31], v[48:51], v[148:151]
    ds_read_b64_tr_b16 v[64:65], v11 offset:0
    v_mfma_f32_16x16x32_bf16 v[152:155], v[32:35], v[48:51], v[152:155]
    ds_read_b64_tr_b16 v[66:67], v11 offset:512
    v_mfma_f32_16x16x32_bf16 v[156:159], v[36:39], v[48:51], v[156:159]
    v_mfma_f32_16x16x32_bf16 v[160:163], v[40:43], v[48:51], v[160:163]
    s_waitcnt lgkmcnt(9)
    v_mfma_f32_16x16x32_bf16 v[100:103], v[12:15], v[52:55], v[100:103]
    ds_read_b128 v[28:31], v5 offset:16384
    s_waitcnt lgkmcnt(9)
    v_mfma_f32_16x16x32_bf16 v[104:107], v[16:19], v[52:55], v[104:107]
    ds_read_b64_tr_b16 v[44:45], v8 offset:28672
    s_waitcnt lgkmcnt(9)
    v_mfma_f32_16x16x32_bf16 v[108:111], v[20:23], v[52:55], v[108:111]
    ds_read_b64_tr_b16 v[46:47], v8 offset:29184
    s_waitcnt lgkmcnt(9)
    v_mfma_f32_16x16x32_bf16 v[112:115], v[24:27], v[52:55], v[112:115]
    ds_read_b128 v[32:35], v5 offset:18432
    s_waitcnt lgkmcnt(8)
    s_nop 0
    v_mfma_f32_16x16x32_bf16 v[116:119], v[12:15], v[56:59], v[116:119]
    ds_read_b128 v[36:39], v5 offset:20480
    v_mfma_f32_16x16x32_bf16 v[120:123], v[16:19], v[56:59], v[120:123]
    ds_read_b128 v[40:43], v5 offset:22528
    v_mfma_f32_16x16x32_bf16 v[124:127], v[20:23], v[56:59], v[124:127]
    ds_read_b64_tr_b16 v[48:49], v9 offset:28672
    v_mfma_f32_16x16x32_bf16 v[128:131], v[24:27], v[56:59], v[128:131]
    ds_read_b64_tr_b16 v[50:51], v9 offset:29184
    s_waitcnt lgkmcnt(10)
    s_nop 0
    v_mfma_f32_16x16x32_bf16 v[132:135], v[12:15], v[60:63], v[132:135]
    ds_read_b64_tr_b16 v[52:53], v10 offset:4096
    v_mfma_f32_16x16x32_bf16 v[136:139], v[16:19], v[60:63], v[136:139]
    ds_read_b64_tr_b16 v[54:55], v10 offset:4608
    v_mfma_f32_16x16x32_bf16 v[140:143], v[20:23], v[60:63], v[140:143]
    ds_read_b64_tr_b16 v[56:57], v11 offset:4096
    v_mfma_f32_16x16x32_bf16 v[144:147], v[24:27], v[60:63], v[144:147]
    ds_read_b64_tr_b16 v[58:59], v11 offset:4608
    s_waitcnt lgkmcnt(12)
    v_mfma_f32_16x16x32_bf16 v[148:151], v[12:15], v[64:67], v[148:151]
    v_mfma_f32_16x16x32_bf16 v[152:155], v[16:19], v[64:67], v[152:155]
    v_mfma_f32_16x16x32_bf16 v[156:159], v[20:23], v[64:67], v[156:159]
    v_mfma_f32_16x16x32_bf16 v[160:163], v[24:27], v[64:67], v[160:163]
    s_waitcnt lgkmcnt(9)
    v_mfma_f32_16x16x32_bf16 v[100:103], v[28:31], v[44:47], v[100:103]
    s_waitcnt lgkmcnt(8)
    v_mfma_f32_16x16x32_bf16 v[104:107], v[32:35], v[44:47], v[104:107]
    s_waitcnt lgkmcnt(0)
    s_barrier
    s_nop 0
    v_mfma_f32_16x16x32_bf16 v[108:111], v[36:39], v[44:47], v[108:111]
    ds_read_b128 v[12:15], v4 offset:32768
    v_mfma_f32_16x16x32_bf16 v[112:115], v[40:43], v[44:47], v[112:115]
    ds_read_b64_tr_b16 v[60:61], v10 offset:8192
    v_mfma_f32_16x16x32_bf16 v[116:119], v[28:31], v[48:51], v[116:119]
    ds_read_b64_tr_b16 v[62:63], v10 offset:8704
    v_mfma_f32_16x16x32_bf16 v[120:123], v[32:35], v[48:51], v[120:123]
    ds_read_b128 v[16:19], v4 offset:34816
    v_mfma_f32_16x16x32_bf16 v[124:127], v[36:39], v[48:51], v[124:127]
    ds_read_b128 v[20:23], v4 offset:36864
    v_mfma_f32_16x16x32_bf16 v[128:131], v[40:43], v[48:51], v[128:131]
    ds_read_b128 v[24:27], v4 offset:38912
    v_mfma_f32_16x16x32_bf16 v[132:135], v[28:31], v[52:55], v[132:135]
    ds_read_b64_tr_b16 v[64:65], v11 offset:8192
    v_mfma_f32_16x16x32_bf16 v[136:139], v[32:35], v[52:55], v[136:139]
    ds_read_b64_tr_b16 v[66:67], v11 offset:8704
    v_mfma_f32_16x16x32_bf16 v[140:143], v[36:39], v[52:55], v[140:143]
    ds_read_b64_tr_b16 v[44:45], v10 offset:16384
    v_mfma_f32_16x16x32_bf16 v[144:147], v[40:43], v[52:55], v[144:147]
    ds_read_b64_tr_b16 v[46:47], v10 offset:16896
    v_mfma_f32_16x16x32_bf16 v[148:151], v[28:31], v[56:59], v[148:151]
    ds_read_b64_tr_b16 v[48:49], v11 offset:16384
    v_mfma_f32_16x16x32_bf16 v[152:155], v[32:35], v[56:59], v[152:155]
    ds_read_b64_tr_b16 v[50:51], v11 offset:16896
    v_mfma_f32_16x16x32_bf16 v[156:159], v[36:39], v[56:59], v[156:159]
    v_mfma_f32_16x16x32_bf16 v[160:163], v[40:43], v[56:59], v[160:163]
    s_waitcnt lgkmcnt(9)
    v_mfma_f32_16x16x32_bf16 v[100:103], v[12:15], v[60:63], v[100:103]
    ds_read_b128 v[28:31], v5 offset:32768
    s_waitcnt lgkmcnt(9)
    v_mfma_f32_16x16x32_bf16 v[104:107], v[16:19], v[60:63], v[104:107]
    ds_read_b64_tr_b16 v[52:53], v10 offset:12288
    s_waitcnt lgkmcnt(9)
    v_mfma_f32_16x16x32_bf16 v[108:111], v[20:23], v[60:63], v[108:111]
    ds_read_b64_tr_b16 v[54:55], v10 offset:12800
    s_waitcnt lgkmcnt(9)
    v_mfma_f32_16x16x32_bf16 v[112:115], v[24:27], v[60:63], v[112:115]
    ds_read_b128 v[32:35], v5 offset:34816
    s_waitcnt lgkmcnt(8)
    s_nop 0
    v_mfma_f32_16x16x32_bf16 v[116:119], v[12:15], v[64:67], v[116:119]
    ds_read_b128 v[36:39], v5 offset:36864
    v_mfma_f32_16x16x32_bf16 v[120:123], v[16:19], v[64:67], v[120:123]
    ds_read_b128 v[40:43], v5 offset:38912
    v_mfma_f32_16x16x32_bf16 v[124:127], v[20:23], v[64:67], v[124:127]
    ds_read_b64_tr_b16 v[56:57], v11 offset:12288
    v_mfma_f32_16x16x32_bf16 v[128:131], v[24:27], v[64:67], v[128:131]
    ds_read_b64_tr_b16 v[58:59], v11 offset:12800
    s_waitcnt lgkmcnt(10)
    s_nop 0
    v_mfma_f32_16x16x32_bf16 v[132:135], v[12:15], v[44:47], v[132:135]
    ds_read_b64_tr_b16 v[60:61], v10 offset:20480
    v_mfma_f32_16x16x32_bf16 v[136:139], v[16:19], v[44:47], v[136:139]
    ds_read_b64_tr_b16 v[62:63], v10 offset:20992
    v_mfma_f32_16x16x32_bf16 v[140:143], v[20:23], v[44:47], v[140:143]
    ds_read_b64_tr_b16 v[64:65], v11 offset:20480
    v_mfma_f32_16x16x32_bf16 v[144:147], v[24:27], v[44:47], v[144:147]
    ds_read_b64_tr_b16 v[66:67], v11 offset:20992
    s_waitcnt lgkmcnt(12)
    v_mfma_f32_16x16x32_bf16 v[148:151], v[12:15], v[48:51], v[148:151]
    v_mfma_f32_16x16x32_bf16 v[152:155], v[16:19], v[48:51], v[152:155]
    v_mfma_f32_16x16x32_bf16 v[156:159], v[20:23], v[48:51], v[156:159]
    v_mfma_f32_16x16x32_bf16 v[160:163], v[24:27], v[48:51], v[160:163]
    s_waitcnt lgkmcnt(9)
    v_mfma_f32_16x16x32_bf16 v[100:103], v[28:31], v[52:55], v[100:103]
    s_waitcnt lgkmcnt(8)
    v_mfma_f32_16x16x32_bf16 v[104:107], v[32:35], v[52:55], v[104:107]
    s_waitcnt lgkmcnt(0)
    s_barrier
    s_nop 0
    v_mfma_f32_16x16x32_bf16 v[108:111], v[36:39], v[52:55], v[108:111]
    ds_read_b128 v[12:15], v4 offset:49152
    v_mfma_f32_16x16x32_bf16 v[112:115], v[40:43], v[52:55], v[112:115]
    ds_read_b64_tr_b16 v[44:45], v8 offset:0
    v_mfma_f32_16x16x32_bf16 v[116:119], v[28:31], v[56:59], v[116:119]
    ds_read_b64_tr_b16 v[46:47], v8 offset:512
    v_mfma_f32_16x16x32_bf16 v[120:123], v[32:35], v[56:59], v[120:123]
    ds_read_b128 v[16:19], v4 offset:51200
    v_mfma_f32_16x16x32_bf16 v[124:127], v[36:39], v[56:59], v[124:127]
    ds_read_b128 v[20:23], v4 offset:53248
    v_mfma_f32_16x16x32_bf16 v[128:131], v[40:43], v[56:59], v[128:131]
    ds_read_b128 v[24:27], v4 offset:55296
    v_mfma_f32_16x16x32_bf16 v[132:135], v[28:31], v[60:63], v[132:135]
    ds_read_b64_tr_b16 v[48:49], v9 offset:0
    v_mfma_f32_16x16x32_bf16 v[136:139], v[32:35], v[60:63], v[136:139]
    ds_read_b64_tr_b16 v[50:51], v9 offset:512
    v_mfma_f32_16x16x32_bf16 v[140:143], v[36:39], v[60:63], v[140:143]
    ds_read_b64_tr_b16 v[52:53], v10 offset:24576
    v_mfma_f32_16x16x32_bf16 v[144:147], v[40:43], v[60:63], v[144:147]
    ds_read_b64_tr_b16 v[54:55], v10 offset:25088
    v_mfma_f32_16x16x32_bf16 v[148:151], v[28:31], v[64:67], v[148:151]
    ds_read_b64_tr_b16 v[56:57], v11 offset:24576
    v_mfma_f32_16x16x32_bf16 v[152:155], v[32:35], v[64:67], v[152:155]
    ds_read_b64_tr_b16 v[58:59], v11 offset:25088
    v_mfma_f32_16x16x32_bf16 v[156:159], v[36:39], v[64:67], v[156:159]
    v_mfma_f32_16x16x32_bf16 v[160:163], v[40:43], v[64:67], v[160:163]
    ds_read_b32 v68, v1 offset:48
    s_waitcnt lgkmcnt(10)
    v_mfma_f32_16x16x32_bf16 v[100:103], v[12:15], v[44:47], v[100:103]
    ds_read_b128 v[28:31], v5 offset:49152
    s_waitcnt lgkmcnt(10)
    v_mfma_f32_16x16x32_bf16 v[104:107], v[16:19], v[44:47], v[104:107]
    ds_read_b64_tr_b16 v[60:61], v8 offset:4096
    s_waitcnt lgkmcnt(10)
    v_mfma_f32_16x16x32_bf16 v[108:111], v[20:23], v[44:47], v[108:111]
    ds_read_b64_tr_b16 v[62:63], v8 offset:4608
    s_waitcnt lgkmcnt(10)
    v_mfma_f32_16x16x32_bf16 v[112:115], v[24:27], v[44:47], v[112:115]
    ds_read_b128 v[32:35], v5 offset:51200
    s_waitcnt lgkmcnt(9)
    s_nop 0
    v_mfma_f32_16x16x32_bf16 v[116:119], v[12:15], v[48:51], v[116:119]
    ds_read_b128 v[36:39], v5 offset:53248
    v_mfma_f32_16x16x32_bf16 v[120:123], v[16:19], v[48:51], v[120:123]
    ds_read_b128 v[40:43], v5 offset:55296
    v_mfma_f32_16x16x32_bf16 v[124:127], v[20:23], v[48:51], v[124:127]
    ds_read_b64_tr_b16 v[64:65], v9 offset:4096
    v_mfma_f32_16x16x32_bf16 v[128:131], v[24:27], v[48:51], v[128:131]
    ds_read_b64_tr_b16 v[66:67], v9 offset:4608
    s_waitcnt lgkmcnt(11)
    s_nop 0
    v_mfma_f32_16x16x32_bf16 v[132:135], v[12:15], v[52:55], v[132:135]
    ds_read_b64_tr_b16 v[44:45], v10 offset:28672
    v_mfma_f32_16x16x32_bf16 v[136:139], v[16:19], v[52:55], v[136:139]
    ds_read_b64_tr_b16 v[46:47], v10 offset:29184
    v_mfma_f32_16x16x32_bf16 v[140:143], v[20:23], v[52:55], v[140:143]
    ds_read_b64_tr_b16 v[48:49], v11 offset:28672
    v_mfma_f32_16x16x32_bf16 v[144:147], v[24:27], v[52:55], v[144:147]
    ds_read_b64_tr_b16 v[50:51], v11 offset:29184
    s_waitcnt lgkmcnt(13)
    v_mfma_f32_16x16x32_bf16 v[148:151], v[12:15], v[56:59], v[148:151]
    v_mfma_f32_16x16x32_bf16 v[152:155], v[16:19], v[56:59], v[152:155]
    v_mfma_f32_16x16x32_bf16 v[156:159], v[20:23], v[56:59], v[156:159]
    v_mfma_f32_16x16x32_bf16 v[160:163], v[24:27], v[56:59], v[160:163]
    s_waitcnt lgkmcnt(9)
    v_mfma_f32_16x16x32_bf16 v[100:103], v[28:31], v[60:63], v[100:103]
    v_lshlrev_b32 v18, 4, v0
    v_add_u32 v12, s52, v18
    s_waitcnt lgkmcnt(8)
    v_mfma_f32_16x16x32_bf16 v[104:107], v[32:35], v[60:63], v[104:107]
    v_xor_b32 v13, 4096, v12
    v_and_b32 v14, 0x30, v0
    s_waitcnt lgkmcnt(0)
    s_barrier
    v_cmp_gt_u32 vcc, 1, v68
    s_nop 0
    s_and_b32 vcc_lo, vcc_lo, 3
    s_cbranch_scc0 SCK_15
    v_and_b32 v69, 1, v0
    v_lshlrev_b32 v69, 2, v69
    v_add_u32 v69, 159088, v69
    ds_read_b32 v68, v69 offset:0
FW_16:
    s_waitcnt lgkmcnt(0)
    v_cmp_gt_u32 vcc, 1, v68
    s_cbranch_vccz FO_17
    ds_read_b32 v68, v69 offset:0
    s_branch FW_16
FO_17:
SCK_15:
    v_mfma_f32_16x16x32_bf16 v[108:111], v[36:39], v[60:63], v[108:111]
    ds_read_b128 v[68:71], v164 offset:0
    v_add_u32 v14, s53, v14
    v_mfma_f32_16x16x32_bf16 v[112:115], v[40:43], v[60:63], v[112:115]
    ds_read2_b32 v[52:53], v165 offset0:64 offset1:64
    v_xor_b32 v15, 64, v14
    v_mfma_f32_16x16x32_bf16 v[116:119], v[28:31], v[64:67], v[116:119]
    ds_read2_b32 v[54:55], v2 offset0:64 offset1:64
    v_lshlrev_b32 v19, 2, v0
    v_mfma_f32_16x16x32_bf16 v[120:123], v[32:35], v[64:67], v[120:123]
    ds_read2_b32 v[56:57], v165 offset0:128 offset1:128
    v_add_u32 v16, s53, v19
    v_mfma_f32_16x16x32_bf16 v[124:127], v[36:39], v[64:67], v[124:127]
    ds_read2_b32 v[58:59], v2 offset0:128 offset1:128
    v_xor_b32 v17, 256, v16
    v_mfma_f32_16x16x32_bf16 v[128:131], v[40:43], v[64:67], v[128:131]
    ds_read_b128 v[72:75], v164 offset:1024
    v_xor_b32_e64 v18, 8, v3
    v_mfma_f32_16x16x32_bf16 v[132:135], v[28:31], v[44:47], v[132:135]
    ds_read_b128 v[76:79], v164 offset:64
    v_writelane_b32 v18, s50, 1
    v_mfma_f32_16x16x32_bf16 v[136:139], v[32:35], v[44:47], v[136:139]
    ds_read_b128 v[80:83], v164 offset:1088
    v_mov_b32 v20, 0x3f803f80
    v_mfma_f32_16x16x32_bf16 v[140:143], v[36:39], v[44:47], v[140:143]
    ds_read_b128 v[84:87], v164 offset:128
    v_mov_b32 v21, 0x3f803f80
    v_mfma_f32_16x16x32_bf16 v[144:147], v[40:43], v[44:47], v[144:147]
    ds_read_b128 v[88:91], v164 offset:1152
    v_mov_b32 v22, 0x3f803f80
    v_mfma_f32_16x16x32_bf16 v[148:151], v[28:31], v[48:51], v[148:151]
    ds_read_b128 v[92:95], v164 offset:192
    v_mov_b32 v23, 0x3f803f80
    v_mfma_f32_16x16x32_bf16 v[152:155], v[32:35], v[48:51], v[152:155]
    ds_read_b128 v[96:99], v164 offset:1216
    v_mov_b32 v24, 1
    v_and_b32 v4, 15, v0
    v_mfma_f32_16x16x32_bf16 v[156:159], v[36:39], v[48:51], v[156:159]
    v_bfe_u32 v5, v0, 4, 1
    v_lshlrev_b32 v5, 5, v5
    v_mfma_f32_16x16x32_bf16 v[160:163], v[40:43], v[48:51], v[160:163]
    v_lshrrev_b32 v6, 5, v0
    v_lshl_add_u32 v5, v6, 4, v5
    v_lshl_add_u32 v7, v4, 11, v5
    v_lshlrev_b32 v6, 4, v0
    s_waitcnt lgkmcnt(10)
    v_pk_fma_f32 v[100:101], v[68:69], v[52:53], v[100:101]
    v_pk_fma_f32 v[102:103], v[70:71], v[52:53], v[102:103]
    s_waitcnt lgkmcnt(9)
    v_pk_fma_f32 v[116:117], v[68:69], v[54:55], v[116:117]
    v_pk_fma_f32 v[118:119], v[70:71], v[54:55], v[118:119]
    s_waitcnt lgkmcnt(8)
    v_pk_fma_f32 v[132:133], v[68:69], v[56:57], v[132:133]
    v_pk_fma_f32 v[134:135], v[70:71], v[56:57], v[134:135]
    s_waitcnt lgkmcnt(7)
    v_pk_fma_f32 v[148:149], v[68:69], v[58:59], v[148:149]
    v_pk_fma_f32 v[150:151], v[70:71], v[58:59], v[150:151]
    s_waitcnt lgkmcnt(6)
    v_pk_mul_f32 v[100:101], v[100:101], v[72:73]
    v_pk_mul_f32 v[102:103], v[102:103], v[74:75]
    v_pk_mul_f32 v[116:117], v[116:117], v[72:73]
    v_pk_mul_f32 v[118:119], v[118:119], v[74:75]
    v_pk_mul_f32 v[132:133], v[132:133], v[72:73]
    v_pk_mul_f32 v[134:135], v[134:135], v[74:75]
    v_pk_mul_f32 v[148:149], v[148:149], v[72:73]
    v_pk_mul_f32 v[150:151], v[150:151], v[74:75]
    v_exp_f32 v28, v100 clamp
    v_exp_f32 v29, v101 clamp
    v_exp_f32 v30, v102 clamp
    v_exp_f32 v31, v103 clamp
    v_exp_f32 v32, v116 clamp
    v_exp_f32 v33, v117 clamp
    v_exp_f32 v34, v118 clamp
    v_exp_f32 v35, v119 clamp
    v_cvt_pk_bf16_f32 v132, v132, v133
    v_cvt_pk_bf16_f32 v133, v134, v135
    v_cvt_pk_bf16_f32 v148, v148, v149
    v_cvt_pk_bf16_f32 v149, v150, v151
    v_pk_mul_f32 v[100:101], v[100:101], s[40:41] clamp
    v_pk_mul_f32 v[102:103], v[102:103], s[40:41] clamp
    v_pk_mul_f32 v[116:117], v[116:117], s[40:41] clamp
    v_pk_mul_f32 v[118:119], v[118:119], s[40:41] clamp
    v_pk_add_f32 v[28:29], v[28:29], s[74:75]
    v_pk_add_f32 v[30:31], v[30:31], s[74:75]
    v_pk_add_f32 v[32:33], v[32:33], s[74:75]
    v_pk_add_f32 v[34:35], v[34:35], s[74:75]
    v_pk_fma_f32 v[100:101], v[100:101], s[76:77], v[28:29]
    v_pk_fma_f32 v[102:103], v[102:103], s[76:77], v[30:31]
    v_pk_fma_f32 v[116:117], v[116:117], s[76:77], v[32:33]
    v_pk_fma_f32 v[118:119], v[118:119], s[76:77], v[34:35]
    v_cvt_pk_bf16_f32 v100, v100, v101
    v_cvt_pk_bf16_f32 v101, v102, v103
    v_cvt_pk_bf16_f32 v116, v116, v117
    v_cvt_pk_bf16_f32 v117, v118, v119
    s_waitcnt lgkmcnt(5)
    s_nop 0
    v_pk_fma_f32 v[104:105], v[76:77], v[52:53], v[104:105]
    v_pk_fma_f32 v[106:107], v[78:79], v[52:53], v[106:107]
    v_pk_fma_f32 v[120:121], v[76:77], v[54:55], v[120:121]
    v_pk_fma_f32 v[122:123], v[78:79], v[54:55], v[122:123]
    v_pk_fma_f32 v[136:137], v[76:77], v[56:57], v[136:137]
    v_pk_fma_f32 v[138:139], v[78:79], v[56:57], v[138:139]
    v_pk_fma_f32 v[152:153], v[76:77], v[58:59], v[152:153]
    v_pk_fma_f32 v[154:155], v[78:79], v[58:59], v[154:155]
    s_waitcnt lgkmcnt(4)
    s_nop 0
    v_pk_mul_f32 v[104:105], v[104:105], v[80:81]
    v_pk_mul_f32 v[106:107], v[106:107], v[82:83]
    v_pk_mul_f32 v[120:121], v[120:121], v[80:81]
    v_pk_mul_f32 v[122:123], v[122:123], v[82:83]
    v_pk_mul_f32 v[136:137], v[136:137], v[80:81]
    v_pk_mul_f32 v[138:139], v[138:139], v[82:83]
    v_pk_mul_f32 v[152:153], v[152:153], v[80:81]
    v_pk_mul_f32 v[154:155], v[154:155], v[82:83]
    v_exp_f32 v36, v104 clamp
    v_exp_f32 v37, v105 clamp
    v_exp_f32 v38, v106 clamp
    v_exp_f32 v39, v107 clamp
    v_exp_f32 v40, v120 clamp
    v_exp_f32 v41, v121 clamp
    v_exp_f32 v42, v122 clamp
    v_exp_f32 v43, v123 clamp
    v_cvt_pk_bf16_f32 v134, v136, v137
    v_cvt_pk_bf16_f32 v135, v138, v139
    v_cvt_pk_bf16_f32 v150, v152, v153
    v_cvt_pk_bf16_f32 v151, v154, v155
    v_pk_mul_f32 v[104:105], v[104:105], s[40:41] clamp
    v_pk_mul_f32 v[106:107], v[106:107], s[40:41] clamp
    v_pk_mul_f32 v[120:121], v[120:121], s[40:41] clamp
    v_pk_mul_f32 v[122:123], v[122:123], s[40:41] clamp
    v_pk_add_f32 v[36:37], v[36:37], s[74:75]
    v_pk_add_f32 v[38:39], v[38:39], s[74:75]
    v_pk_add_f32 v[40:41], v[40:41], s[74:75]
    v_pk_add_f32 v[42:43], v[42:43], s[74:75]
    v_pk_fma_f32 v[104:105], v[104:105], s[76:77], v[36:37]
    v_pk_fma_f32 v[106:107], v[106:107], s[76:77], v[38:39]
    v_pk_fma_f32 v[120:121], v[120:121], s[76:77], v[40:41]
    v_pk_fma_f32 v[122:123], v[122:123], s[76:77], v[42:43]
    v_cvt_pk_bf16_f32 v102, v104, v105
    v_cvt_pk_bf16_f32 v103, v106, v107
    v_cvt_pk_bf16_f32 v118, v120, v121
    v_cvt_pk_bf16_f32 v119, v122, v123
    s_waitcnt lgkmcnt(3)
    s_nop 0
    v_pk_fma_f32 v[108:109], v[84:85], v[52:53], v[108:109]
    v_pk_fma_f32 v[110:111], v[86:87], v[52:53], v[110:111]
    v_pk_fma_f32 v[124:125], v[84:85], v[54:55], v[124:125]
    v_pk_fma_f32 v[126:127], v[86:87], v[54:55], v[126:127]
    v_pk_fma_f32 v[140:141], v[84:85], v[56:57], v[140:141]
    v_pk_fma_f32 v[142:143], v[86:87], v[56:57], v[142:143]
    v_pk_fma_f32 v[156:157], v[84:85], v[58:59], v[156:157]
    v_pk_fma_f32 v[158:159], v[86:87], v[58:59], v[158:159]
    s_waitcnt lgkmcnt(2)
    s_nop 0
    v_pk_mul_f32 v[108:109], v[108:109], v[88:89]
    v_pk_mul_f32 v[110:111], v[110:111], v[90:91]
    v_pk_mul_f32 v[124:125], v[124:125], v[88:89]
    v_pk_mul_f32 v[126:127], v[126:127], v[90:91]
    v_pk_mul_f32 v[140:141], v[140:141], v[88:89]
    v_pk_mul_f32 v[142:143], v[142:143], v[90:91]
    v_pk_mul_f32 v[156:157], v[156:157], v[88:89]
    v_pk_mul_f32 v[158:159], v[158:159], v[90:91]
    v_mfma_f32_16x16x32_bf16 v[60:63], v[100:103], v[148:151], 0
    v_exp_f32 v28, v108 clamp
    v_exp_f32 v29, v109 clamp
    v_mfma_f32_16x16x32_bf16 v[64:67], v[116:119], v[148:151], 0
    v_exp_f32 v30, v110 clamp
    v_exp_f32 v31, v111 clamp
    v_mfma_f32_16x16x32_bf16 v[68:71], v[100:103], v[20:23], 0
    v_exp_f32 v32, v124 clamp
    v_exp_f32 v33, v125 clamp
    v_exp_f32 v34, v126 clamp
    v_exp_f32 v35, v127 clamp
    v_cvt_pk_bf16_f32 v136, v140, v141
    v_cvt_pk_bf16_f32 v137, v142, v143
    v_cvt_pk_bf16_f32 v152, v156, v157
    v_cvt_pk_bf16_f32 v153, v158, v159
    v_pk_mul_f32 v[108:109], v[108:109], s[40:41] clamp
    v_pk_mul_f32 v[110:111], v[110:111], s[40:41] clamp
    v_pk_mul_f32 v[124:125], v[124:125], s[40:41] clamp
    v_pk_mul_f32 v[126:127], v[126:127], s[40:41] clamp
    v_pk_add_f32 v[28:29], v[28:29], s[74:75]
    v_pk_add_f32 v[30:31], v[30:31], s[74:75]
    v_pk_add_f32 v[32:33], v[32:33], s[74:75]
    v_pk_add_f32 v[34:35], v[34:35], s[74:75]
    v_pk_fma_f32 v[108:109], v[108:109], s[76:77], v[28:29]
    v_pk_fma_f32 v[110:111], v[110:111], s[76:77], v[30:31]
    v_pk_fma_f32 v[124:125], v[124:125], s[76:77], v[32:33]
    v_pk_fma_f32 v[126:127], v[126:127], s[76:77], v[34:35]
    s_branch IW_s5
IW_w5:
    s_branch IW_r5
IW_s5:
    v_cvt_pk_bf16_f32 v104, v108, v109
    v_cvt_pk_bf16_f32 v105, v110, v111
    v_cvt_pk_bf16_f32 v120, v124, v125
    v_cvt_pk_bf16_f32 v121, v126, v127
    s_waitcnt lgkmcnt(1)
    s_nop 0
    v_pk_fma_f32 v[112:113], v[92:93], v[52:53], v[112:113]
    v_pk_fma_f32 v[114:115], v[94:95], v[52:53], v[114:115]
    v_pk_fma_f32 v[128:129], v[92:93], v[54:55], v[128:129]
    v_pk_fma_f32 v[130:131], v[94:95], v[54:55], v[130:131]
    v_pk_fma_f32 v[144:145], v[92:93], v[56:57], v[144:145]
    v_pk_fma_f32 v[146:147], v[94:95], v[56:57], v[146:147]
    v_pk_fma_f32 v[160:161], v[92:93], v[58:59], v[160:161]
    v_pk_fma_f32 v[162:163], v[94:95], v[58:59], v[162:163]
    s_waitcnt lgkmcnt(0)
    s_nop 0
    v_pk_mul_f32 v[112:113], v[112:113], v[96:97]
    v_pk_mul_f32 v[114:115], v[114:115], v[98:99]
    v_pk_mul_f32 v[128:129], v[128:129], v[96:97]
    v_pk_mul_f32 v[130:131], v[130:131], v[98:99]
    v_pk_mul_f32 v[144:145], v[144:145], v[96:97]
    v_pk_mul_f32 v[146:147], v[146:147], v[98:99]
    v_pk_mul_f32 v[160:161], v[160:161], v[96:97]
    v_pk_mul_f32 v[162:163], v[162:163], v[98:99]
    v_mfma_f32_16x16x32_bf16 v[72:75], v[116:119], v[20:23], 0
    v_exp_f32 v36, v112 clamp
    v_exp_f32 v37, v113 clamp
    v_mfma_f32_16x16x32_bf16 v[44:47], v[100:103], v[132:135], 0
    v_exp_f32 v38, v114 clamp
    v_exp_f32 v39, v115 clamp
    v_mfma_f32_16x16x32_bf16 v[48:51], v[116:119], v[132:135], 0
    v_exp_f32 v40, v128 clamp
    v_exp_f32 v41, v129 clamp
    v_exp_f32 v42, v130 clamp
    v_exp_f32 v43, v131 clamp
    v_cvt_pk_bf16_f32 v138, v144, v145
    v_cvt_pk_bf16_f32 v139, v146, v147
    v_cvt_pk_bf16_f32 v154, v160, v161
    v_cvt_pk_bf16_f32 v155, v162, v163
    v_pk_mul_f32 v[112:113], v[112:113], s[40:41] clamp
    v_pk_mul_f32 v[114:115], v[114:115], s[40:41] clamp
    v_pk_mul_f32 v[128:129], v[128:129], s[40:41] clamp
    v_pk_mul_f32 v[130:131], v[130:131], s[40:41] clamp
    v_pk_add_f32 v[36:37], v[36:37], s[74:75]
    v_pk_add_f32 v[38:39], v[38:39], s[74:75]
    v_pk_add_f32 v[40:41], v[40:41], s[74:75]
    v_pk_add_f32 v[42:43], v[42:43], s[74:75]
    v_pk_fma_f32 v[112:113], v[112:113], s[76:77], v[36:37]
    v_pk_fma_f32 v[114:115], v[114:115], s[76:77], v[38:39]
    v_pk_fma_f32 v[128:129], v[128:129], s[76:77], v[40:41]
    v_pk_fma_f32 v[130:131], v[130:131], s[76:77], v[42:43]
    v_cvt_pk_bf16_f32 v106, v112, v113
    v_cvt_pk_bf16_f32 v107, v114, v115
    v_cvt_pk_bf16_f32 v122, v128, v129
    v_cvt_pk_bf16_f32 v123, v130, v131
    v_mfma_f32_16x16x32_bf16 v[60:63], v[104:107], v[152:155], v[60:63]
    s_nop 0
    s_nop 0
    v_mfma_f32_16x16x32_bf16 v[64:67], v[120:123], v[152:155], v[64:67]
    v_mfma_f32_16x16x32_bf16 v[68:71], v[104:107], v[20:23], v[68:71]
    v_mfma_f32_16x16x32_bf16 v[72:75], v[120:123], v[20:23], v[72:75]
    v_mfma_f32_16x16x32_bf16 v[44:47], v[104:107], v[136:139], v[44:47]
    v_mfma_f32_16x16x32_bf16 v[48:51], v[120:123], v[136:139], v[48:51]
    buffer_load_dwordx4 v[140:143], v7, s[12:15], s42 offen offset:0
    buffer_load_dwordx4 v[144:147], v7, s[12:15], s42 offen offset:64
    buffer_load_dwordx4 v[156:159], v7, s[12:15], s43 offen offset:0
    buffer_load_dwordx4 v[160:163], v7, s[12:15], s43 offen offset:64
    ds_write_b128 v12, v[60:63] offset:0
    ds_write_b128 v12, v[64:67] offset:1024
    s_mov_b32 exec_lo, 0x10001
    s_mov_b32 exec_hi, 0x10001
    ds_write_b128 v14, v[68:71]
    ds_write_b128 v15, v[72:75]
    s_mov_b64 exec, 1
    ds_write_b32 v3, v24 offset:32
    s_mov_b64 exec, -1
F_xw:
    ds_read_b32 v25, v18 offset:32
    ds_read_b128 v[28:31], v13 offset:1024
    ds_read_b128 v[32:35], v13
    ds_read_b32 v26, v16
    ds_read_b32 v27, v17
    s_waitcnt lgkmcnt(4)
    v_cmp_eq_u32 vcc, 0, v25
    s_cbranch_vccz F_xx
    s_waitcnt lgkmcnt(0)
    s_branch F_xw
F_xx:
    s_waitcnt lgkmcnt(3)
    v_add_f32 v44, v44, v28
    v_add_f32 v45, v45, v29
    v_add_f32 v46, v46, v30
    v_add_f32 v47, v47, v31
    buffer_atomic_add_f32 v44, v19, s[24:27], s46 offen offset:0
    buffer_atomic_add_f32 v45, v19, s[24:27], s46 offen offset:256
    buffer_atomic_add_f32 v46, v19, s[24:27], s46 offen offset:512
    buffer_atomic_add_f32 v47, v19, s[24:27], s46 offen offset:768
    s_waitcnt lgkmcnt(2)
    v_add_f32 v48, v48, v32
    v_add_f32 v49, v49, v33
    v_add_f32 v50, v50, v34
    v_add_f32 v51, v51, v35
    buffer_atomic_add_f32 v48, v19, s[24:27], s47 offen offset:0
    buffer_atomic_add_f32 v49, v19, s[24:27], s47 offen offset:256
    buffer_atomic_add_f32 v50, v19, s[24:27], s47 offen offset:512
    buffer_atomic_add_f32 v51, v19, s[24:27], s47 offen offset:768
    s_waitcnt lgkmcnt(0)
    v_add_f32 v26, v26, v27
    s_mov_b64 exec, 0xffff
    buffer_atomic_add_f32 v26, v19, s[24:27], s48 offen
    s_mov_b64 exec, 1
    ds_add_u32 v3, v24 offset:32
    s_mov_b64 exec, -1
    s_setprio 2
    v_mov_b32 v2, v7
    s_lshl_b32 s47, s3, 7
    s_add_u32 s47, s47, 157184
    v_lshlrev_b32 v5, 2, v4
    v_add_u32 v5, s47, v5
    ds_read2_b32 v[76:77], v5 offset0:0 offset1:128
    ds_read2_b32 v[78:79], v5 offset0:16 offset1:144
    v_lshrrev_b32 v4, 3, v0
    v_and_b32 v5, 7, v0
    v_lshrrev_b32 v6, 1, v4
    v_lshlrev_b32 v7, 1, v6
    v_xor_b32 v7, v5, v7
    v_lshlrev_b32 v7, 4, v7
    v_lshl_add_u32 v40, v4, 11, v7
    v_and_b32 v6, 1, v6
    v_lshlrev_b32 v6, 1, v6
    v_xor_b32 v41, v5, v6
    v_xor_b32 v42, 4, v41
    v_lshlrev_b32 v41, 4, v41
    v_lshlrev_b32 v42, 4, v42
    v_mul_u32_u24 v7, 6144, v4
    v_add_u32 v41, v41, v7
    v_add_u32 v42, v42, v7
    v_add_u32 v42, 49152, v42
    s_mul_i32 s56, s3, 98304
    s_lshl_b32 s47, s10, 7
    s_add_u32 s56, s56, s47
    s_lshl_b32 s57, s29, 7
    s_lshl_b32 s47, s3, 15
    s_add_u32 s57, s57, s47
    s_and_b32 s81, s28, 3
    s_mul_i32 s81, s81, 4
    s_lshr_b32 s47, s28, 2
    s_mul_i32 s47, s47, 1
    s_add_u32 s81, s81, s47
    s_lshl_b32 s78, s3, 11
    s_lshl_b32 s44, s10, 1
    s_add_u32 s44, s44, s37
    s_mul_i32 s45, s44, 4224
    s_mov_b32 s52, s45
    s_add_u32 s53, s45, 4096
    s_lshl_b32 s51, s44, 3
    s_and_b32 s47, s32, 3
    s_add_u32 s51, s51, s47
    s_lshl_b32 s51, s51, 7
    v_xor_b32 v18, 8, v3
    v_mov_b32 v25, 0

    s_add_u32 s54, s51, 0x82d000
    s_add_u32 s54, s72, s54
    s_addc_u32 s55, s73, 0
    s_add_u32 s82, s49, 0x82d000
    s_add_u32 s82, s72, s82
    s_addc_u32 s83, s73, 0
    s_lshl_b32 s57, s29, 7
    s_and_b32 s47, s3, 1
    s_lshl_b32 s79, s47, 12
    s_lshl_b32 s47, s47, 16
    s_add_u32 s57, s57, s47

    s_setprio 2
    s_waitcnt lgkmcnt(0)
    v_mul_f32 v76, v76, v77
    v_add_f32 v77, 1.0, v77
    v_mul_f32 v78, v78, v79
    v_add_f32 v79, 1.0, v79
    s_waitcnt vmcnt(9)
    v_lshlrev_b32 v100, 16, v140
    v_and_b32 v101, 0xffff0000, v140
    v_lshlrev_b32 v102, 16, v141
    v_and_b32 v103, 0xffff0000, v141
    v_lshlrev_b32 v104, 16, v142
    v_and_b32 v105, 0xffff0000, v142
    v_lshlrev_b32 v106, 16, v143
    v_and_b32 v107, 0xffff0000, v143
    v_fma_f32 v100, v100, v77, v76
    v_fma_f32 v101, v101, v77, v76
    v_fma_f32 v102, v102, v77, v76
    v_fma_f32 v103, v103, v77, v76
    v_fma_f32 v104, v104, v77, v76
    v_fma_f32 v105, v105, v77, v76
    v_fma_f32 v106, v106, v77, v76
    v_fma_f32 v107, v107, v77, v76
    v_lshlrev_b32 v108, 16, v144
    v_and_b32 v109, 0xffff0000, v144
    v_lshlrev_b32 v110, 16, v145
    v_and_b32 v111, 0xffff0000, v145
    v_lshlrev_b32 v112, 16, v146
    v_and_b32 v113, 0xffff0000, v146
    v_lshlrev_b32 v114, 16, v147
    v_and_b32 v115, 0xffff0000, v147
    v_fma_f32 v108, v108, v77, v76
    v_fma_f32 v109, v109, v77, v76
    v_fma_f32 v110, v110, v77, v76
    v_fma_f32 v111, v111, v77, v76
    v_fma_f32 v112, v112, v77, v76
    v_fma_f32 v113, v113, v77, v76
    v_fma_f32 v114, v114, v77, v76
    v_fma_f32 v115, v115, v77, v76
    v_lshlrev_b32 v116, 16, v156
    v_and_b32 v117, 0xffff0000, v156
    v_lshlrev_b32 v118, 16, v157
    v_and_b32 v119, 0xffff0000, v157
    v_lshlrev_b32 v120, 16, v158
    v_and_b32 v121, 0xffff0000, v158
    v_lshlrev_b32 v122, 16, v159
    v_and_b32 v123, 0xffff0000, v159
    v_fma_f32 v116, v116, v79, v78
    v_fma_f32 v117, v117, v79, v78
    v_fma_f32 v118, v118, v79, v78
    v_fma_f32 v119, v119, v79, v78
    v_fma_f32 v120, v120, v79, v78
    v_fma_f32 v121, v121, v79, v78
    v_fma_f32 v122, v122, v79, v78
    v_fma_f32 v123, v123, v79, v78
    v_lshlrev_b32 v124, 16, v160
    v_and_b32 v125, 0xffff0000, v160
    v_lshlrev_b32 v126, 16, v161
    v_and_b32 v127, 0xffff0000, v161
    v_lshlrev_b32 v128, 16, v162
    v_and_b32 v129, 0xffff0000, v162
    v_lshlrev_b32 v130, 16, v163
    v_and_b32 v131, 0xffff0000, v163
    v_fma_f32 v124, v124, v79, v78
    v_fma_f32 v125, v125, v79, v78
    v_fma_f32 v126, v126, v79, v78
    v_fma_f32 v127, v127, v79, v78
    v_fma_f32 v128, v128, v79, v78
    v_fma_f32 v129, v129, v79, v78
    v_fma_f32 v130, v130, v79, v78
    v_fma_f32 v131, v131, v79, v78
    v_permlane16_swap_b32 v100, v104
    v_permlane16_swap_b32 v101, v105
    v_permlane16_swap_b32 v102, v106
    v_permlane16_swap_b32 v103, v107
    v_permlane16_swap_b32 v108, v112
    v_permlane16_swap_b32 v109, v113
    v_permlane16_swap_b32 v110, v114
    v_permlane16_swap_b32 v111, v115
    v_permlane16_swap_b32 v116, v120
    v_permlane16_swap_b32 v117, v121
    v_permlane16_swap_b32 v118, v122
    v_permlane16_swap_b32 v119, v123
    v_permlane16_swap_b32 v124, v128
    v_permlane16_swap_b32 v125, v129
    v_permlane16_swap_b32 v126, v130
    v_permlane16_swap_b32 v127, v131
    s_setprio 2
    s_cmp_lt_u32 s3, 2
    s_cbranch_scc1 F_w0
    v_cmp_gt_u32 vcc, 1, v25
    s_cbranch_vccz CW_18
    ds_read_b32 v25, v1 offset:0
FW_19:
    s_waitcnt lgkmcnt(0)
    v_cmp_gt_u32 vcc, 1, v25
    s_cbranch_vccz FO_20
    s_sleep 2
    ds_read_b32 v25, v1 offset:0
    s_branch FW_19
FO_20:
CW_18:
    s_add_u32 s47, s81, 0
    s_and_b32 s47, s47, 15
    s_lshl_b32 s47, s47, 17
    s_add_u32 m0, s79, 147456
    s_add_u32 s47, s47, s57
    buffer_load_dwordx4 v40, s[20:23], s47 offen lds
    s_add_u32 m0, m0, 1024
    s_add_u32 s47, s47, 16384
    buffer_load_dwordx4 v40, s[20:23], s47 offen lds
    s_add_u32 m0, m0, 1024
    s_add_u32 s47, s47, 16384
    buffer_load_dwordx4 v40, s[20:23], s47 offen lds
    s_add_u32 m0, m0, 1024
    s_add_u32 s47, s47, 16384
    buffer_load_dwordx4 v40, s[20:23], s47 offen lds
    v_cmp_gt_u32 vcc, 2, v25
    s_cbranch_vccz CW_21
    ds_read_b32 v25, v1 offset:0
FW_22:
    s_waitcnt lgkmcnt(0)
    v_cmp_gt_u32 vcc, 2, v25
    s_cbranch_vccz FO_23
    s_sleep 2
    ds_read_b32 v25, v1 offset:0
    s_branch FW_22
FO_23:
CW_21:
    s_add_u32 s47, s81, 1
    s_and_b32 s47, s47, 15
    s_lshl_b32 s47, s47, 17
    s_add_u32 m0, s79, 0
    s_add_u32 s47, s47, s57
    buffer_load_dwordx4 v40, s[20:23], s47 offen lds
    s_add_u32 m0, m0, 1024
    s_add_u32 s47, s47, 16384
    buffer_load_dwordx4 v40, s[20:23], s47 offen lds
    s_add_u32 m0, m0, 1024
    s_add_u32 s47, s47, 16384
    buffer_load_dwordx4 v40, s[20:23], s47 offen lds
    s_add_u32 m0, m0, 1024
    s_add_u32 s47, s47, 16384
    buffer_load_dwordx4 v40, s[20:23], s47 offen lds
    s_waitcnt vmcnt(8)
    s_branch F_w1
F_w0:
    s_waitcnt vmcnt(0)
F_w1:
    s_mov_b32 s49, 1
    s_atomic_add s49, s[82:83], 0x0
    s_atomic_add s49, s[82:83], 0x80
    s_atomic_add s49, s[82:83], 0x100
    s_atomic_add s49, s[82:83], 0x180
    v_mov_b32 v26, 3
    s_mov_b64 exec, 1
    ds_write_b32 v3, v26 offset:32
    s_mov_b64 exec, -1
    s_cmp_ge_u32 s3, 2
    s_cbranch_scc1 F_wo
    ds_read_b32 v26, v18 offset:32
FW_24:
    s_waitcnt lgkmcnt(0)
    v_cmp_gt_u32 vcc, 2, v26
    s_cbranch_vccz FO_25
    ds_read_b32 v26, v18 offset:32
    s_branch FW_24
FO_25:
    v_cmp_gt_u32 vcc, 4, v25
    s_cbranch_vccz CW_26
    ds_read_b32 v25, v1 offset:0
FW_27:
    s_waitcnt lgkmcnt(0)
    v_cmp_gt_u32 vcc, 4, v25
    s_cbranch_vccz FO_28
    s_sleep 2
    ds_read_b32 v25, v1 offset:0
    s_branch FW_27
FO_28:
CW_26:
    v_lshlrev_b32 v9, 4, v0
    s_lshl_b32 s50, s3, 7
    s_add_u32 s50, s50, 159232
    s_add_u32 m0, s78, 40960
SP_29:
    s_load_dword s58, s[54:55], 0 glc
    s_waitcnt lgkmcnt(0)
    s_cmp_ge_u32 s58, 32
    s_cbranch_scc1 SD_30
    s_sleep 1
    s_branch SP_29
SD_30:
    buffer_load_dwordx4 v9, s[24:27], s52 offen offset:0 sc1 lds
    buffer_load_dwordx4 v9, s[24:27], s52 offen offset:1024 sc1 lds
    s_add_u32 m0, m0, 2048
    s_nop 0
    buffer_load_dwordx4 v9, s[24:27], s52 offen offset:2048 sc1 lds
    buffer_load_dwordx4 v9, s[24:27], s52 offen offset:3072 sc1 lds
    s_mov_b32 m0, s50
    s_mov_b32 exec_hi, 0
    buffer_load_dword v19, s[24:27], s53 offen sc1 lds
    s_mov_b64 exec, 1
    s_lshl_b32 s50, s3, 2
    s_add_u32 m0, s50, 159168
    s_add_u32 s51, s51, 184320
    buffer_load_dword v19, s[24:27], s51 offen sc1 lds
    s_waitcnt vmcnt(0)
    s_mov_b64 exec, 1
    v_mov_b32 v26, 32
    ds_write_b32 v3, v26 offset:128
    s_mov_b64 exec, -1
    s_branch F_wj
F_wo:
    v_cmp_gt_u32 vcc, 2, v25
    s_cbranch_vccz CW_31
    ds_read_b32 v25, v1 offset:0
FW_32:
    s_waitcnt lgkmcnt(0)
    v_cmp_gt_u32 vcc, 2, v25
    s_cbranch_vccz FO_33
    s_sleep 2
    ds_read_b32 v25, v1 offset:0
    s_branch FW_32
FO_33:
CW_31:
    s_add_u32 s47, s81, 2
    s_and_b32 s47, s47, 15
    s_lshl_b32 s47, s47, 17
    s_add_u32 m0, s79, 8192
    s_add_u32 s47, s47, s57
    buffer_load_dwordx4 v40, s[20:23], s47 offen lds
    s_add_u32 m0, m0, 1024
    s_add_u32 s47, s47, 16384
    buffer_load_dwordx4 v40, s[20:23], s47 offen lds
    s_add_u32 m0, m0, 1024
    s_add_u32 s47, s47, 16384
    buffer_load_dwordx4 v40, s[20:23], s47 offen lds
    s_add_u32 m0, m0, 1024
    s_add_u32 s47, s47, 16384
    buffer_load_dwordx4 v40, s[20:23], s47 offen lds
    v_cmp_gt_u32 vcc, 2, v25
    s_cbranch_vccz CW_34
    ds_read_b32 v25, v1 offset:0
FW_35:
    s_waitcnt lgkmcnt(0)
    v_cmp_gt_u32 vcc, 2, v25
    s_cbranch_vccz FO_36
    s_sleep 2
    ds_read_b32 v25, v1 offset:0
    s_branch FW_35
FO_36:
CW_34:
    s_add_u32 s47, s81, 3
    s_and_b32 s47, s47, 15
    s_lshl_b32 s47, s47, 17
    s_add_u32 m0, s79, 139264
    s_add_u32 s47, s47, s57
    s_nop 0
    buffer_load_dwordx4 v40, s[20:23], s47 offen lds
    s_add_u32 m0, m0, 1024
    s_add_u32 s47, s47, 16384
    buffer_load_dwordx4 v40, s[20:23], s47 offen lds
    s_add_u32 m0, m0, 1024
    s_add_u32 s47, s47, 16384
    buffer_load_dwordx4 v40, s[20:23], s47 offen lds
    s_add_u32 m0, m0, 1024
    s_add_u32 s47, s47, 16384
    buffer_load_dwordx4 v40, s[20:23], s47 offen lds
    v_cmp_gt_u32 vcc, 3, v25
    s_cbranch_vccz CW_37
    ds_read_b32 v25, v1 offset:0
FW_38:
    s_waitcnt lgkmcnt(0)
    v_cmp_gt_u32 vcc, 3, v25
    s_cbranch_vccz FO_39
    s_sleep 2
    ds_read_b32 v25, v1 offset:0
    s_branch FW_38
FO_39:
CW_37:
    s_waitcnt vmcnt(12)
    s_add_u32 s47, s81, 4
    s_and_b32 s47, s47, 15
    s_lshl_b32 s47, s47, 17
    s_add_u32 m0, s79, 16384
    s_add_u32 s47, s47, s57
    buffer_load_dwordx4 v40, s[20:23], s47 offen lds
    s_add_u32 m0, m0, 1024
    s_add_u32 s47, s47, 16384
    buffer_load_dwordx4 v40, s[20:23], s47 offen lds
    s_add_u32 m0, m0, 1024
    s_add_u32 s47, s47, 16384
    buffer_load_dwordx4 v40, s[20:23], s47 offen lds
    s_add_u32 m0, m0, 1024
    s_add_u32 s47, s47, 16384
    buffer_load_dwordx4 v40, s[20:23], s47 offen lds
    v_cmp_gt_u32 vcc, 3, v25
    s_cbranch_vccz CW_40
    ds_read_b32 v25, v1 offset:0
FW_41:
    s_waitcnt lgkmcnt(0)
    v_cmp_gt_u32 vcc, 3, v25
    s_cbranch_vccz FO_42
    s_sleep 2
    ds_read_b32 v25, v1 offset:0
    s_branch FW_41
FO_42:
CW_40:
    s_waitcnt vmcnt(12)
    s_add_u32 s47, s81, 5
    s_and_b32 s47, s47, 15
    s_lshl_b32 s47, s47, 17
    s_add_u32 m0, s79, 24576
    s_add_u32 s47, s47, s57
    buffer_load_dwordx4 v40, s[20:23], s47 offen lds
    s_add_u32 m0, m0, 1024
    s_add_u32 s47, s47, 16384
    buffer_load_dwordx4 v40, s[20:23], s47 offen lds
    s_add_u32 m0, m0, 1024
    s_add_u32 s47, s47, 16384
    buffer_load_dwordx4 v40, s[20:23], s47 offen lds
    s_add_u32 m0, m0, 1024
    s_add_u32 s47, s47, 16384
    buffer_load_dwordx4 v40, s[20:23], s47 offen lds
    v_cmp_gt_u32 vcc, 3, v25
    s_cbranch_vccz CW_43
    ds_read_b32 v25, v1 offset:0
FW_44:
    s_waitcnt lgkmcnt(0)
    v_cmp_gt_u32 vcc, 3, v25
    s_cbranch_vccz FO_45
    s_sleep 2
    ds_read_b32 v25, v1 offset:0
    s_branch FW_44
FO_45:
CW_43:
    s_waitcnt vmcnt(12)
    s_add_u32 s47, s81, 6
    s_and_b32 s47, s47, 15
    s_lshl_b32 s47, s47, 17
    s_add_u32 m0, s79, 131072
    s_add_u32 s47, s47, s57
    buffer_load_dwordx4 v40, s[20:23], s47 offen lds
    s_add_u32 m0, m0, 1024
    s_add_u32 s47, s47, 16384
    buffer_load_dwordx4 v40, s[20:23], s47 offen lds
    s_add_u32 m0, m0, 1024
    s_add_u32 s47, s47, 16384
    buffer_load_dwordx4 v40, s[20:23], s47 offen lds
    s_add_u32 m0, m0, 1024
    s_add_u32 s47, s47, 16384
    buffer_load_dwordx4 v40, s[20:23], s47 offen lds
    v_cmp_gt_u32 vcc, 4, v25
    s_cbranch_vccz CW_46
    ds_read_b32 v25, v1 offset:0
FW_47:
    s_waitcnt lgkmcnt(0)
    v_cmp_gt_u32 vcc, 4, v25
    s_cbranch_vccz FO_48
    s_sleep 2
    ds_read_b32 v25, v1 offset:0
    s_branch FW_47
FO_48:
CW_46:
    s_waitcnt vmcnt(12)
    s_add_u32 s47, s81, 7
    s_and_b32 s47, s47, 15
    s_lshl_b32 s47, s47, 17
    s_add_u32 m0, s79, 81920
    s_add_u32 s47, s47, s57
    buffer_load_dwordx4 v40, s[20:23], s47 offen lds
    s_add_u32 m0, m0, 1024
    s_add_u32 s47, s47, 16384
    buffer_load_dwordx4 v40, s[20:23], s47 offen lds
    s_add_u32 m0, m0, 1024
    s_add_u32 s47, s47, 16384
    buffer_load_dwordx4 v40, s[20:23], s47 offen lds
    s_add_u32 m0, m0, 1024
    s_add_u32 s47, s47, 16384
    buffer_load_dwordx4 v40, s[20:23], s47 offen lds
    v_cmp_gt_u32 vcc, 5, v25
    s_cbranch_vccz CW_49
    ds_read_b32 v25, v1 offset:0
FW_50:
    s_waitcnt lgkmcnt(0)
    v_cmp_gt_u32 vcc, 5, v25
    s_cbranch_vccz FO_51
    s_sleep 2
    ds_read_b32 v25, v1 offset:0
    s_branch FW_50
FO_51:
CW_49:
    s_waitcnt vmcnt(12)
    s_add_u32 s47, s81, 8
    s_and_b32 s47, s47, 15
    s_lshl_b32 s47, s47, 17
    s_add_u32 m0, s79, 49152
    s_add_u32 s47, s47, s57
    buffer_load_dwordx4 v40, s[20:23], s47 offen lds
    s_add_u32 m0, m0, 1024
    s_add_u32 s47, s47, 16384
    buffer_load_dwordx4 v40, s[20:23], s47 offen lds
    s_add_u32 m0, m0, 1024
    s_add_u32 s47, s47, 16384
    buffer_load_dwordx4 v40, s[20:23], s47 offen lds
    s_add_u32 m0, m0, 1024
    s_add_u32 s47, s47, 16384
    buffer_load_dwordx4 v40, s[20:23], s47 offen lds
    v_cmp_gt_u32 vcc, 5, v25
    s_cbranch_vccz CW_52
    ds_read_b32 v25, v1 offset:0
FW_53:
    s_waitcnt lgkmcnt(0)
    v_cmp_gt_u32 vcc, 5, v25
    s_cbranch_vccz FO_54
    s_sleep 2
    ds_read_b32 v25, v1 offset:0
    s_branch FW_53
FO_54:
CW_52:
    s_waitcnt vmcnt(12)
    s_add_u32 s47, s81, 9
    s_and_b32 s47, s47, 15
    s_lshl_b32 s47, s47, 17
    s_add_u32 m0, s79, 57344
    s_add_u32 s47, s47, s57
    buffer_load_dwordx4 v40, s[20:23], s47 offen lds
    s_add_u32 m0, m0, 1024
    s_add_u32 s47, s47, 16384
    buffer_load_dwordx4 v40, s[20:23], s47 offen lds
    s_add_u32 m0, m0, 1024
    s_add_u32 s47, s47, 16384
    buffer_load_dwordx4 v40, s[20:23], s47 offen lds
    s_add_u32 m0, m0, 1024
    s_add_u32 s47, s47, 16384
    buffer_load_dwordx4 v40, s[20:23], s47 offen lds
    v_cmp_gt_u32 vcc, 5, v25
    s_cbranch_vccz CW_55
    ds_read_b32 v25, v1 offset:0
FW_56:
    s_waitcnt lgkmcnt(0)
    v_cmp_gt_u32 vcc, 5, v25
    s_cbranch_vccz FO_57
    s_sleep 2
    ds_read_b32 v25, v1 offset:0
    s_branch FW_56
FO_57:
CW_55:
    s_waitcnt vmcnt(12)
    s_add_u32 s47, s81, 10
    s_and_b32 s47, s47, 15
    s_lshl_b32 s47, s47, 17
    s_add_u32 m0, s79, 73728
    s_add_u32 s47, s47, s57
    buffer_load_dwordx4 v40, s[20:23], s47 offen lds
    s_add_u32 m0, m0, 1024
    s_add_u32 s47, s47, 16384
    buffer_load_dwordx4 v40, s[20:23], s47 offen lds
    s_add_u32 m0, m0, 1024
    s_add_u32 s47, s47, 16384
    buffer_load_dwordx4 v40, s[20:23], s47 offen lds
    s_add_u32 m0, m0, 1024
    s_add_u32 s47, s47, 16384
    buffer_load_dwordx4 v40, s[20:23], s47 offen lds
    v_cmp_gt_u32 vcc, 6, v25
    s_cbranch_vccz CW_58
    ds_read_b32 v25, v1 offset:0
FW_59:
    s_waitcnt lgkmcnt(0)
    v_cmp_gt_u32 vcc, 6, v25
    s_cbranch_vccz FO_60
    s_sleep 2
    ds_read_b32 v25, v1 offset:0
    s_branch FW_59
FO_60:
CW_58:
    s_waitcnt vmcnt(12)
    s_add_u32 s47, s81, 11
    s_and_b32 s47, s47, 15
    s_lshl_b32 s47, s47, 17
    s_add_u32 m0, s79, 98304
    s_add_u32 s47, s47, s57
    buffer_load_dwordx4 v40, s[20:23], s47 offen lds
    s_add_u32 m0, m0, 1024
    s_add_u32 s47, s47, 16384
    buffer_load_dwordx4 v40, s[20:23], s47 offen lds
    s_add_u32 m0, m0, 1024
    s_add_u32 s47, s47, 16384
    buffer_load_dwordx4 v40, s[20:23], s47 offen lds
    s_add_u32 m0, m0, 1024
    s_add_u32 s47, s47, 16384
    buffer_load_dwordx4 v40, s[20:23], s47 offen lds
    v_cmp_gt_u32 vcc, 7, v25
    s_cbranch_vccz CW_61
    ds_read_b32 v25, v1 offset:0
FW_62:
    s_waitcnt lgkmcnt(0)
    v_cmp_gt_u32 vcc, 7, v25
    s_cbranch_vccz FO_63
    s_sleep 2
    ds_read_b32 v25, v1 offset:0
    s_branch FW_62
FO_63:
CW_61:
    s_waitcnt vmcnt(12)
    s_add_u32 s47, s81, 12
    s_and_b32 s47, s47, 15
    s_lshl_b32 s47, s47, 17
    s_add_u32 m0, s79, 90112
    s_add_u32 s47, s47, s57
    buffer_load_dwordx4 v40, s[20:23], s47 offen lds
    s_add_u32 m0, m0, 1024
    s_add_u32 s47, s47, 16384
    buffer_load_dwordx4 v40, s[20:23], s47 offen lds
    s_add_u32 m0, m0, 1024
    s_add_u32 s47, s47, 16384
    buffer_load_dwordx4 v40, s[20:23], s47 offen lds
    s_add_u32 m0, m0, 1024
    s_add_u32 s47, s47, 16384
    buffer_load_dwordx4 v40, s[20:23], s47 offen lds
    v_cmp_gt_u32 vcc, 8, v25
    s_cbranch_vccz CW_64
    ds_read_b32 v25, v1 offset:0
FW_65:
    s_waitcnt lgkmcnt(0)
    v_cmp_gt_u32 vcc, 8, v25
    s_cbranch_vccz FO_66
    s_sleep 2
    ds_read_b32 v25, v1 offset:0
    s_branch FW_65
FO_66:
CW_64:
    s_waitcnt vmcnt(12)
    s_add_u32 s47, s81, 13
    s_and_b32 s47, s47, 15
    s_lshl_b32 s47, s47, 17
    s_add_u32 m0, s79, 114688
    s_add_u32 s47, s47, s57
    buffer_load_dwordx4 v40, s[20:23], s47 offen lds
    s_add_u32 m0, m0, 1024
    s_add_u32 s47, s47, 16384
    buffer_load_dwordx4 v40, s[20:23], s47 offen lds
    s_add_u32 m0, m0, 1024
    s_add_u32 s47, s47, 16384
    buffer_load_dwordx4 v40, s[20:23], s47 offen lds
    s_add_u32 m0, m0, 1024
    s_add_u32 s47, s47, 16384
    buffer_load_dwordx4 v40, s[20:23], s47 offen lds
    v_cmp_gt_u32 vcc, 9, v25
    s_cbranch_vccz CW_67
    ds_read_b32 v25, v1 offset:0
FW_68:
    s_waitcnt lgkmcnt(0)
    v_cmp_gt_u32 vcc, 9, v25
    s_cbranch_vccz FO_69
    s_sleep 2
    ds_read_b32 v25, v1 offset:0
    s_branch IW_s6
IW_w6:
    s_branch IW_r6
IW_s6:
    s_branch FW_68
FO_69:
CW_67:
    s_waitcnt vmcnt(12)
    s_add_u32 s47, s81, 14
    s_and_b32 s47, s47, 15
    s_lshl_b32 s47, s47, 17
    s_add_u32 m0, s79, 106496
    s_add_u32 s47, s47, s57
    buffer_load_dwordx4 v40, s[20:23], s47 offen lds
    s_add_u32 m0, m0, 1024
    s_add_u32 s47, s47, 16384
    buffer_load_dwordx4 v40, s[20:23], s47 offen lds
    s_add_u32 m0, m0, 1024
    s_add_u32 s47, s47, 16384
    buffer_load_dwordx4 v40, s[20:23], s47 offen lds
    s_add_u32 m0, m0, 1024
    s_add_u32 s47, s47, 16384
    buffer_load_dwordx4 v40, s[20:23], s47 offen lds
    v_cmp_gt_u32 vcc, 10, v25
    s_cbranch_vccz CW_70
    ds_read_b32 v25, v1 offset:0
FW_71:
    s_waitcnt lgkmcnt(0)
    v_cmp_gt_u32 vcc, 10, v25
    s_cbranch_vccz FO_72
    s_sleep 2
    ds_read_b32 v25, v1 offset:0
    s_branch FW_71
FO_72:
CW_70:
    s_waitcnt vmcnt(12)
    s_add_u32 s47, s81, 15
    s_and_b32 s47, s47, 15
    s_lshl_b32 s47, s47, 17
    s_add_u32 m0, s79, 122880
    s_add_u32 s47, s47, s57
    buffer_load_dwordx4 v40, s[20:23], s47 offen lds
    s_add_u32 m0, m0, 1024
    s_add_u32 s47, s47, 16384
    buffer_load_dwordx4 v40, s[20:23], s47 offen lds
    s_add_u32 m0, m0, 1024
    s_add_u32 s47, s47, 16384
    buffer_load_dwordx4 v40, s[20:23], s47 offen lds
    s_add_u32 m0, m0, 1024
    s_add_u32 s47, s47, 16384
    buffer_load_dwordx4 v40, s[20:23], s47 offen lds
F_wj:
    v_mov_b32 v5, 159096
    ds_read_b32 v6, v5 offset:0
FW_73:
    s_waitcnt lgkmcnt(0)
    v_cmp_gt_u32 vcc, 1, v6
    s_cbranch_vccz FO_74
    s_sleep 1
    ds_read_b32 v6, v5 offset:0
    s_branch FW_73
FO_74:
    v_and_b32 v5, 7, v0
    v_lshlrev_b32 v5, 2, v5
    v_add_u32 v5, 158976, v5
    ds_read_b32 v5, v5
    s_lshr_b32 s47, s64, 5
    s_sub_u32 s47, 63, s47
    s_mov_b64 s[60:61], 0
    s_waitcnt lgkmcnt(0)
    v_bfe_u32 v5, v5, 5, 6
    v_cmp_eq_u32 vcc, s47, v5
    s_cbranch_vccz F_ns

    v_mov_b32 v5, 158976
    ds_read_b128 v[44:47], v5
    ds_read_b128 v[48:51], v5 offset:16
    v_and_b32 v6, 15, v0
    v_add_u32 v6, s64, v6
    v_sub_u32 v6, 2047, v6
    v_subrev_u32 v7, 16, v6
    v_mov_b32 v164, 0
    v_mov_b32 v165, 0
    s_waitcnt lgkmcnt(0)
    v_and_b32 v5, 0x7ff, v44
    v_or_b32 v44, 0x4000, v44
    v_cmp_eq_u32 vcc, v5, v6
    v_cmp_eq_u32 s[62:63], v5, v7
    s_nop 0
    v_cndmask_b32 v164, v164, v44, vcc
    v_cndmask_b32 v165, v165, v44, s[62:63]
    v_and_b32 v5, 0x7ff, v45
    v_or_b32 v45, 0x4800, v45
    v_cmp_eq_u32 vcc, v5, v6
    v_cmp_eq_u32 s[62:63], v5, v7
    s_nop 0
    v_cndmask_b32 v164, v164, v45, vcc
    v_cndmask_b32 v165, v165, v45, s[62:63]
    v_and_b32 v5, 0x7ff, v46
    v_or_b32 v46, 0x5000, v46
    v_cmp_eq_u32 vcc, v5, v6
    v_cmp_eq_u32 s[62:63], v5, v7
    s_nop 0
    v_cndmask_b32 v164, v164, v46, vcc
    v_cndmask_b32 v165, v165, v46, s[62:63]
    v_and_b32 v5, 0x7ff, v47
    v_or_b32 v47, 0x5800, v47
    v_cmp_eq_u32 vcc, v5, v6
    v_cmp_eq_u32 s[62:63], v5, v7
    s_nop 0
    v_cndmask_b32 v164, v164, v47, vcc
    v_cndmask_b32 v165, v165, v47, s[62:63]
    v_and_b32 v5, 0x7ff, v48
    v_or_b32 v48, 0x6000, v48
    v_cmp_eq_u32 vcc, v5, v6
    v_cmp_eq_u32 s[62:63], v5, v7
    s_nop 0
    v_cndmask_b32 v164, v164, v48, vcc
    v_cndmask_b32 v165, v165, v48, s[62:63]
    v_and_b32 v5, 0x7ff, v49
    v_or_b32 v49, 0x6800, v49
    v_cmp_eq_u32 vcc, v5, v6
    v_cmp_eq_u32 s[62:63], v5, v7
    s_nop 0
    v_cndmask_b32 v164, v164, v49, vcc
    v_cndmask_b32 v165, v165, v49, s[62:63]
    v_and_b32 v5, 0x7ff, v50
    v_or_b32 v50, 0x7000, v50
    v_cmp_eq_u32 vcc, v5, v6
    v_cmp_eq_u32 s[62:63], v5, v7
    s_nop 0
    v_cndmask_b32 v164, v164, v50, vcc
    v_cndmask_b32 v165, v165, v50, s[62:63]
    v_and_b32 v5, 0x7ff, v51
    v_or_b32 v51, 0x7800, v51
    v_cmp_eq_u32 vcc, v5, v6
    v_cmp_eq_u32 s[62:63], v5, v7
    s_nop 0
    v_cndmask_b32 v164, v164, v51, vcc
    v_cndmask_b32 v165, v165, v51, s[62:63]
    s_mov_b64 s[60:61], 1
F_ns:
    s_lshl_b32 s51, s28, 2
    s_add_u32 s51, s51, s3
    s_lshl_b32 s51, s51, 3
    s_and_b32 s47, s29, 3
    s_add_u32 s51, s51, s47
    s_lshl_b32 s51, s51, 7

    s_add_u32 s54, s51, 0x835000
    s_add_u32 s54, s72, s54
    s_addc_u32 s55, s73, 0
    v_lshlrev_b32 v98, 4, v0
    v_lshrrev_b32 v16, 4, v0
    v_bfe_u32 v17, v0, 2, 2
    v_lshl_add_u32 v17, v16, 2, v17
    v_bfe_u32 v16, v17, 1, 2
    v_lshlrev_b32 v16, 5, v16
    v_lshl_add_u32 v16, v17, 7, v16
    v_and_b32 v17, 3, v0
    v_lshl_add_u32 v4, v17, 3, v16
    v_xor_b32 v5, 32, v4
    v_xor_b32 v6, 64, v4
    v_xor_b32 v7, 96, v4
    s_lshl_b32 s79, s28, 18
    s_lshl_b32 s80, s3, 16
    s_add_u32 s79, s79, s80
    s_lshl_b32 s81, s81, 11
    v_mov_b32_e64 v99, 1

    v_add_u32 v8, 57344, v4
    v_add_u32 v9, 57344, v5
    v_add_u32 v10, 57344, v6
    v_add_u32 v11, 57344, v7
    v_add_u32 v12, 114688, v4
    v_add_u32 v13, 114688, v5
    v_add_u32 v14, 114688, v6
    v_add_u32 v15, 114688, v7
    s_add_u32 s16, s72, 0x400000
    s_addc_u32 s17, s73, 0
    s_mov_b32 s18, 0x400000
    s_mov_b32 s19, 0x00020000
    s_mov_b32 s12, s68
    s_mov_b32 s13, s69
    s_mov_b32 s14, 0x400000
    s_mov_b32 s15, 0x00020000
    s_add_u32 s80, s81, 0
    s_and_b32 s80, s80, 0x7fff
    s_add_u32 s4, s80, s79
    s_add_u32 s80, s81, 2048
    s_and_b32 s80, s80, 0x7fff
    s_add_u32 s5, s80, s79
    s_add_u32 s80, s81, 4096
    s_and_b32 s80, s80, 0x7fff
    s_add_u32 s6, s80, s79
    s_add_u32 s80, s81, 6144
    s_and_b32 s80, s80, 0x7fff
    s_add_u32 s7, s80, s79
    s_add_u32 s80, s81, 8192
    s_and_b32 s80, s80, 0x7fff
    s_add_u32 s8, s80, s79
    s_add_u32 s80, s81, 10240
    s_and_b32 s80, s80, 0x7fff
    s_add_u32 s9, s80, s79
    s_add_u32 s80, s81, 12288
    s_and_b32 s80, s80, 0x7fff
    s_add_u32 s10, s80, s79
    s_add_u32 s80, s81, 14336
    s_and_b32 s80, s80, 0x7fff
    s_add_u32 s11, s80, s79
    s_add_u32 s80, s81, 16384
    s_and_b32 s80, s80, 0x7fff
    s_add_u32 s30, s80, s79
    s_add_u32 s80, s81, 18432
    s_and_b32 s80, s80, 0x7fff
    s_add_u32 s31, s80, s79
    s_add_u32 s80, s81, 20480
    s_and_b32 s80, s80, 0x7fff
    s_add_u32 s32, s80, s79
    s_add_u32 s80, s81, 22528
    s_and_b32 s80, s80, 0x7fff
    s_add_u32 s33, s80, s79
    s_add_u32 s80, s81, 24576
    s_and_b32 s80, s80, 0x7fff
    s_add_u32 s34, s80, s79
    s_add_u32 s80, s81, 26624
    s_and_b32 s80, s80, 0x7fff
    s_add_u32 s35, s80, s79
    s_add_u32 s80, s81, 28672
    s_and_b32 s80, s80, 0x7fff
    s_add_u32 s36, s80, s79
    s_add_u32 s80, s81, 30720
    s_and_b32 s80, s80, 0x7fff
    s_add_u32 s37, s80, s79
    v_add_u32 v97, 0x8000, v98
    s_setprio 2
    s_mov_b32 s50, 0
F_op:
    s_load_dword s47, s[54:55], 0 glc
    s_getreg_b32 s51, hwreg(HW_REG_IB_STS)
    s_and_b32 s51, s51, 0xc0000f
    s_or_b32 s51, s51, s50
    s_cbranch_scc1 F_oq
    s_mov_b64 exec, 1
    ds_write_b32 v3, v99 offset:160
    s_mov_b64 exec, -1
    s_mov_b32 s50, 1
F_oq:
    s_waitcnt lgkmcnt(0)
    s_cmp_lt_u32 s47, 16
    s_cbranch_scc1 F_op
    s_nop 0
    buffer_load_dwordx4 v[48:51], v98, s[16:19], s4 offen offset:0 sc1
    buffer_load_dwordx4 v[52:55], v97, s[16:19], s4 offen offset:0 sc1
    buffer_load_dwordx4 v[56:59], v98, s[16:19], s4 offen offset:1024 sc1
    buffer_load_dwordx4 v[60:63], v97, s[16:19], s4 offen offset:1024 sc1
    buffer_load_dwordx4 v[64:67], v98, s[16:19], s5 offen offset:0 sc1
    buffer_load_dwordx4 v[68:71], v97, s[16:19], s5 offen offset:0 sc1
    buffer_load_dwordx4 v[72:75], v98, s[16:19], s5 offen offset:1024 sc1
    buffer_load_dwordx4 v[76:79], v97, s[16:19], s5 offen offset:1024 sc1
    buffer_load_dwordx4 v[80:83], v98, s[16:19], s6 offen offset:0 sc1
    buffer_load_dwordx4 v[84:87], v97, s[16:19], s6 offen offset:0 sc1
    buffer_load_dwordx4 v[88:91], v98, s[16:19], s6 offen offset:1024 sc1
    buffer_load_dwordx4 v[92:95], v97, s[16:19], s6 offen offset:1024 sc1
    s_cmp_lg_u32 s50, 0
    s_cbranch_scc1 F_or
    s_waitcnt vmcnt(12)
    s_mov_b64 exec, 1
    ds_write_b32 v3, v99 offset:160
    s_mov_b64 exec, -1
F_or:
    v_or_b32 v17, 8, v1
    ds_read_b32 v16, v17 offset:160
FW_75:
    s_waitcnt lgkmcnt(0)
    v_cmp_gt_u32 vcc, 1, v16
    s_cbranch_vccz FO_76
    ds_read_b32 v16, v17 offset:160
    s_branch FW_75
FO_76:
    v_and_b32 v1, 0x3fff, v2
    v_bfe_u32 v99, v0, 3, 1
    v_lshl_add_u32 v1, v99, 6, v1
    ds_read_b64_tr_b16 v[16:17], v12 offset:32768
    ds_read_b64_tr_b16 v[18:19], v12 offset:34816
    ds_read_b64_tr_b16 v[20:21], v13 offset:32768
    ds_read_b64_tr_b16 v[22:23], v13 offset:34816
    ds_read_b64_tr_b16 v[24:25], v14 offset:32768
    ds_read_b64_tr_b16 v[26:27], v14 offset:34816
    ds_read_b64_tr_b16 v[28:29], v15 offset:32768
    ds_read_b64_tr_b16 v[30:31], v15 offset:34816
    s_waitcnt vmcnt(10) lgkmcnt(0)
    s_nop 0
    v_mfma_f32_16x16x32_bf16 v[100:103], v[16:19], v[48:51], v[100:103]
    ds_read_b64_tr_b16 v[32:33], v12 offset:36864
    ds_read_b64_tr_b16 v[34:35], v12 offset:38912
    v_mfma_f32_16x16x32_bf16 v[116:119], v[16:19], v[52:55], v[116:119]
    ds_read_b64_tr_b16 v[36:37], v13 offset:36864
    ds_read_b64_tr_b16 v[38:39], v13 offset:38912
    v_mfma_f32_16x16x32_bf16 v[104:107], v[20:23], v[48:51], v[104:107]
    ds_read_b64_tr_b16 v[40:41], v14 offset:36864
    ds_read_b64_tr_b16 v[42:43], v14 offset:38912
    v_mfma_f32_16x16x32_bf16 v[120:123], v[20:23], v[52:55], v[120:123]
    ds_read_b64_tr_b16 v[44:45], v15 offset:36864
    ds_read_b64_tr_b16 v[46:47], v15 offset:38912
    v_mfma_f32_16x16x32_bf16 v[108:111], v[24:27], v[48:51], v[108:111]
    buffer_load_dwordx4 v[132:135], v98, s[16:19], s7 offen offset:0 sc1
    v_mfma_f32_16x16x32_bf16 v[124:127], v[24:27], v[52:55], v[124:127]
    v_mfma_f32_16x16x32_bf16 v[112:115], v[28:31], v[48:51], v[112:115]
    buffer_load_dwordx4 v[136:139], v97, s[16:19], s7 offen offset:0 sc1
    v_mfma_f32_16x16x32_bf16 v[128:131], v[28:31], v[52:55], v[128:131]
    s_waitcnt vmcnt(10) lgkmcnt(0)
    s_nop 0
    v_mfma_f32_16x16x32_bf16 v[100:103], v[32:35], v[56:59], v[100:103]
    ds_read_b64_tr_b16 v[16:17], v4 offset:0
    ds_read_b64_tr_b16 v[18:19], v4 offset:2048
    v_mfma_f32_16x16x32_bf16 v[116:119], v[32:35], v[60:63], v[116:119]
    ds_read_b64_tr_b16 v[20:21], v5 offset:0
    ds_read_b64_tr_b16 v[22:23], v5 offset:2048
    v_mfma_f32_16x16x32_bf16 v[104:107], v[36:39], v[56:59], v[104:107]
    ds_read_b64_tr_b16 v[24:25], v6 offset:0
    ds_read_b64_tr_b16 v[26:27], v6 offset:2048
    v_mfma_f32_16x16x32_bf16 v[120:123], v[36:39], v[60:63], v[120:123]
    ds_read_b64_tr_b16 v[28:29], v7 offset:0
    ds_read_b64_tr_b16 v[30:31], v7 offset:2048
    v_mfma_f32_16x16x32_bf16 v[108:111], v[40:43], v[56:59], v[108:111]
    buffer_load_dwordx4 v[48:51], v98, s[16:19], s7 offen offset:1024 sc1
    v_mfma_f32_16x16x32_bf16 v[124:127], v[40:43], v[60:63], v[124:127]
    v_mfma_f32_16x16x32_bf16 v[112:115], v[44:47], v[56:59], v[112:115]
    buffer_load_dwordx4 v[52:55], v97, s[16:19], s7 offen offset:1024 sc1
    v_mfma_f32_16x16x32_bf16 v[128:131], v[44:47], v[60:63], v[128:131]
    s_waitcnt vmcnt(10) lgkmcnt(0)
    s_nop 0
    v_mfma_f32_16x16x32_bf16 v[100:103], v[16:19], v[64:67], v[100:103]
    ds_read_b64_tr_b16 v[32:33], v4 offset:4096
    ds_read_b64_tr_b16 v[34:35], v4 offset:6144
    v_mfma_f32_16x16x32_bf16 v[116:119], v[16:19], v[68:71], v[116:119]
    ds_read_b64_tr_b16 v[36:37], v5 offset:4096
    ds_read_b64_tr_b16 v[38:39], v5 offset:6144
    v_mfma_f32_16x16x32_bf16 v[104:107], v[20:23], v[64:67], v[104:107]
    ds_read_b64_tr_b16 v[40:41], v6 offset:4096
    ds_read_b64_tr_b16 v[42:43], v6 offset:6144
    v_mfma_f32_16x16x32_bf16 v[120:123], v[20:23], v[68:71], v[120:123]
    ds_read_b64_tr_b16 v[44:45], v7 offset:4096
    ds_read_b64_tr_b16 v[46:47], v7 offset:6144
    v_mfma_f32_16x16x32_bf16 v[108:111], v[24:27], v[64:67], v[108:111]
    buffer_load_dwordx4 v[56:59], v98, s[16:19], s8 offen offset:0 sc1
    v_mfma_f32_16x16x32_bf16 v[124:127], v[24:27], v[68:71], v[124:127]
    v_mfma_f32_16x16x32_bf16 v[112:115], v[28:31], v[64:67], v[112:115]
    buffer_load_dwordx4 v[60:63], v97, s[16:19], s8 offen offset:0 sc1
    v_mfma_f32_16x16x32_bf16 v[128:131], v[28:31], v[68:71], v[128:131]
    s_waitcnt vmcnt(10) lgkmcnt(0)
    s_nop 0
    v_mfma_f32_16x16x32_bf16 v[100:103], v[32:35], v[72:75], v[100:103]
    ds_read_b64_tr_b16 v[16:17], v4 offset:8192
    ds_read_b64_tr_b16 v[18:19], v4 offset:10240
    v_mfma_f32_16x16x32_bf16 v[116:119], v[32:35], v[76:79], v[116:119]
    ds_read_b64_tr_b16 v[20:21], v5 offset:8192
    ds_read_b64_tr_b16 v[22:23], v5 offset:10240
    v_mfma_f32_16x16x32_bf16 v[104:107], v[36:39], v[72:75], v[104:107]
    ds_read_b64_tr_b16 v[24:25], v6 offset:8192
    ds_read_b64_tr_b16 v[26:27], v6 offset:10240
    v_mfma_f32_16x16x32_bf16 v[120:123], v[36:39], v[76:79], v[120:123]
    ds_read_b64_tr_b16 v[28:29], v7 offset:8192
    ds_read_b64_tr_b16 v[30:31], v7 offset:10240
    v_mfma_f32_16x16x32_bf16 v[108:111], v[40:43], v[72:75], v[108:111]
    buffer_load_dwordx4 v[64:67], v98, s[16:19], s8 offen offset:1024 sc1
    v_mfma_f32_16x16x32_bf16 v[124:127], v[40:43], v[76:79], v[124:127]
    v_mfma_f32_16x16x32_bf16 v[112:115], v[44:47], v[72:75], v[112:115]
    buffer_load_dwordx4 v[68:71], v97, s[16:19], s8 offen offset:1024 sc1
    v_mfma_f32_16x16x32_bf16 v[128:131], v[44:47], v[76:79], v[128:131]
    s_waitcnt vmcnt(10) lgkmcnt(0)
    s_nop 0
    v_mfma_f32_16x16x32_bf16 v[100:103], v[16:19], v[80:83], v[100:103]
    ds_read_b64_tr_b16 v[32:33], v4 offset:12288
    ds_read_b64_tr_b16 v[34:35], v4 offset:14336
    v_mfma_f32_16x16x32_bf16 v[116:119], v[16:19], v[84:87], v[116:119]
    ds_read_b64_tr_b16 v[36:37], v5 offset:12288
    ds_read_b64_tr_b16 v[38:39], v5 offset:14336
    v_mfma_f32_16x16x32_bf16 v[104:107], v[20:23], v[80:83], v[104:107]
    ds_read_b64_tr_b16 v[40:41], v6 offset:12288
    ds_read_b64_tr_b16 v[42:43], v6 offset:14336
    v_mfma_f32_16x16x32_bf16 v[120:123], v[20:23], v[84:87], v[120:123]
    ds_read_b64_tr_b16 v[44:45], v7 offset:12288
    ds_read_b64_tr_b16 v[46:47], v7 offset:14336
    v_mfma_f32_16x16x32_bf16 v[108:111], v[24:27], v[80:83], v[108:111]
    buffer_load_dwordx4 v[72:75], v98, s[16:19], s9 offen offset:0 sc1
    v_mfma_f32_16x16x32_bf16 v[124:127], v[24:27], v[84:87], v[124:127]
    v_mfma_f32_16x16x32_bf16 v[112:115], v[28:31], v[80:83], v[112:115]
    buffer_load_dwordx4 v[76:79], v97, s[16:19], s9 offen offset:0 sc1
    v_mfma_f32_16x16x32_bf16 v[128:131], v[28:31], v[84:87], v[128:131]
    s_waitcnt vmcnt(10) lgkmcnt(0)
    s_nop 0
    v_mfma_f32_16x16x32_bf16 v[100:103], v[32:35], v[88:91], v[100:103]
    ds_read_b64_tr_b16 v[16:17], v12 offset:24576
    ds_read_b64_tr_b16 v[18:19], v12 offset:26624
    v_mfma_f32_16x16x32_bf16 v[116:119], v[32:35], v[92:95], v[116:119]
    ds_read_b64_tr_b16 v[20:21], v13 offset:24576
    ds_read_b64_tr_b16 v[22:23], v13 offset:26624
    v_mfma_f32_16x16x32_bf16 v[104:107], v[36:39], v[88:91], v[104:107]
    ds_read_b64_tr_b16 v[24:25], v14 offset:24576
    ds_read_b64_tr_b16 v[26:27], v14 offset:26624
    v_mfma_f32_16x16x32_bf16 v[120:123], v[36:39], v[92:95], v[120:123]
    ds_read_b64_tr_b16 v[28:29], v15 offset:24576
    ds_read_b64_tr_b16 v[30:31], v15 offset:26624
    v_mfma_f32_16x16x32_bf16 v[108:111], v[40:43], v[88:91], v[108:111]
    buffer_load_dwordx4 v[80:83], v98, s[16:19], s9 offen offset:1024 sc1
    v_mfma_f32_16x16x32_bf16 v[124:127], v[40:43], v[92:95], v[124:127]
    v_mfma_f32_16x16x32_bf16 v[112:115], v[44:47], v[88:91], v[112:115]
    buffer_load_dwordx4 v[84:87], v97, s[16:19], s9 offen offset:1024 sc1
    v_mfma_f32_16x16x32_bf16 v[128:131], v[44:47], v[92:95], v[128:131]
    s_waitcnt vmcnt(10) lgkmcnt(0)
    s_nop 0
    v_mfma_f32_16x16x32_bf16 v[100:103], v[16:19], v[132:135], v[100:103]
    ds_read_b64_tr_b16 v[32:33], v12 offset:28672
    ds_read_b64_tr_b16 v[34:35], v12 offset:30720
    v_mfma_f32_16x16x32_bf16 v[116:119], v[16:19], v[136:139], v[116:119]
    ds_read_b64_tr_b16 v[36:37], v13 offset:28672
    ds_read_b64_tr_b16 v[38:39], v13 offset:30720
    v_mfma_f32_16x16x32_bf16 v[104:107], v[20:23], v[132:135], v[104:107]
    ds_read_b64_tr_b16 v[40:41], v14 offset:28672
    ds_read_b64_tr_b16 v[42:43], v14 offset:30720
    v_mfma_f32_16x16x32_bf16 v[120:123], v[20:23], v[136:139], v[120:123]
    ds_read_b64_tr_b16 v[44:45], v15 offset:28672
    ds_read_b64_tr_b16 v[46:47], v15 offset:30720
    v_mfma_f32_16x16x32_bf16 v[108:111], v[24:27], v[132:135], v[108:111]
    buffer_load_dwordx4 v[88:91], v98, s[16:19], s10 offen offset:0 sc1
    v_mfma_f32_16x16x32_bf16 v[124:127], v[24:27], v[136:139], v[124:127]
    v_mfma_f32_16x16x32_bf16 v[112:115], v[28:31], v[132:135], v[112:115]
    buffer_load_dwordx4 v[92:95], v97, s[16:19], s10 offen offset:0 sc1
    v_mfma_f32_16x16x32_bf16 v[128:131], v[28:31], v[136:139], v[128:131]
    s_waitcnt vmcnt(10) lgkmcnt(0)
    s_nop 0
    v_mfma_f32_16x16x32_bf16 v[100:103], v[32:35], v[48:51], v[100:103]
    ds_read_b64_tr_b16 v[16:17], v4 offset:16384
    ds_read_b64_tr_b16 v[18:19], v4 offset:18432
    v_mfma_f32_16x16x32_bf16 v[116:119], v[32:35], v[52:55], v[116:119]
    ds_read_b64_tr_b16 v[20:21], v5 offset:16384
    ds_read_b64_tr_b16 v[22:23], v5 offset:18432
    v_mfma_f32_16x16x32_bf16 v[104:107], v[36:39], v[48:51], v[104:107]
    ds_read_b64_tr_b16 v[24:25], v6 offset:16384
    ds_read_b64_tr_b16 v[26:27], v6 offset:18432
    v_mfma_f32_16x16x32_bf16 v[120:123], v[36:39], v[52:55], v[120:123]
    ds_read_b64_tr_b16 v[28:29], v7 offset:16384
    ds_read_b64_tr_b16 v[30:31], v7 offset:18432
    v_mfma_f32_16x16x32_bf16 v[108:111], v[40:43], v[48:51], v[108:111]
    buffer_load_dwordx4 v[132:135], v98, s[16:19], s10 offen offset:1024 sc1
    v_mfma_f32_16x16x32_bf16 v[124:127], v[40:43], v[52:55], v[124:127]
    v_mfma_f32_16x16x32_bf16 v[112:115], v[44:47], v[48:51], v[112:115]
    buffer_load_dwordx4 v[136:139], v97, s[16:19], s10 offen offset:1024 sc1
    v_mfma_f32_16x16x32_bf16 v[128:131], v[44:47], v[52:55], v[128:131]
    s_waitcnt vmcnt(10) lgkmcnt(0)
    s_nop 0
    v_mfma_f32_16x16x32_bf16 v[100:103], v[16:19], v[56:59], v[100:103]
    ds_read_b64_tr_b16 v[32:33], v4 offset:20480
    ds_read_b64_tr_b16 v[34:35], v4 offset:22528
    v_mfma_f32_16x16x32_bf16 v[116:119], v[16:19], v[60:63], v[116:119]
    ds_read_b64_tr_b16 v[36:37], v5 offset:20480
    ds_read_b64_tr_b16 v[38:39], v5 offset:22528
    v_mfma_f32_16x16x32_bf16 v[104:107], v[20:23], v[56:59], v[104:107]
    ds_read_b64_tr_b16 v[40:41], v6 offset:20480
    ds_read_b64_tr_b16 v[42:43], v6 offset:22528
    v_mfma_f32_16x16x32_bf16 v[120:123], v[20:23], v[60:63], v[120:123]
    ds_read_b64_tr_b16 v[44:45], v7 offset:20480
    ds_read_b64_tr_b16 v[46:47], v7 offset:22528
    v_mfma_f32_16x16x32_bf16 v[108:111], v[24:27], v[56:59], v[108:111]
    buffer_load_dwordx4 v[48:51], v98, s[16:19], s11 offen offset:0 sc1
    v_mfma_f32_16x16x32_bf16 v[124:127], v[24:27], v[60:63], v[124:127]
    v_mfma_f32_16x16x32_bf16 v[112:115], v[28:31], v[56:59], v[112:115]
    buffer_load_dwordx4 v[52:55], v97, s[16:19], s11 offen offset:0 sc1
    v_mfma_f32_16x16x32_bf16 v[128:131], v[28:31], v[60:63], v[128:131]
    s_waitcnt vmcnt(10) lgkmcnt(0)
    s_nop 0
    v_mfma_f32_16x16x32_bf16 v[100:103], v[32:35], v[64:67], v[100:103]
    ds_read_b64_tr_b16 v[16:17], v4 offset:24576
    ds_read_b64_tr_b16 v[18:19], v4 offset:26624
    v_mfma_f32_16x16x32_bf16 v[116:119], v[32:35], v[68:71], v[116:119]
    ds_read_b64_tr_b16 v[20:21], v5 offset:24576
    ds_read_b64_tr_b16 v[22:23], v5 offset:26624
    v_mfma_f32_16x16x32_bf16 v[104:107], v[36:39], v[64:67], v[104:107]
    ds_read_b64_tr_b16 v[24:25], v6 offset:24576
    ds_read_b64_tr_b16 v[26:27], v6 offset:26624
    v_mfma_f32_16x16x32_bf16 v[120:123], v[36:39], v[68:71], v[120:123]
    ds_read_b64_tr_b16 v[28:29], v7 offset:24576
    ds_read_b64_tr_b16 v[30:31], v7 offset:26624
    v_mfma_f32_16x16x32_bf16 v[108:111], v[40:43], v[64:67], v[108:111]
    buffer_load_dwordx4 v[56:59], v98, s[16:19], s11 offen offset:1024 sc1
    v_mfma_f32_16x16x32_bf16 v[124:127], v[40:43], v[68:71], v[124:127]
    v_mfma_f32_16x16x32_bf16 v[112:115], v[44:47], v[64:67], v[112:115]
    buffer_load_dwordx4 v[60:63], v97, s[16:19], s11 offen offset:1024 sc1
    v_mfma_f32_16x16x32_bf16 v[128:131], v[44:47], v[68:71], v[128:131]
    s_waitcnt vmcnt(10) lgkmcnt(0)
    s_nop 0
    v_mfma_f32_16x16x32_bf16 v[100:103], v[16:19], v[72:75], v[100:103]
    ds_read_b64_tr_b16 v[32:33], v4 offset:28672
    ds_read_b64_tr_b16 v[34:35], v4 offset:30720
    v_mfma_f32_16x16x32_bf16 v[116:119], v[16:19], v[76:79], v[116:119]
    ds_read_b64_tr_b16 v[36:37], v5 offset:28672
    ds_read_b64_tr_b16 v[38:39], v5 offset:30720
    v_mfma_f32_16x16x32_bf16 v[104:107], v[20:23], v[72:75], v[104:107]
    ds_read_b64_tr_b16 v[40:41], v6 offset:28672
    ds_read_b64_tr_b16 v[42:43], v6 offset:30720
    v_mfma_f32_16x16x32_bf16 v[120:123], v[20:23], v[76:79], v[120:123]
    ds_read_b64_tr_b16 v[44:45], v7 offset:28672
    ds_read_b64_tr_b16 v[46:47], v7 offset:30720
    v_mfma_f32_16x16x32_bf16 v[108:111], v[24:27], v[72:75], v[108:111]
    buffer_load_dwordx4 v[64:67], v98, s[16:19], s30 offen offset:0 sc1
    v_mfma_f32_16x16x32_bf16 v[124:127], v[24:27], v[76:79], v[124:127]
    v_mfma_f32_16x16x32_bf16 v[112:115], v[28:31], v[72:75], v[112:115]
    buffer_load_dwordx4 v[68:71], v97, s[16:19], s30 offen offset:0 sc1
    v_mfma_f32_16x16x32_bf16 v[128:131], v[28:31], v[76:79], v[128:131]
    s_waitcnt vmcnt(10) lgkmcnt(0)
    s_nop 0
    v_mfma_f32_16x16x32_bf16 v[100:103], v[32:35], v[80:83], v[100:103]
    ds_read_b64_tr_b16 v[16:17], v12 offset:16384
    ds_read_b64_tr_b16 v[18:19], v12 offset:18432
    v_mfma_f32_16x16x32_bf16 v[116:119], v[32:35], v[84:87], v[116:119]
    ds_read_b64_tr_b16 v[20:21], v13 offset:16384
    ds_read_b64_tr_b16 v[22:23], v13 offset:18432
    v_mfma_f32_16x16x32_bf16 v[104:107], v[36:39], v[80:83], v[104:107]
    ds_read_b64_tr_b16 v[24:25], v14 offset:16384
    ds_read_b64_tr_b16 v[26:27], v14 offset:18432
    v_mfma_f32_16x16x32_bf16 v[120:123], v[36:39], v[84:87], v[120:123]
    ds_read_b64_tr_b16 v[28:29], v15 offset:16384
    ds_read_b64_tr_b16 v[30:31], v15 offset:18432
    v_mfma_f32_16x16x32_bf16 v[108:111], v[40:43], v[80:83], v[108:111]
    buffer_load_dwordx4 v[72:75], v98, s[16:19], s30 offen offset:1024 sc1
    v_mfma_f32_16x16x32_bf16 v[124:127], v[40:43], v[84:87], v[124:127]
    v_mfma_f32_16x16x32_bf16 v[112:115], v[44:47], v[80:83], v[112:115]
    buffer_load_dwordx4 v[76:79], v97, s[16:19], s30 offen offset:1024 sc1
    v_mfma_f32_16x16x32_bf16 v[128:131], v[44:47], v[84:87], v[128:131]
    s_waitcnt vmcnt(10) lgkmcnt(0)
    s_nop 0
    v_mfma_f32_16x16x32_bf16 v[100:103], v[16:19], v[88:91], v[100:103]
    ds_read_b64_tr_b16 v[32:33], v12 offset:20480
    ds_read_b64_tr_b16 v[34:35], v12 offset:22528
    v_mfma_f32_16x16x32_bf16 v[116:119], v[16:19], v[92:95], v[116:119]
    ds_read_b64_tr_b16 v[36:37], v13 offset:20480
    ds_read_b64_tr_b16 v[38:39], v13 offset:22528
    v_mfma_f32_16x16x32_bf16 v[104:107], v[20:23], v[88:91], v[104:107]
    ds_read_b64_tr_b16 v[40:41], v14 offset:20480
    ds_read_b64_tr_b16 v[42:43], v14 offset:22528
    v_mfma_f32_16x16x32_bf16 v[120:123], v[20:23], v[92:95], v[120:123]
    ds_read_b64_tr_b16 v[44:45], v15 offset:20480
    ds_read_b64_tr_b16 v[46:47], v15 offset:22528
    v_mfma_f32_16x16x32_bf16 v[108:111], v[24:27], v[88:91], v[108:111]
    buffer_load_dwordx4 v[80:83], v98, s[16:19], s31 offen offset:0 sc1
    v_mfma_f32_16x16x32_bf16 v[124:127], v[24:27], v[92:95], v[124:127]
    v_mfma_f32_16x16x32_bf16 v[112:115], v[28:31], v[88:91], v[112:115]
    buffer_load_dwordx4 v[84:87], v97, s[16:19], s31 offen offset:0 sc1
    v_mfma_f32_16x16x32_bf16 v[128:131], v[28:31], v[92:95], v[128:131]
    s_waitcnt vmcnt(10) lgkmcnt(0)
    s_nop 0
    v_mfma_f32_16x16x32_bf16 v[100:103], v[32:35], v[132:135], v[100:103]
    ds_read_b64_tr_b16 v[16:17], v8 offset:24576
    ds_read_b64_tr_b16 v[18:19], v8 offset:26624
    v_mfma_f32_16x16x32_bf16 v[116:119], v[32:35], v[136:139], v[116:119]
    ds_read_b64_tr_b16 v[20:21], v9 offset:24576
    ds_read_b64_tr_b16 v[22:23], v9 offset:26624
    v_mfma_f32_16x16x32_bf16 v[104:107], v[36:39], v[132:135], v[104:107]
    ds_read_b64_tr_b16 v[24:25], v10 offset:24576
    ds_read_b64_tr_b16 v[26:27], v10 offset:26624
    v_mfma_f32_16x16x32_bf16 v[120:123], v[36:39], v[136:139], v[120:123]
    ds_read_b64_tr_b16 v[28:29], v11 offset:24576
    ds_read_b64_tr_b16 v[30:31], v11 offset:26624
    v_mfma_f32_16x16x32_bf16 v[108:111], v[40:43], v[132:135], v[108:111]
    buffer_load_dwordx4 v[88:91], v98, s[16:19], s31 offen offset:1024 sc1
    v_mfma_f32_16x16x32_bf16 v[124:127], v[40:43], v[136:139], v[124:127]
    v_mfma_f32_16x16x32_bf16 v[112:115], v[44:47], v[132:135], v[112:115]
    buffer_load_dwordx4 v[92:95], v97, s[16:19], s31 offen offset:1024 sc1
    v_mfma_f32_16x16x32_bf16 v[128:131], v[44:47], v[136:139], v[128:131]
    s_waitcnt vmcnt(10) lgkmcnt(0)
    s_nop 0
    v_mfma_f32_16x16x32_bf16 v[100:103], v[16:19], v[48:51], v[100:103]
    ds_read_b64_tr_b16 v[32:33], v8 offset:28672
    ds_read_b64_tr_b16 v[34:35], v8 offset:30720
    v_mfma_f32_16x16x32_bf16 v[116:119], v[16:19], v[52:55], v[116:119]
    ds_read_b64_tr_b16 v[36:37], v9 offset:28672
    ds_read_b64_tr_b16 v[38:39], v9 offset:30720
    v_mfma_f32_16x16x32_bf16 v[104:107], v[20:23], v[48:51], v[104:107]
    ds_read_b64_tr_b16 v[40:41], v10 offset:28672
    ds_read_b64_tr_b16 v[42:43], v10 offset:30720
    v_mfma_f32_16x16x32_bf16 v[120:123], v[20:23], v[52:55], v[120:123]
    ds_read_b64_tr_b16 v[44:45], v11 offset:28672
    ds_read_b64_tr_b16 v[46:47], v11 offset:30720
    v_mfma_f32_16x16x32_bf16 v[108:111], v[24:27], v[48:51], v[108:111]
    buffer_load_dwordx4 v[132:135], v98, s[16:19], s32 offen offset:0 sc1
    v_mfma_f32_16x16x32_bf16 v[124:127], v[24:27], v[52:55], v[124:127]
    v_mfma_f32_16x16x32_bf16 v[112:115], v[28:31], v[48:51], v[112:115]
    buffer_load_dwordx4 v[136:139], v97, s[16:19], s32 offen offset:0 sc1
    v_mfma_f32_16x16x32_bf16 v[128:131], v[28:31], v[52:55], v[128:131]
    s_waitcnt vmcnt(10) lgkmcnt(0)
    s_nop 0
    v_mfma_f32_16x16x32_bf16 v[100:103], v[32:35], v[56:59], v[100:103]
    ds_read_b64_tr_b16 v[16:17], v4 offset:49152
    ds_read_b64_tr_b16 v[18:19], v4 offset:51200
    v_mfma_f32_16x16x32_bf16 v[116:119], v[32:35], v[60:63], v[116:119]
    ds_read_b64_tr_b16 v[20:21], v5 offset:49152
    ds_read_b64_tr_b16 v[22:23], v5 offset:51200
    v_mfma_f32_16x16x32_bf16 v[104:107], v[36:39], v[56:59], v[104:107]
    ds_read_b64_tr_b16 v[24:25], v6 offset:49152
    ds_read_b64_tr_b16 v[26:27], v6 offset:51200
    v_mfma_f32_16x16x32_bf16 v[120:123], v[36:39], v[60:63], v[120:123]
    ds_read_b64_tr_b16 v[28:29], v7 offset:49152
    ds_read_b64_tr_b16 v[30:31], v7 offset:51200
    v_mfma_f32_16x16x32_bf16 v[108:111], v[40:43], v[56:59], v[108:111]
    buffer_load_dwordx4 v[48:51], v98, s[16:19], s32 offen offset:1024 sc1
    v_mfma_f32_16x16x32_bf16 v[124:127], v[40:43], v[60:63], v[124:127]
    v_mfma_f32_16x16x32_bf16 v[112:115], v[44:47], v[56:59], v[112:115]
    s_branch IW_s7
IW_w7:
    s_branch IW_r7
IW_s7:
    buffer_load_dwordx4 v[52:55], v97, s[16:19], s32 offen offset:1024 sc1
    v_mfma_f32_16x16x32_bf16 v[128:131], v[44:47], v[60:63], v[128:131]
    s_waitcnt vmcnt(10) lgkmcnt(0)
    s_nop 0
    v_mfma_f32_16x16x32_bf16 v[100:103], v[16:19], v[64:67], v[100:103]
    ds_read_b64_tr_b16 v[32:33], v4 offset:53248
    ds_read_b64_tr_b16 v[34:35], v4 offset:55296
    v_mfma_f32_16x16x32_bf16 v[116:119], v[16:19], v[68:71], v[116:119]
    ds_read_b64_tr_b16 v[36:37], v5 offset:53248
    ds_read_b64_tr_b16 v[38:39], v5 offset:55296
    v_mfma_f32_16x16x32_bf16 v[104:107], v[20:23], v[64:67], v[104:107]
    ds_read_b64_tr_b16 v[40:41], v6 offset:53248
    ds_read_b64_tr_b16 v[42:43], v6 offset:55296
    v_mfma_f32_16x16x32_bf16 v[120:123], v[20:23], v[68:71], v[120:123]
    ds_read_b64_tr_b16 v[44:45], v7 offset:53248
    ds_read_b64_tr_b16 v[46:47], v7 offset:55296
    v_mfma_f32_16x16x32_bf16 v[108:111], v[24:27], v[64:67], v[108:111]
    buffer_load_dwordx4 v[56:59], v98, s[16:19], s33 offen offset:0 sc1
    v_mfma_f32_16x16x32_bf16 v[124:127], v[24:27], v[68:71], v[124:127]
    v_mfma_f32_16x16x32_bf16 v[112:115], v[28:31], v[64:67], v[112:115]
    buffer_load_dwordx4 v[60:63], v97, s[16:19], s33 offen offset:0 sc1
    v_mfma_f32_16x16x32_bf16 v[128:131], v[28:31], v[68:71], v[128:131]
    s_waitcnt vmcnt(10) lgkmcnt(0)
    s_nop 0
    v_mfma_f32_16x16x32_bf16 v[100:103], v[32:35], v[72:75], v[100:103]
    ds_read_b64_tr_b16 v[16:17], v8 offset:0
    ds_read_b64_tr_b16 v[18:19], v8 offset:2048
    v_mfma_f32_16x16x32_bf16 v[116:119], v[32:35], v[76:79], v[116:119]
    ds_read_b64_tr_b16 v[20:21], v9 offset:0
    ds_read_b64_tr_b16 v[22:23], v9 offset:2048
    v_mfma_f32_16x16x32_bf16 v[104:107], v[36:39], v[72:75], v[104:107]
    ds_read_b64_tr_b16 v[24:25], v10 offset:0
    ds_read_b64_tr_b16 v[26:27], v10 offset:2048
    v_mfma_f32_16x16x32_bf16 v[120:123], v[36:39], v[76:79], v[120:123]
    ds_read_b64_tr_b16 v[28:29], v11 offset:0
    ds_read_b64_tr_b16 v[30:31], v11 offset:2048
    v_mfma_f32_16x16x32_bf16 v[108:111], v[40:43], v[72:75], v[108:111]
    buffer_load_dwordx4 v[64:67], v98, s[16:19], s33 offen offset:1024 sc1
    v_mfma_f32_16x16x32_bf16 v[124:127], v[40:43], v[76:79], v[124:127]
    v_mfma_f32_16x16x32_bf16 v[112:115], v[44:47], v[72:75], v[112:115]
    buffer_load_dwordx4 v[68:71], v97, s[16:19], s33 offen offset:1024 sc1
    v_mfma_f32_16x16x32_bf16 v[128:131], v[44:47], v[76:79], v[128:131]
    s_waitcnt vmcnt(10) lgkmcnt(0)
    s_nop 0
    v_mfma_f32_16x16x32_bf16 v[100:103], v[16:19], v[80:83], v[100:103]
    ds_read_b64_tr_b16 v[32:33], v8 offset:4096
    ds_read_b64_tr_b16 v[34:35], v8 offset:6144
    v_mfma_f32_16x16x32_bf16 v[116:119], v[16:19], v[84:87], v[116:119]
    ds_read_b64_tr_b16 v[36:37], v9 offset:4096
    ds_read_b64_tr_b16 v[38:39], v9 offset:6144
    v_mfma_f32_16x16x32_bf16 v[104:107], v[20:23], v[80:83], v[104:107]
    ds_read_b64_tr_b16 v[40:41], v10 offset:4096
    ds_read_b64_tr_b16 v[42:43], v10 offset:6144
    v_mfma_f32_16x16x32_bf16 v[120:123], v[20:23], v[84:87], v[120:123]
    ds_read_b64_tr_b16 v[44:45], v11 offset:4096
    ds_read_b64_tr_b16 v[46:47], v11 offset:6144
    v_mfma_f32_16x16x32_bf16 v[108:111], v[24:27], v[80:83], v[108:111]
    buffer_load_dwordx4 v[72:75], v98, s[16:19], s34 offen offset:0 sc1
    v_mfma_f32_16x16x32_bf16 v[124:127], v[24:27], v[84:87], v[124:127]
    v_mfma_f32_16x16x32_bf16 v[112:115], v[28:31], v[80:83], v[112:115]
    buffer_load_dwordx4 v[76:79], v97, s[16:19], s34 offen offset:0 sc1
    v_mfma_f32_16x16x32_bf16 v[128:131], v[28:31], v[84:87], v[128:131]
    s_waitcnt vmcnt(10) lgkmcnt(0)
    s_nop 0
    v_mfma_f32_16x16x32_bf16 v[100:103], v[32:35], v[88:91], v[100:103]
    ds_read_b64_tr_b16 v[16:17], v8 offset:16384
    ds_read_b64_tr_b16 v[18:19], v8 offset:18432
    v_mfma_f32_16x16x32_bf16 v[116:119], v[32:35], v[92:95], v[116:119]
    ds_read_b64_tr_b16 v[20:21], v9 offset:16384
    ds_read_b64_tr_b16 v[22:23], v9 offset:18432
    v_mfma_f32_16x16x32_bf16 v[104:107], v[36:39], v[88:91], v[104:107]
    ds_read_b64_tr_b16 v[24:25], v10 offset:16384
    ds_read_b64_tr_b16 v[26:27], v10 offset:18432
    v_mfma_f32_16x16x32_bf16 v[120:123], v[36:39], v[92:95], v[120:123]
    ds_read_b64_tr_b16 v[28:29], v11 offset:16384
    ds_read_b64_tr_b16 v[30:31], v11 offset:18432
    v_mfma_f32_16x16x32_bf16 v[108:111], v[40:43], v[88:91], v[108:111]
    buffer_load_dwordx4 v[80:83], v98, s[16:19], s34 offen offset:1024 sc1
    v_mfma_f32_16x16x32_bf16 v[124:127], v[40:43], v[92:95], v[124:127]
    v_mfma_f32_16x16x32_bf16 v[112:115], v[44:47], v[88:91], v[112:115]
    buffer_load_dwordx4 v[84:87], v97, s[16:19], s34 offen offset:1024 sc1
    v_mfma_f32_16x16x32_bf16 v[128:131], v[44:47], v[92:95], v[128:131]
    s_waitcnt vmcnt(10) lgkmcnt(0)
    s_nop 0
    v_mfma_f32_16x16x32_bf16 v[100:103], v[16:19], v[132:135], v[100:103]
    ds_read_b64_tr_b16 v[32:33], v8 offset:20480
    ds_read_b64_tr_b16 v[34:35], v8 offset:22528
    v_mfma_f32_16x16x32_bf16 v[116:119], v[16:19], v[136:139], v[116:119]
    ds_read_b64_tr_b16 v[36:37], v9 offset:20480
    ds_read_b64_tr_b16 v[38:39], v9 offset:22528
    v_mfma_f32_16x16x32_bf16 v[104:107], v[20:23], v[132:135], v[104:107]
    ds_read_b64_tr_b16 v[40:41], v10 offset:20480
    ds_read_b64_tr_b16 v[42:43], v10 offset:22528
    v_mfma_f32_16x16x32_bf16 v[120:123], v[20:23], v[136:139], v[120:123]
    ds_read_b64_tr_b16 v[44:45], v11 offset:20480
    ds_read_b64_tr_b16 v[46:47], v11 offset:22528
    v_mfma_f32_16x16x32_bf16 v[108:111], v[24:27], v[132:135], v[108:111]
    buffer_load_dwordx4 v[88:91], v98, s[16:19], s35 offen offset:0 sc1
    v_mfma_f32_16x16x32_bf16 v[124:127], v[24:27], v[136:139], v[124:127]
    v_mfma_f32_16x16x32_bf16 v[112:115], v[28:31], v[132:135], v[112:115]
    buffer_load_dwordx4 v[92:95], v97, s[16:19], s35 offen offset:0 sc1
    v_mfma_f32_16x16x32_bf16 v[128:131], v[28:31], v[136:139], v[128:131]
    s_waitcnt vmcnt(10) lgkmcnt(0)
    s_nop 0
    v_mfma_f32_16x16x32_bf16 v[100:103], v[32:35], v[48:51], v[100:103]
    ds_read_b64_tr_b16 v[16:17], v8 offset:40960
    ds_read_b64_tr_b16 v[18:19], v8 offset:43008
    v_mfma_f32_16x16x32_bf16 v[116:119], v[32:35], v[52:55], v[116:119]
    ds_read_b64_tr_b16 v[20:21], v9 offset:40960
    ds_read_b64_tr_b16 v[22:23], v9 offset:43008
    v_mfma_f32_16x16x32_bf16 v[104:107], v[36:39], v[48:51], v[104:107]
    ds_read_b64_tr_b16 v[24:25], v10 offset:40960
    ds_read_b64_tr_b16 v[26:27], v10 offset:43008
    v_mfma_f32_16x16x32_bf16 v[120:123], v[36:39], v[52:55], v[120:123]
    ds_read_b64_tr_b16 v[28:29], v11 offset:40960
    ds_read_b64_tr_b16 v[30:31], v11 offset:43008
    v_mfma_f32_16x16x32_bf16 v[108:111], v[40:43], v[48:51], v[108:111]
    buffer_load_dwordx4 v[132:135], v98, s[16:19], s35 offen offset:1024 sc1
    v_mfma_f32_16x16x32_bf16 v[124:127], v[40:43], v[52:55], v[124:127]
    v_mfma_f32_16x16x32_bf16 v[112:115], v[44:47], v[48:51], v[112:115]
    buffer_load_dwordx4 v[136:139], v97, s[16:19], s35 offen offset:1024 sc1
    v_mfma_f32_16x16x32_bf16 v[128:131], v[44:47], v[52:55], v[128:131]
    s_waitcnt vmcnt(10) lgkmcnt(0)
    s_nop 0
    v_mfma_f32_16x16x32_bf16 v[100:103], v[16:19], v[56:59], v[100:103]
    ds_read_b64_tr_b16 v[32:33], v8 offset:45056
    ds_read_b64_tr_b16 v[34:35], v8 offset:47104
    v_mfma_f32_16x16x32_bf16 v[116:119], v[16:19], v[60:63], v[116:119]
    ds_read_b64_tr_b16 v[36:37], v9 offset:45056
    ds_read_b64_tr_b16 v[38:39], v9 offset:47104
    v_mfma_f32_16x16x32_bf16 v[104:107], v[20:23], v[56:59], v[104:107]
    ds_read_b64_tr_b16 v[40:41], v10 offset:45056
    ds_read_b64_tr_b16 v[42:43], v10 offset:47104
    v_mfma_f32_16x16x32_bf16 v[120:123], v[20:23], v[60:63], v[120:123]
    ds_read_b64_tr_b16 v[44:45], v11 offset:45056
    ds_read_b64_tr_b16 v[46:47], v11 offset:47104
    v_mfma_f32_16x16x32_bf16 v[108:111], v[24:27], v[56:59], v[108:111]
    buffer_load_dwordx4 v[48:51], v98, s[16:19], s36 offen offset:0 sc1
    v_mfma_f32_16x16x32_bf16 v[124:127], v[24:27], v[60:63], v[124:127]
    v_mfma_f32_16x16x32_bf16 v[112:115], v[28:31], v[56:59], v[112:115]
    buffer_load_dwordx4 v[52:55], v97, s[16:19], s36 offen offset:0 sc1
    v_mfma_f32_16x16x32_bf16 v[128:131], v[28:31], v[60:63], v[128:131]
    s_waitcnt vmcnt(10) lgkmcnt(0)
    s_nop 0
    v_mfma_f32_16x16x32_bf16 v[100:103], v[32:35], v[64:67], v[100:103]
    ds_read_b64_tr_b16 v[16:17], v8 offset:32768
    ds_read_b64_tr_b16 v[18:19], v8 offset:34816
    v_mfma_f32_16x16x32_bf16 v[116:119], v[32:35], v[68:71], v[116:119]
    ds_read_b64_tr_b16 v[20:21], v9 offset:32768
    ds_read_b64_tr_b16 v[22:23], v9 offset:34816
    v_mfma_f32_16x16x32_bf16 v[104:107], v[36:39], v[64:67], v[104:107]
    ds_read_b64_tr_b16 v[24:25], v10 offset:32768
    ds_read_b64_tr_b16 v[26:27], v10 offset:34816
    v_mfma_f32_16x16x32_bf16 v[120:123], v[36:39], v[68:71], v[120:123]
    ds_read_b64_tr_b16 v[28:29], v11 offset:32768
    ds_read_b64_tr_b16 v[30:31], v11 offset:34816
    v_mfma_f32_16x16x32_bf16 v[108:111], v[40:43], v[64:67], v[108:111]
    buffer_load_dwordx4 v[56:59], v98, s[16:19], s36 offen offset:1024 sc1
    v_mfma_f32_16x16x32_bf16 v[124:127], v[40:43], v[68:71], v[124:127]
    v_mfma_f32_16x16x32_bf16 v[112:115], v[44:47], v[64:67], v[112:115]
    buffer_load_dwordx4 v[60:63], v97, s[16:19], s36 offen offset:1024 sc1
    v_mfma_f32_16x16x32_bf16 v[128:131], v[44:47], v[68:71], v[128:131]
    s_waitcnt vmcnt(10) lgkmcnt(0)
    s_nop 0
    v_mfma_f32_16x16x32_bf16 v[100:103], v[16:19], v[72:75], v[100:103]
    ds_read_b64_tr_b16 v[32:33], v8 offset:36864
    ds_read_b64_tr_b16 v[34:35], v8 offset:38912
    v_mfma_f32_16x16x32_bf16 v[116:119], v[16:19], v[76:79], v[116:119]
    ds_read_b64_tr_b16 v[36:37], v9 offset:36864
    ds_read_b64_tr_b16 v[38:39], v9 offset:38912
    v_mfma_f32_16x16x32_bf16 v[104:107], v[20:23], v[72:75], v[104:107]
    ds_read_b64_tr_b16 v[40:41], v10 offset:36864
    ds_read_b64_tr_b16 v[42:43], v10 offset:38912
    v_mfma_f32_16x16x32_bf16 v[120:123], v[20:23], v[76:79], v[120:123]
    ds_read_b64_tr_b16 v[44:45], v11 offset:36864
    ds_read_b64_tr_b16 v[46:47], v11 offset:38912
    v_mfma_f32_16x16x32_bf16 v[108:111], v[24:27], v[72:75], v[108:111]
    buffer_load_dwordx4 v[64:67], v98, s[16:19], s37 offen offset:0 sc1
    v_mfma_f32_16x16x32_bf16 v[124:127], v[24:27], v[76:79], v[124:127]
    v_mfma_f32_16x16x32_bf16 v[112:115], v[28:31], v[72:75], v[112:115]
    buffer_load_dwordx4 v[68:71], v97, s[16:19], s37 offen offset:0 sc1
    v_mfma_f32_16x16x32_bf16 v[128:131], v[28:31], v[76:79], v[128:131]
    s_waitcnt vmcnt(10) lgkmcnt(0)
    s_nop 0
    v_mfma_f32_16x16x32_bf16 v[100:103], v[32:35], v[80:83], v[100:103]
    ds_read_b64_tr_b16 v[16:17], v12 offset:0
    ds_read_b64_tr_b16 v[18:19], v12 offset:2048
    v_mfma_f32_16x16x32_bf16 v[116:119], v[32:35], v[84:87], v[116:119]
    ds_read_b64_tr_b16 v[20:21], v13 offset:0
    ds_read_b64_tr_b16 v[22:23], v13 offset:2048
    v_mfma_f32_16x16x32_bf16 v[104:107], v[36:39], v[80:83], v[104:107]
    ds_read_b64_tr_b16 v[24:25], v14 offset:0
    ds_read_b64_tr_b16 v[26:27], v14 offset:2048
    v_mfma_f32_16x16x32_bf16 v[120:123], v[36:39], v[84:87], v[120:123]
    ds_read_b64_tr_b16 v[28:29], v15 offset:0
    ds_read_b64_tr_b16 v[30:31], v15 offset:2048
    v_mfma_f32_16x16x32_bf16 v[108:111], v[40:43], v[80:83], v[108:111]
    buffer_load_dwordx4 v[72:75], v98, s[16:19], s37 offen offset:1024 sc1
    v_mfma_f32_16x16x32_bf16 v[124:127], v[40:43], v[84:87], v[124:127]
    v_mfma_f32_16x16x32_bf16 v[112:115], v[44:47], v[80:83], v[112:115]
    buffer_load_dwordx4 v[76:79], v97, s[16:19], s37 offen offset:1024 sc1
    v_mfma_f32_16x16x32_bf16 v[128:131], v[44:47], v[84:87], v[128:131]
    s_waitcnt vmcnt(10) lgkmcnt(0)
    s_nop 0
    v_mfma_f32_16x16x32_bf16 v[100:103], v[16:19], v[88:91], v[100:103]
    ds_read_b64_tr_b16 v[32:33], v12 offset:4096
    ds_read_b64_tr_b16 v[34:35], v12 offset:6144
    v_mfma_f32_16x16x32_bf16 v[116:119], v[16:19], v[92:95], v[116:119]
    ds_read_b64_tr_b16 v[36:37], v13 offset:4096
    ds_read_b64_tr_b16 v[38:39], v13 offset:6144
    v_mfma_f32_16x16x32_bf16 v[104:107], v[20:23], v[88:91], v[104:107]
    ds_read_b64_tr_b16 v[40:41], v14 offset:4096
    ds_read_b64_tr_b16 v[42:43], v14 offset:6144
    v_mfma_f32_16x16x32_bf16 v[120:123], v[20:23], v[92:95], v[120:123]
    ds_read_b64_tr_b16 v[44:45], v15 offset:4096
    ds_read_b64_tr_b16 v[46:47], v15 offset:6144
    v_mfma_f32_16x16x32_bf16 v[108:111], v[24:27], v[88:91], v[108:111]
    v_mfma_f32_16x16x32_bf16 v[124:127], v[24:27], v[92:95], v[124:127]
    v_mfma_f32_16x16x32_bf16 v[112:115], v[28:31], v[88:91], v[112:115]
    v_mfma_f32_16x16x32_bf16 v[128:131], v[28:31], v[92:95], v[128:131]
    s_waitcnt vmcnt(8) lgkmcnt(0)
    s_nop 0
    v_mfma_f32_16x16x32_bf16 v[100:103], v[32:35], v[132:135], v[100:103]
    ds_read_b64_tr_b16 v[16:17], v8 offset:49152
    ds_read_b64_tr_b16 v[18:19], v8 offset:51200
    v_mfma_f32_16x16x32_bf16 v[116:119], v[32:35], v[136:139], v[116:119]
    ds_read_b64_tr_b16 v[20:21], v9 offset:49152
    ds_read_b64_tr_b16 v[22:23], v9 offset:51200
    v_mfma_f32_16x16x32_bf16 v[104:107], v[36:39], v[132:135], v[104:107]
    ds_read_b64_tr_b16 v[24:25], v10 offset:49152
    ds_read_b64_tr_b16 v[26:27], v10 offset:51200
    v_mfma_f32_16x16x32_bf16 v[120:123], v[36:39], v[136:139], v[120:123]
    ds_read_b64_tr_b16 v[28:29], v11 offset:49152
    ds_read_b64_tr_b16 v[30:31], v11 offset:51200
    v_mfma_f32_16x16x32_bf16 v[108:111], v[40:43], v[132:135], v[108:111]
    v_mfma_f32_16x16x32_bf16 v[124:127], v[40:43], v[136:139], v[124:127]
    v_mfma_f32_16x16x32_bf16 v[112:115], v[44:47], v[132:135], v[112:115]
    v_mfma_f32_16x16x32_bf16 v[128:131], v[44:47], v[136:139], v[128:131]
    s_waitcnt vmcnt(6) lgkmcnt(0)
    s_nop 0
    v_mfma_f32_16x16x32_bf16 v[100:103], v[16:19], v[48:51], v[100:103]
    ds_read_b64_tr_b16 v[32:33], v8 offset:53248
    ds_read_b64_tr_b16 v[34:35], v8 offset:55296
    v_mfma_f32_16x16x32_bf16 v[116:119], v[16:19], v[52:55], v[116:119]
    ds_read_b64_tr_b16 v[36:37], v9 offset:53248
    ds_read_b64_tr_b16 v[38:39], v9 offset:55296
    v_mfma_f32_16x16x32_bf16 v[104:107], v[20:23], v[48:51], v[104:107]
    ds_read_b64_tr_b16 v[40:41], v10 offset:53248
    ds_read_b64_tr_b16 v[42:43], v10 offset:55296
    v_mfma_f32_16x16x32_bf16 v[120:123], v[20:23], v[52:55], v[120:123]
    ds_read_b64_tr_b16 v[44:45], v11 offset:53248
    ds_read_b64_tr_b16 v[46:47], v11 offset:55296
    v_mfma_f32_16x16x32_bf16 v[108:111], v[24:27], v[48:51], v[108:111]
    v_mfma_f32_16x16x32_bf16 v[124:127], v[24:27], v[52:55], v[124:127]
    v_mfma_f32_16x16x32_bf16 v[112:115], v[28:31], v[48:51], v[112:115]
    v_mfma_f32_16x16x32_bf16 v[128:131], v[28:31], v[52:55], v[128:131]
    s_waitcnt vmcnt(4) lgkmcnt(0)
    s_nop 0
    v_mfma_f32_16x16x32_bf16 v[100:103], v[32:35], v[56:59], v[100:103]
    ds_read_b64_tr_b16 v[16:17], v12 offset:8192
    ds_read_b64_tr_b16 v[18:19], v12 offset:10240
    v_mfma_f32_16x16x32_bf16 v[116:119], v[32:35], v[60:63], v[116:119]
    ds_read_b64_tr_b16 v[20:21], v13 offset:8192
    ds_read_b64_tr_b16 v[22:23], v13 offset:10240
    v_mfma_f32_16x16x32_bf16 v[104:107], v[36:39], v[56:59], v[104:107]
    ds_read_b64_tr_b16 v[24:25], v14 offset:8192
    ds_read_b64_tr_b16 v[26:27], v14 offset:10240
    v_mfma_f32_16x16x32_bf16 v[120:123], v[36:39], v[60:63], v[120:123]
    ds_read_b64_tr_b16 v[28:29], v15 offset:8192
    ds_read_b64_tr_b16 v[30:31], v15 offset:10240
    v_mfma_f32_16x16x32_bf16 v[108:111], v[40:43], v[56:59], v[108:111]
    v_mfma_f32_16x16x32_bf16 v[124:127], v[40:43], v[60:63], v[124:127]
    v_mfma_f32_16x16x32_bf16 v[112:115], v[44:47], v[56:59], v[112:115]
    v_mfma_f32_16x16x32_bf16 v[128:131], v[44:47], v[60:63], v[128:131]
    s_waitcnt vmcnt(2) lgkmcnt(0)
    s_nop 0
    v_mfma_f32_16x16x32_bf16 v[100:103], v[16:19], v[64:67], v[100:103]
    ds_read_b64_tr_b16 v[32:33], v12 offset:12288
    ds_read_b64_tr_b16 v[34:35], v12 offset:14336
    v_mfma_f32_16x16x32_bf16 v[116:119], v[16:19], v[68:71], v[116:119]
    ds_read_b64_tr_b16 v[36:37], v13 offset:12288
    ds_read_b64_tr_b16 v[38:39], v13 offset:14336
    v_mfma_f32_16x16x32_bf16 v[104:107], v[20:23], v[64:67], v[104:107]
    ds_read_b64_tr_b16 v[40:41], v14 offset:12288
    ds_read_b64_tr_b16 v[42:43], v14 offset:14336
    v_mfma_f32_16x16x32_bf16 v[120:123], v[20:23], v[68:71], v[120:123]
    ds_read_b64_tr_b16 v[44:45], v15 offset:12288
    ds_read_b64_tr_b16 v[46:47], v15 offset:14336
    v_mfma_f32_16x16x32_bf16 v[108:111], v[24:27], v[64:67], v[108:111]
    v_mfma_f32_16x16x32_bf16 v[124:127], v[24:27], v[68:71], v[124:127]
    v_mfma_f32_16x16x32_bf16 v[112:115], v[28:31], v[64:67], v[112:115]
    v_mfma_f32_16x16x32_bf16 v[128:131], v[28:31], v[68:71], v[128:131]
    s_waitcnt vmcnt(0) lgkmcnt(0)
    s_nop 0
    v_mfma_f32_16x16x32_bf16 v[100:103], v[32:35], v[72:75], v[100:103]
    v_mfma_f32_16x16x32_bf16 v[116:119], v[32:35], v[76:79], v[116:119]
    v_mfma_f32_16x16x32_bf16 v[104:107], v[36:39], v[72:75], v[104:107]
    v_mfma_f32_16x16x32_bf16 v[120:123], v[36:39], v[76:79], v[120:123]
    v_mfma_f32_16x16x32_bf16 v[108:111], v[40:43], v[72:75], v[108:111]
    v_mfma_f32_16x16x32_bf16 v[124:127], v[40:43], v[76:79], v[124:127]
    v_mfma_f32_16x16x32_bf16 v[112:115], v[44:47], v[72:75], v[112:115]
    v_mfma_f32_16x16x32_bf16 v[128:131], v[44:47], v[76:79], v[128:131]
    s_nop 2
    v_permlane16_swap_b32 v100, v104
    v_permlane16_swap_b32 v101, v105
    v_permlane16_swap_b32 v102, v106
    v_permlane16_swap_b32 v103, v107
    v_permlane16_swap_b32 v108, v112
    v_permlane16_swap_b32 v109, v113
    v_permlane16_swap_b32 v110, v114
    v_permlane16_swap_b32 v111, v115
    v_permlane16_swap_b32 v116, v120
    v_permlane16_swap_b32 v117, v121
    v_permlane16_swap_b32 v118, v122
    v_permlane16_swap_b32 v119, v123
    v_permlane16_swap_b32 v124, v128
    v_permlane16_swap_b32 v125, v129
    v_permlane16_swap_b32 v126, v130
    v_permlane16_swap_b32 v127, v131
    s_cmp_eq_u64 s[60:61], 0
    s_cbranch_scc1 F_fin
    s_mov_b32 s48, 0xbfb8aa3b
    v_and_b32 v7, 0x3f, v2
    v_lshlrev_b32 v7, 1, v7
    v_add_u32 v7, 159744, v7
    v_mov_b32 v6, 159136

    ds_read_b32 v5, v6 offset:0
FW_77:
    s_waitcnt lgkmcnt(0)
    v_cmp_gt_u32 vcc, 1, v5
    s_cbranch_vccz FO_78
    ds_read_b32 v5, v6 offset:0
    s_branch FW_77
FO_78:
    v_bfe_u32 v4, v164, 11, 3
    v_lshl_add_u32 v4, v4, 8, v7
    v_cmp_ne_u32 vcc, 0, v164
    s_nop 0
    s_and_saveexec_b64 s[50:51], vcc
    s_cbranch_execz F_rb_79
    ds_read_b128 v[16:19], v4 offset:0
    ds_read_b128 v[20:23], v4 offset:16
    ds_read_b128 v[24:27], v4 offset:128
    ds_read_b128 v[28:31], v4 offset:144
    v_and_b32 v5, 0xffff0000, v164
    v_ashrrev_i32 v6, 31, v5
    v_not_b32 v6, v6
    v_or_b32 v6, 0x80000000, v6
    v_xor_b32 v5, v5, v6
    v_and_b32 v5, 0xffff0000, v5
    v_mul_f32 v5, s48, v5
    v_exp_f32 v5, v5
    s_nop 0
    v_add_f32 v5, 1.0, v5
    v_rcp_f32 v5, v5
    s_nop 0
    v_cvt_pk_bf16_f32 v5, v5, v5
    v_lshlrev_b32 v5, 16, v5
    s_waitcnt lgkmcnt(0)
    v_fmac_f32 v100, v16, v5
    v_fmac_f32 v101, v17, v5
    v_fmac_f32 v102, v18, v5
    v_fmac_f32 v103, v19, v5
    v_fmac_f32 v104, v20, v5
    v_fmac_f32 v105, v21, v5
    v_fmac_f32 v106, v22, v5
    v_fmac_f32 v107, v23, v5
    v_fmac_f32 v108, v24, v5
    v_fmac_f32 v109, v25, v5
    v_fmac_f32 v110, v26, v5
    v_fmac_f32 v111, v27, v5
    v_fmac_f32 v112, v28, v5
    v_fmac_f32 v113, v29, v5
    v_fmac_f32 v114, v30, v5
    v_fmac_f32 v115, v31, v5
F_rb_79:
    s_mov_b64 exec, s[50:51]
    v_bfe_u32 v4, v165, 11, 3
    v_lshl_add_u32 v4, v4, 8, v7
    v_cmp_ne_u32 vcc, 0, v165
    s_nop 0
    s_and_saveexec_b64 s[50:51], vcc
    s_cbranch_execz F_rb_80
    ds_read_b128 v[16:19], v4 offset:0
    ds_read_b128 v[20:23], v4 offset:16
    ds_read_b128 v[24:27], v4 offset:128
    ds_read_b128 v[28:31], v4 offset:144
    v_and_b32 v5, 0xffff0000, v165
    v_ashrrev_i32 v6, 31, v5
    v_not_b32 v6, v6
    v_or_b32 v6, 0x80000000, v6
    v_xor_b32 v5, v5, v6
    v_and_b32 v5, 0xffff0000, v5
    v_mul_f32 v5, s48, v5
    v_exp_f32 v5, v5
    s_nop 0
    v_add_f32 v5, 1.0, v5
    v_rcp_f32 v5, v5
    s_nop 0
    v_cvt_pk_bf16_f32 v5, v5, v5
    v_lshlrev_b32 v5, 16, v5
    s_waitcnt lgkmcnt(0)
    v_fmac_f32 v116, v16, v5
    v_fmac_f32 v117, v17, v5
    v_fmac_f32 v118, v18, v5
    v_fmac_f32 v119, v19, v5
    v_fmac_f32 v120, v20, v5
    v_fmac_f32 v121, v21, v5
    v_fmac_f32 v122, v22, v5
    v_fmac_f32 v123, v23, v5
    v_fmac_f32 v124, v24, v5
    v_fmac_f32 v125, v25, v5
    v_fmac_f32 v126, v26, v5
    v_fmac_f32 v127, v27, v5
    v_fmac_f32 v128, v28, v5
    v_fmac_f32 v129, v29, v5
    v_fmac_f32 v130, v30, v5
    v_fmac_f32 v131, v31, v5
F_rb_80:
    s_mov_b64 exec, s[50:51]
F_fin:
    s_nop 0
    v_cvt_pk_bf16_f32 v48, v100, v101
    v_cvt_pk_bf16_f32 v49, v102, v103
    v_cvt_pk_bf16_f32 v50, v104, v105
    v_cvt_pk_bf16_f32 v51, v106, v107
    v_cvt_pk_bf16_f32 v52, v108, v109
    v_cvt_pk_bf16_f32 v53, v110, v111
    v_cvt_pk_bf16_f32 v54, v112, v113
    v_cvt_pk_bf16_f32 v55, v114, v115
    v_mov_b32 v64, v48
    v_mov_b32 v65, v49
    v_mov_b32 v66, v50
    v_mov_b32 v67, v51
    v_mov_b32_dpp v48, v52 row_ror:8 row_mask:0xf bank_mask:0xc
    v_mov_b32_dpp v49, v53 row_ror:8 row_mask:0xf bank_mask:0xc
    v_mov_b32_dpp v50, v54 row_ror:8 row_mask:0xf bank_mask:0xc
    v_mov_b32_dpp v51, v55 row_ror:8 row_mask:0xf bank_mask:0xc
    v_mov_b32_dpp v52, v64 row_ror:8 row_mask:0xf bank_mask:0x3
    v_mov_b32_dpp v53, v65 row_ror:8 row_mask:0xf bank_mask:0x3
    v_mov_b32_dpp v54, v66 row_ror:8 row_mask:0xf bank_mask:0x3
    v_mov_b32_dpp v55, v67 row_ror:8 row_mask:0xf bank_mask:0x3
    s_add_u32 s44, s42, 0x4000
    buffer_store_dwordx4 v[48:51], v1, s[12:15], s42 offen sc1
    buffer_store_dwordx4 v[52:55], v1, s[12:15], s44 offen sc1
    v_cvt_pk_bf16_f32 v56, v116, v117
    v_cvt_pk_bf16_f32 v57, v118, v119
    v_cvt_pk_bf16_f32 v58, v120, v121
    v_cvt_pk_bf16_f32 v59, v122, v123
    v_cvt_pk_bf16_f32 v60, v124, v125
    v_cvt_pk_bf16_f32 v61, v126, v127
    v_cvt_pk_bf16_f32 v62, v128, v129
    v_cvt_pk_bf16_f32 v63, v130, v131
    v_mov_b32 v64, v56
    v_mov_b32 v65, v57
    v_mov_b32 v66, v58
    v_mov_b32 v67, v59
    v_mov_b32_dpp v56, v60 row_ror:8 row_mask:0xf bank_mask:0xc
    v_mov_b32_dpp v57, v61 row_ror:8 row_mask:0xf bank_mask:0xc
    v_mov_b32_dpp v58, v62 row_ror:8 row_mask:0xf bank_mask:0xc
    v_mov_b32_dpp v59, v63 row_ror:8 row_mask:0xf bank_mask:0xc
    v_mov_b32_dpp v60, v64 row_ror:8 row_mask:0xf bank_mask:0x3
    v_mov_b32_dpp v61, v65 row_ror:8 row_mask:0xf bank_mask:0x3
    v_mov_b32_dpp v62, v66 row_ror:8 row_mask:0xf bank_mask:0x3
    v_mov_b32_dpp v63, v67 row_ror:8 row_mask:0xf bank_mask:0x3
    s_add_u32 s44, s43, 0x4000
    buffer_store_dwordx4 v[56:59], v1, s[12:15], s43 offen sc1
    buffer_store_dwordx4 v[60:63], v1, s[12:15], s44 offen sc1
    s_endpgm
F_aux:
    s_setprio 3
    s_sub_u32 s3, s3, 8
    s_mov_b32 s88, s3
    v_lshrrev_b32 v5, 4, v0
    s_cmp_eq_u32 s3, 1
    s_mov_b32 s45, 73728
    s_cselect_b32 s45, 65536, s45
    s_cmp_eq_u32 s3, 2
    s_cselect_b32 s45, 147456, s45
    v_bfe_u32 v60, v0, 2, 2
    v_lshl_add_u32 v62, v5, 3, v60
    v_lshrrev_b32 v60, 1, v60
    v_and_b32 v63, 1, v5
    v_lshl_add_u32 v60, v63, 1, v60
    v_lshlrev_b32 v60, 5, v60
    v_lshl_add_u32 v60, v62, 7, v60
    v_and_b32 v63, 3, v0
    v_lshl_add_u32 v60, v63, 3, v60
    v_add_u32 v62, s45, v60
    v_xor_b32 v63, 32, v62
    v_xor_b32 v64, 64, v62
    v_xor_b32 v65, 96, v62
    v_lshlrev_b32 v2, 4, v0
    v_lshlrev_b32 v3, 2, v0
    v_and_b32 v7, 15, v0
    v_and_b32 v8, 7, v0
    v_lshlrev_b32 v8, 4, v8
    v_lshl_add_u32 v8, v5, 7, v8
    v_bfe_u32 v9, v0, 3, 1
    v_lshl_add_u32 v4, v9, 11, v8
    v_and_b32 v9, 1, v0
    v_lshlrev_b32 v59, 2, v7
    s_lshl_b32 s76, s32, 4
    s_add_u32 s76, s76, s33
    s_lshl_b32 s77, s76, 3
    s_lshl_b32 s44, s3, 1
    s_add_u32 s77, s77, s44
    v_mov_b32 v12, 0
    v_mov_b32 v13, 0
    v_mov_b32 v14, 0
    v_mov_b32 v15, 0
    s_lshl_b32 s75, s3, 4
    s_add_u32 s75, s75, s33
    s_lshl_b32 s44, s3, 2
    s_add_u32 s44, s44, 159040
    v_mov_b32 v10, s44

    v_mov_b32 v32, 0x3f803f80
    v_mov_b32 v33, 0x3f803f80
    v_mov_b32 v34, 0x3f803f80
    v_mov_b32 v35, 0x3f803f80
    v_mov_b32 v36, 0x3f803f80
    v_mov_b32 v37, 0x3f803f80
    v_mov_b32 v38, 0x3f803f80
    v_mov_b32 v39, 0x3f803f80
    v_mov_b32 v40, 0x3f803f80
    v_mov_b32 v41, 0x3f803f80
    v_mov_b32 v42, 0x3f803f80
    v_mov_b32 v43, 0x3f803f80
    v_mov_b32 v44, 0x3f803f80
    v_mov_b32 v45, 0x3f803f80
    v_mov_b32 v46, 0x3f803f80
    v_mov_b32 v47, 0x3f803f80
    s_waitcnt lgkmcnt(0)
    s_mov_b32 s20, s4
    s_mov_b32 s21, s5
    s_mov_b32 s22, 0x400000
    s_mov_b32 s23, 0x00020000
    s_mov_b32 s19, 0x20000
    s_add_u32 s40, s72, 0x850000
    s_addc_u32 s41, s73, 0
    s_mov_b32 s42, 0xd000
    s_mov_b32 s43, 0x00020000
    s_cmp_lg_u32 s3, 0
    s_cbranch_scc1 F_z0
    s_getpc_b64 s[46:47]
F_pc:
    s_sub_u32 s46, s46, F_pc-parallel_sum__linear_attn_block__moe_arch_mod__prompt_kernel
    s_subb_u32 s47, s47, 0
    s_and_b32 s44, s31, 7
    s_lshl_b32 s44, s44, 13
    v_lshlrev_b32 v67, 7, v0
    v_add_u32 v67, s44, v67
    v_min_u32 v67, F_codeend-parallel_sum__linear_attn_block__moe_arch_mod__prompt_kernel-4, v67
    global_load_dword v61, v67, s[46:47]
    s_cmp_lg_u32 s75, 0
    s_cbranch_scc1 F_z0
    s_lshl_b32 s44, s32, 9
    s_add_u32 s44, s44, 32768
    s_mov_b32 exec_hi, 0
    buffer_store_dwordx4 v[12:15], v2, s[40:43], s44 offen sc0 sc1
    s_mul_i32 s44, s32, 768
    s_add_u32 s44, s44, 40960
    s_mov_b32 exec_hi, 0xffff
    buffer_store_dwordx4 v[12:15], v2, s[40:43], s44 offen sc0 sc1
    s_mov_b64 exec, -1
F_z0:

    s_barrier
    s_bitcmp0_b32 s3, 0
    s_cbranch_scc1 F_cs1
    ds_read_b64_tr_b16 v[72:73], v62 offset:0
    ds_read_b64_tr_b16 v[74:75], v62 offset:512
    ds_read_b64_tr_b16 v[76:77], v62 offset:4096
    ds_read_b64_tr_b16 v[78:79], v62 offset:4608
    ds_read_b64_tr_b16 v[80:81], v63 offset:0
    ds_read_b64_tr_b16 v[82:83], v63 offset:512
    ds_read_b64_tr_b16 v[84:85], v63 offset:4096
    ds_read_b64_tr_b16 v[86:87], v63 offset:4608
    s_waitcnt lgkmcnt(4)
    s_nop 0
    ds_read_b64_tr_b16 v[88:89], v64 offset:0
    ds_read_b64_tr_b16 v[90:91], v64 offset:512
    ds_read_b64_tr_b16 v[92:93], v64 offset:4096
    ds_read_b64_tr_b16 v[94:95], v64 offset:4608
    ds_read_b64_tr_b16 v[96:97], v65 offset:0
    ds_read_b64_tr_b16 v[98:99], v65 offset:512
    ds_read_b64_tr_b16 v[100:101], v65 offset:4096
    ds_read_b64_tr_b16 v[102:103], v65 offset:4608
    s_branch F_cs2
F_cs1:
    v_add_u32 v60, 159040, v3
    s_mov_b32 exec_hi, 0xffff
    ds_write_b32 v60, v12
    s_mov_b64 exec, -1
F_cs2:
    s_add_u32 s24, s72, 0x800000
    s_addc_u32 s25, s73, 0
    s_mov_b32 s26, 0x48000
    s_mov_b32 s27, 0x00020000
    s_mov_b32 s48, s70
    s_mov_b32 s49, s71
    s_mov_b32 s50, 0x100
    s_mov_b32 s51, 0x00020000
    s_lshl_b32 s47, s32, 9
    s_add_u32 s56, s47, 0x858000
    s_add_u32 s56, s72, s56
    s_addc_u32 s57, s73, 0
    s_lshl_b32 s47, s33, 9
    s_add_u32 s58, s47, 0x858100
    s_add_u32 s58, s72, s58
    s_addc_u32 s59, s73, 0
    v_mov_b32 v68, 0x3f803f80
    v_mov_b32 v69, 0x3f803f80
    v_mov_b32 v70, 0x3f803f80
    v_mov_b32 v71, 0x3f803f80
    s_waitcnt lgkmcnt(0)
    s_cmp_lg_u32 s75, 0
    s_cbranch_scc1 F_z4
    s_lshl_b32 s45, s32, 2
    s_add_u32 s44, s70, s45
    s_addc_u32 s45, s71, 0
    s_mov_b32 s46, 1
    s_waitcnt vmcnt(0)
    s_atomic_add s46, s[44:45], 0
F_z4:

    s_branch IW_s8
IW_w8:
    s_branch IW_r8
IW_s8:
    s_bitcmp0_b32 s3, 0
    s_cbranch_scc1 F_c2a
    s_nop 0
    v_mfma_f32_16x16x32_bf16 v[104:107], v[68:71], v[72:75], 0
    v_mfma_f32_16x16x32_bf16 v[108:111], v[68:71], v[80:83], 0
    v_mfma_f32_16x16x32_bf16 v[112:115], v[68:71], v[88:91], 0
    v_mfma_f32_16x16x32_bf16 v[116:119], v[68:71], v[96:99], 0
    v_mfma_f32_16x16x32_bf16 v[104:107], v[68:71], v[76:79], v[104:107]
    v_mfma_f32_16x16x32_bf16 v[108:111], v[68:71], v[84:87], v[108:111]
    v_mfma_f32_16x16x32_bf16 v[112:115], v[68:71], v[92:95], v[112:115]
    v_mfma_f32_16x16x32_bf16 v[116:119], v[68:71], v[100:103], v[116:119]
    v_cmp_eq_u32 vcc, 1, v5
    s_nop 4
    v_cndmask_b32 v66, v104, v108, vcc
    v_cmp_eq_u32 vcc, 2, v5
    s_nop 1
    v_cndmask_b32 v66, v66, v112, vcc
    v_cmp_eq_u32 vcc, 3, v5
    s_nop 1
    v_cndmask_b32 v66, v66, v116, vcc

F_c2a:
    s_barrier
    s_cmp_lg_u32 s3, 2
    s_cbranch_scc1 F_cs3
    ds_read_b64_tr_b16 v[72:73], v62 offset:0
    ds_read_b64_tr_b16 v[74:75], v62 offset:512
    ds_read_b64_tr_b16 v[76:77], v62 offset:4096
    ds_read_b64_tr_b16 v[78:79], v62 offset:4608
    ds_read_b64_tr_b16 v[80:81], v63 offset:0
    ds_read_b64_tr_b16 v[82:83], v63 offset:512
    ds_read_b64_tr_b16 v[84:85], v63 offset:4096
    ds_read_b64_tr_b16 v[86:87], v63 offset:4608
    s_waitcnt lgkmcnt(4)
    s_nop 0
    ds_read_b64_tr_b16 v[88:89], v64 offset:0
    ds_read_b64_tr_b16 v[90:91], v64 offset:512
    ds_read_b64_tr_b16 v[92:93], v64 offset:4096
    ds_read_b64_tr_b16 v[94:95], v64 offset:4608
    ds_read_b64_tr_b16 v[96:97], v65 offset:0
    ds_read_b64_tr_b16 v[98:99], v65 offset:512
    ds_read_b64_tr_b16 v[100:101], v65 offset:4096
    ds_read_b64_tr_b16 v[102:103], v65 offset:4608
    s_waitcnt lgkmcnt(0)
F_cs3:
    s_cmp_lt_u32 s3, 2
    s_mov_b32 s44, 81920
    s_cselect_b32 s44, 81920, s44
    s_lshl_b32 s45, s3, 12
    s_add_u32 s44, s44, s45
    v_add_u32_e64 v4, s44, v4
    v_add_u32 v8, 161792, v8
    ds_read_b128 v[16:19], v4 offset:0
    ds_read_b128 v[20:23], v4 offset:512
    ds_read_b128 v[24:27], v4 offset:1024
    ds_read_b128 v[28:31], v4 offset:1536
    s_mov_b32 exec_lo, 0x00ff00ff
    s_mov_b32 exec_hi, 0x00ff00ff
    ds_read_b128 v[32:35], v8 offset:0
    ds_read_b128 v[36:39], v8 offset:512
    ds_read_b128 v[40:43], v8 offset:1024
    ds_read_b128 v[44:47], v8 offset:1536
    s_mov_b64 exec, -1
    s_waitcnt lgkmcnt(0)
    v_mfma_f32_16x16x32_bf16 v[120:123], v[16:19], v[16:19], 0
    v_mfma_f32_16x16x32_bf16 v[124:127], v[16:19], v[32:35], 0
    v_mfma_f32_16x16x32_bf16 v[128:131], v[32:35], v[32:35], 0
    v_mfma_f32_16x16x32_bf16 v[120:123], v[20:23], v[20:23], v[120:123]
    v_mfma_f32_16x16x32_bf16 v[124:127], v[20:23], v[36:39], v[124:127]
    v_mfma_f32_16x16x32_bf16 v[128:131], v[36:39], v[36:39], v[128:131]
    v_mfma_f32_16x16x32_bf16 v[120:123], v[24:27], v[24:27], v[120:123]
    v_mfma_f32_16x16x32_bf16 v[124:127], v[24:27], v[40:43], v[124:127]
    v_mfma_f32_16x16x32_bf16 v[128:131], v[40:43], v[40:43], v[128:131]
    v_mfma_f32_16x16x32_bf16 v[120:123], v[28:31], v[28:31], v[120:123]
    v_mfma_f32_16x16x32_bf16 v[124:127], v[28:31], v[44:47], v[124:127]
    v_mfma_f32_16x16x32_bf16 v[128:131], v[44:47], v[44:47], v[128:131]
    s_cmp_lg_u32 s3, 0
    s_cbranch_scc1 EV_82
    s_branch IW_w8
IW_r8:
EV_82:
    s_cmp_lg_u32 s3, 1
    s_cbranch_scc1 EV_83
    s_branch IW_w0
IW_r0:
EV_83:
    s_cmp_lg_u32 s3, 2
    s_cbranch_scc1 EV_84
    s_branch IW_w1
IW_r1:
EV_84:
    s_cmp_lg_u32 s3, 3
    s_cbranch_scc1 EV_85
    s_branch IW_w3
IW_r3:
EV_85:
    s_barrier
    s_cmp_lg_u32 s3, 2
    s_cbranch_scc1 F_c2b
    s_nop 0
    v_mfma_f32_16x16x32_bf16 v[104:107], v[68:71], v[72:75], 0
    v_mfma_f32_16x16x32_bf16 v[108:111], v[68:71], v[80:83], 0
    v_mfma_f32_16x16x32_bf16 v[112:115], v[68:71], v[88:91], 0
    v_mfma_f32_16x16x32_bf16 v[116:119], v[68:71], v[96:99], 0
    v_mfma_f32_16x16x32_bf16 v[104:107], v[68:71], v[76:79], v[104:107]
    v_mfma_f32_16x16x32_bf16 v[108:111], v[68:71], v[84:87], v[108:111]
    v_mfma_f32_16x16x32_bf16 v[112:115], v[68:71], v[92:95], v[112:115]
    v_mfma_f32_16x16x32_bf16 v[116:119], v[68:71], v[100:103], v[116:119]
    v_cmp_eq_u32 vcc, 1, v5
    s_nop 4
    v_cndmask_b32 v66, v104, v108, vcc
    v_cmp_eq_u32 vcc, 2, v5
    s_nop 1
    v_cndmask_b32 v66, v66, v112, vcc
    v_cmp_eq_u32 vcc, 3, v5
    s_nop 1
    v_cndmask_b32 v66, v66, v116, vcc

F_c2b:
    v_and_b32 v52, 3, v0
    v_cmp_eq_u32 vcc, 1, v52
    s_nop 1
    v_cndmask_b32 v120, v120, v121, vcc
    v_cndmask_b32 v124, v124, v125, vcc
    v_cndmask_b32 v128, v128, v129, vcc
    v_cmp_eq_u32 vcc, 2, v52
    s_nop 1
    v_cndmask_b32 v120, v120, v122, vcc
    v_cndmask_b32 v124, v124, v126, vcc
    v_cndmask_b32 v128, v128, v130, vcc
    v_cmp_eq_u32 vcc, 3, v52
    s_nop 1
    v_cndmask_b32 v120, v120, v123, vcc
    v_cndmask_b32 v124, v124, v127, vcc
    v_cndmask_b32 v128, v128, v131, vcc
    s_nop 0
    v_add_f32_dpp v120, v120, v120 quad_perm:[1,0,3,2] row_mask:0xf bank_mask:0xf
    v_add_f32_dpp v124, v124, v124 quad_perm:[1,0,3,2] row_mask:0xf bank_mask:0xf
    v_add_f32_dpp v128, v128, v128 quad_perm:[1,0,3,2] row_mask:0xf bank_mask:0xf
    v_add_f32_dpp v120, v120, v120 quad_perm:[2,3,0,1] row_mask:0xf bank_mask:0xf
    v_add_f32_dpp v124, v124, v124 quad_perm:[2,3,0,1] row_mask:0xf bank_mask:0xf
    v_add_f32_dpp v128, v128, v128 quad_perm:[2,3,0,1] row_mask:0xf bank_mask:0xf
    v_readlane_b32 s44, v124, 8
    v_readlane_b32 s45, v124, 24
    v_readlane_b32 s46, v124, 40
    v_readlane_b32 s47, v124, 56
    v_mov_b32 v48, s44
    v_mov_b32 v52, s45
    s_nop 0
    v_writelane_b32 v48, s46, 1
    v_writelane_b32 v52, s47, 1
    v_readlane_b32 s44, v120, 0
    v_readlane_b32 s45, v120, 20
    v_readlane_b32 s46, v120, 40
    v_readlane_b32 s47, v120, 60
    v_mov_b32 v49, s44
    v_mov_b32 v53, s45
    s_nop 0
    v_writelane_b32 v49, s46, 1
    v_writelane_b32 v53, s47, 1
    v_readlane_b32 s44, v124, 0
    v_readlane_b32 s45, v124, 20
    v_readlane_b32 s46, v124, 32
    v_readlane_b32 s47, v124, 52
    v_mov_b32 v50, s44
    v_mov_b32 v54, s45
    s_nop 0
    v_writelane_b32 v50, s46, 1
    v_writelane_b32 v54, s47, 1
    v_readlane_b32 s44, v128, 8
    v_readlane_b32 s45, v128, 24
    v_readlane_b32 s46, v128, 8
    v_readlane_b32 s47, v128, 24
    v_mov_b32 v51, s44
    v_mov_b32 v55, s45
    s_nop 0
    v_writelane_b32 v51, s46, 1
    v_writelane_b32 v55, s47, 1
    s_cmp_lg_u32 s3, 0
    s_cbranch_scc1 F_r1
    buffer_load_dword v11, v59, s[48:51], 0 offen sc0 sc1
F_r1:
    s_cmp_lg_u32 s3, 0
    s_cbranch_scc1 EV_87
    s_branch IW_w4
IW_r4:
EV_87:
    s_cmp_lg_u32 s3, 1
    s_cbranch_scc1 EV_88
    s_branch IW_w9
IW_r9:
EV_88:
    s_cmp_lg_u32 s3, 2
    s_cbranch_scc1 EV_89
    s_branch IW_w10
IW_r10:
EV_89:
    s_cmp_lg_u32 s3, 3
    s_cbranch_scc1 EV_90
    s_nop 0
EV_90:
    s_barrier
    v_add_f32 v48, v48, v52
    v_add_f32 v49, v49, v53
    v_add_f32 v50, v50, v54
    v_add_f32 v51, v51, v55
    v_mul_f32 v48, 0x3a800000, v48
    v_mul_f32 v49, 0x3a800000, v49
    v_fma_f32 v49, -v48, v48, v49
    v_max_f32 v49, 0, v49
    v_cvt_pk_bf16_f32 v52, v48, v49
    v_lshlrev_b32 v48, 16, v52
    v_and_b32 v49, 0xffff0000, v52
    v_add_f32 v49, 0x3727c5ac, v49
    v_cvt_pk_bf16_f32 v49, v49, v49
    v_lshlrev_b32 v49, 16, v49
    v_sqrt_f32 v49, v49
    s_nop 0
    v_cvt_pk_bf16_f32 v49, v49, v49
    v_lshlrev_b32 v49, 16, v49
    v_rcp_f32 v49, v49
    v_xor_b32 v48, 0x80000000, v48
    v_fma_f32 v50, v48, v51, v50
    v_mul_f32 v50, v50, v49
    v_cvt_pk_bf16_f32 v50, v50, v50
    v_and_b32 v50, 0xffff0000, v50
    v_ashrrev_i32 v51, 31, v50
    v_or_b32 v51, 0x80000000, v51
    v_xor_b32 v50, v50, v51
    v_and_b32 v50, 0xffff0000, v50
    s_sub_u32 s44, 2047, s77
    v_sub_u32 v51, s44, v9
    v_or_b32 v50, v50, v51
    s_lshl_b32 s44, s3, 1
    v_add_u32 v52, s44, v9
    v_lshlrev_b32 v53, 3, v52
    v_lshlrev_b32 v52, 2, v52
    v_add_u32 v53, 159744, v53
    v_add_u32 v52, 159808, v52
    s_mov_b64 exec, 3
    ds_write_b64 v53, v[48:49]
    ds_write_b32 v52, v50
    s_mov_b64 exec, -1
    s_waitcnt lgkmcnt(0)

    s_cmp_lg_u32 s3, 0
    s_cbranch_scc1 F_a0r
    s_waitcnt vmcnt(0)
    v_cmp_eq_u32 vcc, 0, v11
    s_cbranch_vccz F_a0r
F_a0p:
    s_sleep 8
    s_load_dwordx8 s[80:87], s[70:71], 0 glc
    s_waitcnt lgkmcnt(0)
    s_and_b64 s[44:45], s[80:81], s[82:83]
    s_and_b64 s[44:45], s[44:45], s[84:85]
    s_and_b64 s[44:45], s[44:45], s[86:87]
    s_load_dwordx8 s[80:87], s[70:71], 32 glc
    s_waitcnt lgkmcnt(0)
    s_and_b64 s[44:45], s[44:45], s[80:81]
    s_and_b64 s[44:45], s[44:45], s[82:83]
    s_and_b64 s[44:45], s[44:45], s[84:85]
    s_and_b64 s[44:45], s[44:45], s[86:87]
    s_and_b32 s44, s44, s45
    s_cbranch_scc0 F_a0p
F_a0r:
    s_barrier
    s_cmp_eq_u32 s3, 0
    s_cbranch_scc1 F_ax0
    s_mul_i32 s44, s33, 768
    s_add_u32 s44, s44, 40960
    s_add_u32 s45, s3, 1
    s_lshr_b32 s45, s45, 1
    s_cmp_eq_u32 s3, 2
    s_cselect_b32 s45, 0, s45
    s_lshl_b32 s45, s45, 8
    s_add_u32 s44, s44, s45
    buffer_atomic_add_f32 v66, v3, s[40:43], s44 offen
    s_mul_i32 s44, s2, 1152
    s_mul_i32 s45, s3, 384
    s_add_u32 s44, s44, s45
    s_sub_u32 s44, s44, 384
    s_mov_b64 exec, 0xffffff
    buffer_store_dwordx4 v[12:15], v2, s[24:27], s44 offen sc0 sc1
    s_mov_b64 exec, -1
    s_branch F_s1
F_ax0:
    v_add_u32 v60, 159744, v3
    ds_read_b32 v60, v60
    s_lshl_b32 s44, s76, 7
    s_mov_b32 exec_hi, 0
    s_waitcnt lgkmcnt(0)
    buffer_store_dword v60, v3, s[40:43], s44 offen sc0 sc1
    s_mov_b64 exec, -1
F_s1:

    s_barrier
    v_mov_b32 v4, 159144
    v_mov_b32 v8, 1
    s_lshr_b32 s47, s32, 2
    s_lshl_b32 s47, s47, 11
    s_add_u32 s54, s47, 0x858180
    s_add_u32 s54, s72, s54
    s_addc_u32 s55, s73, 0
    s_waitcnt vmcnt(0)
    s_mov_b64 exec, 1
    ds_add_rtn_u32 v9, v4, v8
    s_waitcnt lgkmcnt(0)
    v_readfirstlane_b32 s44, v9
    s_mov_b64 exec, -1
    s_cmp_lg_u32 s44, 3
    s_cbranch_scc1 F_a0s
    s_mov_b32 s74, 1
    s_atomic_add s74, s[54:55], 0
    s_atomic_add s74, s[56:57], 0
    s_atomic_add s74, s[58:59], 0
F_a0s:

    s_barrier
    s_and_b32 s89, s2, 0xdd
    s_bfe_u32 s44, s2, 0x10005
    s_lshl_b32 s44, s44, 1
    s_or_b32 s89, s89, s44
    s_bfe_u32 s44, s2, 0x10001
    s_xor_b32 s44, s44, 1
    s_lshl_b32 s44, s44, 5
    s_or_b32 s89, s89, s44
    s_and_b32 s36, s89, 3
    s_bfe_u32 s37, s89, 0x10002
    s_lshr_b32 s38, s89, 3
    s_cmp_eq_u32 s37, 0
    s_cselect_b32 s16, s62, s64
    s_cselect_b32 s17, s63, s65
    s_cmp_lt_u32 s89, 224
    s_cselect_b32 s18, 7340032, 0
    v_mul_u32_u24 v6, 57344, v5
    v_lshl_add_u32 v6, v7, 4, v6
    s_lshl_b32 s44, s36, 2
    s_add_u32 s44, s44, s3
    s_waitcnt lgkmcnt(0)
    s_mul_i32 s54, s44, 458752
    s_lshl_b32 s45, s38, 8
    s_add_u32 s54, s54, s45
    s_lshl_b32 s55, s44, 7

    s_add_u32 s39, s35, 2
    s_and_b32 s39, s39, 7
    s_lshl_b32 s10, s34, 3
    s_add_u32 s10, s10, s30

    s_mul_i32 s10, s10, 112
    s_mul_i32 s79, s3, 28
    s_add_u32 s10, s10, s79
    s_lshl_b32 s78, s10, 11
    s_lshl_b32 s79, s39, 8
    s_add_u32 s78, s78, s79
    v_mul_u32_u24 v160, 14336, v5
    v_lshl_add_u32 v160, v7, 4, v160

    s_mov_b32 s80, s66
    s_mov_b32 s81, s67
    s_mov_b32 s82, 0x700000
    s_mov_b32 s83, 0x00020000
    s_mul_i32 s53, s2, 37
    s_and_b32 s53, s53, 255
    s_mul_i32 s53, s53, 4
    s_lshr_b32 s53, s53, 8
    s_branch F_swx
F_sw0:
    s_add_u32 s91, s54, 0
    buffer_load_dwordx4 v[72:75], v6, s[16:19], s91 offen nt
    s_add_u32 s91, s54, 7168
    buffer_load_dwordx4 v[76:79], v6, s[16:19], s91 offen nt
    s_add_u32 s91, s54, 14336
    buffer_load_dwordx4 v[80:83], v6, s[16:19], s91 offen nt
    s_add_u32 s91, s54, 21504
    buffer_load_dwordx4 v[84:87], v6, s[16:19], s91 offen nt
    s_add_u32 s91, s54, 28672
    buffer_load_dwordx4 v[88:91], v6, s[16:19], s91 offen nt
    s_add_u32 s91, s54, 35840
    buffer_load_dwordx4 v[92:95], v6, s[16:19], s91 offen nt
    s_add_u32 s91, s54, 43008
    buffer_load_dwordx4 v[96:99], v6, s[16:19], s91 offen nt
    s_add_u32 s91, s54, 50176
    buffer_load_dwordx4 v[100:103], v6, s[16:19], s91 offen nt
    s_setpc_b64 s[34:35]
F_swx:
    s_cmp_eq_u32 s3, 2
    s_cbranch_scc1 F_ax2
    s_cmp_eq_u32 s3, 1
    s_cbranch_scc1 F_ax1
    s_cmp_eq_u32 s3, 0
    s_cbranch_scc1 F_ax0b
    s_barrier
    s_cmp_lg_u32 s53, 0
    s_cbranch_scc1 SW_91
    s_call_b64 s[34:35], F_sw0
SW_91:
    s_branch IW_w5
IW_r5:
    s_barrier
    s_cmp_lg_u32 s53, 1
    s_cbranch_scc1 SW_92
    s_call_b64 s[34:35], F_sw0
SW_92:
    s_branch IW_w7
IW_r7:
    s_barrier
    s_cmp_lg_u32 s53, 2
    s_cbranch_scc1 SW_93
    s_call_b64 s[34:35], F_sw0
SW_93:
    s_nop 0
    s_barrier
    s_cmp_lg_u32 s53, 3
    s_cbranch_scc1 SW_94
    s_call_b64 s[34:35], F_sw0
SW_94:
    s_nop 0
    s_barrier
    s_nop 0
    s_barrier
    s_nop 0
    s_barrier
    s_add_u32 s91, s54, 229376
    buffer_load_dwordx4 v[104:107], v6, s[16:19], s91 offen nt
    s_add_u32 s91, s54, 236544
    buffer_load_dwordx4 v[108:111], v6, s[16:19], s91 offen nt
    s_add_u32 s91, s54, 243712
    buffer_load_dwordx4 v[112:115], v6, s[16:19], s91 offen nt
    s_add_u32 s91, s54, 250880
    buffer_load_dwordx4 v[116:119], v6, s[16:19], s91 offen nt
    s_nop 0
    s_load_dword s76, s[56:57], 0 glc
    s_barrier
    s_add_u32 s91, s54, 258048
    buffer_load_dwordx4 v[120:123], v6, s[16:19], s91 offen nt
    s_add_u32 s91, s54, 265216
    buffer_load_dwordx4 v[124:127], v6, s[16:19], s91 offen nt
    s_add_u32 s91, s54, 272384
    buffer_load_dwordx4 v[128:131], v6, s[16:19], s91 offen nt
    s_add_u32 s91, s54, 279552
    buffer_load_dwordx4 v[132:135], v6, s[16:19], s91 offen nt
    s_waitcnt lgkmcnt(0)
    s_cmp_lt_u32 s76, 1000
    s_cbranch_scc1 F_g3
    v_mov_b32 v4, 1
    s_mov_b64 exec, 1
    ds_write_b32 v10, v4 offset:48
    s_mov_b64 exec, -1
    s_mov_b32 s88, 0
F_g3:
    s_barrier
    s_branch F_aj
F_ax1:
    s_barrier
    s_cmp_lg_u32 s53, 0
    s_cbranch_scc1 SW_95
    s_call_b64 s[34:35], F_sw0
SW_95:
    s_branch IW_w6
IW_r6:
    s_barrier
    s_cmp_lg_u32 s53, 1
    s_cbranch_scc1 SW_96
    s_call_b64 s[34:35], F_sw0
SW_96:
    s_nop 0
    s_barrier
    s_cmp_lg_u32 s53, 2
    s_cbranch_scc1 SW_97
    s_call_b64 s[34:35], F_sw0
SW_97:
    s_nop 0
    s_mul_i32 s44, s33, 768
    s_add_u32 s44, s44, 40960
    s_barrier
    s_cmp_lg_u32 s53, 3
    s_cbranch_scc1 SW_98
    s_call_b64 s[34:35], F_sw0
SW_98:
    s_load_dword s76, s[58:59], 0 glc
    s_barrier
    s_waitcnt lgkmcnt(0)
    s_cmp_ge_u32 s76, 16
    s_cbranch_scc1 GC_99
SP_100:
    s_load_dword s76, s[58:59], 0 glc
    s_waitcnt lgkmcnt(0)
    s_cmp_ge_u32 s76, 16
    s_cbranch_scc1 SD_101
    s_sleep 3
    s_branch SP_100
SD_101:
GC_99:
    s_barrier
    s_sleep 4
    s_mov_b32 m0, 158208
    s_mov_b32 exec_hi, 0xffff
    buffer_load_dwordx4 v2, s[40:43], s44 offen sc0 sc1 lds
    s_mov_b64 exec, -1
    s_barrier
    s_add_u32 s91, s54, 229376
    buffer_load_dwordx4 v[104:107], v6, s[16:19], s91 offen nt
    s_add_u32 s91, s54, 236544
    buffer_load_dwordx4 v[108:111], v6, s[16:19], s91 offen nt
    s_add_u32 s91, s54, 243712
    buffer_load_dwordx4 v[112:115], v6, s[16:19], s91 offen nt
    s_add_u32 s91, s54, 250880
    buffer_load_dwordx4 v[116:119], v6, s[16:19], s91 offen nt
    s_barrier
    s_nop 0
    s_add_u32 s91, s54, 258048
    buffer_load_dwordx4 v[120:123], v6, s[16:19], s91 offen nt
    s_add_u32 s91, s54, 265216
    buffer_load_dwordx4 v[124:127], v6, s[16:19], s91 offen nt
    s_add_u32 s91, s54, 272384
    buffer_load_dwordx4 v[128:131], v6, s[16:19], s91 offen nt
    s_add_u32 s91, s54, 279552
    buffer_load_dwordx4 v[132:135], v6, s[16:19], s91 offen nt
    s_waitcnt vmcnt(8)
    v_mov_b32 v4, 1
    s_mov_b64 exec, 1
    ds_write_b32 v10, v4 offset:48
    s_mov_b64 exec, -1
    s_barrier
    s_branch F_aj
IW_w9:
    s_branch IW_r9
F_ax0b:
    s_barrier
    s_cmp_lg_u32 s53, 0
    s_cbranch_scc1 SW_102
    s_call_b64 s[34:35], F_sw0
SW_102:
    s_branch IW_w2
IW_r2:
    s_barrier
    s_cmp_lg_u32 s53, 1
    s_cbranch_scc1 SW_103
    s_call_b64 s[34:35], F_sw0
SW_103:
    s_nop 0
    s_barrier
    s_cmp_lg_u32 s53, 2
    s_cbranch_scc1 SW_104
    s_call_b64 s[34:35], F_sw0
SW_104:
    s_nop 0
    s_lshl_b32 s47, s28, 9
    s_add_u32 s58, s47, 0x858000
    s_add_u32 s58, s72, s58
    s_addc_u32 s59, s73, 0
    s_lshl_b32 s44, s32, 11
    s_lshl_b32 s45, s28, 11
    v_lshrrev_b32 v11, 2, v0
    v_and_b32 v9, 3, v0
    v_lshlrev_b32 v9, 4, v9
    v_lshl_add_u32 v11, v11, 7, v9

    s_barrier
    s_cmp_lg_u32 s53, 3
    s_cbranch_scc1 SW_105
    s_call_b64 s[34:35], F_sw0
SW_105:
    s_load_dword s76, s[56:57], 0 glc
    s_load_dword s77, s[58:59], 0 glc
    s_barrier
    s_waitcnt lgkmcnt(0)
    s_cmp_ge_u32 s76, 16
    s_cbranch_scc1 GC_106
SP_107:
    s_load_dword s76, s[56:57], 0 glc
    s_waitcnt lgkmcnt(0)
    s_cmp_ge_u32 s76, 16
    s_cbranch_scc1 SD_108
    s_sleep 3
    s_branch SP_107
SD_108:
GC_106:
    s_cmp_ge_u32 s77, 16
    s_cbranch_scc1 GC_109
SP_110:
    s_load_dword s77, s[58:59], 0 glc
    s_waitcnt lgkmcnt(0)
    s_cmp_ge_u32 s77, 16
    s_cbranch_scc1 SD_111
    s_sleep 3
    s_branch SP_110
SD_111:
GC_109:
    s_barrier
    s_sleep 4
    buffer_load_dwordx4 v[32:35], v11, s[40:43], s44 offen sc0 sc1
    buffer_load_dwordx4 v[36:39], v11, s[40:43], s45 offen sc0 sc1
    v_lshlrev_b32 v9, 3, v0
    v_add_u32 v9, 155648, v9
    s_mov_b32 s44, 0x3fb8aa3b

    s_barrier
    s_add_u32 s91, s54, 229376
    buffer_load_dwordx4 v[104:107], v6, s[16:19], s91 offen nt
    s_add_u32 s91, s54, 236544
    buffer_load_dwordx4 v[108:111], v6, s[16:19], s91 offen nt
    s_add_u32 s91, s54, 243712
    buffer_load_dwordx4 v[112:115], v6, s[16:19], s91 offen nt
    s_add_u32 s91, s54, 250880
    buffer_load_dwordx4 v[116:119], v6, s[16:19], s91 offen nt
    s_barrier
    s_nop 0
    s_add_u32 s91, s54, 258048
    buffer_load_dwordx4 v[120:123], v6, s[16:19], s91 offen nt
    s_add_u32 s91, s54, 265216
    buffer_load_dwordx4 v[124:127], v6, s[16:19], s91 offen nt
    s_add_u32 s91, s54, 272384
    buffer_load_dwordx4 v[128:131], v6, s[16:19], s91 offen nt
    s_add_u32 s91, s54, 279552
    buffer_load_dwordx4 v[132:135], v6, s[16:19], s91 offen nt
    s_waitcnt vmcnt(8)
    v_swap_b32 v33, v34
    v_swap_b32 v37, v38
    v_mul_f32 v40, s44, v34
    v_mul_f32 v41, s44, v35
    ds_write_b64 v9, v[32:33]
    ds_write_b64 v9, v[40:41] offset:1024
    ds_write_b64 v9, v[36:37] offset:1536
    ds_write_b64 v9, v[38:39] offset:2048

    v_mov_b32 v4, 1
    s_mov_b64 exec, 1
    ds_write_b32 v10, v4 offset:48
    s_mov_b64 exec, -1
    s_barrier
    s_branch F_aj
F_ax2:
    s_cmp_lg_u32 s2, 248
    s_cbranch_scc1 F_a2n
    s_waitcnt lgkmcnt(0)
    s_mov_b32 s74, 7
    v_lshrrev_b32 v11, 1, v0
    v_and_b32 v9, 1, v0
    v_lshlrev_b32 v9, 4, v9
    v_lshl_add_u32 v11, v11, 7, v9
    v_lshlrev_b32 v9, 9, v0
    v_mov_b32 v8, 1000
F_a2l:

    s_load_dword s60, s[40:41], 0x8180 glc
    s_load_dword s61, s[40:41], 0x8980 glc
    s_load_dword s62, s[40:41], 0x9180 glc
    s_load_dword s63, s[40:41], 0x9980 glc
    s_waitcnt lgkmcnt(0)
    s_add_u32 s60, s60, s61
    s_add_u32 s62, s62, s63
    s_add_u32 s60, s60, s62
    s_cmp_ge_u32 s60, 256
    s_cbranch_scc1 F_a2t

    s_cmp_ge_u32 s74, 17
    s_cbranch_scc1 DB_112
    s_barrier
    s_add_u32 s74, s74, 1
DB_112:
    s_branch F_a2l
F_a2t:
    s_movk_i32 s44, 0
    buffer_load_dwordx4 v[16:19], v11, s[40:43], s44 offen offset:64 sc0 sc1
    s_movk_i32 s44, 4096
    buffer_load_dwordx4 v[20:23], v11, s[40:43], s44 offen offset:64 sc0 sc1
    s_movk_i32 s44, 8192
    buffer_load_dwordx4 v[24:27], v11, s[40:43], s44 offen offset:64 sc0 sc1
    s_movk_i32 s44, 12288
    buffer_load_dwordx4 v[28:31], v11, s[40:43], s44 offen offset:64 sc0 sc1
    s_movk_i32 s44, 16384
    buffer_load_dwordx4 v[32:35], v11, s[40:43], s44 offen offset:64 sc0 sc1
    s_movk_i32 s44, 20480
    buffer_load_dwordx4 v[36:39], v11, s[40:43], s44 offen offset:64 sc0 sc1
    s_movk_i32 s44, 24576
    buffer_load_dwordx4 v[40:43], v11, s[40:43], s44 offen offset:64 sc0 sc1
    s_movk_i32 s44, 28672
    buffer_load_dwordx4 v[44:47], v11, s[40:43], s44 offen offset:64 sc0 sc1
    s_mov_b32 s44, 32768
    s_mov_b64 exec, 0xffff
    buffer_atomic_add v8, v9, s[40:43], s44 offen
    s_mov_b64 exec, -1

    s_cmp_ge_u32 s74, 17
    s_cbranch_scc1 DB_113
    s_barrier
    s_add_u32 s74, s74, 1
DB_113:
    s_waitcnt vmcnt(1)
    v_max3_u32 v48, v16, v17, v18
    v_med3_u32 v49, v16, v17, v18
    v_min3_u32 v50, v16, v17, v18
    v_med3_u32 v50, v49, v50, v19
    v_med3_u32 v49, v48, v49, v19
    v_max_u32 v48, v48, v19
    v_med3_u32 v50, v49, v50, v20
    v_med3_u32 v49, v48, v49, v20
    v_max_u32 v48, v48, v20
    v_med3_u32 v50, v49, v50, v21
    v_med3_u32 v49, v48, v49, v21
    v_max_u32 v48, v48, v21
    v_med3_u32 v50, v49, v50, v22
    v_med3_u32 v49, v48, v49, v22
    v_max_u32 v48, v48, v22
    v_med3_u32 v50, v49, v50, v23
    v_med3_u32 v49, v48, v49, v23
    v_max_u32 v48, v48, v23
    v_med3_u32 v50, v49, v50, v24
    v_med3_u32 v49, v48, v49, v24
    v_max_u32 v48, v48, v24
    v_med3_u32 v50, v49, v50, v25
    v_med3_u32 v49, v48, v49, v25
    v_max_u32 v48, v48, v25
    v_med3_u32 v50, v49, v50, v26
    v_med3_u32 v49, v48, v49, v26
    v_max_u32 v48, v48, v26
    v_med3_u32 v50, v49, v50, v27
    v_med3_u32 v49, v48, v49, v27
    v_max_u32 v48, v48, v27
    v_med3_u32 v50, v49, v50, v28
    v_med3_u32 v49, v48, v49, v28
    v_max_u32 v48, v48, v28
    v_med3_u32 v50, v49, v50, v29
    v_med3_u32 v49, v48, v49, v29
    v_max_u32 v48, v48, v29
    v_med3_u32 v50, v49, v50, v30
    v_med3_u32 v49, v48, v49, v30
    v_max_u32 v48, v48, v30
    v_med3_u32 v50, v49, v50, v31
    v_med3_u32 v49, v48, v49, v31
    v_max_u32 v48, v48, v31
    v_med3_u32 v50, v49, v50, v32
    v_med3_u32 v49, v48, v49, v32
    v_max_u32 v48, v48, v32
    v_med3_u32 v50, v49, v50, v33
    v_med3_u32 v49, v48, v49, v33
    v_max_u32 v48, v48, v33
    v_med3_u32 v50, v49, v50, v34
    v_med3_u32 v49, v48, v49, v34
    v_max_u32 v48, v48, v34
    v_med3_u32 v50, v49, v50, v35
    v_med3_u32 v49, v48, v49, v35
    v_max_u32 v48, v48, v35
    v_med3_u32 v50, v49, v50, v36
    v_med3_u32 v49, v48, v49, v36
    v_max_u32 v48, v48, v36
    v_med3_u32 v50, v49, v50, v37
    v_med3_u32 v49, v48, v49, v37
    v_max_u32 v48, v48, v37
    v_med3_u32 v50, v49, v50, v38
    v_med3_u32 v49, v48, v49, v38
    v_max_u32 v48, v48, v38
    v_med3_u32 v50, v49, v50, v39
    v_med3_u32 v49, v48, v49, v39
    v_max_u32 v48, v48, v39
    v_med3_u32 v50, v49, v50, v40
    v_med3_u32 v49, v48, v49, v40
    v_max_u32 v48, v48, v40
    v_med3_u32 v50, v49, v50, v41
    v_med3_u32 v49, v48, v49, v41
    v_max_u32 v48, v48, v41
    v_med3_u32 v50, v49, v50, v42
    v_med3_u32 v49, v48, v49, v42
    v_max_u32 v48, v48, v42
    v_med3_u32 v50, v49, v50, v43
    v_med3_u32 v49, v48, v49, v43
    v_max_u32 v48, v48, v43
    v_med3_u32 v50, v49, v50, v44
    v_med3_u32 v49, v48, v49, v44
    v_max_u32 v48, v48, v44
    v_med3_u32 v50, v49, v50, v45
    v_med3_u32 v49, v48, v49, v45
    v_max_u32 v48, v48, v45
    v_med3_u32 v50, v49, v50, v46
    v_med3_u32 v49, v48, v49, v46
    v_max_u32 v48, v48, v46
    v_med3_u32 v50, v49, v50, v47
    v_med3_u32 v49, v48, v49, v47
    v_max_u32 v48, v48, v47
    s_mov_b32 s53, 0
    v_max_u32 v4, v48, v49
    s_nop 1
    v_max_u32_dpp v4, v4, v4 row_shr:1 row_mask:0xf bank_mask:0xf bound_ctrl:0
    s_nop 1
    v_max_u32_dpp v4, v4, v4 row_shr:2 row_mask:0xf bank_mask:0xf bound_ctrl:0
    s_nop 1
    v_max_u32_dpp v4, v4, v4 row_shr:4 row_mask:0xf bank_mask:0xf bound_ctrl:0
    s_nop 1
    v_max_u32_dpp v4, v4, v4 row_shr:8 row_mask:0xf bank_mask:0xf bound_ctrl:0
    s_nop 1
    v_max_u32_dpp v4, v4, v4 row_bcast:15 row_mask:0xa bank_mask:0xf
    s_nop 1
    v_max_u32_dpp v4, v4, v4 row_bcast:31 row_mask:0xc bank_mask:0xf
    s_nop 0
    v_readlane_b32 s52, v4, 63
    s_nop 0
    s_add_u32 s53, s53, s52
    v_writelane_b32 v13, s53, 0
    v_subrev_u32 v48, s52, v48
    v_subrev_u32 v49, s52, v49
    v_max_u32 v4, v48, v49
    s_nop 1
    v_max_u32_dpp v4, v4, v4 row_shr:1 row_mask:0xf bank_mask:0xf bound_ctrl:0
    s_nop 1
    v_max_u32_dpp v4, v4, v4 row_shr:2 row_mask:0xf bank_mask:0xf bound_ctrl:0
    s_nop 1
    v_max_u32_dpp v4, v4, v4 row_shr:4 row_mask:0xf bank_mask:0xf bound_ctrl:0
    s_nop 1
    v_max_u32_dpp v4, v4, v4 row_shr:8 row_mask:0xf bank_mask:0xf bound_ctrl:0
    s_nop 1
    v_max_u32_dpp v4, v4, v4 row_bcast:15 row_mask:0xa bank_mask:0xf
    s_nop 1
    v_max_u32_dpp v4, v4, v4 row_bcast:31 row_mask:0xc bank_mask:0xf
    s_nop 0
    v_readlane_b32 s52, v4, 63
    s_nop 0
    s_add_u32 s53, s53, s52
    v_writelane_b32 v13, s53, 1
    v_subrev_u32 v48, s52, v48
    v_subrev_u32 v49, s52, v49
    v_max_u32 v4, v48, v49
    s_nop 1
    v_max_u32_dpp v4, v4, v4 row_shr:1 row_mask:0xf bank_mask:0xf bound_ctrl:0
    s_nop 1
    v_max_u32_dpp v4, v4, v4 row_shr:2 row_mask:0xf bank_mask:0xf bound_ctrl:0
    s_nop 1
    v_max_u32_dpp v4, v4, v4 row_shr:4 row_mask:0xf bank_mask:0xf bound_ctrl:0
    s_nop 1
    v_max_u32_dpp v4, v4, v4 row_shr:8 row_mask:0xf bank_mask:0xf bound_ctrl:0
    s_nop 1
    v_max_u32_dpp v4, v4, v4 row_bcast:15 row_mask:0xa bank_mask:0xf
    s_nop 1
    v_max_u32_dpp v4, v4, v4 row_bcast:31 row_mask:0xc bank_mask:0xf
    s_nop 0
    v_readlane_b32 s52, v4, 63
    s_nop 0
    s_add_u32 s53, s53, s52
    v_writelane_b32 v13, s53, 2
    v_subrev_u32 v48, s52, v48
    v_subrev_u32 v49, s52, v49
    v_max_u32 v4, v48, v49
    s_nop 1
    v_max_u32_dpp v4, v4, v4 row_shr:1 row_mask:0xf bank_mask:0xf bound_ctrl:0
    s_nop 1
    v_max_u32_dpp v4, v4, v4 row_shr:2 row_mask:0xf bank_mask:0xf bound_ctrl:0
    s_nop 1
    v_max_u32_dpp v4, v4, v4 row_shr:4 row_mask:0xf bank_mask:0xf bound_ctrl:0
    s_nop 1
    v_max_u32_dpp v4, v4, v4 row_shr:8 row_mask:0xf bank_mask:0xf bound_ctrl:0
    s_nop 1
    v_max_u32_dpp v4, v4, v4 row_bcast:15 row_mask:0xa bank_mask:0xf
    s_nop 1
    v_max_u32_dpp v4, v4, v4 row_bcast:31 row_mask:0xc bank_mask:0xf
    s_nop 0
    v_readlane_b32 s52, v4, 63
    s_nop 0
    s_add_u32 s53, s53, s52
    v_writelane_b32 v13, s53, 3
    v_subrev_u32 v48, s52, v48
    v_subrev_u32 v49, s52, v49
    v_max_u32 v4, v48, v49
    s_nop 1
    v_max_u32_dpp v4, v4, v4 row_shr:1 row_mask:0xf bank_mask:0xf bound_ctrl:0
    s_nop 1
    v_max_u32_dpp v4, v4, v4 row_shr:2 row_mask:0xf bank_mask:0xf bound_ctrl:0
    s_nop 1
    v_max_u32_dpp v4, v4, v4 row_shr:4 row_mask:0xf bank_mask:0xf bound_ctrl:0
    s_nop 1
    v_max_u32_dpp v4, v4, v4 row_shr:8 row_mask:0xf bank_mask:0xf bound_ctrl:0
    s_nop 1
    v_max_u32_dpp v4, v4, v4 row_bcast:15 row_mask:0xa bank_mask:0xf
    s_nop 1
    v_max_u32_dpp v4, v4, v4 row_bcast:31 row_mask:0xc bank_mask:0xf
    s_nop 0
    v_readlane_b32 s52, v4, 63
    s_nop 0
    s_add_u32 s53, s53, s52
    v_writelane_b32 v13, s53, 4
    v_subrev_u32 v48, s52, v48
    v_subrev_u32 v49, s52, v49
    v_max_u32 v4, v48, v49
    s_nop 1
    v_max_u32_dpp v4, v4, v4 row_shr:1 row_mask:0xf bank_mask:0xf bound_ctrl:0
    s_nop 1
    v_max_u32_dpp v4, v4, v4 row_shr:2 row_mask:0xf bank_mask:0xf bound_ctrl:0
    s_nop 1
    v_max_u32_dpp v4, v4, v4 row_shr:4 row_mask:0xf bank_mask:0xf bound_ctrl:0
    s_nop 1
    v_max_u32_dpp v4, v4, v4 row_shr:8 row_mask:0xf bank_mask:0xf bound_ctrl:0
    s_nop 1
    v_max_u32_dpp v4, v4, v4 row_bcast:15 row_mask:0xa bank_mask:0xf
    s_nop 1
    v_max_u32_dpp v4, v4, v4 row_bcast:31 row_mask:0xc bank_mask:0xf
    s_nop 0
    v_readlane_b32 s52, v4, 63
    s_nop 0
    s_add_u32 s53, s53, s52
    v_writelane_b32 v13, s53, 5
    v_subrev_u32 v48, s52, v48
    v_subrev_u32 v49, s52, v49
    v_max_u32 v4, v48, v49
    s_nop 1
    v_max_u32_dpp v4, v4, v4 row_shr:1 row_mask:0xf bank_mask:0xf bound_ctrl:0
    s_nop 1
    v_max_u32_dpp v4, v4, v4 row_shr:2 row_mask:0xf bank_mask:0xf bound_ctrl:0
    s_nop 1
    v_max_u32_dpp v4, v4, v4 row_shr:4 row_mask:0xf bank_mask:0xf bound_ctrl:0
    s_nop 1
    v_max_u32_dpp v4, v4, v4 row_shr:8 row_mask:0xf bank_mask:0xf bound_ctrl:0
    s_nop 1
    v_max_u32_dpp v4, v4, v4 row_bcast:15 row_mask:0xa bank_mask:0xf
    s_nop 1
    v_max_u32_dpp v4, v4, v4 row_bcast:31 row_mask:0xc bank_mask:0xf
    s_nop 0
    v_readlane_b32 s52, v4, 63
    s_nop 0
    s_add_u32 s53, s53, s52
    v_writelane_b32 v13, s53, 6
    v_subrev_u32 v48, s52, v48
    v_subrev_u32 v49, s52, v49
    v_max_u32 v4, v48, v49
    s_nop 1
    v_max_u32_dpp v4, v4, v4 row_shr:1 row_mask:0xf bank_mask:0xf bound_ctrl:0
    s_nop 1
    v_max_u32_dpp v4, v4, v4 row_shr:2 row_mask:0xf bank_mask:0xf bound_ctrl:0
    s_nop 1
    v_max_u32_dpp v4, v4, v4 row_shr:4 row_mask:0xf bank_mask:0xf bound_ctrl:0
    s_nop 1
    v_max_u32_dpp v4, v4, v4 row_shr:8 row_mask:0xf bank_mask:0xf bound_ctrl:0
    s_nop 1
    v_max_u32_dpp v4, v4, v4 row_bcast:15 row_mask:0xa bank_mask:0xf
    s_nop 1
    v_max_u32_dpp v4, v4, v4 row_bcast:31 row_mask:0xc bank_mask:0xf
    s_nop 0
    v_readlane_b32 s52, v4, 63
    s_nop 0
    s_add_u32 s53, s53, s52
    v_writelane_b32 v13, s53, 7
    v_cmp_lt_u32 vcc, s53, v50
    s_cbranch_vccz F_a2k
    s_mov_b32 s53, 0
    s_mov_b32 s52, 0
    s_mov_b32 s64, 0
F_a2f:
    v_subrev_u32 v16, s52, v16
    v_subrev_u32 v17, s52, v17
    v_subrev_u32 v18, s52, v18
    v_subrev_u32 v19, s52, v19
    v_subrev_u32 v20, s52, v20
    v_subrev_u32 v21, s52, v21
    v_subrev_u32 v22, s52, v22
    v_subrev_u32 v23, s52, v23
    v_subrev_u32 v24, s52, v24
    v_subrev_u32 v25, s52, v25
    v_subrev_u32 v26, s52, v26
    v_subrev_u32 v27, s52, v27
    v_subrev_u32 v28, s52, v28
    v_subrev_u32 v29, s52, v29
    v_subrev_u32 v30, s52, v30
    v_subrev_u32 v31, s52, v31
    v_subrev_u32 v32, s52, v32
    v_subrev_u32 v33, s52, v33
    v_subrev_u32 v34, s52, v34
    v_subrev_u32 v35, s52, v35
    v_subrev_u32 v36, s52, v36
    v_subrev_u32 v37, s52, v37
    v_subrev_u32 v38, s52, v38
    v_subrev_u32 v39, s52, v39
    v_subrev_u32 v40, s52, v40
    v_subrev_u32 v41, s52, v41
    v_subrev_u32 v42, s52, v42
    v_subrev_u32 v43, s52, v43
    v_subrev_u32 v44, s52, v44
    v_subrev_u32 v45, s52, v45
    v_subrev_u32 v46, s52, v46
    v_subrev_u32 v47, s52, v47
    v_max3_u32 v4, v16, v17, v18
    v_max3_u32 v12, v19, v20, v21
    v_max3_u32 v4, v4, v22, v23
    v_max3_u32 v12, v12, v24, v25
    v_max3_u32 v4, v4, v26, v27
    v_max3_u32 v12, v12, v28, v29
    v_max3_u32 v4, v4, v30, v31
    v_max3_u32 v12, v12, v32, v33
    v_max3_u32 v4, v4, v34, v35
    v_max3_u32 v12, v12, v36, v37
    v_max3_u32 v4, v4, v38, v39
    v_max3_u32 v12, v12, v40, v41
    v_max3_u32 v4, v4, v42, v43
    v_max3_u32 v12, v12, v44, v45
    v_max3_u32 v4, v4, v46, v47
    v_max_u32 v4, v4, v12
    s_nop 1
    v_max_u32_dpp v4, v4, v4 row_shr:1 row_mask:0xf bank_mask:0xf bound_ctrl:0
    s_nop 1
    v_max_u32_dpp v4, v4, v4 row_shr:2 row_mask:0xf bank_mask:0xf bound_ctrl:0
    s_nop 1
    v_max_u32_dpp v4, v4, v4 row_shr:4 row_mask:0xf bank_mask:0xf bound_ctrl:0
    s_nop 1
    v_max_u32_dpp v4, v4, v4 row_shr:8 row_mask:0xf bank_mask:0xf bound_ctrl:0
    s_nop 1
    v_max_u32_dpp v4, v4, v4 row_bcast:15 row_mask:0xa bank_mask:0xf
    s_nop 1
    v_max_u32_dpp v4, v4, v4 row_bcast:31 row_mask:0xc bank_mask:0xf
    s_nop 0
    v_readlane_b32 s52, v4, 63
    s_nop 0
    s_add_u32 s53, s53, s52
    s_mov_b32 m0, s64
    v_writelane_b32 v13, s53, m0
    s_cmp_ge_u32 s74, 17
    s_cbranch_scc1 DB_114
    s_barrier
    s_add_u32 s74, s74, 1
DB_114:
    s_add_u32 s64, s64, 1
    s_cmp_lt_u32 s64, 8
    s_cbranch_scc1 F_a2f
F_a2k:
    v_and_b32 v4, 7, v0
    v_lshlrev_b32 v4, 2, v4
    ds_bpermute_b32 v12, v4, v13
    v_lshrrev_b32 v9, 3, v0
    v_lshl_add_u32 v4, v9, 9, v4
    s_mov_b32 s44, 32896
    s_mov_b32 s45, 36992
    s_waitcnt lgkmcnt(0)
    v_or_b32 v12, 0x8000, v12
    buffer_store_dword v12, v4, s[40:43], s44 offen sc0 sc1
    buffer_store_dword v12, v4, s[40:43], s45 offen sc0 sc1

F_a2m:
    s_cmp_ge_u32 s74, 17
    s_cbranch_scc1 DB_115
    s_barrier
    s_add_u32 s74, s74, 1
DB_115:
    s_cmp_lt_u32 s74, 17
    s_cbranch_scc1 F_a2m
    s_add_u32 s91, s54, 0
    s_nop 0
    buffer_load_dwordx4 v[72:75], v6, s[16:19], s91 offen nt
    s_add_u32 s91, s54, 7168
    buffer_load_dwordx4 v[76:79], v6, s[16:19], s91 offen nt
    s_add_u32 s91, s54, 14336
    buffer_load_dwordx4 v[80:83], v6, s[16:19], s91 offen nt
    s_add_u32 s91, s54, 21504
    buffer_load_dwordx4 v[84:87], v6, s[16:19], s91 offen nt
    s_add_u32 s91, s54, 28672
    buffer_load_dwordx4 v[88:91], v6, s[16:19], s91 offen nt
    s_add_u32 s91, s54, 35840
    buffer_load_dwordx4 v[92:95], v6, s[16:19], s91 offen nt
    s_add_u32 s91, s54, 43008
    buffer_load_dwordx4 v[96:99], v6, s[16:19], s91 offen nt
    s_add_u32 s91, s54, 50176
    buffer_load_dwordx4 v[100:103], v6, s[16:19], s91 offen nt
    s_add_u32 s91, s54, 229376
    buffer_load_dwordx4 v[104:107], v6, s[16:19], s91 offen nt
    s_add_u32 s91, s54, 236544
    buffer_load_dwordx4 v[108:111], v6, s[16:19], s91 offen nt
    s_add_u32 s91, s54, 243712
    buffer_load_dwordx4 v[112:115], v6, s[16:19], s91 offen nt
    s_add_u32 s91, s54, 250880
    buffer_load_dwordx4 v[116:119], v6, s[16:19], s91 offen nt
    s_add_u32 s91, s54, 258048
    buffer_load_dwordx4 v[120:123], v6, s[16:19], s91 offen nt
    s_add_u32 s91, s54, 265216
    buffer_load_dwordx4 v[124:127], v6, s[16:19], s91 offen nt
    s_add_u32 s91, s54, 272384
    buffer_load_dwordx4 v[128:131], v6, s[16:19], s91 offen nt
    s_add_u32 s91, s54, 279552
    buffer_load_dwordx4 v[132:135], v6, s[16:19], s91 offen nt
    s_branch F_aj2
IW_w10:
    s_branch IW_r10
F_a2n:
    s_barrier
    s_cmp_lg_u32 s53, 0
    s_cbranch_scc1 SW_116
    s_call_b64 s[34:35], F_sw0
SW_116:
    s_branch IW_w11
IW_r11:
    s_barrier
    s_cmp_lg_u32 s53, 1
    s_cbranch_scc1 SW_117
    s_call_b64 s[34:35], F_sw0
SW_117:
    s_nop 0
    s_barrier
    s_cmp_lg_u32 s53, 2
    s_cbranch_scc1 SW_118
    s_call_b64 s[34:35], F_sw0
SW_118:
    s_nop 0
    s_barrier
    s_cmp_lg_u32 s53, 3
    s_cbranch_scc1 SW_119
    s_call_b64 s[34:35], F_sw0
SW_119:
    s_nop 0
    s_barrier
    s_nop 0
    s_barrier
    s_nop 0
    s_barrier
    s_nop 0
    s_add_u32 s91, s54, 229376
    buffer_load_dwordx4 v[104:107], v6, s[16:19], s91 offen nt
    s_add_u32 s91, s54, 236544
    buffer_load_dwordx4 v[108:111], v6, s[16:19], s91 offen nt
    s_add_u32 s91, s54, 243712
    buffer_load_dwordx4 v[112:115], v6, s[16:19], s91 offen nt
    s_add_u32 s91, s54, 250880
    buffer_load_dwordx4 v[116:119], v6, s[16:19], s91 offen nt
    s_nop 0
    s_load_dwordx8 s[60:67], s[56:57], 128 glc
    s_barrier
    s_add_u32 s91, s54, 258048
    buffer_load_dwordx4 v[120:123], v6, s[16:19], s91 offen nt
    s_add_u32 s91, s54, 265216
    buffer_load_dwordx4 v[124:127], v6, s[16:19], s91 offen nt
    s_add_u32 s91, s54, 272384
    buffer_load_dwordx4 v[128:131], v6, s[16:19], s91 offen nt
    s_add_u32 s91, s54, 279552
    buffer_load_dwordx4 v[132:135], v6, s[16:19], s91 offen nt
    s_waitcnt lgkmcnt(0)
    s_and_b64 s[44:45], s[60:61], s[62:63]
    s_and_b64 s[44:45], s[44:45], s[64:65]
    s_and_b64 s[44:45], s[44:45], s[66:67]
    s_and_b32 s44, s44, s45
    s_bitcmp1_b32 s44, 15
    s_cbranch_scc0 F_a2q
    s_nop 0
    s_andn2_b32 s60, s60, 0x8000
    v_writelane_b32 v12, s60, 0
    s_andn2_b32 s61, s61, 0x8000
    v_writelane_b32 v12, s61, 1
    s_andn2_b32 s62, s62, 0x8000
    v_writelane_b32 v12, s62, 2
    s_andn2_b32 s63, s63, 0x8000
    v_writelane_b32 v12, s63, 3
    s_andn2_b32 s64, s64, 0x8000
    v_writelane_b32 v12, s64, 4
    s_andn2_b32 s65, s65, 0x8000
    v_writelane_b32 v12, s65, 5
    s_andn2_b32 s66, s66, 0x8000
    v_writelane_b32 v12, s66, 6
    s_andn2_b32 s67, s67, 0x8000
    v_writelane_b32 v12, s67, 7
    v_add_u32 v4, 158976, v3
    s_mov_b64 exec, 0xff
    ds_write_b32 v4, v12
    s_mov_b64 exec, -1
    v_mov_b32 v4, 1
    s_mov_b64 exec, 1
    ds_write_b32 v10, v4 offset:48
    s_mov_b64 exec, -1
    s_waitcnt lgkmcnt(0)
    s_mov_b32 s88, 1
F_a2q:
    s_barrier
F_aj:
    s_mov_b32 s74, 0
F_aj2:
    v_and_b32 v13, 3, v0
    v_lshlrev_b32 v13, 2, v13
    v_add_u32 v13, 159040, v13

    s_cmp_lt_u32 s3, 2
    s_mov_b32 s75, 65536
    s_cselect_b32 s75, 32768, s75
    s_and_b32 s44, s3, 1
    s_lshl_b32 s44, s44, 12
    s_add_u32 s75, s75, s44
    s_add_u32 s12, s72, 0x900000
    s_addc_u32 s13, s73, 0
    s_mov_b32 s14, 0xe0000
    s_mov_b32 s15, 0x00020000
    s_mov_b32 s47, s10
    v_mov_b32 v4, 159096
    ds_read_b32 v9, v4
    s_waitcnt lgkmcnt(0)
    v_readfirstlane_b32 s79, v9
    s_nop 0
    s_cmp_eq_u32 s79, 0
    s_cbranch_scc1 F_xe
    v_and_b32 v4, 7, v0
    v_lshlrev_b32 v4, 2, v4
    v_add_u32 v4, 158976, v4
    ds_read_b32 v4, v4
    s_waitcnt lgkmcnt(0)
    v_and_b32 v4, 0x7ff, v4
    v_sub_u32 v4, 2047, v4
    v_and_b32 v11, 7, v4
    v_lshrrev_b32 v9, 3, v4
    v_lshlrev_b32 v9, 7, v9
    v_lshl_add_u32 v9, v11, 3, v9
    v_lshlrev_b32 v4, 11, v4
    v_lshl_add_u32 v4, v5, 4, v4
    buffer_load_dwordx4 v[64:67], v4, s[20:23], s55 offen
    buffer_load_dwordx4 v[68:71], v4, s[20:23], s55 offen offset:64
    buffer_load_dwordx2 v[14:15], v9, s[40:43], 0 offen sc0 sc1

F_xe:
    s_cmp_lg_u32 s74, 0
    s_cbranch_scc1 JB_120
    s_barrier
JB_120:
    s_cmp_lg_u32 s88, 3
    s_cbranch_scc1 F_g4
SP_121:
    s_load_dword s76, s[56:57], 0 glc
    s_waitcnt lgkmcnt(0)
    s_cmp_ge_u32 s76, 1000
    s_cbranch_scc1 SD_122
    s_sleep 3
    s_branch SP_121
SD_122:
    v_mov_b32 v4, 1
    s_mov_b64 exec, 1
    ds_write_b32 v10, v4 offset:48
    s_mov_b64 exec, -1
F_g4:
    s_setprio 1
    s_cmp_lg_u32 s79, 0
    s_cbranch_scc1 F_xd
    s_cmp_lg_u32 s88, 2
    s_cbranch_scc1 F_se
F_sc:
    s_load_dwordx8 s[60:67], s[56:57], 128 glc
    s_waitcnt lgkmcnt(0)
    s_and_b64 s[44:45], s[60:61], s[62:63]
    s_and_b64 s[44:45], s[44:45], s[64:65]
    s_and_b64 s[44:45], s[44:45], s[66:67]
    s_and_b32 s44, s44, s45
    s_bitcmp1_b32 s44, 15
    s_cbranch_scc1 F_sd
    s_sleep 4
    s_branch F_sc
F_sd:
    s_andn2_b32 s60, s60, 0x8000
    v_writelane_b32 v12, s60, 0
    s_andn2_b32 s61, s61, 0x8000
    v_writelane_b32 v12, s61, 1
    s_andn2_b32 s62, s62, 0x8000
    v_writelane_b32 v12, s62, 2
    s_andn2_b32 s63, s63, 0x8000
    v_writelane_b32 v12, s63, 3
    s_andn2_b32 s64, s64, 0x8000
    v_writelane_b32 v12, s64, 4
    s_andn2_b32 s65, s65, 0x8000
    v_writelane_b32 v12, s65, 5
    s_andn2_b32 s66, s66, 0x8000
    v_writelane_b32 v12, s66, 6
    s_andn2_b32 s67, s67, 0x8000
    v_writelane_b32 v12, s67, 7
    v_add_u32 v4, 158976, v3
    s_mov_b64 exec, 0xff
    ds_write_b32 v4, v12
    s_mov_b64 exec, -1
    v_mov_b32 v4, 1
    s_mov_b64 exec, 1
    ds_write_b32 v10, v4 offset:48
    s_mov_b64 exec, -1
F_se:
    v_mov_b32 v4, 159096
    ds_read_b32 v9, v4 offset:0
FW_123:
    s_waitcnt lgkmcnt(0)
    v_cmp_gt_u32 vcc, 1, v9
    s_cbranch_vccz FO_124
    s_sleep 1
    ds_read_b32 v9, v4 offset:0
    s_branch FW_123
FO_124:
    v_and_b32 v4, 7, v0
    v_lshlrev_b32 v4, 2, v4
    v_add_u32 v4, 158976, v4
    ds_read_b32 v4, v4
    s_waitcnt lgkmcnt(0)
    v_and_b32 v4, 0x7ff, v4
    v_sub_u32 v4, 2047, v4
    v_and_b32 v11, 7, v4
    v_lshrrev_b32 v9, 3, v4
    v_lshlrev_b32 v9, 7, v9
    v_lshl_add_u32 v9, v11, 3, v9
    v_lshlrev_b32 v4, 11, v4
    v_lshl_add_u32 v4, v5, 4, v4
    buffer_load_dwordx4 v[64:67], v4, s[20:23], s55 offen
    buffer_load_dwordx4 v[68:71], v4, s[20:23], s55 offen offset:64
    buffer_load_dwordx2 v[14:15], v9, s[40:43], 0 offen sc0 sc1

F_xd:
    s_mov_b32 s52, 0x05040100
    s_mov_b32 s53, 0x07060302
    s_setprio 1
    s_cmp_ge_u32 s89, 224
    s_cbranch_scc1 F_adown
    s_waitcnt vmcnt(0)
    v_lshlrev_b32 v34, 16, v64
    v_and_b32 v35, 0xffff0000, v64
    v_lshlrev_b32 v36, 16, v65
    v_and_b32 v37, 0xffff0000, v65
    v_lshlrev_b32 v38, 16, v66
    v_and_b32 v39, 0xffff0000, v66
    v_lshlrev_b32 v40, 16, v67
    v_and_b32 v41, 0xffff0000, v67
    v_lshlrev_b32 v42, 16, v68
    v_and_b32 v43, 0xffff0000, v68
    v_lshlrev_b32 v44, 16, v69
    v_and_b32 v45, 0xffff0000, v69
    v_lshlrev_b32 v46, 16, v70
    v_and_b32 v47, 0xffff0000, v70
    v_lshlrev_b32 v48, 16, v71
    v_and_b32 v49, 0xffff0000, v71
    v_add_f32 v34, v34, v14
    v_add_f32 v35, v35, v14
    v_add_f32 v36, v36, v14
    v_add_f32 v37, v37, v14
    v_add_f32 v38, v38, v14
    v_add_f32 v39, v39, v14
    v_add_f32 v40, v40, v14
    v_add_f32 v41, v41, v14
    v_add_f32 v42, v42, v14
    v_add_f32 v43, v43, v14
    v_add_f32 v44, v44, v14
    v_add_f32 v45, v45, v14
    v_add_f32 v46, v46, v14
    v_add_f32 v47, v47, v14
    v_add_f32 v48, v48, v14
    v_add_f32_e64 v49, v49, v14
    v_cvt_pk_bf16_f32 v64, v34, v35
    v_cvt_pk_bf16_f32 v65, v36, v37
    v_cvt_pk_bf16_f32 v66, v38, v39
    v_cvt_pk_bf16_f32 v67, v40, v41
    v_cvt_pk_bf16_f32 v68, v42, v43
    v_cvt_pk_bf16_f32 v69, v44, v45
    v_cvt_pk_bf16_f32 v70, v46, v47
    v_cvt_pk_bf16_f32 v71, v48, v49
    v_lshlrev_b32 v34, 16, v64
    v_and_b32 v35, 0xffff0000, v64
    v_lshlrev_b32 v36, 16, v65
    v_and_b32 v37, 0xffff0000, v65
    v_lshlrev_b32 v38, 16, v66
    v_and_b32 v39, 0xffff0000, v66
    v_lshlrev_b32 v40, 16, v67
    v_and_b32 v41, 0xffff0000, v67
    v_lshlrev_b32 v42, 16, v68
    v_and_b32 v43, 0xffff0000, v68
    v_lshlrev_b32 v44, 16, v69
    v_and_b32 v45, 0xffff0000, v69
    v_lshlrev_b32 v46, 16, v70
    v_and_b32 v47, 0xffff0000, v70
    v_lshlrev_b32 v48, 16, v71
    v_and_b32 v49, 0xffff0000, v71
    v_mul_f32 v34, v34, v15
    v_mul_f32 v35, v35, v15
    v_mul_f32 v36, v36, v15
    v_mul_f32 v37, v37, v15
    v_mul_f32 v38, v38, v15
    v_mul_f32 v39, v39, v15
    v_mul_f32 v40, v40, v15
    v_mul_f32 v41, v41, v15
    v_mul_f32 v42, v42, v15
    v_mul_f32 v43, v43, v15
    v_mul_f32 v44, v44, v15
    v_mul_f32 v45, v45, v15
    v_mul_f32 v46, v46, v15
    v_mul_f32 v47, v47, v15
    v_mul_f32 v48, v48, v15
    v_mul_f32 v49, v49, v15
    v_cvt_pk_bf16_f32 v64, v34, v35
    v_cvt_pk_bf16_f32 v65, v36, v37
    v_cvt_pk_bf16_f32 v66, v38, v39
    v_cvt_pk_bf16_f32 v67, v40, v41
    v_cvt_pk_bf16_f32 v68, v42, v43
    v_cvt_pk_bf16_f32 v69, v44, v45
    v_cvt_pk_bf16_f32 v70, v46, v47
    v_cvt_pk_bf16_f32 v71, v48, v49
    s_waitcnt vmcnt(0)
    v_perm_b32 v136, v76, v72, s52
    v_perm_b32 v137, v84, v80, s52
    v_perm_b32 v138, v92, v88, s52
    v_perm_b32 v139, v100, v96, s52
    s_nop 1
    v_mfma_f32_16x16x32_bf16 v[32:35], v[64:67], v[136:139], 0
    v_perm_b32 v140, v76, v72, s53
    v_perm_b32 v141, v84, v80, s53
    v_perm_b32 v142, v92, v88, s53
    v_perm_b32 v143, v100, v96, s53
    s_nop 1
    v_mfma_f32_16x16x32_bf16 v[36:39], v[64:67], v[140:143], 0
    v_perm_b32 v136, v77, v73, s52
    v_perm_b32 v137, v85, v81, s52
    v_perm_b32 v138, v93, v89, s52
    v_perm_b32 v139, v101, v97, s52
    s_nop 1
    v_mfma_f32_16x16x32_bf16 v[40:43], v[64:67], v[136:139], 0
    v_perm_b32 v140, v77, v73, s53
    v_perm_b32 v141, v85, v81, s53
    v_perm_b32 v142, v93, v89, s53
    v_perm_b32 v143, v101, v97, s53
    s_nop 1
    v_mfma_f32_16x16x32_bf16 v[44:47], v[64:67], v[140:143], 0
    v_perm_b32 v136, v78, v74, s52
    v_perm_b32 v137, v86, v82, s52
    v_perm_b32 v138, v94, v90, s52
    v_perm_b32 v139, v102, v98, s52
    s_nop 1
    v_mfma_f32_16x16x32_bf16 v[48:51], v[64:67], v[136:139], 0
    v_perm_b32 v140, v78, v74, s53
    v_perm_b32 v141, v86, v82, s53
    v_perm_b32 v142, v94, v90, s53
    v_perm_b32 v143, v102, v98, s53
    s_nop 1
    v_mfma_f32_16x16x32_bf16 v[52:55], v[64:67], v[140:143], 0
    v_perm_b32 v136, v79, v75, s52
    v_perm_b32 v137, v87, v83, s52
    v_perm_b32 v138, v95, v91, s52
    v_perm_b32 v139, v103, v99, s52
    s_nop 1
    v_mfma_f32_16x16x32_bf16 v[56:59], v[64:67], v[136:139], 0
    v_perm_b32 v140, v79, v75, s53
    v_perm_b32 v141, v87, v83, s53
    v_perm_b32 v142, v95, v91, s53
    v_perm_b32 v143, v103, v99, s53
    s_nop 1
    v_mfma_f32_16x16x32_bf16 v[60:63], v[64:67], v[140:143], 0
    s_waitcnt vmcnt(0)
    v_perm_b32 v136, v108, v104, s52
    v_perm_b32 v137, v116, v112, s52
    v_perm_b32 v138, v124, v120, s52
    v_perm_b32 v139, v132, v128, s52
    s_nop 1
    v_mfma_f32_16x16x32_bf16 v[32:35], v[68:71], v[136:139], v[32:35]
    v_perm_b32 v140, v108, v104, s53
    v_perm_b32 v141, v116, v112, s53
    v_perm_b32 v142, v124, v120, s53
    v_perm_b32 v143, v132, v128, s53
    s_nop 1
    v_mfma_f32_16x16x32_bf16 v[36:39], v[68:71], v[140:143], v[36:39]
    v_perm_b32 v136, v109, v105, s52
    v_perm_b32 v137, v117, v113, s52
    v_perm_b32 v138, v125, v121, s52
    v_perm_b32 v139, v133, v129, s52
    s_nop 1
    v_mfma_f32_16x16x32_bf16 v[40:43], v[68:71], v[136:139], v[40:43]
    v_perm_b32 v140, v109, v105, s53
    v_perm_b32 v141, v117, v113, s53
    v_perm_b32 v142, v125, v121, s53
    v_perm_b32 v143, v133, v129, s53
    s_nop 1
    v_mfma_f32_16x16x32_bf16 v[44:47], v[68:71], v[140:143], v[44:47]
    v_perm_b32 v136, v110, v106, s52
    v_perm_b32 v137, v118, v114, s52
    v_perm_b32 v138, v126, v122, s52
    v_perm_b32 v139, v134, v130, s52
    s_nop 1
    v_mfma_f32_16x16x32_bf16 v[48:51], v[68:71], v[136:139], v[48:51]
    v_perm_b32 v140, v110, v106, s53
    v_perm_b32 v141, v118, v114, s53
    v_perm_b32 v142, v126, v122, s53
    v_perm_b32 v143, v134, v130, s53
    s_nop 1
    v_mfma_f32_16x16x32_bf16 v[52:55], v[68:71], v[140:143], v[52:55]
    v_perm_b32 v136, v111, v107, s52
    v_perm_b32 v137, v119, v115, s52
    v_perm_b32 v138, v127, v123, s52
    v_perm_b32 v139, v135, v131, s52
    s_nop 1
    v_mfma_f32_16x16x32_bf16 v[56:59], v[68:71], v[136:139], v[56:59]
    v_perm_b32 v140, v111, v107, s53
    v_perm_b32 v141, v119, v115, s53
    v_perm_b32 v142, v127, v123, s53
    v_perm_b32 v143, v135, v131, s53
    s_nop 1
    v_mfma_f32_16x16x32_bf16 v[60:63], v[68:71], v[140:143], v[60:63]
    s_setprio 3
    s_and_b32 s44, s3, 1
    s_lshl_b32 s44, s44, 12
    s_add_u32 s44, s44, 65536
    v_xor_b32 v4, v7, v5
    v_lshlrev_b32 v4, 4, v4
    v_lshl_add_u32 v4, v5, 8, v4
    v_add_u32 v72, s44, v4
    v_add_u32 v8, 8, v10

    v_xor_b32 v73, 32, v72
    v_xor_b32 v74, 64, v72
    v_xor_b32 v75, 96, v72
    v_xor_b32 v76, 128, v72
    v_xor_b32 v77, 160, v72
    v_xor_b32 v78, 192, v72
    v_xor_b32 v79, 224, v72
    ds_read_b32 v12, v13 offset:32
FW_125:
    s_waitcnt lgkmcnt(0)
    v_cmp_gt_u32 vcc, 2, v12
    s_branch IW_s11
IW_w11:
    s_branch IW_r11
IW_s11:
    s_cbranch_vccz FO_126
    s_sleep 1
    ds_read_b32 v12, v13 offset:32
    s_branch FW_125
FO_126:
    s_add_u32 s45, s78, 0
    s_nop 0
    buffer_load_dwordx4 v[16:19], v160, s[80:83], s45 offen nt
    s_add_u32 s45, s78, 2048
    buffer_load_dwordx4 v[20:23], v160, s[80:83], s45 offen nt
    s_add_u32 s45, s78, 4096
    buffer_load_dwordx4 v[24:27], v160, s[80:83], s45 offen nt
    s_add_u32 s45, s78, 6144
    buffer_load_dwordx4 v[28:31], v160, s[80:83], s45 offen nt
    s_add_u32 s45, s78, 8192
    buffer_load_dwordx4 v[144:147], v160, s[80:83], s45 offen nt
    s_add_u32 s45, s78, 10240
    buffer_load_dwordx4 v[148:151], v160, s[80:83], s45 offen nt
    s_add_u32 s45, s78, 12288
    buffer_load_dwordx4 v[152:155], v160, s[80:83], s45 offen nt
    s_cmp_lt_u32 s3, 2
    s_cbranch_scc1 F_t1
    ds_read_b32 v12, v13 offset:32
FW_127:
    s_waitcnt lgkmcnt(0)
    v_cmp_gt_u32 vcc, 2, v12
    s_cbranch_vccz FO_128
    s_sleep 1
    ds_read_b32 v12, v13 offset:32
    s_branch FW_127
FO_128:
    s_branch F_t2
F_t1:
    ds_read_b32 v12, v8 offset:64
FW_129:
    s_waitcnt lgkmcnt(0)
    v_cmp_gt_u32 vcc, 1, v12
    s_cbranch_vccz FO_130
    s_sleep 1
    ds_read_b32 v12, v8 offset:64
    s_branch FW_129
FO_130:
    s_nop 0
    ds_read_b128 v[80:83], v72 offset:0
    ds_read_b128 v[84:87], v73 offset:512
    ds_read_b128 v[88:91], v74 offset:1024
    ds_read_b128 v[92:95], v75 offset:1536
    ds_read_b128 v[96:99], v76 offset:2048
    ds_read_b128 v[100:103], v77 offset:2560
    ds_read_b128 v[104:107], v78 offset:3072
    ds_read_b128 v[108:111], v79 offset:3584
    s_waitcnt lgkmcnt(7)
    v_add_f32 v32, v32, v80
    v_add_f32 v33, v33, v81
    v_add_f32 v34, v34, v82
    v_add_f32 v35, v35, v83
    s_waitcnt lgkmcnt(6)
    v_add_f32 v36, v36, v84
    v_add_f32 v37, v37, v85
    v_add_f32 v38, v38, v86
    v_add_f32 v39, v39, v87
    s_waitcnt lgkmcnt(5)
    v_add_f32 v40, v40, v88
    v_add_f32 v41, v41, v89
    v_add_f32 v42, v42, v90
    v_add_f32 v43, v43, v91
    s_waitcnt lgkmcnt(4)
    v_add_f32 v44, v44, v92
    v_add_f32 v45, v45, v93
    v_add_f32 v46, v46, v94
    v_add_f32 v47, v47, v95
    s_waitcnt lgkmcnt(3)
    v_add_f32 v48, v48, v96
    v_add_f32 v49, v49, v97
    v_add_f32 v50, v50, v98
    v_add_f32 v51, v51, v99
    s_waitcnt lgkmcnt(2)
    v_add_f32 v52, v52, v100
    v_add_f32 v53, v53, v101
    v_add_f32 v54, v54, v102
    v_add_f32 v55, v55, v103
    s_waitcnt lgkmcnt(1)
    v_add_f32 v56, v56, v104
    v_add_f32 v57, v57, v105
    v_add_f32 v58, v58, v106
    v_add_f32 v59, v59, v107
    s_waitcnt lgkmcnt(0)
    v_add_f32 v60, v60, v108
    v_add_f32 v61, v61, v109
    v_add_f32 v62, v62, v110
    v_add_f32 v63, v63, v111
F_t2:
    s_mov_b32 exec_hi, 0
    s_nop 0
    ds_write_b128 v72, v[32:35] offset:0
    ds_write_b128 v73, v[36:39] offset:512
    ds_write_b128 v74, v[40:43] offset:1024
    ds_write_b128 v75, v[44:47] offset:1536
    ds_write_b128 v76, v[48:51] offset:2048
    ds_write_b128 v77, v[52:55] offset:2560
    ds_write_b128 v78, v[56:59] offset:3072
    ds_write_b128 v79, v[60:63] offset:3584
    s_mov_b64 exec, -1
    v_mov_b32 v4, 1
    s_mov_b64 exec, 1
    ds_write_b32 v10, v4 offset:64
    s_mov_b64 exec, -1
    s_lshl_b32 s44, s3, 2
    v_add_u32 v4, s44, v5
    v_xor_b32 v4, v4, v7
    v_lshlrev_b32 v4, 4, v4
    v_lshl_add_u32 v4, v7, 8, v4
    v_add_u32 v4, 65536, v4
    s_lshl_b32 s44, s3, 10
    s_lshl_b32 s77, s36, 1
    s_add_u32 s77, s77, s37
    s_mul_i32 s77, s77, 114688
    s_lshl_b32 s46, s38, 12
    s_add_u32 s77, s77, s46
    s_add_u32 s77, s77, s44
    s_lshl_b32 s46, s38, 9
    v_mov_b32 v9, 159148
    v_mov_b32 v11, 1

    s_add_u32 s56, s46, 0x829000
    s_add_u32 s56, s72, s56
    s_addc_u32 s57, s73, 0
    ds_read_b32 v12, v13 offset:64
FW_131:
    s_waitcnt lgkmcnt(0)
    v_cmp_gt_u32 vcc, 1, v12
    s_cbranch_vccz FO_132
    ds_read_b32 v12, v13 offset:64
    s_branch FW_131
FO_132:
    ds_read_b128 v[72:75], v4
    ds_read_b128 v[76:79], v4 offset:4096
    s_waitcnt lgkmcnt(0)
    v_add_f32 v72, v72, v76
    v_add_f32 v73, v73, v77
    v_add_f32 v74, v74, v78
    v_add_f32 v75, v75, v79
    buffer_store_dwordx4 v[72:75], v2, s[12:15], s77 offen sc0 sc1
    v_mov_b32 v4, 2
    s_mov_b64 exec, 1
    ds_write_b32 v10, v4 offset:64
    s_mov_b64 exec, -1
    s_waitcnt vmcnt(0)
    s_mov_b64 exec, 1
    ds_add_rtn_u32 v9, v9, v11
    s_waitcnt lgkmcnt(0)
    v_readfirstlane_b32 s44, v9
    s_mov_b64 exec, -1
    s_cmp_lg_u32 s44, 3
    s_cbranch_scc1 F_ad2

    s_mov_b32 s74, 1
    s_atomic_add s74, s[56:57], 0x0
    s_atomic_add s74, s[56:57], 0x80
    s_atomic_add s74, s[56:57], 0x100
    s_atomic_add s74, s[56:57], 0x180
    s_branch F_ad2
F_adown:
    s_add_u32 s45, s78, 0
    buffer_load_dwordx4 v[16:19], v160, s[80:83], s45 offen nt
    s_add_u32 s45, s78, 2048
    buffer_load_dwordx4 v[20:23], v160, s[80:83], s45 offen nt
    s_add_u32 s45, s78, 4096
    buffer_load_dwordx4 v[24:27], v160, s[80:83], s45 offen nt
    s_add_u32 s45, s78, 6144
    buffer_load_dwordx4 v[28:31], v160, s[80:83], s45 offen nt
    s_add_u32 s45, s78, 8192
    buffer_load_dwordx4 v[144:147], v160, s[80:83], s45 offen nt
    s_add_u32 s45, s78, 10240
    buffer_load_dwordx4 v[148:151], v160, s[80:83], s45 offen nt
    s_add_u32 s45, s78, 12288
    buffer_load_dwordx4 v[152:155], v160, s[80:83], s45 offen nt
    v_mov_b32 v4, 2
    s_mov_b64 exec, 1
    ds_write_b32 v10, v4 offset:64
    s_mov_b64 exec, -1
F_ad2:
    s_setprio 3
    v_min_u32 v4, 55, v0
    v_lshlrev_b32 v4, 4, v4
    s_lshl_b32 s38, s47, 5
    s_and_b32 s46, s39, 3
    s_lshr_b32 s44, s47, 7
    s_lshl_b32 s44, s44, 2
    s_add_u32 s44, s44, s46
    s_lshl_b32 s44, s44, 7
    s_add_u32 s45, s47, 111
    s_lshr_b32 s45, s45, 7
    s_lshl_b32 s45, s45, 2
    s_add_u32 s45, s45, s46
    s_lshl_b32 s45, s45, 7
    s_waitcnt lgkmcnt(0)

    s_add_u32 s56, s44, 0x829000
    s_add_u32 s56, s72, s56
    s_addc_u32 s57, s73, 0
    s_add_u32 s58, s45, 0x829000
    s_add_u32 s58, s72, s58
    s_addc_u32 s59, s73, 0
    v_mov_b32 v156, 0
    v_mov_b32 v157, 0
    v_mov_b32 v158, 0
    v_mov_b32 v159, 0
    s_mov_b32 s48, 0xbfb8aa3b
    ds_read_b32 v12, v13 offset:0
FW_133:
    s_waitcnt lgkmcnt(0)
    v_cmp_gt_u32 vcc, 4, v12
    s_cbranch_vccz FO_134
    s_sleep 1
    ds_read_b32 v12, v13 offset:0
    s_branch FW_133
FO_134:
    ds_read_b32 v12, v13 offset:64
FW_135:
    s_waitcnt lgkmcnt(0)
    v_cmp_gt_u32 vcc, 2, v12
    s_cbranch_vccz FO_136
    s_sleep 1
    ds_read_b32 v12, v13 offset:64
    s_branch FW_135
FO_136:
    ds_read_b32 v12, v13 offset:32
FW_137:
    s_waitcnt lgkmcnt(0)
    v_cmp_gt_u32 vcc, 2, v12
    s_cbranch_vccz FO_138
    s_sleep 1
    ds_read_b32 v12, v13 offset:32
    s_branch FW_137
FO_138:
    s_mov_b32 s44, s75
    v_lshlrev_b32 v9, 3, v0
    v_add_u32 v9, s44, v9
    ds_write_b64 v9, v[156:157]
    v_lshrrev_b32 v11, 1, v0
    v_mul_u32_u24 v9, 37, v11
    v_lshrrev_b32 v9, 8, v9
    v_add_u32 v11, v11, v9
    v_lshlrev_b32 v11, 1, v11
    v_and_b32 v9, 1, v0
    v_lshl_add_u32 v11, v9, 8, v11
    v_add_u32 v11, s44, v11
    v_and_b32 v9, 7, v0
    v_lshlrev_b32 v9, 6, v9
    v_lshl_add_u32 v9, v5, 4, v9
    v_add_u32 v9, s44, v9

    s_cmp_lg_u32 s3, 0
    s_cbranch_scc1 F_pp
SP_139:
    s_load_dword s76, s[56:57], 0 glc
    s_waitcnt lgkmcnt(0)
    s_cmp_ge_u32 s76, 8
    s_cbranch_scc1 SD_140
    s_sleep 2
    s_branch SP_139
SD_140:
SP_141:
    s_load_dword s76, s[58:59], 0 glc
    s_waitcnt lgkmcnt(0)
    s_cmp_ge_u32 s76, 8
    s_cbranch_scc1 SD_142
    s_sleep 2
    s_branch SP_141
SD_142:
    v_mov_b32 v12, 3
    s_mov_b64 exec, 1
    ds_write_b32 v10, v12 offset:64
    s_mov_b64 exec, -1
F_pp:
    v_mov_b32 v8, 159104
    ds_read_b32 v12, v8 offset:0
FW_143:
    s_waitcnt lgkmcnt(0)
    v_cmp_gt_u32 vcc, 3, v12
    s_cbranch_vccz FO_144
    s_sleep 1
    ds_read_b32 v12, v8 offset:0
    s_branch FW_143
FO_144:
    s_add_u32 s45, s38, 0
    buffer_load_dwordx4 v[32:35], v4, s[12:15], s45 offen sc0 sc1
    s_add_u32 s45, s38, 114688
    buffer_load_dwordx4 v[36:39], v4, s[12:15], s45 offen sc0 sc1
    s_add_u32 s45, s38, 229376
    buffer_load_dwordx4 v[40:43], v4, s[12:15], s45 offen sc0 sc1
    s_add_u32 s45, s38, 344064
    buffer_load_dwordx4 v[44:47], v4, s[12:15], s45 offen sc0 sc1
    s_add_u32 s45, s38, 458752
    buffer_load_dwordx4 v[48:51], v4, s[12:15], s45 offen sc0 sc1
    s_add_u32 s45, s38, 573440
    buffer_load_dwordx4 v[52:55], v4, s[12:15], s45 offen sc0 sc1
    s_add_u32 s45, s38, 688128
    buffer_load_dwordx4 v[56:59], v4, s[12:15], s45 offen sc0 sc1
    s_add_u32 s45, s38, 802816
    buffer_load_dwordx4 v[60:63], v4, s[12:15], s45 offen sc0 sc1
    s_waitcnt vmcnt(0)
    v_add_f32 v32, v32, v40
    v_add_f32 v48, v48, v56
    v_add_f32 v33, v33, v41
    v_add_f32 v49, v49, v57
    v_add_f32 v34, v34, v42
    v_add_f32 v50, v50, v58
    v_add_f32 v35, v35, v43
    v_add_f32 v51, v51, v59
    v_add_f32 v32, v32, v48
    v_add_f32 v33, v33, v49
    v_add_f32 v34, v34, v50
    v_add_f32 v35, v35, v51
    v_add_f32 v36, v36, v44
    v_add_f32 v52, v52, v60
    v_add_f32 v37, v37, v45
    v_add_f32 v53, v53, v61
    v_add_f32 v38, v38, v46
    v_add_f32 v54, v54, v62
    v_add_f32 v39, v39, v47
    v_add_f32 v55, v55, v63
    v_add_f32 v36, v36, v52
    v_add_f32 v37, v37, v53
    v_add_f32 v38, v38, v54
    v_add_f32 v39, v39, v55
    v_cvt_pk_bf16_f32 v40, v32, v36
    v_cvt_pk_bf16_f32 v41, v33, v37
    v_cvt_pk_bf16_f32 v42, v34, v38
    v_cvt_pk_bf16_f32 v43, v35, v39
    v_lshlrev_b32 v32, 16, v40
    v_and_b32 v36, 0xffff0000, v40
    v_lshlrev_b32 v33, 16, v41
    v_and_b32 v37, 0xffff0000, v41
    v_lshlrev_b32 v34, 16, v42
    v_and_b32 v38, 0xffff0000, v42
    v_lshlrev_b32 v35, 16, v43
    v_and_b32 v39, 0xffff0000, v43
    v_mul_f32 v40, s48, v32
    v_mul_f32 v41, s48, v33
    v_mul_f32 v42, s48, v34
    v_mul_f32 v43, s48, v35
    v_exp_f32 v40, v40
    v_exp_f32 v41, v41
    v_exp_f32 v42, v42
    v_exp_f32 v43, v43
    v_add_f32 v40, 1.0, v40
    v_add_f32 v41, 1.0, v41
    v_add_f32 v42, 1.0, v42
    v_add_f32 v43, 1.0, v43
    v_rcp_f32 v40, v40
    v_rcp_f32 v41, v41
    v_rcp_f32 v42, v42
    v_rcp_f32 v43, v43
    v_mul_f32 v32, v32, v40
    v_mul_f32 v33, v33, v41
    v_mul_f32 v34, v34, v42
    v_mul_f32 v35, v35, v43
    v_cvt_pk_bf16_f32 v32, v32, v32
    v_cvt_pk_bf16_f32 v33, v33, v33
    v_cvt_pk_bf16_f32 v34, v34, v34
    v_cvt_pk_bf16_f32 v35, v35, v35
    v_lshlrev_b32 v32, 16, v32
    v_lshlrev_b32 v33, 16, v33
    v_lshlrev_b32 v34, 16, v34
    v_lshlrev_b32 v35, 16, v35
    v_mul_f32 v32, v32, v36
    v_mul_f32 v33, v33, v37
    v_mul_f32 v34, v34, v38
    v_mul_f32 v35, v35, v39
    v_cvt_pk_bf16_f32 v32, v32, v32
    v_cvt_pk_bf16_f32 v33, v33, v33
    v_cvt_pk_bf16_f32 v34, v34, v34
    v_cvt_pk_bf16_f32 v35, v35, v35
    v_cmp_gt_u32 vcc, 56, v0
    s_nop 0
    s_and_saveexec_b64 s[44:45], vcc
    ds_write_b16 v11, v32 offset:0
    ds_write_b16 v11, v33 offset:64
    ds_write_b16 v11, v34 offset:128
    ds_write_b16 v11, v35 offset:192
    s_mov_b64 exec, s[44:45]
    ds_read_b128 v[64:67], v9
    s_waitcnt lgkmcnt(0)
    v_perm_b32 v136, v20, v16, s52
    v_perm_b32 v137, v28, v24, s52
    v_perm_b32 v138, v148, v144, s52
    v_perm_b32 v139, v156, v152, s52
    s_nop 1
    v_mfma_f32_16x16x32_bf16 v[104:107], v[64:67], v[136:139], 0
    v_perm_b32 v140, v20, v16, s53
    v_perm_b32 v141, v28, v24, s53
    v_perm_b32 v142, v148, v144, s53
    v_perm_b32 v143, v156, v152, s53
    s_nop 1
    v_mfma_f32_16x16x32_bf16 v[108:111], v[64:67], v[140:143], 0
    v_perm_b32 v136, v21, v17, s52
    v_perm_b32 v137, v29, v25, s52
    v_perm_b32 v138, v149, v145, s52
    v_perm_b32 v139, v157, v153, s52
    s_nop 1
    v_mfma_f32_16x16x32_bf16 v[112:115], v[64:67], v[136:139], 0
    v_perm_b32 v140, v21, v17, s53
    v_perm_b32 v141, v29, v25, s53
    v_perm_b32 v142, v149, v145, s53
    v_perm_b32 v143, v157, v153, s53
    s_nop 1
    v_mfma_f32_16x16x32_bf16 v[116:119], v[64:67], v[140:143], 0
    v_perm_b32 v136, v22, v18, s52
    v_perm_b32 v137, v30, v26, s52
    v_perm_b32 v138, v150, v146, s52
    v_perm_b32 v139, v158, v154, s52
    s_nop 1
    v_mfma_f32_16x16x32_bf16 v[120:123], v[64:67], v[136:139], 0
    v_perm_b32 v140, v22, v18, s53
    v_perm_b32 v141, v30, v26, s53
    v_perm_b32 v142, v150, v146, s53
    v_perm_b32 v143, v158, v154, s53
    s_nop 1
    v_mfma_f32_16x16x32_bf16 v[124:127], v[64:67], v[140:143], 0
    v_perm_b32 v136, v23, v19, s52
    v_perm_b32 v137, v31, v27, s52
    v_perm_b32 v138, v151, v147, s52
    v_perm_b32 v139, v159, v155, s52
    s_nop 1
    v_mfma_f32_16x16x32_bf16 v[128:131], v[64:67], v[136:139], 0
    v_perm_b32 v140, v23, v19, s53
    v_perm_b32 v141, v31, v27, s53
    v_perm_b32 v142, v151, v147, s53
    v_perm_b32 v143, v159, v155, s53
    s_nop 1
    v_mfma_f32_16x16x32_bf16 v[132:135], v[64:67], v[140:143], 0
    s_mov_b32 s44, s75
    v_and_b32 v4, 1, v5
    v_lshlrev_b32 v4, 11, v4
    v_lshl_add_u32 v4, v7, 5, v4
    v_lshrrev_b32 v8, 1, v5
    v_lshl_add_u32 v4, v8, 4, v4
    v_add_u32 v4, s44, v4
    v_cmp_gt_u32 vcc, 32, v0

    s_nop 1
    v_cndmask_b32 v72, v120, v104, vcc
    v_cndmask_b32 v73, v124, v108, vcc
    v_cndmask_b32 v74, v128, v112, vcc
    v_cndmask_b32 v75, v132, v116, vcc
    ds_write_b128 v4, v[72:75] offset:0
    v_cndmask_b32 v76, v121, v105, vcc
    v_cndmask_b32 v77, v125, v109, vcc
    v_cndmask_b32 v78, v129, v113, vcc
    v_cndmask_b32 v79, v133, v117, vcc
    ds_write_b128 v4, v[76:79] offset:512
    v_cndmask_b32 v80, v122, v106, vcc
    v_cndmask_b32 v81, v126, v110, vcc
    v_cndmask_b32 v82, v130, v114, vcc
    v_cndmask_b32 v83, v134, v118, vcc
    ds_write_b128 v4, v[80:83] offset:1024
    v_cndmask_b32 v84, v123, v107, vcc
    v_cndmask_b32 v85, v127, v111, vcc
    v_cndmask_b32 v86, v131, v115, vcc
    v_cndmask_b32 v87, v135, v119, vcc
    ds_write_b128 v4, v[84:87] offset:1536
    v_mov_b32 v4, 1
    s_mov_b64 exec, 1
    ds_write_b32 v10, v4 offset:80
    s_mov_b64 exec, -1
    ds_read_b32 v12, v13 offset:80
FW_145:
    s_waitcnt lgkmcnt(0)
    v_cmp_gt_u32 vcc, 1, v12
    s_cbranch_vccz FO_146
    s_sleep 1
    ds_read_b32 v12, v13 offset:80
    s_branch FW_145
FO_146:
    s_lshl_b32 s44, s3, 10
    s_add_u32 s44, s44, 32768
    v_add_u32_e64 v4, s44, v3
    ds_read_b32 v32, v4 offset:0
    ds_read_b32 v33, v4 offset:256
    ds_read_b32 v34, v4 offset:512
    ds_read_b32 v35, v4 offset:768
    ds_read_b32 v36, v4 offset:4096
    ds_read_b32 v37, v4 offset:4352
    ds_read_b32 v38, v4 offset:4608
    ds_read_b32 v39, v4 offset:4864
    ds_read_b32 v40, v4 offset:32768
    ds_read_b32 v41, v4 offset:33024
    ds_read_b32 v42, v4 offset:33280
    ds_read_b32 v43, v4 offset:33536
    ds_read_b32 v44, v4 offset:36864
    ds_read_b32 v45, v4 offset:37120
    ds_read_b32 v46, v4 offset:37376
    s_waitcnt lgkmcnt(8)
    ds_read_b32 v47, v4 offset:37632
    s_lshl_b32 s44, s3, 13
    s_lshl_b32 s45, s39, 9
    s_add_u32 s44, s44, s45
    s_add_u32 s44, s44, 135168
    s_add_u32 s45, s44, 4096
    s_lshl_b32 s46, s39, 9
    s_waitcnt lgkmcnt(0)

    s_add_u32 s56, s46, 0x845000
    s_add_u32 s56, s72, s56
    s_addc_u32 s57, s73, 0
    v_add_f32 v32, v32, v36
    v_add_f32 v40, v40, v44
    v_add_f32 v33, v33, v37
    v_add_f32 v41, v41, v45
    v_add_f32 v34, v34, v38
    v_add_f32 v42, v42, v46
    v_add_f32 v35, v35, v39
    v_add_f32 v43, v43, v47
    v_add_f32 v32, v32, v40
    buffer_atomic_add_f32 v32, v3, s[24:27], s44 offen offset:0
    v_add_f32 v33, v33, v41
    buffer_atomic_add_f32 v33, v3, s[24:27], s44 offen offset:256
    v_add_f32 v34, v34, v42
    buffer_atomic_add_f32 v34, v3, s[24:27], s45 offen offset:0
    v_add_f32 v35, v35, v43
    buffer_atomic_add_f32 v35, v3, s[24:27], s45 offen offset:256
    v_mov_b32 v4, 159140
    v_mov_b32 v8, 1
    s_waitcnt vmcnt(0)
    s_mov_b64 exec, 1
    ds_add_rtn_u32 v9, v4, v8
    s_waitcnt lgkmcnt(0)
    v_readfirstlane_b32 s44, v9
    s_mov_b64 exec, -1
    s_cmp_lg_u32 s44, 3
    s_cbranch_scc1 F_ye
    s_mov_b32 s44, 1
    s_atomic_add s44, s[56:57], 0
    s_atomic_add s44, s[56:57], 0x80
    s_atomic_add s44, s[56:57], 0x100
    s_atomic_add s44, s[56:57], 0x180
F_ye:

    s_endpgm
F_codeend:
.section .rodata,"a"
.p2align 6
.amdhsa_kernel parallel_sum__linear_attn_block__moe_arch_mod__prompt_kernel
  .amdhsa_next_free_vgpr 168
  .amdhsa_next_free_sgpr 98
  .amdhsa_accum_offset 168
  .amdhsa_group_segment_fixed_size 0
  .amdhsa_kernarg_size 88
  .amdhsa_user_sgpr_count 2
  .amdhsa_user_sgpr_kernarg_segment_ptr 1
  .amdhsa_system_sgpr_workgroup_id_x 1
  .amdhsa_float_denorm_mode_32 3
  .amdhsa_float_denorm_mode_16_64 3
.end_amdhsa_kernel
```

```asm
; @launch grid=(256,1,1) block=(768,1,1) lds=163840
.amdgcn_target "amdgcn-amd-amdhsa--gfx950"
.text
.globl parallel_sum__linear_attn_block__moe_arch_mod__prompt_kernel
.p2align 12
.p2align 8
.type parallel_sum__linear_attn_block__moe_arch_mod__prompt_kernel,@function
parallel_sum__linear_attn_block__moe_arch_mod__prompt_kernel:
    s_load_dwordx4 s[4:7], s[0:1], 0
    s_load_dwordx2 s[8:9], s[0:1], 16
    s_load_dwordx8 s[60:67], s[0:1], 32
    s_load_dwordx4 s[68:71], s[0:1], 64
    s_load_dwordx2 s[72:73], s[0:1], 80
    s_cmp_ge_u32 s2, 256
    s_cbranch_scc1 F_end
    v_lshrrev_b32 v1, 6, v0
    v_and_b32 v0, 63, v0
    s_and_b32 s30, s2, 7
    v_readfirstlane_b32 s3, v1
    s_lshr_b32 s31, s2, 3
    s_and_b32 s36, s30, 1
    s_lshl_b32 s32, s36, 3
    s_and_b32 s35, s31, 7
    s_add_u32 s32, s32, s35
    s_lshr_b32 s37, s30, 1
    s_lshl_b32 s33, s37, 2
    s_lshr_b32 s34, s31, 3
    s_add_u32 s33, s33, s34
    s_add_u32 s10, s33, 0
    s_and_b32 s10, s10, 15
    s_add_u32 s11, s35, s34
    s_and_b32 s11, s11, 3
    s_and_b32 s28, s32, 11
    s_and_b32 s29, s37, 1
    s_lshl_b32 s29, s29, 2
    s_add_u32 s28, s28, s29
    s_lshr_b32 s29, s37, 1
    s_lshl_b32 s29, s29, 3
    s_and_b32 s38, s35, 4
    s_add_u32 s29, s29, s38
    s_add_u32 s38, s34, 1
    s_and_b32 s38, s38, 3
    s_add_u32 s29, s29, s38

    s_lshl_b32 s11, s34, 1
    s_add_u32 s11, s11, s35
    s_and_b32 s11, s11, 7
    s_mul_i32 s89, s36, 8
    s_mul_i32 s38, s37, 2
    s_add_u32 s89, s89, s38

    s_mov_b32 s94, 0x53176420
    s_mov_b32 s95, 0xdb9fca8e
    s_cmp_eq_u32 s11, 1
    s_cselect_b32 s94, 0x42067531, s94
    s_cselect_b32 s95, 0xca8edb9f, s95
    s_cmp_eq_u32 s11, 2
    s_cselect_b32 s94, 0x53806412, s94
    s_cselect_b32 s95, 0xfdbeca97, s95
    s_cmp_eq_u32 s11, 3
    s_cselect_b32 s94, 0x42917503, s94
    s_cselect_b32 s95, 0xecafdb86, s95
    s_cmp_eq_u32 s11, 4
    s_cselect_b32 s94, 0x5a120364, s94
    s_cselect_b32 s95, 0xfd9ecb87, s95
    s_cmp_eq_u32 s11, 5
    s_cselect_b32 s94, 0x4b031275, s94
    s_cselect_b32 s95, 0xec8fda96, s95
    s_cmp_eq_u32 s11, 6
    s_cselect_b32 s94, 0xc3145206, s94
    s_cselect_b32 s95, 0xfb9eda87, s95
    s_cmp_eq_u32 s11, 7
    s_cselect_b32 s94, 0xd2054317, s94
    s_cselect_b32 s95, 0xea8fcb96, s95
    s_cmp_ge_u32 s3, 8
    s_cbranch_scc1 F_aux
    s_cmp_ge_u32 s3, 4
    s_cbranch_scc1 F_nl
    v_lshrrev_b32 v2, 3, v0
    v_and_b32 v3, 7, v0
    v_lshrrev_b32 v4, 1, v2
    v_xor_b32 v5, v3, v4
    v_xor_b32 v6, 4, v5
    v_lshlrev_b32 v5, 4, v5
    v_lshlrev_b32 v6, 4, v6
    v_lshlrev_b32 v7, 11, v2
    v_add_u32 v5, v5, v7
    v_add_u32 v6, v6, v7
    v_and_b32 v4, 1, v4
    v_lshlrev_b32 v4, 1, v4
    v_xor_b32 v8, v3, v4
    v_xor_b32 v9, 4, v8
    v_lshlrev_b32 v8, 4, v8
    v_lshlrev_b32 v9, 4, v9
    v_mul_u32_u24 v7, 6144, v2
    v_add_u32 v8, v8, v7
    v_add_u32 v9, v9, v7
    v_add_u32 v9, 49152, v9
    s_lshl_b32 s36, s32, 18
    s_lshl_b32 s37, s3, 16
    s_add_u32 s36, s36, s37
    s_lshl_b32 s38, s33, 7
    s_mul_i32 s37, s3, 98304
    s_add_u32 s38, s38, s37
    s_lshl_b32 s47, s10, 7
    s_add_u32 s47, s47, s37
    s_lshl_b32 s44, s3, 12
    s_lshl_b32 s45, s3, 11
    s_add_u32 s43, s45, 1024
    s_mov_b32 s14, 4194304
    s_mov_b32 s15, 0x20000
    s_mov_b32 s18, 6291456
    s_mov_b32 s19, 0x20000
    s_waitcnt lgkmcnt(0)
    s_mov_b32 s12, s4
    s_mov_b32 s13, s5
    s_mov_b32 s16, s6
    s_mov_b32 s17, s7

    s_setprio 3
    s_bfe_u32 s40, s94, 0x40000
    s_add_u32 s40, s89, s40
    s_and_b32 s40, s40, 15
    s_mul_i32 s41, s40, 393216
    s_lshl_b32 s40, s40, 7
    s_add_u32 s40, s40, s36
    s_add_u32 s42, s41, s47
    s_add_u32 s41, s41, s38
    s_add_u32 m0, s44, 0
    s_add_u32 s46, s40, 0
    s_nop 0
    buffer_load_dwordx4 v5, s[12:15], s46 offen lds
    s_add_u32 m0, s44, 1024
    s_add_u32 s46, s40, 16384
    buffer_load_dwordx4 v6, s[12:15], s46 offen lds
    s_add_u32 m0, s44, 2048
    s_add_u32 s46, s40, 32768
    buffer_load_dwordx4 v5, s[12:15], s46 offen lds
    s_add_u32 m0, s44, 3072
    s_add_u32 s46, s40, 49152
    buffer_load_dwordx4 v6, s[12:15], s46 offen lds
    s_add_u32 m0, s45, 65536
    s_add_u32 s46, s41, 2048
    buffer_load_dwordx4 v8, s[16:19], s46 offen lds
    s_add_u32 m0, s43, 65536
    s_add_u32 s46, s41, 2048
    buffer_load_dwordx4 v9, s[16:19], s46 offen lds
    s_add_u32 m0, s45, 73728
    s_add_u32 s46, s41, 4096
    buffer_load_dwordx4 v8, s[16:19], s46 offen lds
    s_add_u32 m0, s43, 73728
    s_add_u32 s46, s41, 4096
    buffer_load_dwordx4 v9, s[16:19], s46 offen lds
    s_lshl_b32 s51, s32, 4
    s_add_u32 s51, s51, s33
    s_lshl_b32 s51, s51, 14
    s_add_u32 s51, s51, s45
    v_lshlrev_b32 v165, 4, v0
    s_mov_b32 s20, s60
    s_mov_b32 s21, s61
    s_mov_b32 s22, 0x800
    s_mov_b32 s23, 0x00020000
    s_add_u32 m0, s45, 81920
    s_add_u32 s46, s51, 0
    buffer_load_dwordx4 v165, s[12:15], s46 offen lds
    s_add_u32 m0, s45, 82944
    s_add_u32 s46, s51, 1024
    buffer_load_dwordx4 v165, s[12:15], s46 offen lds
    s_and_b32 s46, s3, 1
    s_lshl_b32 s46, s46, 10
    s_add_u32 m0, s46, 161792
    s_nop 0
    s_nop 0
    buffer_load_dwordx4 v165, s[20:23], s46 offen lds
    s_add_u32 m0, s45, 90112
    s_add_u32 s46, s51, 8192
    buffer_load_dwordx4 v165, s[12:15], s46 offen lds
    s_add_u32 m0, s45, 91136
    s_add_u32 s46, s51, 9216
    buffer_load_dwordx4 v165, s[12:15], s46 offen lds
    s_add_u32 m0, s45, 147456
    s_nop 0
    buffer_load_dwordx4 v8, s[16:19], s42 offen lds
    s_add_u32 m0, s43, 147456
    s_nop 0
    buffer_load_dwordx4 v9, s[16:19], s42 offen lds
    v_and_b32 v1, 15, v0
    v_lshrrev_b32 v7, 4, v0
    v_lshrrev_b32 v3, 1, v1
    v_xor_b32 v3, v3, v7
    v_lshlrev_b32 v3, 4, v3
    v_lshlrev_b32 v1, 7, v1
    v_add3_u32 v2, v1, v3, s44
    v_xor_b32 v3, 64, v2
    v_add_u32 v14, 0x10000, v2
    v_add_u32 v15, 0x10000, v3
    v_bfe_u32 v1, v0, 2, 2
    v_lshl_add_u32 v4, v7, 3, v1
    v_lshrrev_b32 v1, 1, v1
    v_and_b32 v7, 1, v7
    v_lshl_add_u32 v1, v7, 1, v1
    v_lshlrev_b32 v1, 5, v1
    v_lshl_add_u32 v1, v4, 7, v1
    v_and_b32 v7, 3, v0
    v_lshl_add_u32 v1, v7, 3, v1
    v_add_u32 v10, 90112, v1
    v_xor_b32 v11, 32, v10
    v_xor_b32 v12, 64, v10
    v_xor_b32 v13, 96, v10
    v_lshlrev_b32 v1, 2, v7
    v_add_u32 v1, 159040, v1
    s_lshl_b32 s50, s3, 2
    s_add_u32 s50, s50, 159040
    v_mov_b32 v4, s50
    v_mov_b32 v164, 1

    s_waitcnt vmcnt(7)
    s_barrier
    s_bfe_u32 s40, s94, 0x40004
    s_add_u32 s40, s89, s40
    s_and_b32 s40, s40, 15
    s_mul_i32 s41, s40, 393216
    s_lshl_b32 s40, s40, 7
    s_add_u32 s40, s40, s36
    s_add_u32 s42, s41, s47
    s_add_u32 s41, s41, s38
    s_add_u32 m0, s44, 16384
    s_add_u32 s46, s40, 0
    buffer_load_dwordx4 v5, s[12:15], s46 offen lds
    ds_read_b128 v[48:51], v2 offset:0
    s_add_u32 m0, s44, 17408
    s_add_u32 s46, s40, 16384
    buffer_load_dwordx4 v6, s[12:15], s46 offen lds
    ds_read_b128 v[52:55], v2 offset:2048
    s_add_u32 m0, s44, 18432
    s_add_u32 s46, s40, 32768
    buffer_load_dwordx4 v5, s[12:15], s46 offen lds
    ds_read_b128 v[56:59], v3 offset:0
    s_add_u32 m0, s44, 19456
    s_add_u32 s46, s40, 49152
    buffer_load_dwordx4 v6, s[12:15], s46 offen lds
    ds_read_b128 v[60:63], v3 offset:2048
    s_add_u32 m0, s45, 98304
    s_add_u32 s46, s41, 2048
    buffer_load_dwordx4 v8, s[16:19], s46 offen lds
    s_add_u32 m0, s43, 98304
    s_add_u32 s46, s41, 2048
    buffer_load_dwordx4 v9, s[16:19], s46 offen lds
    s_add_u32 m0, s45, 106496
    s_add_u32 s46, s41, 4096
    buffer_load_dwordx4 v8, s[16:19], s46 offen lds
    s_add_u32 m0, s43, 106496
    s_add_u32 s46, s41, 4096
    buffer_load_dwordx4 v9, s[16:19], s46 offen lds
    s_bfe_u32 s40, s94, 0x40008
    s_add_u32 s40, s89, s40
    s_and_b32 s40, s40, 15
    s_mul_i32 s41, s40, 393216
    s_lshl_b32 s40, s40, 7
    s_add_u32 s40, s40, s36
    s_add_u32 s42, s41, s47
    s_add_u32 s41, s41, s38
    s_add_u32 m0, s44, 32768
    s_add_u32 s46, s40, 0
    buffer_load_dwordx4 v5, s[12:15], s46 offen lds
    s_add_u32 m0, s44, 33792
    s_add_u32 s46, s40, 16384
    buffer_load_dwordx4 v6, s[12:15], s46 offen lds
    s_add_u32 m0, s44, 34816
    s_add_u32 s46, s40, 32768
    buffer_load_dwordx4 v5, s[12:15], s46 offen lds
    s_waitcnt vmcnt(3) lgkmcnt(0)
    s_barrier
    s_nop 0
    s_add_u32 m0, s44, 35840
    s_add_u32 s46, s40, 49152
    buffer_load_dwordx4 v6, s[12:15], s46 offen lds
    ds_read_b64_tr_b16 v[64:65], v10 offset:57344
    ds_read_b64_tr_b16 v[66:67], v10 offset:57856
    s_add_u32 m0, s45, 114688
    s_add_u32 s46, s41, 2048
    buffer_load_dwordx4 v8, s[16:19], s46 offen lds
    ds_read_b128 v[68:71], v2 offset:16384
    s_add_u32 m0, s43, 114688
    s_add_u32 s46, s41, 2048
    buffer_load_dwordx4 v9, s[16:19], s46 offen lds
    ds_read_b64_tr_b16 v[72:73], v11 offset:57344
    ds_read_b64_tr_b16 v[74:75], v11 offset:57856
    s_add_u32 m0, s45, 122880
    s_add_u32 s46, s41, 4096
    buffer_load_dwordx4 v8, s[16:19], s46 offen lds
    ds_read_b128 v[76:79], v2 offset:18432
    s_add_u32 m0, s43, 122880
    s_add_u32 s46, s41, 4096
    buffer_load_dwordx4 v9, s[16:19], s46 offen lds
    ds_read_b64_tr_b16 v[80:81], v12 offset:57344
    ds_read_b64_tr_b16 v[82:83], v12 offset:57856
    s_bfe_u32 s40, s94, 0x40004
    s_add_u32 s40, s89, s40
    s_and_b32 s40, s40, 15
    s_mul_i32 s41, s40, 393216
    s_lshl_b32 s40, s40, 7
    s_add_u32 s40, s40, s36
    s_add_u32 s42, s41, s47
    s_add_u32 s41, s41, s38
    s_add_u32 m0, s45, 139264
    s_nop 0
    buffer_load_dwordx4 v8, s[16:19], s42 offen lds
    ds_read_b128 v[84:87], v3 offset:16384
    s_add_u32 m0, s43, 139264
    s_nop 0
    buffer_load_dwordx4 v9, s[16:19], s42 offen lds
    ds_read_b64_tr_b16 v[88:89], v13 offset:57344
    ds_read_b64_tr_b16 v[90:91], v13 offset:57856
    s_bfe_u32 s40, s94, 0x4000c
    s_add_u32 s40, s89, s40
    s_and_b32 s40, s40, 15
    s_mul_i32 s41, s40, 393216
    s_lshl_b32 s40, s40, 7
    s_add_u32 s40, s40, s36
    s_add_u32 s42, s41, s47
    s_add_u32 s41, s41, s38
    s_add_u32 m0, s44, 49152
    s_add_u32 s46, s40, 0
    s_nop 0
    buffer_load_dwordx4 v5, s[12:15], s46 offen lds
    ds_read_b128 v[92:95], v3 offset:18432
    s_add_u32 m0, s44, 50176
    s_add_u32 s46, s40, 16384
    buffer_load_dwordx4 v6, s[12:15], s46 offen lds
    s_add_u32 m0, s44, 51200
    s_add_u32 s46, s40, 32768
    buffer_load_dwordx4 v5, s[12:15], s46 offen lds
    s_add_u32 m0, s44, 52224
    s_add_u32 s46, s40, 49152
    buffer_load_dwordx4 v6, s[12:15], s46 offen lds
    s_waitcnt vmcnt(4) lgkmcnt(0)
    s_barrier
    s_add_u32 m0, s45, 131072
    s_add_u32 s46, s41, 2048
    buffer_load_dwordx4 v8, s[16:19], s46 offen lds
    v_mfma_f32_16x16x32_bf16 v[16:19], v[64:67], v[48:51], 0
    ds_read_b64_tr_b16 v[96:97], v10 offset:61440
    ds_read_b64_tr_b16 v[98:99], v10 offset:61952
    s_add_u32 m0, s43, 131072
    s_add_u32 s46, s41, 2048
    buffer_load_dwordx4 v9, s[16:19], s46 offen lds
    v_mfma_f32_16x16x32_bf16 v[32:35], v[64:67], v[52:55], 0
    ds_read_b128 v[100:103], v2 offset:32768
    s_add_u32 m0, s45, 65536
    s_add_u32 s46, s41, 4096
    buffer_load_dwordx4 v8, s[16:19], s46 offen lds
    v_mfma_f32_16x16x32_bf16 v[20:23], v[72:75], v[48:51], 0
    ds_read_b64_tr_b16 v[104:105], v11 offset:61440
    ds_read_b64_tr_b16 v[106:107], v11 offset:61952
    s_add_u32 m0, s43, 65536
    s_add_u32 s46, s41, 4096
    buffer_load_dwordx4 v9, s[16:19], s46 offen lds
    v_mfma_f32_16x16x32_bf16 v[36:39], v[72:75], v[52:55], 0
    ds_read_b128 v[108:111], v2 offset:34816
    s_bfe_u32 s40, s94, 0x40008
    s_add_u32 s40, s89, s40
    s_and_b32 s40, s40, 15
    s_mul_i32 s41, s40, 393216
    s_lshl_b32 s40, s40, 7
    s_add_u32 s40, s40, s36
    s_add_u32 s42, s41, s47
    s_add_u32 s41, s41, s38
    s_add_u32 m0, s45, 106496
    s_nop 0
    buffer_load_dwordx4 v8, s[16:19], s42 offen lds
    v_mfma_f32_16x16x32_bf16 v[24:27], v[80:83], v[48:51], 0
    ds_read_b64_tr_b16 v[112:113], v12 offset:61440
    ds_read_b64_tr_b16 v[114:115], v12 offset:61952
    s_add_u32 m0, s43, 106496
    s_nop 0
    buffer_load_dwordx4 v9, s[16:19], s42 offen lds
    v_mfma_f32_16x16x32_bf16 v[40:43], v[80:83], v[52:55], 0
    ds_read_b128 v[116:119], v3 offset:32768
    s_bfe_u32 s40, s94, 0x40010
    s_add_u32 s40, s89, s40
    s_and_b32 s40, s40, 15
    s_mul_i32 s41, s40, 393216
    s_lshl_b32 s40, s40, 7
    s_add_u32 s40, s40, s36
    s_add_u32 s42, s41, s47
    s_add_u32 s41, s41, s38
    s_add_u32 m0, s44, 0
    s_add_u32 s46, s40, 0
    buffer_load_dwordx4 v5, s[12:15], s46 offen lds
    v_mfma_f32_16x16x32_bf16 v[28:31], v[88:91], v[48:51], 0
    ds_read_b64_tr_b16 v[120:121], v13 offset:61440
    ds_read_b64_tr_b16 v[122:123], v13 offset:61952
    s_add_u32 m0, s44, 1024
    s_add_u32 s46, s40, 16384
    buffer_load_dwordx4 v6, s[12:15], s46 offen lds
    v_mfma_f32_16x16x32_bf16 v[44:47], v[88:91], v[52:55], 0
    ds_read_b128 v[124:127], v3 offset:34816
    s_add_u32 m0, s44, 2048
    s_add_u32 s46, s40, 32768
    buffer_load_dwordx4 v5, s[12:15], s46 offen lds
    ds_read_b64_tr_b16 v[128:129], v10 offset:49152
    ds_read_b64_tr_b16 v[130:131], v10 offset:49664
    s_add_u32 m0, s44, 3072
    s_add_u32 s46, s40, 49152
    buffer_load_dwordx4 v6, s[12:15], s46 offen lds
    ds_read_b64_tr_b16 v[132:133], v11 offset:49152
    s_waitcnt lgkmcnt(8)
    s_nop 0
    ds_read_b64_tr_b16 v[134:135], v11 offset:49664
    s_add_u32 m0, s45, 73728
    s_add_u32 s46, s41, 2048
    buffer_load_dwordx4 v8, s[16:19], s46 offen lds
    ds_read_b64_tr_b16 v[136:137], v12 offset:49152
    ds_read_b64_tr_b16 v[138:139], v12 offset:49664
    ds_read_b64_tr_b16 v[140:141], v13 offset:49152
    ds_read_b64_tr_b16 v[142:143], v13 offset:49664
    s_waitcnt vmcnt(5) lgkmcnt(0)
    s_barrier
    s_add_u32 m0, s43, 73728
    s_add_u32 s46, s41, 2048
    buffer_load_dwordx4 v9, s[16:19], s46 offen lds
    v_mfma_f32_16x16x32_bf16 v[16:19], v[96:99], v[56:59], v[16:19]
    ds_read_b64_tr_b16 v[144:145], v10 offset:53248
    ds_read_b64_tr_b16 v[146:147], v10 offset:53760
    s_add_u32 m0, s45, 81920
    s_add_u32 s46, s41, 4096
    buffer_load_dwordx4 v8, s[16:19], s46 offen lds
    v_mfma_f32_16x16x32_bf16 v[32:35], v[96:99], v[60:63], v[32:35]
    ds_read_b128 v[148:151], v2 offset:49152
    s_add_u32 m0, s43, 81920
    s_add_u32 s46, s41, 4096
    buffer_load_dwordx4 v9, s[16:19], s46 offen lds
    v_mfma_f32_16x16x32_bf16 v[20:23], v[104:107], v[56:59], v[20:23]
    ds_read_b64_tr_b16 v[152:153], v11 offset:53248
    ds_read_b64_tr_b16 v[154:155], v11 offset:53760
    s_bfe_u32 s40, s94, 0x40014
    s_add_u32 s40, s89, s40
    s_and_b32 s40, s40, 15
    s_mul_i32 s41, s40, 393216
    s_lshl_b32 s40, s40, 7
    s_add_u32 s40, s40, s36
    s_add_u32 s42, s41, s47
    s_add_u32 s41, s41, s38
    s_add_u32 m0, s44, 16384
    s_add_u32 s46, s40, 0
    s_nop 0
    buffer_load_dwordx4 v5, s[12:15], s46 offen lds
    v_mfma_f32_16x16x32_bf16 v[36:39], v[104:107], v[60:63], v[36:39]
    ds_read_b128 v[156:159], v2 offset:51200
    s_add_u32 m0, s44, 17408
    s_add_u32 s46, s40, 16384
    buffer_load_dwordx4 v6, s[12:15], s46 offen lds
    v_mfma_f32_16x16x32_bf16 v[24:27], v[112:115], v[56:59], v[24:27]
    ds_read_b64_tr_b16 v[160:161], v12 offset:53248
    ds_read_b64_tr_b16 v[162:163], v12 offset:53760
    s_add_u32 m0, s44, 18432
    s_add_u32 s46, s40, 32768
    buffer_load_dwordx4 v5, s[12:15], s46 offen lds
    v_mfma_f32_16x16x32_bf16 v[40:43], v[112:115], v[60:63], v[40:43]
    ds_read_b128 v[64:67], v3 offset:49152
    s_add_u32 m0, s44, 19456
    s_add_u32 s46, s40, 49152
    buffer_load_dwordx4 v6, s[12:15], s46 offen lds
    v_mfma_f32_16x16x32_bf16 v[28:31], v[120:123], v[56:59], v[28:31]
    ds_read_b64_tr_b16 v[72:73], v13 offset:53248
    ds_read_b64_tr_b16 v[74:75], v13 offset:53760
    s_add_u32 m0, s45, 90112
    s_add_u32 s46, s41, 2048
    buffer_load_dwordx4 v8, s[16:19], s46 offen lds
    v_mfma_f32_16x16x32_bf16 v[44:47], v[120:123], v[60:63], v[44:47]
    ds_read_b128 v[80:83], v3 offset:51200
    s_add_u32 m0, s43, 90112
    s_add_u32 s46, s41, 2048
    buffer_load_dwordx4 v9, s[16:19], s46 offen lds
    v_mfma_f32_16x16x32_bf16 v[16:19], v[128:131], v[68:71], v[16:19]
    ds_read_b64_tr_b16 v[48:49], v10 offset:16384
    ds_read_b64_tr_b16 v[50:51], v10 offset:16896
    s_add_u32 m0, s45, 98304
    s_add_u32 s46, s41, 4096
    buffer_load_dwordx4 v8, s[16:19], s46 offen lds
    v_mfma_f32_16x16x32_bf16 v[32:35], v[128:131], v[76:79], v[32:35]
    ds_read_b64_tr_b16 v[88:89], v11 offset:16384
    s_waitcnt lgkmcnt(8)
    s_nop 0
    ds_read_b64_tr_b16 v[90:91], v11 offset:16896
    s_add_u32 m0, s43, 98304
    s_add_u32 s46, s41, 4096
    buffer_load_dwordx4 v9, s[16:19], s46 offen lds
    v_mfma_f32_16x16x32_bf16 v[20:23], v[132:135], v[68:71], v[20:23]
    ds_read_b64_tr_b16 v[52:53], v12 offset:16384
    ds_read_b64_tr_b16 v[54:55], v12 offset:16896
    v_mfma_f32_16x16x32_bf16 v[36:39], v[132:135], v[76:79], v[36:39]
    ds_read_b64_tr_b16 v[96:97], v13 offset:16384
    ds_read_b64_tr_b16 v[98:99], v13 offset:16896
    v_mfma_f32_16x16x32_bf16 v[24:27], v[136:139], v[68:71], v[24:27]
    v_mfma_f32_16x16x32_bf16 v[40:43], v[136:139], v[76:79], v[40:43]
    v_mfma_f32_16x16x32_bf16 v[28:31], v[140:143], v[68:71], v[28:31]
    v_mfma_f32_16x16x32_bf16 v[44:47], v[140:143], v[76:79], v[44:47]
    s_waitcnt vmcnt(8) lgkmcnt(0)
    s_barrier
    s_bfe_u32 s40, s94, 0x4000c
    s_add_u32 s40, s89, s40
    s_and_b32 s40, s40, 15
    s_mul_i32 s41, s40, 393216
    s_lshl_b32 s40, s40, 7
    s_add_u32 s40, s40, s36
    s_add_u32 s42, s41, s47
    s_add_u32 s41, s41, s38
    s_add_u32 m0, s45, 147456
    s_nop 0
    buffer_load_dwordx4 v8, s[16:19], s42 offen lds
    v_mfma_f32_16x16x32_bf16 v[16:19], v[144:147], v[84:87], v[16:19]
    ds_read_b64_tr_b16 v[104:105], v10 offset:20480
    ds_read_b64_tr_b16 v[106:107], v10 offset:20992
    s_add_u32 m0, s43, 147456
    s_nop 0
    buffer_load_dwordx4 v9, s[16:19], s42 offen lds
    v_mfma_f32_16x16x32_bf16 v[32:35], v[144:147], v[92:95], v[32:35]
    ds_read_b128 v[112:115], v2 offset:0
    s_bfe_u32 s40, s94, 0x40018
    s_add_u32 s40, s89, s40
    s_and_b32 s40, s40, 15
    s_mul_i32 s41, s40, 393216
    s_lshl_b32 s40, s40, 7
    s_add_u32 s40, s40, s36
    s_add_u32 s42, s41, s47
    s_add_u32 s41, s41, s38
    s_add_u32 m0, s44, 32768
    s_branch IW_s0
IW_w0:
    s_branch IW_r0
IW_s0:
    s_add_u32 s46, s40, 0
    s_nop 0
    buffer_load_dwordx4 v5, s[12:15], s46 offen lds
    v_mfma_f32_16x16x32_bf16 v[20:23], v[152:155], v[84:87], v[20:23]
    ds_read_b64_tr_b16 v[56:57], v11 offset:20480
    ds_read_b64_tr_b16 v[58:59], v11 offset:20992
    s_add_u32 m0, s44, 33792
    s_add_u32 s46, s40, 16384
    buffer_load_dwordx4 v6, s[12:15], s46 offen lds
    v_mfma_f32_16x16x32_bf16 v[36:39], v[152:155], v[92:95], v[36:39]
    ds_read_b128 v[120:123], v2 offset:2048
    s_add_u32 m0, s44, 34816
    s_add_u32 s46, s40, 32768
    buffer_load_dwordx4 v5, s[12:15], s46 offen lds
    v_mfma_f32_16x16x32_bf16 v[24:27], v[160:163], v[84:87], v[24:27]
    ds_read_b64_tr_b16 v[60:61], v12 offset:20480
    ds_read_b64_tr_b16 v[62:63], v12 offset:20992
    s_add_u32 m0, s44, 35840
    s_add_u32 s46, s40, 49152
    buffer_load_dwordx4 v6, s[12:15], s46 offen lds
    v_mfma_f32_16x16x32_bf16 v[40:43], v[160:163], v[92:95], v[40:43]
    ds_read_b128 v[128:131], v3 offset:0
    s_add_u32 m0, s45, 114688
    s_add_u32 s46, s41, 2048
    buffer_load_dwordx4 v8, s[16:19], s46 offen lds
    v_mfma_f32_16x16x32_bf16 v[28:31], v[72:75], v[84:87], v[28:31]
    ds_read_b64_tr_b16 v[132:133], v13 offset:20480
    ds_read_b64_tr_b16 v[134:135], v13 offset:20992
    s_add_u32 m0, s43, 114688
    s_add_u32 s46, s41, 2048
    buffer_load_dwordx4 v9, s[16:19], s46 offen lds
    v_mfma_f32_16x16x32_bf16 v[44:47], v[72:75], v[92:95], v[44:47]
    ds_read_b128 v[136:139], v3 offset:2048
    s_add_u32 m0, s45, 122880
    s_add_u32 s46, s41, 4096
    buffer_load_dwordx4 v8, s[16:19], s46 offen lds
    v_mfma_f32_16x16x32_bf16 v[16:19], v[48:51], v[100:103], v[16:19]
    s_add_u32 m0, s43, 122880
    s_add_u32 s46, s41, 4096
    buffer_load_dwordx4 v9, s[16:19], s46 offen lds
    v_mfma_f32_16x16x32_bf16 v[32:35], v[48:51], v[108:111], v[32:35]
    s_bfe_u32 s40, s94, 0x4001c
    s_add_u32 s40, s89, s40
    s_and_b32 s40, s40, 15
    s_mul_i32 s41, s40, 393216
    s_lshl_b32 s40, s40, 7
    s_add_u32 s40, s40, s36
    s_add_u32 s42, s41, s47
    s_add_u32 s41, s41, s38
    s_add_u32 m0, s44, 49152
    s_add_u32 s46, s40, 0
    buffer_load_dwordx4 v5, s[12:15], s46 offen lds
    v_mfma_f32_16x16x32_bf16 v[20:23], v[88:91], v[100:103], v[20:23]
    v_mfma_f32_16x16x32_bf16 v[36:39], v[88:91], v[108:111], v[36:39]
    v_mfma_f32_16x16x32_bf16 v[24:27], v[52:55], v[100:103], v[24:27]
    v_mfma_f32_16x16x32_bf16 v[40:43], v[52:55], v[108:111], v[40:43]
    v_mfma_f32_16x16x32_bf16 v[28:31], v[96:99], v[100:103], v[28:31]
    v_mfma_f32_16x16x32_bf16 v[44:47], v[96:99], v[108:111], v[44:47]
    s_waitcnt vmcnt(9) lgkmcnt(0)
    s_barrier
    s_nop 0
    s_add_u32 m0, s44, 50176
    s_add_u32 s46, s40, 16384
    buffer_load_dwordx4 v6, s[12:15], s46 offen lds
    v_mfma_f32_16x16x32_bf16 v[16:19], v[104:107], v[116:119], v[16:19]
    ds_read_b64_tr_b16 v[68:69], v10 offset:57344
    ds_read_b64_tr_b16 v[70:71], v10 offset:57856
    s_add_u32 m0, s44, 51200
    s_add_u32 s46, s40, 32768
    buffer_load_dwordx4 v5, s[12:15], s46 offen lds
    v_mfma_f32_16x16x32_bf16 v[32:35], v[104:107], v[124:127], v[32:35]
    ds_read_b128 v[140:143], v2 offset:16384
    s_add_u32 m0, s44, 52224
    s_add_u32 s46, s40, 49152
    buffer_load_dwordx4 v6, s[12:15], s46 offen lds
    v_mfma_f32_16x16x32_bf16 v[20:23], v[56:59], v[116:119], v[20:23]
    ds_read_b64_tr_b16 v[76:77], v11 offset:57344
    ds_read_b64_tr_b16 v[78:79], v11 offset:57856
    s_add_u32 m0, s45, 65536
    s_add_u32 s46, s41, 2048
    buffer_load_dwordx4 v8, s[16:19], s46 offen lds
    v_mfma_f32_16x16x32_bf16 v[36:39], v[56:59], v[124:127], v[36:39]
    ds_read_b128 v[144:147], v2 offset:18432
    s_add_u32 m0, s43, 65536
    s_add_u32 s46, s41, 2048
    buffer_load_dwordx4 v9, s[16:19], s46 offen lds
    v_mfma_f32_16x16x32_bf16 v[24:27], v[60:63], v[116:119], v[24:27]
    ds_read_b64_tr_b16 v[152:153], v12 offset:57344
    ds_read_b64_tr_b16 v[154:155], v12 offset:57856
    s_add_u32 m0, s45, 131072
    s_add_u32 s46, s41, 4096
    buffer_load_dwordx4 v8, s[16:19], s46 offen lds
    v_mfma_f32_16x16x32_bf16 v[40:43], v[60:63], v[124:127], v[40:43]
    ds_read_b128 v[160:163], v3 offset:16384
    s_add_u32 m0, s43, 131072
    s_add_u32 s46, s41, 4096
    buffer_load_dwordx4 v9, s[16:19], s46 offen lds
    v_mfma_f32_16x16x32_bf16 v[28:31], v[132:135], v[116:119], v[28:31]
    ds_read_b64_tr_b16 v[84:85], v13 offset:57344
    ds_read_b64_tr_b16 v[86:87], v13 offset:57856
    s_bfe_u32 s40, s94, 0x40010
    s_add_u32 s40, s89, s40
    s_and_b32 s40, s40, 15
    s_mul_i32 s41, s40, 393216
    s_lshl_b32 s40, s40, 7
    s_add_u32 s40, s40, s36
    s_add_u32 s42, s41, s47
    s_add_u32 s41, s41, s38
    s_add_u32 m0, s45, 139264
    s_nop 0
    buffer_load_dwordx4 v8, s[16:19], s42 offen lds
    v_mfma_f32_16x16x32_bf16 v[44:47], v[132:135], v[124:127], v[44:47]
    ds_read_b128 v[72:75], v3 offset:18432
    s_add_u32 m0, s43, 139264
    s_nop 0
    buffer_load_dwordx4 v9, s[16:19], s42 offen lds
    s_bfe_u32 s40, s95, 0x40000
    s_add_u32 s40, s89, s40
    s_and_b32 s40, s40, 15
    s_mul_i32 s41, s40, 393216
    s_lshl_b32 s40, s40, 7
    s_add_u32 s40, s40, s36
    s_add_u32 s42, s41, s47
    s_add_u32 s41, s41, s38
    s_add_u32 m0, s44, 0
    s_add_u32 s46, s40, 0
    buffer_load_dwordx4 v5, s[12:15], s46 offen lds
    s_add_u32 m0, s44, 1024
    s_add_u32 s46, s40, 16384
    buffer_load_dwordx4 v6, s[12:15], s46 offen lds
    s_waitcnt vmcnt(12) lgkmcnt(0)
    s_barrier
    s_add_u32 m0, s44, 2048
    s_add_u32 s46, s40, 32768
    buffer_load_dwordx4 v5, s[12:15], s46 offen lds
    v_mfma_f32_16x16x32_bf16 v[16:19], v[68:71], v[148:151], v[16:19]
    ds_read_b64_tr_b16 v[92:93], v10 offset:61440
    ds_read_b64_tr_b16 v[94:95], v10 offset:61952
    s_add_u32 m0, s44, 3072
    s_add_u32 s46, s40, 49152
    buffer_load_dwordx4 v6, s[12:15], s46 offen lds
    v_mfma_f32_16x16x32_bf16 v[32:35], v[68:71], v[156:159], v[32:35]
    ds_read_b128 v[48:51], v2 offset:32768
    s_add_u32 m0, s45, 73728
    s_add_u32 s46, s41, 2048
    buffer_load_dwordx4 v8, s[16:19], s46 offen lds
    v_mfma_f32_16x16x32_bf16 v[20:23], v[76:79], v[148:151], v[20:23]
    ds_read_b64_tr_b16 v[88:89], v11 offset:61440
    ds_read_b64_tr_b16 v[90:91], v11 offset:61952
    s_add_u32 m0, s43, 73728
    s_add_u32 s46, s41, 2048
    buffer_load_dwordx4 v9, s[16:19], s46 offen lds
    v_mfma_f32_16x16x32_bf16 v[36:39], v[76:79], v[156:159], v[36:39]
    ds_read_b128 v[52:55], v2 offset:34816
    s_add_u32 m0, s45, 81920
    s_add_u32 s46, s41, 4096
    buffer_load_dwordx4 v8, s[16:19], s46 offen lds
    v_mfma_f32_16x16x32_bf16 v[24:27], v[152:155], v[148:151], v[24:27]
    ds_read_b64_tr_b16 v[100:101], v12 offset:61440
    ds_read_b64_tr_b16 v[102:103], v12 offset:61952
    s_add_u32 m0, s43, 81920
    s_add_u32 s46, s41, 4096
    buffer_load_dwordx4 v9, s[16:19], s46 offen lds
    v_mfma_f32_16x16x32_bf16 v[40:43], v[152:155], v[156:159], v[40:43]
    ds_read_b128 v[96:99], v3 offset:32768
    s_bfe_u32 s40, s95, 0x40004
    s_add_u32 s40, s89, s40
    s_and_b32 s40, s40, 15
    s_mul_i32 s41, s40, 393216
    s_lshl_b32 s40, s40, 7
    s_add_u32 s40, s40, s36
    s_add_u32 s42, s41, s47
    s_add_u32 s41, s41, s38
    s_add_u32 m0, s44, 16384
    s_add_u32 s46, s40, 0
    s_nop 0
    buffer_load_dwordx4 v5, s[12:15], s46 offen lds
    v_mfma_f32_16x16x32_bf16 v[28:31], v[84:87], v[148:151], v[28:31]
    ds_read_b64_tr_b16 v[108:109], v13 offset:61440
    ds_read_b64_tr_b16 v[110:111], v13 offset:61952
    s_add_u32 m0, s44, 17408
    s_add_u32 s46, s40, 16384
    buffer_load_dwordx4 v6, s[12:15], s46 offen lds
    v_mfma_f32_16x16x32_bf16 v[44:47], v[84:87], v[156:159], v[44:47]
    ds_read_b128 v[104:107], v3 offset:34816
    s_add_u32 m0, s44, 18432
    s_add_u32 s46, s40, 32768
    buffer_load_dwordx4 v5, s[12:15], s46 offen lds
    s_add_u32 m0, s44, 19456
    s_add_u32 s46, s40, 49152
    buffer_load_dwordx4 v6, s[12:15], s46 offen lds
    s_add_u32 m0, s45, 90112
    s_add_u32 s46, s41, 2048
    buffer_load_dwordx4 v8, s[16:19], s46 offen lds
    s_waitcnt vmcnt(13) lgkmcnt(0)
    s_barrier
    s_add_u32 m0, s43, 90112
    s_add_u32 s46, s41, 2048
    buffer_load_dwordx4 v9, s[16:19], s46 offen lds
    v_mfma_f32_16x16x32_bf16 v[16:19], v[92:95], v[64:67], v[16:19]
    ds_read_b64_tr_b16 v[56:57], v10 offset:49152
    ds_read_b64_tr_b16 v[58:59], v10 offset:49664
    s_add_u32 m0, s45, 98304
    s_add_u32 s46, s41, 4096
    buffer_load_dwordx4 v8, s[16:19], s46 offen lds
    v_mfma_f32_16x16x32_bf16 v[32:35], v[92:95], v[80:83], v[32:35]
    ds_read_b128 v[60:63], v2 offset:49152
    s_add_u32 m0, s43, 98304
    s_add_u32 s46, s41, 4096
    buffer_load_dwordx4 v9, s[16:19], s46 offen lds
    v_mfma_f32_16x16x32_bf16 v[20:23], v[88:91], v[64:67], v[20:23]
    ds_read_b64_tr_b16 v[116:117], v11 offset:49152
    ds_read_b64_tr_b16 v[118:119], v11 offset:49664
    s_bfe_u32 s40, s94, 0x40014
    s_add_u32 s40, s89, s40
    s_and_b32 s40, s40, 15
    s_mul_i32 s41, s40, 393216
    s_lshl_b32 s40, s40, 7
    s_add_u32 s40, s40, s36
    s_add_u32 s42, s41, s47
    s_add_u32 s41, s41, s38
    s_add_u32 m0, s45, 106496
    s_nop 0
    buffer_load_dwordx4 v8, s[16:19], s42 offen lds
    v_mfma_f32_16x16x32_bf16 v[36:39], v[88:91], v[80:83], v[36:39]
    ds_read_b128 v[132:135], v2 offset:51200
    s_add_u32 m0, s43, 106496
    s_nop 0
    buffer_load_dwordx4 v9, s[16:19], s42 offen lds
    v_mfma_f32_16x16x32_bf16 v[24:27], v[100:103], v[64:67], v[24:27]
    ds_read_b64_tr_b16 v[124:125], v12 offset:49152
    ds_read_b64_tr_b16 v[126:127], v12 offset:49664
    s_bfe_u32 s40, s95, 0x40008
    s_add_u32 s40, s89, s40
    s_and_b32 s40, s40, 15
    s_mul_i32 s41, s40, 393216
    s_lshl_b32 s40, s40, 7
    s_add_u32 s40, s40, s36
    s_add_u32 s42, s41, s47
    s_add_u32 s41, s41, s38
    s_add_u32 m0, s44, 32768
    s_add_u32 s46, s40, 0
    s_nop 0
    buffer_load_dwordx4 v5, s[12:15], s46 offen lds
    v_mfma_f32_16x16x32_bf16 v[40:43], v[100:103], v[80:83], v[40:43]
    ds_read_b128 v[68:71], v3 offset:49152
    s_add_u32 m0, s44, 33792
    s_add_u32 s46, s40, 16384
    buffer_load_dwordx4 v6, s[12:15], s46 offen lds
    v_mfma_f32_16x16x32_bf16 v[28:31], v[108:111], v[64:67], v[28:31]
    ds_read_b64_tr_b16 v[76:77], v13 offset:49152
    ds_read_b64_tr_b16 v[78:79], v13 offset:49664
    s_add_u32 m0, s44, 34816
    s_add_u32 s46, s40, 32768
    buffer_load_dwordx4 v5, s[12:15], s46 offen lds
    v_mfma_f32_16x16x32_bf16 v[44:47], v[108:111], v[80:83], v[44:47]
    ds_read_b128 v[152:155], v3 offset:51200
    s_add_u32 m0, s44, 35840
    s_add_u32 s46, s40, 49152
    buffer_load_dwordx4 v6, s[12:15], s46 offen lds
    s_add_u32 m0, s45, 114688
    s_add_u32 s46, s41, 2048
    buffer_load_dwordx4 v8, s[16:19], s46 offen lds
    s_add_u32 m0, s43, 114688
    s_add_u32 s46, s41, 2048
    buffer_load_dwordx4 v9, s[16:19], s46 offen lds
    s_waitcnt vmcnt(16) lgkmcnt(0)
    s_barrier
    s_add_u32 m0, s45, 122880
    s_add_u32 s46, s41, 4096
    buffer_load_dwordx4 v8, s[16:19], s46 offen lds
    v_mfma_f32_16x16x32_bf16 v[16:19], v[56:59], v[112:115], v[16:19]
    ds_read_b64_tr_b16 v[148:149], v10 offset:53248
    ds_read_b64_tr_b16 v[150:151], v10 offset:53760
    s_add_u32 m0, s43, 122880
    s_add_u32 s46, s41, 4096
    buffer_load_dwordx4 v9, s[16:19], s46 offen lds
    v_mfma_f32_16x16x32_bf16 v[32:35], v[56:59], v[120:123], v[32:35]
    ds_read_b128 v[84:87], v2 offset:0
    s_bfe_u32 s40, s95, 0x4000c
    s_add_u32 s40, s89, s40
    s_and_b32 s40, s40, 15
    s_mul_i32 s41, s40, 393216
    s_lshl_b32 s40, s40, 7
    s_add_u32 s40, s40, s36
    s_add_u32 s42, s41, s47
    s_add_u32 s41, s41, s38
    s_add_u32 m0, s44, 49152
    s_add_u32 s46, s40, 0
    s_nop 0
    buffer_load_dwordx4 v5, s[12:15], s46 offen lds
    v_mfma_f32_16x16x32_bf16 v[20:23], v[116:119], v[112:115], v[20:23]
    ds_read_b64_tr_b16 v[156:157], v11 offset:53248
    ds_read_b64_tr_b16 v[158:159], v11 offset:53760
    s_add_u32 m0, s44, 50176
    s_add_u32 s46, s40, 16384
    buffer_load_dwordx4 v6, s[12:15], s46 offen lds
    v_mfma_f32_16x16x32_bf16 v[36:39], v[116:119], v[120:123], v[36:39]
    ds_read_b128 v[92:95], v2 offset:2048
    s_add_u32 m0, s44, 51200
    s_add_u32 s46, s40, 32768
    buffer_load_dwordx4 v5, s[12:15], s46 offen lds
    v_mfma_f32_16x16x32_bf16 v[24:27], v[124:127], v[112:115], v[24:27]
    ds_read_b64_tr_b16 v[88:89], v12 offset:53248
    ds_read_b64_tr_b16 v[90:91], v12 offset:53760
    s_add_u32 m0, s44, 52224
    s_add_u32 s46, s40, 49152
    buffer_load_dwordx4 v6, s[12:15], s46 offen lds
    v_mfma_f32_16x16x32_bf16 v[40:43], v[124:127], v[120:123], v[40:43]
    ds_read_b128 v[100:103], v3 offset:0
    s_add_u32 m0, s45, 65536
    s_add_u32 s46, s41, 2048
    buffer_load_dwordx4 v8, s[16:19], s46 offen lds
    v_mfma_f32_16x16x32_bf16 v[28:31], v[76:79], v[112:115], v[28:31]
    ds_read_b64_tr_b16 v[64:65], v13 offset:53248
    ds_read_b64_tr_b16 v[66:67], v13 offset:53760
    s_add_u32 m0, s43, 65536
    s_add_u32 s46, s41, 2048
    buffer_load_dwordx4 v9, s[16:19], s46 offen lds
    v_mfma_f32_16x16x32_bf16 v[44:47], v[76:79], v[120:123], v[44:47]
    ds_read_b128 v[108:111], v3 offset:2048
    s_add_u32 m0, s45, 131072
    s_add_u32 s46, s41, 4096
    buffer_load_dwordx4 v8, s[16:19], s46 offen lds
    s_add_u32 m0, s43, 131072
    s_add_u32 s46, s41, 4096
    buffer_load_dwordx4 v9, s[16:19], s46 offen lds
    s_waitcnt vmcnt(16) lgkmcnt(0)
    s_barrier
    s_bfe_u32 s40, s95, 0x40010
    s_add_u32 s40, s89, s40
    s_and_b32 s40, s40, 15
    s_mul_i32 s41, s40, 393216
    s_lshl_b32 s40, s40, 7
    s_add_u32 s40, s40, s36
    s_add_u32 s42, s41, s47
    s_add_u32 s41, s41, s38
    s_add_u32 m0, s44, 0
    s_add_u32 s46, s40, 0
    buffer_load_dwordx4 v5, s[12:15], s46 offen lds
    v_mfma_f32_16x16x32_bf16 v[16:19], v[148:151], v[128:131], v[16:19]
    ds_read_b64_tr_b16 v[80:81], v10 offset:16384
    ds_read_b64_tr_b16 v[82:83], v10 offset:16896
    s_add_u32 m0, s44, 1024
    s_add_u32 s46, s40, 16384
    buffer_load_dwordx4 v6, s[12:15], s46 offen lds
    v_mfma_f32_16x16x32_bf16 v[32:35], v[148:151], v[136:139], v[32:35]
    ds_read_b128 v[56:59], v2 offset:16384
    s_add_u32 m0, s44, 2048
    s_add_u32 s46, s40, 32768
    buffer_load_dwordx4 v5, s[12:15], s46 offen lds
    v_mfma_f32_16x16x32_bf16 v[20:23], v[156:159], v[128:131], v[20:23]
    ds_read_b64_tr_b16 v[116:117], v11 offset:16384
    ds_read_b64_tr_b16 v[118:119], v11 offset:16896
    s_add_u32 m0, s44, 3072
    s_add_u32 s46, s40, 49152
    buffer_load_dwordx4 v6, s[12:15], s46 offen lds
    v_mfma_f32_16x16x32_bf16 v[36:39], v[156:159], v[136:139], v[36:39]
    ds_read_b128 v[124:127], v2 offset:18432
    s_add_u32 m0, s45, 73728
    s_add_u32 s46, s41, 2048
    buffer_load_dwordx4 v8, s[16:19], s46 offen lds
    v_mfma_f32_16x16x32_bf16 v[24:27], v[88:91], v[128:131], v[24:27]
    ds_read_b64_tr_b16 v[112:113], v12 offset:16384
    ds_read_b64_tr_b16 v[114:115], v12 offset:16896
    s_add_u32 m0, s43, 73728
    s_add_u32 s46, s41, 2048
    buffer_load_dwordx4 v9, s[16:19], s46 offen lds
    v_mfma_f32_16x16x32_bf16 v[40:43], v[88:91], v[136:139], v[40:43]
    ds_read_b128 v[76:79], v3 offset:16384
    s_add_u32 m0, s45, 81920
    s_add_u32 s46, s41, 4096
    buffer_load_dwordx4 v8, s[16:19], s46 offen lds
    v_mfma_f32_16x16x32_bf16 v[28:31], v[64:67], v[128:131], v[28:31]
    ds_read_b64_tr_b16 v[120:121], v13 offset:16384
    ds_read_b64_tr_b16 v[122:123], v13 offset:16896
    s_add_u32 m0, s43, 81920
    s_add_u32 s46, s41, 4096
    buffer_load_dwordx4 v9, s[16:19], s46 offen lds
    v_mfma_f32_16x16x32_bf16 v[44:47], v[64:67], v[136:139], v[44:47]
    ds_read_b128 v[148:151], v3 offset:18432
    s_waitcnt vmcnt(16) lgkmcnt(0)
    s_barrier
    s_bfe_u32 s40, s95, 0x40014
    s_add_u32 s40, s89, s40
    s_and_b32 s40, s40, 15
    s_mul_i32 s41, s40, 393216
    s_lshl_b32 s40, s40, 7
    s_add_u32 s40, s40, s36
    s_add_u32 s42, s41, s47
    s_add_u32 s41, s41, s38
    s_add_u32 m0, s44, 16384
    s_add_u32 s46, s40, 0
    s_nop 0
    buffer_load_dwordx4 v5, s[12:15], s46 offen lds
    v_mfma_f32_16x16x32_bf16 v[16:19], v[80:83], v[140:143], v[16:19]
    ds_read_b64_tr_b16 v[156:157], v10 offset:20480
    ds_read_b64_tr_b16 v[158:159], v10 offset:20992
    s_add_u32 m0, s44, 17408
    s_add_u32 s46, s40, 16384
    buffer_load_dwordx4 v6, s[12:15], s46 offen lds
    v_mfma_f32_16x16x32_bf16 v[32:35], v[80:83], v[144:147], v[32:35]
    ds_read_b128 v[88:91], v2 offset:32768
    s_add_u32 m0, s44, 18432
    s_add_u32 s46, s40, 32768
    buffer_load_dwordx4 v5, s[12:15], s46 offen lds
    v_mfma_f32_16x16x32_bf16 v[20:23], v[116:119], v[140:143], v[20:23]
    ds_read_b64_tr_b16 v[128:129], v11 offset:20480
    ds_read_b64_tr_b16 v[130:131], v11 offset:20992
    s_add_u32 m0, s44, 19456
    s_add_u32 s46, s40, 49152
    buffer_load_dwordx4 v6, s[12:15], s46 offen lds
    v_mfma_f32_16x16x32_bf16 v[36:39], v[116:119], v[144:147], v[36:39]
    ds_read_b128 v[64:67], v2 offset:34816
    s_add_u32 m0, s45, 90112
    s_add_u32 s46, s41, 2048
    buffer_load_dwordx4 v8, s[16:19], s46 offen lds
    v_mfma_f32_16x16x32_bf16 v[24:27], v[112:115], v[140:143], v[24:27]
    ds_read_b64_tr_b16 v[136:137], v12 offset:20480
    ds_read_b64_tr_b16 v[138:139], v12 offset:20992
    s_add_u32 m0, s43, 90112
    s_add_u32 s46, s41, 2048
    buffer_load_dwordx4 v9, s[16:19], s46 offen lds
    v_mfma_f32_16x16x32_bf16 v[40:43], v[112:115], v[144:147], v[40:43]
    ds_read_b128 v[80:83], v3 offset:32768
    s_add_u32 m0, s45, 98304
    s_add_u32 s46, s41, 4096
    buffer_load_dwordx4 v8, s[16:19], s46 offen lds
    v_mfma_f32_16x16x32_bf16 v[28:31], v[120:123], v[140:143], v[28:31]
    ds_read_b64_tr_b16 v[116:117], v13 offset:20480
    ds_read_b64_tr_b16 v[118:119], v13 offset:20992
    s_add_u32 m0, s43, 98304
    s_add_u32 s46, s41, 4096
    buffer_load_dwordx4 v9, s[16:19], s46 offen lds
    v_mfma_f32_16x16x32_bf16 v[44:47], v[120:123], v[144:147], v[44:47]
    ds_read_b128 v[112:115], v3 offset:34816
    s_waitcnt vmcnt(16) lgkmcnt(0)
    s_barrier
    s_bfe_u32 s40, s95, 0x40018
    s_add_u32 s40, s89, s40
    s_and_b32 s40, s40, 15
    s_mul_i32 s41, s40, 393216
    s_lshl_b32 s40, s40, 7
    s_add_u32 s40, s40, s36
    s_add_u32 s42, s41, s47
    s_add_u32 s41, s41, s38
    s_add_u32 m0, s44, 32768
    s_add_u32 s46, s40, 0
    s_nop 0
    buffer_load_dwordx4 v5, s[12:15], s46 offen lds
    v_mfma_f32_16x16x32_bf16 v[16:19], v[156:159], v[160:163], v[16:19]
    ds_read_b128 v[140:143], v2 offset:49152
    s_add_u32 m0, s44, 33792
    s_add_u32 s46, s40, 16384
    buffer_load_dwordx4 v6, s[12:15], s46 offen lds
    v_mfma_f32_16x16x32_bf16 v[32:35], v[156:159], v[72:75], v[32:35]
    ds_read_b128 v[120:123], v2 offset:51200
    s_add_u32 m0, s44, 34816
    s_add_u32 s46, s40, 32768
    buffer_load_dwordx4 v5, s[12:15], s46 offen lds
    v_mfma_f32_16x16x32_bf16 v[20:23], v[128:131], v[160:163], v[20:23]
    ds_read_b128 v[144:147], v3 offset:49152
    s_add_u32 m0, s44, 35840
    s_add_u32 s46, s40, 49152
    buffer_load_dwordx4 v6, s[12:15], s46 offen lds
    v_mfma_f32_16x16x32_bf16 v[36:39], v[128:131], v[72:75], v[36:39]
    ds_read_b128 v[156:159], v3 offset:51200
    s_add_u32 m0, s45, 106496
    s_add_u32 s46, s41, 2048
    buffer_load_dwordx4 v8, s[16:19], s46 offen lds
    v_mfma_f32_16x16x32_bf16 v[24:27], v[136:139], v[160:163], v[24:27]
    s_add_u32 m0, s43, 106496
    s_add_u32 s46, s41, 2048
    buffer_load_dwordx4 v9, s[16:19], s46 offen lds
    v_mfma_f32_16x16x32_bf16 v[40:43], v[136:139], v[72:75], v[40:43]
    s_add_u32 m0, s45, 114688
    s_add_u32 s46, s41, 4096
    buffer_load_dwordx4 v8, s[16:19], s46 offen lds
    v_mfma_f32_16x16x32_bf16 v[28:31], v[116:119], v[160:163], v[28:31]
    s_add_u32 m0, s43, 114688
    s_add_u32 s46, s41, 4096
    buffer_load_dwordx4 v9, s[16:19], s46 offen lds
    v_mfma_f32_16x16x32_bf16 v[44:47], v[116:119], v[72:75], v[44:47]
    s_waitcnt vmcnt(16) lgkmcnt(0)
    s_barrier
    s_bfe_u32 s40, s95, 0x4001c
    s_add_u32 s40, s89, s40
    s_and_b32 s40, s40, 15
    s_mul_i32 s41, s40, 393216
    s_lshl_b32 s40, s40, 7
    s_add_u32 s40, s40, s36
    s_add_u32 s42, s41, s47
    s_add_u32 s41, s41, s38
    s_add_u32 m0, s44, 49152
    s_add_u32 s46, s40, 0
    s_nop 0
    buffer_load_dwordx4 v5, s[12:15], s46 offen lds
    s_add_u32 m0, s44, 50176
    s_add_u32 s46, s40, 16384
    buffer_load_dwordx4 v6, s[12:15], s46 offen lds
    s_add_u32 m0, s44, 51200
    s_add_u32 s46, s40, 32768
    buffer_load_dwordx4 v5, s[12:15], s46 offen lds
    s_add_u32 m0, s44, 52224
    s_add_u32 s46, s40, 49152
    buffer_load_dwordx4 v6, s[12:15], s46 offen lds
    s_add_u32 m0, s45, 65536
    s_add_u32 s46, s41, 2048
    buffer_load_dwordx4 v8, s[16:19], s46 offen lds
    s_add_u32 m0, s43, 65536
    s_add_u32 s46, s41, 2048
    buffer_load_dwordx4 v9, s[16:19], s46 offen lds
    s_add_u32 m0, s45, 122880
    s_add_u32 s46, s41, 4096
    buffer_load_dwordx4 v8, s[16:19], s46 offen lds
    s_add_u32 m0, s43, 122880
    s_add_u32 s46, s41, 4096
    buffer_load_dwordx4 v9, s[16:19], s46 offen lds
    s_waitcnt vmcnt(16)
    s_barrier
    s_bfe_u32 s40, s94, 0x40018
    s_add_u32 s40, s89, s40
    s_and_b32 s40, s40, 15
    s_mul_i32 s41, s40, 393216
    s_lshl_b32 s40, s40, 7
    s_add_u32 s40, s40, s36
    s_add_u32 s42, s41, s47
    s_add_u32 s41, s41, s38
    s_add_u32 m0, s45, 147456
    s_nop 0
    buffer_load_dwordx4 v8, s[16:19], s42 offen lds
    s_add_u32 m0, s43, 147456
    s_nop 0
    buffer_load_dwordx4 v9, s[16:19], s42 offen lds
    s_waitcnt vmcnt(10)
    s_barrier
    s_bfe_u32 s40, s95, 0x40010
    s_add_u32 s40, s89, s40
    s_and_b32 s40, s40, 15
    s_mul_i32 s41, s40, 393216
    s_lshl_b32 s40, s40, 7
    s_add_u32 s40, s40, s36
    s_add_u32 s42, s41, s47
    s_add_u32 s41, s41, s38
    s_add_u32 m0, s45, 139264
    s_nop 0
    buffer_load_dwordx4 v8, s[16:19], s42 offen lds
    s_add_u32 m0, s43, 139264
    s_nop 0
    buffer_load_dwordx4 v9, s[16:19], s42 offen lds
    s_waitcnt vmcnt(4)
    s_barrier
    s_bfe_u32 s40, s95, 0x40014
    s_add_u32 s40, s89, s40
    s_and_b32 s40, s40, 15
    s_mul_i32 s41, s40, 393216
    s_lshl_b32 s40, s40, 7
    s_add_u32 s40, s40, s36
    s_add_u32 s42, s41, s47
    s_add_u32 s41, s41, s38
    s_add_u32 m0, s45, 131072
    s_nop 0
    buffer_load_dwordx4 v8, s[16:19], s42 offen lds
    s_add_u32 m0, s43, 131072
    s_nop 0
    buffer_load_dwordx4 v9, s[16:19], s42 offen lds
    s_waitcnt vmcnt(6)
    s_barrier
    s_bfe_u32 s40, s95, 0x40018
    s_add_u32 s40, s89, s40
    s_and_b32 s40, s40, 15
    s_mul_i32 s41, s40, 393216
    s_lshl_b32 s40, s40, 7
    s_add_u32 s40, s40, s36
    s_add_u32 s42, s41, s47
    s_add_u32 s41, s41, s38
    s_add_u32 m0, s45, 81920
    s_nop 0
    buffer_load_dwordx4 v8, s[16:19], s42 offen lds
    s_add_u32 m0, s43, 81920
    s_nop 0
    buffer_load_dwordx4 v9, s[16:19], s42 offen lds
    s_bfe_u32 s40, s95, 0x4001c
    s_add_u32 s40, s89, s40
    s_branch IW_s1
IW_w1:
    s_branch IW_r1
IW_s1:
    s_and_b32 s40, s40, 15
    s_mul_i32 s41, s40, 393216
    s_lshl_b32 s40, s40, 7
    s_add_u32 s40, s40, s36
    s_add_u32 s42, s41, s47
    s_add_u32 s41, s41, s38
    s_add_u32 m0, s45, 73728
    s_nop 0
    buffer_load_dwordx4 v8, s[16:19], s42 offen lds
    s_add_u32 m0, s43, 73728
    s_nop 0
    buffer_load_dwordx4 v9, s[16:19], s42 offen lds
    s_bfe_u32 s40, s94, 0x4001c
    s_add_u32 s40, s89, s40
    s_and_b32 s40, s40, 15
    s_mul_i32 s41, s40, 393216
    s_lshl_b32 s40, s40, 7
    s_add_u32 s40, s40, s36
    s_add_u32 s42, s41, s47
    s_add_u32 s41, s41, s38
    s_add_u32 m0, s45, 98304
    s_nop 0
    buffer_load_dwordx4 v8, s[16:19], s42 offen lds
    s_add_u32 m0, s43, 98304
    s_nop 0
    buffer_load_dwordx4 v9, s[16:19], s42 offen lds
    s_bfe_u32 s40, s95, 0x40000
    s_add_u32 s40, s89, s40
    s_and_b32 s40, s40, 15
    s_mul_i32 s41, s40, 393216
    s_lshl_b32 s40, s40, 7
    s_add_u32 s40, s40, s36
    s_add_u32 s42, s41, s47
    s_add_u32 s41, s41, s38
    s_add_u32 m0, s45, 90112
    s_nop 0
    buffer_load_dwordx4 v8, s[16:19], s42 offen lds
    s_add_u32 m0, s43, 90112
    s_nop 0
    buffer_load_dwordx4 v9, s[16:19], s42 offen lds
    s_bfe_u32 s40, s95, 0x40004
    s_add_u32 s40, s89, s40
    s_and_b32 s40, s40, 15
    s_mul_i32 s41, s40, 393216
    s_lshl_b32 s40, s40, 7
    s_add_u32 s40, s40, s36
    s_add_u32 s42, s41, s47
    s_add_u32 s41, s41, s38
    s_add_u32 m0, s45, 114688
    s_nop 0
    buffer_load_dwordx4 v8, s[16:19], s42 offen lds
    s_add_u32 m0, s43, 114688
    s_nop 0
    buffer_load_dwordx4 v9, s[16:19], s42 offen lds
    s_bfe_u32 s40, s95, 0x40008
    s_add_u32 s40, s89, s40
    s_and_b32 s40, s40, 15
    s_mul_i32 s41, s40, 393216
    s_lshl_b32 s40, s40, 7
    s_add_u32 s40, s40, s36
    s_add_u32 s42, s41, s47
    s_add_u32 s41, s41, s38
    s_add_u32 m0, s45, 106496
    s_nop 0
    buffer_load_dwordx4 v8, s[16:19], s42 offen lds
    s_add_u32 m0, s43, 106496
    s_nop 0
    buffer_load_dwordx4 v9, s[16:19], s42 offen lds
    s_bfe_u32 s40, s95, 0x4000c
    s_add_u32 s40, s89, s40
    s_and_b32 s40, s40, 15
    s_mul_i32 s41, s40, 393216
    s_lshl_b32 s40, s40, 7
    s_add_u32 s40, s40, s36
    s_add_u32 s42, s41, s47
    s_add_u32 s41, s41, s38
    s_add_u32 m0, s45, 122880
    s_nop 0
    buffer_load_dwordx4 v8, s[16:19], s42 offen lds
    s_add_u32 m0, s43, 122880
    s_nop 0
    buffer_load_dwordx4 v9, s[16:19], s42 offen lds
    s_setprio 1
    v_subrev_u32 v5, 24576, v10
    v_subrev_u32 v6, 24576, v11
    v_subrev_u32 v8, 24576, v12
    v_subrev_u32 v9, 24576, v13
    s_add_u32 s16, s72, 0x400000
    s_addc_u32 s17, s73, 0
    s_mov_b32 s18, 0x400000
    s_mov_b32 s19, 0x00020000
    s_add_u32 s24, s72, 0x800000
    s_addc_u32 s25, s73, 0
    s_mov_b32 s26, 0x48000
    s_mov_b32 s27, 0x00020000
    s_waitcnt vmcnt(8)
    s_mov_b64 exec, 1
    ds_add_u32 v4, v164 offset:112
    s_mov_b64 exec, -1
    ds_read_b32 v7, v1 offset:32
FW_1:
    s_waitcnt lgkmcnt(0)
    v_cmp_gt_u32 vcc, 1, v7
    s_cbranch_vccz FO_2
    s_sleep 2
    ds_read_b32 v7, v1 offset:32
    s_branch FW_1
FO_2:
    ds_read_b32 v7, v1 offset:112
FW_3:
    s_waitcnt lgkmcnt(0)
    v_cmp_gt_u32 vcc, 1, v7
    s_cbranch_vccz FO_4
    ds_read_b32 v7, v1 offset:112
    s_branch FW_3
FO_4:
    s_nop 0
    ds_read_b64_tr_b16 v[128:129], v10 offset:57344
    ds_read_b64_tr_b16 v[130:131], v10 offset:57856
    ds_read_b64_tr_b16 v[136:137], v11 offset:57344
    ds_read_b64_tr_b16 v[138:139], v11 offset:57856
    ds_read_b64_tr_b16 v[160:161], v12 offset:57344
    ds_read_b64_tr_b16 v[162:163], v12 offset:57856
    ds_read_b64_tr_b16 v[116:117], v13 offset:57344
    ds_read_b64_tr_b16 v[118:119], v13 offset:57856
    ds_read_b64_tr_b16 v[72:73], v10 offset:61440
    ds_read_b64_tr_b16 v[74:75], v10 offset:61952
    s_waitcnt lgkmcnt(8)
    v_mfma_f32_16x16x32_bf16 v[16:19], v[128:131], v[48:51], v[16:19]
    v_mfma_f32_16x16x32_bf16 v[32:35], v[128:131], v[52:55], v[32:35]
    ds_read_b64_tr_b16 v[128:129], v11 offset:61440
    ds_read_b64_tr_b16 v[130:131], v11 offset:61952
    s_waitcnt lgkmcnt(8)
    v_mfma_f32_16x16x32_bf16 v[20:23], v[136:139], v[48:51], v[20:23]
    v_mfma_f32_16x16x32_bf16 v[36:39], v[136:139], v[52:55], v[36:39]
    ds_read_b64_tr_b16 v[136:137], v12 offset:61440
    ds_read_b64_tr_b16 v[138:139], v12 offset:61952
    s_waitcnt lgkmcnt(8)
    v_mfma_f32_16x16x32_bf16 v[24:27], v[160:163], v[48:51], v[24:27]
    v_mfma_f32_16x16x32_bf16 v[40:43], v[160:163], v[52:55], v[40:43]
    ds_read_b64_tr_b16 v[160:161], v13 offset:61440
    ds_read_b64_tr_b16 v[162:163], v13 offset:61952
    s_waitcnt lgkmcnt(8)
    v_mfma_f32_16x16x32_bf16 v[28:31], v[116:119], v[48:51], v[28:31]
    ds_read_b128 v[48:51], v2 offset:0
    v_mfma_f32_16x16x32_bf16 v[44:47], v[116:119], v[52:55], v[44:47]
    ds_read_b64_tr_b16 v[116:117], v10 offset:49152
    ds_read_b64_tr_b16 v[118:119], v10 offset:49664
    s_waitcnt lgkmcnt(9)
    v_mfma_f32_16x16x32_bf16 v[16:19], v[72:75], v[96:99], v[16:19]
    ds_read_b128 v[52:55], v2 offset:2048
    v_mfma_f32_16x16x32_bf16 v[32:35], v[72:75], v[104:107], v[32:35]
    ds_read_b64_tr_b16 v[72:73], v11 offset:49152
    ds_read_b64_tr_b16 v[74:75], v11 offset:49664
    s_waitcnt lgkmcnt(10)
    v_mfma_f32_16x16x32_bf16 v[20:23], v[128:131], v[96:99], v[20:23]
    v_mfma_f32_16x16x32_bf16 v[36:39], v[128:131], v[104:107], v[36:39]
    ds_read_b64_tr_b16 v[128:129], v12 offset:49152
    ds_read_b64_tr_b16 v[130:131], v12 offset:49664
    s_waitcnt lgkmcnt(10)
    v_mfma_f32_16x16x32_bf16 v[24:27], v[136:139], v[96:99], v[24:27]
    v_mfma_f32_16x16x32_bf16 v[40:43], v[136:139], v[104:107], v[40:43]
    ds_read_b64_tr_b16 v[136:137], v13 offset:49152
    ds_read_b64_tr_b16 v[138:139], v13 offset:49664
    s_waitcnt lgkmcnt(10)
    v_mfma_f32_16x16x32_bf16 v[28:31], v[160:163], v[96:99], v[28:31]
    ds_read_b128 v[96:99], v3 offset:0
    v_mfma_f32_16x16x32_bf16 v[44:47], v[160:163], v[104:107], v[44:47]
    ds_read_b64_tr_b16 v[160:161], v10 offset:53248
    ds_read_b64_tr_b16 v[162:163], v10 offset:53760
    s_waitcnt lgkmcnt(10)
    v_mfma_f32_16x16x32_bf16 v[16:19], v[116:119], v[48:51], v[16:19]
    ds_read_b128 v[104:107], v3 offset:2048
    s_waitcnt lgkmcnt(10)
    v_mfma_f32_16x16x32_bf16 v[32:35], v[116:119], v[52:55], v[32:35]
    ds_read_b64_tr_b16 v[116:117], v11 offset:53248
    ds_read_b64_tr_b16 v[118:119], v11 offset:53760
    s_waitcnt lgkmcnt(10)
    v_mfma_f32_16x16x32_bf16 v[20:23], v[72:75], v[48:51], v[20:23]
    v_mfma_f32_16x16x32_bf16 v[36:39], v[72:75], v[52:55], v[36:39]
    ds_read_b64_tr_b16 v[72:73], v12 offset:53248
    ds_read_b64_tr_b16 v[74:75], v12 offset:53760
    s_waitcnt lgkmcnt(10)
    v_mfma_f32_16x16x32_bf16 v[24:27], v[128:131], v[48:51], v[24:27]
    v_mfma_f32_16x16x32_bf16 v[40:43], v[128:131], v[52:55], v[40:43]
    ds_read_b64_tr_b16 v[128:129], v13 offset:53248
    ds_read_b64_tr_b16 v[130:131], v13 offset:53760
    s_waitcnt lgkmcnt(10)
    v_mfma_f32_16x16x32_bf16 v[28:31], v[136:139], v[48:51], v[28:31]
    ds_read_b128 v[48:51], v2 offset:16384
    v_mfma_f32_16x16x32_bf16 v[44:47], v[136:139], v[52:55], v[44:47]
    ds_read_b64_tr_b16 v[136:137], v10 offset:40960
    ds_read_b64_tr_b16 v[138:139], v10 offset:41472
    s_waitcnt lgkmcnt(10)
    v_mfma_f32_16x16x32_bf16 v[16:19], v[160:163], v[96:99], v[16:19]
    ds_read_b128 v[52:55], v2 offset:18432
    s_waitcnt lgkmcnt(10)
    v_mfma_f32_16x16x32_bf16 v[32:35], v[160:163], v[104:107], v[32:35]
    ds_read_b64_tr_b16 v[160:161], v11 offset:40960
    ds_read_b64_tr_b16 v[162:163], v11 offset:41472
    s_waitcnt lgkmcnt(10)
    v_mfma_f32_16x16x32_bf16 v[20:23], v[116:119], v[96:99], v[20:23]
    v_mfma_f32_16x16x32_bf16 v[36:39], v[116:119], v[104:107], v[36:39]
    ds_read_b64_tr_b16 v[116:117], v12 offset:40960
    ds_read_b64_tr_b16 v[118:119], v12 offset:41472
    s_waitcnt lgkmcnt(10)
    v_mfma_f32_16x16x32_bf16 v[24:27], v[72:75], v[96:99], v[24:27]
    v_mfma_f32_16x16x32_bf16 v[40:43], v[72:75], v[104:107], v[40:43]
    ds_read_b64_tr_b16 v[72:73], v13 offset:40960
    ds_read_b64_tr_b16 v[74:75], v13 offset:41472
    s_waitcnt lgkmcnt(10)
    v_mfma_f32_16x16x32_bf16 v[28:31], v[128:131], v[96:99], v[28:31]
    ds_read_b128 v[96:99], v3 offset:16384
    v_mfma_f32_16x16x32_bf16 v[44:47], v[128:131], v[104:107], v[44:47]
    ds_read_b64_tr_b16 v[128:129], v10 offset:45056
    ds_read_b64_tr_b16 v[130:131], v10 offset:45568
    s_waitcnt lgkmcnt(10)
    v_mfma_f32_16x16x32_bf16 v[16:19], v[136:139], v[48:51], v[16:19]
    ds_read_b128 v[104:107], v3 offset:18432
    s_waitcnt lgkmcnt(10)
    v_mfma_f32_16x16x32_bf16 v[32:35], v[136:139], v[52:55], v[32:35]
    ds_read_b64_tr_b16 v[136:137], v11 offset:45056
    ds_read_b64_tr_b16 v[138:139], v11 offset:45568
    s_waitcnt lgkmcnt(10)
    v_mfma_f32_16x16x32_bf16 v[20:23], v[160:163], v[48:51], v[20:23]
    v_mfma_f32_16x16x32_bf16 v[36:39], v[160:163], v[52:55], v[36:39]
    ds_read_b64_tr_b16 v[160:161], v12 offset:45056
    ds_read_b64_tr_b16 v[162:163], v12 offset:45568
    s_waitcnt lgkmcnt(10)
    v_mfma_f32_16x16x32_bf16 v[24:27], v[116:119], v[48:51], v[24:27]
    v_mfma_f32_16x16x32_bf16 v[40:43], v[116:119], v[52:55], v[40:43]
    ds_read_b64_tr_b16 v[116:117], v13 offset:45056
    ds_read_b64_tr_b16 v[118:119], v13 offset:45568
    s_waitcnt lgkmcnt(10)
    v_mfma_f32_16x16x32_bf16 v[28:31], v[72:75], v[48:51], v[28:31]
    ds_read_b128 v[48:51], v2 offset:32768
    v_mfma_f32_16x16x32_bf16 v[44:47], v[72:75], v[52:55], v[44:47]
    ds_read_b64_tr_b16 v[72:73], v5 offset:16384
    ds_read_b64_tr_b16 v[74:75], v5 offset:16896
    s_waitcnt lgkmcnt(10)
    v_mfma_f32_16x16x32_bf16 v[16:19], v[128:131], v[96:99], v[16:19]
    ds_read_b128 v[52:55], v2 offset:34816
    s_waitcnt lgkmcnt(10)
    v_mfma_f32_16x16x32_bf16 v[32:35], v[128:131], v[104:107], v[32:35]
    ds_read_b64_tr_b16 v[128:129], v6 offset:16384
    ds_read_b64_tr_b16 v[130:131], v6 offset:16896
    s_waitcnt lgkmcnt(10)
    v_mfma_f32_16x16x32_bf16 v[20:23], v[136:139], v[96:99], v[20:23]
    v_mfma_f32_16x16x32_bf16 v[36:39], v[136:139], v[104:107], v[36:39]
    ds_read_b64_tr_b16 v[136:137], v8 offset:16384
    ds_read_b64_tr_b16 v[138:139], v8 offset:16896
    s_waitcnt lgkmcnt(10)
    v_mfma_f32_16x16x32_bf16 v[24:27], v[160:163], v[96:99], v[24:27]
    v_mfma_f32_16x16x32_bf16 v[40:43], v[160:163], v[104:107], v[40:43]
    ds_read_b64_tr_b16 v[160:161], v9 offset:16384
    ds_read_b64_tr_b16 v[162:163], v9 offset:16896
    s_waitcnt lgkmcnt(10)
    v_mfma_f32_16x16x32_bf16 v[28:31], v[116:119], v[96:99], v[28:31]
    ds_read_b128 v[96:99], v3 offset:32768
    v_mfma_f32_16x16x32_bf16 v[44:47], v[116:119], v[104:107], v[44:47]
    ds_read_b64_tr_b16 v[116:117], v5 offset:20480
    ds_read_b64_tr_b16 v[118:119], v5 offset:20992
    s_waitcnt lgkmcnt(10)
    v_mfma_f32_16x16x32_bf16 v[16:19], v[72:75], v[48:51], v[16:19]
    ds_read_b128 v[104:107], v3 offset:34816
    s_waitcnt lgkmcnt(10)
    v_mfma_f32_16x16x32_bf16 v[32:35], v[72:75], v[52:55], v[32:35]
    ds_read_b64_tr_b16 v[72:73], v6 offset:20480
    ds_read_b64_tr_b16 v[74:75], v6 offset:20992
    s_waitcnt lgkmcnt(10)
    v_mfma_f32_16x16x32_bf16 v[20:23], v[128:131], v[48:51], v[20:23]
    v_mfma_f32_16x16x32_bf16 v[36:39], v[128:131], v[52:55], v[36:39]
    ds_read_b64_tr_b16 v[128:129], v8 offset:20480
    ds_read_b64_tr_b16 v[130:131], v8 offset:20992
    s_waitcnt lgkmcnt(10)
    v_mfma_f32_16x16x32_bf16 v[24:27], v[136:139], v[48:51], v[24:27]
    v_mfma_f32_16x16x32_bf16 v[40:43], v[136:139], v[52:55], v[40:43]
    ds_read_b64_tr_b16 v[136:137], v9 offset:20480
    ds_read_b64_tr_b16 v[138:139], v9 offset:20992
    s_waitcnt lgkmcnt(10)
    v_mfma_f32_16x16x32_bf16 v[28:31], v[160:163], v[48:51], v[28:31]
    s_waitcnt vmcnt(0)
    s_mov_b64 exec, 1
    ds_add_u32 v4, v164 offset:112
    s_mov_b64 exec, -1
    ds_read_b128 v[48:51], v2 offset:49152
    v_mfma_f32_16x16x32_bf16 v[44:47], v[160:163], v[52:55], v[44:47]
    ds_read_b64_tr_b16 v[160:161], v5 offset:8192
    ds_read_b64_tr_b16 v[162:163], v5 offset:8704
    s_waitcnt lgkmcnt(11)
    v_mfma_f32_16x16x32_bf16 v[16:19], v[116:119], v[96:99], v[16:19]
    ds_read_b128 v[52:55], v2 offset:51200
    s_waitcnt lgkmcnt(11)
    v_mfma_f32_16x16x32_bf16 v[32:35], v[116:119], v[104:107], v[32:35]
    ds_read_b64_tr_b16 v[116:117], v6 offset:8192
    ds_read_b64_tr_b16 v[118:119], v6 offset:8704
    s_waitcnt lgkmcnt(11)
    v_mfma_f32_16x16x32_bf16 v[20:23], v[72:75], v[96:99], v[20:23]
    v_mfma_f32_16x16x32_bf16 v[36:39], v[72:75], v[104:107], v[36:39]
    ds_read_b64_tr_b16 v[72:73], v8 offset:8192
    ds_read_b64_tr_b16 v[74:75], v8 offset:8704
    s_waitcnt lgkmcnt(9)
    v_mov_b32 v165, 4
    s_mov_b64 exec, 1
    ds_write_b32 v4, v165 offset:0
    s_mov_b64 exec, -1
    s_nop 0
    v_mfma_f32_16x16x32_bf16 v[24:27], v[128:131], v[96:99], v[24:27]
    v_mfma_f32_16x16x32_bf16 v[40:43], v[128:131], v[104:107], v[40:43]
    ds_read_b64_tr_b16 v[128:129], v9 offset:8192
    ds_read_b64_tr_b16 v[130:131], v9 offset:8704
    v_mfma_f32_16x16x32_bf16 v[28:31], v[136:139], v[96:99], v[28:31]
    ds_read_b128 v[96:99], v3 offset:49152
    v_mfma_f32_16x16x32_bf16 v[44:47], v[136:139], v[104:107], v[44:47]
    ds_read_b64_tr_b16 v[136:137], v5 offset:12288
    ds_read_b64_tr_b16 v[138:139], v5 offset:12800
    s_waitcnt lgkmcnt(11)
    v_mfma_f32_16x16x32_bf16 v[16:19], v[160:163], v[48:51], v[16:19]
    ds_read_b128 v[104:107], v3 offset:51200
    s_waitcnt lgkmcnt(11)
    v_mfma_f32_16x16x32_bf16 v[32:35], v[160:163], v[52:55], v[32:35]
    ds_read_b64_tr_b16 v[160:161], v6 offset:12288
    ds_read_b64_tr_b16 v[162:163], v6 offset:12800
    s_waitcnt lgkmcnt(11)
    v_mfma_f32_16x16x32_bf16 v[20:23], v[116:119], v[48:51], v[20:23]
    v_mfma_f32_16x16x32_bf16 v[36:39], v[116:119], v[52:55], v[36:39]
    ds_read_b64_tr_b16 v[116:117], v8 offset:12288
    ds_read_b64_tr_b16 v[118:119], v8 offset:12800
    s_waitcnt lgkmcnt(11)
    v_mfma_f32_16x16x32_bf16 v[24:27], v[72:75], v[48:51], v[24:27]
    v_mfma_f32_16x16x32_bf16 v[40:43], v[72:75], v[52:55], v[40:43]
    ds_read_b64_tr_b16 v[72:73], v9 offset:12288
    ds_read_b64_tr_b16 v[74:75], v9 offset:12800
    s_waitcnt lgkmcnt(10)
    v_mfma_f32_16x16x32_bf16 v[28:31], v[128:131], v[48:51], v[28:31]
    ds_read_b64_tr_b16 v[48:49], v10 offset:8192
    v_mfma_f32_16x16x32_bf16 v[44:47], v[128:131], v[52:55], v[44:47]
    ds_read_b64_tr_b16 v[50:51], v10 offset:8704
    ds_read_b64_tr_b16 v[128:129], v11 offset:8192
    s_waitcnt lgkmcnt(10)
    v_mfma_f32_16x16x32_bf16 v[16:19], v[136:139], v[96:99], v[16:19]
    ds_read_b64_tr_b16 v[130:131], v11 offset:8704
    s_waitcnt lgkmcnt(10)
    v_mfma_f32_16x16x32_bf16 v[32:35], v[136:139], v[104:107], v[32:35]
    ds_read_b64_tr_b16 v[52:53], v12 offset:8192
    ds_read_b64_tr_b16 v[54:55], v12 offset:8704
    s_waitcnt lgkmcnt(10)
    v_mfma_f32_16x16x32_bf16 v[20:23], v[160:163], v[96:99], v[20:23]
    ds_read_b64_tr_b16 v[136:137], v13 offset:8192
    v_mfma_f32_16x16x32_bf16 v[36:39], v[160:163], v[104:107], v[36:39]
    ds_read_b64_tr_b16 v[138:139], v13 offset:8704
    ds_read_b64_tr_b16 v[160:161], v10 offset:12288
    s_waitcnt lgkmcnt(11)
    v_mfma_f32_16x16x32_bf16 v[24:27], v[116:119], v[96:99], v[24:27]
    ds_read_b64_tr_b16 v[162:163], v10 offset:12800
    v_mfma_f32_16x16x32_bf16 v[40:43], v[116:119], v[104:107], v[40:43]
    ds_read_b64_tr_b16 v[116:117], v11 offset:12288
    ds_read_b64_tr_b16 v[118:119], v11 offset:12800
    s_waitcnt lgkmcnt(12)
    v_mfma_f32_16x16x32_bf16 v[28:31], v[72:75], v[96:99], v[28:31]
    ds_read_b64_tr_b16 v[96:97], v12 offset:12288
    v_mfma_f32_16x16x32_bf16 v[44:47], v[72:75], v[104:107], v[44:47]
    ds_read_b64_tr_b16 v[98:99], v12 offset:12800
    ds_read_b64_tr_b16 v[72:73], v13 offset:12288
    s_waitcnt lgkmcnt(13)
    v_mfma_f32_16x16x32_bf16 v[16:19], v[48:51], v[60:63], v[16:19]
    ds_read_b64_tr_b16 v[74:75], v13 offset:12800
    v_mfma_f32_16x16x32_bf16 v[32:35], v[48:51], v[132:135], v[32:35]
    ds_read_b32 v7, v1 offset:112
FW_5:
    s_waitcnt lgkmcnt(0)
    v_cmp_gt_u32 vcc, 2, v7
    s_cbranch_vccz FO_6
    ds_read_b32 v7, v1 offset:112
    s_branch FW_5
FO_6:
    s_nop 0
    ds_read_b64_tr_b16 v[104:105], v10 offset:0
    ds_read_b64_tr_b16 v[106:107], v10 offset:512
    v_mfma_f32_16x16x32_bf16 v[20:23], v[128:131], v[60:63], v[20:23]
    ds_read_b64_tr_b16 v[48:49], v11 offset:0
    v_mfma_f32_16x16x32_bf16 v[36:39], v[128:131], v[132:135], v[36:39]
    ds_read_b64_tr_b16 v[50:51], v11 offset:512
    ds_read_b64_tr_b16 v[128:129], v12 offset:0
    v_mfma_f32_16x16x32_bf16 v[24:27], v[52:55], v[60:63], v[24:27]
    ds_read_b64_tr_b16 v[130:131], v12 offset:512
    v_mfma_f32_16x16x32_bf16 v[40:43], v[52:55], v[132:135], v[40:43]
    ds_read_b64_tr_b16 v[52:53], v13 offset:0
    ds_read_b64_tr_b16 v[54:55], v13 offset:512
    v_mfma_f32_16x16x32_bf16 v[28:31], v[136:139], v[60:63], v[28:31]
    v_mfma_f32_16x16x32_bf16 v[44:47], v[136:139], v[132:135], v[44:47]
    v_mfma_f32_16x16x32_bf16 v[16:19], v[160:163], v[68:71], v[16:19]
    ds_read_b64_tr_b16 v[60:61], v10 offset:4096
    v_mfma_f32_16x16x32_bf16 v[32:35], v[160:163], v[152:155], v[32:35]
    ds_read_b64_tr_b16 v[62:63], v10 offset:4608
    ds_read_b64_tr_b16 v[136:137], v11 offset:4096
    v_mfma_f32_16x16x32_bf16 v[20:23], v[116:119], v[68:71], v[20:23]
    ds_read_b64_tr_b16 v[138:139], v11 offset:4608
    v_mfma_f32_16x16x32_bf16 v[36:39], v[116:119], v[152:155], v[36:39]
    ds_read_b64_tr_b16 v[132:133], v12 offset:4096
    ds_read_b64_tr_b16 v[134:135], v12 offset:4608
    v_mfma_f32_16x16x32_bf16 v[24:27], v[96:99], v[68:71], v[24:27]
    ds_read_b64_tr_b16 v[160:161], v13 offset:4096
    v_mfma_f32_16x16x32_bf16 v[40:43], v[96:99], v[152:155], v[40:43]
    s_waitcnt lgkmcnt(8)
    ds_read_b64_tr_b16 v[162:163], v13 offset:4608
    v_mfma_f32_16x16x32_bf16 v[28:31], v[72:75], v[68:71], v[28:31]
    v_mfma_f32_16x16x32_bf16 v[44:47], v[72:75], v[152:155], v[44:47]
    s_waitcnt lgkmcnt(14)
    v_mfma_f32_16x16x32_bf16 v[16:19], v[104:107], v[84:87], v[16:19]
    ds_read_b64_tr_b16 v[116:117], v10 offset:24576
    v_mfma_f32_16x16x32_bf16 v[32:35], v[104:107], v[92:95], v[32:35]
    ds_read_b64_tr_b16 v[118:119], v10 offset:25088
    ds_read_b64_tr_b16 v[96:97], v11 offset:24576
    s_waitcnt lgkmcnt(15)
    v_mfma_f32_16x16x32_bf16 v[20:23], v[48:51], v[84:87], v[20:23]
    ds_read_b64_tr_b16 v[98:99], v11 offset:25088
    v_mfma_f32_16x16x32_bf16 v[36:39], v[48:51], v[92:95], v[36:39]
    ds_read_b64_tr_b16 v[68:69], v12 offset:24576
    ds_read_b64_tr_b16 v[70:71], v12 offset:25088
    s_waitcnt lgkmcnt(15)
    v_mfma_f32_16x16x32_bf16 v[24:27], v[128:131], v[84:87], v[24:27]
    s_waitcnt lgkmcnt(8)
    ds_read_b64_tr_b16 v[72:73], v13 offset:24576
    v_mfma_f32_16x16x32_bf16 v[40:43], v[128:131], v[92:95], v[40:43]
    ds_read_b64_tr_b16 v[74:75], v13 offset:25088
    s_waitcnt lgkmcnt(15)
    v_mfma_f32_16x16x32_bf16 v[28:31], v[52:55], v[84:87], v[28:31]
    v_mfma_f32_16x16x32_bf16 v[44:47], v[52:55], v[92:95], v[44:47]
    s_waitcnt lgkmcnt(14)
    v_mfma_f32_16x16x32_bf16 v[16:19], v[60:63], v[100:103], v[16:19]
    ds_read_b64_tr_b16 v[152:153], v10 offset:28672
    v_mfma_f32_16x16x32_bf16 v[32:35], v[60:63], v[108:111], v[32:35]
    ds_read_b64_tr_b16 v[154:155], v10 offset:29184
    ds_read_b64_tr_b16 v[104:105], v11 offset:28672
    s_waitcnt lgkmcnt(15)
    v_mfma_f32_16x16x32_bf16 v[20:23], v[136:139], v[100:103], v[20:23]
    ds_read_b64_tr_b16 v[106:107], v11 offset:29184
    v_mfma_f32_16x16x32_bf16 v[36:39], v[136:139], v[108:111], v[36:39]
    ds_read_b64_tr_b16 v[48:49], v12 offset:28672
    s_waitcnt lgkmcnt(8)
    ds_read_b64_tr_b16 v[50:51], v12 offset:29184
    s_waitcnt lgkmcnt(15)
    v_mfma_f32_16x16x32_bf16 v[24:27], v[132:135], v[100:103], v[24:27]
    ds_read_b64_tr_b16 v[128:129], v13 offset:28672
    v_mfma_f32_16x16x32_bf16 v[40:43], v[132:135], v[108:111], v[40:43]
    ds_read_b64_tr_b16 v[130:131], v13 offset:29184
    s_waitcnt lgkmcnt(15)
    v_mfma_f32_16x16x32_bf16 v[28:31], v[160:163], v[100:103], v[28:31]
    v_mfma_f32_16x16x32_bf16 v[44:47], v[160:163], v[108:111], v[44:47]
    s_waitcnt lgkmcnt(14)
    v_mfma_f32_16x16x32_bf16 v[16:19], v[116:119], v[56:59], v[16:19]
    ds_read_b64_tr_b16 v[84:85], v10 offset:16384
    v_mfma_f32_16x16x32_bf16 v[32:35], v[116:119], v[124:127], v[32:35]
    ds_read_b64_tr_b16 v[86:87], v10 offset:16896
    ds_read_b64_tr_b16 v[52:53], v11 offset:16384
    s_waitcnt lgkmcnt(15)
    v_mfma_f32_16x16x32_bf16 v[20:23], v[96:99], v[56:59], v[20:23]
    ds_read_b64_tr_b16 v[54:55], v11 offset:16896
    v_mfma_f32_16x16x32_bf16 v[36:39], v[96:99], v[124:127], v[36:39]
    s_waitcnt lgkmcnt(8)
    ds_read_b64_tr_b16 v[92:93], v12 offset:16384
    ds_read_b64_tr_b16 v[94:95], v12 offset:16896
    s_waitcnt lgkmcnt(15)
    v_mfma_f32_16x16x32_bf16 v[24:27], v[68:71], v[56:59], v[24:27]
    ds_read_b64_tr_b16 v[60:61], v13 offset:16384
    v_mfma_f32_16x16x32_bf16 v[40:43], v[68:71], v[124:127], v[40:43]
    ds_read_b64_tr_b16 v[62:63], v13 offset:16896
    s_waitcnt lgkmcnt(15)
    v_mfma_f32_16x16x32_bf16 v[28:31], v[72:75], v[56:59], v[28:31]
    v_mfma_f32_16x16x32_bf16 v[44:47], v[72:75], v[124:127], v[44:47]
    s_waitcnt lgkmcnt(14)
    v_mfma_f32_16x16x32_bf16 v[16:19], v[152:155], v[76:79], v[16:19]
    ds_read_b64_tr_b16 v[136:137], v10 offset:20480
    v_mfma_f32_16x16x32_bf16 v[32:35], v[152:155], v[148:151], v[32:35]
    ds_read_b64_tr_b16 v[138:139], v10 offset:20992
    ds_read_b64_tr_b16 v[132:133], v11 offset:20480
    s_waitcnt lgkmcnt(15)
    v_mfma_f32_16x16x32_bf16 v[20:23], v[104:107], v[76:79], v[20:23]
    s_waitcnt lgkmcnt(8)
    ds_read_b64_tr_b16 v[134:135], v11 offset:20992
    v_mfma_f32_16x16x32_bf16 v[36:39], v[104:107], v[148:151], v[36:39]
    ds_read_b64_tr_b16 v[100:101], v12 offset:20480
    ds_read_b64_tr_b16 v[102:103], v12 offset:20992
    s_waitcnt lgkmcnt(15)
    v_mfma_f32_16x16x32_bf16 v[24:27], v[48:51], v[76:79], v[24:27]
    ds_read_b64_tr_b16 v[160:161], v13 offset:20480
    v_mfma_f32_16x16x32_bf16 v[40:43], v[48:51], v[148:151], v[40:43]
    ds_read_b64_tr_b16 v[162:163], v13 offset:20992
    s_waitcnt lgkmcnt(15)
    v_mfma_f32_16x16x32_bf16 v[28:31], v[128:131], v[76:79], v[28:31]
    v_mfma_f32_16x16x32_bf16 v[44:47], v[128:131], v[148:151], v[44:47]
    s_waitcnt lgkmcnt(14)
    v_mfma_f32_16x16x32_bf16 v[16:19], v[84:87], v[88:91], v[16:19]
    ds_read_b64_tr_b16 v[108:109], v10 offset:32768
    v_mfma_f32_16x16x32_bf16 v[32:35], v[84:87], v[64:67], v[32:35]
    ds_read_b64_tr_b16 v[110:111], v10 offset:33280
    s_waitcnt lgkmcnt(8)
    ds_read_b64_tr_b16 v[116:117], v11 offset:32768
    s_waitcnt lgkmcnt(15)
    v_mfma_f32_16x16x32_bf16 v[20:23], v[52:55], v[88:91], v[20:23]
    ds_read_b64_tr_b16 v[118:119], v11 offset:33280
    v_mfma_f32_16x16x32_bf16 v[36:39], v[52:55], v[64:67], v[36:39]
    ds_read_b64_tr_b16 v[96:97], v12 offset:32768
    ds_read_b64_tr_b16 v[98:99], v12 offset:33280
    s_waitcnt lgkmcnt(15)
    v_mfma_f32_16x16x32_bf16 v[24:27], v[92:95], v[88:91], v[24:27]
    ds_read_b64_tr_b16 v[68:69], v13 offset:32768
    v_mfma_f32_16x16x32_bf16 v[40:43], v[92:95], v[64:67], v[40:43]
    ds_read_b64_tr_b16 v[70:71], v13 offset:33280
    s_waitcnt lgkmcnt(15)
    v_mfma_f32_16x16x32_bf16 v[28:31], v[60:63], v[88:91], v[28:31]
    v_mfma_f32_16x16x32_bf16 v[44:47], v[60:63], v[64:67], v[44:47]
    s_waitcnt lgkmcnt(14)
    v_mfma_f32_16x16x32_bf16 v[16:19], v[136:139], v[80:83], v[16:19]
    ds_read_b64_tr_b16 v[56:57], v10 offset:36864
    v_mfma_f32_16x16x32_bf16 v[32:35], v[136:139], v[112:115], v[32:35]
    s_waitcnt lgkmcnt(8)
    ds_read_b64_tr_b16 v[58:59], v10 offset:37376
    ds_read_b64_tr_b16 v[72:73], v11 offset:36864
    s_waitcnt lgkmcnt(15)
    v_mfma_f32_16x16x32_bf16 v[20:23], v[132:135], v[80:83], v[20:23]
    ds_read_b64_tr_b16 v[74:75], v11 offset:37376
    v_mfma_f32_16x16x32_bf16 v[36:39], v[132:135], v[112:115], v[36:39]
    ds_read_b64_tr_b16 v[124:125], v12 offset:36864
    ds_read_b64_tr_b16 v[126:127], v12 offset:37376
    s_waitcnt lgkmcnt(15)
    v_mfma_f32_16x16x32_bf16 v[24:27], v[100:103], v[80:83], v[24:27]
    ds_read_b64_tr_b16 v[152:153], v13 offset:36864
    v_mfma_f32_16x16x32_bf16 v[40:43], v[100:103], v[112:115], v[40:43]
    ds_read_b64_tr_b16 v[154:155], v13 offset:37376
    s_waitcnt lgkmcnt(15)
    v_mfma_f32_16x16x32_bf16 v[28:31], v[160:163], v[80:83], v[28:31]
    v_mfma_f32_16x16x32_bf16 v[44:47], v[160:163], v[112:115], v[44:47]
    s_waitcnt lgkmcnt(14)
    v_mfma_f32_16x16x32_bf16 v[16:19], v[108:111], v[140:143], v[16:19]
    v_mfma_f32_16x16x32_bf16 v[32:35], v[108:111], v[120:123], v[32:35]
    s_waitcnt lgkmcnt(12)
    v_mfma_f32_16x16x32_bf16 v[20:23], v[116:119], v[140:143], v[20:23]
    s_waitcnt lgkmcnt(0)
    v_mov_b32 v165, 10
    s_mov_b64 exec, 1
    ds_write_b32 v4, v165 offset:0
    s_mov_b64 exec, -1
    s_nop 0
    v_mfma_f32_16x16x32_bf16 v[36:39], v[116:119], v[120:123], v[36:39]
    v_mfma_f32_16x16x32_bf16 v[24:27], v[96:99], v[140:143], v[24:27]
    v_mfma_f32_16x16x32_bf16 v[40:43], v[96:99], v[120:123], v[40:43]
    v_mfma_f32_16x16x32_bf16 v[28:31], v[68:71], v[140:143], v[28:31]
    v_mfma_f32_16x16x32_bf16 v[44:47], v[68:71], v[120:123], v[44:47]
    v_mfma_f32_16x16x32_bf16 v[16:19], v[56:59], v[144:147], v[16:19]
    v_mfma_f32_16x16x32_bf16 v[32:35], v[56:59], v[156:159], v[32:35]
    v_mfma_f32_16x16x32_bf16 v[20:23], v[72:75], v[144:147], v[20:23]
    v_mfma_f32_16x16x32_bf16 v[36:39], v[72:75], v[156:159], v[36:39]
    v_mfma_f32_16x16x32_bf16 v[24:27], v[124:127], v[144:147], v[24:27]
    v_mfma_f32_16x16x32_bf16 v[40:43], v[124:127], v[156:159], v[40:43]
    v_mfma_f32_16x16x32_bf16 v[28:31], v[152:155], v[144:147], v[28:31]
    v_mfma_f32_16x16x32_bf16 v[44:47], v[152:155], v[156:159], v[44:47]
    s_setprio 3
    s_mov_b32 s40, 0x21317218
    s_mov_b32 s41, s40
    s_mov_b32 s74, 0x358637bd
    s_mov_b32 s75, s74
    s_mov_b32 s76, 0x5d800000
    s_mov_b32 s77, s76
    v_and_b32 v2, 15, v0
    v_lshlrev_b32 v2, 2, v2
    s_lshl_b32 s42, s3, 7
    s_add_u32 s42, s42, 155648
    v_add_u32 v2, s42, v2
    v_add_u32 v3, 1024, v2
    v_and_b32_e64 v5, 0x30, v0
    v_add_u32 v5, 158208, v5

    ds_read2_b32 v[48:49], v2 offset0:0 offset1:0
    ds_read2_b32 v[50:51], v2 offset0:16 offset1:16
    ds_read_b128 v[56:59], v5 offset:0
    ds_read_b128 v[60:63], v5 offset:64
    ds_read_b128 v[64:67], v5 offset:128
    ds_read_b128 v[68:71], v5 offset:192
    ds_read2_b32 v[52:53], v3 offset0:0 offset1:0
    ds_read2_b32 v[54:55], v3 offset0:16 offset1:16
    v_lshlrev_b32 v6, 4, v0
    v_lshlrev_b32 v8, 2, v0
    v_add_u32 v8, 40960, v8
    s_lshl_b32 s79, s32, 18
    s_lshl_b32 s80, s3, 16
    s_add_u32 s79, s79, s80
    s_lshl_b32 s80, s10, 11
    s_add_u32 s79, s79, s80
    s_add_u32 s80, s79, 0x8000
    s_lshl_b32 s45, s32, 2
    s_add_u32 s45, s45, s3
    s_lshl_b32 s45, s45, 10
    s_mov_b32 s46, 0x3fb8aa3b
    v_mov_b32 v11, 0x35c1a2a0

    s_add_u32 s54, s45, 0x835000
    s_add_u32 s54, s72, s54
    s_addc_u32 s55, s73, 0
    s_waitcnt lgkmcnt(5)
    v_pk_fma_f32 v[16:17], v[56:57], v[48:49], v[16:17]
    v_pk_fma_f32 v[18:19], v[58:59], v[48:49], v[18:19]
    v_pk_fma_f32 v[32:33], v[56:57], v[50:51], v[32:33]
    v_pk_fma_f32 v[34:35], v[58:59], v[50:51], v[34:35]
    s_waitcnt lgkmcnt(4)
    v_pk_fma_f32 v[20:21], v[60:61], v[48:49], v[20:21]
    v_pk_fma_f32 v[22:23], v[62:63], v[48:49], v[22:23]
    v_pk_fma_f32 v[36:37], v[60:61], v[50:51], v[36:37]
    v_pk_fma_f32 v[38:39], v[62:63], v[50:51], v[38:39]
    s_waitcnt lgkmcnt(3)
    s_branch IW_s2
IW_w2:
    s_branch IW_r2
IW_s2:
    v_pk_fma_f32 v[24:25], v[64:65], v[48:49], v[24:25]
    v_pk_fma_f32 v[26:27], v[66:67], v[48:49], v[26:27]
    v_pk_fma_f32 v[40:41], v[64:65], v[50:51], v[40:41]
    v_pk_fma_f32 v[42:43], v[66:67], v[50:51], v[42:43]
    s_waitcnt lgkmcnt(2)
    v_pk_fma_f32 v[28:29], v[68:69], v[48:49], v[28:29]
    v_pk_fma_f32 v[30:31], v[70:71], v[48:49], v[30:31]
    v_pk_fma_f32 v[44:45], v[68:69], v[50:51], v[44:45]
    v_pk_fma_f32 v[46:47], v[70:71], v[50:51], v[46:47]
    s_waitcnt lgkmcnt(1)
    s_nop 0
    v_pk_mul_f32 v[16:17], v[16:17], v[52:53]
    v_pk_mul_f32 v[18:19], v[18:19], v[52:53]
    v_pk_mul_f32 v[20:21], v[20:21], v[52:53]
    v_pk_mul_f32 v[22:23], v[22:23], v[52:53]
    v_pk_mul_f32 v[24:25], v[24:25], v[52:53]
    v_pk_mul_f32 v[26:27], v[26:27], v[52:53]
    v_pk_mul_f32 v[28:29], v[28:29], v[52:53]
    v_pk_mul_f32 v[30:31], v[30:31], v[52:53]
    s_waitcnt lgkmcnt(0)
    s_nop 0
    v_pk_mul_f32 v[32:33], v[32:33], v[54:55]
    v_pk_mul_f32 v[34:35], v[34:35], v[54:55]
    v_pk_mul_f32 v[36:37], v[36:37], v[54:55]
    v_pk_mul_f32 v[38:39], v[38:39], v[54:55]
    v_pk_mul_f32 v[40:41], v[40:41], v[54:55]
    v_pk_mul_f32 v[42:43], v[42:43], v[54:55]
    v_pk_mul_f32 v[44:45], v[44:45], v[54:55]
    v_pk_mul_f32 v[46:47], v[46:47], v[54:55]
    v_exp_f32 v80, v16 clamp
    v_exp_f32 v81, v17 clamp
    v_exp_f32 v82, v18 clamp
    v_exp_f32 v83, v19 clamp
    v_exp_f32 v84, v20 clamp
    v_exp_f32 v85, v21 clamp
    v_exp_f32 v86, v22 clamp
    v_exp_f32 v87, v23 clamp
    v_exp_f32 v88, v24 clamp
    v_exp_f32 v89, v25 clamp
    v_exp_f32 v90, v26 clamp
    v_exp_f32 v91, v27 clamp
    v_exp_f32 v92, v28 clamp
    v_exp_f32 v93, v29 clamp
    v_exp_f32 v94, v30 clamp
    v_exp_f32 v95, v31 clamp
    v_exp_f32 v96, v32 clamp
    v_exp_f32 v97, v33 clamp
    v_exp_f32 v98, v34 clamp
    v_exp_f32 v99, v35 clamp
    v_exp_f32 v100, v36 clamp
    v_exp_f32 v101, v37 clamp
    v_exp_f32 v102, v38 clamp
    v_exp_f32 v103, v39 clamp
    v_exp_f32 v104, v40 clamp
    v_exp_f32 v105, v41 clamp
    v_exp_f32 v106, v42 clamp
    v_exp_f32 v107, v43 clamp
    v_exp_f32 v108, v44 clamp
    v_exp_f32 v109, v45 clamp
    v_exp_f32 v110, v46 clamp
    v_exp_f32 v111, v47 clamp
    v_pk_mul_f32 v[16:17], v[16:17], s[40:41] clamp
    v_pk_mul_f32 v[18:19], v[18:19], s[40:41] clamp
    v_pk_mul_f32 v[20:21], v[20:21], s[40:41] clamp
    v_pk_mul_f32 v[22:23], v[22:23], s[40:41] clamp
    v_pk_mul_f32 v[24:25], v[24:25], s[40:41] clamp
    v_pk_mul_f32 v[26:27], v[26:27], s[40:41] clamp
    v_pk_mul_f32 v[28:29], v[28:29], s[40:41] clamp
    v_pk_mul_f32 v[30:31], v[30:31], s[40:41] clamp
    v_pk_mul_f32 v[32:33], v[32:33], s[40:41] clamp
    v_pk_mul_f32 v[34:35], v[34:35], s[40:41] clamp
    v_pk_mul_f32 v[36:37], v[36:37], s[40:41] clamp
    v_pk_mul_f32 v[38:39], v[38:39], s[40:41] clamp
    v_pk_mul_f32 v[40:41], v[40:41], s[40:41] clamp
    v_pk_mul_f32 v[42:43], v[42:43], s[40:41] clamp
    v_pk_mul_f32 v[44:45], v[44:45], s[40:41] clamp
    v_pk_mul_f32 v[46:47], v[46:47], s[40:41] clamp
    v_pk_add_f32 v[80:81], v[80:81], s[74:75]
    v_pk_add_f32 v[82:83], v[82:83], s[74:75]
    v_pk_add_f32 v[84:85], v[84:85], s[74:75]
    v_pk_add_f32 v[86:87], v[86:87], s[74:75]
    v_pk_add_f32 v[88:89], v[88:89], s[74:75]
    v_pk_add_f32 v[90:91], v[90:91], s[74:75]
    v_pk_add_f32 v[92:93], v[92:93], s[74:75]
    v_pk_add_f32 v[94:95], v[94:95], s[74:75]
    v_pk_add_f32 v[96:97], v[96:97], s[74:75]
    v_pk_add_f32 v[98:99], v[98:99], s[74:75]
    v_pk_add_f32 v[100:101], v[100:101], s[74:75]
    v_pk_add_f32 v[102:103], v[102:103], s[74:75]
    v_pk_add_f32 v[104:105], v[104:105], s[74:75]
    v_pk_add_f32 v[106:107], v[106:107], s[74:75]
    v_pk_add_f32 v[108:109], v[108:109], s[74:75]
    v_pk_add_f32 v[110:111], v[110:111], s[74:75]
    v_pk_fma_f32 v[16:17], v[16:17], s[76:77], v[80:81]
    v_pk_fma_f32 v[18:19], v[18:19], s[76:77], v[82:83]
    v_pk_fma_f32 v[20:21], v[20:21], s[76:77], v[84:85]
    v_pk_fma_f32 v[22:23], v[22:23], s[76:77], v[86:87]
    v_pk_fma_f32 v[24:25], v[24:25], s[76:77], v[88:89]
    v_pk_fma_f32 v[26:27], v[26:27], s[76:77], v[90:91]
    v_pk_fma_f32 v[28:29], v[28:29], s[76:77], v[92:93]
    v_pk_fma_f32 v[30:31], v[30:31], s[76:77], v[94:95]
    v_pk_fma_f32 v[32:33], v[32:33], s[76:77], v[96:97]
    v_pk_fma_f32 v[34:35], v[34:35], s[76:77], v[98:99]
    v_pk_fma_f32 v[36:37], v[36:37], s[76:77], v[100:101]
    v_pk_fma_f32 v[38:39], v[38:39], s[76:77], v[102:103]
    v_pk_fma_f32 v[40:41], v[40:41], s[76:77], v[104:105]
    v_pk_fma_f32 v[42:43], v[42:43], s[76:77], v[106:107]
    v_pk_fma_f32 v[44:45], v[44:45], s[76:77], v[108:109]
    v_pk_fma_f32 v[46:47], v[46:47], s[76:77], v[110:111]
    v_cvt_pk_bf16_f32 v112, v16, v17
    v_cvt_pk_bf16_f32 v113, v18, v19
    v_cvt_pk_bf16_f32 v114, v20, v21
    v_cvt_pk_bf16_f32 v115, v22, v23
    v_cvt_pk_bf16_f32 v116, v24, v25
    v_cvt_pk_bf16_f32 v117, v26, v27
    v_cvt_pk_bf16_f32 v118, v28, v29
    v_cvt_pk_bf16_f32 v119, v30, v31
    v_cvt_pk_bf16_f32 v120, v32, v33
    v_cvt_pk_bf16_f32 v121, v34, v35
    v_cvt_pk_bf16_f32 v122, v36, v37
    v_cvt_pk_bf16_f32 v123, v38, v39
    v_cvt_pk_bf16_f32 v124, v40, v41
    v_cvt_pk_bf16_f32 v125, v42, v43
    v_cvt_pk_bf16_f32 v126, v44, v45
    v_cvt_pk_bf16_f32 v127, v46, v47
    v_and_b32 v9, 0xfffffff7, v1
    v_and_b32 v5, 0x30, v0
    v_add_u32 v5, 159232, v5
    ds_read_b32 v7, v9 offset:128
FW_7:
    s_waitcnt lgkmcnt(0)
    v_cmp_gt_u32 vcc, 1, v7
    s_cbranch_vccz FO_8
    s_sleep 1
    ds_read_b32 v7, v9 offset:128
    s_branch FW_7
FO_8:
    ds_read_b32 v7, v9 offset:128
FW_9:
    s_waitcnt lgkmcnt(0)
    v_cmp_gt_u32 vcc, 2, v7
    s_cbranch_vccz FO_10
    ds_read_b32 v7, v9 offset:128
    s_branch FW_9
FO_10:
    s_nop 0
    ds_read_b128 v[32:35], v5 offset:0
    ds_read_b128 v[36:39], v5 offset:64
    ds_read2st64_b32 v[16:17], v8 offset0:0 offset1:1
    ds_read2st64_b32 v[18:19], v8 offset0:2 offset1:3
    ds_read2st64_b32 v[20:21], v8 offset0:4 offset1:5
    ds_read2st64_b32 v[22:23], v8 offset0:6 offset1:7
    ds_read2st64_b32 v[24:25], v8 offset0:16 offset1:17
    ds_read2st64_b32 v[26:27], v8 offset0:18 offset1:19
    ds_read2st64_b32 v[28:29], v8 offset0:20 offset1:21
    ds_read2st64_b32 v[30:31], v8 offset0:22 offset1:23
    s_waitcnt lgkmcnt(5)
    s_nop 0
    ds_read_b128 v[56:59], v5 offset:128
    ds_read_b128 v[60:63], v5 offset:192
    ds_read2st64_b32 v[40:41], v8 offset0:8 offset1:9
    ds_read2st64_b32 v[42:43], v8 offset0:10 offset1:11
    ds_read2st64_b32 v[44:45], v8 offset0:12 offset1:13
    ds_read2st64_b32 v[46:47], v8 offset0:14 offset1:15
    ds_read2st64_b32 v[48:49], v8 offset0:24 offset1:25
    ds_read2st64_b32 v[50:51], v8 offset0:26 offset1:27
    ds_read2st64_b32 v[52:53], v8 offset0:28 offset1:29
    ds_read2st64_b32 v[54:55], v8 offset0:30 offset1:31
    s_waitcnt lgkmcnt(10)
    v_cvt_pk_bf16_f32 v136, v32, v33
    v_cvt_pk_bf16_f32 v137, v34, v35
    v_cvt_pk_bf16_f32 v138, v36, v37
    v_cvt_pk_bf16_f32 v139, v38, v39
    s_nop 1
    v_mfma_f32_16x16x32_bf16 v[72:75], v[136:139], v[112:115], 0
    v_mfma_f32_16x16x32_bf16 v[84:87], v[136:139], v[120:123], 0
    v_cvt_pk_bf16_f32 v128, v16, v17
    v_cvt_pk_bf16_f32 v129, v18, v19
    v_cvt_pk_bf16_f32 v130, v20, v21
    v_cvt_pk_bf16_f32 v131, v22, v23
    s_nop 1
    v_mfma_f32_16x16x32_bf16 v[64:67], v[128:131], v[112:115], 0
    v_mfma_f32_16x16x32_bf16 v[76:79], v[128:131], v[120:123], 0
    v_cvt_pk_bf16_f32 v132, v24, v25
    v_cvt_pk_bf16_f32 v133, v26, v27
    v_cvt_pk_bf16_f32 v134, v28, v29
    v_cvt_pk_bf16_f32 v135, v30, v31
    s_nop 1
    v_mfma_f32_16x16x32_bf16 v[68:71], v[132:135], v[112:115], 0
    v_mfma_f32_16x16x32_bf16 v[80:83], v[132:135], v[120:123], 0
    s_waitcnt lgkmcnt(0)
    v_cvt_pk_bf16_f32 v148, v56, v57
    v_cvt_pk_bf16_f32 v149, v58, v59
    v_cvt_pk_bf16_f32 v150, v60, v61
    v_cvt_pk_bf16_f32 v151, v62, v63
    v_fma_f32 v72, v72, s46, v11
    v_rcp_f32 v72, v72
    v_fma_f32 v84, v84, s46, v11
    v_rcp_f32 v84, v84
    v_mfma_f32_16x16x32_bf16 v[96:99], v[148:151], v[116:119], 0
    v_mfma_f32_16x16x32_bf16 v[108:111], v[148:151], v[124:127], 0
    v_cvt_pk_bf16_f32 v140, v40, v41
    v_cvt_pk_bf16_f32 v141, v42, v43
    v_cvt_pk_bf16_f32 v142, v44, v45
    v_cvt_pk_bf16_f32 v143, v46, v47
    s_nop 1
    v_mfma_f32_16x16x32_bf16 v[88:91], v[140:143], v[116:119], 0
    v_mfma_f32_16x16x32_bf16 v[100:103], v[140:143], v[124:127], 0
    v_mul_f32 v64, v64, v72
    v_mul_f32 v65, v65, v72
    v_mul_f32 v66, v66, v72
    v_mul_f32 v67, v67, v72
    v_mul_f32 v68, v68, v72
    v_mul_f32 v69, v69, v72
    v_mul_f32 v70, v70, v72
    v_mul_f32 v71, v71, v72
    v_cvt_pk_bf16_f32 v16, v64, v65
    v_cvt_pk_bf16_f32 v17, v66, v67
    v_cvt_pk_bf16_f32 v18, v68, v69
    v_cvt_pk_bf16_f32 v19, v70, v71
    buffer_store_dwordx4 v[16:19], v6, s[16:19], s79 offen offset:0 sc0 sc1
    v_cvt_pk_bf16_f32 v144, v48, v49
    v_cvt_pk_bf16_f32 v145, v50, v51
    v_cvt_pk_bf16_f32 v146, v52, v53
    v_cvt_pk_bf16_f32 v147, v54, v55
    s_nop 1
    v_mfma_f32_16x16x32_bf16 v[92:95], v[144:147], v[116:119], 0
    v_mfma_f32_16x16x32_bf16 v[104:107], v[144:147], v[124:127], 0
    v_mul_f32 v76, v76, v84
    v_mul_f32 v77, v77, v84
    v_mul_f32 v78, v78, v84
    v_mul_f32 v79, v79, v84
    v_mul_f32 v80, v80, v84
    v_mul_f32 v81, v81, v84
    v_mul_f32 v82, v82, v84
    v_mul_f32 v83, v83, v84
    v_cvt_pk_bf16_f32 v20, v76, v77
    v_cvt_pk_bf16_f32 v21, v78, v79
    v_cvt_pk_bf16_f32 v22, v80, v81
    v_cvt_pk_bf16_f32 v23, v82, v83
    buffer_store_dwordx4 v[20:23], v6, s[16:19], s80 offen offset:0 sc0 sc1
    v_fma_f32 v96, v96, s46, v11
    v_rcp_f32 v96, v96
    v_fma_f32 v108, v108, s46, v11
    v_rcp_f32 v108, v108
    v_mul_f32 v88, v88, v96
    v_mul_f32 v89, v89, v96
    v_mul_f32 v90, v90, v96
    v_mul_f32 v91, v91, v96
    v_mul_f32 v92, v92, v96
    v_mul_f32 v93, v93, v96
    v_mul_f32 v94, v94, v96
    v_mul_f32 v95, v95, v96
    v_cvt_pk_bf16_f32 v24, v88, v89
    v_cvt_pk_bf16_f32 v25, v90, v91
    v_cvt_pk_bf16_f32 v26, v92, v93
    v_cvt_pk_bf16_f32 v27, v94, v95
    buffer_store_dwordx4 v[24:27], v6, s[16:19], s79 offen offset:1024 sc0 sc1
    v_mul_f32 v100, v100, v108
    v_mul_f32 v101, v101, v108
    v_mul_f32 v102, v102, v108
    v_mul_f32 v103, v103, v108
    v_mul_f32 v104, v104, v108
    v_mul_f32 v105, v105, v108
    v_mul_f32 v106, v106, v108
    v_mul_f32 v107, v107, v108
    v_cvt_pk_bf16_f32 v28, v100, v101
    v_cvt_pk_bf16_f32 v29, v102, v103
    v_cvt_pk_bf16_f32 v30, v104, v105
    v_cvt_pk_bf16_f32 v31, v106, v107
    buffer_store_dwordx4 v[28:31], v6, s[16:19], s80 offen offset:1024 sc0 sc1
    s_mov_b64 exec, 1
    ds_write_b32 v4, v164 offset:144
    s_waitcnt vmcnt(0)
    s_mov_b32 s45, 1
    s_atomic_add s45, s[54:55], 0x0
    s_atomic_add s45, s[54:55], 0x80
    s_atomic_add s45, s[54:55], 0x100
    s_atomic_add s45, s[54:55], 0x180
    ds_add_u32 v4, v164 offset:144
    s_mov_b64 exec, -1
    s_cmp_lg_u32 s3, 0
    s_cbranch_scc1 F_end
    s_setprio 3
    s_lshr_b32 s50, s29, 1
    s_lshl_b32 s50, s50, 2
    s_and_b32 s51, s28, 3
    s_add_u32 s50, s50, s51
    s_lshl_b32 s50, s50, 7
    s_add_u32 s56, s50, 0x845000
    s_add_u32 s56, s72, s56
    s_addc_u32 s57, s73, 0
    v_mov_b32 v2, 159096
    ds_read_b32 v7, v2 offset:0
FW_11:
    s_waitcnt lgkmcnt(0)
    v_cmp_gt_u32 vcc, 1, v7
    s_cbranch_vccz FO_12
    s_sleep 2
    ds_read_b32 v7, v2 offset:0
    s_branch FW_11
FO_12:
    v_and_b32 v2, 7, v0
    v_lshlrev_b32 v2, 2, v2
    v_add_u32 v2, 158976, v2
    ds_read_b32 v2, v2
    s_sub_u32 s51, 15, s28
    s_waitcnt lgkmcnt(0)
    v_bfe_u32 v2, v2, 7, 4
    v_cmp_eq_u32 vcc, s51, v2
    s_cbranch_vccz F_ny

    v_lshrrev_b32 v2, 4, v0
    v_and_b32 v6, 15, v0
    v_lshlrev_b32 v6, 4, v6
    v_lshl_add_u32 v2, v2, 12, v6
    s_lshl_b32 s50, s29, 8
    s_add_u32 s50, s50, 135168

SP_13:
    s_load_dword s58, s[56:57], 0 glc
    s_waitcnt lgkmcnt(0)
    s_cmp_ge_u32 s58, 32
    s_cbranch_scc1 SD_14
    s_sleep 2
    s_branch SP_13
SD_14:
    s_mov_b32 m0, 159744
    s_nop 0
    buffer_load_dwordx4 v2, s[24:27], s50 offen sc0 sc1 lds
    s_add_u32 s50, s50, 16384
    s_add_u32 m0, m0, 1024
    s_nop 0
    buffer_load_dwordx4 v2, s[24:27], s50 offen sc0 sc1 lds
    s_waitcnt vmcnt(0)
    v_mov_b32 v7, 1
    s_mov_b64 exec, 1
    ds_write_b32 v4, v7 offset:96
    s_mov_b64 exec, -1
F_ny:
F_end:
    s_endpgm
F_nl:
    s_sub_u32 s3, s3, 4
    s_setprio 2
    s_lshr_b32 s36, s3, 1
    s_and_b32 s37, s3, 1
    v_and_b32 v1, 15, v0
    v_lshrrev_b32 v2, 4, v0
    v_lshrrev_b32 v3, 1, v1
    v_xor_b32 v3, v3, v2
    v_lshlrev_b32 v3, 4, v3
    v_lshlrev_b32 v1, 7, v1
    s_lshl_b32 s38, s36, 13
    v_add3_u32 v4, v1, v3, s38
    v_xor_b32 v5, 64, v4
    v_add_u32 v6, 0x10000, v4
    v_add_u32 v7, 0x10000, v5
    v_bfe_u32 v1, v0, 2, 2
    v_lshl_add_u32 v3, v2, 3, v1
    v_lshrrev_b32 v1, 1, v1
    v_and_b32 v2, 1, v2
    v_lshl_add_u32 v1, v2, 1, v1
    s_lshl_b32 s38, s37, 1
    s_add_u32 s38, s38, s36
    v_xor_b32 v1, s38, v1
    v_lshlrev_b32 v1, 5, v1
    v_lshl_add_u32 v1, v3, 7, v1
    v_and_b32 v2, 3, v0
    v_lshl_add_u32 v1, v2, 3, v1
    v_add_u32 v8, 0x10000, v1
    v_xor_b32 v9, 32, v8
    v_add_u32 v10, 0x8000, v8
    v_add_u32 v11, 0x8000, v9
    s_mov_b32 s40, 0x21317218
    s_mov_b32 s41, s40
    s_mov_b32 s74, 0x358637bd
    s_mov_b32 s75, s74
    s_mov_b32 s76, 0x5d800000
    s_mov_b32 s77, s76
    v_and_b32 v164, 0x30, v0
    s_lshl_b32 s42, s36, 8
    s_add_u32 s42, s42, 155648
    v_add_u32 v164, s42, v164
    v_and_b32 v165, 15, v0
    v_lshlrev_b32 v165, 2, v165
    s_lshl_b32 s42, s38, 6
    s_add_u32 s42, s42, 158208
    v_add_u32 v165, s42, v165
    s_lshl_b32 s42, s3, 2
    s_add_u32 s42, s42, 159040
    v_mov_b32 v3, s42
    v_lshlrev_b32 v1, 2, v2
    v_add_u32 v1, 159040, v1
    v_xor_b32 v2, 64, v165
    s_lshl_b32 s44, s33, 1
    s_add_u32 s44, s44, s37
    s_mul_i32 s45, s44, 4224
    s_mul_i32 s46, s36, 3072
    s_add_u32 s46, s46, s45
    s_lshl_b32 s47, s36, 10
    s_add_u32 s47, s47, 1024
    s_add_u32 s47, s47, s45
    s_lshl_b32 s48, s36, 6
    s_add_u32 s48, s48, 4096
    s_add_u32 s48, s48, s45
    s_lshl_b32 s49, s44, 10
    s_lshl_b32 s52, s3, 11
    s_add_u32 s52, s52, 65536
    s_lshl_b32 s53, s3, 7
    s_lshl_b32 s43, s36, 6
    s_add_u32 s53, s53, s43
    s_add_u32 s53, s53, 159232
    s_mov_b32 s50, 159068
    s_waitcnt lgkmcnt(0)
    s_lshl_b32 s64, s28, 7
    s_lshl_b32 s65, s3, 5
    s_add_u32 s64, s64, s65
    s_lshl_b32 s42, s64, 11
    s_lshl_b32 s65, s29, 7
    s_add_u32 s42, s42, s65
    s_add_u32 s43, s42, 0x8000
    s_lshl_b32 s66, s44, 1
    s_add_u32 s66, s66, s36
    s_lshl_b32 s66, s66, 4
    s_add_u32 s66, s66, s32
    s_lshl_b32 s66, s66, 10

    s_mov_b32 s12, s4
    s_mov_b32 s13, s5
    s_mov_b32 s14, 0x400000
    s_mov_b32 s15, 0x00020000
    s_mov_b32 s16, s6
    s_mov_b32 s17, s7
    s_mov_b32 s18, 0x600000
    s_mov_b32 s19, 0x00020000
    s_mov_b32 s20, s8
    s_mov_b32 s21, s9
    s_mov_b32 s22, 0x200000
    s_mov_b32 s23, 0x00020000
    s_add_u32 s24, s72, 0x800000
    s_addc_u32 s25, s73, 0
    s_mov_b32 s26, 0x48000
    s_mov_b32 s27, 0x00020000
    s_add_u32 s84, s72, 0xa00000
    s_addc_u32 s85, s73, 0
    s_mov_b32 s86, 0x100000
    s_mov_b32 s87, 0x00020000
    s_barrier
    s_nop 0
    ds_read_b128 v[12:15], v4 offset:0
    ds_read_b64_tr_b16 v[44:45], v8 offset:0
    ds_read_b64_tr_b16 v[46:47], v8 offset:512
    ds_read_b128 v[16:19], v4 offset:2048
    ds_read_b128 v[20:23], v4 offset:4096
    ds_read_b128 v[24:27], v4 offset:6144
    ds_read_b64_tr_b16 v[48:49], v9 offset:0
    ds_read_b64_tr_b16 v[50:51], v9 offset:512
    ds_read_b64_tr_b16 v[52:53], v8 offset:8192
    ds_read_b64_tr_b16 v[54:55], v8 offset:8704
    ds_read_b64_tr_b16 v[56:57], v9 offset:8192
    ds_read_b64_tr_b16 v[58:59], v9 offset:8704
    s_waitcnt lgkmcnt(9)
    v_mfma_f32_16x16x32_bf16 v[100:103], v[12:15], v[44:47], 0
    ds_read_b128 v[28:31], v5 offset:0
    s_waitcnt lgkmcnt(9)
    v_mfma_f32_16x16x32_bf16 v[104:107], v[16:19], v[44:47], 0
    ds_read_b64_tr_b16 v[60:61], v8 offset:4096
    s_waitcnt lgkmcnt(9)
    v_mfma_f32_16x16x32_bf16 v[108:111], v[20:23], v[44:47], 0
    ds_read_b64_tr_b16 v[62:63], v8 offset:4608
    s_waitcnt lgkmcnt(9)
    v_mfma_f32_16x16x32_bf16 v[112:115], v[24:27], v[44:47], 0
    ds_read_b128 v[32:35], v5 offset:2048
    s_waitcnt lgkmcnt(8)
    s_nop 0
    v_mfma_f32_16x16x32_bf16 v[116:119], v[12:15], v[48:51], 0
    ds_read_b128 v[36:39], v5 offset:4096
    v_mfma_f32_16x16x32_bf16 v[120:123], v[16:19], v[48:51], 0
    ds_read_b128 v[40:43], v5 offset:6144
    v_mfma_f32_16x16x32_bf16 v[124:127], v[20:23], v[48:51], 0
    ds_read_b64_tr_b16 v[64:65], v9 offset:4096
    v_mfma_f32_16x16x32_bf16 v[128:131], v[24:27], v[48:51], 0
    ds_read_b64_tr_b16 v[66:67], v9 offset:4608
    s_waitcnt lgkmcnt(10)
    s_nop 0
    v_mfma_f32_16x16x32_bf16 v[132:135], v[12:15], v[52:55], 0
    ds_read_b64_tr_b16 v[44:45], v8 offset:12288
    v_mfma_f32_16x16x32_bf16 v[136:139], v[16:19], v[52:55], 0
    ds_read_b64_tr_b16 v[46:47], v8 offset:12800
    v_mfma_f32_16x16x32_bf16 v[140:143], v[20:23], v[52:55], 0
    ds_read_b64_tr_b16 v[48:49], v9 offset:12288
    v_mfma_f32_16x16x32_bf16 v[144:147], v[24:27], v[52:55], 0
    ds_read_b64_tr_b16 v[50:51], v9 offset:12800
    s_waitcnt lgkmcnt(12)
    v_mfma_f32_16x16x32_bf16 v[148:151], v[12:15], v[56:59], 0
    v_mfma_f32_16x16x32_bf16 v[152:155], v[16:19], v[56:59], 0
    v_mfma_f32_16x16x32_bf16 v[156:159], v[20:23], v[56:59], 0
    v_mfma_f32_16x16x32_bf16 v[160:163], v[24:27], v[56:59], 0
    s_waitcnt lgkmcnt(9)
    v_mfma_f32_16x16x32_bf16 v[100:103], v[28:31], v[60:63], v[100:103]
    s_waitcnt lgkmcnt(8)
    v_mfma_f32_16x16x32_bf16 v[104:107], v[32:35], v[60:63], v[104:107]
    s_waitcnt lgkmcnt(0)
    s_barrier
    s_nop 0
    v_mfma_f32_16x16x32_bf16 v[108:111], v[36:39], v[60:63], v[108:111]
    ds_read_b128 v[12:15], v4 offset:16384
    v_mfma_f32_16x16x32_bf16 v[112:115], v[40:43], v[60:63], v[112:115]
    ds_read_b64_tr_b16 v[52:53], v10 offset:0
    v_mfma_f32_16x16x32_bf16 v[116:119], v[28:31], v[64:67], v[116:119]
    ds_read_b64_tr_b16 v[54:55], v10 offset:512
    v_mfma_f32_16x16x32_bf16 v[120:123], v[32:35], v[64:67], v[120:123]
    ds_read_b128 v[16:19], v4 offset:18432
    v_mfma_f32_16x16x32_bf16 v[124:127], v[36:39], v[64:67], v[124:127]
    ds_read_b128 v[20:23], v4 offset:20480
    v_mfma_f32_16x16x32_bf16 v[128:131], v[40:43], v[64:67], v[128:131]
    ds_read_b128 v[24:27], v4 offset:22528
    v_mfma_f32_16x16x32_bf16 v[132:135], v[28:31], v[44:47], v[132:135]
    ds_read_b64_tr_b16 v[56:57], v11 offset:0
    v_mfma_f32_16x16x32_bf16 v[136:139], v[32:35], v[44:47], v[136:139]
    ds_read_b64_tr_b16 v[58:59], v11 offset:512
    v_mfma_f32_16x16x32_bf16 v[140:143], v[36:39], v[44:47], v[140:143]
    ds_read_b64_tr_b16 v[60:61], v10 offset:8192
    v_mfma_f32_16x16x32_bf16 v[144:147], v[40:43], v[44:47], v[144:147]
    ds_read_b64_tr_b16 v[62:63], v10 offset:8704
    v_mfma_f32_16x16x32_bf16 v[148:151], v[28:31], v[48:51], v[148:151]
    ds_read_b64_tr_b16 v[64:65], v11 offset:8192
    v_mfma_f32_16x16x32_bf16 v[152:155], v[32:35], v[48:51], v[152:155]
    ds_read_b64_tr_b16 v[66:67], v11 offset:8704
    v_mfma_f32_16x16x32_bf16 v[156:159], v[36:39], v[48:51], v[156:159]
    v_mfma_f32_16x16x32_bf16 v[160:163], v[40:43], v[48:51], v[160:163]
    s_waitcnt lgkmcnt(9)
    v_mfma_f32_16x16x32_bf16 v[100:103], v[12:15], v[52:55], v[100:103]
    ds_read_b128 v[28:31], v5 offset:16384
    s_waitcnt lgkmcnt(9)
    v_mfma_f32_16x16x32_bf16 v[104:107], v[16:19], v[52:55], v[104:107]
    ds_read_b64_tr_b16 v[44:45], v10 offset:4096
    s_waitcnt lgkmcnt(9)
    v_mfma_f32_16x16x32_bf16 v[108:111], v[20:23], v[52:55], v[108:111]
    ds_read_b64_tr_b16 v[46:47], v10 offset:4608
    s_waitcnt lgkmcnt(9)
    v_mfma_f32_16x16x32_bf16 v[112:115], v[24:27], v[52:55], v[112:115]
    ds_read_b128 v[32:35], v5 offset:18432
    s_waitcnt lgkmcnt(8)
    s_nop 0
    v_mfma_f32_16x16x32_bf16 v[116:119], v[12:15], v[56:59], v[116:119]
    ds_read_b128 v[36:39], v5 offset:20480
    v_mfma_f32_16x16x32_bf16 v[120:123], v[16:19], v[56:59], v[120:123]
    ds_read_b128 v[40:43], v5 offset:22528
    v_mfma_f32_16x16x32_bf16 v[124:127], v[20:23], v[56:59], v[124:127]
    ds_read_b64_tr_b16 v[48:49], v11 offset:4096
    v_mfma_f32_16x16x32_bf16 v[128:131], v[24:27], v[56:59], v[128:131]
    ds_read_b64_tr_b16 v[50:51], v11 offset:4608
    s_waitcnt lgkmcnt(10)
    s_nop 0
    v_mfma_f32_16x16x32_bf16 v[132:135], v[12:15], v[60:63], v[132:135]
    ds_read_b64_tr_b16 v[52:53], v10 offset:12288
    v_mfma_f32_16x16x32_bf16 v[136:139], v[16:19], v[60:63], v[136:139]
    ds_read_b64_tr_b16 v[54:55], v10 offset:12800
    v_mfma_f32_16x16x32_bf16 v[140:143], v[20:23], v[60:63], v[140:143]
    ds_read_b64_tr_b16 v[56:57], v11 offset:12288
    v_mfma_f32_16x16x32_bf16 v[144:147], v[24:27], v[60:63], v[144:147]
    ds_read_b64_tr_b16 v[58:59], v11 offset:12800
    s_waitcnt lgkmcnt(12)
    v_mfma_f32_16x16x32_bf16 v[148:151], v[12:15], v[64:67], v[148:151]
    v_mfma_f32_16x16x32_bf16 v[152:155], v[16:19], v[64:67], v[152:155]
    v_mfma_f32_16x16x32_bf16 v[156:159], v[20:23], v[64:67], v[156:159]
    v_mfma_f32_16x16x32_bf16 v[160:163], v[24:27], v[64:67], v[160:163]
    s_waitcnt lgkmcnt(9)
    v_mfma_f32_16x16x32_bf16 v[100:103], v[28:31], v[44:47], v[100:103]
    s_waitcnt lgkmcnt(8)
    v_mfma_f32_16x16x32_bf16 v[104:107], v[32:35], v[44:47], v[104:107]
    s_waitcnt lgkmcnt(0)
    s_barrier
    s_nop 0
    v_mfma_f32_16x16x32_bf16 v[108:111], v[36:39], v[44:47], v[108:111]
    ds_read_b128 v[12:15], v4 offset:32768
    v_mfma_f32_16x16x32_bf16 v[112:115], v[40:43], v[44:47], v[112:115]
    ds_read_b64_tr_b16 v[60:61], v10 offset:16384
    v_mfma_f32_16x16x32_bf16 v[116:119], v[28:31], v[48:51], v[116:119]
    ds_read_b64_tr_b16 v[62:63], v10 offset:16896
    v_mfma_f32_16x16x32_bf16 v[120:123], v[32:35], v[48:51], v[120:123]
    ds_read_b128 v[16:19], v4 offset:34816
    v_mfma_f32_16x16x32_bf16 v[124:127], v[36:39], v[48:51], v[124:127]
    ds_read_b128 v[20:23], v4 offset:36864
    v_mfma_f32_16x16x32_bf16 v[128:131], v[40:43], v[48:51], v[128:131]
    ds_read_b128 v[24:27], v4 offset:38912
    v_mfma_f32_16x16x32_bf16 v[132:135], v[28:31], v[52:55], v[132:135]
    ds_read_b64_tr_b16 v[64:65], v11 offset:16384
    v_mfma_f32_16x16x32_bf16 v[136:139], v[32:35], v[52:55], v[136:139]
    ds_read_b64_tr_b16 v[66:67], v11 offset:16896
    v_mfma_f32_16x16x32_bf16 v[140:143], v[36:39], v[52:55], v[140:143]
    ds_read_b64_tr_b16 v[44:45], v10 offset:24576
    v_mfma_f32_16x16x32_bf16 v[144:147], v[40:43], v[52:55], v[144:147]
    ds_read_b64_tr_b16 v[46:47], v10 offset:25088
    v_mfma_f32_16x16x32_bf16 v[148:151], v[28:31], v[56:59], v[148:151]
    ds_read_b64_tr_b16 v[48:49], v11 offset:24576
    v_mfma_f32_16x16x32_bf16 v[152:155], v[32:35], v[56:59], v[152:155]
    ds_read_b64_tr_b16 v[50:51], v11 offset:25088
    v_mfma_f32_16x16x32_bf16 v[156:159], v[36:39], v[56:59], v[156:159]
    v_mfma_f32_16x16x32_bf16 v[160:163], v[40:43], v[56:59], v[160:163]
    s_waitcnt lgkmcnt(9)
    v_mfma_f32_16x16x32_bf16 v[100:103], v[12:15], v[60:63], v[100:103]
    ds_read_b128 v[28:31], v5 offset:32768
    s_waitcnt lgkmcnt(9)
    v_mfma_f32_16x16x32_bf16 v[104:107], v[16:19], v[60:63], v[104:107]
    ds_read_b64_tr_b16 v[52:53], v10 offset:20480
    s_waitcnt lgkmcnt(9)
    v_mfma_f32_16x16x32_bf16 v[108:111], v[20:23], v[60:63], v[108:111]
    ds_read_b64_tr_b16 v[54:55], v10 offset:20992
    s_waitcnt lgkmcnt(9)
    v_mfma_f32_16x16x32_bf16 v[112:115], v[24:27], v[60:63], v[112:115]
    ds_read_b128 v[32:35], v5 offset:34816
    s_waitcnt lgkmcnt(8)
    s_nop 0
    v_mfma_f32_16x16x32_bf16 v[116:119], v[12:15], v[64:67], v[116:119]
    ds_read_b128 v[36:39], v5 offset:36864
    v_mfma_f32_16x16x32_bf16 v[120:123], v[16:19], v[64:67], v[120:123]
    ds_read_b128 v[40:43], v5 offset:38912
    v_mfma_f32_16x16x32_bf16 v[124:127], v[20:23], v[64:67], v[124:127]
    ds_read_b64_tr_b16 v[56:57], v11 offset:20480
    v_mfma_f32_16x16x32_bf16 v[128:131], v[24:27], v[64:67], v[128:131]
    ds_read_b64_tr_b16 v[58:59], v11 offset:20992
    s_waitcnt lgkmcnt(10)
    s_nop 0
    v_mfma_f32_16x16x32_bf16 v[132:135], v[12:15], v[44:47], v[132:135]
    ds_read_b64_tr_b16 v[60:61], v10 offset:28672
    v_mfma_f32_16x16x32_bf16 v[136:139], v[16:19], v[44:47], v[136:139]
    s_branch IW_s3
IW_w3:
    s_branch IW_r3
IW_s3:
    ds_read_b64_tr_b16 v[62:63], v10 offset:29184
    v_mfma_f32_16x16x32_bf16 v[140:143], v[20:23], v[44:47], v[140:143]
    ds_read_b64_tr_b16 v[64:65], v11 offset:28672
    v_mfma_f32_16x16x32_bf16 v[144:147], v[24:27], v[44:47], v[144:147]
    ds_read_b64_tr_b16 v[66:67], v11 offset:29184
    s_waitcnt lgkmcnt(12)
    v_mfma_f32_16x16x32_bf16 v[148:151], v[12:15], v[48:51], v[148:151]
    v_mfma_f32_16x16x32_bf16 v[152:155], v[16:19], v[48:51], v[152:155]
    v_mfma_f32_16x16x32_bf16 v[156:159], v[20:23], v[48:51], v[156:159]
    v_mfma_f32_16x16x32_bf16 v[160:163], v[24:27], v[48:51], v[160:163]
    s_waitcnt lgkmcnt(9)
    v_mfma_f32_16x16x32_bf16 v[100:103], v[28:31], v[52:55], v[100:103]
    s_waitcnt lgkmcnt(8)
    v_mfma_f32_16x16x32_bf16 v[104:107], v[32:35], v[52:55], v[104:107]
    s_waitcnt lgkmcnt(0)
    s_barrier
    s_nop 0
    v_mfma_f32_16x16x32_bf16 v[108:111], v[36:39], v[52:55], v[108:111]
    ds_read_b128 v[12:15], v4 offset:49152
    v_mfma_f32_16x16x32_bf16 v[112:115], v[40:43], v[52:55], v[112:115]
    ds_read_b64_tr_b16 v[44:45], v10 offset:32768
    v_mfma_f32_16x16x32_bf16 v[116:119], v[28:31], v[56:59], v[116:119]
    ds_read_b64_tr_b16 v[46:47], v10 offset:33280
    v_mfma_f32_16x16x32_bf16 v[120:123], v[32:35], v[56:59], v[120:123]
    ds_read_b128 v[16:19], v4 offset:51200
    v_mfma_f32_16x16x32_bf16 v[124:127], v[36:39], v[56:59], v[124:127]
    ds_read_b128 v[20:23], v4 offset:53248
    v_mfma_f32_16x16x32_bf16 v[128:131], v[40:43], v[56:59], v[128:131]
    ds_read_b128 v[24:27], v4 offset:55296
    v_mfma_f32_16x16x32_bf16 v[132:135], v[28:31], v[60:63], v[132:135]
    ds_read_b64_tr_b16 v[48:49], v11 offset:32768
    v_mfma_f32_16x16x32_bf16 v[136:139], v[32:35], v[60:63], v[136:139]
    ds_read_b64_tr_b16 v[50:51], v11 offset:33280
    v_mfma_f32_16x16x32_bf16 v[140:143], v[36:39], v[60:63], v[140:143]
    ds_read_b64_tr_b16 v[52:53], v8 offset:0
    v_mfma_f32_16x16x32_bf16 v[144:147], v[40:43], v[60:63], v[144:147]
    ds_read_b64_tr_b16 v[54:55], v8 offset:512
    v_mfma_f32_16x16x32_bf16 v[148:151], v[28:31], v[64:67], v[148:151]
    ds_read_b64_tr_b16 v[56:57], v9 offset:0
    v_mfma_f32_16x16x32_bf16 v[152:155], v[32:35], v[64:67], v[152:155]
    ds_read_b64_tr_b16 v[58:59], v9 offset:512
    v_mfma_f32_16x16x32_bf16 v[156:159], v[36:39], v[64:67], v[156:159]
    v_mfma_f32_16x16x32_bf16 v[160:163], v[40:43], v[64:67], v[160:163]
    s_waitcnt lgkmcnt(9)
    v_mfma_f32_16x16x32_bf16 v[100:103], v[12:15], v[44:47], v[100:103]
    ds_read_b128 v[28:31], v5 offset:49152
    s_waitcnt lgkmcnt(9)
    v_mfma_f32_16x16x32_bf16 v[104:107], v[16:19], v[44:47], v[104:107]
    ds_read_b64_tr_b16 v[60:61], v10 offset:36864
    s_waitcnt lgkmcnt(9)
    v_mfma_f32_16x16x32_bf16 v[108:111], v[20:23], v[44:47], v[108:111]
    ds_read_b64_tr_b16 v[62:63], v10 offset:37376
    s_waitcnt lgkmcnt(9)
    v_mfma_f32_16x16x32_bf16 v[112:115], v[24:27], v[44:47], v[112:115]
    ds_read_b128 v[32:35], v5 offset:51200
    s_waitcnt lgkmcnt(8)
    s_nop 0
    v_mfma_f32_16x16x32_bf16 v[116:119], v[12:15], v[48:51], v[116:119]
    ds_read_b128 v[36:39], v5 offset:53248
    v_mfma_f32_16x16x32_bf16 v[120:123], v[16:19], v[48:51], v[120:123]
    ds_read_b128 v[40:43], v5 offset:55296
    v_mfma_f32_16x16x32_bf16 v[124:127], v[20:23], v[48:51], v[124:127]
    ds_read_b64_tr_b16 v[64:65], v11 offset:36864
    v_mfma_f32_16x16x32_bf16 v[128:131], v[24:27], v[48:51], v[128:131]
    ds_read_b64_tr_b16 v[66:67], v11 offset:37376
    s_waitcnt lgkmcnt(10)
    s_nop 0
    v_mfma_f32_16x16x32_bf16 v[132:135], v[12:15], v[52:55], v[132:135]
    ds_read_b64_tr_b16 v[44:45], v8 offset:4096
    v_mfma_f32_16x16x32_bf16 v[136:139], v[16:19], v[52:55], v[136:139]
    ds_read_b64_tr_b16 v[46:47], v8 offset:4608
    v_mfma_f32_16x16x32_bf16 v[140:143], v[20:23], v[52:55], v[140:143]
    ds_read_b64_tr_b16 v[48:49], v9 offset:4096
    v_mfma_f32_16x16x32_bf16 v[144:147], v[24:27], v[52:55], v[144:147]
    ds_read_b64_tr_b16 v[50:51], v9 offset:4608
    s_waitcnt lgkmcnt(12)
    v_mfma_f32_16x16x32_bf16 v[148:151], v[12:15], v[56:59], v[148:151]
    v_mfma_f32_16x16x32_bf16 v[152:155], v[16:19], v[56:59], v[152:155]
    v_mfma_f32_16x16x32_bf16 v[156:159], v[20:23], v[56:59], v[156:159]
    v_mfma_f32_16x16x32_bf16 v[160:163], v[24:27], v[56:59], v[160:163]
    s_waitcnt lgkmcnt(9)
    v_mfma_f32_16x16x32_bf16 v[100:103], v[28:31], v[60:63], v[100:103]
    s_waitcnt lgkmcnt(8)
    v_mfma_f32_16x16x32_bf16 v[104:107], v[32:35], v[60:63], v[104:107]
    s_waitcnt lgkmcnt(0)
    s_barrier
    s_nop 0
    v_mfma_f32_16x16x32_bf16 v[108:111], v[36:39], v[60:63], v[108:111]
    ds_read_b128 v[12:15], v4 offset:0
    v_mfma_f32_16x16x32_bf16 v[112:115], v[40:43], v[60:63], v[112:115]
    ds_read_b64_tr_b16 v[52:53], v8 offset:8192
    v_mfma_f32_16x16x32_bf16 v[116:119], v[28:31], v[64:67], v[116:119]
    ds_read_b64_tr_b16 v[54:55], v8 offset:8704
    v_mfma_f32_16x16x32_bf16 v[120:123], v[32:35], v[64:67], v[120:123]
    ds_read_b128 v[16:19], v4 offset:2048
    v_mfma_f32_16x16x32_bf16 v[124:127], v[36:39], v[64:67], v[124:127]
    ds_read_b128 v[20:23], v4 offset:4096
    v_mfma_f32_16x16x32_bf16 v[128:131], v[40:43], v[64:67], v[128:131]
    ds_read_b128 v[24:27], v4 offset:6144
    v_mfma_f32_16x16x32_bf16 v[132:135], v[28:31], v[44:47], v[132:135]
    ds_read_b64_tr_b16 v[56:57], v9 offset:8192
    v_mfma_f32_16x16x32_bf16 v[136:139], v[32:35], v[44:47], v[136:139]
    ds_read_b64_tr_b16 v[58:59], v9 offset:8704
    v_mfma_f32_16x16x32_bf16 v[140:143], v[36:39], v[44:47], v[140:143]
    ds_read_b64_tr_b16 v[60:61], v8 offset:16384
    v_mfma_f32_16x16x32_bf16 v[144:147], v[40:43], v[44:47], v[144:147]
    ds_read_b64_tr_b16 v[62:63], v8 offset:16896
    v_mfma_f32_16x16x32_bf16 v[148:151], v[28:31], v[48:51], v[148:151]
    ds_read_b64_tr_b16 v[64:65], v9 offset:16384
    v_mfma_f32_16x16x32_bf16 v[152:155], v[32:35], v[48:51], v[152:155]
    ds_read_b64_tr_b16 v[66:67], v9 offset:16896
    v_mfma_f32_16x16x32_bf16 v[156:159], v[36:39], v[48:51], v[156:159]
    v_mfma_f32_16x16x32_bf16 v[160:163], v[40:43], v[48:51], v[160:163]
    s_waitcnt lgkmcnt(9)
    v_mfma_f32_16x16x32_bf16 v[100:103], v[12:15], v[52:55], v[100:103]
    ds_read_b128 v[28:31], v5 offset:0
    s_waitcnt lgkmcnt(9)
    v_mfma_f32_16x16x32_bf16 v[104:107], v[16:19], v[52:55], v[104:107]
    ds_read_b64_tr_b16 v[44:45], v8 offset:12288
    s_waitcnt lgkmcnt(9)
    v_mfma_f32_16x16x32_bf16 v[108:111], v[20:23], v[52:55], v[108:111]
    ds_read_b64_tr_b16 v[46:47], v8 offset:12800
    s_waitcnt lgkmcnt(9)
    v_mfma_f32_16x16x32_bf16 v[112:115], v[24:27], v[52:55], v[112:115]
    ds_read_b128 v[32:35], v5 offset:2048
    s_waitcnt lgkmcnt(8)
    s_nop 0
    v_mfma_f32_16x16x32_bf16 v[116:119], v[12:15], v[56:59], v[116:119]
    ds_read_b128 v[36:39], v5 offset:4096
    v_mfma_f32_16x16x32_bf16 v[120:123], v[16:19], v[56:59], v[120:123]
    ds_read_b128 v[40:43], v5 offset:6144
    v_mfma_f32_16x16x32_bf16 v[124:127], v[20:23], v[56:59], v[124:127]
    ds_read_b64_tr_b16 v[48:49], v9 offset:12288
    v_mfma_f32_16x16x32_bf16 v[128:131], v[24:27], v[56:59], v[128:131]
    ds_read_b64_tr_b16 v[50:51], v9 offset:12800
    s_waitcnt lgkmcnt(10)
    s_nop 0
    v_mfma_f32_16x16x32_bf16 v[132:135], v[12:15], v[60:63], v[132:135]
    ds_read_b64_tr_b16 v[52:53], v8 offset:20480
    v_mfma_f32_16x16x32_bf16 v[136:139], v[16:19], v[60:63], v[136:139]
    ds_read_b64_tr_b16 v[54:55], v8 offset:20992
    v_mfma_f32_16x16x32_bf16 v[140:143], v[20:23], v[60:63], v[140:143]
    ds_read_b64_tr_b16 v[56:57], v9 offset:20480
    v_mfma_f32_16x16x32_bf16 v[144:147], v[24:27], v[60:63], v[144:147]
    ds_read_b64_tr_b16 v[58:59], v9 offset:20992
    s_waitcnt lgkmcnt(12)
    v_mfma_f32_16x16x32_bf16 v[148:151], v[12:15], v[64:67], v[148:151]
    v_mfma_f32_16x16x32_bf16 v[152:155], v[16:19], v[64:67], v[152:155]
    v_mfma_f32_16x16x32_bf16 v[156:159], v[20:23], v[64:67], v[156:159]
    v_mfma_f32_16x16x32_bf16 v[160:163], v[24:27], v[64:67], v[160:163]
    s_waitcnt lgkmcnt(9)
    v_mfma_f32_16x16x32_bf16 v[100:103], v[28:31], v[44:47], v[100:103]
    s_waitcnt lgkmcnt(8)
    v_mfma_f32_16x16x32_bf16 v[104:107], v[32:35], v[44:47], v[104:107]
    s_waitcnt lgkmcnt(0)
    s_barrier
    s_nop 0
    v_mfma_f32_16x16x32_bf16 v[108:111], v[36:39], v[44:47], v[108:111]
    ds_read_b128 v[12:15], v4 offset:16384
    v_mfma_f32_16x16x32_bf16 v[112:115], v[40:43], v[44:47], v[112:115]
    ds_read_b64_tr_b16 v[60:61], v8 offset:24576
    v_mfma_f32_16x16x32_bf16 v[116:119], v[28:31], v[48:51], v[116:119]
    ds_read_b64_tr_b16 v[62:63], v8 offset:25088
    v_mfma_f32_16x16x32_bf16 v[120:123], v[32:35], v[48:51], v[120:123]
    ds_read_b128 v[16:19], v4 offset:18432
    v_mfma_f32_16x16x32_bf16 v[124:127], v[36:39], v[48:51], v[124:127]
    ds_read_b128 v[20:23], v4 offset:20480
    v_mfma_f32_16x16x32_bf16 v[128:131], v[40:43], v[48:51], v[128:131]
    ds_read_b128 v[24:27], v4 offset:22528
    v_mfma_f32_16x16x32_bf16 v[132:135], v[28:31], v[52:55], v[132:135]
    ds_read_b64_tr_b16 v[64:65], v9 offset:24576
    v_mfma_f32_16x16x32_bf16 v[136:139], v[32:35], v[52:55], v[136:139]
    ds_read_b64_tr_b16 v[66:67], v9 offset:25088
    v_mfma_f32_16x16x32_bf16 v[140:143], v[36:39], v[52:55], v[140:143]
    ds_read_b64_tr_b16 v[44:45], v10 offset:0
    v_mfma_f32_16x16x32_bf16 v[144:147], v[40:43], v[52:55], v[144:147]
    ds_read_b64_tr_b16 v[46:47], v10 offset:512
    v_mfma_f32_16x16x32_bf16 v[148:151], v[28:31], v[56:59], v[148:151]
    ds_read_b64_tr_b16 v[48:49], v11 offset:0
    v_mfma_f32_16x16x32_bf16 v[152:155], v[32:35], v[56:59], v[152:155]
    ds_read_b64_tr_b16 v[50:51], v11 offset:512
    v_mfma_f32_16x16x32_bf16 v[156:159], v[36:39], v[56:59], v[156:159]
    v_mfma_f32_16x16x32_bf16 v[160:163], v[40:43], v[56:59], v[160:163]
    s_waitcnt lgkmcnt(9)
    v_mfma_f32_16x16x32_bf16 v[100:103], v[12:15], v[60:63], v[100:103]
    ds_read_b128 v[28:31], v5 offset:16384
    s_waitcnt lgkmcnt(9)
    v_mfma_f32_16x16x32_bf16 v[104:107], v[16:19], v[60:63], v[104:107]
    ds_read_b64_tr_b16 v[52:53], v8 offset:28672
    s_waitcnt lgkmcnt(9)
    v_mfma_f32_16x16x32_bf16 v[108:111], v[20:23], v[60:63], v[108:111]
    ds_read_b64_tr_b16 v[54:55], v8 offset:29184
    s_waitcnt lgkmcnt(9)
    v_mfma_f32_16x16x32_bf16 v[112:115], v[24:27], v[60:63], v[112:115]
    ds_read_b128 v[32:35], v5 offset:18432
    s_waitcnt lgkmcnt(8)
    s_nop 0
    v_mfma_f32_16x16x32_bf16 v[116:119], v[12:15], v[64:67], v[116:119]
    ds_read_b128 v[36:39], v5 offset:20480
    v_mfma_f32_16x16x32_bf16 v[120:123], v[16:19], v[64:67], v[120:123]
    ds_read_b128 v[40:43], v5 offset:22528
    v_mfma_f32_16x16x32_bf16 v[124:127], v[20:23], v[64:67], v[124:127]
    ds_read_b64_tr_b16 v[56:57], v9 offset:28672
    v_mfma_f32_16x16x32_bf16 v[128:131], v[24:27], v[64:67], v[128:131]
    ds_read_b64_tr_b16 v[58:59], v9 offset:29184
    s_waitcnt lgkmcnt(10)
    s_nop 0
    v_mfma_f32_16x16x32_bf16 v[132:135], v[12:15], v[44:47], v[132:135]
    ds_read_b64_tr_b16 v[60:61], v10 offset:4096
    v_mfma_f32_16x16x32_bf16 v[136:139], v[16:19], v[44:47], v[136:139]
    ds_read_b64_tr_b16 v[62:63], v10 offset:4608
    v_mfma_f32_16x16x32_bf16 v[140:143], v[20:23], v[44:47], v[140:143]
    ds_read_b64_tr_b16 v[64:65], v11 offset:4096
    v_mfma_f32_16x16x32_bf16 v[144:147], v[24:27], v[44:47], v[144:147]
    ds_read_b64_tr_b16 v[66:67], v11 offset:4608
    s_waitcnt lgkmcnt(12)
    v_mfma_f32_16x16x32_bf16 v[148:151], v[12:15], v[48:51], v[148:151]
    v_mfma_f32_16x16x32_bf16 v[152:155], v[16:19], v[48:51], v[152:155]
    v_mfma_f32_16x16x32_bf16 v[156:159], v[20:23], v[48:51], v[156:159]
    v_mfma_f32_16x16x32_bf16 v[160:163], v[24:27], v[48:51], v[160:163]
    s_waitcnt lgkmcnt(9)
    v_mfma_f32_16x16x32_bf16 v[100:103], v[28:31], v[52:55], v[100:103]
    s_waitcnt lgkmcnt(8)
    v_mfma_f32_16x16x32_bf16 v[104:107], v[32:35], v[52:55], v[104:107]
    s_waitcnt lgkmcnt(0)
    s_barrier
    s_nop 0
    v_mfma_f32_16x16x32_bf16 v[108:111], v[36:39], v[52:55], v[108:111]
    ds_read_b128 v[12:15], v4 offset:32768
    v_mfma_f32_16x16x32_bf16 v[112:115], v[40:43], v[52:55], v[112:115]
    ds_read_b64_tr_b16 v[44:45], v10 offset:16384
    v_mfma_f32_16x16x32_bf16 v[116:119], v[28:31], v[56:59], v[116:119]
    ds_read_b64_tr_b16 v[46:47], v10 offset:16896
    v_mfma_f32_16x16x32_bf16 v[120:123], v[32:35], v[56:59], v[120:123]
    ds_read_b128 v[16:19], v4 offset:34816
    v_mfma_f32_16x16x32_bf16 v[124:127], v[36:39], v[56:59], v[124:127]
    ds_read_b128 v[20:23], v4 offset:36864
    v_mfma_f32_16x16x32_bf16 v[128:131], v[40:43], v[56:59], v[128:131]
    ds_read_b128 v[24:27], v4 offset:38912
    v_mfma_f32_16x16x32_bf16 v[132:135], v[28:31], v[60:63], v[132:135]
    ds_read_b64_tr_b16 v[48:49], v11 offset:16384
    v_mfma_f32_16x16x32_bf16 v[136:139], v[32:35], v[60:63], v[136:139]
    ds_read_b64_tr_b16 v[50:51], v11 offset:16896
    v_mfma_f32_16x16x32_bf16 v[140:143], v[36:39], v[60:63], v[140:143]
    ds_read_b64_tr_b16 v[52:53], v10 offset:24576
    v_mfma_f32_16x16x32_bf16 v[144:147], v[40:43], v[60:63], v[144:147]
    ds_read_b64_tr_b16 v[54:55], v10 offset:25088
    v_mfma_f32_16x16x32_bf16 v[148:151], v[28:31], v[64:67], v[148:151]
    ds_read_b64_tr_b16 v[56:57], v11 offset:24576
    v_mfma_f32_16x16x32_bf16 v[152:155], v[32:35], v[64:67], v[152:155]
    ds_read_b64_tr_b16 v[58:59], v11 offset:25088
    v_mfma_f32_16x16x32_bf16 v[156:159], v[36:39], v[64:67], v[156:159]
    v_mfma_f32_16x16x32_bf16 v[160:163], v[40:43], v[64:67], v[160:163]
    s_waitcnt lgkmcnt(9)
    v_mfma_f32_16x16x32_bf16 v[100:103], v[12:15], v[44:47], v[100:103]
    ds_read_b128 v[28:31], v5 offset:32768
    s_waitcnt lgkmcnt(9)
    v_mfma_f32_16x16x32_bf16 v[104:107], v[16:19], v[44:47], v[104:107]
    ds_read_b64_tr_b16 v[60:61], v10 offset:20480
    s_waitcnt lgkmcnt(9)
    v_mfma_f32_16x16x32_bf16 v[108:111], v[20:23], v[44:47], v[108:111]
    ds_read_b64_tr_b16 v[62:63], v10 offset:20992
    s_waitcnt lgkmcnt(9)
    v_mfma_f32_16x16x32_bf16 v[112:115], v[24:27], v[44:47], v[112:115]
    ds_read_b128 v[32:35], v5 offset:34816
    s_waitcnt lgkmcnt(8)
    s_nop 0
    v_mfma_f32_16x16x32_bf16 v[116:119], v[12:15], v[48:51], v[116:119]
    ds_read_b128 v[36:39], v5 offset:36864
    v_mfma_f32_16x16x32_bf16 v[120:123], v[16:19], v[48:51], v[120:123]
    ds_read_b128 v[40:43], v5 offset:38912
    v_mfma_f32_16x16x32_bf16 v[124:127], v[20:23], v[48:51], v[124:127]
    ds_read_b64_tr_b16 v[64:65], v11 offset:20480
    v_mfma_f32_16x16x32_bf16 v[128:131], v[24:27], v[48:51], v[128:131]
    ds_read_b64_tr_b16 v[66:67], v11 offset:20992
    s_waitcnt lgkmcnt(10)
    s_nop 0
    v_mfma_f32_16x16x32_bf16 v[132:135], v[12:15], v[52:55], v[132:135]
    ds_read_b64_tr_b16 v[44:45], v10 offset:28672
    v_mfma_f32_16x16x32_bf16 v[136:139], v[16:19], v[52:55], v[136:139]
    ds_read_b64_tr_b16 v[46:47], v10 offset:29184
    v_mfma_f32_16x16x32_bf16 v[140:143], v[20:23], v[52:55], v[140:143]
    ds_read_b64_tr_b16 v[48:49], v11 offset:28672
    v_mfma_f32_16x16x32_bf16 v[144:147], v[24:27], v[52:55], v[144:147]
    ds_read_b64_tr_b16 v[50:51], v11 offset:29184
    s_waitcnt lgkmcnt(12)
    v_mfma_f32_16x16x32_bf16 v[148:151], v[12:15], v[56:59], v[148:151]
    v_mfma_f32_16x16x32_bf16 v[152:155], v[16:19], v[56:59], v[152:155]
    v_mfma_f32_16x16x32_bf16 v[156:159], v[20:23], v[56:59], v[156:159]
    v_mfma_f32_16x16x32_bf16 v[160:163], v[24:27], v[56:59], v[160:163]
    s_waitcnt lgkmcnt(9)
    v_mfma_f32_16x16x32_bf16 v[100:103], v[28:31], v[60:63], v[100:103]
    s_waitcnt lgkmcnt(8)
    v_mfma_f32_16x16x32_bf16 v[104:107], v[32:35], v[60:63], v[104:107]
    s_waitcnt lgkmcnt(0)
    s_barrier
    s_nop 0
    v_mfma_f32_16x16x32_bf16 v[108:111], v[36:39], v[60:63], v[108:111]
    ds_read_b128 v[12:15], v4 offset:49152
    v_mfma_f32_16x16x32_bf16 v[112:115], v[40:43], v[60:63], v[112:115]
    ds_read_b64_tr_b16 v[52:53], v8 offset:0
    v_mfma_f32_16x16x32_bf16 v[116:119], v[28:31], v[64:67], v[116:119]
    ds_read_b64_tr_b16 v[54:55], v8 offset:512
    v_mfma_f32_16x16x32_bf16 v[120:123], v[32:35], v[64:67], v[120:123]
    ds_read_b128 v[16:19], v4 offset:51200
    v_mfma_f32_16x16x32_bf16 v[124:127], v[36:39], v[64:67], v[124:127]
    ds_read_b128 v[20:23], v4 offset:53248
    v_mfma_f32_16x16x32_bf16 v[128:131], v[40:43], v[64:67], v[128:131]
    ds_read_b128 v[24:27], v4 offset:55296
    v_mfma_f32_16x16x32_bf16 v[132:135], v[28:31], v[44:47], v[132:135]
    ds_read_b64_tr_b16 v[56:57], v9 offset:0
    v_mfma_f32_16x16x32_bf16 v[136:139], v[32:35], v[44:47], v[136:139]
    ds_read_b64_tr_b16 v[58:59], v9 offset:512
    v_mfma_f32_16x16x32_bf16 v[140:143], v[36:39], v[44:47], v[140:143]
    ds_read_b64_tr_b16 v[60:61], v10 offset:32768
    v_mfma_f32_16x16x32_bf16 v[144:147], v[40:43], v[44:47], v[144:147]
    ds_read_b64_tr_b16 v[62:63], v10 offset:33280
    v_mfma_f32_16x16x32_bf16 v[148:151], v[28:31], v[48:51], v[148:151]
    ds_read_b64_tr_b16 v[64:65], v11 offset:32768
    v_mfma_f32_16x16x32_bf16 v[152:155], v[32:35], v[48:51], v[152:155]
    ds_read_b64_tr_b16 v[66:67], v11 offset:33280
    v_mfma_f32_16x16x32_bf16 v[156:159], v[36:39], v[48:51], v[156:159]
    v_mfma_f32_16x16x32_bf16 v[160:163], v[40:43], v[48:51], v[160:163]
    s_waitcnt lgkmcnt(9)
    v_mfma_f32_16x16x32_bf16 v[100:103], v[12:15], v[52:55], v[100:103]
    ds_read_b128 v[28:31], v5 offset:49152
    s_waitcnt lgkmcnt(9)
    v_mfma_f32_16x16x32_bf16 v[104:107], v[16:19], v[52:55], v[104:107]
    ds_read_b64_tr_b16 v[44:45], v8 offset:4096
    s_waitcnt lgkmcnt(9)
    v_mfma_f32_16x16x32_bf16 v[108:111], v[20:23], v[52:55], v[108:111]
    ds_read_b64_tr_b16 v[46:47], v8 offset:4608
    s_waitcnt lgkmcnt(9)
    v_mfma_f32_16x16x32_bf16 v[112:115], v[24:27], v[52:55], v[112:115]
    ds_read_b128 v[32:35], v5 offset:51200
    s_waitcnt lgkmcnt(8)
    s_nop 0
    v_mfma_f32_16x16x32_bf16 v[116:119], v[12:15], v[56:59], v[116:119]
    ds_read_b128 v[36:39], v5 offset:53248
    v_mfma_f32_16x16x32_bf16 v[120:123], v[16:19], v[56:59], v[120:123]
    ds_read_b128 v[40:43], v5 offset:55296
    v_mfma_f32_16x16x32_bf16 v[124:127], v[20:23], v[56:59], v[124:127]
    ds_read_b64_tr_b16 v[48:49], v9 offset:4096
    v_mfma_f32_16x16x32_bf16 v[128:131], v[24:27], v[56:59], v[128:131]
    ds_read_b64_tr_b16 v[50:51], v9 offset:4608
    s_waitcnt lgkmcnt(10)
    s_nop 0
    v_mfma_f32_16x16x32_bf16 v[132:135], v[12:15], v[60:63], v[132:135]
    ds_read_b64_tr_b16 v[52:53], v10 offset:36864
    v_mfma_f32_16x16x32_bf16 v[136:139], v[16:19], v[60:63], v[136:139]
    ds_read_b64_tr_b16 v[54:55], v10 offset:37376
    v_mfma_f32_16x16x32_bf16 v[140:143], v[20:23], v[60:63], v[140:143]
    ds_read_b64_tr_b16 v[56:57], v11 offset:36864
    v_mfma_f32_16x16x32_bf16 v[144:147], v[24:27], v[60:63], v[144:147]
    ds_read_b64_tr_b16 v[58:59], v11 offset:37376
    s_waitcnt lgkmcnt(12)
    v_mfma_f32_16x16x32_bf16 v[148:151], v[12:15], v[64:67], v[148:151]
    v_mfma_f32_16x16x32_bf16 v[152:155], v[16:19], v[64:67], v[152:155]
    v_mfma_f32_16x16x32_bf16 v[156:159], v[20:23], v[64:67], v[156:159]
    v_mfma_f32_16x16x32_bf16 v[160:163], v[24:27], v[64:67], v[160:163]
    s_waitcnt lgkmcnt(9)
    v_mfma_f32_16x16x32_bf16 v[100:103], v[28:31], v[44:47], v[100:103]
    s_waitcnt lgkmcnt(8)
    v_mfma_f32_16x16x32_bf16 v[104:107], v[32:35], v[44:47], v[104:107]
    s_waitcnt lgkmcnt(0)
    s_barrier
    s_nop 0
    v_mfma_f32_16x16x32_bf16 v[108:111], v[36:39], v[44:47], v[108:111]
    ds_read_b128 v[12:15], v4 offset:0
    v_mfma_f32_16x16x32_bf16 v[112:115], v[40:43], v[44:47], v[112:115]
    ds_read_b64_tr_b16 v[60:61], v8 offset:8192
    v_mfma_f32_16x16x32_bf16 v[116:119], v[28:31], v[48:51], v[116:119]
    ds_read_b64_tr_b16 v[62:63], v8 offset:8704
    v_mfma_f32_16x16x32_bf16 v[120:123], v[32:35], v[48:51], v[120:123]
    ds_read_b128 v[16:19], v4 offset:2048
    v_mfma_f32_16x16x32_bf16 v[124:127], v[36:39], v[48:51], v[124:127]
    ds_read_b128 v[20:23], v4 offset:4096
    v_mfma_f32_16x16x32_bf16 v[128:131], v[40:43], v[48:51], v[128:131]
    ds_read_b128 v[24:27], v4 offset:6144
    v_mfma_f32_16x16x32_bf16 v[132:135], v[28:31], v[52:55], v[132:135]
    ds_read_b64_tr_b16 v[64:65], v9 offset:8192
    v_mfma_f32_16x16x32_bf16 v[136:139], v[32:35], v[52:55], v[136:139]
    ds_read_b64_tr_b16 v[66:67], v9 offset:8704
    v_mfma_f32_16x16x32_bf16 v[140:143], v[36:39], v[52:55], v[140:143]
    ds_read_b64_tr_b16 v[44:45], v8 offset:16384
    v_mfma_f32_16x16x32_bf16 v[144:147], v[40:43], v[52:55], v[144:147]
    ds_read_b64_tr_b16 v[46:47], v8 offset:16896
    v_mfma_f32_16x16x32_bf16 v[148:151], v[28:31], v[56:59], v[148:151]
    ds_read_b64_tr_b16 v[48:49], v9 offset:16384
    v_mfma_f32_16x16x32_bf16 v[152:155], v[32:35], v[56:59], v[152:155]
    ds_read_b64_tr_b16 v[50:51], v9 offset:16896
    v_mfma_f32_16x16x32_bf16 v[156:159], v[36:39], v[56:59], v[156:159]
    v_mfma_f32_16x16x32_bf16 v[160:163], v[40:43], v[56:59], v[160:163]
    s_waitcnt lgkmcnt(9)
    v_mfma_f32_16x16x32_bf16 v[100:103], v[12:15], v[60:63], v[100:103]
    ds_read_b128 v[28:31], v5 offset:0
    s_waitcnt lgkmcnt(9)
    v_mfma_f32_16x16x32_bf16 v[104:107], v[16:19], v[60:63], v[104:107]
    ds_read_b64_tr_b16 v[52:53], v8 offset:12288
    s_waitcnt lgkmcnt(9)
    v_mfma_f32_16x16x32_bf16 v[108:111], v[20:23], v[60:63], v[108:111]
    ds_read_b64_tr_b16 v[54:55], v8 offset:12800
    s_waitcnt lgkmcnt(9)
    v_mfma_f32_16x16x32_bf16 v[112:115], v[24:27], v[60:63], v[112:115]
    ds_read_b128 v[32:35], v5 offset:2048
    s_waitcnt lgkmcnt(8)
    s_nop 0
    v_mfma_f32_16x16x32_bf16 v[116:119], v[12:15], v[64:67], v[116:119]
    ds_read_b128 v[36:39], v5 offset:4096
    v_mfma_f32_16x16x32_bf16 v[120:123], v[16:19], v[64:67], v[120:123]
    ds_read_b128 v[40:43], v5 offset:6144
    v_mfma_f32_16x16x32_bf16 v[124:127], v[20:23], v[64:67], v[124:127]
    ds_read_b64_tr_b16 v[56:57], v9 offset:12288
    v_mfma_f32_16x16x32_bf16 v[128:131], v[24:27], v[64:67], v[128:131]
    ds_read_b64_tr_b16 v[58:59], v9 offset:12800
    s_waitcnt lgkmcnt(10)
    s_nop 0
    v_mfma_f32_16x16x32_bf16 v[132:135], v[12:15], v[44:47], v[132:135]
    ds_read_b64_tr_b16 v[60:61], v8 offset:20480
    v_mfma_f32_16x16x32_bf16 v[136:139], v[16:19], v[44:47], v[136:139]
    ds_read_b64_tr_b16 v[62:63], v8 offset:20992
    v_mfma_f32_16x16x32_bf16 v[140:143], v[20:23], v[44:47], v[140:143]
    ds_read_b64_tr_b16 v[64:65], v9 offset:20480
    v_mfma_f32_16x16x32_bf16 v[144:147], v[24:27], v[44:47], v[144:147]
    ds_read_b64_tr_b16 v[66:67], v9 offset:20992
    s_waitcnt lgkmcnt(12)
    v_mfma_f32_16x16x32_bf16 v[148:151], v[12:15], v[48:51], v[148:151]
    v_mfma_f32_16x16x32_bf16 v[152:155], v[16:19], v[48:51], v[152:155]
    v_mfma_f32_16x16x32_bf16 v[156:159], v[20:23], v[48:51], v[156:159]
    v_mfma_f32_16x16x32_bf16 v[160:163], v[24:27], v[48:51], v[160:163]
    s_waitcnt lgkmcnt(9)
    v_mfma_f32_16x16x32_bf16 v[100:103], v[28:31], v[52:55], v[100:103]
    s_waitcnt lgkmcnt(8)
    v_mfma_f32_16x16x32_bf16 v[104:107], v[32:35], v[52:55], v[104:107]
    s_waitcnt lgkmcnt(0)
    s_barrier
    s_nop 0
    v_mfma_f32_16x16x32_bf16 v[108:111], v[36:39], v[52:55], v[108:111]
    ds_read_b128 v[12:15], v4 offset:16384
    v_mfma_f32_16x16x32_bf16 v[112:115], v[40:43], v[52:55], v[112:115]
    ds_read_b64_tr_b16 v[44:45], v8 offset:24576
    v_mfma_f32_16x16x32_bf16 v[116:119], v[28:31], v[56:59], v[116:119]
    ds_read_b64_tr_b16 v[46:47], v8 offset:25088
    v_mfma_f32_16x16x32_bf16 v[120:123], v[32:35], v[56:59], v[120:123]
    ds_read_b128 v[16:19], v4 offset:18432
    v_mfma_f32_16x16x32_bf16 v[124:127], v[36:39], v[56:59], v[124:127]
    ds_read_b128 v[20:23], v4 offset:20480
    v_mfma_f32_16x16x32_bf16 v[128:131], v[40:43], v[56:59], v[128:131]
    ds_read_b128 v[24:27], v4 offset:22528
    v_mfma_f32_16x16x32_bf16 v[132:135], v[28:31], v[60:63], v[132:135]
    ds_read_b64_tr_b16 v[48:49], v9 offset:24576
    v_mfma_f32_16x16x32_bf16 v[136:139], v[32:35], v[60:63], v[136:139]
    ds_read_b64_tr_b16 v[50:51], v9 offset:25088
    v_mfma_f32_16x16x32_bf16 v[140:143], v[36:39], v[60:63], v[140:143]
    ds_read_b64_tr_b16 v[52:53], v10 offset:0
    v_mfma_f32_16x16x32_bf16 v[144:147], v[40:43], v[60:63], v[144:147]
    ds_read_b64_tr_b16 v[54:55], v10 offset:512
    v_mfma_f32_16x16x32_bf16 v[148:151], v[28:31], v[64:67], v[148:151]
    ds_read_b64_tr_b16 v[56:57], v11 offset:0
    v_mfma_f32_16x16x32_bf16 v[152:155], v[32:35], v[64:67], v[152:155]
    ds_read_b64_tr_b16 v[58:59], v11 offset:512
    v_mfma_f32_16x16x32_bf16 v[156:159], v[36:39], v[64:67], v[156:159]
    v_mfma_f32_16x16x32_bf16 v[160:163], v[40:43], v[64:67], v[160:163]
    s_waitcnt lgkmcnt(9)
    v_mfma_f32_16x16x32_bf16 v[100:103], v[12:15], v[44:47], v[100:103]
    ds_read_b128 v[28:31], v5 offset:16384
    s_waitcnt lgkmcnt(9)
    v_mfma_f32_16x16x32_bf16 v[104:107], v[16:19], v[44:47], v[104:107]
    ds_read_b64_tr_b16 v[60:61], v8 offset:28672
    s_waitcnt lgkmcnt(9)
    v_mfma_f32_16x16x32_bf16 v[108:111], v[20:23], v[44:47], v[108:111]
    ds_read_b64_tr_b16 v[62:63], v8 offset:29184
    s_waitcnt lgkmcnt(9)
    v_mfma_f32_16x16x32_bf16 v[112:115], v[24:27], v[44:47], v[112:115]
    ds_read_b128 v[32:35], v5 offset:18432
    s_waitcnt lgkmcnt(8)
    s_nop 0
    v_mfma_f32_16x16x32_bf16 v[116:119], v[12:15], v[48:51], v[116:119]
    ds_read_b128 v[36:39], v5 offset:20480
    v_mfma_f32_16x16x32_bf16 v[120:123], v[16:19], v[48:51], v[120:123]
    ds_read_b128 v[40:43], v5 offset:22528
    v_mfma_f32_16x16x32_bf16 v[124:127], v[20:23], v[48:51], v[124:127]
    ds_read_b64_tr_b16 v[64:65], v9 offset:28672
    v_mfma_f32_16x16x32_bf16 v[128:131], v[24:27], v[48:51], v[128:131]
    ds_read_b64_tr_b16 v[66:67], v9 offset:29184
    s_waitcnt lgkmcnt(10)
    s_nop 0
    v_mfma_f32_16x16x32_bf16 v[132:135], v[12:15], v[52:55], v[132:135]
    ds_read_b64_tr_b16 v[44:45], v10 offset:4096
    v_mfma_f32_16x16x32_bf16 v[136:139], v[16:19], v[52:55], v[136:139]
    ds_read_b64_tr_b16 v[46:47], v10 offset:4608
    v_mfma_f32_16x16x32_bf16 v[140:143], v[20:23], v[52:55], v[140:143]
    ds_read_b64_tr_b16 v[48:49], v11 offset:4096
    v_mfma_f32_16x16x32_bf16 v[144:147], v[24:27], v[52:55], v[144:147]
    ds_read_b64_tr_b16 v[50:51], v11 offset:4608
    s_waitcnt lgkmcnt(12)
    v_mfma_f32_16x16x32_bf16 v[148:151], v[12:15], v[56:59], v[148:151]
    v_mfma_f32_16x16x32_bf16 v[152:155], v[16:19], v[56:59], v[152:155]
    v_mfma_f32_16x16x32_bf16 v[156:159], v[20:23], v[56:59], v[156:159]
    v_mfma_f32_16x16x32_bf16 v[160:163], v[24:27], v[56:59], v[160:163]
    s_waitcnt lgkmcnt(9)
    v_mfma_f32_16x16x32_bf16 v[100:103], v[28:31], v[60:63], v[100:103]
    s_waitcnt lgkmcnt(8)
    v_mfma_f32_16x16x32_bf16 v[104:107], v[32:35], v[60:63], v[104:107]
    s_waitcnt lgkmcnt(0)
    s_barrier
    s_nop 0
    v_mfma_f32_16x16x32_bf16 v[108:111], v[36:39], v[60:63], v[108:111]
    ds_read_b128 v[12:15], v4 offset:32768
    v_mfma_f32_16x16x32_bf16 v[112:115], v[40:43], v[60:63], v[112:115]
    ds_read_b64_tr_b16 v[52:53], v10 offset:16384
    v_mfma_f32_16x16x32_bf16 v[116:119], v[28:31], v[64:67], v[116:119]
    ds_read_b64_tr_b16 v[54:55], v10 offset:16896
    v_mfma_f32_16x16x32_bf16 v[120:123], v[32:35], v[64:67], v[120:123]
    ds_read_b128 v[16:19], v4 offset:34816
    v_mfma_f32_16x16x32_bf16 v[124:127], v[36:39], v[64:67], v[124:127]
    ds_read_b128 v[20:23], v4 offset:36864
    v_mfma_f32_16x16x32_bf16 v[128:131], v[40:43], v[64:67], v[128:131]
    ds_read_b128 v[24:27], v4 offset:38912
    v_mfma_f32_16x16x32_bf16 v[132:135], v[28:31], v[44:47], v[132:135]
    ds_read_b64_tr_b16 v[56:57], v11 offset:16384
    v_mfma_f32_16x16x32_bf16 v[136:139], v[32:35], v[44:47], v[136:139]
    ds_read_b64_tr_b16 v[58:59], v11 offset:16896
    v_mfma_f32_16x16x32_bf16 v[140:143], v[36:39], v[44:47], v[140:143]
    ds_read_b64_tr_b16 v[60:61], v10 offset:24576
    v_mfma_f32_16x16x32_bf16 v[144:147], v[40:43], v[44:47], v[144:147]
    ds_read_b64_tr_b16 v[62:63], v10 offset:25088
    v_mfma_f32_16x16x32_bf16 v[148:151], v[28:31], v[48:51], v[148:151]
    ds_read_b64_tr_b16 v[64:65], v11 offset:24576
    v_mfma_f32_16x16x32_bf16 v[152:155], v[32:35], v[48:51], v[152:155]
    ds_read_b64_tr_b16 v[66:67], v11 offset:25088
    v_mfma_f32_16x16x32_bf16 v[156:159], v[36:39], v[48:51], v[156:159]
    v_mfma_f32_16x16x32_bf16 v[160:163], v[40:43], v[48:51], v[160:163]
    s_waitcnt lgkmcnt(9)
    v_mfma_f32_16x16x32_bf16 v[100:103], v[12:15], v[52:55], v[100:103]
    ds_read_b128 v[28:31], v5 offset:32768
    s_waitcnt lgkmcnt(9)
    v_mfma_f32_16x16x32_bf16 v[104:107], v[16:19], v[52:55], v[104:107]
    ds_read_b64_tr_b16 v[44:45], v10 offset:20480
    s_waitcnt lgkmcnt(9)
    v_mfma_f32_16x16x32_bf16 v[108:111], v[20:23], v[52:55], v[108:111]
    ds_read_b64_tr_b16 v[46:47], v10 offset:20992
    s_waitcnt lgkmcnt(9)
    v_mfma_f32_16x16x32_bf16 v[112:115], v[24:27], v[52:55], v[112:115]
    ds_read_b128 v[32:35], v5 offset:34816
    s_waitcnt lgkmcnt(8)
    s_nop 0
    v_mfma_f32_16x16x32_bf16 v[116:119], v[12:15], v[56:59], v[116:119]
    ds_read_b128 v[36:39], v5 offset:36864
    v_mfma_f32_16x16x32_bf16 v[120:123], v[16:19], v[56:59], v[120:123]
    ds_read_b128 v[40:43], v5 offset:38912
    v_mfma_f32_16x16x32_bf16 v[124:127], v[20:23], v[56:59], v[124:127]
    ds_read_b64_tr_b16 v[48:49], v11 offset:20480
    v_mfma_f32_16x16x32_bf16 v[128:131], v[24:27], v[56:59], v[128:131]
    ds_read_b64_tr_b16 v[50:51], v11 offset:20992
    s_waitcnt lgkmcnt(10)
    s_nop 0
    v_mfma_f32_16x16x32_bf16 v[132:135], v[12:15], v[60:63], v[132:135]
    ds_read_b64_tr_b16 v[52:53], v10 offset:28672
    v_mfma_f32_16x16x32_bf16 v[136:139], v[16:19], v[60:63], v[136:139]
    ds_read_b64_tr_b16 v[54:55], v10 offset:29184
    v_mfma_f32_16x16x32_bf16 v[140:143], v[20:23], v[60:63], v[140:143]
    ds_read_b64_tr_b16 v[56:57], v11 offset:28672
    v_mfma_f32_16x16x32_bf16 v[144:147], v[24:27], v[60:63], v[144:147]
    ds_read_b64_tr_b16 v[58:59], v11 offset:29184
    s_waitcnt lgkmcnt(12)
    v_mfma_f32_16x16x32_bf16 v[148:151], v[12:15], v[64:67], v[148:151]
    s_branch IW_s4
IW_w4:
    s_branch IW_r4
IW_s4:
    v_mfma_f32_16x16x32_bf16 v[152:155], v[16:19], v[64:67], v[152:155]
    v_mfma_f32_16x16x32_bf16 v[156:159], v[20:23], v[64:67], v[156:159]
    v_mfma_f32_16x16x32_bf16 v[160:163], v[24:27], v[64:67], v[160:163]
    s_waitcnt lgkmcnt(9)
    v_mfma_f32_16x16x32_bf16 v[100:103], v[28:31], v[44:47], v[100:103]
    s_waitcnt lgkmcnt(8)
    v_mfma_f32_16x16x32_bf16 v[104:107], v[32:35], v[44:47], v[104:107]
    s_waitcnt lgkmcnt(0)
    s_barrier
    s_nop 0
    v_mfma_f32_16x16x32_bf16 v[108:111], v[36:39], v[44:47], v[108:111]
    ds_read_b128 v[12:15], v4 offset:49152
    v_mfma_f32_16x16x32_bf16 v[112:115], v[40:43], v[44:47], v[112:115]
    ds_read_b64_tr_b16 v[60:61], v8 offset:0
    v_mfma_f32_16x16x32_bf16 v[116:119], v[28:31], v[48:51], v[116:119]
    ds_read_b64_tr_b16 v[62:63], v8 offset:512
    v_mfma_f32_16x16x32_bf16 v[120:123], v[32:35], v[48:51], v[120:123]
    ds_read_b128 v[16:19], v4 offset:51200
    v_mfma_f32_16x16x32_bf16 v[124:127], v[36:39], v[48:51], v[124:127]
    ds_read_b128 v[20:23], v4 offset:53248
    v_mfma_f32_16x16x32_bf16 v[128:131], v[40:43], v[48:51], v[128:131]
    ds_read_b128 v[24:27], v4 offset:55296
    v_mfma_f32_16x16x32_bf16 v[132:135], v[28:31], v[52:55], v[132:135]
    ds_read_b64_tr_b16 v[64:65], v9 offset:0
    v_mfma_f32_16x16x32_bf16 v[136:139], v[32:35], v[52:55], v[136:139]
    ds_read_b64_tr_b16 v[66:67], v9 offset:512
    v_mfma_f32_16x16x32_bf16 v[140:143], v[36:39], v[52:55], v[140:143]
    ds_read_b64_tr_b16 v[44:45], v10 offset:32768
    v_mfma_f32_16x16x32_bf16 v[144:147], v[40:43], v[52:55], v[144:147]
    ds_read_b64_tr_b16 v[46:47], v10 offset:33280
    v_mfma_f32_16x16x32_bf16 v[148:151], v[28:31], v[56:59], v[148:151]
    ds_read_b64_tr_b16 v[48:49], v11 offset:32768
    v_mfma_f32_16x16x32_bf16 v[152:155], v[32:35], v[56:59], v[152:155]
    ds_read_b64_tr_b16 v[50:51], v11 offset:33280
    v_mfma_f32_16x16x32_bf16 v[156:159], v[36:39], v[56:59], v[156:159]
    v_mfma_f32_16x16x32_bf16 v[160:163], v[40:43], v[56:59], v[160:163]
    s_waitcnt lgkmcnt(9)
    v_mfma_f32_16x16x32_bf16 v[100:103], v[12:15], v[60:63], v[100:103]
    ds_read_b128 v[28:31], v5 offset:49152
    s_waitcnt lgkmcnt(9)
    v_mfma_f32_16x16x32_bf16 v[104:107], v[16:19], v[60:63], v[104:107]
    ds_read_b64_tr_b16 v[52:53], v8 offset:4096
    s_waitcnt lgkmcnt(9)
    v_mfma_f32_16x16x32_bf16 v[108:111], v[20:23], v[60:63], v[108:111]
    ds_read_b64_tr_b16 v[54:55], v8 offset:4608
    s_waitcnt lgkmcnt(9)
    v_mfma_f32_16x16x32_bf16 v[112:115], v[24:27], v[60:63], v[112:115]
    ds_read_b128 v[32:35], v5 offset:51200
    s_waitcnt lgkmcnt(8)
    s_nop 0
    v_mfma_f32_16x16x32_bf16 v[116:119], v[12:15], v[64:67], v[116:119]
    ds_read_b128 v[36:39], v5 offset:53248
    v_mfma_f32_16x16x32_bf16 v[120:123], v[16:19], v[64:67], v[120:123]
    ds_read_b128 v[40:43], v5 offset:55296
    v_mfma_f32_16x16x32_bf16 v[124:127], v[20:23], v[64:67], v[124:127]
    ds_read_b64_tr_b16 v[56:57], v9 offset:4096
    v_mfma_f32_16x16x32_bf16 v[128:131], v[24:27], v[64:67], v[128:131]
    ds_read_b64_tr_b16 v[58:59], v9 offset:4608
    s_waitcnt lgkmcnt(10)
    s_nop 0
    v_mfma_f32_16x16x32_bf16 v[132:135], v[12:15], v[44:47], v[132:135]
    ds_read_b64_tr_b16 v[60:61], v10 offset:36864
    v_mfma_f32_16x16x32_bf16 v[136:139], v[16:19], v[44:47], v[136:139]
    ds_read_b64_tr_b16 v[62:63], v10 offset:37376
    v_mfma_f32_16x16x32_bf16 v[140:143], v[20:23], v[44:47], v[140:143]
    ds_read_b64_tr_b16 v[64:65], v11 offset:36864
    v_mfma_f32_16x16x32_bf16 v[144:147], v[24:27], v[44:47], v[144:147]
    ds_read_b64_tr_b16 v[66:67], v11 offset:37376
    s_waitcnt lgkmcnt(12)
    v_mfma_f32_16x16x32_bf16 v[148:151], v[12:15], v[48:51], v[148:151]
    v_mfma_f32_16x16x32_bf16 v[152:155], v[16:19], v[48:51], v[152:155]
    v_mfma_f32_16x16x32_bf16 v[156:159], v[20:23], v[48:51], v[156:159]
    v_mfma_f32_16x16x32_bf16 v[160:163], v[24:27], v[48:51], v[160:163]
    s_waitcnt lgkmcnt(9)
    v_mfma_f32_16x16x32_bf16 v[100:103], v[28:31], v[52:55], v[100:103]
    s_waitcnt lgkmcnt(8)
    v_mfma_f32_16x16x32_bf16 v[104:107], v[32:35], v[52:55], v[104:107]
    s_waitcnt lgkmcnt(0)
    s_barrier
    s_nop 0
    v_mfma_f32_16x16x32_bf16 v[108:111], v[36:39], v[52:55], v[108:111]
    ds_read_b128 v[12:15], v4 offset:0
    v_mfma_f32_16x16x32_bf16 v[112:115], v[40:43], v[52:55], v[112:115]
    ds_read_b64_tr_b16 v[44:45], v8 offset:8192
    v_mfma_f32_16x16x32_bf16 v[116:119], v[28:31], v[56:59], v[116:119]
    ds_read_b64_tr_b16 v[46:47], v8 offset:8704
    v_mfma_f32_16x16x32_bf16 v[120:123], v[32:35], v[56:59], v[120:123]
    ds_read_b128 v[16:19], v4 offset:2048
    v_mfma_f32_16x16x32_bf16 v[124:127], v[36:39], v[56:59], v[124:127]
    ds_read_b128 v[20:23], v4 offset:4096
    v_mfma_f32_16x16x32_bf16 v[128:131], v[40:43], v[56:59], v[128:131]
    ds_read_b128 v[24:27], v4 offset:6144
    v_mfma_f32_16x16x32_bf16 v[132:135], v[28:31], v[60:63], v[132:135]
    ds_read_b64_tr_b16 v[48:49], v9 offset:8192
    v_mfma_f32_16x16x32_bf16 v[136:139], v[32:35], v[60:63], v[136:139]
    ds_read_b64_tr_b16 v[50:51], v9 offset:8704
    v_mfma_f32_16x16x32_bf16 v[140:143], v[36:39], v[60:63], v[140:143]
    ds_read_b64_tr_b16 v[52:53], v8 offset:16384
    v_mfma_f32_16x16x32_bf16 v[144:147], v[40:43], v[60:63], v[144:147]
    ds_read_b64_tr_b16 v[54:55], v8 offset:16896
    v_mfma_f32_16x16x32_bf16 v[148:151], v[28:31], v[64:67], v[148:151]
    ds_read_b64_tr_b16 v[56:57], v9 offset:16384
    v_mfma_f32_16x16x32_bf16 v[152:155], v[32:35], v[64:67], v[152:155]
    ds_read_b64_tr_b16 v[58:59], v9 offset:16896
    v_mfma_f32_16x16x32_bf16 v[156:159], v[36:39], v[64:67], v[156:159]
    v_mfma_f32_16x16x32_bf16 v[160:163], v[40:43], v[64:67], v[160:163]
    s_waitcnt lgkmcnt(9)
    v_mfma_f32_16x16x32_bf16 v[100:103], v[12:15], v[44:47], v[100:103]
    ds_read_b128 v[28:31], v5 offset:0
    s_waitcnt lgkmcnt(9)
    v_mfma_f32_16x16x32_bf16 v[104:107], v[16:19], v[44:47], v[104:107]
    ds_read_b64_tr_b16 v[60:61], v8 offset:12288
    s_waitcnt lgkmcnt(9)
    v_mfma_f32_16x16x32_bf16 v[108:111], v[20:23], v[44:47], v[108:111]
    ds_read_b64_tr_b16 v[62:63], v8 offset:12800
    s_waitcnt lgkmcnt(9)
    v_mfma_f32_16x16x32_bf16 v[112:115], v[24:27], v[44:47], v[112:115]
    ds_read_b128 v[32:35], v5 offset:2048
    s_waitcnt lgkmcnt(8)
    s_nop 0
    v_mfma_f32_16x16x32_bf16 v[116:119], v[12:15], v[48:51], v[116:119]
    ds_read_b128 v[36:39], v5 offset:4096
    v_mfma_f32_16x16x32_bf16 v[120:123], v[16:19], v[48:51], v[120:123]
    ds_read_b128 v[40:43], v5 offset:6144
    v_mfma_f32_16x16x32_bf16 v[124:127], v[20:23], v[48:51], v[124:127]
    ds_read_b64_tr_b16 v[64:65], v9 offset:12288
    v_mfma_f32_16x16x32_bf16 v[128:131], v[24:27], v[48:51], v[128:131]
    ds_read_b64_tr_b16 v[66:67], v9 offset:12800
    s_waitcnt lgkmcnt(10)
    s_nop 0
    v_mfma_f32_16x16x32_bf16 v[132:135], v[12:15], v[52:55], v[132:135]
    ds_read_b64_tr_b16 v[44:45], v8 offset:20480
    v_mfma_f32_16x16x32_bf16 v[136:139], v[16:19], v[52:55], v[136:139]
    ds_read_b64_tr_b16 v[46:47], v8 offset:20992
    v_mfma_f32_16x16x32_bf16 v[140:143], v[20:23], v[52:55], v[140:143]
    ds_read_b64_tr_b16 v[48:49], v9 offset:20480
    v_mfma_f32_16x16x32_bf16 v[144:147], v[24:27], v[52:55], v[144:147]
    ds_read_b64_tr_b16 v[50:51], v9 offset:20992
    s_waitcnt lgkmcnt(12)
    v_mfma_f32_16x16x32_bf16 v[148:151], v[12:15], v[56:59], v[148:151]
    v_mfma_f32_16x16x32_bf16 v[152:155], v[16:19], v[56:59], v[152:155]
    v_mfma_f32_16x16x32_bf16 v[156:159], v[20:23], v[56:59], v[156:159]
    v_mfma_f32_16x16x32_bf16 v[160:163], v[24:27], v[56:59], v[160:163]
    s_waitcnt lgkmcnt(9)
    v_mfma_f32_16x16x32_bf16 v[100:103], v[28:31], v[60:63], v[100:103]
    s_waitcnt lgkmcnt(8)
    v_mfma_f32_16x16x32_bf16 v[104:107], v[32:35], v[60:63], v[104:107]
    s_waitcnt lgkmcnt(0)
    s_barrier
    s_nop 0
    v_mfma_f32_16x16x32_bf16 v[108:111], v[36:39], v[60:63], v[108:111]
    ds_read_b128 v[12:15], v4 offset:16384
    v_mfma_f32_16x16x32_bf16 v[112:115], v[40:43], v[60:63], v[112:115]
    ds_read_b64_tr_b16 v[52:53], v8 offset:24576
    v_mfma_f32_16x16x32_bf16 v[116:119], v[28:31], v[64:67], v[116:119]
    ds_read_b64_tr_b16 v[54:55], v8 offset:25088
    v_mfma_f32_16x16x32_bf16 v[120:123], v[32:35], v[64:67], v[120:123]
    ds_read_b128 v[16:19], v4 offset:18432
    v_mfma_f32_16x16x32_bf16 v[124:127], v[36:39], v[64:67], v[124:127]
    ds_read_b128 v[20:23], v4 offset:20480
    v_mfma_f32_16x16x32_bf16 v[128:131], v[40:43], v[64:67], v[128:131]
    ds_read_b128 v[24:27], v4 offset:22528
    v_mfma_f32_16x16x32_bf16 v[132:135], v[28:31], v[44:47], v[132:135]
    ds_read_b64_tr_b16 v[56:57], v9 offset:24576
    v_mfma_f32_16x16x32_bf16 v[136:139], v[32:35], v[44:47], v[136:139]
    ds_read_b64_tr_b16 v[58:59], v9 offset:25088
    v_mfma_f32_16x16x32_bf16 v[140:143], v[36:39], v[44:47], v[140:143]
    ds_read_b64_tr_b16 v[60:61], v10 offset:0
    v_mfma_f32_16x16x32_bf16 v[144:147], v[40:43], v[44:47], v[144:147]
    ds_read_b64_tr_b16 v[62:63], v10 offset:512
    v_mfma_f32_16x16x32_bf16 v[148:151], v[28:31], v[48:51], v[148:151]
    ds_read_b64_tr_b16 v[64:65], v11 offset:0
    v_mfma_f32_16x16x32_bf16 v[152:155], v[32:35], v[48:51], v[152:155]
    ds_read_b64_tr_b16 v[66:67], v11 offset:512
    v_mfma_f32_16x16x32_bf16 v[156:159], v[36:39], v[48:51], v[156:159]
    v_mfma_f32_16x16x32_bf16 v[160:163], v[40:43], v[48:51], v[160:163]
    s_waitcnt lgkmcnt(9)
    v_mfma_f32_16x16x32_bf16 v[100:103], v[12:15], v[52:55], v[100:103]
    ds_read_b128 v[28:31], v5 offset:16384
    s_waitcnt lgkmcnt(9)
    v_mfma_f32_16x16x32_bf16 v[104:107], v[16:19], v[52:55], v[104:107]
    ds_read_b64_tr_b16 v[44:45], v8 offset:28672
    s_waitcnt lgkmcnt(9)
    v_mfma_f32_16x16x32_bf16 v[108:111], v[20:23], v[52:55], v[108:111]
    ds_read_b64_tr_b16 v[46:47], v8 offset:29184
    s_waitcnt lgkmcnt(9)
    v_mfma_f32_16x16x32_bf16 v[112:115], v[24:27], v[52:55], v[112:115]
    ds_read_b128 v[32:35], v5 offset:18432
    s_waitcnt lgkmcnt(8)
    s_nop 0
    v_mfma_f32_16x16x32_bf16 v[116:119], v[12:15], v[56:59], v[116:119]
    ds_read_b128 v[36:39], v5 offset:20480
    v_mfma_f32_16x16x32_bf16 v[120:123], v[16:19], v[56:59], v[120:123]
    ds_read_b128 v[40:43], v5 offset:22528
    v_mfma_f32_16x16x32_bf16 v[124:127], v[20:23], v[56:59], v[124:127]
    ds_read_b64_tr_b16 v[48:49], v9 offset:28672
    v_mfma_f32_16x16x32_bf16 v[128:131], v[24:27], v[56:59], v[128:131]
    ds_read_b64_tr_b16 v[50:51], v9 offset:29184
    s_waitcnt lgkmcnt(10)
    s_nop 0
    v_mfma_f32_16x16x32_bf16 v[132:135], v[12:15], v[60:63], v[132:135]
    ds_read_b64_tr_b16 v[52:53], v10 offset:4096
    v_mfma_f32_16x16x32_bf16 v[136:139], v[16:19], v[60:63], v[136:139]
    ds_read_b64_tr_b16 v[54:55], v10 offset:4608
    v_mfma_f32_16x16x32_bf16 v[140:143], v[20:23], v[60:63], v[140:143]
    ds_read_b64_tr_b16 v[56:57], v11 offset:4096
    v_mfma_f32_16x16x32_bf16 v[144:147], v[24:27], v[60:63], v[144:147]
    ds_read_b64_tr_b16 v[58:59], v11 offset:4608
    s_waitcnt lgkmcnt(12)
    v_mfma_f32_16x16x32_bf16 v[148:151], v[12:15], v[64:67], v[148:151]
    v_mfma_f32_16x16x32_bf16 v[152:155], v[16:19], v[64:67], v[152:155]
    v_mfma_f32_16x16x32_bf16 v[156:159], v[20:23], v[64:67], v[156:159]
    v_mfma_f32_16x16x32_bf16 v[160:163], v[24:27], v[64:67], v[160:163]
    s_waitcnt lgkmcnt(9)
    v_mfma_f32_16x16x32_bf16 v[100:103], v[28:31], v[44:47], v[100:103]
    s_waitcnt lgkmcnt(8)
    v_mfma_f32_16x16x32_bf16 v[104:107], v[32:35], v[44:47], v[104:107]
    s_waitcnt lgkmcnt(0)
    s_barrier
    s_nop 0
    v_mfma_f32_16x16x32_bf16 v[108:111], v[36:39], v[44:47], v[108:111]
    ds_read_b128 v[12:15], v4 offset:32768
    v_mfma_f32_16x16x32_bf16 v[112:115], v[40:43], v[44:47], v[112:115]
    ds_read_b64_tr_b16 v[60:61], v10 offset:8192
    v_mfma_f32_16x16x32_bf16 v[116:119], v[28:31], v[48:51], v[116:119]
    ds_read_b64_tr_b16 v[62:63], v10 offset:8704
    v_mfma_f32_16x16x32_bf16 v[120:123], v[32:35], v[48:51], v[120:123]
    ds_read_b128 v[16:19], v4 offset:34816
    v_mfma_f32_16x16x32_bf16 v[124:127], v[36:39], v[48:51], v[124:127]
    ds_read_b128 v[20:23], v4 offset:36864
    v_mfma_f32_16x16x32_bf16 v[128:131], v[40:43], v[48:51], v[128:131]
    ds_read_b128 v[24:27], v4 offset:38912
    v_mfma_f32_16x16x32_bf16 v[132:135], v[28:31], v[52:55], v[132:135]
    ds_read_b64_tr_b16 v[64:65], v11 offset:8192
    v_mfma_f32_16x16x32_bf16 v[136:139], v[32:35], v[52:55], v[136:139]
    ds_read_b64_tr_b16 v[66:67], v11 offset:8704
    v_mfma_f32_16x16x32_bf16 v[140:143], v[36:39], v[52:55], v[140:143]
    ds_read_b64_tr_b16 v[44:45], v10 offset:16384
    v_mfma_f32_16x16x32_bf16 v[144:147], v[40:43], v[52:55], v[144:147]
    ds_read_b64_tr_b16 v[46:47], v10 offset:16896
    v_mfma_f32_16x16x32_bf16 v[148:151], v[28:31], v[56:59], v[148:151]
    ds_read_b64_tr_b16 v[48:49], v11 offset:16384
    v_mfma_f32_16x16x32_bf16 v[152:155], v[32:35], v[56:59], v[152:155]
    ds_read_b64_tr_b16 v[50:51], v11 offset:16896
    v_mfma_f32_16x16x32_bf16 v[156:159], v[36:39], v[56:59], v[156:159]
    v_mfma_f32_16x16x32_bf16 v[160:163], v[40:43], v[56:59], v[160:163]
    s_waitcnt lgkmcnt(9)
    v_mfma_f32_16x16x32_bf16 v[100:103], v[12:15], v[60:63], v[100:103]
    ds_read_b128 v[28:31], v5 offset:32768
    s_waitcnt lgkmcnt(9)
    v_mfma_f32_16x16x32_bf16 v[104:107], v[16:19], v[60:63], v[104:107]
    ds_read_b64_tr_b16 v[52:53], v10 offset:12288
    s_waitcnt lgkmcnt(9)
    v_mfma_f32_16x16x32_bf16 v[108:111], v[20:23], v[60:63], v[108:111]
    ds_read_b64_tr_b16 v[54:55], v10 offset:12800
    s_waitcnt lgkmcnt(9)
    v_mfma_f32_16x16x32_bf16 v[112:115], v[24:27], v[60:63], v[112:115]
    ds_read_b128 v[32:35], v5 offset:34816
    s_waitcnt lgkmcnt(8)
    s_nop 0
    v_mfma_f32_16x16x32_bf16 v[116:119], v[12:15], v[64:67], v[116:119]
    ds_read_b128 v[36:39], v5 offset:36864
    v_mfma_f32_16x16x32_bf16 v[120:123], v[16:19], v[64:67], v[120:123]
    ds_read_b128 v[40:43], v5 offset:38912
    v_mfma_f32_16x16x32_bf16 v[124:127], v[20:23], v[64:67], v[124:127]
    ds_read_b64_tr_b16 v[56:57], v11 offset:12288
    v_mfma_f32_16x16x32_bf16 v[128:131], v[24:27], v[64:67], v[128:131]
    ds_read_b64_tr_b16 v[58:59], v11 offset:12800
    s_waitcnt lgkmcnt(10)
    s_nop 0
    v_mfma_f32_16x16x32_bf16 v[132:135], v[12:15], v[44:47], v[132:135]
    ds_read_b64_tr_b16 v[60:61], v10 offset:20480
    v_mfma_f32_16x16x32_bf16 v[136:139], v[16:19], v[44:47], v[136:139]
    ds_read_b64_tr_b16 v[62:63], v10 offset:20992
    v_mfma_f32_16x16x32_bf16 v[140:143], v[20:23], v[44:47], v[140:143]
    ds_read_b64_tr_b16 v[64:65], v11 offset:20480
    v_mfma_f32_16x16x32_bf16 v[144:147], v[24:27], v[44:47], v[144:147]
    ds_read_b64_tr_b16 v[66:67], v11 offset:20992
    s_waitcnt lgkmcnt(12)
    v_mfma_f32_16x16x32_bf16 v[148:151], v[12:15], v[48:51], v[148:151]
    v_mfma_f32_16x16x32_bf16 v[152:155], v[16:19], v[48:51], v[152:155]
    v_mfma_f32_16x16x32_bf16 v[156:159], v[20:23], v[48:51], v[156:159]
    v_mfma_f32_16x16x32_bf16 v[160:163], v[24:27], v[48:51], v[160:163]
    s_waitcnt lgkmcnt(9)
    v_mfma_f32_16x16x32_bf16 v[100:103], v[28:31], v[52:55], v[100:103]
    s_waitcnt lgkmcnt(8)
    v_mfma_f32_16x16x32_bf16 v[104:107], v[32:35], v[52:55], v[104:107]
    s_waitcnt lgkmcnt(0)
    s_barrier
    s_nop 0
    v_mfma_f32_16x16x32_bf16 v[108:111], v[36:39], v[52:55], v[108:111]
    ds_read_b128 v[12:15], v4 offset:49152
    v_mfma_f32_16x16x32_bf16 v[112:115], v[40:43], v[52:55], v[112:115]
    ds_read_b64_tr_b16 v[44:45], v8 offset:0
    v_mfma_f32_16x16x32_bf16 v[116:119], v[28:31], v[56:59], v[116:119]
    ds_read_b64_tr_b16 v[46:47], v8 offset:512
    v_mfma_f32_16x16x32_bf16 v[120:123], v[32:35], v[56:59], v[120:123]
    ds_read_b128 v[16:19], v4 offset:51200
    v_mfma_f32_16x16x32_bf16 v[124:127], v[36:39], v[56:59], v[124:127]
    ds_read_b128 v[20:23], v4 offset:53248
    v_mfma_f32_16x16x32_bf16 v[128:131], v[40:43], v[56:59], v[128:131]
    ds_read_b128 v[24:27], v4 offset:55296
    v_mfma_f32_16x16x32_bf16 v[132:135], v[28:31], v[60:63], v[132:135]
    ds_read_b64_tr_b16 v[48:49], v9 offset:0
    v_mfma_f32_16x16x32_bf16 v[136:139], v[32:35], v[60:63], v[136:139]
    ds_read_b64_tr_b16 v[50:51], v9 offset:512
    v_mfma_f32_16x16x32_bf16 v[140:143], v[36:39], v[60:63], v[140:143]
    ds_read_b64_tr_b16 v[52:53], v10 offset:24576
    v_mfma_f32_16x16x32_bf16 v[144:147], v[40:43], v[60:63], v[144:147]
    ds_read_b64_tr_b16 v[54:55], v10 offset:25088
    v_mfma_f32_16x16x32_bf16 v[148:151], v[28:31], v[64:67], v[148:151]
    ds_read_b64_tr_b16 v[56:57], v11 offset:24576
    v_mfma_f32_16x16x32_bf16 v[152:155], v[32:35], v[64:67], v[152:155]
    ds_read_b64_tr_b16 v[58:59], v11 offset:25088
    v_mfma_f32_16x16x32_bf16 v[156:159], v[36:39], v[64:67], v[156:159]
    v_mfma_f32_16x16x32_bf16 v[160:163], v[40:43], v[64:67], v[160:163]
    ds_read_b32 v68, v1 offset:48
    s_waitcnt lgkmcnt(10)
    v_mfma_f32_16x16x32_bf16 v[100:103], v[12:15], v[44:47], v[100:103]
    ds_read_b128 v[28:31], v5 offset:49152
    s_waitcnt lgkmcnt(10)
    v_mfma_f32_16x16x32_bf16 v[104:107], v[16:19], v[44:47], v[104:107]
    ds_read_b64_tr_b16 v[60:61], v8 offset:4096
    s_waitcnt lgkmcnt(10)
    v_mfma_f32_16x16x32_bf16 v[108:111], v[20:23], v[44:47], v[108:111]
    ds_read_b64_tr_b16 v[62:63], v8 offset:4608
    s_waitcnt lgkmcnt(10)
    v_mfma_f32_16x16x32_bf16 v[112:115], v[24:27], v[44:47], v[112:115]
    ds_read_b128 v[32:35], v5 offset:51200
    s_waitcnt lgkmcnt(9)
    s_nop 0
    v_mfma_f32_16x16x32_bf16 v[116:119], v[12:15], v[48:51], v[116:119]
    ds_read_b128 v[36:39], v5 offset:53248
    v_mfma_f32_16x16x32_bf16 v[120:123], v[16:19], v[48:51], v[120:123]
    ds_read_b128 v[40:43], v5 offset:55296
    v_mfma_f32_16x16x32_bf16 v[124:127], v[20:23], v[48:51], v[124:127]
    ds_read_b64_tr_b16 v[64:65], v9 offset:4096
    v_mfma_f32_16x16x32_bf16 v[128:131], v[24:27], v[48:51], v[128:131]
    ds_read_b64_tr_b16 v[66:67], v9 offset:4608
    s_waitcnt lgkmcnt(11)
    s_nop 0
    v_mfma_f32_16x16x32_bf16 v[132:135], v[12:15], v[52:55], v[132:135]
    ds_read_b64_tr_b16 v[44:45], v10 offset:28672
    v_mfma_f32_16x16x32_bf16 v[136:139], v[16:19], v[52:55], v[136:139]
    ds_read_b64_tr_b16 v[46:47], v10 offset:29184
    v_mfma_f32_16x16x32_bf16 v[140:143], v[20:23], v[52:55], v[140:143]
    ds_read_b64_tr_b16 v[48:49], v11 offset:28672
    v_mfma_f32_16x16x32_bf16 v[144:147], v[24:27], v[52:55], v[144:147]
    ds_read_b64_tr_b16 v[50:51], v11 offset:29184
    s_waitcnt lgkmcnt(13)
    v_mfma_f32_16x16x32_bf16 v[148:151], v[12:15], v[56:59], v[148:151]
    v_mfma_f32_16x16x32_bf16 v[152:155], v[16:19], v[56:59], v[152:155]
    v_mfma_f32_16x16x32_bf16 v[156:159], v[20:23], v[56:59], v[156:159]
    v_mfma_f32_16x16x32_bf16 v[160:163], v[24:27], v[56:59], v[160:163]
    s_waitcnt lgkmcnt(9)
    v_mfma_f32_16x16x32_bf16 v[100:103], v[28:31], v[60:63], v[100:103]
    v_lshlrev_b32 v18, 4, v0
    v_add_u32 v12, s52, v18
    s_waitcnt lgkmcnt(8)
    v_mfma_f32_16x16x32_bf16 v[104:107], v[32:35], v[60:63], v[104:107]
    v_xor_b32 v13, 4096, v12
    v_and_b32 v14, 0x30, v0
    s_waitcnt lgkmcnt(0)
    s_barrier
    v_cmp_gt_u32 vcc, 1, v68
    s_nop 0
    s_and_b32 vcc_lo, vcc_lo, 3
    s_cbranch_scc0 SCK_15
    v_and_b32 v69, 1, v0
    v_lshlrev_b32 v69, 2, v69
    v_add_u32 v69, 159088, v69
    ds_read_b32 v68, v69 offset:0
FW_16:
    s_waitcnt lgkmcnt(0)
    v_cmp_gt_u32 vcc, 1, v68
    s_cbranch_vccz FO_17
    ds_read_b32 v68, v69 offset:0
    s_branch FW_16
FO_17:
SCK_15:
    v_mfma_f32_16x16x32_bf16 v[108:111], v[36:39], v[60:63], v[108:111]
    ds_read_b128 v[68:71], v164 offset:0
    v_add_u32 v14, s53, v14
    v_mfma_f32_16x16x32_bf16 v[112:115], v[40:43], v[60:63], v[112:115]
    ds_read2_b32 v[52:53], v165 offset0:64 offset1:64
    v_xor_b32 v15, 64, v14
    v_mfma_f32_16x16x32_bf16 v[116:119], v[28:31], v[64:67], v[116:119]
    ds_read2_b32 v[54:55], v2 offset0:64 offset1:64
    v_lshlrev_b32 v19, 2, v0
    v_mfma_f32_16x16x32_bf16 v[120:123], v[32:35], v[64:67], v[120:123]
    ds_read2_b32 v[56:57], v165 offset0:128 offset1:128
    v_add_u32 v16, s53, v19
    v_mfma_f32_16x16x32_bf16 v[124:127], v[36:39], v[64:67], v[124:127]
    ds_read2_b32 v[58:59], v2 offset0:128 offset1:128
    v_xor_b32 v17, 256, v16
    v_mfma_f32_16x16x32_bf16 v[128:131], v[40:43], v[64:67], v[128:131]
    ds_read_b128 v[72:75], v164 offset:1024
    v_xor_b32_e64 v18, 8, v3
    v_mfma_f32_16x16x32_bf16 v[132:135], v[28:31], v[44:47], v[132:135]
    ds_read_b128 v[76:79], v164 offset:64
    v_writelane_b32 v18, s50, 1
    v_mfma_f32_16x16x32_bf16 v[136:139], v[32:35], v[44:47], v[136:139]
    ds_read_b128 v[80:83], v164 offset:1088
    v_mov_b32 v20, 0x3f803f80
    v_mfma_f32_16x16x32_bf16 v[140:143], v[36:39], v[44:47], v[140:143]
    ds_read_b128 v[84:87], v164 offset:128
    v_mov_b32 v21, 0x3f803f80
    v_mfma_f32_16x16x32_bf16 v[144:147], v[40:43], v[44:47], v[144:147]
    ds_read_b128 v[88:91], v164 offset:1152
    v_mov_b32 v22, 0x3f803f80
    v_mfma_f32_16x16x32_bf16 v[148:151], v[28:31], v[48:51], v[148:151]
    ds_read_b128 v[92:95], v164 offset:192
    v_mov_b32 v23, 0x3f803f80
    v_mfma_f32_16x16x32_bf16 v[152:155], v[32:35], v[48:51], v[152:155]
    ds_read_b128 v[96:99], v164 offset:1216
    v_mov_b32 v24, 1
    v_and_b32 v4, 15, v0
    v_mfma_f32_16x16x32_bf16 v[156:159], v[36:39], v[48:51], v[156:159]
    v_bfe_u32 v5, v0, 4, 1
    v_lshlrev_b32 v5, 5, v5
    v_mfma_f32_16x16x32_bf16 v[160:163], v[40:43], v[48:51], v[160:163]
    v_lshrrev_b32 v6, 5, v0
    v_lshl_add_u32 v5, v6, 4, v5
    v_lshl_add_u32 v7, v4, 11, v5
    v_lshlrev_b32 v6, 4, v0
    s_waitcnt lgkmcnt(10)
    v_pk_fma_f32 v[100:101], v[68:69], v[52:53], v[100:101]
    v_pk_fma_f32 v[102:103], v[70:71], v[52:53], v[102:103]
    s_waitcnt lgkmcnt(9)
    v_pk_fma_f32 v[116:117], v[68:69], v[54:55], v[116:117]
    v_pk_fma_f32 v[118:119], v[70:71], v[54:55], v[118:119]
    s_waitcnt lgkmcnt(8)
    v_pk_fma_f32 v[132:133], v[68:69], v[56:57], v[132:133]
    v_pk_fma_f32 v[134:135], v[70:71], v[56:57], v[134:135]
    s_waitcnt lgkmcnt(7)
    v_pk_fma_f32 v[148:149], v[68:69], v[58:59], v[148:149]
    v_pk_fma_f32 v[150:151], v[70:71], v[58:59], v[150:151]
    s_waitcnt lgkmcnt(6)
    v_pk_mul_f32 v[100:101], v[100:101], v[72:73]
    v_pk_mul_f32 v[102:103], v[102:103], v[74:75]
    v_pk_mul_f32 v[116:117], v[116:117], v[72:73]
    v_pk_mul_f32 v[118:119], v[118:119], v[74:75]
    v_pk_mul_f32 v[132:133], v[132:133], v[72:73]
    v_pk_mul_f32 v[134:135], v[134:135], v[74:75]
    v_pk_mul_f32 v[148:149], v[148:149], v[72:73]
    v_pk_mul_f32 v[150:151], v[150:151], v[74:75]
    v_exp_f32 v28, v100 clamp
    v_exp_f32 v29, v101 clamp
    v_exp_f32 v30, v102 clamp
    v_exp_f32 v31, v103 clamp
    v_exp_f32 v32, v116 clamp
    v_exp_f32 v33, v117 clamp
    v_exp_f32 v34, v118 clamp
    v_exp_f32 v35, v119 clamp
    v_cvt_pk_bf16_f32 v132, v132, v133
    v_cvt_pk_bf16_f32 v133, v134, v135
    v_cvt_pk_bf16_f32 v148, v148, v149
    v_cvt_pk_bf16_f32 v149, v150, v151
    v_pk_mul_f32 v[100:101], v[100:101], s[40:41] clamp
    v_pk_mul_f32 v[102:103], v[102:103], s[40:41] clamp
    v_pk_mul_f32 v[116:117], v[116:117], s[40:41] clamp
    v_pk_mul_f32 v[118:119], v[118:119], s[40:41] clamp
    v_pk_add_f32 v[28:29], v[28:29], s[74:75]
    v_pk_add_f32 v[30:31], v[30:31], s[74:75]
    v_pk_add_f32 v[32:33], v[32:33], s[74:75]
    v_pk_add_f32 v[34:35], v[34:35], s[74:75]
    v_pk_fma_f32 v[100:101], v[100:101], s[76:77], v[28:29]
    v_pk_fma_f32 v[102:103], v[102:103], s[76:77], v[30:31]
    v_pk_fma_f32 v[116:117], v[116:117], s[76:77], v[32:33]
    v_pk_fma_f32 v[118:119], v[118:119], s[76:77], v[34:35]
    v_cvt_pk_bf16_f32 v100, v100, v101
    v_cvt_pk_bf16_f32 v101, v102, v103
    v_cvt_pk_bf16_f32 v116, v116, v117
    v_cvt_pk_bf16_f32 v117, v118, v119
    s_waitcnt lgkmcnt(5)
    s_nop 0
    v_pk_fma_f32 v[104:105], v[76:77], v[52:53], v[104:105]
    v_pk_fma_f32 v[106:107], v[78:79], v[52:53], v[106:107]
    v_pk_fma_f32 v[120:121], v[76:77], v[54:55], v[120:121]
    v_pk_fma_f32 v[122:123], v[78:79], v[54:55], v[122:123]
    v_pk_fma_f32 v[136:137], v[76:77], v[56:57], v[136:137]
    v_pk_fma_f32 v[138:139], v[78:79], v[56:57], v[138:139]
    v_pk_fma_f32 v[152:153], v[76:77], v[58:59], v[152:153]
    v_pk_fma_f32 v[154:155], v[78:79], v[58:59], v[154:155]
    s_waitcnt lgkmcnt(4)
    s_nop 0
    v_pk_mul_f32 v[104:105], v[104:105], v[80:81]
    v_pk_mul_f32 v[106:107], v[106:107], v[82:83]
    v_pk_mul_f32 v[120:121], v[120:121], v[80:81]
    v_pk_mul_f32 v[122:123], v[122:123], v[82:83]
    v_pk_mul_f32 v[136:137], v[136:137], v[80:81]
    v_pk_mul_f32 v[138:139], v[138:139], v[82:83]
    v_pk_mul_f32 v[152:153], v[152:153], v[80:81]
    v_pk_mul_f32 v[154:155], v[154:155], v[82:83]
    v_exp_f32 v36, v104 clamp
    v_exp_f32 v37, v105 clamp
    v_exp_f32 v38, v106 clamp
    v_exp_f32 v39, v107 clamp
    v_exp_f32 v40, v120 clamp
    v_exp_f32 v41, v121 clamp
    v_exp_f32 v42, v122 clamp
    v_exp_f32 v43, v123 clamp
    v_cvt_pk_bf16_f32 v134, v136, v137
    v_cvt_pk_bf16_f32 v135, v138, v139
    v_cvt_pk_bf16_f32 v150, v152, v153
    v_cvt_pk_bf16_f32 v151, v154, v155
    v_pk_mul_f32 v[104:105], v[104:105], s[40:41] clamp
    v_pk_mul_f32 v[106:107], v[106:107], s[40:41] clamp
    v_pk_mul_f32 v[120:121], v[120:121], s[40:41] clamp
    v_pk_mul_f32 v[122:123], v[122:123], s[40:41] clamp
    v_pk_add_f32 v[36:37], v[36:37], s[74:75]
    v_pk_add_f32 v[38:39], v[38:39], s[74:75]
    v_pk_add_f32 v[40:41], v[40:41], s[74:75]
    v_pk_add_f32 v[42:43], v[42:43], s[74:75]
    v_pk_fma_f32 v[104:105], v[104:105], s[76:77], v[36:37]
    v_pk_fma_f32 v[106:107], v[106:107], s[76:77], v[38:39]
    v_pk_fma_f32 v[120:121], v[120:121], s[76:77], v[40:41]
    v_pk_fma_f32 v[122:123], v[122:123], s[76:77], v[42:43]
    v_cvt_pk_bf16_f32 v102, v104, v105
    v_cvt_pk_bf16_f32 v103, v106, v107
    v_cvt_pk_bf16_f32 v118, v120, v121
    v_cvt_pk_bf16_f32 v119, v122, v123
    s_waitcnt lgkmcnt(3)
    s_nop 0
    v_pk_fma_f32 v[108:109], v[84:85], v[52:53], v[108:109]
    v_pk_fma_f32 v[110:111], v[86:87], v[52:53], v[110:111]
    v_pk_fma_f32 v[124:125], v[84:85], v[54:55], v[124:125]
    v_pk_fma_f32 v[126:127], v[86:87], v[54:55], v[126:127]
    v_pk_fma_f32 v[140:141], v[84:85], v[56:57], v[140:141]
    v_pk_fma_f32 v[142:143], v[86:87], v[56:57], v[142:143]
    v_pk_fma_f32 v[156:157], v[84:85], v[58:59], v[156:157]
    v_pk_fma_f32 v[158:159], v[86:87], v[58:59], v[158:159]
    s_waitcnt lgkmcnt(2)
    s_nop 0
    v_pk_mul_f32 v[108:109], v[108:109], v[88:89]
    v_pk_mul_f32 v[110:111], v[110:111], v[90:91]
    v_pk_mul_f32 v[124:125], v[124:125], v[88:89]
    v_pk_mul_f32 v[126:127], v[126:127], v[90:91]
    v_pk_mul_f32 v[140:141], v[140:141], v[88:89]
    v_pk_mul_f32 v[142:143], v[142:143], v[90:91]
    v_pk_mul_f32 v[156:157], v[156:157], v[88:89]
    v_pk_mul_f32 v[158:159], v[158:159], v[90:91]
    v_mfma_f32_16x16x32_bf16 v[60:63], v[100:103], v[148:151], 0
    v_exp_f32 v28, v108 clamp
    v_exp_f32 v29, v109 clamp
    v_mfma_f32_16x16x32_bf16 v[64:67], v[116:119], v[148:151], 0
    v_exp_f32 v30, v110 clamp
    v_exp_f32 v31, v111 clamp
    v_mfma_f32_16x16x32_bf16 v[68:71], v[100:103], v[20:23], 0
    v_exp_f32 v32, v124 clamp
    v_exp_f32 v33, v125 clamp
    v_exp_f32 v34, v126 clamp
    v_exp_f32 v35, v127 clamp
    v_cvt_pk_bf16_f32 v136, v140, v141
    v_cvt_pk_bf16_f32 v137, v142, v143
    v_cvt_pk_bf16_f32 v152, v156, v157
    v_cvt_pk_bf16_f32 v153, v158, v159
    v_pk_mul_f32 v[108:109], v[108:109], s[40:41] clamp
    v_pk_mul_f32 v[110:111], v[110:111], s[40:41] clamp
    v_pk_mul_f32 v[124:125], v[124:125], s[40:41] clamp
    v_pk_mul_f32 v[126:127], v[126:127], s[40:41] clamp
    v_pk_add_f32 v[28:29], v[28:29], s[74:75]
    v_pk_add_f32 v[30:31], v[30:31], s[74:75]
    v_pk_add_f32 v[32:33], v[32:33], s[74:75]
    v_pk_add_f32 v[34:35], v[34:35], s[74:75]
    v_pk_fma_f32 v[108:109], v[108:109], s[76:77], v[28:29]
    v_pk_fma_f32 v[110:111], v[110:111], s[76:77], v[30:31]
    v_pk_fma_f32 v[124:125], v[124:125], s[76:77], v[32:33]
    v_pk_fma_f32 v[126:127], v[126:127], s[76:77], v[34:35]
    s_branch IW_s5
IW_w5:
    s_branch IW_r5
IW_s5:
    v_cvt_pk_bf16_f32 v104, v108, v109
    v_cvt_pk_bf16_f32 v105, v110, v111
    v_cvt_pk_bf16_f32 v120, v124, v125
    v_cvt_pk_bf16_f32 v121, v126, v127
    s_waitcnt lgkmcnt(1)
    s_nop 0
    v_pk_fma_f32 v[112:113], v[92:93], v[52:53], v[112:113]
    v_pk_fma_f32 v[114:115], v[94:95], v[52:53], v[114:115]
    v_pk_fma_f32 v[128:129], v[92:93], v[54:55], v[128:129]
    v_pk_fma_f32 v[130:131], v[94:95], v[54:55], v[130:131]
    v_pk_fma_f32 v[144:145], v[92:93], v[56:57], v[144:145]
    v_pk_fma_f32 v[146:147], v[94:95], v[56:57], v[146:147]
    v_pk_fma_f32 v[160:161], v[92:93], v[58:59], v[160:161]
    v_pk_fma_f32 v[162:163], v[94:95], v[58:59], v[162:163]
    s_waitcnt lgkmcnt(0)
    s_nop 0
    v_pk_mul_f32 v[112:113], v[112:113], v[96:97]
    v_pk_mul_f32 v[114:115], v[114:115], v[98:99]
    v_pk_mul_f32 v[128:129], v[128:129], v[96:97]
    v_pk_mul_f32 v[130:131], v[130:131], v[98:99]
    v_pk_mul_f32 v[144:145], v[144:145], v[96:97]
    v_pk_mul_f32 v[146:147], v[146:147], v[98:99]
    v_pk_mul_f32 v[160:161], v[160:161], v[96:97]
    v_pk_mul_f32 v[162:163], v[162:163], v[98:99]
    v_mfma_f32_16x16x32_bf16 v[72:75], v[116:119], v[20:23], 0
    v_exp_f32 v36, v112 clamp
    v_exp_f32 v37, v113 clamp
    v_mfma_f32_16x16x32_bf16 v[44:47], v[100:103], v[132:135], 0
    v_exp_f32 v38, v114 clamp
    v_exp_f32 v39, v115 clamp
    v_mfma_f32_16x16x32_bf16 v[48:51], v[116:119], v[132:135], 0
    v_exp_f32 v40, v128 clamp
    v_exp_f32 v41, v129 clamp
    v_exp_f32 v42, v130 clamp
    v_exp_f32 v43, v131 clamp
    v_cvt_pk_bf16_f32 v138, v144, v145
    v_cvt_pk_bf16_f32 v139, v146, v147
    v_cvt_pk_bf16_f32 v154, v160, v161
    v_cvt_pk_bf16_f32 v155, v162, v163
    v_pk_mul_f32 v[112:113], v[112:113], s[40:41] clamp
    v_pk_mul_f32 v[114:115], v[114:115], s[40:41] clamp
    v_pk_mul_f32 v[128:129], v[128:129], s[40:41] clamp
    v_pk_mul_f32 v[130:131], v[130:131], s[40:41] clamp
    v_pk_add_f32 v[36:37], v[36:37], s[74:75]
    v_pk_add_f32 v[38:39], v[38:39], s[74:75]
    v_pk_add_f32 v[40:41], v[40:41], s[74:75]
    v_pk_add_f32 v[42:43], v[42:43], s[74:75]
    v_pk_fma_f32 v[112:113], v[112:113], s[76:77], v[36:37]
    v_pk_fma_f32 v[114:115], v[114:115], s[76:77], v[38:39]
    v_pk_fma_f32 v[128:129], v[128:129], s[76:77], v[40:41]
    v_pk_fma_f32 v[130:131], v[130:131], s[76:77], v[42:43]
    v_cvt_pk_bf16_f32 v106, v112, v113
    v_cvt_pk_bf16_f32 v107, v114, v115
    v_cvt_pk_bf16_f32 v122, v128, v129
    v_cvt_pk_bf16_f32 v123, v130, v131
    v_mfma_f32_16x16x32_bf16 v[60:63], v[104:107], v[152:155], v[60:63]
    s_nop 0
    s_nop 0
    v_mfma_f32_16x16x32_bf16 v[64:67], v[120:123], v[152:155], v[64:67]
    v_mfma_f32_16x16x32_bf16 v[68:71], v[104:107], v[20:23], v[68:71]
    v_mfma_f32_16x16x32_bf16 v[72:75], v[120:123], v[20:23], v[72:75]
    v_mfma_f32_16x16x32_bf16 v[44:47], v[104:107], v[136:139], v[44:47]
    v_mfma_f32_16x16x32_bf16 v[48:51], v[120:123], v[136:139], v[48:51]
    buffer_load_dwordx4 v[140:143], v7, s[12:15], s42 offen offset:0
    buffer_load_dwordx4 v[144:147], v7, s[12:15], s42 offen offset:64
    buffer_load_dwordx4 v[156:159], v7, s[12:15], s43 offen offset:0
    buffer_load_dwordx4 v[160:163], v7, s[12:15], s43 offen offset:64
    ds_write_b128 v12, v[60:63] offset:0
    ds_write_b128 v12, v[64:67] offset:1024
    s_mov_b32 exec_lo, 0x10001
    s_mov_b32 exec_hi, 0x10001
    ds_write_b128 v14, v[68:71]
    ds_write_b128 v15, v[72:75]
    s_mov_b64 exec, 1
    ds_write_b32 v3, v24 offset:32
    s_mov_b64 exec, -1
F_xw:
    ds_read_b32 v25, v18 offset:32
    ds_read_b128 v[28:31], v13 offset:1024
    ds_read_b128 v[32:35], v13
    ds_read_b32 v26, v16
    ds_read_b32 v27, v17
    s_waitcnt lgkmcnt(4)
    v_cmp_eq_u32 vcc, 0, v25
    s_cbranch_vccz F_xx
    s_waitcnt lgkmcnt(0)
    s_branch F_xw
F_xx:
    s_waitcnt lgkmcnt(3)
    v_add_f32 v44, v44, v28
    v_add_f32 v45, v45, v29
    v_add_f32 v46, v46, v30
    v_add_f32 v47, v47, v31
    buffer_atomic_add_f32 v44, v19, s[24:27], s46 offen offset:0
    buffer_atomic_add_f32 v45, v19, s[24:27], s46 offen offset:256
    buffer_atomic_add_f32 v46, v19, s[24:27], s46 offen offset:512
    buffer_atomic_add_f32 v47, v19, s[24:27], s46 offen offset:768
    s_waitcnt lgkmcnt(2)
    v_add_f32 v48, v48, v32
    v_add_f32 v49, v49, v33
    v_add_f32 v50, v50, v34
    v_add_f32 v51, v51, v35
    buffer_atomic_add_f32 v48, v19, s[24:27], s47 offen offset:0
    buffer_atomic_add_f32 v49, v19, s[24:27], s47 offen offset:256
    buffer_atomic_add_f32 v50, v19, s[24:27], s47 offen offset:512
    buffer_atomic_add_f32 v51, v19, s[24:27], s47 offen offset:768
    s_waitcnt lgkmcnt(0)
    v_add_f32 v26, v26, v27
    s_mov_b64 exec, 0xffff
    buffer_atomic_add_f32 v26, v19, s[24:27], s48 offen
    s_mov_b64 exec, 1
    ds_add_u32 v3, v24 offset:32
    s_mov_b64 exec, -1
    s_setprio 2
    v_mov_b32 v2, v7
    s_lshl_b32 s47, s3, 7
    s_add_u32 s47, s47, 157184
    v_lshlrev_b32 v5, 2, v4
    v_add_u32 v5, s47, v5
    ds_read2_b32 v[76:77], v5 offset0:0 offset1:128
    ds_read2_b32 v[78:79], v5 offset0:16 offset1:144
    v_lshrrev_b32 v4, 3, v0
    v_and_b32 v5, 7, v0
    v_lshrrev_b32 v6, 1, v4
    v_lshlrev_b32 v7, 1, v6
    v_xor_b32 v7, v5, v7
    v_lshlrev_b32 v7, 4, v7
    v_lshl_add_u32 v40, v4, 11, v7
    v_and_b32 v6, 1, v6
    v_lshlrev_b32 v6, 1, v6
    v_xor_b32 v41, v5, v6
    v_xor_b32 v42, 4, v41
    v_lshlrev_b32 v41, 4, v41
    v_lshlrev_b32 v42, 4, v42
    v_mul_u32_u24 v7, 6144, v4
    v_add_u32 v41, v41, v7
    v_add_u32 v42, v42, v7
    v_add_u32 v42, 49152, v42
    s_mul_i32 s56, s3, 98304
    s_lshl_b32 s47, s10, 7
    s_add_u32 s56, s56, s47
    s_lshl_b32 s57, s29, 7
    s_lshl_b32 s47, s3, 15
    s_add_u32 s57, s57, s47
    s_and_b32 s81, s28, 3
    s_mul_i32 s81, s81, 4
    s_lshr_b32 s47, s28, 2
    s_mul_i32 s47, s47, 1
    s_add_u32 s81, s81, s47
    s_lshl_b32 s78, s3, 11
    s_lshl_b32 s44, s10, 1
    s_add_u32 s44, s44, s37
    s_mul_i32 s45, s44, 4224
    s_mov_b32 s52, s45
    s_add_u32 s53, s45, 4096
    s_lshl_b32 s51, s44, 3
    s_and_b32 s47, s32, 3
    s_add_u32 s51, s51, s47
    s_lshl_b32 s51, s51, 7
    v_xor_b32 v18, 8, v3
    v_mov_b32 v25, 0

    s_add_u32 s54, s51, 0x82d000
    s_add_u32 s54, s72, s54
    s_addc_u32 s55, s73, 0
    s_add_u32 s82, s49, 0x82d000
    s_add_u32 s82, s72, s82
    s_addc_u32 s83, s73, 0
    s_lshl_b32 s57, s29, 7
    s_and_b32 s47, s3, 1
    s_lshl_b32 s79, s47, 12
    s_lshl_b32 s47, s47, 16
    s_add_u32 s57, s57, s47

    s_setprio 2
    s_waitcnt lgkmcnt(0)
    v_mul_f32 v76, v76, v77
    v_add_f32 v77, 1.0, v77
    v_mul_f32 v78, v78, v79
    v_add_f32 v79, 1.0, v79
    s_waitcnt vmcnt(9)
    v_lshlrev_b32 v100, 16, v140
    v_and_b32 v101, 0xffff0000, v140
    v_lshlrev_b32 v102, 16, v141
    v_and_b32 v103, 0xffff0000, v141
    v_lshlrev_b32 v104, 16, v142
    v_and_b32 v105, 0xffff0000, v142
    v_lshlrev_b32 v106, 16, v143
    v_and_b32 v107, 0xffff0000, v143
    v_fma_f32 v100, v100, v77, v76
    v_fma_f32 v101, v101, v77, v76
    v_fma_f32 v102, v102, v77, v76
    v_fma_f32 v103, v103, v77, v76
    v_fma_f32 v104, v104, v77, v76
    v_fma_f32 v105, v105, v77, v76
    v_fma_f32 v106, v106, v77, v76
    v_fma_f32 v107, v107, v77, v76
    v_lshlrev_b32 v108, 16, v144
    v_and_b32 v109, 0xffff0000, v144
    v_lshlrev_b32 v110, 16, v145
    v_and_b32 v111, 0xffff0000, v145
    v_lshlrev_b32 v112, 16, v146
    v_and_b32 v113, 0xffff0000, v146
    v_lshlrev_b32 v114, 16, v147
    v_and_b32 v115, 0xffff0000, v147
    v_fma_f32 v108, v108, v77, v76
    v_fma_f32 v109, v109, v77, v76
    v_fma_f32 v110, v110, v77, v76
    v_fma_f32 v111, v111, v77, v76
    v_fma_f32 v112, v112, v77, v76
    v_fma_f32 v113, v113, v77, v76
    v_fma_f32 v114, v114, v77, v76
    v_fma_f32 v115, v115, v77, v76
    v_lshlrev_b32 v116, 16, v156
    v_and_b32 v117, 0xffff0000, v156
    v_lshlrev_b32 v118, 16, v157
    v_and_b32 v119, 0xffff0000, v157
    v_lshlrev_b32 v120, 16, v158
    v_and_b32 v121, 0xffff0000, v158
    v_lshlrev_b32 v122, 16, v159
    v_and_b32 v123, 0xffff0000, v159
    v_fma_f32 v116, v116, v79, v78
    v_fma_f32 v117, v117, v79, v78
    v_fma_f32 v118, v118, v79, v78
    v_fma_f32 v119, v119, v79, v78
    v_fma_f32 v120, v120, v79, v78
    v_fma_f32 v121, v121, v79, v78
    v_fma_f32 v122, v122, v79, v78
    v_fma_f32 v123, v123, v79, v78
    v_lshlrev_b32 v124, 16, v160
    v_and_b32 v125, 0xffff0000, v160
    v_lshlrev_b32 v126, 16, v161
    v_and_b32 v127, 0xffff0000, v161
    v_lshlrev_b32 v128, 16, v162
    v_and_b32 v129, 0xffff0000, v162
    v_lshlrev_b32 v130, 16, v163
    v_and_b32 v131, 0xffff0000, v163
    v_fma_f32 v124, v124, v79, v78
    v_fma_f32 v125, v125, v79, v78
    v_fma_f32 v126, v126, v79, v78
    v_fma_f32 v127, v127, v79, v78
    v_fma_f32 v128, v128, v79, v78
    v_fma_f32 v129, v129, v79, v78
    v_fma_f32 v130, v130, v79, v78
    v_fma_f32 v131, v131, v79, v78
    v_permlane16_swap_b32 v100, v104
    v_permlane16_swap_b32 v101, v105
    v_permlane16_swap_b32 v102, v106
    v_permlane16_swap_b32 v103, v107
    v_permlane16_swap_b32 v108, v112
    v_permlane16_swap_b32 v109, v113
    v_permlane16_swap_b32 v110, v114
    v_permlane16_swap_b32 v111, v115
    v_permlane16_swap_b32 v116, v120
    v_permlane16_swap_b32 v117, v121
    v_permlane16_swap_b32 v118, v122
    v_permlane16_swap_b32 v119, v123
    v_permlane16_swap_b32 v124, v128
    v_permlane16_swap_b32 v125, v129
    v_permlane16_swap_b32 v126, v130
    v_permlane16_swap_b32 v127, v131
    s_setprio 2
    s_cmp_lt_u32 s3, 2
    s_cbranch_scc1 F_w0
    v_cmp_gt_u32 vcc, 1, v25
    s_cbranch_vccz CW_18
    ds_read_b32 v25, v1 offset:0
FW_19:
    s_waitcnt lgkmcnt(0)
    v_cmp_gt_u32 vcc, 1, v25
    s_cbranch_vccz FO_20
    s_sleep 2
    ds_read_b32 v25, v1 offset:0
    s_branch FW_19
FO_20:
CW_18:
    s_add_u32 s47, s81, 0
    s_and_b32 s47, s47, 15
    s_lshl_b32 s47, s47, 17
    s_add_u32 m0, s79, 147456
    s_add_u32 s47, s47, s57
    buffer_load_dwordx4 v40, s[20:23], s47 offen lds
    s_add_u32 m0, m0, 1024
    s_add_u32 s47, s47, 16384
    buffer_load_dwordx4 v40, s[20:23], s47 offen lds
    s_add_u32 m0, m0, 1024
    s_add_u32 s47, s47, 16384
    buffer_load_dwordx4 v40, s[20:23], s47 offen lds
    s_add_u32 m0, m0, 1024
    s_add_u32 s47, s47, 16384
    buffer_load_dwordx4 v40, s[20:23], s47 offen lds
    v_cmp_gt_u32 vcc, 2, v25
    s_cbranch_vccz CW_21
    ds_read_b32 v25, v1 offset:0
FW_22:
    s_waitcnt lgkmcnt(0)
    v_cmp_gt_u32 vcc, 2, v25
    s_cbranch_vccz FO_23
    s_sleep 2
    ds_read_b32 v25, v1 offset:0
    s_branch FW_22
FO_23:
CW_21:
    s_add_u32 s47, s81, 1
    s_and_b32 s47, s47, 15
    s_lshl_b32 s47, s47, 17
    s_add_u32 m0, s79, 0
    s_add_u32 s47, s47, s57
    buffer_load_dwordx4 v40, s[20:23], s47 offen lds
    s_add_u32 m0, m0, 1024
    s_add_u32 s47, s47, 16384
    buffer_load_dwordx4 v40, s[20:23], s47 offen lds
    s_add_u32 m0, m0, 1024
    s_add_u32 s47, s47, 16384
    buffer_load_dwordx4 v40, s[20:23], s47 offen lds
    s_add_u32 m0, m0, 1024
    s_add_u32 s47, s47, 16384
    buffer_load_dwordx4 v40, s[20:23], s47 offen lds
    s_waitcnt vmcnt(8)
    s_branch F_w1
F_w0:
    s_waitcnt vmcnt(0)
F_w1:
    s_mov_b32 s49, 1
    s_atomic_add s49, s[82:83], 0x0
    s_atomic_add s49, s[82:83], 0x80
    s_atomic_add s49, s[82:83], 0x100
    s_atomic_add s49, s[82:83], 0x180
    v_mov_b32 v26, 3
    s_mov_b64 exec, 1
    ds_write_b32 v3, v26 offset:32
    s_mov_b64 exec, -1
    s_cmp_ge_u32 s3, 2
    s_cbranch_scc1 F_wo
    ds_read_b32 v26, v18 offset:32
FW_24:
    s_waitcnt lgkmcnt(0)
    v_cmp_gt_u32 vcc, 2, v26
    s_cbranch_vccz FO_25
    ds_read_b32 v26, v18 offset:32
    s_branch FW_24
FO_25:
    v_cmp_gt_u32 vcc, 4, v25
    s_cbranch_vccz CW_26
    ds_read_b32 v25, v1 offset:0
FW_27:
    s_waitcnt lgkmcnt(0)
    v_cmp_gt_u32 vcc, 4, v25
    s_cbranch_vccz FO_28
    s_sleep 2
    ds_read_b32 v25, v1 offset:0
    s_branch FW_27
FO_28:
CW_26:
    v_lshlrev_b32 v9, 4, v0
    s_lshl_b32 s50, s3, 7
    s_add_u32 s50, s50, 159232
    s_add_u32 m0, s78, 40960
SP_29:
    s_load_dword s58, s[54:55], 0 glc
    s_waitcnt lgkmcnt(0)
    s_cmp_ge_u32 s58, 32
    s_cbranch_scc1 SD_30
    s_sleep 1
    s_branch SP_29
SD_30:
    buffer_load_dwordx4 v9, s[24:27], s52 offen offset:0 sc1 lds
    buffer_load_dwordx4 v9, s[24:27], s52 offen offset:1024 sc1 lds
    s_add_u32 m0, m0, 2048
    s_nop 0
    buffer_load_dwordx4 v9, s[24:27], s52 offen offset:2048 sc1 lds
    buffer_load_dwordx4 v9, s[24:27], s52 offen offset:3072 sc1 lds
    s_mov_b32 m0, s50
    s_mov_b32 exec_hi, 0
    buffer_load_dword v19, s[24:27], s53 offen sc1 lds
    s_mov_b64 exec, 1
    s_lshl_b32 s50, s3, 2
    s_add_u32 m0, s50, 159168
    s_add_u32 s51, s51, 184320
    buffer_load_dword v19, s[24:27], s51 offen sc1 lds
    s_waitcnt vmcnt(0)
    s_mov_b64 exec, 1
    v_mov_b32 v26, 32
    ds_write_b32 v3, v26 offset:128
    s_mov_b64 exec, -1
    s_branch F_wj
F_wo:
    v_cmp_gt_u32 vcc, 2, v25
    s_cbranch_vccz CW_31
    ds_read_b32 v25, v1 offset:0
FW_32:
    s_waitcnt lgkmcnt(0)
    v_cmp_gt_u32 vcc, 2, v25
    s_cbranch_vccz FO_33
    s_sleep 2
    ds_read_b32 v25, v1 offset:0
    s_branch FW_32
FO_33:
CW_31:
    s_add_u32 s47, s81, 2
    s_and_b32 s47, s47, 15
    s_lshl_b32 s47, s47, 17
    s_add_u32 m0, s79, 8192
    s_add_u32 s47, s47, s57
    buffer_load_dwordx4 v40, s[20:23], s47 offen lds
    s_add_u32 m0, m0, 1024
    s_add_u32 s47, s47, 16384
    buffer_load_dwordx4 v40, s[20:23], s47 offen lds
    s_add_u32 m0, m0, 1024
    s_add_u32 s47, s47, 16384
    buffer_load_dwordx4 v40, s[20:23], s47 offen lds
    s_add_u32 m0, m0, 1024
    s_add_u32 s47, s47, 16384
    buffer_load_dwordx4 v40, s[20:23], s47 offen lds
    v_cmp_gt_u32 vcc, 2, v25
    s_cbranch_vccz CW_34
    ds_read_b32 v25, v1 offset:0
FW_35:
    s_waitcnt lgkmcnt(0)
    v_cmp_gt_u32 vcc, 2, v25
    s_cbranch_vccz FO_36
    s_sleep 2
    ds_read_b32 v25, v1 offset:0
    s_branch FW_35
FO_36:
CW_34:
    s_add_u32 s47, s81, 3
    s_and_b32 s47, s47, 15
    s_lshl_b32 s47, s47, 17
    s_add_u32 m0, s79, 139264
    s_add_u32 s47, s47, s57
    s_nop 0
    buffer_load_dwordx4 v40, s[20:23], s47 offen lds
    s_add_u32 m0, m0, 1024
    s_add_u32 s47, s47, 16384
    buffer_load_dwordx4 v40, s[20:23], s47 offen lds
    s_add_u32 m0, m0, 1024
    s_add_u32 s47, s47, 16384
    buffer_load_dwordx4 v40, s[20:23], s47 offen lds
    s_add_u32 m0, m0, 1024
    s_add_u32 s47, s47, 16384
    buffer_load_dwordx4 v40, s[20:23], s47 offen lds
    v_cmp_gt_u32 vcc, 3, v25
    s_cbranch_vccz CW_37
    ds_read_b32 v25, v1 offset:0
FW_38:
    s_waitcnt lgkmcnt(0)
    v_cmp_gt_u32 vcc, 3, v25
    s_cbranch_vccz FO_39
    s_sleep 2
    ds_read_b32 v25, v1 offset:0
    s_branch FW_38
FO_39:
CW_37:
    s_waitcnt vmcnt(12)
    s_add_u32 s47, s81, 4
    s_and_b32 s47, s47, 15
    s_lshl_b32 s47, s47, 17
    s_add_u32 m0, s79, 16384
    s_add_u32 s47, s47, s57
    buffer_load_dwordx4 v40, s[20:23], s47 offen lds
    s_add_u32 m0, m0, 1024
    s_add_u32 s47, s47, 16384
    buffer_load_dwordx4 v40, s[20:23], s47 offen lds
    s_add_u32 m0, m0, 1024
    s_add_u32 s47, s47, 16384
    buffer_load_dwordx4 v40, s[20:23], s47 offen lds
    s_add_u32 m0, m0, 1024
    s_add_u32 s47, s47, 16384
    buffer_load_dwordx4 v40, s[20:23], s47 offen lds
    v_cmp_gt_u32 vcc, 3, v25
    s_cbranch_vccz CW_40
    ds_read_b32 v25, v1 offset:0
FW_41:
    s_waitcnt lgkmcnt(0)
    v_cmp_gt_u32 vcc, 3, v25
    s_cbranch_vccz FO_42
    s_sleep 2
    ds_read_b32 v25, v1 offset:0
    s_branch FW_41
FO_42:
CW_40:
    s_waitcnt vmcnt(12)
    s_add_u32 s47, s81, 5
    s_and_b32 s47, s47, 15
    s_lshl_b32 s47, s47, 17
    s_add_u32 m0, s79, 24576
    s_add_u32 s47, s47, s57
    buffer_load_dwordx4 v40, s[20:23], s47 offen lds
    s_add_u32 m0, m0, 1024
    s_add_u32 s47, s47, 16384
    buffer_load_dwordx4 v40, s[20:23], s47 offen lds
    s_add_u32 m0, m0, 1024
    s_add_u32 s47, s47, 16384
    buffer_load_dwordx4 v40, s[20:23], s47 offen lds
    s_add_u32 m0, m0, 1024
    s_add_u32 s47, s47, 16384
    buffer_load_dwordx4 v40, s[20:23], s47 offen lds
    v_cmp_gt_u32 vcc, 3, v25
    s_cbranch_vccz CW_43
    ds_read_b32 v25, v1 offset:0
FW_44:
    s_waitcnt lgkmcnt(0)
    v_cmp_gt_u32 vcc, 3, v25
    s_cbranch_vccz FO_45
    s_sleep 2
    ds_read_b32 v25, v1 offset:0
    s_branch FW_44
FO_45:
CW_43:
    s_waitcnt vmcnt(12)
    s_add_u32 s47, s81, 6
    s_and_b32 s47, s47, 15
    s_lshl_b32 s47, s47, 17
    s_add_u32 m0, s79, 131072
    s_add_u32 s47, s47, s57
    buffer_load_dwordx4 v40, s[20:23], s47 offen lds
    s_add_u32 m0, m0, 1024
    s_add_u32 s47, s47, 16384
    buffer_load_dwordx4 v40, s[20:23], s47 offen lds
    s_add_u32 m0, m0, 1024
    s_add_u32 s47, s47, 16384
    buffer_load_dwordx4 v40, s[20:23], s47 offen lds
    s_add_u32 m0, m0, 1024
    s_add_u32 s47, s47, 16384
    buffer_load_dwordx4 v40, s[20:23], s47 offen lds
    v_cmp_gt_u32 vcc, 4, v25
    s_cbranch_vccz CW_46
    ds_read_b32 v25, v1 offset:0
FW_47:
    s_waitcnt lgkmcnt(0)
    v_cmp_gt_u32 vcc, 4, v25
    s_cbranch_vccz FO_48
    s_sleep 2
    ds_read_b32 v25, v1 offset:0
    s_branch FW_47
FO_48:
CW_46:
    s_waitcnt vmcnt(12)
    s_add_u32 s47, s81, 7
    s_and_b32 s47, s47, 15
    s_lshl_b32 s47, s47, 17
    s_add_u32 m0, s79, 81920
    s_add_u32 s47, s47, s57
    buffer_load_dwordx4 v40, s[20:23], s47 offen lds
    s_add_u32 m0, m0, 1024
    s_add_u32 s47, s47, 16384
    buffer_load_dwordx4 v40, s[20:23], s47 offen lds
    s_add_u32 m0, m0, 1024
    s_add_u32 s47, s47, 16384
    buffer_load_dwordx4 v40, s[20:23], s47 offen lds
    s_add_u32 m0, m0, 1024
    s_add_u32 s47, s47, 16384
    buffer_load_dwordx4 v40, s[20:23], s47 offen lds
    v_cmp_gt_u32 vcc, 5, v25
    s_cbranch_vccz CW_49
    ds_read_b32 v25, v1 offset:0
FW_50:
    s_waitcnt lgkmcnt(0)
    v_cmp_gt_u32 vcc, 5, v25
    s_cbranch_vccz FO_51
    s_sleep 2
    ds_read_b32 v25, v1 offset:0
    s_branch FW_50
FO_51:
CW_49:
    s_waitcnt vmcnt(12)
    s_add_u32 s47, s81, 8
    s_and_b32 s47, s47, 15
    s_lshl_b32 s47, s47, 17
    s_add_u32 m0, s79, 49152
    s_add_u32 s47, s47, s57
    buffer_load_dwordx4 v40, s[20:23], s47 offen lds
    s_add_u32 m0, m0, 1024
    s_add_u32 s47, s47, 16384
    buffer_load_dwordx4 v40, s[20:23], s47 offen lds
    s_add_u32 m0, m0, 1024
    s_add_u32 s47, s47, 16384
    buffer_load_dwordx4 v40, s[20:23], s47 offen lds
    s_add_u32 m0, m0, 1024
    s_add_u32 s47, s47, 16384
    buffer_load_dwordx4 v40, s[20:23], s47 offen lds
    v_cmp_gt_u32 vcc, 5, v25
    s_cbranch_vccz CW_52
    ds_read_b32 v25, v1 offset:0
FW_53:
    s_waitcnt lgkmcnt(0)
    v_cmp_gt_u32 vcc, 5, v25
    s_cbranch_vccz FO_54
    s_sleep 2
    ds_read_b32 v25, v1 offset:0
    s_branch FW_53
FO_54:
CW_52:
    s_waitcnt vmcnt(12)
    s_add_u32 s47, s81, 9
    s_and_b32 s47, s47, 15
    s_lshl_b32 s47, s47, 17
    s_add_u32 m0, s79, 57344
    s_add_u32 s47, s47, s57
    buffer_load_dwordx4 v40, s[20:23], s47 offen lds
    s_add_u32 m0, m0, 1024
    s_add_u32 s47, s47, 16384
    buffer_load_dwordx4 v40, s[20:23], s47 offen lds
    s_add_u32 m0, m0, 1024
    s_add_u32 s47, s47, 16384
    buffer_load_dwordx4 v40, s[20:23], s47 offen lds
    s_add_u32 m0, m0, 1024
    s_add_u32 s47, s47, 16384
    buffer_load_dwordx4 v40, s[20:23], s47 offen lds
    v_cmp_gt_u32 vcc, 5, v25
    s_cbranch_vccz CW_55
    ds_read_b32 v25, v1 offset:0
FW_56:
    s_waitcnt lgkmcnt(0)
    v_cmp_gt_u32 vcc, 5, v25
    s_cbranch_vccz FO_57
    s_sleep 2
    ds_read_b32 v25, v1 offset:0
    s_branch FW_56
FO_57:
CW_55:
    s_waitcnt vmcnt(12)
    s_add_u32 s47, s81, 10
    s_and_b32 s47, s47, 15
    s_lshl_b32 s47, s47, 17
    s_add_u32 m0, s79, 73728
    s_add_u32 s47, s47, s57
    buffer_load_dwordx4 v40, s[20:23], s47 offen lds
    s_add_u32 m0, m0, 1024
    s_add_u32 s47, s47, 16384
    buffer_load_dwordx4 v40, s[20:23], s47 offen lds
    s_add_u32 m0, m0, 1024
    s_add_u32 s47, s47, 16384
    buffer_load_dwordx4 v40, s[20:23], s47 offen lds
    s_add_u32 m0, m0, 1024
    s_add_u32 s47, s47, 16384
    buffer_load_dwordx4 v40, s[20:23], s47 offen lds
    v_cmp_gt_u32 vcc, 6, v25
    s_cbranch_vccz CW_58
    ds_read_b32 v25, v1 offset:0
FW_59:
    s_waitcnt lgkmcnt(0)
    v_cmp_gt_u32 vcc, 6, v25
    s_cbranch_vccz FO_60
    s_sleep 2
    ds_read_b32 v25, v1 offset:0
    s_branch FW_59
FO_60:
CW_58:
    s_waitcnt vmcnt(12)
    s_add_u32 s47, s81, 11
    s_and_b32 s47, s47, 15
    s_lshl_b32 s47, s47, 17
    s_add_u32 m0, s79, 98304
    s_add_u32 s47, s47, s57
    buffer_load_dwordx4 v40, s[20:23], s47 offen lds
    s_add_u32 m0, m0, 1024
    s_add_u32 s47, s47, 16384
    buffer_load_dwordx4 v40, s[20:23], s47 offen lds
    s_add_u32 m0, m0, 1024
    s_add_u32 s47, s47, 16384
    buffer_load_dwordx4 v40, s[20:23], s47 offen lds
    s_add_u32 m0, m0, 1024
    s_add_u32 s47, s47, 16384
    buffer_load_dwordx4 v40, s[20:23], s47 offen lds
    v_cmp_gt_u32 vcc, 7, v25
    s_cbranch_vccz CW_61
    ds_read_b32 v25, v1 offset:0
FW_62:
    s_waitcnt lgkmcnt(0)
    v_cmp_gt_u32 vcc, 7, v25
    s_cbranch_vccz FO_63
    s_sleep 2
    ds_read_b32 v25, v1 offset:0
    s_branch FW_62
FO_63:
CW_61:
    s_waitcnt vmcnt(12)
    s_add_u32 s47, s81, 12
    s_and_b32 s47, s47, 15
    s_lshl_b32 s47, s47, 17
    s_add_u32 m0, s79, 90112
    s_add_u32 s47, s47, s57
    buffer_load_dwordx4 v40, s[20:23], s47 offen lds
    s_add_u32 m0, m0, 1024
    s_add_u32 s47, s47, 16384
    buffer_load_dwordx4 v40, s[20:23], s47 offen lds
    s_add_u32 m0, m0, 1024
    s_add_u32 s47, s47, 16384
    buffer_load_dwordx4 v40, s[20:23], s47 offen lds
    s_add_u32 m0, m0, 1024
    s_add_u32 s47, s47, 16384
    buffer_load_dwordx4 v40, s[20:23], s47 offen lds
    v_cmp_gt_u32 vcc, 8, v25
    s_cbranch_vccz CW_64
    ds_read_b32 v25, v1 offset:0
FW_65:
    s_waitcnt lgkmcnt(0)
    v_cmp_gt_u32 vcc, 8, v25
    s_cbranch_vccz FO_66
    s_sleep 2
    ds_read_b32 v25, v1 offset:0
    s_branch FW_65
FO_66:
CW_64:
    s_waitcnt vmcnt(12)
    s_add_u32 s47, s81, 13
    s_and_b32 s47, s47, 15
    s_lshl_b32 s47, s47, 17
    s_add_u32 m0, s79, 114688
    s_add_u32 s47, s47, s57
    buffer_load_dwordx4 v40, s[20:23], s47 offen lds
    s_add_u32 m0, m0, 1024
    s_add_u32 s47, s47, 16384
    buffer_load_dwordx4 v40, s[20:23], s47 offen lds
    s_add_u32 m0, m0, 1024
    s_add_u32 s47, s47, 16384
    buffer_load_dwordx4 v40, s[20:23], s47 offen lds
    s_add_u32 m0, m0, 1024
    s_add_u32 s47, s47, 16384
    buffer_load_dwordx4 v40, s[20:23], s47 offen lds
    v_cmp_gt_u32 vcc, 9, v25
    s_cbranch_vccz CW_67
    ds_read_b32 v25, v1 offset:0
FW_68:
    s_waitcnt lgkmcnt(0)
    v_cmp_gt_u32 vcc, 9, v25
    s_cbranch_vccz FO_69
    s_sleep 2
    ds_read_b32 v25, v1 offset:0
    s_branch IW_s6
IW_w6:
    s_branch IW_r6
IW_s6:
    s_branch FW_68
FO_69:
CW_67:
    s_waitcnt vmcnt(12)
    s_add_u32 s47, s81, 14
    s_and_b32 s47, s47, 15
    s_lshl_b32 s47, s47, 17
    s_add_u32 m0, s79, 106496
    s_add_u32 s47, s47, s57
    buffer_load_dwordx4 v40, s[20:23], s47 offen lds
    s_add_u32 m0, m0, 1024
    s_add_u32 s47, s47, 16384
    buffer_load_dwordx4 v40, s[20:23], s47 offen lds
    s_add_u32 m0, m0, 1024
    s_add_u32 s47, s47, 16384
    buffer_load_dwordx4 v40, s[20:23], s47 offen lds
    s_add_u32 m0, m0, 1024
    s_add_u32 s47, s47, 16384
    buffer_load_dwordx4 v40, s[20:23], s47 offen lds
    v_cmp_gt_u32 vcc, 10, v25
    s_cbranch_vccz CW_70
    ds_read_b32 v25, v1 offset:0
FW_71:
    s_waitcnt lgkmcnt(0)
    v_cmp_gt_u32 vcc, 10, v25
    s_cbranch_vccz FO_72
    s_sleep 2
    ds_read_b32 v25, v1 offset:0
    s_branch FW_71
FO_72:
CW_70:
    s_waitcnt vmcnt(12)
    s_add_u32 s47, s81, 15
    s_and_b32 s47, s47, 15
    s_lshl_b32 s47, s47, 17
    s_add_u32 m0, s79, 122880
    s_add_u32 s47, s47, s57
    buffer_load_dwordx4 v40, s[20:23], s47 offen lds
    s_add_u32 m0, m0, 1024
    s_add_u32 s47, s47, 16384
    buffer_load_dwordx4 v40, s[20:23], s47 offen lds
    s_add_u32 m0, m0, 1024
    s_add_u32 s47, s47, 16384
    buffer_load_dwordx4 v40, s[20:23], s47 offen lds
    s_add_u32 m0, m0, 1024
    s_add_u32 s47, s47, 16384
    buffer_load_dwordx4 v40, s[20:23], s47 offen lds
F_wj:
    v_mov_b32 v5, 159096
    ds_read_b32 v6, v5 offset:0
FW_73:
    s_waitcnt lgkmcnt(0)
    v_cmp_gt_u32 vcc, 1, v6
    s_cbranch_vccz FO_74
    s_sleep 1
    ds_read_b32 v6, v5 offset:0
    s_branch FW_73
FO_74:
    v_and_b32 v5, 7, v0
    v_lshlrev_b32 v5, 2, v5
    v_add_u32 v5, 158976, v5
    ds_read_b32 v5, v5
    s_lshr_b32 s47, s64, 5
    s_sub_u32 s47, 63, s47
    s_mov_b64 s[60:61], 0
    s_waitcnt lgkmcnt(0)
    v_bfe_u32 v5, v5, 5, 6
    v_cmp_eq_u32 vcc, s47, v5
    s_cbranch_vccz F_ns

    v_mov_b32 v5, 158976
    ds_read_b128 v[44:47], v5
    ds_read_b128 v[48:51], v5 offset:16
    v_and_b32 v6, 15, v0
    v_add_u32 v6, s64, v6
    v_sub_u32 v6, 2047, v6
    v_subrev_u32 v7, 16, v6
    v_mov_b32 v164, 0
    v_mov_b32 v165, 0
    s_waitcnt lgkmcnt(0)
    v_and_b32 v5, 0x7ff, v44
    v_or_b32 v44, 0x4000, v44
    v_cmp_eq_u32 vcc, v5, v6
    v_cmp_eq_u32 s[62:63], v5, v7
    s_nop 0
    v_cndmask_b32 v164, v164, v44, vcc
    v_cndmask_b32 v165, v165, v44, s[62:63]
    v_and_b32 v5, 0x7ff, v45
    v_or_b32 v45, 0x4800, v45
    v_cmp_eq_u32 vcc, v5, v6
    v_cmp_eq_u32 s[62:63], v5, v7
    s_nop 0
    v_cndmask_b32 v164, v164, v45, vcc
    v_cndmask_b32 v165, v165, v45, s[62:63]
    v_and_b32 v5, 0x7ff, v46
    v_or_b32 v46, 0x5000, v46
    v_cmp_eq_u32 vcc, v5, v6
    v_cmp_eq_u32 s[62:63], v5, v7
    s_nop 0
    v_cndmask_b32 v164, v164, v46, vcc
    v_cndmask_b32 v165, v165, v46, s[62:63]
    v_and_b32 v5, 0x7ff, v47
    v_or_b32 v47, 0x5800, v47
    v_cmp_eq_u32 vcc, v5, v6
    v_cmp_eq_u32 s[62:63], v5, v7
    s_nop 0
    v_cndmask_b32 v164, v164, v47, vcc
    v_cndmask_b32 v165, v165, v47, s[62:63]
    v_and_b32 v5, 0x7ff, v48
    v_or_b32 v48, 0x6000, v48
    v_cmp_eq_u32 vcc, v5, v6
    v_cmp_eq_u32 s[62:63], v5, v7
    s_nop 0
    v_cndmask_b32 v164, v164, v48, vcc
    v_cndmask_b32 v165, v165, v48, s[62:63]
    v_and_b32 v5, 0x7ff, v49
    v_or_b32 v49, 0x6800, v49
    v_cmp_eq_u32 vcc, v5, v6
    v_cmp_eq_u32 s[62:63], v5, v7
    s_nop 0
    v_cndmask_b32 v164, v164, v49, vcc
    v_cndmask_b32 v165, v165, v49, s[62:63]
    v_and_b32 v5, 0x7ff, v50
    v_or_b32 v50, 0x7000, v50
    v_cmp_eq_u32 vcc, v5, v6
    v_cmp_eq_u32 s[62:63], v5, v7
    s_nop 0
    v_cndmask_b32 v164, v164, v50, vcc
    v_cndmask_b32 v165, v165, v50, s[62:63]
    v_and_b32 v5, 0x7ff, v51
    v_or_b32 v51, 0x7800, v51
    v_cmp_eq_u32 vcc, v5, v6
    v_cmp_eq_u32 s[62:63], v5, v7
    s_nop 0
    v_cndmask_b32 v164, v164, v51, vcc
    v_cndmask_b32 v165, v165, v51, s[62:63]
    s_mov_b64 s[60:61], 1
F_ns:
    s_lshl_b32 s51, s28, 2
    s_add_u32 s51, s51, s3
    s_lshl_b32 s51, s51, 3
    s_and_b32 s47, s29, 3
    s_add_u32 s51, s51, s47
    s_lshl_b32 s51, s51, 7

    s_add_u32 s54, s51, 0x835000
    s_add_u32 s54, s72, s54
    s_addc_u32 s55, s73, 0
    v_lshlrev_b32 v98, 4, v0
    v_lshrrev_b32 v16, 4, v0
    v_bfe_u32 v17, v0, 2, 2
    v_lshl_add_u32 v17, v16, 2, v17
    v_bfe_u32 v16, v17, 1, 2
    v_lshlrev_b32 v16, 5, v16
    v_lshl_add_u32 v16, v17, 7, v16
    v_and_b32 v17, 3, v0
    v_lshl_add_u32 v4, v17, 3, v16
    v_xor_b32 v5, 32, v4
    v_xor_b32 v6, 64, v4
    v_xor_b32 v7, 96, v4
    s_lshl_b32 s79, s28, 18
    s_lshl_b32 s80, s3, 16
    s_add_u32 s79, s79, s80
    s_lshl_b32 s81, s81, 11
    v_mov_b32_e64 v99, 1

    v_add_u32 v8, 57344, v4
    v_add_u32 v9, 57344, v5
    v_add_u32 v10, 57344, v6
    v_add_u32 v11, 57344, v7
    v_add_u32 v12, 114688, v4
    v_add_u32 v13, 114688, v5
    v_add_u32 v14, 114688, v6
    v_add_u32 v15, 114688, v7
    s_add_u32 s16, s72, 0x400000
    s_addc_u32 s17, s73, 0
    s_mov_b32 s18, 0x400000
    s_mov_b32 s19, 0x00020000
    s_mov_b32 s12, s68
    s_mov_b32 s13, s69
    s_mov_b32 s14, 0x400000
    s_mov_b32 s15, 0x00020000
    s_add_u32 s80, s81, 0
    s_and_b32 s80, s80, 0x7fff
    s_add_u32 s4, s80, s79
    s_add_u32 s80, s81, 2048
    s_and_b32 s80, s80, 0x7fff
    s_add_u32 s5, s80, s79
    s_add_u32 s80, s81, 4096
    s_and_b32 s80, s80, 0x7fff
    s_add_u32 s6, s80, s79
    s_add_u32 s80, s81, 6144
    s_and_b32 s80, s80, 0x7fff
    s_add_u32 s7, s80, s79
    s_add_u32 s80, s81, 8192
    s_and_b32 s80, s80, 0x7fff
    s_add_u32 s8, s80, s79
    s_add_u32 s80, s81, 10240
    s_and_b32 s80, s80, 0x7fff
    s_add_u32 s9, s80, s79
    s_add_u32 s80, s81, 12288
    s_and_b32 s80, s80, 0x7fff
    s_add_u32 s10, s80, s79
    s_add_u32 s80, s81, 14336
    s_and_b32 s80, s80, 0x7fff
    s_add_u32 s11, s80, s79
    s_add_u32 s80, s81, 16384
    s_and_b32 s80, s80, 0x7fff
    s_add_u32 s30, s80, s79
    s_add_u32 s80, s81, 18432
    s_and_b32 s80, s80, 0x7fff
    s_add_u32 s31, s80, s79
    s_add_u32 s80, s81, 20480
    s_and_b32 s80, s80, 0x7fff
    s_add_u32 s32, s80, s79
    s_add_u32 s80, s81, 22528
    s_and_b32 s80, s80, 0x7fff
    s_add_u32 s33, s80, s79
    s_add_u32 s80, s81, 24576
    s_and_b32 s80, s80, 0x7fff
    s_add_u32 s34, s80, s79
    s_add_u32 s80, s81, 26624
    s_and_b32 s80, s80, 0x7fff
    s_add_u32 s35, s80, s79
    s_add_u32 s80, s81, 28672
    s_and_b32 s80, s80, 0x7fff
    s_add_u32 s36, s80, s79
    s_add_u32 s80, s81, 30720
    s_and_b32 s80, s80, 0x7fff
    s_add_u32 s37, s80, s79
    v_add_u32 v97, 0x8000, v98
    s_setprio 2
    s_mov_b32 s50, 0
F_op:
    s_load_dword s47, s[54:55], 0 glc
    s_getreg_b32 s51, hwreg(HW_REG_IB_STS)
    s_and_b32 s51, s51, 0xc0000f
    s_or_b32 s51, s51, s50
    s_cbranch_scc1 F_oq
    s_mov_b64 exec, 1
    ds_write_b32 v3, v99 offset:160
    s_mov_b64 exec, -1
    s_mov_b32 s50, 1
F_oq:
    s_waitcnt lgkmcnt(0)
    s_cmp_lt_u32 s47, 16
    s_cbranch_scc1 F_op
    s_nop 0
    buffer_load_dwordx4 v[48:51], v98, s[16:19], s4 offen offset:0 sc1
    buffer_load_dwordx4 v[52:55], v97, s[16:19], s4 offen offset:0 sc1
    buffer_load_dwordx4 v[56:59], v98, s[16:19], s4 offen offset:1024 sc1
    buffer_load_dwordx4 v[60:63], v97, s[16:19], s4 offen offset:1024 sc1
    buffer_load_dwordx4 v[64:67], v98, s[16:19], s5 offen offset:0 sc1
    buffer_load_dwordx4 v[68:71], v97, s[16:19], s5 offen offset:0 sc1
    buffer_load_dwordx4 v[72:75], v98, s[16:19], s5 offen offset:1024 sc1
    buffer_load_dwordx4 v[76:79], v97, s[16:19], s5 offen offset:1024 sc1
    buffer_load_dwordx4 v[80:83], v98, s[16:19], s6 offen offset:0 sc1
    buffer_load_dwordx4 v[84:87], v97, s[16:19], s6 offen offset:0 sc1
    buffer_load_dwordx4 v[88:91], v98, s[16:19], s6 offen offset:1024 sc1
    buffer_load_dwordx4 v[92:95], v97, s[16:19], s6 offen offset:1024 sc1
    s_cmp_lg_u32 s50, 0
    s_cbranch_scc1 F_or
    s_waitcnt vmcnt(12)
    s_mov_b64 exec, 1
    ds_write_b32 v3, v99 offset:160
    s_mov_b64 exec, -1
F_or:
    v_or_b32 v17, 8, v1
    ds_read_b32 v16, v17 offset:160
FW_75:
    s_waitcnt lgkmcnt(0)
    v_cmp_gt_u32 vcc, 1, v16
    s_cbranch_vccz FO_76
    ds_read_b32 v16, v17 offset:160
    s_branch FW_75
FO_76:
    v_and_b32 v1, 0x3fff, v2
    v_bfe_u32 v99, v0, 3, 1
    v_lshl_add_u32 v1, v99, 6, v1
    ds_read_b64_tr_b16 v[16:17], v12 offset:32768
    ds_read_b64_tr_b16 v[18:19], v12 offset:34816
    ds_read_b64_tr_b16 v[20:21], v13 offset:32768
    ds_read_b64_tr_b16 v[22:23], v13 offset:34816
    ds_read_b64_tr_b16 v[24:25], v14 offset:32768
    ds_read_b64_tr_b16 v[26:27], v14 offset:34816
    ds_read_b64_tr_b16 v[28:29], v15 offset:32768
    ds_read_b64_tr_b16 v[30:31], v15 offset:34816
    s_waitcnt vmcnt(10) lgkmcnt(0)
    s_nop 0
    v_mfma_f32_16x16x32_bf16 v[100:103], v[16:19], v[48:51], v[100:103]
    ds_read_b64_tr_b16 v[32:33], v12 offset:36864
    ds_read_b64_tr_b16 v[34:35], v12 offset:38912
    v_mfma_f32_16x16x32_bf16 v[116:119], v[16:19], v[52:55], v[116:119]
    ds_read_b64_tr_b16 v[36:37], v13 offset:36864
    ds_read_b64_tr_b16 v[38:39], v13 offset:38912
    v_mfma_f32_16x16x32_bf16 v[104:107], v[20:23], v[48:51], v[104:107]
    ds_read_b64_tr_b16 v[40:41], v14 offset:36864
    ds_read_b64_tr_b16 v[42:43], v14 offset:38912
    v_mfma_f32_16x16x32_bf16 v[120:123], v[20:23], v[52:55], v[120:123]
    ds_read_b64_tr_b16 v[44:45], v15 offset:36864
    ds_read_b64_tr_b16 v[46:47], v15 offset:38912
    v_mfma_f32_16x16x32_bf16 v[108:111], v[24:27], v[48:51], v[108:111]
    buffer_load_dwordx4 v[132:135], v98, s[16:19], s7 offen offset:0 sc1
    v_mfma_f32_16x16x32_bf16 v[124:127], v[24:27], v[52:55], v[124:127]
    v_mfma_f32_16x16x32_bf16 v[112:115], v[28:31], v[48:51], v[112:115]
    buffer_load_dwordx4 v[136:139], v97, s[16:19], s7 offen offset:0 sc1
    v_mfma_f32_16x16x32_bf16 v[128:131], v[28:31], v[52:55], v[128:131]
    s_waitcnt vmcnt(10) lgkmcnt(0)
    s_nop 0
    v_mfma_f32_16x16x32_bf16 v[100:103], v[32:35], v[56:59], v[100:103]
    ds_read_b64_tr_b16 v[16:17], v4 offset:0
    ds_read_b64_tr_b16 v[18:19], v4 offset:2048
    v_mfma_f32_16x16x32_bf16 v[116:119], v[32:35], v[60:63], v[116:119]
    ds_read_b64_tr_b16 v[20:21], v5 offset:0
    ds_read_b64_tr_b16 v[22:23], v5 offset:2048
    v_mfma_f32_16x16x32_bf16 v[104:107], v[36:39], v[56:59], v[104:107]
    ds_read_b64_tr_b16 v[24:25], v6 offset:0
    ds_read_b64_tr_b16 v[26:27], v6 offset:2048
    v_mfma_f32_16x16x32_bf16 v[120:123], v[36:39], v[60:63], v[120:123]
    ds_read_b64_tr_b16 v[28:29], v7 offset:0
    ds_read_b64_tr_b16 v[30:31], v7 offset:2048
    v_mfma_f32_16x16x32_bf16 v[108:111], v[40:43], v[56:59], v[108:111]
    buffer_load_dwordx4 v[48:51], v98, s[16:19], s7 offen offset:1024 sc1
    v_mfma_f32_16x16x32_bf16 v[124:127], v[40:43], v[60:63], v[124:127]
    v_mfma_f32_16x16x32_bf16 v[112:115], v[44:47], v[56:59], v[112:115]
    buffer_load_dwordx4 v[52:55], v97, s[16:19], s7 offen offset:1024 sc1
    v_mfma_f32_16x16x32_bf16 v[128:131], v[44:47], v[60:63], v[128:131]
    s_waitcnt vmcnt(10) lgkmcnt(0)
    s_nop 0
    v_mfma_f32_16x16x32_bf16 v[100:103], v[16:19], v[64:67], v[100:103]
    ds_read_b64_tr_b16 v[32:33], v4 offset:4096
    ds_read_b64_tr_b16 v[34:35], v4 offset:6144
    v_mfma_f32_16x16x32_bf16 v[116:119], v[16:19], v[68:71], v[116:119]
    ds_read_b64_tr_b16 v[36:37], v5 offset:4096
    ds_read_b64_tr_b16 v[38:39], v5 offset:6144
    v_mfma_f32_16x16x32_bf16 v[104:107], v[20:23], v[64:67], v[104:107]
    ds_read_b64_tr_b16 v[40:41], v6 offset:4096
    ds_read_b64_tr_b16 v[42:43], v6 offset:6144
    v_mfma_f32_16x16x32_bf16 v[120:123], v[20:23], v[68:71], v[120:123]
    ds_read_b64_tr_b16 v[44:45], v7 offset:4096
    ds_read_b64_tr_b16 v[46:47], v7 offset:6144
    v_mfma_f32_16x16x32_bf16 v[108:111], v[24:27], v[64:67], v[108:111]
    buffer_load_dwordx4 v[56:59], v98, s[16:19], s8 offen offset:0 sc1
    v_mfma_f32_16x16x32_bf16 v[124:127], v[24:27], v[68:71], v[124:127]
    v_mfma_f32_16x16x32_bf16 v[112:115], v[28:31], v[64:67], v[112:115]
    buffer_load_dwordx4 v[60:63], v97, s[16:19], s8 offen offset:0 sc1
    v_mfma_f32_16x16x32_bf16 v[128:131], v[28:31], v[68:71], v[128:131]
    s_waitcnt vmcnt(10) lgkmcnt(0)
    s_nop 0
    v_mfma_f32_16x16x32_bf16 v[100:103], v[32:35], v[72:75], v[100:103]
    ds_read_b64_tr_b16 v[16:17], v4 offset:8192
    ds_read_b64_tr_b16 v[18:19], v4 offset:10240
    v_mfma_f32_16x16x32_bf16 v[116:119], v[32:35], v[76:79], v[116:119]
    ds_read_b64_tr_b16 v[20:21], v5 offset:8192
    ds_read_b64_tr_b16 v[22:23], v5 offset:10240
    v_mfma_f32_16x16x32_bf16 v[104:107], v[36:39], v[72:75], v[104:107]
    ds_read_b64_tr_b16 v[24:25], v6 offset:8192
    ds_read_b64_tr_b16 v[26:27], v6 offset:10240
    v_mfma_f32_16x16x32_bf16 v[120:123], v[36:39], v[76:79], v[120:123]
    ds_read_b64_tr_b16 v[28:29], v7 offset:8192
    ds_read_b64_tr_b16 v[30:31], v7 offset:10240
    v_mfma_f32_16x16x32_bf16 v[108:111], v[40:43], v[72:75], v[108:111]
    buffer_load_dwordx4 v[64:67], v98, s[16:19], s8 offen offset:1024 sc1
    v_mfma_f32_16x16x32_bf16 v[124:127], v[40:43], v[76:79], v[124:127]
    v_mfma_f32_16x16x32_bf16 v[112:115], v[44:47], v[72:75], v[112:115]
    buffer_load_dwordx4 v[68:71], v97, s[16:19], s8 offen offset:1024 sc1
    v_mfma_f32_16x16x32_bf16 v[128:131], v[44:47], v[76:79], v[128:131]
    s_waitcnt vmcnt(10) lgkmcnt(0)
    s_nop 0
    v_mfma_f32_16x16x32_bf16 v[100:103], v[16:19], v[80:83], v[100:103]
    ds_read_b64_tr_b16 v[32:33], v4 offset:12288
    ds_read_b64_tr_b16 v[34:35], v4 offset:14336
    v_mfma_f32_16x16x32_bf16 v[116:119], v[16:19], v[84:87], v[116:119]
    ds_read_b64_tr_b16 v[36:37], v5 offset:12288
    ds_read_b64_tr_b16 v[38:39], v5 offset:14336
    v_mfma_f32_16x16x32_bf16 v[104:107], v[20:23], v[80:83], v[104:107]
    ds_read_b64_tr_b16 v[40:41], v6 offset:12288
    ds_read_b64_tr_b16 v[42:43], v6 offset:14336
    v_mfma_f32_16x16x32_bf16 v[120:123], v[20:23], v[84:87], v[120:123]
    ds_read_b64_tr_b16 v[44:45], v7 offset:12288
    ds_read_b64_tr_b16 v[46:47], v7 offset:14336
    v_mfma_f32_16x16x32_bf16 v[108:111], v[24:27], v[80:83], v[108:111]
    buffer_load_dwordx4 v[72:75], v98, s[16:19], s9 offen offset:0 sc1
    v_mfma_f32_16x16x32_bf16 v[124:127], v[24:27], v[84:87], v[124:127]
    v_mfma_f32_16x16x32_bf16 v[112:115], v[28:31], v[80:83], v[112:115]
    buffer_load_dwordx4 v[76:79], v97, s[16:19], s9 offen offset:0 sc1
    v_mfma_f32_16x16x32_bf16 v[128:131], v[28:31], v[84:87], v[128:131]
    s_waitcnt vmcnt(10) lgkmcnt(0)
    s_nop 0
    v_mfma_f32_16x16x32_bf16 v[100:103], v[32:35], v[88:91], v[100:103]
    ds_read_b64_tr_b16 v[16:17], v12 offset:24576
    ds_read_b64_tr_b16 v[18:19], v12 offset:26624
    v_mfma_f32_16x16x32_bf16 v[116:119], v[32:35], v[92:95], v[116:119]
    ds_read_b64_tr_b16 v[20:21], v13 offset:24576
    ds_read_b64_tr_b16 v[22:23], v13 offset:26624
    v_mfma_f32_16x16x32_bf16 v[104:107], v[36:39], v[88:91], v[104:107]
    ds_read_b64_tr_b16 v[24:25], v14 offset:24576
    ds_read_b64_tr_b16 v[26:27], v14 offset:26624
    v_mfma_f32_16x16x32_bf16 v[120:123], v[36:39], v[92:95], v[120:123]
    ds_read_b64_tr_b16 v[28:29], v15 offset:24576
    ds_read_b64_tr_b16 v[30:31], v15 offset:26624
    v_mfma_f32_16x16x32_bf16 v[108:111], v[40:43], v[88:91], v[108:111]
    buffer_load_dwordx4 v[80:83], v98, s[16:19], s9 offen offset:1024 sc1
    v_mfma_f32_16x16x32_bf16 v[124:127], v[40:43], v[92:95], v[124:127]
    v_mfma_f32_16x16x32_bf16 v[112:115], v[44:47], v[88:91], v[112:115]
    buffer_load_dwordx4 v[84:87], v97, s[16:19], s9 offen offset:1024 sc1
    v_mfma_f32_16x16x32_bf16 v[128:131], v[44:47], v[92:95], v[128:131]
    s_waitcnt vmcnt(10) lgkmcnt(0)
    s_nop 0
    v_mfma_f32_16x16x32_bf16 v[100:103], v[16:19], v[132:135], v[100:103]
    ds_read_b64_tr_b16 v[32:33], v12 offset:28672
    ds_read_b64_tr_b16 v[34:35], v12 offset:30720
    v_mfma_f32_16x16x32_bf16 v[116:119], v[16:19], v[136:139], v[116:119]
    ds_read_b64_tr_b16 v[36:37], v13 offset:28672
    ds_read_b64_tr_b16 v[38:39], v13 offset:30720
    v_mfma_f32_16x16x32_bf16 v[104:107], v[20:23], v[132:135], v[104:107]
    ds_read_b64_tr_b16 v[40:41], v14 offset:28672
    ds_read_b64_tr_b16 v[42:43], v14 offset:30720
    v_mfma_f32_16x16x32_bf16 v[120:123], v[20:23], v[136:139], v[120:123]
    ds_read_b64_tr_b16 v[44:45], v15 offset:28672
    ds_read_b64_tr_b16 v[46:47], v15 offset:30720
    v_mfma_f32_16x16x32_bf16 v[108:111], v[24:27], v[132:135], v[108:111]
    buffer_load_dwordx4 v[88:91], v98, s[16:19], s10 offen offset:0 sc1
    v_mfma_f32_16x16x32_bf16 v[124:127], v[24:27], v[136:139], v[124:127]
    v_mfma_f32_16x16x32_bf16 v[112:115], v[28:31], v[132:135], v[112:115]
    buffer_load_dwordx4 v[92:95], v97, s[16:19], s10 offen offset:0 sc1
    v_mfma_f32_16x16x32_bf16 v[128:131], v[28:31], v[136:139], v[128:131]
    s_waitcnt vmcnt(10) lgkmcnt(0)
    s_nop 0
    v_mfma_f32_16x16x32_bf16 v[100:103], v[32:35], v[48:51], v[100:103]
    ds_read_b64_tr_b16 v[16:17], v4 offset:16384
    ds_read_b64_tr_b16 v[18:19], v4 offset:18432
    v_mfma_f32_16x16x32_bf16 v[116:119], v[32:35], v[52:55], v[116:119]
    ds_read_b64_tr_b16 v[20:21], v5 offset:16384
    ds_read_b64_tr_b16 v[22:23], v5 offset:18432
    v_mfma_f32_16x16x32_bf16 v[104:107], v[36:39], v[48:51], v[104:107]
    ds_read_b64_tr_b16 v[24:25], v6 offset:16384
    ds_read_b64_tr_b16 v[26:27], v6 offset:18432
    v_mfma_f32_16x16x32_bf16 v[120:123], v[36:39], v[52:55], v[120:123]
    ds_read_b64_tr_b16 v[28:29], v7 offset:16384
    ds_read_b64_tr_b16 v[30:31], v7 offset:18432
    v_mfma_f32_16x16x32_bf16 v[108:111], v[40:43], v[48:51], v[108:111]
    buffer_load_dwordx4 v[132:135], v98, s[16:19], s10 offen offset:1024 sc1
    v_mfma_f32_16x16x32_bf16 v[124:127], v[40:43], v[52:55], v[124:127]
    v_mfma_f32_16x16x32_bf16 v[112:115], v[44:47], v[48:51], v[112:115]
    buffer_load_dwordx4 v[136:139], v97, s[16:19], s10 offen offset:1024 sc1
    v_mfma_f32_16x16x32_bf16 v[128:131], v[44:47], v[52:55], v[128:131]
    s_waitcnt vmcnt(10) lgkmcnt(0)
    s_nop 0
    v_mfma_f32_16x16x32_bf16 v[100:103], v[16:19], v[56:59], v[100:103]
    ds_read_b64_tr_b16 v[32:33], v4 offset:20480
    ds_read_b64_tr_b16 v[34:35], v4 offset:22528
    v_mfma_f32_16x16x32_bf16 v[116:119], v[16:19], v[60:63], v[116:119]
    ds_read_b64_tr_b16 v[36:37], v5 offset:20480
    ds_read_b64_tr_b16 v[38:39], v5 offset:22528
    v_mfma_f32_16x16x32_bf16 v[104:107], v[20:23], v[56:59], v[104:107]
    ds_read_b64_tr_b16 v[40:41], v6 offset:20480
    ds_read_b64_tr_b16 v[42:43], v6 offset:22528
    v_mfma_f32_16x16x32_bf16 v[120:123], v[20:23], v[60:63], v[120:123]
    ds_read_b64_tr_b16 v[44:45], v7 offset:20480
    ds_read_b64_tr_b16 v[46:47], v7 offset:22528
    v_mfma_f32_16x16x32_bf16 v[108:111], v[24:27], v[56:59], v[108:111]
    buffer_load_dwordx4 v[48:51], v98, s[16:19], s11 offen offset:0 sc1
    v_mfma_f32_16x16x32_bf16 v[124:127], v[24:27], v[60:63], v[124:127]
    v_mfma_f32_16x16x32_bf16 v[112:115], v[28:31], v[56:59], v[112:115]
    buffer_load_dwordx4 v[52:55], v97, s[16:19], s11 offen offset:0 sc1
    v_mfma_f32_16x16x32_bf16 v[128:131], v[28:31], v[60:63], v[128:131]
    s_waitcnt vmcnt(10) lgkmcnt(0)
    s_nop 0
    v_mfma_f32_16x16x32_bf16 v[100:103], v[32:35], v[64:67], v[100:103]
    ds_read_b64_tr_b16 v[16:17], v4 offset:24576
    ds_read_b64_tr_b16 v[18:19], v4 offset:26624
    v_mfma_f32_16x16x32_bf16 v[116:119], v[32:35], v[68:71], v[116:119]
    ds_read_b64_tr_b16 v[20:21], v5 offset:24576
    ds_read_b64_tr_b16 v[22:23], v5 offset:26624
    v_mfma_f32_16x16x32_bf16 v[104:107], v[36:39], v[64:67], v[104:107]
    ds_read_b64_tr_b16 v[24:25], v6 offset:24576
    ds_read_b64_tr_b16 v[26:27], v6 offset:26624
    v_mfma_f32_16x16x32_bf16 v[120:123], v[36:39], v[68:71], v[120:123]
    ds_read_b64_tr_b16 v[28:29], v7 offset:24576
    ds_read_b64_tr_b16 v[30:31], v7 offset:26624
    v_mfma_f32_16x16x32_bf16 v[108:111], v[40:43], v[64:67], v[108:111]
    buffer_load_dwordx4 v[56:59], v98, s[16:19], s11 offen offset:1024 sc1
    v_mfma_f32_16x16x32_bf16 v[124:127], v[40:43], v[68:71], v[124:127]
    v_mfma_f32_16x16x32_bf16 v[112:115], v[44:47], v[64:67], v[112:115]
    buffer_load_dwordx4 v[60:63], v97, s[16:19], s11 offen offset:1024 sc1
    v_mfma_f32_16x16x32_bf16 v[128:131], v[44:47], v[68:71], v[128:131]
    s_waitcnt vmcnt(10) lgkmcnt(0)
    s_nop 0
    v_mfma_f32_16x16x32_bf16 v[100:103], v[16:19], v[72:75], v[100:103]
    ds_read_b64_tr_b16 v[32:33], v4 offset:28672
    ds_read_b64_tr_b16 v[34:35], v4 offset:30720
    v_mfma_f32_16x16x32_bf16 v[116:119], v[16:19], v[76:79], v[116:119]
    ds_read_b64_tr_b16 v[36:37], v5 offset:28672
    ds_read_b64_tr_b16 v[38:39], v5 offset:30720
    v_mfma_f32_16x16x32_bf16 v[104:107], v[20:23], v[72:75], v[104:107]
    ds_read_b64_tr_b16 v[40:41], v6 offset:28672
    ds_read_b64_tr_b16 v[42:43], v6 offset:30720
    v_mfma_f32_16x16x32_bf16 v[120:123], v[20:23], v[76:79], v[120:123]
    ds_read_b64_tr_b16 v[44:45], v7 offset:28672
    ds_read_b64_tr_b16 v[46:47], v7 offset:30720
    v_mfma_f32_16x16x32_bf16 v[108:111], v[24:27], v[72:75], v[108:111]
    buffer_load_dwordx4 v[64:67], v98, s[16:19], s30 offen offset:0 sc1
    v_mfma_f32_16x16x32_bf16 v[124:127], v[24:27], v[76:79], v[124:127]
    v_mfma_f32_16x16x32_bf16 v[112:115], v[28:31], v[72:75], v[112:115]
    buffer_load_dwordx4 v[68:71], v97, s[16:19], s30 offen offset:0 sc1
    v_mfma_f32_16x16x32_bf16 v[128:131], v[28:31], v[76:79], v[128:131]
    s_waitcnt vmcnt(10) lgkmcnt(0)
    s_nop 0
    v_mfma_f32_16x16x32_bf16 v[100:103], v[32:35], v[80:83], v[100:103]
    ds_read_b64_tr_b16 v[16:17], v12 offset:16384
    ds_read_b64_tr_b16 v[18:19], v12 offset:18432
    v_mfma_f32_16x16x32_bf16 v[116:119], v[32:35], v[84:87], v[116:119]
    ds_read_b64_tr_b16 v[20:21], v13 offset:16384
    ds_read_b64_tr_b16 v[22:23], v13 offset:18432
    v_mfma_f32_16x16x32_bf16 v[104:107], v[36:39], v[80:83], v[104:107]
    ds_read_b64_tr_b16 v[24:25], v14 offset:16384
    ds_read_b64_tr_b16 v[26:27], v14 offset:18432
    v_mfma_f32_16x16x32_bf16 v[120:123], v[36:39], v[84:87], v[120:123]
    ds_read_b64_tr_b16 v[28:29], v15 offset:16384
    ds_read_b64_tr_b16 v[30:31], v15 offset:18432
    v_mfma_f32_16x16x32_bf16 v[108:111], v[40:43], v[80:83], v[108:111]
    buffer_load_dwordx4 v[72:75], v98, s[16:19], s30 offen offset:1024 sc1
    v_mfma_f32_16x16x32_bf16 v[124:127], v[40:43], v[84:87], v[124:127]
    v_mfma_f32_16x16x32_bf16 v[112:115], v[44:47], v[80:83], v[112:115]
    buffer_load_dwordx4 v[76:79], v97, s[16:19], s30 offen offset:1024 sc1
    v_mfma_f32_16x16x32_bf16 v[128:131], v[44:47], v[84:87], v[128:131]
    s_waitcnt vmcnt(10) lgkmcnt(0)
    s_nop 0
    v_mfma_f32_16x16x32_bf16 v[100:103], v[16:19], v[88:91], v[100:103]
    ds_read_b64_tr_b16 v[32:33], v12 offset:20480
    ds_read_b64_tr_b16 v[34:35], v12 offset:22528
    v_mfma_f32_16x16x32_bf16 v[116:119], v[16:19], v[92:95], v[116:119]
    ds_read_b64_tr_b16 v[36:37], v13 offset:20480
    ds_read_b64_tr_b16 v[38:39], v13 offset:22528
    v_mfma_f32_16x16x32_bf16 v[104:107], v[20:23], v[88:91], v[104:107]
    ds_read_b64_tr_b16 v[40:41], v14 offset:20480
    ds_read_b64_tr_b16 v[42:43], v14 offset:22528
    v_mfma_f32_16x16x32_bf16 v[120:123], v[20:23], v[92:95], v[120:123]
    ds_read_b64_tr_b16 v[44:45], v15 offset:20480
    ds_read_b64_tr_b16 v[46:47], v15 offset:22528
    v_mfma_f32_16x16x32_bf16 v[108:111], v[24:27], v[88:91], v[108:111]
    buffer_load_dwordx4 v[80:83], v98, s[16:19], s31 offen offset:0 sc1
    v_mfma_f32_16x16x32_bf16 v[124:127], v[24:27], v[92:95], v[124:127]
    v_mfma_f32_16x16x32_bf16 v[112:115], v[28:31], v[88:91], v[112:115]
    buffer_load_dwordx4 v[84:87], v97, s[16:19], s31 offen offset:0 sc1
    v_mfma_f32_16x16x32_bf16 v[128:131], v[28:31], v[92:95], v[128:131]
    s_waitcnt vmcnt(10) lgkmcnt(0)
    s_nop 0
    v_mfma_f32_16x16x32_bf16 v[100:103], v[32:35], v[132:135], v[100:103]
    ds_read_b64_tr_b16 v[16:17], v8 offset:24576
    ds_read_b64_tr_b16 v[18:19], v8 offset:26624
    v_mfma_f32_16x16x32_bf16 v[116:119], v[32:35], v[136:139], v[116:119]
    ds_read_b64_tr_b16 v[20:21], v9 offset:24576
    ds_read_b64_tr_b16 v[22:23], v9 offset:26624
    v_mfma_f32_16x16x32_bf16 v[104:107], v[36:39], v[132:135], v[104:107]
    ds_read_b64_tr_b16 v[24:25], v10 offset:24576
    ds_read_b64_tr_b16 v[26:27], v10 offset:26624
    v_mfma_f32_16x16x32_bf16 v[120:123], v[36:39], v[136:139], v[120:123]
    ds_read_b64_tr_b16 v[28:29], v11 offset:24576
    ds_read_b64_tr_b16 v[30:31], v11 offset:26624
    v_mfma_f32_16x16x32_bf16 v[108:111], v[40:43], v[132:135], v[108:111]
    buffer_load_dwordx4 v[88:91], v98, s[16:19], s31 offen offset:1024 sc1
    v_mfma_f32_16x16x32_bf16 v[124:127], v[40:43], v[136:139], v[124:127]
    v_mfma_f32_16x16x32_bf16 v[112:115], v[44:47], v[132:135], v[112:115]
    buffer_load_dwordx4 v[92:95], v97, s[16:19], s31 offen offset:1024 sc1
    v_mfma_f32_16x16x32_bf16 v[128:131], v[44:47], v[136:139], v[128:131]
    s_waitcnt vmcnt(10) lgkmcnt(0)
    s_nop 0
    v_mfma_f32_16x16x32_bf16 v[100:103], v[16:19], v[48:51], v[100:103]
    ds_read_b64_tr_b16 v[32:33], v8 offset:28672
    ds_read_b64_tr_b16 v[34:35], v8 offset:30720
    v_mfma_f32_16x16x32_bf16 v[116:119], v[16:19], v[52:55], v[116:119]
    ds_read_b64_tr_b16 v[36:37], v9 offset:28672
    ds_read_b64_tr_b16 v[38:39], v9 offset:30720
    v_mfma_f32_16x16x32_bf16 v[104:107], v[20:23], v[48:51], v[104:107]
    ds_read_b64_tr_b16 v[40:41], v10 offset:28672
    ds_read_b64_tr_b16 v[42:43], v10 offset:30720
    v_mfma_f32_16x16x32_bf16 v[120:123], v[20:23], v[52:55], v[120:123]
    ds_read_b64_tr_b16 v[44:45], v11 offset:28672
    ds_read_b64_tr_b16 v[46:47], v11 offset:30720
    v_mfma_f32_16x16x32_bf16 v[108:111], v[24:27], v[48:51], v[108:111]
    buffer_load_dwordx4 v[132:135], v98, s[16:19], s32 offen offset:0 sc1
    v_mfma_f32_16x16x32_bf16 v[124:127], v[24:27], v[52:55], v[124:127]
    v_mfma_f32_16x16x32_bf16 v[112:115], v[28:31], v[48:51], v[112:115]
    buffer_load_dwordx4 v[136:139], v97, s[16:19], s32 offen offset:0 sc1
    v_mfma_f32_16x16x32_bf16 v[128:131], v[28:31], v[52:55], v[128:131]
    s_waitcnt vmcnt(10) lgkmcnt(0)
    s_nop 0
    v_mfma_f32_16x16x32_bf16 v[100:103], v[32:35], v[56:59], v[100:103]
    ds_read_b64_tr_b16 v[16:17], v4 offset:49152
    ds_read_b64_tr_b16 v[18:19], v4 offset:51200
    v_mfma_f32_16x16x32_bf16 v[116:119], v[32:35], v[60:63], v[116:119]
    ds_read_b64_tr_b16 v[20:21], v5 offset:49152
    ds_read_b64_tr_b16 v[22:23], v5 offset:51200
    v_mfma_f32_16x16x32_bf16 v[104:107], v[36:39], v[56:59], v[104:107]
    ds_read_b64_tr_b16 v[24:25], v6 offset:49152
    ds_read_b64_tr_b16 v[26:27], v6 offset:51200
    v_mfma_f32_16x16x32_bf16 v[120:123], v[36:39], v[60:63], v[120:123]
    ds_read_b64_tr_b16 v[28:29], v7 offset:49152
    ds_read_b64_tr_b16 v[30:31], v7 offset:51200
    v_mfma_f32_16x16x32_bf16 v[108:111], v[40:43], v[56:59], v[108:111]
    buffer_load_dwordx4 v[48:51], v98, s[16:19], s32 offen offset:1024 sc1
    v_mfma_f32_16x16x32_bf16 v[124:127], v[40:43], v[60:63], v[124:127]
    v_mfma_f32_16x16x32_bf16 v[112:115], v[44:47], v[56:59], v[112:115]
    s_branch IW_s7
IW_w7:
    s_branch IW_r7
IW_s7:
    buffer_load_dwordx4 v[52:55], v97, s[16:19], s32 offen offset:1024 sc1
    v_mfma_f32_16x16x32_bf16 v[128:131], v[44:47], v[60:63], v[128:131]
    s_waitcnt vmcnt(10) lgkmcnt(0)
    s_nop 0
    v_mfma_f32_16x16x32_bf16 v[100:103], v[16:19], v[64:67], v[100:103]
    ds_read_b64_tr_b16 v[32:33], v4 offset:53248
    ds_read_b64_tr_b16 v[34:35], v4 offset:55296
    v_mfma_f32_16x16x32_bf16 v[116:119], v[16:19], v[68:71], v[116:119]
    ds_read_b64_tr_b16 v[36:37], v5 offset:53248
    ds_read_b64_tr_b16 v[38:39], v5 offset:55296
    v_mfma_f32_16x16x32_bf16 v[104:107], v[20:23], v[64:67], v[104:107]
    ds_read_b64_tr_b16 v[40:41], v6 offset:53248
    ds_read_b64_tr_b16 v[42:43], v6 offset:55296
    v_mfma_f32_16x16x32_bf16 v[120:123], v[20:23], v[68:71], v[120:123]
    ds_read_b64_tr_b16 v[44:45], v7 offset:53248
    ds_read_b64_tr_b16 v[46:47], v7 offset:55296
    v_mfma_f32_16x16x32_bf16 v[108:111], v[24:27], v[64:67], v[108:111]
    buffer_load_dwordx4 v[56:59], v98, s[16:19], s33 offen offset:0 sc1
    v_mfma_f32_16x16x32_bf16 v[124:127], v[24:27], v[68:71], v[124:127]
    v_mfma_f32_16x16x32_bf16 v[112:115], v[28:31], v[64:67], v[112:115]
    buffer_load_dwordx4 v[60:63], v97, s[16:19], s33 offen offset:0 sc1
    v_mfma_f32_16x16x32_bf16 v[128:131], v[28:31], v[68:71], v[128:131]
    s_waitcnt vmcnt(10) lgkmcnt(0)
    s_nop 0
    v_mfma_f32_16x16x32_bf16 v[100:103], v[32:35], v[72:75], v[100:103]
    ds_read_b64_tr_b16 v[16:17], v8 offset:0
    ds_read_b64_tr_b16 v[18:19], v8 offset:2048
    v_mfma_f32_16x16x32_bf16 v[116:119], v[32:35], v[76:79], v[116:119]
    ds_read_b64_tr_b16 v[20:21], v9 offset:0
    ds_read_b64_tr_b16 v[22:23], v9 offset:2048
    v_mfma_f32_16x16x32_bf16 v[104:107], v[36:39], v[72:75], v[104:107]
    ds_read_b64_tr_b16 v[24:25], v10 offset:0
    ds_read_b64_tr_b16 v[26:27], v10 offset:2048
    v_mfma_f32_16x16x32_bf16 v[120:123], v[36:39], v[76:79], v[120:123]
    ds_read_b64_tr_b16 v[28:29], v11 offset:0
    ds_read_b64_tr_b16 v[30:31], v11 offset:2048
    v_mfma_f32_16x16x32_bf16 v[108:111], v[40:43], v[72:75], v[108:111]
    buffer_load_dwordx4 v[64:67], v98, s[16:19], s33 offen offset:1024 sc1
    v_mfma_f32_16x16x32_bf16 v[124:127], v[40:43], v[76:79], v[124:127]
    v_mfma_f32_16x16x32_bf16 v[112:115], v[44:47], v[72:75], v[112:115]
    buffer_load_dwordx4 v[68:71], v97, s[16:19], s33 offen offset:1024 sc1
    v_mfma_f32_16x16x32_bf16 v[128:131], v[44:47], v[76:79], v[128:131]
    s_waitcnt vmcnt(10) lgkmcnt(0)
    s_nop 0
    v_mfma_f32_16x16x32_bf16 v[100:103], v[16:19], v[80:83], v[100:103]
    ds_read_b64_tr_b16 v[32:33], v8 offset:4096
    ds_read_b64_tr_b16 v[34:35], v8 offset:6144
    v_mfma_f32_16x16x32_bf16 v[116:119], v[16:19], v[84:87], v[116:119]
    ds_read_b64_tr_b16 v[36:37], v9 offset:4096
    ds_read_b64_tr_b16 v[38:39], v9 offset:6144
    v_mfma_f32_16x16x32_bf16 v[104:107], v[20:23], v[80:83], v[104:107]
    ds_read_b64_tr_b16 v[40:41], v10 offset:4096
    ds_read_b64_tr_b16 v[42:43], v10 offset:6144
    v_mfma_f32_16x16x32_bf16 v[120:123], v[20:23], v[84:87], v[120:123]
    ds_read_b64_tr_b16 v[44:45], v11 offset:4096
    ds_read_b64_tr_b16 v[46:47], v11 offset:6144
    v_mfma_f32_16x16x32_bf16 v[108:111], v[24:27], v[80:83], v[108:111]
    buffer_load_dwordx4 v[72:75], v98, s[16:19], s34 offen offset:0 sc1
    v_mfma_f32_16x16x32_bf16 v[124:127], v[24:27], v[84:87], v[124:127]
    v_mfma_f32_16x16x32_bf16 v[112:115], v[28:31], v[80:83], v[112:115]
    buffer_load_dwordx4 v[76:79], v97, s[16:19], s34 offen offset:0 sc1
    v_mfma_f32_16x16x32_bf16 v[128:131], v[28:31], v[84:87], v[128:131]
    s_waitcnt vmcnt(10) lgkmcnt(0)
    s_nop 0
    v_mfma_f32_16x16x32_bf16 v[100:103], v[32:35], v[88:91], v[100:103]
    ds_read_b64_tr_b16 v[16:17], v8 offset:16384
    ds_read_b64_tr_b16 v[18:19], v8 offset:18432
    v_mfma_f32_16x16x32_bf16 v[116:119], v[32:35], v[92:95], v[116:119]
    ds_read_b64_tr_b16 v[20:21], v9 offset:16384
    ds_read_b64_tr_b16 v[22:23], v9 offset:18432
    v_mfma_f32_16x16x32_bf16 v[104:107], v[36:39], v[88:91], v[104:107]
    ds_read_b64_tr_b16 v[24:25], v10 offset:16384
    ds_read_b64_tr_b16 v[26:27], v10 offset:18432
    v_mfma_f32_16x16x32_bf16 v[120:123], v[36:39], v[92:95], v[120:123]
    ds_read_b64_tr_b16 v[28:29], v11 offset:16384
    ds_read_b64_tr_b16 v[30:31], v11 offset:18432
    v_mfma_f32_16x16x32_bf16 v[108:111], v[40:43], v[88:91], v[108:111]
    buffer_load_dwordx4 v[80:83], v98, s[16:19], s34 offen offset:1024 sc1
    v_mfma_f32_16x16x32_bf16 v[124:127], v[40:43], v[92:95], v[124:127]
    v_mfma_f32_16x16x32_bf16 v[112:115], v[44:47], v[88:91], v[112:115]
    buffer_load_dwordx4 v[84:87], v97, s[16:19], s34 offen offset:1024 sc1
    v_mfma_f32_16x16x32_bf16 v[128:131], v[44:47], v[92:95], v[128:131]
    s_waitcnt vmcnt(10) lgkmcnt(0)
    s_nop 0
    v_mfma_f32_16x16x32_bf16 v[100:103], v[16:19], v[132:135], v[100:103]
    ds_read_b64_tr_b16 v[32:33], v8 offset:20480
    ds_read_b64_tr_b16 v[34:35], v8 offset:22528
    v_mfma_f32_16x16x32_bf16 v[116:119], v[16:19], v[136:139], v[116:119]
    ds_read_b64_tr_b16 v[36:37], v9 offset:20480
    ds_read_b64_tr_b16 v[38:39], v9 offset:22528
    v_mfma_f32_16x16x32_bf16 v[104:107], v[20:23], v[132:135], v[104:107]
    ds_read_b64_tr_b16 v[40:41], v10 offset:20480
    ds_read_b64_tr_b16 v[42:43], v10 offset:22528
    v_mfma_f32_16x16x32_bf16 v[120:123], v[20:23], v[136:139], v[120:123]
    ds_read_b64_tr_b16 v[44:45], v11 offset:20480
    ds_read_b64_tr_b16 v[46:47], v11 offset:22528
    v_mfma_f32_16x16x32_bf16 v[108:111], v[24:27], v[132:135], v[108:111]
    buffer_load_dwordx4 v[88:91], v98, s[16:19], s35 offen offset:0 sc1
    v_mfma_f32_16x16x32_bf16 v[124:127], v[24:27], v[136:139], v[124:127]
    v_mfma_f32_16x16x32_bf16 v[112:115], v[28:31], v[132:135], v[112:115]
    buffer_load_dwordx4 v[92:95], v97, s[16:19], s35 offen offset:0 sc1
    v_mfma_f32_16x16x32_bf16 v[128:131], v[28:31], v[136:139], v[128:131]
    s_waitcnt vmcnt(10) lgkmcnt(0)
    s_nop 0
    v_mfma_f32_16x16x32_bf16 v[100:103], v[32:35], v[48:51], v[100:103]
    ds_read_b64_tr_b16 v[16:17], v8 offset:40960
    ds_read_b64_tr_b16 v[18:19], v8 offset:43008
    v_mfma_f32_16x16x32_bf16 v[116:119], v[32:35], v[52:55], v[116:119]
    ds_read_b64_tr_b16 v[20:21], v9 offset:40960
    ds_read_b64_tr_b16 v[22:23], v9 offset:43008
    v_mfma_f32_16x16x32_bf16 v[104:107], v[36:39], v[48:51], v[104:107]
    ds_read_b64_tr_b16 v[24:25], v10 offset:40960
    ds_read_b64_tr_b16 v[26:27], v10 offset:43008
    v_mfma_f32_16x16x32_bf16 v[120:123], v[36:39], v[52:55], v[120:123]
    ds_read_b64_tr_b16 v[28:29], v11 offset:40960
    ds_read_b64_tr_b16 v[30:31], v11 offset:43008
    v_mfma_f32_16x16x32_bf16 v[108:111], v[40:43], v[48:51], v[108:111]
    buffer_load_dwordx4 v[132:135], v98, s[16:19], s35 offen offset:1024 sc1
    v_mfma_f32_16x16x32_bf16 v[124:127], v[40:43], v[52:55], v[124:127]
    v_mfma_f32_16x16x32_bf16 v[112:115], v[44:47], v[48:51], v[112:115]
    buffer_load_dwordx4 v[136:139], v97, s[16:19], s35 offen offset:1024 sc1
    v_mfma_f32_16x16x32_bf16 v[128:131], v[44:47], v[52:55], v[128:131]
    s_waitcnt vmcnt(10) lgkmcnt(0)
    s_nop 0
    v_mfma_f32_16x16x32_bf16 v[100:103], v[16:19], v[56:59], v[100:103]
    ds_read_b64_tr_b16 v[32:33], v8 offset:45056
    ds_read_b64_tr_b16 v[34:35], v8 offset:47104
    v_mfma_f32_16x16x32_bf16 v[116:119], v[16:19], v[60:63], v[116:119]
    ds_read_b64_tr_b16 v[36:37], v9 offset:45056
    ds_read_b64_tr_b16 v[38:39], v9 offset:47104
    v_mfma_f32_16x16x32_bf16 v[104:107], v[20:23], v[56:59], v[104:107]
    ds_read_b64_tr_b16 v[40:41], v10 offset:45056
    ds_read_b64_tr_b16 v[42:43], v10 offset:47104
    v_mfma_f32_16x16x32_bf16 v[120:123], v[20:23], v[60:63], v[120:123]
    ds_read_b64_tr_b16 v[44:45], v11 offset:45056
    ds_read_b64_tr_b16 v[46:47], v11 offset:47104
    v_mfma_f32_16x16x32_bf16 v[108:111], v[24:27], v[56:59], v[108:111]
    buffer_load_dwordx4 v[48:51], v98, s[16:19], s36 offen offset:0 sc1
    v_mfma_f32_16x16x32_bf16 v[124:127], v[24:27], v[60:63], v[124:127]
    v_mfma_f32_16x16x32_bf16 v[112:115], v[28:31], v[56:59], v[112:115]
    buffer_load_dwordx4 v[52:55], v97, s[16:19], s36 offen offset:0 sc1
    v_mfma_f32_16x16x32_bf16 v[128:131], v[28:31], v[60:63], v[128:131]
    s_waitcnt vmcnt(10) lgkmcnt(0)
    s_nop 0
    v_mfma_f32_16x16x32_bf16 v[100:103], v[32:35], v[64:67], v[100:103]
    ds_read_b64_tr_b16 v[16:17], v8 offset:32768
    ds_read_b64_tr_b16 v[18:19], v8 offset:34816
    v_mfma_f32_16x16x32_bf16 v[116:119], v[32:35], v[68:71], v[116:119]
    ds_read_b64_tr_b16 v[20:21], v9 offset:32768
    ds_read_b64_tr_b16 v[22:23], v9 offset:34816
    v_mfma_f32_16x16x32_bf16 v[104:107], v[36:39], v[64:67], v[104:107]
    ds_read_b64_tr_b16 v[24:25], v10 offset:32768
    ds_read_b64_tr_b16 v[26:27], v10 offset:34816
    v_mfma_f32_16x16x32_bf16 v[120:123], v[36:39], v[68:71], v[120:123]
    ds_read_b64_tr_b16 v[28:29], v11 offset:32768
    ds_read_b64_tr_b16 v[30:31], v11 offset:34816
    v_mfma_f32_16x16x32_bf16 v[108:111], v[40:43], v[64:67], v[108:111]
    buffer_load_dwordx4 v[56:59], v98, s[16:19], s36 offen offset:1024 sc1
    v_mfma_f32_16x16x32_bf16 v[124:127], v[40:43], v[68:71], v[124:127]
    v_mfma_f32_16x16x32_bf16 v[112:115], v[44:47], v[64:67], v[112:115]
    buffer_load_dwordx4 v[60:63], v97, s[16:19], s36 offen offset:1024 sc1
    v_mfma_f32_16x16x32_bf16 v[128:131], v[44:47], v[68:71], v[128:131]
    s_waitcnt vmcnt(10) lgkmcnt(0)
    s_nop 0
    v_mfma_f32_16x16x32_bf16 v[100:103], v[16:19], v[72:75], v[100:103]
    ds_read_b64_tr_b16 v[32:33], v8 offset:36864
    ds_read_b64_tr_b16 v[34:35], v8 offset:38912
    v_mfma_f32_16x16x32_bf16 v[116:119], v[16:19], v[76:79], v[116:119]
    ds_read_b64_tr_b16 v[36:37], v9 offset:36864
    ds_read_b64_tr_b16 v[38:39], v9 offset:38912
    v_mfma_f32_16x16x32_bf16 v[104:107], v[20:23], v[72:75], v[104:107]
    ds_read_b64_tr_b16 v[40:41], v10 offset:36864
    ds_read_b64_tr_b16 v[42:43], v10 offset:38912
    v_mfma_f32_16x16x32_bf16 v[120:123], v[20:23], v[76:79], v[120:123]
    ds_read_b64_tr_b16 v[44:45], v11 offset:36864
    ds_read_b64_tr_b16 v[46:47], v11 offset:38912
    v_mfma_f32_16x16x32_bf16 v[108:111], v[24:27], v[72:75], v[108:111]
    buffer_load_dwordx4 v[64:67], v98, s[16:19], s37 offen offset:0 sc1
    v_mfma_f32_16x16x32_bf16 v[124:127], v[24:27], v[76:79], v[124:127]
    v_mfma_f32_16x16x32_bf16 v[112:115], v[28:31], v[72:75], v[112:115]
    buffer_load_dwordx4 v[68:71], v97, s[16:19], s37 offen offset:0 sc1
    v_mfma_f32_16x16x32_bf16 v[128:131], v[28:31], v[76:79], v[128:131]
    s_waitcnt vmcnt(10) lgkmcnt(0)
    s_nop 0
    v_mfma_f32_16x16x32_bf16 v[100:103], v[32:35], v[80:83], v[100:103]
    ds_read_b64_tr_b16 v[16:17], v12 offset:0
    ds_read_b64_tr_b16 v[18:19], v12 offset:2048
    v_mfma_f32_16x16x32_bf16 v[116:119], v[32:35], v[84:87], v[116:119]
    ds_read_b64_tr_b16 v[20:21], v13 offset:0
    ds_read_b64_tr_b16 v[22:23], v13 offset:2048
    v_mfma_f32_16x16x32_bf16 v[104:107], v[36:39], v[80:83], v[104:107]
    ds_read_b64_tr_b16 v[24:25], v14 offset:0
    ds_read_b64_tr_b16 v[26:27], v14 offset:2048
    v_mfma_f32_16x16x32_bf16 v[120:123], v[36:39], v[84:87], v[120:123]
    ds_read_b64_tr_b16 v[28:29], v15 offset:0
    ds_read_b64_tr_b16 v[30:31], v15 offset:2048
    v_mfma_f32_16x16x32_bf16 v[108:111], v[40:43], v[80:83], v[108:111]
    buffer_load_dwordx4 v[72:75], v98, s[16:19], s37 offen offset:1024 sc1
    v_mfma_f32_16x16x32_bf16 v[124:127], v[40:43], v[84:87], v[124:127]
    v_mfma_f32_16x16x32_bf16 v[112:115], v[44:47], v[80:83], v[112:115]
    buffer_load_dwordx4 v[76:79], v97, s[16:19], s37 offen offset:1024 sc1
    v_mfma_f32_16x16x32_bf16 v[128:131], v[44:47], v[84:87], v[128:131]
    s_waitcnt vmcnt(10) lgkmcnt(0)
    s_nop 0
    v_mfma_f32_16x16x32_bf16 v[100:103], v[16:19], v[88:91], v[100:103]
    ds_read_b64_tr_b16 v[32:33], v12 offset:4096
    ds_read_b64_tr_b16 v[34:35], v12 offset:6144
    v_mfma_f32_16x16x32_bf16 v[116:119], v[16:19], v[92:95], v[116:119]
    ds_read_b64_tr_b16 v[36:37], v13 offset:4096
    ds_read_b64_tr_b16 v[38:39], v13 offset:6144
    v_mfma_f32_16x16x32_bf16 v[104:107], v[20:23], v[88:91], v[104:107]
    ds_read_b64_tr_b16 v[40:41], v14 offset:4096
    ds_read_b64_tr_b16 v[42:43], v14 offset:6144
    v_mfma_f32_16x16x32_bf16 v[120:123], v[20:23], v[92:95], v[120:123]
    ds_read_b64_tr_b16 v[44:45], v15 offset:4096
    ds_read_b64_tr_b16 v[46:47], v15 offset:6144
    v_mfma_f32_16x16x32_bf16 v[108:111], v[24:27], v[88:91], v[108:111]
    v_mfma_f32_16x16x32_bf16 v[124:127], v[24:27], v[92:95], v[124:127]
    v_mfma_f32_16x16x32_bf16 v[112:115], v[28:31], v[88:91], v[112:115]
    v_mfma_f32_16x16x32_bf16 v[128:131], v[28:31], v[92:95], v[128:131]
    s_waitcnt vmcnt(8) lgkmcnt(0)
    s_nop 0
    v_mfma_f32_16x16x32_bf16 v[100:103], v[32:35], v[132:135], v[100:103]
    ds_read_b64_tr_b16 v[16:17], v8 offset:49152
    ds_read_b64_tr_b16 v[18:19], v8 offset:51200
    v_mfma_f32_16x16x32_bf16 v[116:119], v[32:35], v[136:139], v[116:119]
    ds_read_b64_tr_b16 v[20:21], v9 offset:49152
    ds_read_b64_tr_b16 v[22:23], v9 offset:51200
    v_mfma_f32_16x16x32_bf16 v[104:107], v[36:39], v[132:135], v[104:107]
    ds_read_b64_tr_b16 v[24:25], v10 offset:49152
    ds_read_b64_tr_b16 v[26:27], v10 offset:51200
    v_mfma_f32_16x16x32_bf16 v[120:123], v[36:39], v[136:139], v[120:123]
    ds_read_b64_tr_b16 v[28:29], v11 offset:49152
    ds_read_b64_tr_b16 v[30:31], v11 offset:51200
    v_mfma_f32_16x16x32_bf16 v[108:111], v[40:43], v[132:135], v[108:111]
    v_mfma_f32_16x16x32_bf16 v[124:127], v[40:43], v[136:139], v[124:127]
    v_mfma_f32_16x16x32_bf16 v[112:115], v[44:47], v[132:135], v[112:115]
    v_mfma_f32_16x16x32_bf16 v[128:131], v[44:47], v[136:139], v[128:131]
    s_waitcnt vmcnt(6) lgkmcnt(0)
    s_nop 0
    v_mfma_f32_16x16x32_bf16 v[100:103], v[16:19], v[48:51], v[100:103]
    ds_read_b64_tr_b16 v[32:33], v8 offset:53248
    ds_read_b64_tr_b16 v[34:35], v8 offset:55296
    v_mfma_f32_16x16x32_bf16 v[116:119], v[16:19], v[52:55], v[116:119]
    ds_read_b64_tr_b16 v[36:37], v9 offset:53248
    ds_read_b64_tr_b16 v[38:39], v9 offset:55296
    v_mfma_f32_16x16x32_bf16 v[104:107], v[20:23], v[48:51], v[104:107]
    ds_read_b64_tr_b16 v[40:41], v10 offset:53248
    ds_read_b64_tr_b16 v[42:43], v10 offset:55296
    v_mfma_f32_16x16x32_bf16 v[120:123], v[20:23], v[52:55], v[120:123]
    ds_read_b64_tr_b16 v[44:45], v11 offset:53248
    ds_read_b64_tr_b16 v[46:47], v11 offset:55296
    v_mfma_f32_16x16x32_bf16 v[108:111], v[24:27], v[48:51], v[108:111]
    v_mfma_f32_16x16x32_bf16 v[124:127], v[24:27], v[52:55], v[124:127]
    v_mfma_f32_16x16x32_bf16 v[112:115], v[28:31], v[48:51], v[112:115]
    v_mfma_f32_16x16x32_bf16 v[128:131], v[28:31], v[52:55], v[128:131]
    s_waitcnt vmcnt(4) lgkmcnt(0)
    s_nop 0
    v_mfma_f32_16x16x32_bf16 v[100:103], v[32:35], v[56:59], v[100:103]
    ds_read_b64_tr_b16 v[16:17], v12 offset:8192
    ds_read_b64_tr_b16 v[18:19], v12 offset:10240
    v_mfma_f32_16x16x32_bf16 v[116:119], v[32:35], v[60:63], v[116:119]
    ds_read_b64_tr_b16 v[20:21], v13 offset:8192
    ds_read_b64_tr_b16 v[22:23], v13 offset:10240
    v_mfma_f32_16x16x32_bf16 v[104:107], v[36:39], v[56:59], v[104:107]
    ds_read_b64_tr_b16 v[24:25], v14 offset:8192
    ds_read_b64_tr_b16 v[26:27], v14 offset:10240
    v_mfma_f32_16x16x32_bf16 v[120:123], v[36:39], v[60:63], v[120:123]
    ds_read_b64_tr_b16 v[28:29], v15 offset:8192
    ds_read_b64_tr_b16 v[30:31], v15 offset:10240
    v_mfma_f32_16x16x32_bf16 v[108:111], v[40:43], v[56:59], v[108:111]
    v_mfma_f32_16x16x32_bf16 v[124:127], v[40:43], v[60:63], v[124:127]
    v_mfma_f32_16x16x32_bf16 v[112:115], v[44:47], v[56:59], v[112:115]
    v_mfma_f32_16x16x32_bf16 v[128:131], v[44:47], v[60:63], v[128:131]
    s_waitcnt vmcnt(2) lgkmcnt(0)
    s_nop 0
    v_mfma_f32_16x16x32_bf16 v[100:103], v[16:19], v[64:67], v[100:103]
    ds_read_b64_tr_b16 v[32:33], v12 offset:12288
    ds_read_b64_tr_b16 v[34:35], v12 offset:14336
    v_mfma_f32_16x16x32_bf16 v[116:119], v[16:19], v[68:71], v[116:119]
    ds_read_b64_tr_b16 v[36:37], v13 offset:12288
    ds_read_b64_tr_b16 v[38:39], v13 offset:14336
    v_mfma_f32_16x16x32_bf16 v[104:107], v[20:23], v[64:67], v[104:107]
    ds_read_b64_tr_b16 v[40:41], v14 offset:12288
    ds_read_b64_tr_b16 v[42:43], v14 offset:14336
    v_mfma_f32_16x16x32_bf16 v[120:123], v[20:23], v[68:71], v[120:123]
    ds_read_b64_tr_b16 v[44:45], v15 offset:12288
    ds_read_b64_tr_b16 v[46:47], v15 offset:14336
    v_mfma_f32_16x16x32_bf16 v[108:111], v[24:27], v[64:67], v[108:111]
    v_mfma_f32_16x16x32_bf16 v[124:127], v[24:27], v[68:71], v[124:127]
    v_mfma_f32_16x16x32_bf16 v[112:115], v[28:31], v[64:67], v[112:115]
    v_mfma_f32_16x16x32_bf16 v[128:131], v[28:31], v[68:71], v[128:131]
    s_waitcnt vmcnt(0) lgkmcnt(0)
    s_nop 0
    v_mfma_f32_16x16x32_bf16 v[100:103], v[32:35], v[72:75], v[100:103]
    v_mfma_f32_16x16x32_bf16 v[116:119], v[32:35], v[76:79], v[116:119]
    v_mfma_f32_16x16x32_bf16 v[104:107], v[36:39], v[72:75], v[104:107]
    v_mfma_f32_16x16x32_bf16 v[120:123], v[36:39], v[76:79], v[120:123]
    v_mfma_f32_16x16x32_bf16 v[108:111], v[40:43], v[72:75], v[108:111]
    v_mfma_f32_16x16x32_bf16 v[124:127], v[40:43], v[76:79], v[124:127]
    v_mfma_f32_16x16x32_bf16 v[112:115], v[44:47], v[72:75], v[112:115]
    v_mfma_f32_16x16x32_bf16 v[128:131], v[44:47], v[76:79], v[128:131]
    s_nop 2
    v_permlane16_swap_b32 v100, v104
    v_permlane16_swap_b32 v101, v105
    v_permlane16_swap_b32 v102, v106
    v_permlane16_swap_b32 v103, v107
    v_permlane16_swap_b32 v108, v112
    v_permlane16_swap_b32 v109, v113
    v_permlane16_swap_b32 v110, v114
    v_permlane16_swap_b32 v111, v115
    v_permlane16_swap_b32 v116, v120
    v_permlane16_swap_b32 v117, v121
    v_permlane16_swap_b32 v118, v122
    v_permlane16_swap_b32 v119, v123
    v_permlane16_swap_b32 v124, v128
    v_permlane16_swap_b32 v125, v129
    v_permlane16_swap_b32 v126, v130
    v_permlane16_swap_b32 v127, v131
    s_cmp_eq_u64 s[60:61], 0
    s_cbranch_scc1 F_fin
    s_mov_b32 s48, 0xbfb8aa3b
    v_and_b32 v7, 0x3f, v2
    v_lshlrev_b32 v7, 1, v7
    v_add_u32 v7, 159744, v7
    v_mov_b32 v6, 159136

    ds_read_b32 v5, v6 offset:0
FW_77:
    s_waitcnt lgkmcnt(0)
    v_cmp_gt_u32 vcc, 1, v5
    s_cbranch_vccz FO_78
    ds_read_b32 v5, v6 offset:0
    s_branch FW_77
FO_78:
    v_bfe_u32 v4, v164, 11, 3
    v_lshl_add_u32 v4, v4, 8, v7
    v_cmp_ne_u32 vcc, 0, v164
    s_nop 0
    s_and_saveexec_b64 s[50:51], vcc
    s_cbranch_execz F_rb_79
    ds_read_b128 v[16:19], v4 offset:0
    ds_read_b128 v[20:23], v4 offset:16
    ds_read_b128 v[24:27], v4 offset:128
    ds_read_b128 v[28:31], v4 offset:144
    v_and_b32 v5, 0xffff0000, v164
    v_ashrrev_i32 v6, 31, v5
    v_not_b32 v6, v6
    v_or_b32 v6, 0x80000000, v6
    v_xor_b32 v5, v5, v6
    v_and_b32 v5, 0xffff0000, v5
    v_mul_f32 v5, s48, v5
    v_exp_f32 v5, v5
    s_nop 0
    v_add_f32 v5, 1.0, v5
    v_rcp_f32 v5, v5
    s_nop 0
    v_cvt_pk_bf16_f32 v5, v5, v5
    v_lshlrev_b32 v5, 16, v5
    s_waitcnt lgkmcnt(0)
    v_fmac_f32 v100, v16, v5
    v_fmac_f32 v101, v17, v5
    v_fmac_f32 v102, v18, v5
    v_fmac_f32 v103, v19, v5
    v_fmac_f32 v104, v20, v5
    v_fmac_f32 v105, v21, v5
    v_fmac_f32 v106, v22, v5
    v_fmac_f32 v107, v23, v5
    v_fmac_f32 v108, v24, v5
    v_fmac_f32 v109, v25, v5
    v_fmac_f32 v110, v26, v5
    v_fmac_f32 v111, v27, v5
    v_fmac_f32 v112, v28, v5
    v_fmac_f32 v113, v29, v5
    v_fmac_f32 v114, v30, v5
    v_fmac_f32 v115, v31, v5
F_rb_79:
    s_mov_b64 exec, s[50:51]
    v_bfe_u32 v4, v165, 11, 3
    v_lshl_add_u32 v4, v4, 8, v7
    v_cmp_ne_u32 vcc, 0, v165
    s_nop 0
    s_and_saveexec_b64 s[50:51], vcc
    s_cbranch_execz F_rb_80
    ds_read_b128 v[16:19], v4 offset:0
    ds_read_b128 v[20:23], v4 offset:16
    ds_read_b128 v[24:27], v4 offset:128
    ds_read_b128 v[28:31], v4 offset:144
    v_and_b32 v5, 0xffff0000, v165
    v_ashrrev_i32 v6, 31, v5
    v_not_b32 v6, v6
    v_or_b32 v6, 0x80000000, v6
    v_xor_b32 v5, v5, v6
    v_and_b32 v5, 0xffff0000, v5
    v_mul_f32 v5, s48, v5
    v_exp_f32 v5, v5
    s_nop 0
    v_add_f32 v5, 1.0, v5
    v_rcp_f32 v5, v5
    s_nop 0
    v_cvt_pk_bf16_f32 v5, v5, v5
    v_lshlrev_b32 v5, 16, v5
    s_waitcnt lgkmcnt(0)
    v_fmac_f32 v116, v16, v5
    v_fmac_f32 v117, v17, v5
    v_fmac_f32 v118, v18, v5
    v_fmac_f32 v119, v19, v5
    v_fmac_f32 v120, v20, v5
    v_fmac_f32 v121, v21, v5
    v_fmac_f32 v122, v22, v5
    v_fmac_f32 v123, v23, v5
    v_fmac_f32 v124, v24, v5
    v_fmac_f32 v125, v25, v5
    v_fmac_f32 v126, v26, v5
    v_fmac_f32 v127, v27, v5
    v_fmac_f32 v128, v28, v5
    v_fmac_f32 v129, v29, v5
    v_fmac_f32 v130, v30, v5
    v_fmac_f32 v131, v31, v5
F_rb_80:
    s_mov_b64 exec, s[50:51]
F_fin:
    s_nop 0
    v_cvt_pk_bf16_f32 v48, v100, v101
    v_cvt_pk_bf16_f32 v49, v102, v103
    v_cvt_pk_bf16_f32 v50, v104, v105
    v_cvt_pk_bf16_f32 v51, v106, v107
    v_cvt_pk_bf16_f32 v52, v108, v109
    v_cvt_pk_bf16_f32 v53, v110, v111
    v_cvt_pk_bf16_f32 v54, v112, v113
    v_cvt_pk_bf16_f32 v55, v114, v115
    v_mov_b32 v64, v48
    v_mov_b32 v65, v49
    v_mov_b32 v66, v50
    v_mov_b32 v67, v51
    v_mov_b32_dpp v48, v52 row_ror:8 row_mask:0xf bank_mask:0xc
    v_mov_b32_dpp v49, v53 row_ror:8 row_mask:0xf bank_mask:0xc
    v_mov_b32_dpp v50, v54 row_ror:8 row_mask:0xf bank_mask:0xc
    v_mov_b32_dpp v51, v55 row_ror:8 row_mask:0xf bank_mask:0xc
    v_mov_b32_dpp v52, v64 row_ror:8 row_mask:0xf bank_mask:0x3
    v_mov_b32_dpp v53, v65 row_ror:8 row_mask:0xf bank_mask:0x3
    v_mov_b32_dpp v54, v66 row_ror:8 row_mask:0xf bank_mask:0x3
    v_mov_b32_dpp v55, v67 row_ror:8 row_mask:0xf bank_mask:0x3
    s_add_u32 s44, s42, 0x4000
    buffer_store_dwordx4 v[48:51], v1, s[12:15], s42 offen sc1
    buffer_store_dwordx4 v[52:55], v1, s[12:15], s44 offen sc1
    v_cvt_pk_bf16_f32 v56, v116, v117
    v_cvt_pk_bf16_f32 v57, v118, v119
    v_cvt_pk_bf16_f32 v58, v120, v121
    v_cvt_pk_bf16_f32 v59, v122, v123
    v_cvt_pk_bf16_f32 v60, v124, v125
    v_cvt_pk_bf16_f32 v61, v126, v127
    v_cvt_pk_bf16_f32 v62, v128, v129
    v_cvt_pk_bf16_f32 v63, v130, v131
    v_mov_b32 v64, v56
    v_mov_b32 v65, v57
    v_mov_b32 v66, v58
    v_mov_b32 v67, v59
    v_mov_b32_dpp v56, v60 row_ror:8 row_mask:0xf bank_mask:0xc
    v_mov_b32_dpp v57, v61 row_ror:8 row_mask:0xf bank_mask:0xc
    v_mov_b32_dpp v58, v62 row_ror:8 row_mask:0xf bank_mask:0xc
    v_mov_b32_dpp v59, v63 row_ror:8 row_mask:0xf bank_mask:0xc
    v_mov_b32_dpp v60, v64 row_ror:8 row_mask:0xf bank_mask:0x3
    v_mov_b32_dpp v61, v65 row_ror:8 row_mask:0xf bank_mask:0x3
    v_mov_b32_dpp v62, v66 row_ror:8 row_mask:0xf bank_mask:0x3
    v_mov_b32_dpp v63, v67 row_ror:8 row_mask:0xf bank_mask:0x3
    s_add_u32 s44, s43, 0x4000
    buffer_store_dwordx4 v[56:59], v1, s[12:15], s43 offen sc1
    buffer_store_dwordx4 v[60:63], v1, s[12:15], s44 offen sc1
    s_endpgm
F_aux:
    s_setprio 3
    s_sub_u32 s3, s3, 8
    s_mov_b32 s88, s3
    v_lshrrev_b32 v5, 4, v0
    s_cmp_eq_u32 s3, 1
    s_mov_b32 s45, 73728
    s_cselect_b32 s45, 65536, s45
    s_cmp_eq_u32 s3, 2
    s_cselect_b32 s45, 147456, s45
    v_bfe_u32 v60, v0, 2, 2
    v_lshl_add_u32 v62, v5, 3, v60
    v_lshrrev_b32 v60, 1, v60
    v_and_b32 v63, 1, v5
    v_lshl_add_u32 v60, v63, 1, v60
    v_lshlrev_b32 v60, 5, v60
    v_lshl_add_u32 v60, v62, 7, v60
    v_and_b32 v63, 3, v0
    v_lshl_add_u32 v60, v63, 3, v60
    v_add_u32 v62, s45, v60
    v_xor_b32 v63, 32, v62
    v_xor_b32 v64, 64, v62
    v_xor_b32 v65, 96, v62
    v_lshlrev_b32 v2, 4, v0
    v_lshlrev_b32 v3, 2, v0
    v_and_b32 v7, 15, v0
    v_and_b32 v8, 7, v0
    v_lshlrev_b32 v8, 4, v8
    v_lshl_add_u32 v8, v5, 7, v8
    v_bfe_u32 v9, v0, 3, 1
    v_lshl_add_u32 v4, v9, 11, v8
    v_and_b32 v9, 1, v0
    v_lshlrev_b32 v59, 2, v7
    s_lshl_b32 s76, s32, 4
    s_add_u32 s76, s76, s33
    s_lshl_b32 s77, s76, 3
    s_lshl_b32 s44, s3, 1
    s_add_u32 s77, s77, s44
    v_mov_b32 v12, 0
    v_mov_b32 v13, 0
    v_mov_b32 v14, 0
    v_mov_b32 v15, 0
    s_lshl_b32 s75, s3, 4
    s_add_u32 s75, s75, s33
    s_lshl_b32 s44, s3, 2
    s_add_u32 s44, s44, 159040
    v_mov_b32 v10, s44

    v_mov_b32 v32, 0x3f803f80
    v_mov_b32 v33, 0x3f803f80
    v_mov_b32 v34, 0x3f803f80
    v_mov_b32 v35, 0x3f803f80
    v_mov_b32 v36, 0x3f803f80
    v_mov_b32 v37, 0x3f803f80
    v_mov_b32 v38, 0x3f803f80
    v_mov_b32 v39, 0x3f803f80
    v_mov_b32 v40, 0x3f803f80
    v_mov_b32 v41, 0x3f803f80
    v_mov_b32 v42, 0x3f803f80
    v_mov_b32 v43, 0x3f803f80
    v_mov_b32 v44, 0x3f803f80
    v_mov_b32 v45, 0x3f803f80
    v_mov_b32 v46, 0x3f803f80
    v_mov_b32 v47, 0x3f803f80
    s_waitcnt lgkmcnt(0)
    s_mov_b32 s20, s4
    s_mov_b32 s21, s5
    s_mov_b32 s22, 0x400000
    s_mov_b32 s23, 0x00020000
    s_mov_b32 s19, 0x20000
    s_add_u32 s40, s72, 0x850000
    s_addc_u32 s41, s73, 0
    s_mov_b32 s42, 0xd000
    s_mov_b32 s43, 0x00020000
    s_cmp_lg_u32 s3, 0
    s_cbranch_scc1 F_z0
    s_getpc_b64 s[46:47]
F_pc:
    s_sub_u32 s46, s46, F_pc-parallel_sum__linear_attn_block__moe_arch_mod__prompt_kernel
    s_subb_u32 s47, s47, 0
    s_and_b32 s44, s31, 7
    s_lshl_b32 s44, s44, 13
    v_lshlrev_b32 v67, 7, v0
    v_add_u32 v67, s44, v67
    v_min_u32 v67, F_codeend-parallel_sum__linear_attn_block__moe_arch_mod__prompt_kernel-4, v67
    global_load_dword v61, v67, s[46:47]
    s_cmp_lg_u32 s75, 0
    s_cbranch_scc1 F_z0
    s_lshl_b32 s44, s32, 9
    s_add_u32 s44, s44, 32768
    s_mov_b32 exec_hi, 0
    buffer_store_dwordx4 v[12:15], v2, s[40:43], s44 offen sc0 sc1
    s_mul_i32 s44, s32, 768
    s_add_u32 s44, s44, 40960
    s_mov_b32 exec_hi, 0xffff
    buffer_store_dwordx4 v[12:15], v2, s[40:43], s44 offen sc0 sc1
    s_mov_b64 exec, -1
F_z0:

    s_barrier
    s_bitcmp0_b32 s3, 0
    s_cbranch_scc1 F_cs1
    ds_read_b64_tr_b16 v[72:73], v62 offset:0
    ds_read_b64_tr_b16 v[74:75], v62 offset:512
    ds_read_b64_tr_b16 v[76:77], v62 offset:4096
    ds_read_b64_tr_b16 v[78:79], v62 offset:4608
    ds_read_b64_tr_b16 v[80:81], v63 offset:0
    ds_read_b64_tr_b16 v[82:83], v63 offset:512
    ds_read_b64_tr_b16 v[84:85], v63 offset:4096
    ds_read_b64_tr_b16 v[86:87], v63 offset:4608
    s_waitcnt lgkmcnt(4)
    s_nop 0
    ds_read_b64_tr_b16 v[88:89], v64 offset:0
    ds_read_b64_tr_b16 v[90:91], v64 offset:512
    ds_read_b64_tr_b16 v[92:93], v64 offset:4096
    ds_read_b64_tr_b16 v[94:95], v64 offset:4608
    ds_read_b64_tr_b16 v[96:97], v65 offset:0
    ds_read_b64_tr_b16 v[98:99], v65 offset:512
    ds_read_b64_tr_b16 v[100:101], v65 offset:4096
    ds_read_b64_tr_b16 v[102:103], v65 offset:4608
    s_branch F_cs2
F_cs1:
    v_add_u32 v60, 159040, v3
    s_mov_b32 exec_hi, 0xffff
    ds_write_b32 v60, v12
    s_mov_b64 exec, -1
F_cs2:
    s_add_u32 s24, s72, 0x800000
    s_addc_u32 s25, s73, 0
    s_mov_b32 s26, 0x48000
    s_mov_b32 s27, 0x00020000
    s_mov_b32 s48, s70
    s_mov_b32 s49, s71
    s_mov_b32 s50, 0x100
    s_mov_b32 s51, 0x00020000
    s_lshl_b32 s47, s32, 9
    s_add_u32 s56, s47, 0x858000
    s_add_u32 s56, s72, s56
    s_addc_u32 s57, s73, 0
    s_lshl_b32 s47, s33, 9
    s_add_u32 s58, s47, 0x858100
    s_add_u32 s58, s72, s58
    s_addc_u32 s59, s73, 0
    v_mov_b32 v68, 0x3f803f80
    v_mov_b32 v69, 0x3f803f80
    v_mov_b32 v70, 0x3f803f80
    v_mov_b32 v71, 0x3f803f80
    s_waitcnt lgkmcnt(0)
    s_cmp_lg_u32 s75, 0
    s_cbranch_scc1 F_z4
    s_lshl_b32 s45, s32, 2
    s_add_u32 s44, s70, s45
    s_addc_u32 s45, s71, 0
    s_mov_b32 s46, 1
    s_waitcnt vmcnt(0)
    s_atomic_add s46, s[44:45], 0
F_z4:

    s_branch IW_s8
IW_w8:
    s_branch IW_r8
IW_s8:
    s_bitcmp0_b32 s3, 0
    s_cbranch_scc1 F_c2a
    s_nop 0
    v_mfma_f32_16x16x32_bf16 v[104:107], v[68:71], v[72:75], 0
    v_mfma_f32_16x16x32_bf16 v[108:111], v[68:71], v[80:83], 0
    v_mfma_f32_16x16x32_bf16 v[112:115], v[68:71], v[88:91], 0
    v_mfma_f32_16x16x32_bf16 v[116:119], v[68:71], v[96:99], 0
    v_mfma_f32_16x16x32_bf16 v[104:107], v[68:71], v[76:79], v[104:107]
    v_mfma_f32_16x16x32_bf16 v[108:111], v[68:71], v[84:87], v[108:111]
    v_mfma_f32_16x16x32_bf16 v[112:115], v[68:71], v[92:95], v[112:115]
    v_mfma_f32_16x16x32_bf16 v[116:119], v[68:71], v[100:103], v[116:119]
    v_cmp_eq_u32 vcc, 1, v5
    s_nop 4
    v_cndmask_b32 v66, v104, v108, vcc
    v_cmp_eq_u32 vcc, 2, v5
    s_nop 1
    v_cndmask_b32 v66, v66, v112, vcc
    v_cmp_eq_u32 vcc, 3, v5
    s_nop 1
    v_cndmask_b32 v66, v66, v116, vcc

F_c2a:
    s_barrier
    s_cmp_lg_u32 s3, 2
    s_cbranch_scc1 F_cs3
    ds_read_b64_tr_b16 v[72:73], v62 offset:0
    ds_read_b64_tr_b16 v[74:75], v62 offset:512
    ds_read_b64_tr_b16 v[76:77], v62 offset:4096
    ds_read_b64_tr_b16 v[78:79], v62 offset:4608
    ds_read_b64_tr_b16 v[80:81], v63 offset:0
    ds_read_b64_tr_b16 v[82:83], v63 offset:512
    ds_read_b64_tr_b16 v[84:85], v63 offset:4096
    ds_read_b64_tr_b16 v[86:87], v63 offset:4608
    s_waitcnt lgkmcnt(4)
    s_nop 0
    ds_read_b64_tr_b16 v[88:89], v64 offset:0
    ds_read_b64_tr_b16 v[90:91], v64 offset:512
    ds_read_b64_tr_b16 v[92:93], v64 offset:4096
    ds_read_b64_tr_b16 v[94:95], v64 offset:4608
    ds_read_b64_tr_b16 v[96:97], v65 offset:0
    ds_read_b64_tr_b16 v[98:99], v65 offset:512
    ds_read_b64_tr_b16 v[100:101], v65 offset:4096
    ds_read_b64_tr_b16 v[102:103], v65 offset:4608
    s_waitcnt lgkmcnt(0)
F_cs3:
    s_cmp_lt_u32 s3, 2
    s_mov_b32 s44, 81920
    s_cselect_b32 s44, 81920, s44
    s_lshl_b32 s45, s3, 12
    s_add_u32 s44, s44, s45
    v_add_u32_e64 v4, s44, v4
    v_add_u32 v8, 161792, v8
    ds_read_b128 v[16:19], v4 offset:0
    ds_read_b128 v[20:23], v4 offset:512
    ds_read_b128 v[24:27], v4 offset:1024
    ds_read_b128 v[28:31], v4 offset:1536
    s_mov_b32 exec_lo, 0x00ff00ff
    s_mov_b32 exec_hi, 0x00ff00ff
    ds_read_b128 v[32:35], v8 offset:0
    ds_read_b128 v[36:39], v8 offset:512
    ds_read_b128 v[40:43], v8 offset:1024
    ds_read_b128 v[44:47], v8 offset:1536
    s_mov_b64 exec, -1
    s_waitcnt lgkmcnt(0)
    v_mfma_f32_16x16x32_bf16 v[120:123], v[16:19], v[16:19], 0
    v_mfma_f32_16x16x32_bf16 v[124:127], v[16:19], v[32:35], 0
    v_mfma_f32_16x16x32_bf16 v[128:131], v[32:35], v[32:35], 0
    v_mfma_f32_16x16x32_bf16 v[120:123], v[20:23], v[20:23], v[120:123]
    v_mfma_f32_16x16x32_bf16 v[124:127], v[20:23], v[36:39], v[124:127]
    v_mfma_f32_16x16x32_bf16 v[128:131], v[36:39], v[36:39], v[128:131]
    v_mfma_f32_16x16x32_bf16 v[120:123], v[24:27], v[24:27], v[120:123]
    v_mfma_f32_16x16x32_bf16 v[124:127], v[24:27], v[40:43], v[124:127]
    v_mfma_f32_16x16x32_bf16 v[128:131], v[40:43], v[40:43], v[128:131]
    v_mfma_f32_16x16x32_bf16 v[120:123], v[28:31], v[28:31], v[120:123]
    v_mfma_f32_16x16x32_bf16 v[124:127], v[28:31], v[44:47], v[124:127]
    v_mfma_f32_16x16x32_bf16 v[128:131], v[44:47], v[44:47], v[128:131]
    s_cmp_lg_u32 s3, 0
    s_cbranch_scc1 EV_82
    s_branch IW_w8
IW_r8:
EV_82:
    s_cmp_lg_u32 s3, 1
    s_cbranch_scc1 EV_83
    s_branch IW_w0
IW_r0:
EV_83:
    s_cmp_lg_u32 s3, 2
    s_cbranch_scc1 EV_84
    s_branch IW_w1
IW_r1:
EV_84:
    s_cmp_lg_u32 s3, 3
    s_cbranch_scc1 EV_85
    s_branch IW_w3
IW_r3:
EV_85:
    s_barrier
    s_cmp_lg_u32 s3, 2
    s_cbranch_scc1 F_c2b
    s_nop 0
    v_mfma_f32_16x16x32_bf16 v[104:107], v[68:71], v[72:75], 0
    v_mfma_f32_16x16x32_bf16 v[108:111], v[68:71], v[80:83], 0
    v_mfma_f32_16x16x32_bf16 v[112:115], v[68:71], v[88:91], 0
    v_mfma_f32_16x16x32_bf16 v[116:119], v[68:71], v[96:99], 0
    v_mfma_f32_16x16x32_bf16 v[104:107], v[68:71], v[76:79], v[104:107]
    v_mfma_f32_16x16x32_bf16 v[108:111], v[68:71], v[84:87], v[108:111]
    v_mfma_f32_16x16x32_bf16 v[112:115], v[68:71], v[92:95], v[112:115]
    v_mfma_f32_16x16x32_bf16 v[116:119], v[68:71], v[100:103], v[116:119]
    v_cmp_eq_u32 vcc, 1, v5
    s_nop 4
    v_cndmask_b32 v66, v104, v108, vcc
    v_cmp_eq_u32 vcc, 2, v5
    s_nop 1
    v_cndmask_b32 v66, v66, v112, vcc
    v_cmp_eq_u32 vcc, 3, v5
    s_nop 1
    v_cndmask_b32 v66, v66, v116, vcc

F_c2b:
    v_and_b32 v52, 3, v0
    v_cmp_eq_u32 vcc, 1, v52
    s_nop 1
    v_cndmask_b32 v120, v120, v121, vcc
    v_cndmask_b32 v124, v124, v125, vcc
    v_cndmask_b32 v128, v128, v129, vcc
    v_cmp_eq_u32 vcc, 2, v52
    s_nop 1
    v_cndmask_b32 v120, v120, v122, vcc
    v_cndmask_b32 v124, v124, v126, vcc
    v_cndmask_b32 v128, v128, v130, vcc
    v_cmp_eq_u32 vcc, 3, v52
    s_nop 1
    v_cndmask_b32 v120, v120, v123, vcc
    v_cndmask_b32 v124, v124, v127, vcc
    v_cndmask_b32 v128, v128, v131, vcc
    s_nop 0
    v_add_f32_dpp v120, v120, v120 quad_perm:[1,0,3,2] row_mask:0xf bank_mask:0xf
    v_add_f32_dpp v124, v124, v124 quad_perm:[1,0,3,2] row_mask:0xf bank_mask:0xf
    v_add_f32_dpp v128, v128, v128 quad_perm:[1,0,3,2] row_mask:0xf bank_mask:0xf
    v_add_f32_dpp v120, v120, v120 quad_perm:[2,3,0,1] row_mask:0xf bank_mask:0xf
    v_add_f32_dpp v124, v124, v124 quad_perm:[2,3,0,1] row_mask:0xf bank_mask:0xf
    v_add_f32_dpp v128, v128, v128 quad_perm:[2,3,0,1] row_mask:0xf bank_mask:0xf
    v_readlane_b32 s44, v124, 8
    v_readlane_b32 s45, v124, 24
    v_readlane_b32 s46, v124, 40
    v_readlane_b32 s47, v124, 56
    v_mov_b32 v48, s44
    v_mov_b32 v52, s45
    s_nop 0
    v_writelane_b32 v48, s46, 1
    v_writelane_b32 v52, s47, 1
    v_readlane_b32 s44, v120, 0
    v_readlane_b32 s45, v120, 20
    v_readlane_b32 s46, v120, 40
    v_readlane_b32 s47, v120, 60
    v_mov_b32 v49, s44
    v_mov_b32 v53, s45
    s_nop 0
    v_writelane_b32 v49, s46, 1
    v_writelane_b32 v53, s47, 1
    v_readlane_b32 s44, v124, 0
    v_readlane_b32 s45, v124, 20
    v_readlane_b32 s46, v124, 32
    v_readlane_b32 s47, v124, 52
    v_mov_b32 v50, s44
    v_mov_b32 v54, s45
    s_nop 0
    v_writelane_b32 v50, s46, 1
    v_writelane_b32 v54, s47, 1
    v_readlane_b32 s44, v128, 8
    v_readlane_b32 s45, v128, 24
    v_readlane_b32 s46, v128, 8
    v_readlane_b32 s47, v128, 24
    v_mov_b32 v51, s44
    v_mov_b32 v55, s45
    s_nop 0
    v_writelane_b32 v51, s46, 1
    v_writelane_b32 v55, s47, 1
    s_cmp_lg_u32 s3, 0
    s_cbranch_scc1 F_r1
    buffer_load_dword v11, v59, s[48:51], 0 offen sc0 sc1
F_r1:
    s_cmp_lg_u32 s3, 0
    s_cbranch_scc1 EV_87
    s_branch IW_w4
IW_r4:
EV_87:
    s_cmp_lg_u32 s3, 1
    s_cbranch_scc1 EV_88
    s_branch IW_w9
IW_r9:
EV_88:
    s_cmp_lg_u32 s3, 2
    s_cbranch_scc1 EV_89
    s_branch IW_w10
IW_r10:
EV_89:
    s_cmp_lg_u32 s3, 3
    s_cbranch_scc1 EV_90
    s_nop 0
EV_90:
    s_barrier
    v_add_f32 v48, v48, v52
    v_add_f32 v49, v49, v53
    v_add_f32 v50, v50, v54
    v_add_f32 v51, v51, v55
    v_mul_f32 v48, 0x3a800000, v48
    v_mul_f32 v49, 0x3a800000, v49
    v_fma_f32 v49, -v48, v48, v49
    v_max_f32 v49, 0, v49
    v_cvt_pk_bf16_f32 v52, v48, v49
    v_lshlrev_b32 v48, 16, v52
    v_and_b32 v49, 0xffff0000, v52
    v_add_f32 v49, 0x3727c5ac, v49
    v_cvt_pk_bf16_f32 v49, v49, v49
    v_lshlrev_b32 v49, 16, v49
    v_sqrt_f32 v49, v49
    s_nop 0
    v_cvt_pk_bf16_f32 v49, v49, v49
    v_lshlrev_b32 v49, 16, v49
    v_rcp_f32 v49, v49
    v_xor_b32 v48, 0x80000000, v48
    v_fma_f32 v50, v48, v51, v50
    v_mul_f32 v50, v50, v49
    v_cvt_pk_bf16_f32 v50, v50, v50
    v_and_b32 v50, 0xffff0000, v50
    v_ashrrev_i32 v51, 31, v50
    v_or_b32 v51, 0x80000000, v51
    v_xor_b32 v50, v50, v51
    v_and_b32 v50, 0xffff0000, v50
    s_sub_u32 s44, 2047, s77
    v_sub_u32 v51, s44, v9
    v_or_b32 v50, v50, v51
    s_lshl_b32 s44, s3, 1
    v_add_u32 v52, s44, v9
    v_lshlrev_b32 v53, 3, v52
    v_lshlrev_b32 v52, 2, v52
    v_add_u32 v53, 159744, v53
    v_add_u32 v52, 159808, v52
    s_mov_b64 exec, 3
    ds_write_b64 v53, v[48:49]
    ds_write_b32 v52, v50
    s_mov_b64 exec, -1
    s_waitcnt lgkmcnt(0)

    s_cmp_lg_u32 s3, 0
    s_cbranch_scc1 F_a0r
F_a0p:
    s_waitcnt vmcnt(0)
    v_cmp_eq_u32 vcc, 0, v11
    s_cbranch_vccz F_a0r
    s_sleep 4
    buffer_load_dword v11, v59, s[48:51], 0 offen sc0 sc1
    s_branch F_a0p
F_a0r:
    s_barrier
    s_cmp_eq_u32 s3, 0
    s_cbranch_scc1 F_ax0
    s_mul_i32 s44, s33, 768
    s_add_u32 s44, s44, 40960
    s_add_u32 s45, s3, 1
    s_lshr_b32 s45, s45, 1
    s_cmp_eq_u32 s3, 2
    s_cselect_b32 s45, 0, s45
    s_lshl_b32 s45, s45, 8
    s_add_u32 s44, s44, s45
    buffer_atomic_add_f32 v66, v3, s[40:43], s44 offen
    s_mul_i32 s44, s2, 1152
    s_mul_i32 s45, s3, 384
    s_add_u32 s44, s44, s45
    s_sub_u32 s44, s44, 384
    s_mov_b64 exec, 0xffffff
    buffer_store_dwordx4 v[12:15], v2, s[24:27], s44 offen sc0 sc1
    s_mov_b64 exec, -1
    s_branch F_s1
F_ax0:
    v_add_u32 v60, 159744, v3
    ds_read_b32 v60, v60
    s_lshl_b32 s44, s76, 7
    s_mov_b32 exec_hi, 0
    s_waitcnt lgkmcnt(0)
    buffer_store_dword v60, v3, s[40:43], s44 offen sc0 sc1
    s_mov_b64 exec, -1
F_s1:

    s_barrier
    v_mov_b32 v4, 159144
    v_mov_b32 v8, 1
    s_lshr_b32 s47, s32, 2
    s_lshl_b32 s47, s47, 11
    s_add_u32 s54, s47, 0x858180
    s_add_u32 s54, s72, s54
    s_addc_u32 s55, s73, 0
    s_waitcnt vmcnt(0)
    s_mov_b64 exec, 1
    ds_add_rtn_u32 v9, v4, v8
    s_waitcnt lgkmcnt(0)
    v_readfirstlane_b32 s44, v9
    s_mov_b64 exec, -1
    s_cmp_lg_u32 s44, 3
    s_cbranch_scc1 F_a0s
    s_mov_b32 s74, 1
    s_atomic_add s74, s[54:55], 0
    s_atomic_add s74, s[56:57], 0
    s_atomic_add s74, s[58:59], 0
F_a0s:

    s_barrier
    s_and_b32 s89, s2, 0xdd
    s_bfe_u32 s44, s2, 0x10005
    s_lshl_b32 s44, s44, 1
    s_or_b32 s89, s89, s44
    s_bfe_u32 s44, s2, 0x10001
    s_xor_b32 s44, s44, 1
    s_lshl_b32 s44, s44, 5
    s_or_b32 s89, s89, s44
    s_and_b32 s36, s89, 3
    s_bfe_u32 s37, s89, 0x10002
    s_lshr_b32 s38, s89, 3
    s_cmp_eq_u32 s37, 0
    s_cselect_b32 s16, s62, s64
    s_cselect_b32 s17, s63, s65
    s_cmp_lt_u32 s89, 224
    s_cselect_b32 s18, 7340032, 0
    v_mul_u32_u24 v6, 57344, v5
    v_lshl_add_u32 v6, v7, 4, v6
    s_lshl_b32 s44, s36, 2
    s_add_u32 s44, s44, s3
    s_waitcnt lgkmcnt(0)
    s_mul_i32 s54, s44, 458752
    s_lshl_b32 s45, s38, 8
    s_add_u32 s54, s54, s45
    s_lshl_b32 s55, s44, 7

    s_add_u32 s39, s35, 2
    s_and_b32 s39, s39, 7
    s_lshl_b32 s10, s34, 3
    s_add_u32 s10, s10, s30

    s_mul_i32 s10, s10, 112
    s_mul_i32 s79, s3, 28
    s_add_u32 s10, s10, s79
    s_lshl_b32 s78, s10, 11
    s_lshl_b32 s79, s39, 8
    s_add_u32 s78, s78, s79
    v_mul_u32_u24 v160, 14336, v5
    v_lshl_add_u32 v160, v7, 4, v160

    s_mov_b32 s80, s66
    s_mov_b32 s81, s67
    s_mov_b32 s82, 0x700000
    s_mov_b32 s83, 0x00020000
    s_mul_i32 s53, s2, 37
    s_and_b32 s53, s53, 255
    s_mul_i32 s53, s53, 4
    s_lshr_b32 s53, s53, 8
    s_branch F_swx
F_sw0:
    s_add_u32 s91, s54, 0
    buffer_load_dwordx4 v[72:75], v6, s[16:19], s91 offen nt
    s_add_u32 s91, s54, 7168
    buffer_load_dwordx4 v[76:79], v6, s[16:19], s91 offen nt
    s_add_u32 s91, s54, 14336
    buffer_load_dwordx4 v[80:83], v6, s[16:19], s91 offen nt
    s_add_u32 s91, s54, 21504
    buffer_load_dwordx4 v[84:87], v6, s[16:19], s91 offen nt
    s_add_u32 s91, s54, 28672
    buffer_load_dwordx4 v[88:91], v6, s[16:19], s91 offen nt
    s_add_u32 s91, s54, 35840
    buffer_load_dwordx4 v[92:95], v6, s[16:19], s91 offen nt
    s_add_u32 s91, s54, 43008
    buffer_load_dwordx4 v[96:99], v6, s[16:19], s91 offen nt
    s_add_u32 s91, s54, 50176
    buffer_load_dwordx4 v[100:103], v6, s[16:19], s91 offen nt
    s_setpc_b64 s[34:35]
F_swx:
    s_cmp_eq_u32 s3, 2
    s_cbranch_scc1 F_ax2
    s_cmp_eq_u32 s3, 1
    s_cbranch_scc1 F_ax1
    s_cmp_eq_u32 s3, 0
    s_cbranch_scc1 F_ax0b
    s_barrier
    s_cmp_lg_u32 s53, 0
    s_cbranch_scc1 SW_91
    s_call_b64 s[34:35], F_sw0
SW_91:
    s_branch IW_w5
IW_r5:
    s_barrier
    s_cmp_lg_u32 s53, 1
    s_cbranch_scc1 SW_92
    s_call_b64 s[34:35], F_sw0
SW_92:
    s_branch IW_w7
IW_r7:
    s_barrier
    s_cmp_lg_u32 s53, 2
    s_cbranch_scc1 SW_93
    s_call_b64 s[34:35], F_sw0
SW_93:
    s_nop 0
    s_barrier
    s_cmp_lg_u32 s53, 3
    s_cbranch_scc1 SW_94
    s_call_b64 s[34:35], F_sw0
SW_94:
    s_nop 0
    s_barrier
    s_nop 0
    s_barrier
    s_nop 0
    s_barrier
    s_add_u32 s91, s54, 229376
    buffer_load_dwordx4 v[104:107], v6, s[16:19], s91 offen nt
    s_add_u32 s91, s54, 236544
    buffer_load_dwordx4 v[108:111], v6, s[16:19], s91 offen nt
    s_add_u32 s91, s54, 243712
    buffer_load_dwordx4 v[112:115], v6, s[16:19], s91 offen nt
    s_add_u32 s91, s54, 250880
    buffer_load_dwordx4 v[116:119], v6, s[16:19], s91 offen nt
    s_nop 0
    s_load_dword s76, s[56:57], 0 glc
    s_barrier
    s_add_u32 s91, s54, 258048
    buffer_load_dwordx4 v[120:123], v6, s[16:19], s91 offen nt
    s_add_u32 s91, s54, 265216
    buffer_load_dwordx4 v[124:127], v6, s[16:19], s91 offen nt
    s_add_u32 s91, s54, 272384
    buffer_load_dwordx4 v[128:131], v6, s[16:19], s91 offen nt
    s_add_u32 s91, s54, 279552
    buffer_load_dwordx4 v[132:135], v6, s[16:19], s91 offen nt
    s_waitcnt lgkmcnt(0)
    s_cmp_lt_u32 s76, 1000
    s_cbranch_scc1 F_g3
    v_mov_b32 v4, 1
    s_mov_b64 exec, 1
    ds_write_b32 v10, v4 offset:48
    s_mov_b64 exec, -1
    s_mov_b32 s88, 0
F_g3:
    s_barrier
    s_branch F_aj
F_ax1:
    s_barrier
    s_cmp_lg_u32 s53, 0
    s_cbranch_scc1 SW_95
    s_call_b64 s[34:35], F_sw0
SW_95:
    s_branch IW_w6
IW_r6:
    s_barrier
    s_cmp_lg_u32 s53, 1
    s_cbranch_scc1 SW_96
    s_call_b64 s[34:35], F_sw0
SW_96:
    s_nop 0
    s_barrier
    s_cmp_lg_u32 s53, 2
    s_cbranch_scc1 SW_97
    s_call_b64 s[34:35], F_sw0
SW_97:
    s_nop 0
    s_mul_i32 s44, s33, 768
    s_add_u32 s44, s44, 40960
    s_barrier
    s_cmp_lg_u32 s53, 3
    s_cbranch_scc1 SW_98
    s_call_b64 s[34:35], F_sw0
SW_98:
    s_load_dword s76, s[58:59], 0 glc
    s_barrier
    s_waitcnt lgkmcnt(0)
    s_cmp_ge_u32 s76, 16
    s_cbranch_scc1 GC_99
SP_100:
    s_load_dword s76, s[58:59], 0 glc
    s_waitcnt lgkmcnt(0)
    s_cmp_ge_u32 s76, 16
    s_cbranch_scc1 SD_101
    s_sleep 3
    s_branch SP_100
SD_101:
GC_99:
    s_barrier
    s_sleep 4
    s_mov_b32 m0, 158208
    s_mov_b32 exec_hi, 0xffff
    buffer_load_dwordx4 v2, s[40:43], s44 offen sc0 sc1 lds
    s_mov_b64 exec, -1
    s_barrier
    s_add_u32 s91, s54, 229376
    buffer_load_dwordx4 v[104:107], v6, s[16:19], s91 offen nt
    s_add_u32 s91, s54, 236544
    buffer_load_dwordx4 v[108:111], v6, s[16:19], s91 offen nt
    s_add_u32 s91, s54, 243712
    buffer_load_dwordx4 v[112:115], v6, s[16:19], s91 offen nt
    s_add_u32 s91, s54, 250880
    buffer_load_dwordx4 v[116:119], v6, s[16:19], s91 offen nt
    s_barrier
    s_nop 0
    s_add_u32 s91, s54, 258048
    buffer_load_dwordx4 v[120:123], v6, s[16:19], s91 offen nt
    s_add_u32 s91, s54, 265216
    buffer_load_dwordx4 v[124:127], v6, s[16:19], s91 offen nt
    s_add_u32 s91, s54, 272384
    buffer_load_dwordx4 v[128:131], v6, s[16:19], s91 offen nt
    s_add_u32 s91, s54, 279552
    buffer_load_dwordx4 v[132:135], v6, s[16:19], s91 offen nt
    s_waitcnt vmcnt(8)
    v_mov_b32 v4, 1
    s_mov_b64 exec, 1
    ds_write_b32 v10, v4 offset:48
    s_mov_b64 exec, -1
    s_barrier
    s_branch F_aj
IW_w9:
    s_branch IW_r9
F_ax0b:
    s_barrier
    s_cmp_lg_u32 s53, 0
    s_cbranch_scc1 SW_102
    s_call_b64 s[34:35], F_sw0
SW_102:
    s_branch IW_w2
IW_r2:
    s_barrier
    s_cmp_lg_u32 s53, 1
    s_cbranch_scc1 SW_103
    s_call_b64 s[34:35], F_sw0
SW_103:
    s_nop 0
    s_barrier
    s_cmp_lg_u32 s53, 2
    s_cbranch_scc1 SW_104
    s_call_b64 s[34:35], F_sw0
SW_104:
    s_nop 0
    s_lshl_b32 s47, s28, 9
    s_add_u32 s58, s47, 0x858000
    s_add_u32 s58, s72, s58
    s_addc_u32 s59, s73, 0
    s_lshl_b32 s44, s32, 11
    s_lshl_b32 s45, s28, 11
    v_lshrrev_b32 v11, 2, v0
    v_and_b32 v9, 3, v0
    v_lshlrev_b32 v9, 4, v9
    v_lshl_add_u32 v11, v11, 7, v9

    s_barrier
    s_cmp_lg_u32 s53, 3
    s_cbranch_scc1 SW_105
    s_call_b64 s[34:35], F_sw0
SW_105:
    s_load_dword s76, s[56:57], 0 glc
    s_load_dword s77, s[58:59], 0 glc
    s_barrier
    s_waitcnt lgkmcnt(0)
    s_cmp_ge_u32 s76, 16
    s_cbranch_scc1 GC_106
SP_107:
    s_load_dword s76, s[56:57], 0 glc
    s_waitcnt lgkmcnt(0)
    s_cmp_ge_u32 s76, 16
    s_cbranch_scc1 SD_108
    s_sleep 3
    s_branch SP_107
SD_108:
GC_106:
    s_cmp_ge_u32 s77, 16
    s_cbranch_scc1 GC_109
SP_110:
    s_load_dword s77, s[58:59], 0 glc
    s_waitcnt lgkmcnt(0)
    s_cmp_ge_u32 s77, 16
    s_cbranch_scc1 SD_111
    s_sleep 3
    s_branch SP_110
SD_111:
GC_109:
    s_barrier
    s_sleep 4
    buffer_load_dwordx4 v[32:35], v11, s[40:43], s44 offen sc0 sc1
    buffer_load_dwordx4 v[36:39], v11, s[40:43], s45 offen sc0 sc1
    v_lshlrev_b32 v9, 3, v0
    v_add_u32 v9, 155648, v9
    s_mov_b32 s44, 0x3fb8aa3b

    s_barrier
    s_add_u32 s91, s54, 229376
    buffer_load_dwordx4 v[104:107], v6, s[16:19], s91 offen nt
    s_add_u32 s91, s54, 236544
    buffer_load_dwordx4 v[108:111], v6, s[16:19], s91 offen nt
    s_add_u32 s91, s54, 243712
    buffer_load_dwordx4 v[112:115], v6, s[16:19], s91 offen nt
    s_add_u32 s91, s54, 250880
    buffer_load_dwordx4 v[116:119], v6, s[16:19], s91 offen nt
    s_barrier
    s_nop 0
    s_add_u32 s91, s54, 258048
    buffer_load_dwordx4 v[120:123], v6, s[16:19], s91 offen nt
    s_add_u32 s91, s54, 265216
    buffer_load_dwordx4 v[124:127], v6, s[16:19], s91 offen nt
    s_add_u32 s91, s54, 272384
    buffer_load_dwordx4 v[128:131], v6, s[16:19], s91 offen nt
    s_add_u32 s91, s54, 279552
    buffer_load_dwordx4 v[132:135], v6, s[16:19], s91 offen nt
    s_waitcnt vmcnt(8)
    v_swap_b32 v33, v34
    v_swap_b32 v37, v38
    v_mul_f32 v40, s44, v34
    v_mul_f32 v41, s44, v35
    ds_write_b64 v9, v[32:33]
    ds_write_b64 v9, v[40:41] offset:1024
    ds_write_b64 v9, v[36:37] offset:1536
    ds_write_b64 v9, v[38:39] offset:2048

    v_mov_b32 v4, 1
    s_mov_b64 exec, 1
    ds_write_b32 v10, v4 offset:48
    s_mov_b64 exec, -1
    s_barrier
    s_branch F_aj
F_ax2:
    s_cmp_lg_u32 s2, 248
    s_cbranch_scc1 F_a2n
    s_waitcnt lgkmcnt(0)
    s_mov_b32 s74, 7
    v_lshrrev_b32 v11, 1, v0
    v_and_b32 v9, 1, v0
    v_lshlrev_b32 v9, 4, v9
    v_lshl_add_u32 v11, v11, 7, v9
    v_lshlrev_b32 v9, 9, v0
    v_mov_b32 v8, 1000
F_a2l:

    s_load_dword s60, s[40:41], 0x8180 glc
    s_load_dword s61, s[40:41], 0x8980 glc
    s_load_dword s62, s[40:41], 0x9180 glc
    s_load_dword s63, s[40:41], 0x9980 glc
    s_waitcnt lgkmcnt(0)
    s_add_u32 s60, s60, s61
    s_add_u32 s62, s62, s63
    s_add_u32 s60, s60, s62
    s_cmp_ge_u32 s60, 256
    s_cbranch_scc1 F_a2t

    s_cmp_ge_u32 s74, 17
    s_cbranch_scc1 DB_112
    s_barrier
    s_add_u32 s74, s74, 1
DB_112:
    s_branch F_a2l
F_a2t:
    s_movk_i32 s44, 0
    buffer_load_dwordx4 v[16:19], v11, s[40:43], s44 offen offset:64 sc0 sc1
    s_movk_i32 s44, 4096
    buffer_load_dwordx4 v[20:23], v11, s[40:43], s44 offen offset:64 sc0 sc1
    s_movk_i32 s44, 8192
    buffer_load_dwordx4 v[24:27], v11, s[40:43], s44 offen offset:64 sc0 sc1
    s_movk_i32 s44, 12288
    buffer_load_dwordx4 v[28:31], v11, s[40:43], s44 offen offset:64 sc0 sc1
    s_movk_i32 s44, 16384
    buffer_load_dwordx4 v[32:35], v11, s[40:43], s44 offen offset:64 sc0 sc1
    s_movk_i32 s44, 20480
    buffer_load_dwordx4 v[36:39], v11, s[40:43], s44 offen offset:64 sc0 sc1
    s_movk_i32 s44, 24576
    buffer_load_dwordx4 v[40:43], v11, s[40:43], s44 offen offset:64 sc0 sc1
    s_movk_i32 s44, 28672
    buffer_load_dwordx4 v[44:47], v11, s[40:43], s44 offen offset:64 sc0 sc1
    s_mov_b32 s44, 32768
    s_mov_b64 exec, 0xffff
    buffer_atomic_add v8, v9, s[40:43], s44 offen
    s_mov_b64 exec, -1

    s_cmp_ge_u32 s74, 17
    s_cbranch_scc1 DB_113
    s_barrier
    s_add_u32 s74, s74, 1
DB_113:
    s_waitcnt vmcnt(1)
    v_max3_u32 v48, v16, v17, v18
    v_med3_u32 v49, v16, v17, v18
    v_min3_u32 v50, v16, v17, v18
    v_med3_u32 v50, v49, v50, v19
    v_med3_u32 v49, v48, v49, v19
    v_max_u32 v48, v48, v19
    v_med3_u32 v50, v49, v50, v20
    v_med3_u32 v49, v48, v49, v20
    v_max_u32 v48, v48, v20
    v_med3_u32 v50, v49, v50, v21
    v_med3_u32 v49, v48, v49, v21
    v_max_u32 v48, v48, v21
    v_med3_u32 v50, v49, v50, v22
    v_med3_u32 v49, v48, v49, v22
    v_max_u32 v48, v48, v22
    v_med3_u32 v50, v49, v50, v23
    v_med3_u32 v49, v48, v49, v23
    v_max_u32 v48, v48, v23
    v_med3_u32 v50, v49, v50, v24
    v_med3_u32 v49, v48, v49, v24
    v_max_u32 v48, v48, v24
    v_med3_u32 v50, v49, v50, v25
    v_med3_u32 v49, v48, v49, v25
    v_max_u32 v48, v48, v25
    v_med3_u32 v50, v49, v50, v26
    v_med3_u32 v49, v48, v49, v26
    v_max_u32 v48, v48, v26
    v_med3_u32 v50, v49, v50, v27
    v_med3_u32 v49, v48, v49, v27
    v_max_u32 v48, v48, v27
    v_med3_u32 v50, v49, v50, v28
    v_med3_u32 v49, v48, v49, v28
    v_max_u32 v48, v48, v28
    v_med3_u32 v50, v49, v50, v29
    v_med3_u32 v49, v48, v49, v29
    v_max_u32 v48, v48, v29
    v_med3_u32 v50, v49, v50, v30
    v_med3_u32 v49, v48, v49, v30
    v_max_u32 v48, v48, v30
    v_med3_u32 v50, v49, v50, v31
    v_med3_u32 v49, v48, v49, v31
    v_max_u32 v48, v48, v31
    v_med3_u32 v50, v49, v50, v32
    v_med3_u32 v49, v48, v49, v32
    v_max_u32 v48, v48, v32
    v_med3_u32 v50, v49, v50, v33
    v_med3_u32 v49, v48, v49, v33
    v_max_u32 v48, v48, v33
    v_med3_u32 v50, v49, v50, v34
    v_med3_u32 v49, v48, v49, v34
    v_max_u32 v48, v48, v34
    v_med3_u32 v50, v49, v50, v35
    v_med3_u32 v49, v48, v49, v35
    v_max_u32 v48, v48, v35
    v_med3_u32 v50, v49, v50, v36
    v_med3_u32 v49, v48, v49, v36
    v_max_u32 v48, v48, v36
    v_med3_u32 v50, v49, v50, v37
    v_med3_u32 v49, v48, v49, v37
    v_max_u32 v48, v48, v37
    v_med3_u32 v50, v49, v50, v38
    v_med3_u32 v49, v48, v49, v38
    v_max_u32 v48, v48, v38
    v_med3_u32 v50, v49, v50, v39
    v_med3_u32 v49, v48, v49, v39
    v_max_u32 v48, v48, v39
    v_med3_u32 v50, v49, v50, v40
    v_med3_u32 v49, v48, v49, v40
    v_max_u32 v48, v48, v40
    v_med3_u32 v50, v49, v50, v41
    v_med3_u32 v49, v48, v49, v41
    v_max_u32 v48, v48, v41
    v_med3_u32 v50, v49, v50, v42
    v_med3_u32 v49, v48, v49, v42
    v_max_u32 v48, v48, v42
    v_med3_u32 v50, v49, v50, v43
    v_med3_u32 v49, v48, v49, v43
    v_max_u32 v48, v48, v43
    v_med3_u32 v50, v49, v50, v44
    v_med3_u32 v49, v48, v49, v44
    v_max_u32 v48, v48, v44
    v_med3_u32 v50, v49, v50, v45
    v_med3_u32 v49, v48, v49, v45
    v_max_u32 v48, v48, v45
    v_med3_u32 v50, v49, v50, v46
    v_med3_u32 v49, v48, v49, v46
    v_max_u32 v48, v48, v46
    v_med3_u32 v50, v49, v50, v47
    v_med3_u32 v49, v48, v49, v47
    v_max_u32 v48, v48, v47
    s_mov_b32 s53, 0
    v_max_u32 v4, v48, v49
    s_nop 1
    v_max_u32_dpp v4, v4, v4 row_shr:1 row_mask:0xf bank_mask:0xf bound_ctrl:0
    s_nop 1
    v_max_u32_dpp v4, v4, v4 row_shr:2 row_mask:0xf bank_mask:0xf bound_ctrl:0
    s_nop 1
    v_max_u32_dpp v4, v4, v4 row_shr:4 row_mask:0xf bank_mask:0xf bound_ctrl:0
    s_nop 1
    v_max_u32_dpp v4, v4, v4 row_shr:8 row_mask:0xf bank_mask:0xf bound_ctrl:0
    s_nop 1
    v_max_u32_dpp v4, v4, v4 row_bcast:15 row_mask:0xa bank_mask:0xf
    s_nop 1
    v_max_u32_dpp v4, v4, v4 row_bcast:31 row_mask:0xc bank_mask:0xf
    s_nop 0
    v_readlane_b32 s52, v4, 63
    s_nop 0
    s_add_u32 s53, s53, s52
    v_writelane_b32 v13, s53, 0
    v_subrev_u32 v48, s52, v48
    v_subrev_u32 v49, s52, v49
    v_max_u32 v4, v48, v49
    s_nop 1
    v_max_u32_dpp v4, v4, v4 row_shr:1 row_mask:0xf bank_mask:0xf bound_ctrl:0
    s_nop 1
    v_max_u32_dpp v4, v4, v4 row_shr:2 row_mask:0xf bank_mask:0xf bound_ctrl:0
    s_nop 1
    v_max_u32_dpp v4, v4, v4 row_shr:4 row_mask:0xf bank_mask:0xf bound_ctrl:0
    s_nop 1
    v_max_u32_dpp v4, v4, v4 row_shr:8 row_mask:0xf bank_mask:0xf bound_ctrl:0
    s_nop 1
    v_max_u32_dpp v4, v4, v4 row_bcast:15 row_mask:0xa bank_mask:0xf
    s_nop 1
    v_max_u32_dpp v4, v4, v4 row_bcast:31 row_mask:0xc bank_mask:0xf
    s_nop 0
    v_readlane_b32 s52, v4, 63
    s_nop 0
    s_add_u32 s53, s53, s52
    v_writelane_b32 v13, s53, 1
    v_subrev_u32 v48, s52, v48
    v_subrev_u32 v49, s52, v49
    v_max_u32 v4, v48, v49
    s_nop 1
    v_max_u32_dpp v4, v4, v4 row_shr:1 row_mask:0xf bank_mask:0xf bound_ctrl:0
    s_nop 1
    v_max_u32_dpp v4, v4, v4 row_shr:2 row_mask:0xf bank_mask:0xf bound_ctrl:0
    s_nop 1
    v_max_u32_dpp v4, v4, v4 row_shr:4 row_mask:0xf bank_mask:0xf bound_ctrl:0
    s_nop 1
    v_max_u32_dpp v4, v4, v4 row_shr:8 row_mask:0xf bank_mask:0xf bound_ctrl:0
    s_nop 1
    v_max_u32_dpp v4, v4, v4 row_bcast:15 row_mask:0xa bank_mask:0xf
    s_nop 1
    v_max_u32_dpp v4, v4, v4 row_bcast:31 row_mask:0xc bank_mask:0xf
    s_nop 0
    v_readlane_b32 s52, v4, 63
    s_nop 0
    s_add_u32 s53, s53, s52
    v_writelane_b32 v13, s53, 2
    v_subrev_u32 v48, s52, v48
    v_subrev_u32 v49, s52, v49
    v_max_u32 v4, v48, v49
    s_nop 1
    v_max_u32_dpp v4, v4, v4 row_shr:1 row_mask:0xf bank_mask:0xf bound_ctrl:0
    s_nop 1
    v_max_u32_dpp v4, v4, v4 row_shr:2 row_mask:0xf bank_mask:0xf bound_ctrl:0
    s_nop 1
    v_max_u32_dpp v4, v4, v4 row_shr:4 row_mask:0xf bank_mask:0xf bound_ctrl:0
    s_nop 1
    v_max_u32_dpp v4, v4, v4 row_shr:8 row_mask:0xf bank_mask:0xf bound_ctrl:0
    s_nop 1
    v_max_u32_dpp v4, v4, v4 row_bcast:15 row_mask:0xa bank_mask:0xf
    s_nop 1
    v_max_u32_dpp v4, v4, v4 row_bcast:31 row_mask:0xc bank_mask:0xf
    s_nop 0
    v_readlane_b32 s52, v4, 63
    s_nop 0
    s_add_u32 s53, s53, s52
    v_writelane_b32 v13, s53, 3
    v_subrev_u32 v48, s52, v48
    v_subrev_u32 v49, s52, v49
    v_max_u32 v4, v48, v49
    s_nop 1
    v_max_u32_dpp v4, v4, v4 row_shr:1 row_mask:0xf bank_mask:0xf bound_ctrl:0
    s_nop 1
    v_max_u32_dpp v4, v4, v4 row_shr:2 row_mask:0xf bank_mask:0xf bound_ctrl:0
    s_nop 1
    v_max_u32_dpp v4, v4, v4 row_shr:4 row_mask:0xf bank_mask:0xf bound_ctrl:0
    s_nop 1
    v_max_u32_dpp v4, v4, v4 row_shr:8 row_mask:0xf bank_mask:0xf bound_ctrl:0
    s_nop 1
    v_max_u32_dpp v4, v4, v4 row_bcast:15 row_mask:0xa bank_mask:0xf
    s_nop 1
    v_max_u32_dpp v4, v4, v4 row_bcast:31 row_mask:0xc bank_mask:0xf
    s_nop 0
    v_readlane_b32 s52, v4, 63
    s_nop 0
    s_add_u32 s53, s53, s52
    v_writelane_b32 v13, s53, 4
    v_subrev_u32 v48, s52, v48
    v_subrev_u32 v49, s52, v49
    v_max_u32 v4, v48, v49
    s_nop 1
    v_max_u32_dpp v4, v4, v4 row_shr:1 row_mask:0xf bank_mask:0xf bound_ctrl:0
    s_nop 1
    v_max_u32_dpp v4, v4, v4 row_shr:2 row_mask:0xf bank_mask:0xf bound_ctrl:0
    s_nop 1
    v_max_u32_dpp v4, v4, v4 row_shr:4 row_mask:0xf bank_mask:0xf bound_ctrl:0
    s_nop 1
    v_max_u32_dpp v4, v4, v4 row_shr:8 row_mask:0xf bank_mask:0xf bound_ctrl:0
    s_nop 1
    v_max_u32_dpp v4, v4, v4 row_bcast:15 row_mask:0xa bank_mask:0xf
    s_nop 1
    v_max_u32_dpp v4, v4, v4 row_bcast:31 row_mask:0xc bank_mask:0xf
    s_nop 0
    v_readlane_b32 s52, v4, 63
    s_nop 0
    s_add_u32 s53, s53, s52
    v_writelane_b32 v13, s53, 5
    v_subrev_u32 v48, s52, v48
    v_subrev_u32 v49, s52, v49
    v_max_u32 v4, v48, v49
    s_nop 1
    v_max_u32_dpp v4, v4, v4 row_shr:1 row_mask:0xf bank_mask:0xf bound_ctrl:0
    s_nop 1
    v_max_u32_dpp v4, v4, v4 row_shr:2 row_mask:0xf bank_mask:0xf bound_ctrl:0
    s_nop 1
    v_max_u32_dpp v4, v4, v4 row_shr:4 row_mask:0xf bank_mask:0xf bound_ctrl:0
    s_nop 1
    v_max_u32_dpp v4, v4, v4 row_shr:8 row_mask:0xf bank_mask:0xf bound_ctrl:0
    s_nop 1
    v_max_u32_dpp v4, v4, v4 row_bcast:15 row_mask:0xa bank_mask:0xf
    s_nop 1
    v_max_u32_dpp v4, v4, v4 row_bcast:31 row_mask:0xc bank_mask:0xf
    s_nop 0
    v_readlane_b32 s52, v4, 63
    s_nop 0
    s_add_u32 s53, s53, s52
    v_writelane_b32 v13, s53, 6
    v_subrev_u32 v48, s52, v48
    v_subrev_u32 v49, s52, v49
    v_max_u32 v4, v48, v49
    s_nop 1
    v_max_u32_dpp v4, v4, v4 row_shr:1 row_mask:0xf bank_mask:0xf bound_ctrl:0
    s_nop 1
    v_max_u32_dpp v4, v4, v4 row_shr:2 row_mask:0xf bank_mask:0xf bound_ctrl:0
    s_nop 1
    v_max_u32_dpp v4, v4, v4 row_shr:4 row_mask:0xf bank_mask:0xf bound_ctrl:0
    s_nop 1
    v_max_u32_dpp v4, v4, v4 row_shr:8 row_mask:0xf bank_mask:0xf bound_ctrl:0
    s_nop 1
    v_max_u32_dpp v4, v4, v4 row_bcast:15 row_mask:0xa bank_mask:0xf
    s_nop 1
    v_max_u32_dpp v4, v4, v4 row_bcast:31 row_mask:0xc bank_mask:0xf
    s_nop 0
    v_readlane_b32 s52, v4, 63
    s_nop 0
    s_add_u32 s53, s53, s52
    v_writelane_b32 v13, s53, 7
    v_cmp_lt_u32 vcc, s53, v50
    s_cbranch_vccz F_a2k
    s_mov_b32 s53, 0
    s_mov_b32 s52, 0
    s_mov_b32 s64, 0
F_a2f:
    v_subrev_u32 v16, s52, v16
    v_subrev_u32 v17, s52, v17
    v_subrev_u32 v18, s52, v18
    v_subrev_u32 v19, s52, v19
    v_subrev_u32 v20, s52, v20
    v_subrev_u32 v21, s52, v21
    v_subrev_u32 v22, s52, v22
    v_subrev_u32 v23, s52, v23
    v_subrev_u32 v24, s52, v24
    v_subrev_u32 v25, s52, v25
    v_subrev_u32 v26, s52, v26
    v_subrev_u32 v27, s52, v27
    v_subrev_u32 v28, s52, v28
    v_subrev_u32 v29, s52, v29
    v_subrev_u32 v30, s52, v30
    v_subrev_u32 v31, s52, v31
    v_subrev_u32 v32, s52, v32
    v_subrev_u32 v33, s52, v33
    v_subrev_u32 v34, s52, v34
    v_subrev_u32 v35, s52, v35
    v_subrev_u32 v36, s52, v36
    v_subrev_u32 v37, s52, v37
    v_subrev_u32 v38, s52, v38
    v_subrev_u32 v39, s52, v39
    v_subrev_u32 v40, s52, v40
    v_subrev_u32 v41, s52, v41
    v_subrev_u32 v42, s52, v42
    v_subrev_u32 v43, s52, v43
    v_subrev_u32 v44, s52, v44
    v_subrev_u32 v45, s52, v45
    v_subrev_u32 v46, s52, v46
    v_subrev_u32 v47, s52, v47
    v_max3_u32 v4, v16, v17, v18
    v_max3_u32 v12, v19, v20, v21
    v_max3_u32 v4, v4, v22, v23
    v_max3_u32 v12, v12, v24, v25
    v_max3_u32 v4, v4, v26, v27
    v_max3_u32 v12, v12, v28, v29
    v_max3_u32 v4, v4, v30, v31
    v_max3_u32 v12, v12, v32, v33
    v_max3_u32 v4, v4, v34, v35
    v_max3_u32 v12, v12, v36, v37
    v_max3_u32 v4, v4, v38, v39
    v_max3_u32 v12, v12, v40, v41
    v_max3_u32 v4, v4, v42, v43
    v_max3_u32 v12, v12, v44, v45
    v_max3_u32 v4, v4, v46, v47
    v_max_u32 v4, v4, v12
    s_nop 1
    v_max_u32_dpp v4, v4, v4 row_shr:1 row_mask:0xf bank_mask:0xf bound_ctrl:0
    s_nop 1
    v_max_u32_dpp v4, v4, v4 row_shr:2 row_mask:0xf bank_mask:0xf bound_ctrl:0
    s_nop 1
    v_max_u32_dpp v4, v4, v4 row_shr:4 row_mask:0xf bank_mask:0xf bound_ctrl:0
    s_nop 1
    v_max_u32_dpp v4, v4, v4 row_shr:8 row_mask:0xf bank_mask:0xf bound_ctrl:0
    s_nop 1
    v_max_u32_dpp v4, v4, v4 row_bcast:15 row_mask:0xa bank_mask:0xf
    s_nop 1
    v_max_u32_dpp v4, v4, v4 row_bcast:31 row_mask:0xc bank_mask:0xf
    s_nop 0
    v_readlane_b32 s52, v4, 63
    s_nop 0
    s_add_u32 s53, s53, s52
    s_mov_b32 m0, s64
    v_writelane_b32 v13, s53, m0
    s_cmp_ge_u32 s74, 17
    s_cbranch_scc1 DB_114
    s_barrier
    s_add_u32 s74, s74, 1
DB_114:
    s_add_u32 s64, s64, 1
    s_cmp_lt_u32 s64, 8
    s_cbranch_scc1 F_a2f
F_a2k:
    v_and_b32 v4, 7, v0
    v_lshlrev_b32 v4, 2, v4
    ds_bpermute_b32 v12, v4, v13
    v_lshrrev_b32 v9, 3, v0
    v_lshl_add_u32 v4, v9, 9, v4
    s_mov_b32 s44, 32896
    s_mov_b32 s45, 36992
    s_waitcnt lgkmcnt(0)
    v_or_b32 v12, 0x8000, v12
    buffer_store_dword v12, v4, s[40:43], s44 offen sc0 sc1
    buffer_store_dword v12, v4, s[40:43], s45 offen sc0 sc1

F_a2m:
    s_cmp_ge_u32 s74, 17
    s_cbranch_scc1 DB_115
    s_barrier
    s_add_u32 s74, s74, 1
DB_115:
    s_cmp_lt_u32 s74, 17
    s_cbranch_scc1 F_a2m
    s_add_u32 s91, s54, 0
    s_nop 0
    buffer_load_dwordx4 v[72:75], v6, s[16:19], s91 offen nt
    s_add_u32 s91, s54, 7168
    buffer_load_dwordx4 v[76:79], v6, s[16:19], s91 offen nt
    s_add_u32 s91, s54, 14336
    buffer_load_dwordx4 v[80:83], v6, s[16:19], s91 offen nt
    s_add_u32 s91, s54, 21504
    buffer_load_dwordx4 v[84:87], v6, s[16:19], s91 offen nt
    s_add_u32 s91, s54, 28672
    buffer_load_dwordx4 v[88:91], v6, s[16:19], s91 offen nt
    s_add_u32 s91, s54, 35840
    buffer_load_dwordx4 v[92:95], v6, s[16:19], s91 offen nt
    s_add_u32 s91, s54, 43008
    buffer_load_dwordx4 v[96:99], v6, s[16:19], s91 offen nt
    s_add_u32 s91, s54, 50176
    buffer_load_dwordx4 v[100:103], v6, s[16:19], s91 offen nt
    s_add_u32 s91, s54, 229376
    buffer_load_dwordx4 v[104:107], v6, s[16:19], s91 offen nt
    s_add_u32 s91, s54, 236544
    buffer_load_dwordx4 v[108:111], v6, s[16:19], s91 offen nt
    s_add_u32 s91, s54, 243712
    buffer_load_dwordx4 v[112:115], v6, s[16:19], s91 offen nt
    s_add_u32 s91, s54, 250880
    buffer_load_dwordx4 v[116:119], v6, s[16:19], s91 offen nt
    s_add_u32 s91, s54, 258048
    buffer_load_dwordx4 v[120:123], v6, s[16:19], s91 offen nt
    s_add_u32 s91, s54, 265216
    buffer_load_dwordx4 v[124:127], v6, s[16:19], s91 offen nt
    s_add_u32 s91, s54, 272384
    buffer_load_dwordx4 v[128:131], v6, s[16:19], s91 offen nt
    s_add_u32 s91, s54, 279552
    buffer_load_dwordx4 v[132:135], v6, s[16:19], s91 offen nt
    s_branch F_aj2
IW_w10:
    s_branch IW_r10
F_a2n:
    s_barrier
    s_cmp_lg_u32 s53, 0
    s_cbranch_scc1 SW_116
    s_call_b64 s[34:35], F_sw0
SW_116:
    s_branch IW_w11
IW_r11:
    s_barrier
    s_cmp_lg_u32 s53, 1
    s_cbranch_scc1 SW_117
    s_call_b64 s[34:35], F_sw0
SW_117:
    s_nop 0
    s_barrier
    s_cmp_lg_u32 s53, 2
    s_cbranch_scc1 SW_118
    s_call_b64 s[34:35], F_sw0
SW_118:
    s_nop 0
    s_barrier
    s_cmp_lg_u32 s53, 3
    s_cbranch_scc1 SW_119
    s_call_b64 s[34:35], F_sw0
SW_119:
    s_nop 0
    s_barrier
    s_nop 0
    s_barrier
    s_nop 0
    s_barrier
    s_nop 0
    s_add_u32 s91, s54, 229376
    buffer_load_dwordx4 v[104:107], v6, s[16:19], s91 offen nt
    s_add_u32 s91, s54, 236544
    buffer_load_dwordx4 v[108:111], v6, s[16:19], s91 offen nt
    s_add_u32 s91, s54, 243712
    buffer_load_dwordx4 v[112:115], v6, s[16:19], s91 offen nt
    s_add_u32 s91, s54, 250880
    buffer_load_dwordx4 v[116:119], v6, s[16:19], s91 offen nt
    s_nop 0
    s_load_dwordx8 s[60:67], s[56:57], 128 glc
    s_barrier
    s_add_u32 s91, s54, 258048
    buffer_load_dwordx4 v[120:123], v6, s[16:19], s91 offen nt
    s_add_u32 s91, s54, 265216
    buffer_load_dwordx4 v[124:127], v6, s[16:19], s91 offen nt
    s_add_u32 s91, s54, 272384
    buffer_load_dwordx4 v[128:131], v6, s[16:19], s91 offen nt
    s_add_u32 s91, s54, 279552
    buffer_load_dwordx4 v[132:135], v6, s[16:19], s91 offen nt
    s_waitcnt lgkmcnt(0)
    s_and_b64 s[44:45], s[60:61], s[62:63]
    s_and_b64 s[44:45], s[44:45], s[64:65]
    s_and_b64 s[44:45], s[44:45], s[66:67]
    s_and_b32 s44, s44, s45
    s_bitcmp1_b32 s44, 15
    s_cbranch_scc0 F_a2q
    s_nop 0
    s_andn2_b32 s60, s60, 0x8000
    v_writelane_b32 v12, s60, 0
    s_andn2_b32 s61, s61, 0x8000
    v_writelane_b32 v12, s61, 1
    s_andn2_b32 s62, s62, 0x8000
    v_writelane_b32 v12, s62, 2
    s_andn2_b32 s63, s63, 0x8000
    v_writelane_b32 v12, s63, 3
    s_andn2_b32 s64, s64, 0x8000
    v_writelane_b32 v12, s64, 4
    s_andn2_b32 s65, s65, 0x8000
    v_writelane_b32 v12, s65, 5
    s_andn2_b32 s66, s66, 0x8000
    v_writelane_b32 v12, s66, 6
    s_andn2_b32 s67, s67, 0x8000
    v_writelane_b32 v12, s67, 7
    v_add_u32 v4, 158976, v3
    s_mov_b64 exec, 0xff
    ds_write_b32 v4, v12
    s_mov_b64 exec, -1
    v_mov_b32 v4, 1
    s_mov_b64 exec, 1
    ds_write_b32 v10, v4 offset:48
    s_mov_b64 exec, -1
    s_waitcnt lgkmcnt(0)
    s_mov_b32 s88, 1
F_a2q:
    s_barrier
F_aj:
    s_mov_b32 s74, 0
F_aj2:
    v_and_b32 v13, 3, v0
    v_lshlrev_b32 v13, 2, v13
    v_add_u32 v13, 159040, v13

    s_cmp_lt_u32 s3, 2
    s_mov_b32 s75, 65536
    s_cselect_b32 s75, 32768, s75
    s_and_b32 s44, s3, 1
    s_lshl_b32 s44, s44, 12
    s_add_u32 s75, s75, s44
    s_add_u32 s12, s72, 0x900000
    s_addc_u32 s13, s73, 0
    s_mov_b32 s14, 0xe0000
    s_mov_b32 s15, 0x00020000
    s_mov_b32 s47, s10
    v_mov_b32 v4, 159096
    ds_read_b32 v9, v4
    s_waitcnt lgkmcnt(0)
    v_readfirstlane_b32 s79, v9
    s_nop 0
    s_cmp_eq_u32 s79, 0
    s_cbranch_scc1 F_xe
    v_and_b32 v4, 7, v0
    v_lshlrev_b32 v4, 2, v4
    v_add_u32 v4, 158976, v4
    ds_read_b32 v4, v4
    s_waitcnt lgkmcnt(0)
    v_and_b32 v4, 0x7ff, v4
    v_sub_u32 v4, 2047, v4
    v_and_b32 v11, 7, v4
    v_lshrrev_b32 v9, 3, v4
    v_lshlrev_b32 v9, 7, v9
    v_lshl_add_u32 v9, v11, 3, v9
    v_lshlrev_b32 v4, 11, v4
    v_lshl_add_u32 v4, v5, 4, v4
    buffer_load_dwordx4 v[64:67], v4, s[20:23], s55 offen
    buffer_load_dwordx4 v[68:71], v4, s[20:23], s55 offen offset:64
    buffer_load_dwordx2 v[14:15], v9, s[40:43], 0 offen sc0 sc1

F_xe:
    s_cmp_lg_u32 s74, 0
    s_cbranch_scc1 JB_120
    s_barrier
JB_120:
    s_cmp_lg_u32 s88, 3
    s_cbranch_scc1 F_g4
SP_121:
    s_load_dword s76, s[56:57], 0 glc
    s_waitcnt lgkmcnt(0)
    s_cmp_ge_u32 s76, 1000
    s_cbranch_scc1 SD_122
    s_sleep 3
    s_branch SP_121
SD_122:
    v_mov_b32 v4, 1
    s_mov_b64 exec, 1
    ds_write_b32 v10, v4 offset:48
    s_mov_b64 exec, -1
F_g4:
    s_setprio 1
    s_cmp_lg_u32 s79, 0
    s_cbranch_scc1 F_xd
    s_cmp_lg_u32 s88, 2
    s_cbranch_scc1 F_se
F_sc:
    s_load_dwordx8 s[60:67], s[56:57], 128 glc
    s_waitcnt lgkmcnt(0)
    s_and_b64 s[44:45], s[60:61], s[62:63]
    s_and_b64 s[44:45], s[44:45], s[64:65]
    s_and_b64 s[44:45], s[44:45], s[66:67]
    s_and_b32 s44, s44, s45
    s_bitcmp1_b32 s44, 15
    s_cbranch_scc1 F_sd
    s_sleep 4
    s_branch F_sc
F_sd:
    s_andn2_b32 s60, s60, 0x8000
    v_writelane_b32 v12, s60, 0
    s_andn2_b32 s61, s61, 0x8000
    v_writelane_b32 v12, s61, 1
    s_andn2_b32 s62, s62, 0x8000
    v_writelane_b32 v12, s62, 2
    s_andn2_b32 s63, s63, 0x8000
    v_writelane_b32 v12, s63, 3
    s_andn2_b32 s64, s64, 0x8000
    v_writelane_b32 v12, s64, 4
    s_andn2_b32 s65, s65, 0x8000
    v_writelane_b32 v12, s65, 5
    s_andn2_b32 s66, s66, 0x8000
    v_writelane_b32 v12, s66, 6
    s_andn2_b32 s67, s67, 0x8000
    v_writelane_b32 v12, s67, 7
    v_add_u32 v4, 158976, v3
    s_mov_b64 exec, 0xff
    ds_write_b32 v4, v12
    s_mov_b64 exec, -1
    v_mov_b32 v4, 1
    s_mov_b64 exec, 1
    ds_write_b32 v10, v4 offset:48
    s_mov_b64 exec, -1
F_se:
    v_mov_b32 v4, 159096
    ds_read_b32 v9, v4 offset:0
FW_123:
    s_waitcnt lgkmcnt(0)
    v_cmp_gt_u32 vcc, 1, v9
    s_cbranch_vccz FO_124
    s_sleep 1
    ds_read_b32 v9, v4 offset:0
    s_branch FW_123
FO_124:
    v_and_b32 v4, 7, v0
    v_lshlrev_b32 v4, 2, v4
    v_add_u32 v4, 158976, v4
    ds_read_b32 v4, v4
    s_waitcnt lgkmcnt(0)
    v_and_b32 v4, 0x7ff, v4
    v_sub_u32 v4, 2047, v4
    v_and_b32 v11, 7, v4
    v_lshrrev_b32 v9, 3, v4
    v_lshlrev_b32 v9, 7, v9
    v_lshl_add_u32 v9, v11, 3, v9
    v_lshlrev_b32 v4, 11, v4
    v_lshl_add_u32 v4, v5, 4, v4
    buffer_load_dwordx4 v[64:67], v4, s[20:23], s55 offen
    buffer_load_dwordx4 v[68:71], v4, s[20:23], s55 offen offset:64
    buffer_load_dwordx2 v[14:15], v9, s[40:43], 0 offen sc0 sc1

F_xd:
    s_mov_b32 s52, 0x05040100
    s_mov_b32 s53, 0x07060302
    s_setprio 1
    s_cmp_ge_u32 s89, 224
    s_cbranch_scc1 F_adown
    s_waitcnt vmcnt(0)
    v_lshlrev_b32 v34, 16, v64
    v_and_b32 v35, 0xffff0000, v64
    v_lshlrev_b32 v36, 16, v65
    v_and_b32 v37, 0xffff0000, v65
    v_lshlrev_b32 v38, 16, v66
    v_and_b32 v39, 0xffff0000, v66
    v_lshlrev_b32 v40, 16, v67
    v_and_b32 v41, 0xffff0000, v67
    v_lshlrev_b32 v42, 16, v68
    v_and_b32 v43, 0xffff0000, v68
    v_lshlrev_b32 v44, 16, v69
    v_and_b32 v45, 0xffff0000, v69
    v_lshlrev_b32 v46, 16, v70
    v_and_b32 v47, 0xffff0000, v70
    v_lshlrev_b32 v48, 16, v71
    v_and_b32 v49, 0xffff0000, v71
    v_add_f32 v34, v34, v14
    v_add_f32 v35, v35, v14
    v_add_f32 v36, v36, v14
    v_add_f32 v37, v37, v14
    v_add_f32 v38, v38, v14
    v_add_f32 v39, v39, v14
    v_add_f32 v40, v40, v14
    v_add_f32 v41, v41, v14
    v_add_f32 v42, v42, v14
    v_add_f32 v43, v43, v14
    v_add_f32 v44, v44, v14
    v_add_f32 v45, v45, v14
    v_add_f32 v46, v46, v14
    v_add_f32 v47, v47, v14
    v_add_f32 v48, v48, v14
    v_add_f32_e64 v49, v49, v14
    v_cvt_pk_bf16_f32 v64, v34, v35
    v_cvt_pk_bf16_f32 v65, v36, v37
    v_cvt_pk_bf16_f32 v66, v38, v39
    v_cvt_pk_bf16_f32 v67, v40, v41
    v_cvt_pk_bf16_f32 v68, v42, v43
    v_cvt_pk_bf16_f32 v69, v44, v45
    v_cvt_pk_bf16_f32 v70, v46, v47
    v_cvt_pk_bf16_f32 v71, v48, v49
    v_lshlrev_b32 v34, 16, v64
    v_and_b32 v35, 0xffff0000, v64
    v_lshlrev_b32 v36, 16, v65
    v_and_b32 v37, 0xffff0000, v65
    v_lshlrev_b32 v38, 16, v66
    v_and_b32 v39, 0xffff0000, v66
    v_lshlrev_b32 v40, 16, v67
    v_and_b32 v41, 0xffff0000, v67
    v_lshlrev_b32 v42, 16, v68
    v_and_b32 v43, 0xffff0000, v68
    v_lshlrev_b32 v44, 16, v69
    v_and_b32 v45, 0xffff0000, v69
    v_lshlrev_b32 v46, 16, v70
    v_and_b32 v47, 0xffff0000, v70
    v_lshlrev_b32 v48, 16, v71
    v_and_b32 v49, 0xffff0000, v71
    v_mul_f32 v34, v34, v15
    v_mul_f32 v35, v35, v15
    v_mul_f32 v36, v36, v15
    v_mul_f32 v37, v37, v15
    v_mul_f32 v38, v38, v15
    v_mul_f32 v39, v39, v15
    v_mul_f32 v40, v40, v15
    v_mul_f32 v41, v41, v15
    v_mul_f32 v42, v42, v15
    v_mul_f32 v43, v43, v15
    v_mul_f32 v44, v44, v15
    v_mul_f32 v45, v45, v15
    v_mul_f32 v46, v46, v15
    v_mul_f32 v47, v47, v15
    v_mul_f32 v48, v48, v15
    v_mul_f32 v49, v49, v15
    v_cvt_pk_bf16_f32 v64, v34, v35
    v_cvt_pk_bf16_f32 v65, v36, v37
    v_cvt_pk_bf16_f32 v66, v38, v39
    v_cvt_pk_bf16_f32 v67, v40, v41
    v_cvt_pk_bf16_f32 v68, v42, v43
    v_cvt_pk_bf16_f32 v69, v44, v45
    v_cvt_pk_bf16_f32 v70, v46, v47
    v_cvt_pk_bf16_f32 v71, v48, v49
    s_waitcnt vmcnt(0)
    v_perm_b32 v136, v76, v72, s52
    v_perm_b32 v137, v84, v80, s52
    v_perm_b32 v138, v92, v88, s52
    v_perm_b32 v139, v100, v96, s52
    s_nop 1
    v_mfma_f32_16x16x32_bf16 v[32:35], v[64:67], v[136:139], 0
    v_perm_b32 v140, v76, v72, s53
    v_perm_b32 v141, v84, v80, s53
    v_perm_b32 v142, v92, v88, s53
    v_perm_b32 v143, v100, v96, s53
    s_nop 1
    v_mfma_f32_16x16x32_bf16 v[36:39], v[64:67], v[140:143], 0
    v_perm_b32 v136, v77, v73, s52
    v_perm_b32 v137, v85, v81, s52
    v_perm_b32 v138, v93, v89, s52
    v_perm_b32 v139, v101, v97, s52
    s_nop 1
    v_mfma_f32_16x16x32_bf16 v[40:43], v[64:67], v[136:139], 0
    v_perm_b32 v140, v77, v73, s53
    v_perm_b32 v141, v85, v81, s53
    v_perm_b32 v142, v93, v89, s53
    v_perm_b32 v143, v101, v97, s53
    s_nop 1
    v_mfma_f32_16x16x32_bf16 v[44:47], v[64:67], v[140:143], 0
    v_perm_b32 v136, v78, v74, s52
    v_perm_b32 v137, v86, v82, s52
    v_perm_b32 v138, v94, v90, s52
    v_perm_b32 v139, v102, v98, s52
    s_nop 1
    v_mfma_f32_16x16x32_bf16 v[48:51], v[64:67], v[136:139], 0
    v_perm_b32 v140, v78, v74, s53
    v_perm_b32 v141, v86, v82, s53
    v_perm_b32 v142, v94, v90, s53
    v_perm_b32 v143, v102, v98, s53
    s_nop 1
    v_mfma_f32_16x16x32_bf16 v[52:55], v[64:67], v[140:143], 0
    v_perm_b32 v136, v79, v75, s52
    v_perm_b32 v137, v87, v83, s52
    v_perm_b32 v138, v95, v91, s52
    v_perm_b32 v139, v103, v99, s52
    s_nop 1
    v_mfma_f32_16x16x32_bf16 v[56:59], v[64:67], v[136:139], 0
    v_perm_b32 v140, v79, v75, s53
    v_perm_b32 v141, v87, v83, s53
    v_perm_b32 v142, v95, v91, s53
    v_perm_b32 v143, v103, v99, s53
    s_nop 1
    v_mfma_f32_16x16x32_bf16 v[60:63], v[64:67], v[140:143], 0
    s_waitcnt vmcnt(0)
    v_perm_b32 v136, v108, v104, s52
    v_perm_b32 v137, v116, v112, s52
    v_perm_b32 v138, v124, v120, s52
    v_perm_b32 v139, v132, v128, s52
    s_nop 1
    v_mfma_f32_16x16x32_bf16 v[32:35], v[68:71], v[136:139], v[32:35]
    v_perm_b32 v140, v108, v104, s53
    v_perm_b32 v141, v116, v112, s53
    v_perm_b32 v142, v124, v120, s53
    v_perm_b32 v143, v132, v128, s53
    s_nop 1
    v_mfma_f32_16x16x32_bf16 v[36:39], v[68:71], v[140:143], v[36:39]
    v_perm_b32 v136, v109, v105, s52
    v_perm_b32 v137, v117, v113, s52
    v_perm_b32 v138, v125, v121, s52
    v_perm_b32 v139, v133, v129, s52
    s_nop 1
    v_mfma_f32_16x16x32_bf16 v[40:43], v[68:71], v[136:139], v[40:43]
    v_perm_b32 v140, v109, v105, s53
    v_perm_b32 v141, v117, v113, s53
    v_perm_b32 v142, v125, v121, s53
    v_perm_b32 v143, v133, v129, s53
    s_nop 1
    v_mfma_f32_16x16x32_bf16 v[44:47], v[68:71], v[140:143], v[44:47]
    v_perm_b32 v136, v110, v106, s52
    v_perm_b32 v137, v118, v114, s52
    v_perm_b32 v138, v126, v122, s52
    v_perm_b32 v139, v134, v130, s52
    s_nop 1
    v_mfma_f32_16x16x32_bf16 v[48:51], v[68:71], v[136:139], v[48:51]
    v_perm_b32 v140, v110, v106, s53
    v_perm_b32 v141, v118, v114, s53
    v_perm_b32 v142, v126, v122, s53
    v_perm_b32 v143, v134, v130, s53
    s_nop 1
    v_mfma_f32_16x16x32_bf16 v[52:55], v[68:71], v[140:143], v[52:55]
    v_perm_b32 v136, v111, v107, s52
    v_perm_b32 v137, v119, v115, s52
    v_perm_b32 v138, v127, v123, s52
    v_perm_b32 v139, v135, v131, s52
    s_nop 1
    v_mfma_f32_16x16x32_bf16 v[56:59], v[68:71], v[136:139], v[56:59]
    v_perm_b32 v140, v111, v107, s53
    v_perm_b32 v141, v119, v115, s53
    v_perm_b32 v142, v127, v123, s53
    v_perm_b32 v143, v135, v131, s53
    s_nop 1
    v_mfma_f32_16x16x32_bf16 v[60:63], v[68:71], v[140:143], v[60:63]
    s_setprio 3
    s_and_b32 s44, s3, 1
    s_lshl_b32 s44, s44, 12
    s_add_u32 s44, s44, 65536
    v_xor_b32 v4, v7, v5
    v_lshlrev_b32 v4, 4, v4
    v_lshl_add_u32 v4, v5, 8, v4
    v_add_u32 v72, s44, v4
    v_add_u32 v8, 8, v10

    v_xor_b32 v73, 32, v72
    v_xor_b32 v74, 64, v72
    v_xor_b32 v75, 96, v72
    v_xor_b32 v76, 128, v72
    v_xor_b32 v77, 160, v72
    v_xor_b32 v78, 192, v72
    v_xor_b32 v79, 224, v72
    ds_read_b32 v12, v13 offset:32
FW_125:
    s_waitcnt lgkmcnt(0)
    v_cmp_gt_u32 vcc, 2, v12
    s_cbranch_vccz FO_126
    s_sleep 1
    ds_read_b32 v12, v13 offset:32
    s_branch FW_125
FO_126:
    s_add_u32 s45, s78, 0
    s_nop 0
    buffer_load_dwordx4 v[16:19], v160, s[80:83], s45 offen nt
    s_add_u32 s45, s78, 2048
    buffer_load_dwordx4 v[20:23], v160, s[80:83], s45 offen nt
    s_branch IW_s11
IW_w11:
    s_branch IW_r11
IW_s11:
    s_add_u32 s45, s78, 4096
    buffer_load_dwordx4 v[24:27], v160, s[80:83], s45 offen nt
    s_add_u32 s45, s78, 6144
    buffer_load_dwordx4 v[28:31], v160, s[80:83], s45 offen nt
    s_add_u32 s45, s78, 8192
    buffer_load_dwordx4 v[144:147], v160, s[80:83], s45 offen nt
    s_add_u32 s45, s78, 10240
    buffer_load_dwordx4 v[148:151], v160, s[80:83], s45 offen nt
    s_add_u32 s45, s78, 12288
    buffer_load_dwordx4 v[152:155], v160, s[80:83], s45 offen nt
    s_cmp_lt_u32 s3, 2
    s_cbranch_scc1 F_t1
    ds_read_b32 v12, v13 offset:32
FW_127:
    s_waitcnt lgkmcnt(0)
    v_cmp_gt_u32 vcc, 2, v12
    s_cbranch_vccz FO_128
    s_sleep 1
    ds_read_b32 v12, v13 offset:32
    s_branch FW_127
FO_128:
    s_branch F_t2
F_t1:
    ds_read_b32 v12, v8 offset:64
FW_129:
    s_waitcnt lgkmcnt(0)
    v_cmp_gt_u32 vcc, 1, v12
    s_cbranch_vccz FO_130
    s_sleep 1
    ds_read_b32 v12, v8 offset:64
    s_branch FW_129
FO_130:
    s_nop 0
    ds_read_b128 v[80:83], v72 offset:0
    ds_read_b128 v[84:87], v73 offset:512
    ds_read_b128 v[88:91], v74 offset:1024
    ds_read_b128 v[92:95], v75 offset:1536
    ds_read_b128 v[96:99], v76 offset:2048
    ds_read_b128 v[100:103], v77 offset:2560
    ds_read_b128 v[104:107], v78 offset:3072
    ds_read_b128 v[108:111], v79 offset:3584
    s_waitcnt lgkmcnt(7)
    v_add_f32 v32, v32, v80
    v_add_f32 v33, v33, v81
    v_add_f32 v34, v34, v82
    v_add_f32 v35, v35, v83
    s_waitcnt lgkmcnt(6)
    v_add_f32 v36, v36, v84
    v_add_f32 v37, v37, v85
    v_add_f32 v38, v38, v86
    v_add_f32 v39, v39, v87
    s_waitcnt lgkmcnt(5)
    v_add_f32 v40, v40, v88
    v_add_f32 v41, v41, v89
    v_add_f32 v42, v42, v90
    v_add_f32 v43, v43, v91
    s_waitcnt lgkmcnt(4)
    v_add_f32 v44, v44, v92
    v_add_f32 v45, v45, v93
    v_add_f32 v46, v46, v94
    v_add_f32 v47, v47, v95
    s_waitcnt lgkmcnt(3)
    v_add_f32 v48, v48, v96
    v_add_f32 v49, v49, v97
    v_add_f32 v50, v50, v98
    v_add_f32 v51, v51, v99
    s_waitcnt lgkmcnt(2)
    v_add_f32 v52, v52, v100
    v_add_f32 v53, v53, v101
    v_add_f32 v54, v54, v102
    v_add_f32 v55, v55, v103
    s_waitcnt lgkmcnt(1)
    v_add_f32 v56, v56, v104
    v_add_f32 v57, v57, v105
    v_add_f32 v58, v58, v106
    v_add_f32 v59, v59, v107
    s_waitcnt lgkmcnt(0)
    v_add_f32 v60, v60, v108
    v_add_f32 v61, v61, v109
    v_add_f32 v62, v62, v110
    v_add_f32 v63, v63, v111
F_t2:
    s_mov_b32 exec_hi, 0
    s_nop 0
    ds_write_b128 v72, v[32:35] offset:0
    ds_write_b128 v73, v[36:39] offset:512
    ds_write_b128 v74, v[40:43] offset:1024
    ds_write_b128 v75, v[44:47] offset:1536
    ds_write_b128 v76, v[48:51] offset:2048
    ds_write_b128 v77, v[52:55] offset:2560
    ds_write_b128 v78, v[56:59] offset:3072
    ds_write_b128 v79, v[60:63] offset:3584
    s_mov_b64 exec, -1
    v_mov_b32 v4, 1
    s_mov_b64 exec, 1
    ds_write_b32 v10, v4 offset:64
    s_mov_b64 exec, -1
    s_lshl_b32 s44, s3, 2
    v_add_u32 v4, s44, v5
    v_xor_b32 v4, v4, v7
    v_lshlrev_b32 v4, 4, v4
    v_lshl_add_u32 v4, v7, 8, v4
    v_add_u32 v4, 65536, v4
    s_lshl_b32 s44, s3, 10
    s_lshl_b32 s77, s36, 1
    s_add_u32 s77, s77, s37
    s_mul_i32 s77, s77, 114688
    s_lshl_b32 s46, s38, 12
    s_add_u32 s77, s77, s46
    s_add_u32 s77, s77, s44
    s_lshl_b32 s46, s38, 9
    v_mov_b32 v9, 159148
    v_mov_b32 v11, 1

    s_add_u32 s56, s46, 0x829000
    s_add_u32 s56, s72, s56
    s_addc_u32 s57, s73, 0
    ds_read_b32 v12, v13 offset:64
FW_131:
    s_waitcnt lgkmcnt(0)
    v_cmp_gt_u32 vcc, 1, v12
    s_cbranch_vccz FO_132
    ds_read_b32 v12, v13 offset:64
    s_branch FW_131
FO_132:
    ds_read_b128 v[72:75], v4
    ds_read_b128 v[76:79], v4 offset:4096
    s_waitcnt lgkmcnt(0)
    v_add_f32 v72, v72, v76
    v_add_f32 v73, v73, v77
    v_add_f32 v74, v74, v78
    v_add_f32 v75, v75, v79
    buffer_store_dwordx4 v[72:75], v2, s[12:15], s77 offen sc0 sc1
    v_mov_b32 v4, 2
    s_mov_b64 exec, 1
    ds_write_b32 v10, v4 offset:64
    s_mov_b64 exec, -1
    s_waitcnt vmcnt(0)
    s_mov_b64 exec, 1
    ds_add_rtn_u32 v9, v9, v11
    s_waitcnt lgkmcnt(0)
    v_readfirstlane_b32 s44, v9
    s_mov_b64 exec, -1
    s_cmp_lg_u32 s44, 3
    s_cbranch_scc1 F_ad2

    s_mov_b32 s74, 1
    s_atomic_add s74, s[56:57], 0x0
    s_atomic_add s74, s[56:57], 0x80
    s_atomic_add s74, s[56:57], 0x100
    s_atomic_add s74, s[56:57], 0x180
    s_branch F_ad2
F_adown:
    s_add_u32 s45, s78, 0
    buffer_load_dwordx4 v[16:19], v160, s[80:83], s45 offen nt
    s_add_u32 s45, s78, 2048
    buffer_load_dwordx4 v[20:23], v160, s[80:83], s45 offen nt
    s_add_u32 s45, s78, 4096
    buffer_load_dwordx4 v[24:27], v160, s[80:83], s45 offen nt
    s_add_u32 s45, s78, 6144
    buffer_load_dwordx4 v[28:31], v160, s[80:83], s45 offen nt
    s_add_u32 s45, s78, 8192
    buffer_load_dwordx4 v[144:147], v160, s[80:83], s45 offen nt
    s_add_u32 s45, s78, 10240
    buffer_load_dwordx4 v[148:151], v160, s[80:83], s45 offen nt
    s_add_u32 s45, s78, 12288
    buffer_load_dwordx4 v[152:155], v160, s[80:83], s45 offen nt
    v_mov_b32 v4, 2
    s_mov_b64 exec, 1
    ds_write_b32 v10, v4 offset:64
    s_mov_b64 exec, -1
F_ad2:
    s_setprio 3
    v_min_u32 v4, 55, v0
    v_lshlrev_b32 v4, 4, v4
    s_lshl_b32 s38, s47, 5
    s_and_b32 s46, s39, 3
    s_lshr_b32 s44, s47, 7
    s_lshl_b32 s44, s44, 2
    s_add_u32 s44, s44, s46
    s_lshl_b32 s44, s44, 7
    s_add_u32 s45, s47, 111
    s_lshr_b32 s45, s45, 7
    s_lshl_b32 s45, s45, 2
    s_add_u32 s45, s45, s46
    s_lshl_b32 s45, s45, 7
    s_waitcnt lgkmcnt(0)

    s_add_u32 s56, s44, 0x829000
    s_add_u32 s56, s72, s56
    s_addc_u32 s57, s73, 0
    s_add_u32 s58, s45, 0x829000
    s_add_u32 s58, s72, s58
    s_addc_u32 s59, s73, 0
    v_mov_b32 v156, 0
    v_mov_b32 v157, 0
    v_mov_b32 v158, 0
    v_mov_b32 v159, 0
    s_mov_b32 s48, 0xbfb8aa3b
    ds_read_b32 v12, v13 offset:0
FW_133:
    s_waitcnt lgkmcnt(0)
    v_cmp_gt_u32 vcc, 4, v12
    s_cbranch_vccz FO_134
    s_sleep 1
    ds_read_b32 v12, v13 offset:0
    s_branch FW_133
FO_134:
    ds_read_b32 v12, v13 offset:64
FW_135:
    s_waitcnt lgkmcnt(0)
    v_cmp_gt_u32 vcc, 2, v12
    s_cbranch_vccz FO_136
    s_sleep 1
    ds_read_b32 v12, v13 offset:64
    s_branch FW_135
FO_136:
    ds_read_b32 v12, v13 offset:32
FW_137:
    s_waitcnt lgkmcnt(0)
    v_cmp_gt_u32 vcc, 2, v12
    s_cbranch_vccz FO_138
    s_sleep 1
    ds_read_b32 v12, v13 offset:32
    s_branch FW_137
FO_138:
    s_mov_b32 s44, s75
    v_lshlrev_b32 v9, 3, v0
    v_add_u32 v9, s44, v9
    ds_write_b64 v9, v[156:157]
    v_lshrrev_b32 v11, 1, v0
    v_mul_u32_u24 v9, 37, v11
    v_lshrrev_b32 v9, 8, v9
    v_add_u32 v11, v11, v9
    v_lshlrev_b32 v11, 1, v11
    v_and_b32 v9, 1, v0
    v_lshl_add_u32 v11, v9, 8, v11
    v_add_u32 v11, s44, v11
    v_and_b32 v9, 7, v0
    v_lshlrev_b32 v9, 6, v9
    v_lshl_add_u32 v9, v5, 4, v9
    v_add_u32 v9, s44, v9

    s_cmp_lg_u32 s3, 0
    s_cbranch_scc1 F_pp
SP_139:
    s_load_dword s76, s[56:57], 0 glc
    s_waitcnt lgkmcnt(0)
    s_cmp_ge_u32 s76, 8
    s_cbranch_scc1 SD_140
    s_sleep 2
    s_branch SP_139
SD_140:
SP_141:
    s_load_dword s76, s[58:59], 0 glc
    s_waitcnt lgkmcnt(0)
    s_cmp_ge_u32 s76, 8
    s_cbranch_scc1 SD_142
    s_sleep 2
    s_branch SP_141
SD_142:
    v_mov_b32 v12, 3
    s_mov_b64 exec, 1
    ds_write_b32 v10, v12 offset:64
    s_mov_b64 exec, -1
F_pp:
    v_mov_b32 v8, 159104
    ds_read_b32 v12, v8 offset:0
FW_143:
    s_waitcnt lgkmcnt(0)
    v_cmp_gt_u32 vcc, 3, v12
    s_cbranch_vccz FO_144
    s_sleep 1
    ds_read_b32 v12, v8 offset:0
    s_branch FW_143
FO_144:
    s_add_u32 s45, s38, 0
    buffer_load_dwordx4 v[32:35], v4, s[12:15], s45 offen sc0 sc1
    s_add_u32 s45, s38, 114688
    buffer_load_dwordx4 v[36:39], v4, s[12:15], s45 offen sc0 sc1
    s_add_u32 s45, s38, 229376
    buffer_load_dwordx4 v[40:43], v4, s[12:15], s45 offen sc0 sc1
    s_add_u32 s45, s38, 344064
    buffer_load_dwordx4 v[44:47], v4, s[12:15], s45 offen sc0 sc1
    s_add_u32 s45, s38, 458752
    buffer_load_dwordx4 v[48:51], v4, s[12:15], s45 offen sc0 sc1
    s_add_u32 s45, s38, 573440
    buffer_load_dwordx4 v[52:55], v4, s[12:15], s45 offen sc0 sc1
    s_add_u32 s45, s38, 688128
    buffer_load_dwordx4 v[56:59], v4, s[12:15], s45 offen sc0 sc1
    s_add_u32 s45, s38, 802816
    buffer_load_dwordx4 v[60:63], v4, s[12:15], s45 offen sc0 sc1
    s_waitcnt vmcnt(0)
    v_add_f32 v32, v32, v40
    v_add_f32 v48, v48, v56
    v_add_f32 v33, v33, v41
    v_add_f32 v49, v49, v57
    v_add_f32 v34, v34, v42
    v_add_f32 v50, v50, v58
    v_add_f32 v35, v35, v43
    v_add_f32 v51, v51, v59
    v_add_f32 v32, v32, v48
    v_add_f32 v33, v33, v49
    v_add_f32 v34, v34, v50
    v_add_f32 v35, v35, v51
    v_add_f32 v36, v36, v44
    v_add_f32 v52, v52, v60
    v_add_f32 v37, v37, v45
    v_add_f32 v53, v53, v61
    v_add_f32 v38, v38, v46
    v_add_f32 v54, v54, v62
    v_add_f32 v39, v39, v47
    v_add_f32 v55, v55, v63
    v_add_f32 v36, v36, v52
    v_add_f32 v37, v37, v53
    v_add_f32 v38, v38, v54
    v_add_f32 v39, v39, v55
    v_cvt_pk_bf16_f32 v40, v32, v36
    v_cvt_pk_bf16_f32 v41, v33, v37
    v_cvt_pk_bf16_f32 v42, v34, v38
    v_cvt_pk_bf16_f32 v43, v35, v39
    v_lshlrev_b32 v32, 16, v40
    v_and_b32 v36, 0xffff0000, v40
    v_lshlrev_b32 v33, 16, v41
    v_and_b32 v37, 0xffff0000, v41
    v_lshlrev_b32 v34, 16, v42
    v_and_b32 v38, 0xffff0000, v42
    v_lshlrev_b32 v35, 16, v43
    v_and_b32 v39, 0xffff0000, v43
    v_mul_f32 v40, s48, v32
    v_mul_f32 v41, s48, v33
    v_mul_f32 v42, s48, v34
    v_mul_f32 v43, s48, v35
    v_exp_f32 v40, v40
    v_exp_f32 v41, v41
    v_exp_f32 v42, v42
    v_exp_f32 v43, v43
    v_add_f32 v40, 1.0, v40
    v_add_f32 v41, 1.0, v41
    v_add_f32 v42, 1.0, v42
    v_add_f32 v43, 1.0, v43
    v_rcp_f32 v40, v40
    v_rcp_f32 v41, v41
    v_rcp_f32 v42, v42
    v_rcp_f32 v43, v43
    v_mul_f32 v32, v32, v40
    v_mul_f32 v33, v33, v41
    v_mul_f32 v34, v34, v42
    v_mul_f32 v35, v35, v43
    v_cvt_pk_bf16_f32 v32, v32, v32
    v_cvt_pk_bf16_f32 v33, v33, v33
    v_cvt_pk_bf16_f32 v34, v34, v34
    v_cvt_pk_bf16_f32 v35, v35, v35
    v_lshlrev_b32 v32, 16, v32
    v_lshlrev_b32 v33, 16, v33
    v_lshlrev_b32 v34, 16, v34
    v_lshlrev_b32 v35, 16, v35
    v_mul_f32 v32, v32, v36
    v_mul_f32 v33, v33, v37
    v_mul_f32 v34, v34, v38
    v_mul_f32 v35, v35, v39
    v_cvt_pk_bf16_f32 v32, v32, v32
    v_cvt_pk_bf16_f32 v33, v33, v33
    v_cvt_pk_bf16_f32 v34, v34, v34
    v_cvt_pk_bf16_f32 v35, v35, v35
    v_cmp_gt_u32 vcc, 56, v0
    s_nop 0
    s_and_saveexec_b64 s[44:45], vcc
    ds_write_b16 v11, v32 offset:0
    ds_write_b16 v11, v33 offset:64
    ds_write_b16 v11, v34 offset:128
    ds_write_b16 v11, v35 offset:192
    s_mov_b64 exec, s[44:45]
    ds_read_b128 v[64:67], v9
    s_waitcnt lgkmcnt(0)
    v_perm_b32 v136, v20, v16, s52
    v_perm_b32 v137, v28, v24, s52
    v_perm_b32 v138, v148, v144, s52
    v_perm_b32 v139, v156, v152, s52
    s_nop 1
    v_mfma_f32_16x16x32_bf16 v[104:107], v[64:67], v[136:139], 0
    v_perm_b32 v140, v20, v16, s53
    v_perm_b32 v141, v28, v24, s53
    v_perm_b32 v142, v148, v144, s53
    v_perm_b32 v143, v156, v152, s53
    s_nop 1
    v_mfma_f32_16x16x32_bf16 v[108:111], v[64:67], v[140:143], 0
    v_perm_b32 v136, v21, v17, s52
    v_perm_b32 v137, v29, v25, s52
    v_perm_b32 v138, v149, v145, s52
    v_perm_b32 v139, v157, v153, s52
    s_nop 1
    v_mfma_f32_16x16x32_bf16 v[112:115], v[64:67], v[136:139], 0
    v_perm_b32 v140, v21, v17, s53
    v_perm_b32 v141, v29, v25, s53
    v_perm_b32 v142, v149, v145, s53
    v_perm_b32 v143, v157, v153, s53
    s_nop 1
    v_mfma_f32_16x16x32_bf16 v[116:119], v[64:67], v[140:143], 0
    v_perm_b32 v136, v22, v18, s52
    v_perm_b32 v137, v30, v26, s52
    v_perm_b32 v138, v150, v146, s52
    v_perm_b32 v139, v158, v154, s52
    s_nop 1
    v_mfma_f32_16x16x32_bf16 v[120:123], v[64:67], v[136:139], 0
    v_perm_b32 v140, v22, v18, s53
    v_perm_b32 v141, v30, v26, s53
    v_perm_b32 v142, v150, v146, s53
    v_perm_b32 v143, v158, v154, s53
    s_nop 1
    v_mfma_f32_16x16x32_bf16 v[124:127], v[64:67], v[140:143], 0
    v_perm_b32 v136, v23, v19, s52
    v_perm_b32 v137, v31, v27, s52
    v_perm_b32 v138, v151, v147, s52
    v_perm_b32 v139, v159, v155, s52
    s_nop 1
    v_mfma_f32_16x16x32_bf16 v[128:131], v[64:67], v[136:139], 0
    v_perm_b32 v140, v23, v19, s53
    v_perm_b32 v141, v31, v27, s53
    v_perm_b32 v142, v151, v147, s53
    v_perm_b32 v143, v159, v155, s53
    s_nop 1
    v_mfma_f32_16x16x32_bf16 v[132:135], v[64:67], v[140:143], 0
    s_mov_b32 s44, s75
    v_and_b32 v4, 1, v5
    v_lshlrev_b32 v4, 11, v4
    v_lshl_add_u32 v4, v7, 5, v4
    v_lshrrev_b32 v8, 1, v5
    v_lshl_add_u32 v4, v8, 4, v4
    v_add_u32 v4, s44, v4
    v_cmp_gt_u32 vcc, 32, v0

    s_nop 1
    v_cndmask_b32 v72, v120, v104, vcc
    v_cndmask_b32 v73, v124, v108, vcc
    v_cndmask_b32 v74, v128, v112, vcc
    v_cndmask_b32 v75, v132, v116, vcc
    ds_write_b128 v4, v[72:75] offset:0
    v_cndmask_b32 v76, v121, v105, vcc
    v_cndmask_b32 v77, v125, v109, vcc
    v_cndmask_b32 v78, v129, v113, vcc
    v_cndmask_b32 v79, v133, v117, vcc
    ds_write_b128 v4, v[76:79] offset:512
    v_cndmask_b32 v80, v122, v106, vcc
    v_cndmask_b32 v81, v126, v110, vcc
    v_cndmask_b32 v82, v130, v114, vcc
    v_cndmask_b32 v83, v134, v118, vcc
    ds_write_b128 v4, v[80:83] offset:1024
    v_cndmask_b32 v84, v123, v107, vcc
    v_cndmask_b32 v85, v127, v111, vcc
    v_cndmask_b32 v86, v131, v115, vcc
    v_cndmask_b32 v87, v135, v119, vcc
    ds_write_b128 v4, v[84:87] offset:1536
    v_mov_b32 v4, 1
    s_mov_b64 exec, 1
    ds_write_b32 v10, v4 offset:80
    s_mov_b64 exec, -1
    ds_read_b32 v12, v13 offset:80
FW_145:
    s_waitcnt lgkmcnt(0)
    v_cmp_gt_u32 vcc, 1, v12
    s_cbranch_vccz FO_146
    s_sleep 1
    ds_read_b32 v12, v13 offset:80
    s_branch FW_145
FO_146:
    s_lshl_b32 s44, s3, 10
    s_add_u32 s44, s44, 32768
    v_add_u32_e64 v4, s44, v3
    ds_read_b32 v32, v4 offset:0
    ds_read_b32 v33, v4 offset:256
    ds_read_b32 v34, v4 offset:512
    ds_read_b32 v35, v4 offset:768
    ds_read_b32 v36, v4 offset:4096
    ds_read_b32 v37, v4 offset:4352
    ds_read_b32 v38, v4 offset:4608
    ds_read_b32 v39, v4 offset:4864
    ds_read_b32 v40, v4 offset:32768
    ds_read_b32 v41, v4 offset:33024
    ds_read_b32 v42, v4 offset:33280
    ds_read_b32 v43, v4 offset:33536
    ds_read_b32 v44, v4 offset:36864
    ds_read_b32 v45, v4 offset:37120
    ds_read_b32 v46, v4 offset:37376
    s_waitcnt lgkmcnt(8)
    ds_read_b32 v47, v4 offset:37632
    s_lshl_b32 s44, s3, 13
    s_lshl_b32 s45, s39, 9
    s_add_u32 s44, s44, s45
    s_add_u32 s44, s44, 135168
    s_add_u32 s45, s44, 4096
    s_lshl_b32 s46, s39, 9
    s_waitcnt lgkmcnt(0)

    s_add_u32 s56, s46, 0x845000
    s_add_u32 s56, s72, s56
    s_addc_u32 s57, s73, 0
    v_add_f32 v32, v32, v36
    v_add_f32 v40, v40, v44
    v_add_f32 v33, v33, v37
    v_add_f32 v41, v41, v45
    v_add_f32 v34, v34, v38
    v_add_f32 v42, v42, v46
    v_add_f32 v35, v35, v39
    v_add_f32 v43, v43, v47
    v_add_f32 v32, v32, v40
    buffer_atomic_add_f32 v32, v3, s[24:27], s44 offen offset:0
    v_add_f32 v33, v33, v41
    buffer_atomic_add_f32 v33, v3, s[24:27], s44 offen offset:256
    v_add_f32 v34, v34, v42
    buffer_atomic_add_f32 v34, v3, s[24:27], s45 offen offset:0
    v_add_f32 v35, v35, v43
    buffer_atomic_add_f32 v35, v3, s[24:27], s45 offen offset:256
    v_mov_b32 v4, 159140
    v_mov_b32 v8, 1
    s_waitcnt vmcnt(0)
    s_mov_b64 exec, 1
    ds_add_rtn_u32 v9, v4, v8
    s_waitcnt lgkmcnt(0)
    v_readfirstlane_b32 s44, v9
    s_mov_b64 exec, -1
    s_cmp_lg_u32 s44, 3
    s_cbranch_scc1 F_ye
    s_mov_b32 s44, 1
    s_atomic_add s44, s[56:57], 0
    s_atomic_add s44, s[56:57], 0x80
    s_atomic_add s44, s[56:57], 0x100
    s_atomic_add s44, s[56:57], 0x180
F_ye:

    s_endpgm
F_codeend:
.section .rodata,"a"
.p2align 6
.amdhsa_kernel parallel_sum__linear_attn_block__moe_arch_mod__prompt_kernel
  .amdhsa_next_free_vgpr 168
  .amdhsa_next_free_sgpr 98
  .amdhsa_accum_offset 168
  .amdhsa_group_segment_fixed_size 0
  .amdhsa_kernarg_size 88
  .amdhsa_user_sgpr_count 2
  .amdhsa_user_sgpr_kernarg_segment_ptr 1
  .amdhsa_system_sgpr_workgroup_id_x 1
  .amdhsa_float_denorm_mode_32 3
  .amdhsa_float_denorm_mode_16_64 3
.end_amdhsa_kernel
```

```asm
; @launch grid=(256,1,1) block=(768,1,1) lds=163840
.amdgcn_target "amdgcn-amd-amdhsa--gfx950"
.text
.globl parallel_sum__linear_attn_block__moe_arch_mod__prompt_kernel
.p2align 12
.p2align 8
.type parallel_sum__linear_attn_block__moe_arch_mod__prompt_kernel,@function
parallel_sum__linear_attn_block__moe_arch_mod__prompt_kernel:
    s_load_dwordx4 s[4:7], s[0:1], 0
    s_load_dwordx2 s[8:9], s[0:1], 16
    s_load_dwordx8 s[60:67], s[0:1], 32
    s_load_dwordx4 s[68:71], s[0:1], 64
    s_load_dwordx2 s[72:73], s[0:1], 80
    s_cmp_ge_u32 s2, 256
    s_cbranch_scc1 F_end
    v_lshrrev_b32 v1, 6, v0
    v_and_b32 v0, 63, v0
    s_and_b32 s30, s2, 7
    v_readfirstlane_b32 s3, v1
    s_lshr_b32 s31, s2, 3
    s_and_b32 s36, s30, 1
    s_lshl_b32 s32, s36, 3
    s_and_b32 s35, s31, 7
    s_add_u32 s32, s32, s35
    s_lshr_b32 s37, s30, 1
    s_lshl_b32 s33, s37, 2
    s_lshr_b32 s34, s31, 3
    s_add_u32 s33, s33, s34
    s_add_u32 s10, s33, 0
    s_and_b32 s10, s10, 15
    s_add_u32 s11, s35, s34
    s_and_b32 s11, s11, 3
    s_and_b32 s28, s32, 11
    s_and_b32 s29, s37, 1
    s_lshl_b32 s29, s29, 2
    s_add_u32 s28, s28, s29
    s_lshr_b32 s29, s37, 1
    s_lshl_b32 s29, s29, 3
    s_and_b32 s38, s35, 4
    s_add_u32 s29, s29, s38
    s_add_u32 s38, s34, 1
    s_and_b32 s38, s38, 3
    s_add_u32 s29, s29, s38

    s_lshl_b32 s11, s34, 1
    s_add_u32 s11, s11, s35
    s_and_b32 s11, s11, 7
    s_mul_i32 s89, s36, 8
    s_mul_i32 s38, s37, 2
    s_add_u32 s89, s89, s38

    s_mov_b32 s94, 0x73156420
    s_mov_b32 s95, 0xfb9dea8c
    s_cmp_eq_u32 s11, 1
    s_cselect_b32 s94, 0x62047531, s94
    s_cselect_b32 s95, 0xea8cfb9d, s95
    s_cmp_eq_u32 s11, 2
    s_cselect_b32 s94, 0x53710642, s94
    s_cselect_b32 s95, 0xdbf9cae8, s95
    s_cmp_eq_u32 s11, 3
    s_cselect_b32 s94, 0x42601753, s94
    s_cselect_b32 s95, 0xcae8dbf9, s95
    s_cmp_eq_u32 s11, 4
    s_cselect_b32 s94, 0x58320164, s94
    s_cselect_b32 s95, 0xfdbec9a7, s95
    s_cmp_eq_u32 s11, 5
    s_cselect_b32 s94, 0x49231075, s94
    s_cselect_b32 s95, 0xecafd8b6, s95
    s_cmp_eq_u32 s11, 6
    s_cselect_b32 s94, 0xa5143206, s94
    s_cselect_b32 s95, 0xfd9ebc87, s95
    s_cmp_eq_u32 s11, 7
    s_cselect_b32 s94, 0xb4052317, s94
    s_cselect_b32 s95, 0xec8fad96, s95
    s_cmp_ge_u32 s3, 8
    s_cbranch_scc1 F_aux
    s_cmp_ge_u32 s3, 4
    s_cbranch_scc1 F_nl
    v_lshrrev_b32 v2, 3, v0
    v_and_b32 v3, 7, v0
    v_lshrrev_b32 v4, 1, v2
    v_xor_b32 v5, v3, v4
    v_xor_b32 v6, 4, v5
    v_lshlrev_b32 v5, 4, v5
    v_lshlrev_b32 v6, 4, v6
    v_lshlrev_b32 v7, 11, v2
    v_add_u32 v5, v5, v7
    v_add_u32 v6, v6, v7
    v_and_b32 v4, 1, v4
    v_lshlrev_b32 v4, 1, v4
    v_xor_b32 v8, v3, v4
    v_xor_b32 v9, 4, v8
    v_lshlrev_b32 v8, 4, v8
    v_lshlrev_b32 v9, 4, v9
    v_mul_u32_u24 v7, 6144, v2
    v_add_u32 v8, v8, v7
    v_add_u32 v9, v9, v7
    v_add_u32 v9, 49152, v9
    s_lshl_b32 s36, s32, 18
    s_lshl_b32 s37, s3, 16
    s_add_u32 s36, s36, s37
    s_lshl_b32 s38, s33, 7
    s_mul_i32 s37, s3, 98304
    s_add_u32 s38, s38, s37
    s_lshl_b32 s47, s10, 7
    s_add_u32 s47, s47, s37
    s_lshl_b32 s44, s3, 12
    s_lshl_b32 s45, s3, 11
    s_add_u32 s43, s45, 1024
    s_mov_b32 s14, 4194304
    s_mov_b32 s15, 0x20000
    s_mov_b32 s18, 6291456
    s_mov_b32 s19, 0x20000
    s_waitcnt lgkmcnt(0)
    s_mov_b32 s12, s4
    s_mov_b32 s13, s5
    s_mov_b32 s16, s6
    s_mov_b32 s17, s7

    s_setprio 3
    s_bfe_u32 s40, s94, 0x40000
    s_add_u32 s40, s89, s40
    s_and_b32 s40, s40, 15
    s_mul_i32 s41, s40, 393216
    s_lshl_b32 s40, s40, 7
    s_add_u32 s40, s40, s36
    s_add_u32 s42, s41, s47
    s_add_u32 s41, s41, s38
    s_add_u32 m0, s44, 0
    s_add_u32 s46, s40, 0
    s_nop 0
    buffer_load_dwordx4 v5, s[12:15], s46 offen lds
    s_add_u32 m0, s44, 1024
    s_add_u32 s46, s40, 16384
    buffer_load_dwordx4 v6, s[12:15], s46 offen lds
    s_add_u32 m0, s44, 2048
    s_add_u32 s46, s40, 32768
    buffer_load_dwordx4 v5, s[12:15], s46 offen lds
    s_add_u32 m0, s44, 3072
    s_add_u32 s46, s40, 49152
    buffer_load_dwordx4 v6, s[12:15], s46 offen lds
    s_add_u32 m0, s45, 65536
    s_add_u32 s46, s41, 2048
    buffer_load_dwordx4 v8, s[16:19], s46 offen lds
    s_add_u32 m0, s43, 65536
    s_add_u32 s46, s41, 2048
    buffer_load_dwordx4 v9, s[16:19], s46 offen lds
    s_add_u32 m0, s45, 73728
    s_add_u32 s46, s41, 4096
    buffer_load_dwordx4 v8, s[16:19], s46 offen lds
    s_add_u32 m0, s43, 73728
    s_add_u32 s46, s41, 4096
    buffer_load_dwordx4 v9, s[16:19], s46 offen lds
    s_add_u32 m0, s45, 147456
    s_nop 0
    buffer_load_dwordx4 v8, s[16:19], s42 offen lds
    s_add_u32 m0, s43, 147456
    s_nop 0
    buffer_load_dwordx4 v9, s[16:19], s42 offen lds
    s_bfe_u32 s40, s94, 0x40004
    s_add_u32 s40, s89, s40
    s_and_b32 s40, s40, 15
    s_mul_i32 s41, s40, 393216
    s_lshl_b32 s40, s40, 7
    s_add_u32 s40, s40, s36
    s_add_u32 s42, s41, s47
    s_add_u32 s41, s41, s38
    s_add_u32 m0, s44, 16384
    s_add_u32 s46, s40, 0
    s_nop 0
    buffer_load_dwordx4 v5, s[12:15], s46 offen lds
    s_add_u32 m0, s44, 17408
    s_add_u32 s46, s40, 16384
    buffer_load_dwordx4 v6, s[12:15], s46 offen lds
    s_add_u32 m0, s44, 18432
    s_add_u32 s46, s40, 32768
    buffer_load_dwordx4 v5, s[12:15], s46 offen lds
    s_add_u32 m0, s44, 19456
    s_add_u32 s46, s40, 49152
    buffer_load_dwordx4 v6, s[12:15], s46 offen lds
    s_add_u32 m0, s45, 81920
    s_add_u32 s46, s41, 2048
    buffer_load_dwordx4 v8, s[16:19], s46 offen lds
    s_add_u32 m0, s43, 81920
    s_add_u32 s46, s41, 2048
    buffer_load_dwordx4 v9, s[16:19], s46 offen lds
    v_and_b32 v1, 15, v0
    v_lshrrev_b32 v7, 4, v0
    v_lshrrev_b32 v3, 1, v1
    v_xor_b32 v3, v3, v7
    v_lshlrev_b32 v3, 4, v3
    v_lshlrev_b32 v1, 7, v1
    v_add3_u32 v2, v1, v3, s44
    v_xor_b32 v3, 64, v2
    v_add_u32 v14, 0x10000, v2
    v_add_u32 v15, 0x10000, v3
    v_bfe_u32 v1, v0, 2, 2
    v_lshl_add_u32 v4, v7, 3, v1
    v_lshrrev_b32 v1, 1, v1
    v_and_b32 v7, 1, v7
    v_lshl_add_u32 v1, v7, 1, v1
    v_lshlrev_b32 v1, 5, v1
    v_lshl_add_u32 v1, v4, 7, v1
    v_and_b32 v7, 3, v0
    v_lshl_add_u32 v1, v7, 3, v1
    v_add_u32 v10, 90112, v1
    v_xor_b32 v11, 32, v10
    v_xor_b32 v12, 64, v10
    v_xor_b32 v13, 96, v10
    v_lshlrev_b32 v1, 2, v7
    v_add_u32 v1, 159040, v1
    s_lshl_b32 s50, s3, 2
    s_add_u32 s50, s50, 159040
    v_mov_b32 v4, s50
    v_mov_b32 v164, 1

    s_waitcnt vmcnt(8)
    s_barrier
    s_nop 0
    s_add_u32 m0, s45, 90112
    s_add_u32 s46, s41, 4096
    buffer_load_dwordx4 v8, s[16:19], s46 offen lds
    ds_read_b128 v[48:51], v2 offset:0
    s_add_u32 m0, s43, 90112
    s_add_u32 s46, s41, 4096
    buffer_load_dwordx4 v9, s[16:19], s46 offen lds
    ds_read_b128 v[52:55], v2 offset:2048
    s_bfe_u32 s40, s94, 0x40008
    s_add_u32 s40, s89, s40
    s_and_b32 s40, s40, 15
    s_mul_i32 s41, s40, 393216
    s_lshl_b32 s40, s40, 7
    s_add_u32 s40, s40, s36
    s_add_u32 s42, s41, s47
    s_add_u32 s41, s41, s38
    s_add_u32 m0, s44, 32768
    s_add_u32 s46, s40, 0
    s_nop 0
    buffer_load_dwordx4 v5, s[12:15], s46 offen lds
    ds_read_b128 v[56:59], v3 offset:0
    s_add_u32 m0, s44, 33792
    s_add_u32 s46, s40, 16384
    buffer_load_dwordx4 v6, s[12:15], s46 offen lds
    ds_read_b128 v[60:63], v3 offset:2048
    s_add_u32 m0, s44, 34816
    s_add_u32 s46, s40, 32768
    buffer_load_dwordx4 v5, s[12:15], s46 offen lds
    s_add_u32 m0, s44, 35840
    s_add_u32 s46, s40, 49152
    buffer_load_dwordx4 v6, s[12:15], s46 offen lds
    s_add_u32 m0, s45, 98304
    s_add_u32 s46, s41, 2048
    buffer_load_dwordx4 v8, s[16:19], s46 offen lds
    s_add_u32 m0, s43, 98304
    s_add_u32 s46, s41, 2048
    buffer_load_dwordx4 v9, s[16:19], s46 offen lds
    s_add_u32 m0, s45, 106496
    s_add_u32 s46, s41, 4096
    buffer_load_dwordx4 v8, s[16:19], s46 offen lds
    s_add_u32 m0, s43, 106496
    s_add_u32 s46, s41, 4096
    buffer_load_dwordx4 v9, s[16:19], s46 offen lds
    s_bfe_u32 s40, s94, 0x40004
    s_add_u32 s40, s89, s40
    s_and_b32 s40, s40, 15
    s_mul_i32 s41, s40, 393216
    s_lshl_b32 s40, s40, 7
    s_add_u32 s40, s40, s36
    s_add_u32 s42, s41, s47
    s_add_u32 s41, s41, s38
    s_add_u32 m0, s45, 139264
    s_nop 0
    buffer_load_dwordx4 v8, s[16:19], s42 offen lds
    s_waitcnt vmcnt(9) lgkmcnt(0)
    s_barrier
    s_add_u32 m0, s43, 139264
    s_nop 0
    buffer_load_dwordx4 v9, s[16:19], s42 offen lds
    ds_read_b64_tr_b16 v[64:65], v10 offset:57344
    ds_read_b64_tr_b16 v[66:67], v10 offset:57856
    s_lshl_b32 s51, s32, 4
    s_add_u32 s51, s51, s33
    s_lshl_b32 s51, s51, 14
    s_add_u32 s51, s51, s45
    v_lshlrev_b32 v165, 4, v0
    s_mov_b32 s20, s60
    s_mov_b32 s21, s61
    s_mov_b32 s22, 0x800
    s_mov_b32 s23, 0x00020000
    s_add_u32 m0, s45, 114688
    s_add_u32 s46, s51, 0
    buffer_load_dwordx4 v165, s[12:15], s46 offen lds
    ds_read_b128 v[68:71], v2 offset:16384
    s_add_u32 m0, s45, 115712
    s_add_u32 s46, s51, 1024
    buffer_load_dwordx4 v165, s[12:15], s46 offen lds
    ds_read_b64_tr_b16 v[72:73], v11 offset:57344
    ds_read_b64_tr_b16 v[74:75], v11 offset:57856
    s_and_b32 s46, s3, 1
    s_lshl_b32 s46, s46, 10
    s_add_u32 m0, s46, 161792
    s_nop 0
    s_nop 0
    buffer_load_dwordx4 v165, s[20:23], s46 offen lds
    ds_read_b128 v[76:79], v2 offset:18432
    s_add_u32 m0, s45, 122880
    s_add_u32 s46, s51, 8192
    buffer_load_dwordx4 v165, s[12:15], s46 offen lds
    ds_read_b64_tr_b16 v[80:81], v12 offset:57344
    ds_read_b64_tr_b16 v[82:83], v12 offset:57856
    s_add_u32 m0, s45, 123904
    s_add_u32 s46, s51, 9216
    buffer_load_dwordx4 v165, s[12:15], s46 offen lds
    ds_read_b128 v[84:87], v3 offset:16384
    s_bfe_u32 s40, s94, 0x4000c
    s_add_u32 s40, s89, s40
    s_and_b32 s40, s40, 15
    s_mul_i32 s41, s40, 393216
    s_lshl_b32 s40, s40, 7
    s_add_u32 s40, s40, s36
    s_add_u32 s42, s41, s47
    s_add_u32 s41, s41, s38
    s_add_u32 m0, s44, 49152
    s_add_u32 s46, s40, 0
    s_nop 0
    buffer_load_dwordx4 v5, s[12:15], s46 offen lds
    ds_read_b64_tr_b16 v[88:89], v13 offset:57344
    ds_read_b64_tr_b16 v[90:91], v13 offset:57856
    s_add_u32 m0, s44, 50176
    s_add_u32 s46, s40, 16384
    buffer_load_dwordx4 v6, s[12:15], s46 offen lds
    ds_read_b128 v[92:95], v3 offset:18432
    s_add_u32 m0, s44, 51200
    s_add_u32 s46, s40, 32768
    buffer_load_dwordx4 v5, s[12:15], s46 offen lds
    s_add_u32 m0, s44, 52224
    s_add_u32 s46, s40, 49152
    buffer_load_dwordx4 v6, s[12:15], s46 offen lds
    s_add_u32 m0, s45, 131072
    s_add_u32 s46, s41, 2048
    buffer_load_dwordx4 v8, s[16:19], s46 offen lds
    s_waitcnt vmcnt(10) lgkmcnt(0)
    s_barrier
    s_add_u32 m0, s43, 131072
    s_add_u32 s46, s41, 2048
    buffer_load_dwordx4 v9, s[16:19], s46 offen lds
    v_mfma_f32_16x16x32_bf16 v[16:19], v[64:67], v[48:51], 0
    ds_read_b64_tr_b16 v[96:97], v10 offset:61440
    ds_read_b64_tr_b16 v[98:99], v10 offset:61952
    s_add_u32 m0, s45, 65536
    s_add_u32 s46, s41, 4096
    buffer_load_dwordx4 v8, s[16:19], s46 offen lds
    v_mfma_f32_16x16x32_bf16 v[32:35], v[64:67], v[52:55], 0
    ds_read_b128 v[100:103], v2 offset:32768
    s_add_u32 m0, s43, 65536
    s_add_u32 s46, s41, 4096
    buffer_load_dwordx4 v9, s[16:19], s46 offen lds
    v_mfma_f32_16x16x32_bf16 v[20:23], v[72:75], v[48:51], 0
    ds_read_b64_tr_b16 v[104:105], v11 offset:61440
    ds_read_b64_tr_b16 v[106:107], v11 offset:61952
    s_bfe_u32 s40, s94, 0x40008
    s_add_u32 s40, s89, s40
    s_and_b32 s40, s40, 15
    s_mul_i32 s41, s40, 393216
    s_lshl_b32 s40, s40, 7
    s_add_u32 s40, s40, s36
    s_add_u32 s42, s41, s47
    s_add_u32 s41, s41, s38
    s_add_u32 m0, s45, 90112
    s_nop 0
    buffer_load_dwordx4 v8, s[16:19], s42 offen lds
    v_mfma_f32_16x16x32_bf16 v[36:39], v[72:75], v[52:55], 0
    ds_read_b128 v[108:111], v2 offset:34816
    s_add_u32 m0, s43, 90112
    s_nop 0
    buffer_load_dwordx4 v9, s[16:19], s42 offen lds
    v_mfma_f32_16x16x32_bf16 v[24:27], v[80:83], v[48:51], 0
    ds_read_b64_tr_b16 v[112:113], v12 offset:61440
    ds_read_b64_tr_b16 v[114:115], v12 offset:61952
    s_bfe_u32 s40, s94, 0x40010
    s_add_u32 s40, s89, s40
    s_and_b32 s40, s40, 15
    s_mul_i32 s41, s40, 393216
    s_lshl_b32 s40, s40, 7
    s_add_u32 s40, s40, s36
    s_add_u32 s42, s41, s47
    s_add_u32 s41, s41, s38
    s_add_u32 m0, s44, 0
    s_add_u32 s46, s40, 0
    buffer_load_dwordx4 v5, s[12:15], s46 offen lds
    v_mfma_f32_16x16x32_bf16 v[40:43], v[80:83], v[52:55], 0
    ds_read_b128 v[116:119], v3 offset:32768
    s_add_u32 m0, s44, 1024
    s_add_u32 s46, s40, 16384
    buffer_load_dwordx4 v6, s[12:15], s46 offen lds
    v_mfma_f32_16x16x32_bf16 v[28:31], v[88:91], v[48:51], 0
    ds_read_b64_tr_b16 v[120:121], v13 offset:61440
    ds_read_b64_tr_b16 v[122:123], v13 offset:61952
    s_add_u32 m0, s44, 2048
    s_add_u32 s46, s40, 32768
    buffer_load_dwordx4 v5, s[12:15], s46 offen lds
    v_mfma_f32_16x16x32_bf16 v[44:47], v[88:91], v[52:55], 0
    ds_read_b128 v[124:127], v3 offset:34816
    s_add_u32 m0, s44, 3072
    s_add_u32 s46, s40, 49152
    buffer_load_dwordx4 v6, s[12:15], s46 offen lds
    ds_read_b64_tr_b16 v[128:129], v10 offset:49152
    ds_read_b64_tr_b16 v[130:131], v10 offset:49664
    s_add_u32 m0, s45, 73728
    s_add_u32 s46, s41, 2048
    buffer_load_dwordx4 v8, s[16:19], s46 offen lds
    ds_read_b64_tr_b16 v[132:133], v11 offset:49152
    s_waitcnt lgkmcnt(8)
    s_nop 0
    ds_read_b64_tr_b16 v[134:135], v11 offset:49664
    s_add_u32 m0, s43, 73728
    s_add_u32 s46, s41, 2048
    buffer_load_dwordx4 v9, s[16:19], s46 offen lds
    ds_read_b64_tr_b16 v[136:137], v12 offset:49152
    ds_read_b64_tr_b16 v[138:139], v12 offset:49664
    ds_read_b64_tr_b16 v[140:141], v13 offset:49152
    ds_read_b64_tr_b16 v[142:143], v13 offset:49664
    s_waitcnt vmcnt(6) lgkmcnt(0)
    s_barrier
    s_add_u32 m0, s45, 81920
    s_add_u32 s46, s41, 4096
    buffer_load_dwordx4 v8, s[16:19], s46 offen lds
    v_mfma_f32_16x16x32_bf16 v[16:19], v[96:99], v[56:59], v[16:19]
    ds_read_b64_tr_b16 v[144:145], v10 offset:53248
    ds_read_b64_tr_b16 v[146:147], v10 offset:53760
    s_add_u32 m0, s43, 81920
    s_add_u32 s46, s41, 4096
    buffer_load_dwordx4 v9, s[16:19], s46 offen lds
    v_mfma_f32_16x16x32_bf16 v[32:35], v[96:99], v[60:63], v[32:35]
    ds_read_b128 v[148:151], v2 offset:49152
    s_bfe_u32 s40, s94, 0x40014
    s_add_u32 s40, s89, s40
    s_and_b32 s40, s40, 15
    s_mul_i32 s41, s40, 393216
    s_lshl_b32 s40, s40, 7
    s_add_u32 s40, s40, s36
    s_add_u32 s42, s41, s47
    s_add_u32 s41, s41, s38
    s_add_u32 m0, s44, 16384
    s_add_u32 s46, s40, 0
    s_nop 0
    buffer_load_dwordx4 v5, s[12:15], s46 offen lds
    v_mfma_f32_16x16x32_bf16 v[20:23], v[104:107], v[56:59], v[20:23]
    ds_read_b64_tr_b16 v[152:153], v11 offset:53248
    ds_read_b64_tr_b16 v[154:155], v11 offset:53760
    s_add_u32 m0, s44, 17408
    s_add_u32 s46, s40, 16384
    buffer_load_dwordx4 v6, s[12:15], s46 offen lds
    v_mfma_f32_16x16x32_bf16 v[36:39], v[104:107], v[60:63], v[36:39]
    ds_read_b128 v[156:159], v2 offset:51200
    s_add_u32 m0, s44, 18432
    s_add_u32 s46, s40, 32768
    buffer_load_dwordx4 v5, s[12:15], s46 offen lds
    v_mfma_f32_16x16x32_bf16 v[24:27], v[112:115], v[56:59], v[24:27]
    ds_read_b64_tr_b16 v[160:161], v12 offset:53248
    ds_read_b64_tr_b16 v[162:163], v12 offset:53760
    s_add_u32 m0, s44, 19456
    s_add_u32 s46, s40, 49152
    buffer_load_dwordx4 v6, s[12:15], s46 offen lds
    v_mfma_f32_16x16x32_bf16 v[40:43], v[112:115], v[60:63], v[40:43]
    ds_read_b128 v[64:67], v3 offset:49152
    s_add_u32 m0, s45, 98304
    s_add_u32 s46, s41, 2048
    buffer_load_dwordx4 v8, s[16:19], s46 offen lds
    v_mfma_f32_16x16x32_bf16 v[28:31], v[120:123], v[56:59], v[28:31]
    ds_read_b64_tr_b16 v[72:73], v13 offset:53248
    ds_read_b64_tr_b16 v[74:75], v13 offset:53760
    s_add_u32 m0, s43, 98304
    s_add_u32 s46, s41, 2048
    buffer_load_dwordx4 v9, s[16:19], s46 offen lds
    v_mfma_f32_16x16x32_bf16 v[44:47], v[120:123], v[60:63], v[44:47]
    ds_read_b128 v[80:83], v3 offset:51200
    s_add_u32 m0, s45, 106496
    s_add_u32 s46, s41, 4096
    buffer_load_dwordx4 v8, s[16:19], s46 offen lds
    v_mfma_f32_16x16x32_bf16 v[16:19], v[128:131], v[68:71], v[16:19]
    ds_read_b64_tr_b16 v[48:49], v10 offset:0
    ds_read_b64_tr_b16 v[50:51], v10 offset:512
    s_add_u32 m0, s43, 106496
    s_add_u32 s46, s41, 4096
    buffer_load_dwordx4 v9, s[16:19], s46 offen lds
    v_mfma_f32_16x16x32_bf16 v[32:35], v[128:131], v[76:79], v[32:35]
    ds_read_b64_tr_b16 v[88:89], v11 offset:0
    s_waitcnt lgkmcnt(8)
    ds_read_b64_tr_b16 v[90:91], v11 offset:512
    s_bfe_u32 s40, s94, 0x4000c
    s_add_u32 s40, s89, s40
    s_and_b32 s40, s40, 15
    s_mul_i32 s41, s40, 393216
    s_lshl_b32 s40, s40, 7
    s_add_u32 s40, s40, s36
    s_add_u32 s42, s41, s47
    s_add_u32 s41, s41, s38
    s_add_u32 m0, s45, 147456
    s_nop 0
    buffer_load_dwordx4 v8, s[16:19], s42 offen lds
    v_mfma_f32_16x16x32_bf16 v[20:23], v[132:135], v[68:71], v[20:23]
    ds_read_b64_tr_b16 v[52:53], v12 offset:0
    ds_read_b64_tr_b16 v[54:55], v12 offset:512
    v_mfma_f32_16x16x32_bf16 v[36:39], v[132:135], v[76:79], v[36:39]
    ds_read_b64_tr_b16 v[96:97], v13 offset:0
    ds_read_b64_tr_b16 v[98:99], v13 offset:512
    v_mfma_f32_16x16x32_bf16 v[24:27], v[136:139], v[68:71], v[24:27]
    v_mfma_f32_16x16x32_bf16 v[40:43], v[136:139], v[76:79], v[40:43]
    v_mfma_f32_16x16x32_bf16 v[28:31], v[140:143], v[68:71], v[28:31]
    v_mfma_f32_16x16x32_bf16 v[44:47], v[140:143], v[76:79], v[44:47]
    s_waitcnt vmcnt(9) lgkmcnt(0)
    s_barrier
    s_add_u32 m0, s43, 147456
    s_nop 0
    buffer_load_dwordx4 v9, s[16:19], s42 offen lds
    v_mfma_f32_16x16x32_bf16 v[16:19], v[144:147], v[84:87], v[16:19]
    ds_read_b64_tr_b16 v[104:105], v10 offset:4096
    ds_read_b64_tr_b16 v[106:107], v10 offset:4608
    s_bfe_u32 s40, s94, 0x40018
    s_add_u32 s40, s89, s40
    s_and_b32 s40, s40, 15
    s_mul_i32 s41, s40, 393216
    s_lshl_b32 s40, s40, 7
    s_add_u32 s40, s40, s36
    s_add_u32 s42, s41, s47
    s_add_u32 s41, s41, s38
    s_add_u32 m0, s44, 32768
    s_add_u32 s46, s40, 0
    buffer_load_dwordx4 v5, s[12:15], s46 offen lds
    s_branch IW_s0
IW_w0:
    s_branch IW_r0
IW_s0:
    v_mfma_f32_16x16x32_bf16 v[32:35], v[144:147], v[92:95], v[32:35]
    ds_read_b128 v[112:115], v2 offset:0
    s_add_u32 m0, s44, 33792
    s_add_u32 s46, s40, 16384
    buffer_load_dwordx4 v6, s[12:15], s46 offen lds
    v_mfma_f32_16x16x32_bf16 v[20:23], v[152:155], v[84:87], v[20:23]
    ds_read_b64_tr_b16 v[56:57], v11 offset:4096
    ds_read_b64_tr_b16 v[58:59], v11 offset:4608
    s_add_u32 m0, s44, 34816
    s_add_u32 s46, s40, 32768
    buffer_load_dwordx4 v5, s[12:15], s46 offen lds
    v_mfma_f32_16x16x32_bf16 v[36:39], v[152:155], v[92:95], v[36:39]
    ds_read_b128 v[120:123], v2 offset:2048
    s_add_u32 m0, s44, 35840
    s_add_u32 s46, s40, 49152
    buffer_load_dwordx4 v6, s[12:15], s46 offen lds
    v_mfma_f32_16x16x32_bf16 v[24:27], v[160:163], v[84:87], v[24:27]
    ds_read_b64_tr_b16 v[60:61], v12 offset:4096
    ds_read_b64_tr_b16 v[62:63], v12 offset:4608
    s_add_u32 m0, s45, 65536
    s_add_u32 s46, s41, 2048
    buffer_load_dwordx4 v8, s[16:19], s46 offen lds
    v_mfma_f32_16x16x32_bf16 v[40:43], v[160:163], v[92:95], v[40:43]
    ds_read_b128 v[128:131], v3 offset:0
    s_add_u32 m0, s43, 65536
    s_add_u32 s46, s41, 2048
    buffer_load_dwordx4 v9, s[16:19], s46 offen lds
    v_mfma_f32_16x16x32_bf16 v[28:31], v[72:75], v[84:87], v[28:31]
    ds_read_b64_tr_b16 v[132:133], v13 offset:4096
    ds_read_b64_tr_b16 v[134:135], v13 offset:4608
    s_add_u32 m0, s45, 114688
    s_add_u32 s46, s41, 4096
    buffer_load_dwordx4 v8, s[16:19], s46 offen lds
    v_mfma_f32_16x16x32_bf16 v[44:47], v[72:75], v[92:95], v[44:47]
    ds_read_b128 v[136:139], v3 offset:2048
    s_add_u32 m0, s43, 114688
    s_add_u32 s46, s41, 4096
    buffer_load_dwordx4 v9, s[16:19], s46 offen lds
    v_mfma_f32_16x16x32_bf16 v[16:19], v[48:51], v[100:103], v[16:19]
    s_bfe_u32 s40, s94, 0x4001c
    s_add_u32 s40, s89, s40
    s_and_b32 s40, s40, 15
    s_mul_i32 s41, s40, 393216
    s_lshl_b32 s40, s40, 7
    s_add_u32 s40, s40, s36
    s_add_u32 s42, s41, s47
    s_add_u32 s41, s41, s38
    s_add_u32 m0, s44, 49152
    s_add_u32 s46, s40, 0
    s_nop 0
    buffer_load_dwordx4 v5, s[12:15], s46 offen lds
    v_mfma_f32_16x16x32_bf16 v[32:35], v[48:51], v[108:111], v[32:35]
    s_add_u32 m0, s44, 50176
    s_add_u32 s46, s40, 16384
    buffer_load_dwordx4 v6, s[12:15], s46 offen lds
    v_mfma_f32_16x16x32_bf16 v[20:23], v[88:91], v[100:103], v[20:23]
    v_mfma_f32_16x16x32_bf16 v[36:39], v[88:91], v[108:111], v[36:39]
    v_mfma_f32_16x16x32_bf16 v[24:27], v[52:55], v[100:103], v[24:27]
    v_mfma_f32_16x16x32_bf16 v[40:43], v[52:55], v[108:111], v[40:43]
    v_mfma_f32_16x16x32_bf16 v[28:31], v[96:99], v[100:103], v[28:31]
    v_mfma_f32_16x16x32_bf16 v[44:47], v[96:99], v[108:111], v[44:47]
    s_waitcnt vmcnt(10) lgkmcnt(0)
    s_barrier
    s_add_u32 m0, s44, 51200
    s_add_u32 s46, s40, 32768
    buffer_load_dwordx4 v5, s[12:15], s46 offen lds
    v_mfma_f32_16x16x32_bf16 v[16:19], v[104:107], v[116:119], v[16:19]
    ds_read_b64_tr_b16 v[68:69], v10 offset:57344
    ds_read_b64_tr_b16 v[70:71], v10 offset:57856
    s_add_u32 m0, s44, 52224
    s_add_u32 s46, s40, 49152
    buffer_load_dwordx4 v6, s[12:15], s46 offen lds
    v_mfma_f32_16x16x32_bf16 v[32:35], v[104:107], v[124:127], v[32:35]
    ds_read_b128 v[140:143], v2 offset:16384
    s_add_u32 m0, s45, 122880
    s_add_u32 s46, s41, 2048
    buffer_load_dwordx4 v8, s[16:19], s46 offen lds
    v_mfma_f32_16x16x32_bf16 v[20:23], v[56:59], v[116:119], v[20:23]
    ds_read_b64_tr_b16 v[76:77], v11 offset:57344
    ds_read_b64_tr_b16 v[78:79], v11 offset:57856
    s_add_u32 m0, s43, 122880
    s_add_u32 s46, s41, 2048
    buffer_load_dwordx4 v9, s[16:19], s46 offen lds
    v_mfma_f32_16x16x32_bf16 v[36:39], v[56:59], v[124:127], v[36:39]
    ds_read_b128 v[144:147], v2 offset:18432
    s_add_u32 m0, s45, 131072
    s_add_u32 s46, s41, 4096
    buffer_load_dwordx4 v8, s[16:19], s46 offen lds
    v_mfma_f32_16x16x32_bf16 v[24:27], v[60:63], v[116:119], v[24:27]
    ds_read_b64_tr_b16 v[152:153], v12 offset:57344
    ds_read_b64_tr_b16 v[154:155], v12 offset:57856
    s_add_u32 m0, s43, 131072
    s_add_u32 s46, s41, 4096
    buffer_load_dwordx4 v9, s[16:19], s46 offen lds
    v_mfma_f32_16x16x32_bf16 v[40:43], v[60:63], v[124:127], v[40:43]
    ds_read_b128 v[160:163], v3 offset:16384
    s_bfe_u32 s40, s94, 0x40010
    s_add_u32 s40, s89, s40
    s_and_b32 s40, s40, 15
    s_mul_i32 s41, s40, 393216
    s_lshl_b32 s40, s40, 7
    s_add_u32 s40, s40, s36
    s_add_u32 s42, s41, s47
    s_add_u32 s41, s41, s38
    s_add_u32 m0, s45, 139264
    s_nop 0
    buffer_load_dwordx4 v8, s[16:19], s42 offen lds
    v_mfma_f32_16x16x32_bf16 v[28:31], v[132:135], v[116:119], v[28:31]
    ds_read_b64_tr_b16 v[84:85], v13 offset:57344
    ds_read_b64_tr_b16 v[86:87], v13 offset:57856
    s_add_u32 m0, s43, 139264
    s_nop 0
    buffer_load_dwordx4 v9, s[16:19], s42 offen lds
    v_mfma_f32_16x16x32_bf16 v[44:47], v[132:135], v[124:127], v[44:47]
    ds_read_b128 v[72:75], v3 offset:18432
    s_bfe_u32 s40, s95, 0x40000
    s_add_u32 s40, s89, s40
    s_and_b32 s40, s40, 15
    s_mul_i32 s41, s40, 393216
    s_lshl_b32 s40, s40, 7
    s_add_u32 s40, s40, s36
    s_add_u32 s42, s41, s47
    s_add_u32 s41, s41, s38
    s_add_u32 m0, s44, 0
    s_add_u32 s46, s40, 0
    buffer_load_dwordx4 v5, s[12:15], s46 offen lds
    s_add_u32 m0, s44, 1024
    s_add_u32 s46, s40, 16384
    buffer_load_dwordx4 v6, s[12:15], s46 offen lds
    s_add_u32 m0, s44, 2048
    s_add_u32 s46, s40, 32768
    buffer_load_dwordx4 v5, s[12:15], s46 offen lds
    s_waitcnt vmcnt(13) lgkmcnt(0)
    s_barrier
    s_add_u32 m0, s44, 3072
    s_add_u32 s46, s40, 49152
    buffer_load_dwordx4 v6, s[12:15], s46 offen lds
    v_mfma_f32_16x16x32_bf16 v[16:19], v[68:71], v[148:151], v[16:19]
    ds_read_b64_tr_b16 v[92:93], v10 offset:61440
    ds_read_b64_tr_b16 v[94:95], v10 offset:61952
    s_add_u32 m0, s45, 73728
    s_add_u32 s46, s41, 2048
    buffer_load_dwordx4 v8, s[16:19], s46 offen lds
    v_mfma_f32_16x16x32_bf16 v[32:35], v[68:71], v[156:159], v[32:35]
    ds_read_b128 v[48:51], v2 offset:32768
    s_add_u32 m0, s43, 73728
    s_add_u32 s46, s41, 2048
    buffer_load_dwordx4 v9, s[16:19], s46 offen lds
    v_mfma_f32_16x16x32_bf16 v[20:23], v[76:79], v[148:151], v[20:23]
    ds_read_b64_tr_b16 v[88:89], v11 offset:61440
    ds_read_b64_tr_b16 v[90:91], v11 offset:61952
    s_add_u32 m0, s45, 81920
    s_add_u32 s46, s41, 4096
    buffer_load_dwordx4 v8, s[16:19], s46 offen lds
    v_mfma_f32_16x16x32_bf16 v[36:39], v[76:79], v[156:159], v[36:39]
    ds_read_b128 v[52:55], v2 offset:34816
    s_add_u32 m0, s43, 81920
    s_add_u32 s46, s41, 4096
    buffer_load_dwordx4 v9, s[16:19], s46 offen lds
    v_mfma_f32_16x16x32_bf16 v[24:27], v[152:155], v[148:151], v[24:27]
    ds_read_b64_tr_b16 v[100:101], v12 offset:61440
    ds_read_b64_tr_b16 v[102:103], v12 offset:61952
    s_bfe_u32 s40, s95, 0x40004
    s_add_u32 s40, s89, s40
    s_and_b32 s40, s40, 15
    s_mul_i32 s41, s40, 393216
    s_lshl_b32 s40, s40, 7
    s_add_u32 s40, s40, s36
    s_add_u32 s42, s41, s47
    s_add_u32 s41, s41, s38
    s_add_u32 m0, s44, 16384
    s_add_u32 s46, s40, 0
    s_nop 0
    buffer_load_dwordx4 v5, s[12:15], s46 offen lds
    v_mfma_f32_16x16x32_bf16 v[40:43], v[152:155], v[156:159], v[40:43]
    ds_read_b128 v[96:99], v3 offset:32768
    s_add_u32 m0, s44, 17408
    s_add_u32 s46, s40, 16384
    buffer_load_dwordx4 v6, s[12:15], s46 offen lds
    v_mfma_f32_16x16x32_bf16 v[28:31], v[84:87], v[148:151], v[28:31]
    ds_read_b64_tr_b16 v[108:109], v13 offset:61440
    ds_read_b64_tr_b16 v[110:111], v13 offset:61952
    s_add_u32 m0, s44, 18432
    s_add_u32 s46, s40, 32768
    buffer_load_dwordx4 v5, s[12:15], s46 offen lds
    v_mfma_f32_16x16x32_bf16 v[44:47], v[84:87], v[156:159], v[44:47]
    ds_read_b128 v[104:107], v3 offset:34816
    s_add_u32 m0, s44, 19456
    s_add_u32 s46, s40, 49152
    buffer_load_dwordx4 v6, s[12:15], s46 offen lds
    s_add_u32 m0, s45, 90112
    s_add_u32 s46, s41, 2048
    buffer_load_dwordx4 v8, s[16:19], s46 offen lds
    s_add_u32 m0, s43, 90112
    s_add_u32 s46, s41, 2048
    buffer_load_dwordx4 v9, s[16:19], s46 offen lds
    s_waitcnt vmcnt(14) lgkmcnt(0)
    s_barrier
    s_add_u32 m0, s45, 98304
    s_add_u32 s46, s41, 4096
    buffer_load_dwordx4 v8, s[16:19], s46 offen lds
    v_mfma_f32_16x16x32_bf16 v[16:19], v[92:95], v[64:67], v[16:19]
    ds_read_b64_tr_b16 v[56:57], v10 offset:49152
    ds_read_b64_tr_b16 v[58:59], v10 offset:49664
    s_add_u32 m0, s43, 98304
    s_add_u32 s46, s41, 4096
    buffer_load_dwordx4 v9, s[16:19], s46 offen lds
    v_mfma_f32_16x16x32_bf16 v[32:35], v[92:95], v[80:83], v[32:35]
    ds_read_b128 v[60:63], v2 offset:49152
    s_bfe_u32 s40, s94, 0x40014
    s_add_u32 s40, s89, s40
    s_and_b32 s40, s40, 15
    s_mul_i32 s41, s40, 393216
    s_lshl_b32 s40, s40, 7
    s_add_u32 s40, s40, s36
    s_add_u32 s42, s41, s47
    s_add_u32 s41, s41, s38
    s_add_u32 m0, s45, 106496
    s_nop 0
    buffer_load_dwordx4 v8, s[16:19], s42 offen lds
    v_mfma_f32_16x16x32_bf16 v[20:23], v[88:91], v[64:67], v[20:23]
    ds_read_b64_tr_b16 v[116:117], v11 offset:49152
    ds_read_b64_tr_b16 v[118:119], v11 offset:49664
    s_add_u32 m0, s43, 106496
    s_nop 0
    buffer_load_dwordx4 v9, s[16:19], s42 offen lds
    v_mfma_f32_16x16x32_bf16 v[36:39], v[88:91], v[80:83], v[36:39]
    ds_read_b128 v[132:135], v2 offset:51200
    s_bfe_u32 s40, s95, 0x40008
    s_add_u32 s40, s89, s40
    s_and_b32 s40, s40, 15
    s_mul_i32 s41, s40, 393216
    s_lshl_b32 s40, s40, 7
    s_add_u32 s40, s40, s36
    s_add_u32 s42, s41, s47
    s_add_u32 s41, s41, s38
    s_add_u32 m0, s44, 32768
    s_add_u32 s46, s40, 0
    s_nop 0
    buffer_load_dwordx4 v5, s[12:15], s46 offen lds
    v_mfma_f32_16x16x32_bf16 v[24:27], v[100:103], v[64:67], v[24:27]
    ds_read_b64_tr_b16 v[124:125], v12 offset:49152
    ds_read_b64_tr_b16 v[126:127], v12 offset:49664
    s_add_u32 m0, s44, 33792
    s_add_u32 s46, s40, 16384
    buffer_load_dwordx4 v6, s[12:15], s46 offen lds
    v_mfma_f32_16x16x32_bf16 v[40:43], v[100:103], v[80:83], v[40:43]
    ds_read_b128 v[68:71], v3 offset:49152
    s_add_u32 m0, s44, 34816
    s_add_u32 s46, s40, 32768
    buffer_load_dwordx4 v5, s[12:15], s46 offen lds
    v_mfma_f32_16x16x32_bf16 v[28:31], v[108:111], v[64:67], v[28:31]
    ds_read_b64_tr_b16 v[76:77], v13 offset:49152
    ds_read_b64_tr_b16 v[78:79], v13 offset:49664
    s_add_u32 m0, s44, 35840
    s_add_u32 s46, s40, 49152
    buffer_load_dwordx4 v6, s[12:15], s46 offen lds
    v_mfma_f32_16x16x32_bf16 v[44:47], v[108:111], v[80:83], v[44:47]
    ds_read_b128 v[152:155], v3 offset:51200
    s_add_u32 m0, s45, 65536
    s_add_u32 s46, s41, 2048
    buffer_load_dwordx4 v8, s[16:19], s46 offen lds
    s_add_u32 m0, s43, 65536
    s_add_u32 s46, s41, 2048
    buffer_load_dwordx4 v9, s[16:19], s46 offen lds
    s_add_u32 m0, s45, 114688
    s_add_u32 s46, s41, 4096
    buffer_load_dwordx4 v8, s[16:19], s46 offen lds
    s_waitcnt vmcnt(17) lgkmcnt(0)
    s_barrier
    s_add_u32 m0, s43, 114688
    s_add_u32 s46, s41, 4096
    buffer_load_dwordx4 v9, s[16:19], s46 offen lds
    v_mfma_f32_16x16x32_bf16 v[16:19], v[56:59], v[112:115], v[16:19]
    ds_read_b64_tr_b16 v[148:149], v10 offset:53248
    ds_read_b64_tr_b16 v[150:151], v10 offset:53760
    s_bfe_u32 s40, s95, 0x4000c
    s_add_u32 s40, s89, s40
    s_and_b32 s40, s40, 15
    s_mul_i32 s41, s40, 393216
    s_lshl_b32 s40, s40, 7
    s_add_u32 s40, s40, s36
    s_add_u32 s42, s41, s47
    s_add_u32 s41, s41, s38
    s_add_u32 m0, s44, 49152
    s_add_u32 s46, s40, 0
    s_nop 0
    buffer_load_dwordx4 v5, s[12:15], s46 offen lds
    v_mfma_f32_16x16x32_bf16 v[32:35], v[56:59], v[120:123], v[32:35]
    ds_read_b128 v[84:87], v2 offset:0
    s_add_u32 m0, s44, 50176
    s_add_u32 s46, s40, 16384
    buffer_load_dwordx4 v6, s[12:15], s46 offen lds
    v_mfma_f32_16x16x32_bf16 v[20:23], v[116:119], v[112:115], v[20:23]
    ds_read_b64_tr_b16 v[156:157], v11 offset:53248
    ds_read_b64_tr_b16 v[158:159], v11 offset:53760
    s_add_u32 m0, s44, 51200
    s_add_u32 s46, s40, 32768
    buffer_load_dwordx4 v5, s[12:15], s46 offen lds
    v_mfma_f32_16x16x32_bf16 v[36:39], v[116:119], v[120:123], v[36:39]
    ds_read_b128 v[92:95], v2 offset:2048
    s_add_u32 m0, s44, 52224
    s_add_u32 s46, s40, 49152
    buffer_load_dwordx4 v6, s[12:15], s46 offen lds
    v_mfma_f32_16x16x32_bf16 v[24:27], v[124:127], v[112:115], v[24:27]
    ds_read_b64_tr_b16 v[88:89], v12 offset:53248
    ds_read_b64_tr_b16 v[90:91], v12 offset:53760
    s_add_u32 m0, s45, 122880
    s_add_u32 s46, s41, 2048
    buffer_load_dwordx4 v8, s[16:19], s46 offen lds
    v_mfma_f32_16x16x32_bf16 v[40:43], v[124:127], v[120:123], v[40:43]
    ds_read_b128 v[100:103], v3 offset:0
    s_add_u32 m0, s43, 122880
    s_add_u32 s46, s41, 2048
    buffer_load_dwordx4 v9, s[16:19], s46 offen lds
    v_mfma_f32_16x16x32_bf16 v[28:31], v[76:79], v[112:115], v[28:31]
    ds_read_b64_tr_b16 v[64:65], v13 offset:53248
    ds_read_b64_tr_b16 v[66:67], v13 offset:53760
    s_add_u32 m0, s45, 131072
    s_add_u32 s46, s41, 4096
    buffer_load_dwordx4 v8, s[16:19], s46 offen lds
    v_mfma_f32_16x16x32_bf16 v[44:47], v[76:79], v[120:123], v[44:47]
    ds_read_b128 v[108:111], v3 offset:2048
    s_add_u32 m0, s43, 131072
    s_add_u32 s46, s41, 4096
    buffer_load_dwordx4 v9, s[16:19], s46 offen lds
    s_waitcnt vmcnt(16) lgkmcnt(0)
    s_barrier
    s_bfe_u32 s40, s95, 0x40010
    s_add_u32 s40, s89, s40
    s_and_b32 s40, s40, 15
    s_mul_i32 s41, s40, 393216
    s_lshl_b32 s40, s40, 7
    s_add_u32 s40, s40, s36
    s_add_u32 s42, s41, s47
    s_add_u32 s41, s41, s38
    s_add_u32 m0, s44, 0
    s_add_u32 s46, s40, 0
    buffer_load_dwordx4 v5, s[12:15], s46 offen lds
    v_mfma_f32_16x16x32_bf16 v[16:19], v[148:151], v[128:131], v[16:19]
    ds_read_b64_tr_b16 v[80:81], v10 offset:16384
    ds_read_b64_tr_b16 v[82:83], v10 offset:16896
    s_add_u32 m0, s44, 1024
    s_add_u32 s46, s40, 16384
    buffer_load_dwordx4 v6, s[12:15], s46 offen lds
    v_mfma_f32_16x16x32_bf16 v[32:35], v[148:151], v[136:139], v[32:35]
    ds_read_b128 v[56:59], v2 offset:16384
    s_add_u32 m0, s44, 2048
    s_add_u32 s46, s40, 32768
    buffer_load_dwordx4 v5, s[12:15], s46 offen lds
    v_mfma_f32_16x16x32_bf16 v[20:23], v[156:159], v[128:131], v[20:23]
    ds_read_b64_tr_b16 v[116:117], v11 offset:16384
    ds_read_b64_tr_b16 v[118:119], v11 offset:16896
    s_add_u32 m0, s44, 3072
    s_add_u32 s46, s40, 49152
    buffer_load_dwordx4 v6, s[12:15], s46 offen lds
    v_mfma_f32_16x16x32_bf16 v[36:39], v[156:159], v[136:139], v[36:39]
    ds_read_b128 v[124:127], v2 offset:18432
    s_add_u32 m0, s45, 73728
    s_add_u32 s46, s41, 2048
    buffer_load_dwordx4 v8, s[16:19], s46 offen lds
    v_mfma_f32_16x16x32_bf16 v[24:27], v[88:91], v[128:131], v[24:27]
    ds_read_b64_tr_b16 v[112:113], v12 offset:16384
    ds_read_b64_tr_b16 v[114:115], v12 offset:16896
    s_add_u32 m0, s43, 73728
    s_add_u32 s46, s41, 2048
    buffer_load_dwordx4 v9, s[16:19], s46 offen lds
    v_mfma_f32_16x16x32_bf16 v[40:43], v[88:91], v[136:139], v[40:43]
    ds_read_b128 v[76:79], v3 offset:16384
    s_add_u32 m0, s45, 81920
    s_add_u32 s46, s41, 4096
    buffer_load_dwordx4 v8, s[16:19], s46 offen lds
    v_mfma_f32_16x16x32_bf16 v[28:31], v[64:67], v[128:131], v[28:31]
    ds_read_b64_tr_b16 v[120:121], v13 offset:16384
    ds_read_b64_tr_b16 v[122:123], v13 offset:16896
    s_add_u32 m0, s43, 81920
    s_add_u32 s46, s41, 4096
    buffer_load_dwordx4 v9, s[16:19], s46 offen lds
    v_mfma_f32_16x16x32_bf16 v[44:47], v[64:67], v[136:139], v[44:47]
    ds_read_b128 v[148:151], v3 offset:18432
    s_waitcnt vmcnt(16) lgkmcnt(0)
    s_barrier
    s_bfe_u32 s40, s95, 0x40014
    s_add_u32 s40, s89, s40
    s_and_b32 s40, s40, 15
    s_mul_i32 s41, s40, 393216
    s_lshl_b32 s40, s40, 7
    s_add_u32 s40, s40, s36
    s_add_u32 s42, s41, s47
    s_add_u32 s41, s41, s38
    s_add_u32 m0, s44, 16384
    s_add_u32 s46, s40, 0
    s_nop 0
    buffer_load_dwordx4 v5, s[12:15], s46 offen lds
    v_mfma_f32_16x16x32_bf16 v[16:19], v[80:83], v[140:143], v[16:19]
    ds_read_b64_tr_b16 v[156:157], v10 offset:20480
    ds_read_b64_tr_b16 v[158:159], v10 offset:20992
    s_add_u32 m0, s44, 17408
    s_add_u32 s46, s40, 16384
    buffer_load_dwordx4 v6, s[12:15], s46 offen lds
    v_mfma_f32_16x16x32_bf16 v[32:35], v[80:83], v[144:147], v[32:35]
    ds_read_b128 v[88:91], v2 offset:32768
    s_add_u32 m0, s44, 18432
    s_add_u32 s46, s40, 32768
    buffer_load_dwordx4 v5, s[12:15], s46 offen lds
    v_mfma_f32_16x16x32_bf16 v[20:23], v[116:119], v[140:143], v[20:23]
    ds_read_b64_tr_b16 v[128:129], v11 offset:20480
    ds_read_b64_tr_b16 v[130:131], v11 offset:20992
    s_add_u32 m0, s44, 19456
    s_add_u32 s46, s40, 49152
    buffer_load_dwordx4 v6, s[12:15], s46 offen lds
    v_mfma_f32_16x16x32_bf16 v[36:39], v[116:119], v[144:147], v[36:39]
    ds_read_b128 v[64:67], v2 offset:34816
    s_add_u32 m0, s45, 90112
    s_add_u32 s46, s41, 2048
    buffer_load_dwordx4 v8, s[16:19], s46 offen lds
    v_mfma_f32_16x16x32_bf16 v[24:27], v[112:115], v[140:143], v[24:27]
    ds_read_b64_tr_b16 v[136:137], v12 offset:20480
    ds_read_b64_tr_b16 v[138:139], v12 offset:20992
    s_add_u32 m0, s43, 90112
    s_add_u32 s46, s41, 2048
    buffer_load_dwordx4 v9, s[16:19], s46 offen lds
    v_mfma_f32_16x16x32_bf16 v[40:43], v[112:115], v[144:147], v[40:43]
    ds_read_b128 v[80:83], v3 offset:32768
    s_add_u32 m0, s45, 98304
    s_add_u32 s46, s41, 4096
    buffer_load_dwordx4 v8, s[16:19], s46 offen lds
    v_mfma_f32_16x16x32_bf16 v[28:31], v[120:123], v[140:143], v[28:31]
    ds_read_b64_tr_b16 v[116:117], v13 offset:20480
    ds_read_b64_tr_b16 v[118:119], v13 offset:20992
    s_add_u32 m0, s43, 98304
    s_add_u32 s46, s41, 4096
    buffer_load_dwordx4 v9, s[16:19], s46 offen lds
    v_mfma_f32_16x16x32_bf16 v[44:47], v[120:123], v[144:147], v[44:47]
    ds_read_b128 v[112:115], v3 offset:34816
    s_waitcnt vmcnt(16) lgkmcnt(0)
    s_barrier
    s_bfe_u32 s40, s95, 0x40018
    s_add_u32 s40, s89, s40
    s_and_b32 s40, s40, 15
    s_mul_i32 s41, s40, 393216
    s_lshl_b32 s40, s40, 7
    s_add_u32 s40, s40, s36
    s_add_u32 s42, s41, s47
    s_add_u32 s41, s41, s38
    s_add_u32 m0, s44, 32768
    s_add_u32 s46, s40, 0
    s_nop 0
    buffer_load_dwordx4 v5, s[12:15], s46 offen lds
    v_mfma_f32_16x16x32_bf16 v[16:19], v[156:159], v[160:163], v[16:19]
    ds_read_b128 v[140:143], v2 offset:49152
    s_add_u32 m0, s44, 33792
    s_add_u32 s46, s40, 16384
    buffer_load_dwordx4 v6, s[12:15], s46 offen lds
    v_mfma_f32_16x16x32_bf16 v[32:35], v[156:159], v[72:75], v[32:35]
    ds_read_b128 v[120:123], v2 offset:51200
    s_add_u32 m0, s44, 34816
    s_add_u32 s46, s40, 32768
    buffer_load_dwordx4 v5, s[12:15], s46 offen lds
    v_mfma_f32_16x16x32_bf16 v[20:23], v[128:131], v[160:163], v[20:23]
    ds_read_b128 v[144:147], v3 offset:49152
    s_add_u32 m0, s44, 35840
    s_add_u32 s46, s40, 49152
    buffer_load_dwordx4 v6, s[12:15], s46 offen lds
    v_mfma_f32_16x16x32_bf16 v[36:39], v[128:131], v[72:75], v[36:39]
    ds_read_b128 v[156:159], v3 offset:51200
    s_add_u32 m0, s45, 65536
    s_add_u32 s46, s41, 2048
    buffer_load_dwordx4 v8, s[16:19], s46 offen lds
    v_mfma_f32_16x16x32_bf16 v[24:27], v[136:139], v[160:163], v[24:27]
    s_add_u32 m0, s43, 65536
    s_add_u32 s46, s41, 2048
    buffer_load_dwordx4 v9, s[16:19], s46 offen lds
    v_mfma_f32_16x16x32_bf16 v[40:43], v[136:139], v[72:75], v[40:43]
    s_add_u32 m0, s45, 106496
    s_add_u32 s46, s41, 4096
    buffer_load_dwordx4 v8, s[16:19], s46 offen lds
    v_mfma_f32_16x16x32_bf16 v[28:31], v[116:119], v[160:163], v[28:31]
    s_add_u32 m0, s43, 106496
    s_add_u32 s46, s41, 4096
    buffer_load_dwordx4 v9, s[16:19], s46 offen lds
    v_mfma_f32_16x16x32_bf16 v[44:47], v[116:119], v[72:75], v[44:47]
    s_waitcnt vmcnt(16) lgkmcnt(0)
    s_barrier
    s_bfe_u32 s40, s95, 0x4001c
    s_add_u32 s40, s89, s40
    s_and_b32 s40, s40, 15
    s_mul_i32 s41, s40, 393216
    s_lshl_b32 s40, s40, 7
    s_add_u32 s40, s40, s36
    s_add_u32 s42, s41, s47
    s_add_u32 s41, s41, s38
    s_add_u32 m0, s44, 49152
    s_add_u32 s46, s40, 0
    s_nop 0
    buffer_load_dwordx4 v5, s[12:15], s46 offen lds
    s_add_u32 m0, s44, 50176
    s_add_u32 s46, s40, 16384
    buffer_load_dwordx4 v6, s[12:15], s46 offen lds
    s_add_u32 m0, s44, 51200
    s_add_u32 s46, s40, 32768
    buffer_load_dwordx4 v5, s[12:15], s46 offen lds
    s_add_u32 m0, s44, 52224
    s_add_u32 s46, s40, 49152
    buffer_load_dwordx4 v6, s[12:15], s46 offen lds
    s_add_u32 m0, s45, 114688
    s_add_u32 s46, s41, 2048
    buffer_load_dwordx4 v8, s[16:19], s46 offen lds
    s_add_u32 m0, s43, 114688
    s_add_u32 s46, s41, 2048
    buffer_load_dwordx4 v9, s[16:19], s46 offen lds
    s_add_u32 m0, s45, 122880
    s_add_u32 s46, s41, 4096
    buffer_load_dwordx4 v8, s[16:19], s46 offen lds
    s_add_u32 m0, s43, 122880
    s_add_u32 s46, s41, 4096
    buffer_load_dwordx4 v9, s[16:19], s46 offen lds
    s_waitcnt vmcnt(16)
    s_barrier
    s_bfe_u32 s40, s94, 0x40018
    s_add_u32 s40, s89, s40
    s_and_b32 s40, s40, 15
    s_mul_i32 s41, s40, 393216
    s_lshl_b32 s40, s40, 7
    s_add_u32 s40, s40, s36
    s_add_u32 s42, s41, s47
    s_add_u32 s41, s41, s38
    s_add_u32 m0, s45, 147456
    s_nop 0
    buffer_load_dwordx4 v8, s[16:19], s42 offen lds
    s_add_u32 m0, s43, 147456
    s_nop 0
    buffer_load_dwordx4 v9, s[16:19], s42 offen lds
    s_waitcnt vmcnt(10)
    s_barrier
    s_bfe_u32 s40, s95, 0x40010
    s_add_u32 s40, s89, s40
    s_and_b32 s40, s40, 15
    s_mul_i32 s41, s40, 393216
    s_lshl_b32 s40, s40, 7
    s_add_u32 s40, s40, s36
    s_add_u32 s42, s41, s47
    s_add_u32 s41, s41, s38
    s_add_u32 m0, s45, 139264
    s_nop 0
    buffer_load_dwordx4 v8, s[16:19], s42 offen lds
    s_add_u32 m0, s43, 139264
    s_nop 0
    buffer_load_dwordx4 v9, s[16:19], s42 offen lds
    s_waitcnt vmcnt(4)
    s_barrier
    s_bfe_u32 s40, s95, 0x40014
    s_add_u32 s40, s89, s40
    s_and_b32 s40, s40, 15
    s_mul_i32 s41, s40, 393216
    s_lshl_b32 s40, s40, 7
    s_add_u32 s40, s40, s36
    s_add_u32 s42, s41, s47
    s_add_u32 s41, s41, s38
    s_add_u32 m0, s45, 131072
    s_nop 0
    buffer_load_dwordx4 v8, s[16:19], s42 offen lds
    s_add_u32 m0, s43, 131072
    s_nop 0
    buffer_load_dwordx4 v9, s[16:19], s42 offen lds
    s_waitcnt vmcnt(6)
    s_barrier
    s_bfe_u32 s40, s95, 0x40018
    s_add_u32 s40, s89, s40
    s_and_b32 s40, s40, 15
    s_mul_i32 s41, s40, 393216
    s_lshl_b32 s40, s40, 7
    s_add_u32 s40, s40, s36
    s_add_u32 s42, s41, s47
    s_add_u32 s41, s41, s38
    s_add_u32 m0, s45, 81920
    s_nop 0
    buffer_load_dwordx4 v8, s[16:19], s42 offen lds
    s_add_u32 m0, s43, 81920
    s_nop 0
    buffer_load_dwordx4 v9, s[16:19], s42 offen lds
    s_bfe_u32 s40, s95, 0x4001c
    s_add_u32 s40, s89, s40
    s_branch IW_s1
IW_w1:
    s_branch IW_r1
IW_s1:
    s_and_b32 s40, s40, 15
    s_mul_i32 s41, s40, 393216
    s_lshl_b32 s40, s40, 7
    s_add_u32 s40, s40, s36
    s_add_u32 s42, s41, s47
    s_add_u32 s41, s41, s38
    s_add_u32 m0, s45, 73728
    s_nop 0
    buffer_load_dwordx4 v8, s[16:19], s42 offen lds
    s_add_u32 m0, s43, 73728
    s_nop 0
    buffer_load_dwordx4 v9, s[16:19], s42 offen lds
    s_bfe_u32 s40, s94, 0x4001c
    s_add_u32 s40, s89, s40
    s_and_b32 s40, s40, 15
    s_mul_i32 s41, s40, 393216
    s_lshl_b32 s40, s40, 7
    s_add_u32 s40, s40, s36
    s_add_u32 s42, s41, s47
    s_add_u32 s41, s41, s38
    s_add_u32 m0, s45, 98304
    s_nop 0
    buffer_load_dwordx4 v8, s[16:19], s42 offen lds
    s_add_u32 m0, s43, 98304
    s_nop 0
    buffer_load_dwordx4 v9, s[16:19], s42 offen lds
    s_bfe_u32 s40, s95, 0x40000
    s_add_u32 s40, s89, s40
    s_and_b32 s40, s40, 15
    s_mul_i32 s41, s40, 393216
    s_lshl_b32 s40, s40, 7
    s_add_u32 s40, s40, s36
    s_add_u32 s42, s41, s47
    s_add_u32 s41, s41, s38
    s_add_u32 m0, s45, 90112
    s_nop 0
    buffer_load_dwordx4 v8, s[16:19], s42 offen lds
    s_add_u32 m0, s43, 90112
    s_nop 0
    buffer_load_dwordx4 v9, s[16:19], s42 offen lds
    s_bfe_u32 s40, s95, 0x40004
    s_add_u32 s40, s89, s40
    s_and_b32 s40, s40, 15
    s_mul_i32 s41, s40, 393216
    s_lshl_b32 s40, s40, 7
    s_add_u32 s40, s40, s36
    s_add_u32 s42, s41, s47
    s_add_u32 s41, s41, s38
    s_add_u32 m0, s45, 106496
    s_nop 0
    buffer_load_dwordx4 v8, s[16:19], s42 offen lds
    s_add_u32 m0, s43, 106496
    s_nop 0
    buffer_load_dwordx4 v9, s[16:19], s42 offen lds
    s_bfe_u32 s40, s95, 0x40008
    s_add_u32 s40, s89, s40
    s_and_b32 s40, s40, 15
    s_mul_i32 s41, s40, 393216
    s_lshl_b32 s40, s40, 7
    s_add_u32 s40, s40, s36
    s_add_u32 s42, s41, s47
    s_add_u32 s41, s41, s38
    s_add_u32 m0, s45, 65536
    s_nop 0
    buffer_load_dwordx4 v8, s[16:19], s42 offen lds
    s_add_u32 m0, s43, 65536
    s_nop 0
    buffer_load_dwordx4 v9, s[16:19], s42 offen lds
    s_bfe_u32 s40, s95, 0x4000c
    s_add_u32 s40, s89, s40
    s_and_b32 s40, s40, 15
    s_mul_i32 s41, s40, 393216
    s_lshl_b32 s40, s40, 7
    s_add_u32 s40, s40, s36
    s_add_u32 s42, s41, s47
    s_add_u32 s41, s41, s38
    s_add_u32 m0, s45, 122880
    s_nop 0
    buffer_load_dwordx4 v8, s[16:19], s42 offen lds
    s_add_u32 m0, s43, 122880
    s_nop 0
    buffer_load_dwordx4 v9, s[16:19], s42 offen lds
    s_setprio 1
    v_subrev_u32 v5, 24576, v10
    v_subrev_u32 v6, 24576, v11
    v_subrev_u32 v8, 24576, v12
    v_subrev_u32 v9, 24576, v13
    s_add_u32 s16, s72, 0x400000
    s_addc_u32 s17, s73, 0
    s_mov_b32 s18, 0x400000
    s_mov_b32 s19, 0x00020000
    s_add_u32 s24, s72, 0x800000
    s_addc_u32 s25, s73, 0
    s_mov_b32 s26, 0x48000
    s_mov_b32 s27, 0x00020000
    s_waitcnt vmcnt(8)
    s_mov_b64 exec, 1
    ds_add_u32 v4, v164 offset:112
    s_mov_b64 exec, -1
    ds_read_b32 v7, v1 offset:32
FW_1:
    s_waitcnt lgkmcnt(0)
    v_cmp_gt_u32 vcc, 1, v7
    s_cbranch_vccz FO_2
    s_sleep 2
    ds_read_b32 v7, v1 offset:32
    s_branch FW_1
FO_2:
    ds_read_b32 v7, v1 offset:112
FW_3:
    s_waitcnt lgkmcnt(0)
    v_cmp_gt_u32 vcc, 1, v7
    s_cbranch_vccz FO_4
    ds_read_b32 v7, v1 offset:112
    s_branch FW_3
FO_4:
    s_nop 0
    ds_read_b64_tr_b16 v[128:129], v10 offset:57344
    ds_read_b64_tr_b16 v[130:131], v10 offset:57856
    ds_read_b64_tr_b16 v[136:137], v11 offset:57344
    ds_read_b64_tr_b16 v[138:139], v11 offset:57856
    ds_read_b64_tr_b16 v[160:161], v12 offset:57344
    ds_read_b64_tr_b16 v[162:163], v12 offset:57856
    ds_read_b64_tr_b16 v[116:117], v13 offset:57344
    ds_read_b64_tr_b16 v[118:119], v13 offset:57856
    ds_read_b64_tr_b16 v[72:73], v10 offset:61440
    ds_read_b64_tr_b16 v[74:75], v10 offset:61952
    s_waitcnt lgkmcnt(8)
    v_mfma_f32_16x16x32_bf16 v[16:19], v[128:131], v[48:51], v[16:19]
    v_mfma_f32_16x16x32_bf16 v[32:35], v[128:131], v[52:55], v[32:35]
    ds_read_b64_tr_b16 v[128:129], v11 offset:61440
    ds_read_b64_tr_b16 v[130:131], v11 offset:61952
    s_waitcnt lgkmcnt(8)
    v_mfma_f32_16x16x32_bf16 v[20:23], v[136:139], v[48:51], v[20:23]
    v_mfma_f32_16x16x32_bf16 v[36:39], v[136:139], v[52:55], v[36:39]
    ds_read_b64_tr_b16 v[136:137], v12 offset:61440
    ds_read_b64_tr_b16 v[138:139], v12 offset:61952
    s_waitcnt lgkmcnt(8)
    v_mfma_f32_16x16x32_bf16 v[24:27], v[160:163], v[48:51], v[24:27]
    v_mfma_f32_16x16x32_bf16 v[40:43], v[160:163], v[52:55], v[40:43]
    ds_read_b64_tr_b16 v[160:161], v13 offset:61440
    ds_read_b64_tr_b16 v[162:163], v13 offset:61952
    s_waitcnt lgkmcnt(8)
    v_mfma_f32_16x16x32_bf16 v[28:31], v[116:119], v[48:51], v[28:31]
    ds_read_b128 v[48:51], v2 offset:0
    v_mfma_f32_16x16x32_bf16 v[44:47], v[116:119], v[52:55], v[44:47]
    ds_read_b64_tr_b16 v[116:117], v10 offset:49152
    ds_read_b64_tr_b16 v[118:119], v10 offset:49664
    s_waitcnt lgkmcnt(9)
    v_mfma_f32_16x16x32_bf16 v[16:19], v[72:75], v[96:99], v[16:19]
    ds_read_b128 v[52:55], v2 offset:2048
    v_mfma_f32_16x16x32_bf16 v[32:35], v[72:75], v[104:107], v[32:35]
    ds_read_b64_tr_b16 v[72:73], v11 offset:49152
    ds_read_b64_tr_b16 v[74:75], v11 offset:49664
    s_waitcnt lgkmcnt(10)
    v_mfma_f32_16x16x32_bf16 v[20:23], v[128:131], v[96:99], v[20:23]
    v_mfma_f32_16x16x32_bf16 v[36:39], v[128:131], v[104:107], v[36:39]
    ds_read_b64_tr_b16 v[128:129], v12 offset:49152
    ds_read_b64_tr_b16 v[130:131], v12 offset:49664
    s_waitcnt lgkmcnt(10)
    v_mfma_f32_16x16x32_bf16 v[24:27], v[136:139], v[96:99], v[24:27]
    v_mfma_f32_16x16x32_bf16 v[40:43], v[136:139], v[104:107], v[40:43]
    ds_read_b64_tr_b16 v[136:137], v13 offset:49152
    ds_read_b64_tr_b16 v[138:139], v13 offset:49664
    s_waitcnt lgkmcnt(10)
    v_mfma_f32_16x16x32_bf16 v[28:31], v[160:163], v[96:99], v[28:31]
    ds_read_b128 v[96:99], v3 offset:0
    v_mfma_f32_16x16x32_bf16 v[44:47], v[160:163], v[104:107], v[44:47]
    ds_read_b64_tr_b16 v[160:161], v10 offset:53248
    ds_read_b64_tr_b16 v[162:163], v10 offset:53760
    s_waitcnt lgkmcnt(10)
    v_mfma_f32_16x16x32_bf16 v[16:19], v[116:119], v[48:51], v[16:19]
    ds_read_b128 v[104:107], v3 offset:2048
    s_waitcnt lgkmcnt(10)
    v_mfma_f32_16x16x32_bf16 v[32:35], v[116:119], v[52:55], v[32:35]
    ds_read_b64_tr_b16 v[116:117], v11 offset:53248
    ds_read_b64_tr_b16 v[118:119], v11 offset:53760
    s_waitcnt lgkmcnt(10)
    v_mfma_f32_16x16x32_bf16 v[20:23], v[72:75], v[48:51], v[20:23]
    v_mfma_f32_16x16x32_bf16 v[36:39], v[72:75], v[52:55], v[36:39]
    ds_read_b64_tr_b16 v[72:73], v12 offset:53248
    ds_read_b64_tr_b16 v[74:75], v12 offset:53760
    s_waitcnt lgkmcnt(10)
    v_mfma_f32_16x16x32_bf16 v[24:27], v[128:131], v[48:51], v[24:27]
    v_mfma_f32_16x16x32_bf16 v[40:43], v[128:131], v[52:55], v[40:43]
    ds_read_b64_tr_b16 v[128:129], v13 offset:53248
    ds_read_b64_tr_b16 v[130:131], v13 offset:53760
    s_waitcnt lgkmcnt(10)
    v_mfma_f32_16x16x32_bf16 v[28:31], v[136:139], v[48:51], v[28:31]
    ds_read_b128 v[48:51], v2 offset:16384
    v_mfma_f32_16x16x32_bf16 v[44:47], v[136:139], v[52:55], v[44:47]
    ds_read_b64_tr_b16 v[136:137], v10 offset:40960
    ds_read_b64_tr_b16 v[138:139], v10 offset:41472
    s_waitcnt lgkmcnt(10)
    v_mfma_f32_16x16x32_bf16 v[16:19], v[160:163], v[96:99], v[16:19]
    ds_read_b128 v[52:55], v2 offset:18432
    s_waitcnt lgkmcnt(10)
    v_mfma_f32_16x16x32_bf16 v[32:35], v[160:163], v[104:107], v[32:35]
    ds_read_b64_tr_b16 v[160:161], v11 offset:40960
    ds_read_b64_tr_b16 v[162:163], v11 offset:41472
    s_waitcnt lgkmcnt(10)
    v_mfma_f32_16x16x32_bf16 v[20:23], v[116:119], v[96:99], v[20:23]
    v_mfma_f32_16x16x32_bf16 v[36:39], v[116:119], v[104:107], v[36:39]
    ds_read_b64_tr_b16 v[116:117], v12 offset:40960
    ds_read_b64_tr_b16 v[118:119], v12 offset:41472
    s_waitcnt lgkmcnt(10)
    v_mfma_f32_16x16x32_bf16 v[24:27], v[72:75], v[96:99], v[24:27]
    v_mfma_f32_16x16x32_bf16 v[40:43], v[72:75], v[104:107], v[40:43]
    ds_read_b64_tr_b16 v[72:73], v13 offset:40960
    ds_read_b64_tr_b16 v[74:75], v13 offset:41472
    s_waitcnt lgkmcnt(10)
    v_mfma_f32_16x16x32_bf16 v[28:31], v[128:131], v[96:99], v[28:31]
    ds_read_b128 v[96:99], v3 offset:16384
    v_mfma_f32_16x16x32_bf16 v[44:47], v[128:131], v[104:107], v[44:47]
    ds_read_b64_tr_b16 v[128:129], v10 offset:45056
    ds_read_b64_tr_b16 v[130:131], v10 offset:45568
    s_waitcnt lgkmcnt(10)
    v_mfma_f32_16x16x32_bf16 v[16:19], v[136:139], v[48:51], v[16:19]
    ds_read_b128 v[104:107], v3 offset:18432
    s_waitcnt lgkmcnt(10)
    v_mfma_f32_16x16x32_bf16 v[32:35], v[136:139], v[52:55], v[32:35]
    ds_read_b64_tr_b16 v[136:137], v11 offset:45056
    ds_read_b64_tr_b16 v[138:139], v11 offset:45568
    s_waitcnt lgkmcnt(10)
    v_mfma_f32_16x16x32_bf16 v[20:23], v[160:163], v[48:51], v[20:23]
    v_mfma_f32_16x16x32_bf16 v[36:39], v[160:163], v[52:55], v[36:39]
    ds_read_b64_tr_b16 v[160:161], v12 offset:45056
    ds_read_b64_tr_b16 v[162:163], v12 offset:45568
    s_waitcnt lgkmcnt(10)
    v_mfma_f32_16x16x32_bf16 v[24:27], v[116:119], v[48:51], v[24:27]
    v_mfma_f32_16x16x32_bf16 v[40:43], v[116:119], v[52:55], v[40:43]
    ds_read_b64_tr_b16 v[116:117], v13 offset:45056
    ds_read_b64_tr_b16 v[118:119], v13 offset:45568
    s_waitcnt lgkmcnt(10)
    v_mfma_f32_16x16x32_bf16 v[28:31], v[72:75], v[48:51], v[28:31]
    ds_read_b128 v[48:51], v2 offset:32768
    v_mfma_f32_16x16x32_bf16 v[44:47], v[72:75], v[52:55], v[44:47]
    ds_read_b64_tr_b16 v[72:73], v5 offset:16384
    ds_read_b64_tr_b16 v[74:75], v5 offset:16896
    s_waitcnt lgkmcnt(10)
    v_mfma_f32_16x16x32_bf16 v[16:19], v[128:131], v[96:99], v[16:19]
    ds_read_b128 v[52:55], v2 offset:34816
    s_waitcnt lgkmcnt(10)
    v_mfma_f32_16x16x32_bf16 v[32:35], v[128:131], v[104:107], v[32:35]
    ds_read_b64_tr_b16 v[128:129], v6 offset:16384
    ds_read_b64_tr_b16 v[130:131], v6 offset:16896
    s_waitcnt lgkmcnt(10)
    v_mfma_f32_16x16x32_bf16 v[20:23], v[136:139], v[96:99], v[20:23]
    v_mfma_f32_16x16x32_bf16 v[36:39], v[136:139], v[104:107], v[36:39]
    ds_read_b64_tr_b16 v[136:137], v8 offset:16384
    ds_read_b64_tr_b16 v[138:139], v8 offset:16896
    s_waitcnt lgkmcnt(10)
    v_mfma_f32_16x16x32_bf16 v[24:27], v[160:163], v[96:99], v[24:27]
    v_mfma_f32_16x16x32_bf16 v[40:43], v[160:163], v[104:107], v[40:43]
    ds_read_b64_tr_b16 v[160:161], v9 offset:16384
    ds_read_b64_tr_b16 v[162:163], v9 offset:16896
    s_waitcnt lgkmcnt(10)
    v_mfma_f32_16x16x32_bf16 v[28:31], v[116:119], v[96:99], v[28:31]
    ds_read_b128 v[96:99], v3 offset:32768
    v_mfma_f32_16x16x32_bf16 v[44:47], v[116:119], v[104:107], v[44:47]
    ds_read_b64_tr_b16 v[116:117], v5 offset:20480
    ds_read_b64_tr_b16 v[118:119], v5 offset:20992
    s_waitcnt lgkmcnt(10)
    v_mfma_f32_16x16x32_bf16 v[16:19], v[72:75], v[48:51], v[16:19]
    ds_read_b128 v[104:107], v3 offset:34816
    s_waitcnt lgkmcnt(10)
    v_mfma_f32_16x16x32_bf16 v[32:35], v[72:75], v[52:55], v[32:35]
    ds_read_b64_tr_b16 v[72:73], v6 offset:20480
    ds_read_b64_tr_b16 v[74:75], v6 offset:20992
    s_waitcnt lgkmcnt(10)
    v_mfma_f32_16x16x32_bf16 v[20:23], v[128:131], v[48:51], v[20:23]
    v_mfma_f32_16x16x32_bf16 v[36:39], v[128:131], v[52:55], v[36:39]
    ds_read_b64_tr_b16 v[128:129], v8 offset:20480
    ds_read_b64_tr_b16 v[130:131], v8 offset:20992
    s_waitcnt lgkmcnt(10)
    v_mfma_f32_16x16x32_bf16 v[24:27], v[136:139], v[48:51], v[24:27]
    v_mfma_f32_16x16x32_bf16 v[40:43], v[136:139], v[52:55], v[40:43]
    ds_read_b64_tr_b16 v[136:137], v9 offset:20480
    ds_read_b64_tr_b16 v[138:139], v9 offset:20992
    s_waitcnt lgkmcnt(10)
    v_mfma_f32_16x16x32_bf16 v[28:31], v[160:163], v[48:51], v[28:31]
    s_waitcnt vmcnt(0)
    s_mov_b64 exec, 1
    ds_add_u32 v4, v164 offset:112
    s_mov_b64 exec, -1
    ds_read_b128 v[48:51], v2 offset:49152
    v_mfma_f32_16x16x32_bf16 v[44:47], v[160:163], v[52:55], v[44:47]
    ds_read_b64_tr_b16 v[160:161], v5 offset:8192
    ds_read_b64_tr_b16 v[162:163], v5 offset:8704
    s_waitcnt lgkmcnt(11)
    v_mfma_f32_16x16x32_bf16 v[16:19], v[116:119], v[96:99], v[16:19]
    ds_read_b128 v[52:55], v2 offset:51200
    s_waitcnt lgkmcnt(11)
    v_mfma_f32_16x16x32_bf16 v[32:35], v[116:119], v[104:107], v[32:35]
    ds_read_b64_tr_b16 v[116:117], v6 offset:8192
    ds_read_b64_tr_b16 v[118:119], v6 offset:8704
    s_waitcnt lgkmcnt(11)
    v_mfma_f32_16x16x32_bf16 v[20:23], v[72:75], v[96:99], v[20:23]
    v_mfma_f32_16x16x32_bf16 v[36:39], v[72:75], v[104:107], v[36:39]
    ds_read_b64_tr_b16 v[72:73], v8 offset:8192
    ds_read_b64_tr_b16 v[74:75], v8 offset:8704
    s_waitcnt lgkmcnt(9)
    v_mov_b32 v165, 4
    s_mov_b64 exec, 1
    ds_write_b32 v4, v165 offset:0
    s_mov_b64 exec, -1
    s_nop 0
    v_mfma_f32_16x16x32_bf16 v[24:27], v[128:131], v[96:99], v[24:27]
    v_mfma_f32_16x16x32_bf16 v[40:43], v[128:131], v[104:107], v[40:43]
    ds_read_b64_tr_b16 v[128:129], v9 offset:8192
    ds_read_b64_tr_b16 v[130:131], v9 offset:8704
    v_mfma_f32_16x16x32_bf16 v[28:31], v[136:139], v[96:99], v[28:31]
    ds_read_b128 v[96:99], v3 offset:49152
    v_mfma_f32_16x16x32_bf16 v[44:47], v[136:139], v[104:107], v[44:47]
    ds_read_b64_tr_b16 v[136:137], v5 offset:12288
    ds_read_b64_tr_b16 v[138:139], v5 offset:12800
    s_waitcnt lgkmcnt(11)
    v_mfma_f32_16x16x32_bf16 v[16:19], v[160:163], v[48:51], v[16:19]
    ds_read_b128 v[104:107], v3 offset:51200
    s_waitcnt lgkmcnt(11)
    v_mfma_f32_16x16x32_bf16 v[32:35], v[160:163], v[52:55], v[32:35]
    ds_read_b64_tr_b16 v[160:161], v6 offset:12288
    ds_read_b64_tr_b16 v[162:163], v6 offset:12800
    s_waitcnt lgkmcnt(11)
    v_mfma_f32_16x16x32_bf16 v[20:23], v[116:119], v[48:51], v[20:23]
    v_mfma_f32_16x16x32_bf16 v[36:39], v[116:119], v[52:55], v[36:39]
    ds_read_b64_tr_b16 v[116:117], v8 offset:12288
    ds_read_b64_tr_b16 v[118:119], v8 offset:12800
    s_waitcnt lgkmcnt(11)
    v_mfma_f32_16x16x32_bf16 v[24:27], v[72:75], v[48:51], v[24:27]
    v_mfma_f32_16x16x32_bf16 v[40:43], v[72:75], v[52:55], v[40:43]
    ds_read_b64_tr_b16 v[72:73], v9 offset:12288
    ds_read_b64_tr_b16 v[74:75], v9 offset:12800
    s_waitcnt lgkmcnt(10)
    v_mfma_f32_16x16x32_bf16 v[28:31], v[128:131], v[48:51], v[28:31]
    ds_read_b64_tr_b16 v[48:49], v10 offset:8192
    v_mfma_f32_16x16x32_bf16 v[44:47], v[128:131], v[52:55], v[44:47]
    ds_read_b64_tr_b16 v[50:51], v10 offset:8704
    ds_read_b64_tr_b16 v[128:129], v11 offset:8192
    s_waitcnt lgkmcnt(10)
    v_mfma_f32_16x16x32_bf16 v[16:19], v[136:139], v[96:99], v[16:19]
    ds_read_b64_tr_b16 v[130:131], v11 offset:8704
    s_waitcnt lgkmcnt(10)
    v_mfma_f32_16x16x32_bf16 v[32:35], v[136:139], v[104:107], v[32:35]
    ds_read_b64_tr_b16 v[52:53], v12 offset:8192
    ds_read_b64_tr_b16 v[54:55], v12 offset:8704
    s_waitcnt lgkmcnt(10)
    v_mfma_f32_16x16x32_bf16 v[20:23], v[160:163], v[96:99], v[20:23]
    ds_read_b64_tr_b16 v[136:137], v13 offset:8192
    v_mfma_f32_16x16x32_bf16 v[36:39], v[160:163], v[104:107], v[36:39]
    ds_read_b64_tr_b16 v[138:139], v13 offset:8704
    ds_read_b64_tr_b16 v[160:161], v10 offset:12288
    s_waitcnt lgkmcnt(11)
    v_mfma_f32_16x16x32_bf16 v[24:27], v[116:119], v[96:99], v[24:27]
    ds_read_b64_tr_b16 v[162:163], v10 offset:12800
    v_mfma_f32_16x16x32_bf16 v[40:43], v[116:119], v[104:107], v[40:43]
    ds_read_b64_tr_b16 v[116:117], v11 offset:12288
    ds_read_b64_tr_b16 v[118:119], v11 offset:12800
    s_waitcnt lgkmcnt(12)
    v_mfma_f32_16x16x32_bf16 v[28:31], v[72:75], v[96:99], v[28:31]
    ds_read_b64_tr_b16 v[96:97], v12 offset:12288
    v_mfma_f32_16x16x32_bf16 v[44:47], v[72:75], v[104:107], v[44:47]
    ds_read_b64_tr_b16 v[98:99], v12 offset:12800
    ds_read_b64_tr_b16 v[72:73], v13 offset:12288
    s_waitcnt lgkmcnt(13)
    v_mfma_f32_16x16x32_bf16 v[16:19], v[48:51], v[60:63], v[16:19]
    ds_read_b64_tr_b16 v[74:75], v13 offset:12800
    v_mfma_f32_16x16x32_bf16 v[32:35], v[48:51], v[132:135], v[32:35]
    ds_read_b32 v7, v1 offset:112
FW_5:
    s_waitcnt lgkmcnt(0)
    v_cmp_gt_u32 vcc, 2, v7
    s_cbranch_vccz FO_6
    ds_read_b32 v7, v1 offset:112
    s_branch FW_5
FO_6:
    s_nop 0
    ds_read_b64_tr_b16 v[104:105], v10 offset:0
    ds_read_b64_tr_b16 v[106:107], v10 offset:512
    v_mfma_f32_16x16x32_bf16 v[20:23], v[128:131], v[60:63], v[20:23]
    ds_read_b64_tr_b16 v[48:49], v11 offset:0
    v_mfma_f32_16x16x32_bf16 v[36:39], v[128:131], v[132:135], v[36:39]
    ds_read_b64_tr_b16 v[50:51], v11 offset:512
    ds_read_b64_tr_b16 v[128:129], v12 offset:0
    v_mfma_f32_16x16x32_bf16 v[24:27], v[52:55], v[60:63], v[24:27]
    ds_read_b64_tr_b16 v[130:131], v12 offset:512
    v_mfma_f32_16x16x32_bf16 v[40:43], v[52:55], v[132:135], v[40:43]
    ds_read_b64_tr_b16 v[52:53], v13 offset:0
    ds_read_b64_tr_b16 v[54:55], v13 offset:512
    v_mfma_f32_16x16x32_bf16 v[28:31], v[136:139], v[60:63], v[28:31]
    v_mfma_f32_16x16x32_bf16 v[44:47], v[136:139], v[132:135], v[44:47]
    v_mfma_f32_16x16x32_bf16 v[16:19], v[160:163], v[68:71], v[16:19]
    ds_read_b64_tr_b16 v[60:61], v10 offset:4096
    v_mfma_f32_16x16x32_bf16 v[32:35], v[160:163], v[152:155], v[32:35]
    ds_read_b64_tr_b16 v[62:63], v10 offset:4608
    ds_read_b64_tr_b16 v[136:137], v11 offset:4096
    v_mfma_f32_16x16x32_bf16 v[20:23], v[116:119], v[68:71], v[20:23]
    ds_read_b64_tr_b16 v[138:139], v11 offset:4608
    v_mfma_f32_16x16x32_bf16 v[36:39], v[116:119], v[152:155], v[36:39]
    ds_read_b64_tr_b16 v[132:133], v12 offset:4096
    ds_read_b64_tr_b16 v[134:135], v12 offset:4608
    v_mfma_f32_16x16x32_bf16 v[24:27], v[96:99], v[68:71], v[24:27]
    ds_read_b64_tr_b16 v[160:161], v13 offset:4096
    v_mfma_f32_16x16x32_bf16 v[40:43], v[96:99], v[152:155], v[40:43]
    s_waitcnt lgkmcnt(8)
    ds_read_b64_tr_b16 v[162:163], v13 offset:4608
    v_mfma_f32_16x16x32_bf16 v[28:31], v[72:75], v[68:71], v[28:31]
    v_mfma_f32_16x16x32_bf16 v[44:47], v[72:75], v[152:155], v[44:47]
    s_waitcnt lgkmcnt(14)
    v_mfma_f32_16x16x32_bf16 v[16:19], v[104:107], v[84:87], v[16:19]
    ds_read_b64_tr_b16 v[116:117], v10 offset:16384
    v_mfma_f32_16x16x32_bf16 v[32:35], v[104:107], v[92:95], v[32:35]
    ds_read_b64_tr_b16 v[118:119], v10 offset:16896
    ds_read_b64_tr_b16 v[96:97], v11 offset:16384
    s_waitcnt lgkmcnt(15)
    v_mfma_f32_16x16x32_bf16 v[20:23], v[48:51], v[84:87], v[20:23]
    ds_read_b64_tr_b16 v[98:99], v11 offset:16896
    v_mfma_f32_16x16x32_bf16 v[36:39], v[48:51], v[92:95], v[36:39]
    ds_read_b64_tr_b16 v[68:69], v12 offset:16384
    ds_read_b64_tr_b16 v[70:71], v12 offset:16896
    s_waitcnt lgkmcnt(15)
    v_mfma_f32_16x16x32_bf16 v[24:27], v[128:131], v[84:87], v[24:27]
    s_waitcnt lgkmcnt(8)
    ds_read_b64_tr_b16 v[72:73], v13 offset:16384
    v_mfma_f32_16x16x32_bf16 v[40:43], v[128:131], v[92:95], v[40:43]
    ds_read_b64_tr_b16 v[74:75], v13 offset:16896
    s_waitcnt lgkmcnt(15)
    v_mfma_f32_16x16x32_bf16 v[28:31], v[52:55], v[84:87], v[28:31]
    v_mfma_f32_16x16x32_bf16 v[44:47], v[52:55], v[92:95], v[44:47]
    s_waitcnt lgkmcnt(14)
    v_mfma_f32_16x16x32_bf16 v[16:19], v[60:63], v[100:103], v[16:19]
    ds_read_b64_tr_b16 v[152:153], v10 offset:20480
    v_mfma_f32_16x16x32_bf16 v[32:35], v[60:63], v[108:111], v[32:35]
    ds_read_b64_tr_b16 v[154:155], v10 offset:20992
    ds_read_b64_tr_b16 v[104:105], v11 offset:20480
    s_waitcnt lgkmcnt(15)
    v_mfma_f32_16x16x32_bf16 v[20:23], v[136:139], v[100:103], v[20:23]
    ds_read_b64_tr_b16 v[106:107], v11 offset:20992
    v_mfma_f32_16x16x32_bf16 v[36:39], v[136:139], v[108:111], v[36:39]
    ds_read_b64_tr_b16 v[48:49], v12 offset:20480
    s_waitcnt lgkmcnt(8)
    ds_read_b64_tr_b16 v[50:51], v12 offset:20992
    s_waitcnt lgkmcnt(15)
    v_mfma_f32_16x16x32_bf16 v[24:27], v[132:135], v[100:103], v[24:27]
    ds_read_b64_tr_b16 v[128:129], v13 offset:20480
    v_mfma_f32_16x16x32_bf16 v[40:43], v[132:135], v[108:111], v[40:43]
    ds_read_b64_tr_b16 v[130:131], v13 offset:20992
    s_waitcnt lgkmcnt(15)
    v_mfma_f32_16x16x32_bf16 v[28:31], v[160:163], v[100:103], v[28:31]
    v_mfma_f32_16x16x32_bf16 v[44:47], v[160:163], v[108:111], v[44:47]
    s_waitcnt lgkmcnt(14)
    v_mfma_f32_16x16x32_bf16 v[16:19], v[116:119], v[56:59], v[16:19]
    ds_read_b64_tr_b16 v[84:85], v5 offset:0
    v_mfma_f32_16x16x32_bf16 v[32:35], v[116:119], v[124:127], v[32:35]
    ds_read_b64_tr_b16 v[86:87], v5 offset:512
    ds_read_b64_tr_b16 v[52:53], v6 offset:0
    s_waitcnt lgkmcnt(15)
    v_mfma_f32_16x16x32_bf16 v[20:23], v[96:99], v[56:59], v[20:23]
    ds_read_b64_tr_b16 v[54:55], v6 offset:512
    v_mfma_f32_16x16x32_bf16 v[36:39], v[96:99], v[124:127], v[36:39]
    s_waitcnt lgkmcnt(8)
    ds_read_b64_tr_b16 v[92:93], v8 offset:0
    ds_read_b64_tr_b16 v[94:95], v8 offset:512
    s_waitcnt lgkmcnt(15)
    v_mfma_f32_16x16x32_bf16 v[24:27], v[68:71], v[56:59], v[24:27]
    ds_read_b64_tr_b16 v[60:61], v9 offset:0
    v_mfma_f32_16x16x32_bf16 v[40:43], v[68:71], v[124:127], v[40:43]
    ds_read_b64_tr_b16 v[62:63], v9 offset:512
    s_waitcnt lgkmcnt(15)
    v_mfma_f32_16x16x32_bf16 v[28:31], v[72:75], v[56:59], v[28:31]
    v_mfma_f32_16x16x32_bf16 v[44:47], v[72:75], v[124:127], v[44:47]
    s_waitcnt lgkmcnt(14)
    v_mfma_f32_16x16x32_bf16 v[16:19], v[152:155], v[76:79], v[16:19]
    ds_read_b64_tr_b16 v[136:137], v5 offset:4096
    v_mfma_f32_16x16x32_bf16 v[32:35], v[152:155], v[148:151], v[32:35]
    ds_read_b64_tr_b16 v[138:139], v5 offset:4608
    ds_read_b64_tr_b16 v[132:133], v6 offset:4096
    s_waitcnt lgkmcnt(15)
    v_mfma_f32_16x16x32_bf16 v[20:23], v[104:107], v[76:79], v[20:23]
    s_waitcnt lgkmcnt(8)
    ds_read_b64_tr_b16 v[134:135], v6 offset:4608
    v_mfma_f32_16x16x32_bf16 v[36:39], v[104:107], v[148:151], v[36:39]
    ds_read_b64_tr_b16 v[100:101], v8 offset:4096
    ds_read_b64_tr_b16 v[102:103], v8 offset:4608
    s_waitcnt lgkmcnt(15)
    v_mfma_f32_16x16x32_bf16 v[24:27], v[48:51], v[76:79], v[24:27]
    ds_read_b64_tr_b16 v[160:161], v9 offset:4096
    v_mfma_f32_16x16x32_bf16 v[40:43], v[48:51], v[148:151], v[40:43]
    ds_read_b64_tr_b16 v[162:163], v9 offset:4608
    s_waitcnt lgkmcnt(15)
    v_mfma_f32_16x16x32_bf16 v[28:31], v[128:131], v[76:79], v[28:31]
    v_mfma_f32_16x16x32_bf16 v[44:47], v[128:131], v[148:151], v[44:47]
    s_waitcnt lgkmcnt(14)
    v_mfma_f32_16x16x32_bf16 v[16:19], v[84:87], v[88:91], v[16:19]
    ds_read_b64_tr_b16 v[108:109], v10 offset:32768
    v_mfma_f32_16x16x32_bf16 v[32:35], v[84:87], v[64:67], v[32:35]
    ds_read_b64_tr_b16 v[110:111], v10 offset:33280
    s_waitcnt lgkmcnt(8)
    ds_read_b64_tr_b16 v[116:117], v11 offset:32768
    s_waitcnt lgkmcnt(15)
    v_mfma_f32_16x16x32_bf16 v[20:23], v[52:55], v[88:91], v[20:23]
    ds_read_b64_tr_b16 v[118:119], v11 offset:33280
    v_mfma_f32_16x16x32_bf16 v[36:39], v[52:55], v[64:67], v[36:39]
    ds_read_b64_tr_b16 v[96:97], v12 offset:32768
    ds_read_b64_tr_b16 v[98:99], v12 offset:33280
    s_waitcnt lgkmcnt(15)
    v_mfma_f32_16x16x32_bf16 v[24:27], v[92:95], v[88:91], v[24:27]
    ds_read_b64_tr_b16 v[68:69], v13 offset:32768
    v_mfma_f32_16x16x32_bf16 v[40:43], v[92:95], v[64:67], v[40:43]
    ds_read_b64_tr_b16 v[70:71], v13 offset:33280
    s_waitcnt lgkmcnt(15)
    v_mfma_f32_16x16x32_bf16 v[28:31], v[60:63], v[88:91], v[28:31]
    v_mfma_f32_16x16x32_bf16 v[44:47], v[60:63], v[64:67], v[44:47]
    s_waitcnt lgkmcnt(14)
    v_mfma_f32_16x16x32_bf16 v[16:19], v[136:139], v[80:83], v[16:19]
    ds_read_b64_tr_b16 v[56:57], v10 offset:36864
    v_mfma_f32_16x16x32_bf16 v[32:35], v[136:139], v[112:115], v[32:35]
    s_waitcnt lgkmcnt(8)
    ds_read_b64_tr_b16 v[58:59], v10 offset:37376
    ds_read_b64_tr_b16 v[72:73], v11 offset:36864
    s_waitcnt lgkmcnt(15)
    v_mfma_f32_16x16x32_bf16 v[20:23], v[132:135], v[80:83], v[20:23]
    ds_read_b64_tr_b16 v[74:75], v11 offset:37376
    v_mfma_f32_16x16x32_bf16 v[36:39], v[132:135], v[112:115], v[36:39]
    ds_read_b64_tr_b16 v[124:125], v12 offset:36864
    ds_read_b64_tr_b16 v[126:127], v12 offset:37376
    s_waitcnt lgkmcnt(15)
    v_mfma_f32_16x16x32_bf16 v[24:27], v[100:103], v[80:83], v[24:27]
    ds_read_b64_tr_b16 v[152:153], v13 offset:36864
    v_mfma_f32_16x16x32_bf16 v[40:43], v[100:103], v[112:115], v[40:43]
    ds_read_b64_tr_b16 v[154:155], v13 offset:37376
    s_waitcnt lgkmcnt(15)
    v_mfma_f32_16x16x32_bf16 v[28:31], v[160:163], v[80:83], v[28:31]
    v_mfma_f32_16x16x32_bf16 v[44:47], v[160:163], v[112:115], v[44:47]
    s_waitcnt lgkmcnt(14)
    v_mfma_f32_16x16x32_bf16 v[16:19], v[108:111], v[140:143], v[16:19]
    v_mfma_f32_16x16x32_bf16 v[32:35], v[108:111], v[120:123], v[32:35]
    s_waitcnt lgkmcnt(12)
    v_mfma_f32_16x16x32_bf16 v[20:23], v[116:119], v[140:143], v[20:23]
    s_waitcnt lgkmcnt(0)
    v_mov_b32 v165, 10
    s_mov_b64 exec, 1
    ds_write_b32 v4, v165 offset:0
    s_mov_b64 exec, -1
    s_nop 0
    v_mfma_f32_16x16x32_bf16 v[36:39], v[116:119], v[120:123], v[36:39]
    v_mfma_f32_16x16x32_bf16 v[24:27], v[96:99], v[140:143], v[24:27]
    v_mfma_f32_16x16x32_bf16 v[40:43], v[96:99], v[120:123], v[40:43]
    v_mfma_f32_16x16x32_bf16 v[28:31], v[68:71], v[140:143], v[28:31]
    v_mfma_f32_16x16x32_bf16 v[44:47], v[68:71], v[120:123], v[44:47]
    v_mfma_f32_16x16x32_bf16 v[16:19], v[56:59], v[144:147], v[16:19]
    v_mfma_f32_16x16x32_bf16 v[32:35], v[56:59], v[156:159], v[32:35]
    v_mfma_f32_16x16x32_bf16 v[20:23], v[72:75], v[144:147], v[20:23]
    v_mfma_f32_16x16x32_bf16 v[36:39], v[72:75], v[156:159], v[36:39]
    v_mfma_f32_16x16x32_bf16 v[24:27], v[124:127], v[144:147], v[24:27]
    v_mfma_f32_16x16x32_bf16 v[40:43], v[124:127], v[156:159], v[40:43]
    v_mfma_f32_16x16x32_bf16 v[28:31], v[152:155], v[144:147], v[28:31]
    v_mfma_f32_16x16x32_bf16 v[44:47], v[152:155], v[156:159], v[44:47]
    s_setprio 3
    s_mov_b32 s40, 0x21317218
    s_mov_b32 s41, s40
    s_mov_b32 s74, 0x358637bd
    s_mov_b32 s75, s74
    s_mov_b32 s76, 0x5d800000
    s_mov_b32 s77, s76
    v_and_b32 v2, 15, v0
    v_lshlrev_b32 v2, 2, v2
    s_lshl_b32 s42, s3, 7
    s_add_u32 s42, s42, 155648
    v_add_u32 v2, s42, v2
    v_add_u32 v3, 1024, v2
    v_and_b32_e64 v5, 0x30, v0
    v_add_u32 v5, 158208, v5

    ds_read2_b32 v[48:49], v2 offset0:0 offset1:0
    ds_read2_b32 v[50:51], v2 offset0:16 offset1:16
    ds_read_b128 v[56:59], v5 offset:0
    ds_read_b128 v[60:63], v5 offset:64
    ds_read_b128 v[64:67], v5 offset:128
    ds_read_b128 v[68:71], v5 offset:192
    ds_read2_b32 v[52:53], v3 offset0:0 offset1:0
    ds_read2_b32 v[54:55], v3 offset0:16 offset1:16
    v_lshlrev_b32 v6, 4, v0
    v_lshlrev_b32 v8, 2, v0
    v_add_u32 v8, 32768, v8
    s_lshl_b32 s79, s32, 18
    s_lshl_b32 s80, s3, 16
    s_add_u32 s79, s79, s80
    s_lshl_b32 s80, s10, 11
    s_add_u32 s79, s79, s80
    s_add_u32 s80, s79, 0x8000
    s_lshl_b32 s45, s32, 2
    s_add_u32 s45, s45, s3
    s_lshl_b32 s45, s45, 10
    s_mov_b32 s46, 0x3fb8aa3b
    v_mov_b32 v11, 0x35c1a2a0

    s_add_u32 s54, s45, 0x835000
    s_add_u32 s54, s72, s54
    s_addc_u32 s55, s73, 0
    s_waitcnt lgkmcnt(5)
    v_pk_fma_f32 v[16:17], v[56:57], v[48:49], v[16:17]
    v_pk_fma_f32 v[18:19], v[58:59], v[48:49], v[18:19]
    v_pk_fma_f32 v[32:33], v[56:57], v[50:51], v[32:33]
    v_pk_fma_f32 v[34:35], v[58:59], v[50:51], v[34:35]
    s_waitcnt lgkmcnt(4)
    v_pk_fma_f32 v[20:21], v[60:61], v[48:49], v[20:21]
    v_pk_fma_f32 v[22:23], v[62:63], v[48:49], v[22:23]
    v_pk_fma_f32 v[36:37], v[60:61], v[50:51], v[36:37]
    v_pk_fma_f32 v[38:39], v[62:63], v[50:51], v[38:39]
    s_waitcnt lgkmcnt(3)
    s_branch IW_s2
IW_w2:
    s_branch IW_r2
IW_s2:
    v_pk_fma_f32 v[24:25], v[64:65], v[48:49], v[24:25]
    v_pk_fma_f32 v[26:27], v[66:67], v[48:49], v[26:27]
    v_pk_fma_f32 v[40:41], v[64:65], v[50:51], v[40:41]
    v_pk_fma_f32 v[42:43], v[66:67], v[50:51], v[42:43]
    s_waitcnt lgkmcnt(2)
    v_pk_fma_f32 v[28:29], v[68:69], v[48:49], v[28:29]
    v_pk_fma_f32 v[30:31], v[70:71], v[48:49], v[30:31]
    v_pk_fma_f32 v[44:45], v[68:69], v[50:51], v[44:45]
    v_pk_fma_f32 v[46:47], v[70:71], v[50:51], v[46:47]
    s_waitcnt lgkmcnt(1)
    s_nop 0
    v_pk_mul_f32 v[16:17], v[16:17], v[52:53]
    v_pk_mul_f32 v[18:19], v[18:19], v[52:53]
    v_pk_mul_f32 v[20:21], v[20:21], v[52:53]
    v_pk_mul_f32 v[22:23], v[22:23], v[52:53]
    v_pk_mul_f32 v[24:25], v[24:25], v[52:53]
    v_pk_mul_f32 v[26:27], v[26:27], v[52:53]
    v_pk_mul_f32 v[28:29], v[28:29], v[52:53]
    v_pk_mul_f32 v[30:31], v[30:31], v[52:53]
    s_waitcnt lgkmcnt(0)
    s_nop 0
    v_pk_mul_f32 v[32:33], v[32:33], v[54:55]
    v_pk_mul_f32 v[34:35], v[34:35], v[54:55]
    v_pk_mul_f32 v[36:37], v[36:37], v[54:55]
    v_pk_mul_f32 v[38:39], v[38:39], v[54:55]
    v_pk_mul_f32 v[40:41], v[40:41], v[54:55]
    v_pk_mul_f32 v[42:43], v[42:43], v[54:55]
    v_pk_mul_f32 v[44:45], v[44:45], v[54:55]
    v_pk_mul_f32 v[46:47], v[46:47], v[54:55]
    v_exp_f32 v80, v16 clamp
    v_exp_f32 v81, v17 clamp
    v_exp_f32 v82, v18 clamp
    v_exp_f32 v83, v19 clamp
    v_exp_f32 v84, v20 clamp
    v_exp_f32 v85, v21 clamp
    v_exp_f32 v86, v22 clamp
    v_exp_f32 v87, v23 clamp
    v_exp_f32 v88, v24 clamp
    v_exp_f32 v89, v25 clamp
    v_exp_f32 v90, v26 clamp
    v_exp_f32 v91, v27 clamp
    v_exp_f32 v92, v28 clamp
    v_exp_f32 v93, v29 clamp
    v_exp_f32 v94, v30 clamp
    v_exp_f32 v95, v31 clamp
    v_exp_f32 v96, v32 clamp
    v_exp_f32 v97, v33 clamp
    v_exp_f32 v98, v34 clamp
    v_exp_f32 v99, v35 clamp
    v_exp_f32 v100, v36 clamp
    v_exp_f32 v101, v37 clamp
    v_exp_f32 v102, v38 clamp
    v_exp_f32 v103, v39 clamp
    v_exp_f32 v104, v40 clamp
    v_exp_f32 v105, v41 clamp
    v_exp_f32 v106, v42 clamp
    v_exp_f32 v107, v43 clamp
    v_exp_f32 v108, v44 clamp
    v_exp_f32 v109, v45 clamp
    v_exp_f32 v110, v46 clamp
    v_exp_f32 v111, v47 clamp
    v_pk_mul_f32 v[16:17], v[16:17], s[40:41] clamp
    v_pk_mul_f32 v[18:19], v[18:19], s[40:41] clamp
    v_pk_mul_f32 v[20:21], v[20:21], s[40:41] clamp
    v_pk_mul_f32 v[22:23], v[22:23], s[40:41] clamp
    v_pk_mul_f32 v[24:25], v[24:25], s[40:41] clamp
    v_pk_mul_f32 v[26:27], v[26:27], s[40:41] clamp
    v_pk_mul_f32 v[28:29], v[28:29], s[40:41] clamp
    v_pk_mul_f32 v[30:31], v[30:31], s[40:41] clamp
    v_pk_mul_f32 v[32:33], v[32:33], s[40:41] clamp
    v_pk_mul_f32 v[34:35], v[34:35], s[40:41] clamp
    v_pk_mul_f32 v[36:37], v[36:37], s[40:41] clamp
    v_pk_mul_f32 v[38:39], v[38:39], s[40:41] clamp
    v_pk_mul_f32 v[40:41], v[40:41], s[40:41] clamp
    v_pk_mul_f32 v[42:43], v[42:43], s[40:41] clamp
    v_pk_mul_f32 v[44:45], v[44:45], s[40:41] clamp
    v_pk_mul_f32 v[46:47], v[46:47], s[40:41] clamp
    v_pk_add_f32 v[80:81], v[80:81], s[74:75]
    v_pk_add_f32 v[82:83], v[82:83], s[74:75]
    v_pk_add_f32 v[84:85], v[84:85], s[74:75]
    v_pk_add_f32 v[86:87], v[86:87], s[74:75]
    v_pk_add_f32 v[88:89], v[88:89], s[74:75]
    v_pk_add_f32 v[90:91], v[90:91], s[74:75]
    v_pk_add_f32 v[92:93], v[92:93], s[74:75]
    v_pk_add_f32 v[94:95], v[94:95], s[74:75]
    v_pk_add_f32 v[96:97], v[96:97], s[74:75]
    v_pk_add_f32 v[98:99], v[98:99], s[74:75]
    v_pk_add_f32 v[100:101], v[100:101], s[74:75]
    v_pk_add_f32 v[102:103], v[102:103], s[74:75]
    v_pk_add_f32 v[104:105], v[104:105], s[74:75]
    v_pk_add_f32 v[106:107], v[106:107], s[74:75]
    v_pk_add_f32 v[108:109], v[108:109], s[74:75]
    v_pk_add_f32 v[110:111], v[110:111], s[74:75]
    v_pk_fma_f32 v[16:17], v[16:17], s[76:77], v[80:81]
    v_pk_fma_f32 v[18:19], v[18:19], s[76:77], v[82:83]
    v_pk_fma_f32 v[20:21], v[20:21], s[76:77], v[84:85]
    v_pk_fma_f32 v[22:23], v[22:23], s[76:77], v[86:87]
    v_pk_fma_f32 v[24:25], v[24:25], s[76:77], v[88:89]
    v_pk_fma_f32 v[26:27], v[26:27], s[76:77], v[90:91]
    v_pk_fma_f32 v[28:29], v[28:29], s[76:77], v[92:93]
    v_pk_fma_f32 v[30:31], v[30:31], s[76:77], v[94:95]
    v_pk_fma_f32 v[32:33], v[32:33], s[76:77], v[96:97]
    v_pk_fma_f32 v[34:35], v[34:35], s[76:77], v[98:99]
    v_pk_fma_f32 v[36:37], v[36:37], s[76:77], v[100:101]
    v_pk_fma_f32 v[38:39], v[38:39], s[76:77], v[102:103]
    v_pk_fma_f32 v[40:41], v[40:41], s[76:77], v[104:105]
    v_pk_fma_f32 v[42:43], v[42:43], s[76:77], v[106:107]
    v_pk_fma_f32 v[44:45], v[44:45], s[76:77], v[108:109]
    v_pk_fma_f32 v[46:47], v[46:47], s[76:77], v[110:111]
    v_cvt_pk_bf16_f32 v112, v16, v17
    v_cvt_pk_bf16_f32 v113, v18, v19
    v_cvt_pk_bf16_f32 v114, v20, v21
    v_cvt_pk_bf16_f32 v115, v22, v23
    v_cvt_pk_bf16_f32 v116, v24, v25
    v_cvt_pk_bf16_f32 v117, v26, v27
    v_cvt_pk_bf16_f32 v118, v28, v29
    v_cvt_pk_bf16_f32 v119, v30, v31
    v_cvt_pk_bf16_f32 v120, v32, v33
    v_cvt_pk_bf16_f32 v121, v34, v35
    v_cvt_pk_bf16_f32 v122, v36, v37
    v_cvt_pk_bf16_f32 v123, v38, v39
    v_cvt_pk_bf16_f32 v124, v40, v41
    v_cvt_pk_bf16_f32 v125, v42, v43
    v_cvt_pk_bf16_f32 v126, v44, v45
    v_cvt_pk_bf16_f32 v127, v46, v47
    v_and_b32 v9, 0xfffffff7, v1
    v_and_b32 v5, 0x30, v0
    v_add_u32 v5, 159232, v5
    ds_read_b32 v7, v9 offset:128
FW_7:
    s_waitcnt lgkmcnt(0)
    v_cmp_gt_u32 vcc, 1, v7
    s_cbranch_vccz FO_8
    s_sleep 1
    ds_read_b32 v7, v9 offset:128
    s_branch FW_7
FO_8:
    ds_read_b32 v7, v9 offset:128
FW_9:
    s_waitcnt lgkmcnt(0)
    v_cmp_gt_u32 vcc, 2, v7
    s_cbranch_vccz FO_10
    ds_read_b32 v7, v9 offset:128
    s_branch FW_9
FO_10:
    s_nop 0
    ds_read_b128 v[32:35], v5 offset:0
    ds_read_b128 v[36:39], v5 offset:64
    ds_read2st64_b32 v[16:17], v8 offset0:0 offset1:1
    ds_read2st64_b32 v[18:19], v8 offset0:2 offset1:3
    ds_read2st64_b32 v[20:21], v8 offset0:4 offset1:5
    ds_read2st64_b32 v[22:23], v8 offset0:6 offset1:7
    ds_read2st64_b32 v[24:25], v8 offset0:16 offset1:17
    ds_read2st64_b32 v[26:27], v8 offset0:18 offset1:19
    ds_read2st64_b32 v[28:29], v8 offset0:20 offset1:21
    ds_read2st64_b32 v[30:31], v8 offset0:22 offset1:23
    s_waitcnt lgkmcnt(5)
    s_nop 0
    ds_read_b128 v[56:59], v5 offset:128
    ds_read_b128 v[60:63], v5 offset:192
    ds_read2st64_b32 v[40:41], v8 offset0:8 offset1:9
    ds_read2st64_b32 v[42:43], v8 offset0:10 offset1:11
    ds_read2st64_b32 v[44:45], v8 offset0:12 offset1:13
    ds_read2st64_b32 v[46:47], v8 offset0:14 offset1:15
    ds_read2st64_b32 v[48:49], v8 offset0:24 offset1:25
    ds_read2st64_b32 v[50:51], v8 offset0:26 offset1:27
    ds_read2st64_b32 v[52:53], v8 offset0:28 offset1:29
    ds_read2st64_b32 v[54:55], v8 offset0:30 offset1:31
    s_waitcnt lgkmcnt(10)
    v_cvt_pk_bf16_f32 v136, v32, v33
    v_cvt_pk_bf16_f32 v137, v34, v35
    v_cvt_pk_bf16_f32 v138, v36, v37
    v_cvt_pk_bf16_f32 v139, v38, v39
    s_nop 1
    v_mfma_f32_16x16x32_bf16 v[72:75], v[136:139], v[112:115], 0
    v_mfma_f32_16x16x32_bf16 v[84:87], v[136:139], v[120:123], 0
    v_cvt_pk_bf16_f32 v128, v16, v17
    v_cvt_pk_bf16_f32 v129, v18, v19
    v_cvt_pk_bf16_f32 v130, v20, v21
    v_cvt_pk_bf16_f32 v131, v22, v23
    s_nop 1
    v_mfma_f32_16x16x32_bf16 v[64:67], v[128:131], v[112:115], 0
    v_mfma_f32_16x16x32_bf16 v[76:79], v[128:131], v[120:123], 0
    v_cvt_pk_bf16_f32 v132, v24, v25
    v_cvt_pk_bf16_f32 v133, v26, v27
    v_cvt_pk_bf16_f32 v134, v28, v29
    v_cvt_pk_bf16_f32 v135, v30, v31
    s_nop 1
    v_mfma_f32_16x16x32_bf16 v[68:71], v[132:135], v[112:115], 0
    v_mfma_f32_16x16x32_bf16 v[80:83], v[132:135], v[120:123], 0
    s_waitcnt lgkmcnt(0)
    v_cvt_pk_bf16_f32 v148, v56, v57
    v_cvt_pk_bf16_f32 v149, v58, v59
    v_cvt_pk_bf16_f32 v150, v60, v61
    v_cvt_pk_bf16_f32 v151, v62, v63
    v_fma_f32 v72, v72, s46, v11
    v_rcp_f32 v72, v72
    v_fma_f32 v84, v84, s46, v11
    v_rcp_f32 v84, v84
    v_mfma_f32_16x16x32_bf16 v[96:99], v[148:151], v[116:119], 0
    v_mfma_f32_16x16x32_bf16 v[108:111], v[148:151], v[124:127], 0
    v_cvt_pk_bf16_f32 v140, v40, v41
    v_cvt_pk_bf16_f32 v141, v42, v43
    v_cvt_pk_bf16_f32 v142, v44, v45
    v_cvt_pk_bf16_f32 v143, v46, v47
    s_nop 1
    v_mfma_f32_16x16x32_bf16 v[88:91], v[140:143], v[116:119], 0
    v_mfma_f32_16x16x32_bf16 v[100:103], v[140:143], v[124:127], 0
    v_mul_f32 v64, v64, v72
    v_mul_f32 v65, v65, v72
    v_mul_f32 v66, v66, v72
    v_mul_f32 v67, v67, v72
    v_mul_f32 v68, v68, v72
    v_mul_f32 v69, v69, v72
    v_mul_f32 v70, v70, v72
    v_mul_f32 v71, v71, v72
    v_cvt_pk_bf16_f32 v16, v64, v65
    v_cvt_pk_bf16_f32 v17, v66, v67
    v_cvt_pk_bf16_f32 v18, v68, v69
    v_cvt_pk_bf16_f32 v19, v70, v71
    buffer_store_dwordx4 v[16:19], v6, s[16:19], s79 offen offset:0 sc0 sc1
    v_cvt_pk_bf16_f32 v144, v48, v49
    v_cvt_pk_bf16_f32 v145, v50, v51
    v_cvt_pk_bf16_f32 v146, v52, v53
    v_cvt_pk_bf16_f32 v147, v54, v55
    s_nop 1
    v_mfma_f32_16x16x32_bf16 v[92:95], v[144:147], v[116:119], 0
    v_mfma_f32_16x16x32_bf16 v[104:107], v[144:147], v[124:127], 0
    v_mul_f32 v76, v76, v84
    v_mul_f32 v77, v77, v84
    v_mul_f32 v78, v78, v84
    v_mul_f32 v79, v79, v84
    v_mul_f32 v80, v80, v84
    v_mul_f32 v81, v81, v84
    v_mul_f32 v82, v82, v84
    v_mul_f32 v83, v83, v84
    v_cvt_pk_bf16_f32 v20, v76, v77
    v_cvt_pk_bf16_f32 v21, v78, v79
    v_cvt_pk_bf16_f32 v22, v80, v81
    v_cvt_pk_bf16_f32 v23, v82, v83
    buffer_store_dwordx4 v[20:23], v6, s[16:19], s80 offen offset:0 sc0 sc1
    v_fma_f32 v96, v96, s46, v11
    v_rcp_f32 v96, v96
    v_fma_f32 v108, v108, s46, v11
    v_rcp_f32 v108, v108
    v_mul_f32 v88, v88, v96
    v_mul_f32 v89, v89, v96
    v_mul_f32 v90, v90, v96
    v_mul_f32 v91, v91, v96
    v_mul_f32 v92, v92, v96
    v_mul_f32 v93, v93, v96
    v_mul_f32 v94, v94, v96
    v_mul_f32 v95, v95, v96
    v_cvt_pk_bf16_f32 v24, v88, v89
    v_cvt_pk_bf16_f32 v25, v90, v91
    v_cvt_pk_bf16_f32 v26, v92, v93
    v_cvt_pk_bf16_f32 v27, v94, v95
    buffer_store_dwordx4 v[24:27], v6, s[16:19], s79 offen offset:1024 sc0 sc1
    v_mul_f32 v100, v100, v108
    v_mul_f32 v101, v101, v108
    v_mul_f32 v102, v102, v108
    v_mul_f32 v103, v103, v108
    v_mul_f32 v104, v104, v108
    v_mul_f32 v105, v105, v108
    v_mul_f32 v106, v106, v108
    v_mul_f32 v107, v107, v108
    v_cvt_pk_bf16_f32 v28, v100, v101
    v_cvt_pk_bf16_f32 v29, v102, v103
    v_cvt_pk_bf16_f32 v30, v104, v105
    v_cvt_pk_bf16_f32 v31, v106, v107
    buffer_store_dwordx4 v[28:31], v6, s[16:19], s80 offen offset:1024 sc0 sc1
    s_mov_b64 exec, 1
    ds_write_b32 v4, v164 offset:144
    s_waitcnt vmcnt(0)
    s_mov_b32 s45, 1
    s_atomic_add s45, s[54:55], 0x0
    s_atomic_add s45, s[54:55], 0x80
    s_atomic_add s45, s[54:55], 0x100
    s_atomic_add s45, s[54:55], 0x180
    ds_add_u32 v4, v164 offset:144
    s_mov_b64 exec, -1
    s_cmp_lg_u32 s3, 0
    s_cbranch_scc1 F_end
    s_setprio 3
    s_lshr_b32 s50, s29, 1
    s_lshl_b32 s50, s50, 2
    s_and_b32 s51, s28, 3
    s_add_u32 s50, s50, s51
    s_lshl_b32 s50, s50, 7
    s_add_u32 s56, s50, 0x845000
    s_add_u32 s56, s72, s56
    s_addc_u32 s57, s73, 0
    v_mov_b32 v2, 159096
    ds_read_b32 v7, v2 offset:0
FW_11:
    s_waitcnt lgkmcnt(0)
    v_cmp_gt_u32 vcc, 1, v7
    s_cbranch_vccz FO_12
    s_sleep 2
    ds_read_b32 v7, v2 offset:0
    s_branch FW_11
FO_12:
    v_and_b32 v2, 7, v0
    v_lshlrev_b32 v2, 2, v2
    v_add_u32 v2, 158976, v2
    ds_read_b32 v2, v2
    s_sub_u32 s51, 15, s28
    s_waitcnt lgkmcnt(0)
    v_bfe_u32 v2, v2, 7, 4
    v_cmp_eq_u32 vcc, s51, v2
    s_cbranch_vccz F_ny

    v_lshrrev_b32 v2, 4, v0
    v_and_b32 v6, 15, v0
    v_lshlrev_b32 v6, 4, v6
    v_lshl_add_u32 v2, v2, 12, v6
    s_lshl_b32 s50, s29, 8
    s_add_u32 s50, s50, 135168

SP_13:
    s_load_dword s58, s[56:57], 0 glc
    s_waitcnt lgkmcnt(0)
    s_cmp_ge_u32 s58, 32
    s_cbranch_scc1 SD_14
    s_sleep 2
    s_branch SP_13
SD_14:
    s_mov_b32 m0, 159744
    s_nop 0
    buffer_load_dwordx4 v2, s[24:27], s50 offen sc0 sc1 lds
    s_add_u32 s50, s50, 16384
    s_add_u32 m0, m0, 1024
    s_nop 0
    buffer_load_dwordx4 v2, s[24:27], s50 offen sc0 sc1 lds
    s_waitcnt vmcnt(0)
    v_mov_b32 v7, 1
    s_mov_b64 exec, 1
    ds_write_b32 v4, v7 offset:96
    s_mov_b64 exec, -1
F_ny:
F_end:
    s_endpgm
F_nl:
    s_sub_u32 s3, s3, 4
    s_setprio 2
    s_lshr_b32 s36, s3, 1
    s_and_b32 s37, s3, 1
    v_and_b32 v1, 15, v0
    v_lshrrev_b32 v2, 4, v0
    v_lshrrev_b32 v3, 1, v1
    v_xor_b32 v3, v3, v2
    v_lshlrev_b32 v3, 4, v3
    v_lshlrev_b32 v1, 7, v1
    s_lshl_b32 s38, s36, 13
    v_add3_u32 v4, v1, v3, s38
    v_xor_b32 v5, 64, v4
    v_add_u32 v6, 0x10000, v4
    v_add_u32 v7, 0x10000, v5
    v_bfe_u32 v1, v0, 2, 2
    v_lshl_add_u32 v3, v2, 3, v1
    v_lshrrev_b32 v1, 1, v1
    v_and_b32 v2, 1, v2
    v_lshl_add_u32 v1, v2, 1, v1
    s_lshl_b32 s38, s37, 1
    s_add_u32 s38, s38, s36
    v_xor_b32 v1, s38, v1
    v_lshlrev_b32 v1, 5, v1
    v_lshl_add_u32 v1, v3, 7, v1
    v_and_b32 v2, 3, v0
    v_lshl_add_u32 v1, v2, 3, v1
    v_add_u32 v8, 0x10000, v1
    v_xor_b32 v9, 32, v8
    v_add_u32 v10, 0x8000, v8
    v_add_u32 v11, 0x8000, v9
    s_mov_b32 s40, 0x21317218
    s_mov_b32 s41, s40
    s_mov_b32 s74, 0x358637bd
    s_mov_b32 s75, s74
    s_mov_b32 s76, 0x5d800000
    s_mov_b32 s77, s76
    v_and_b32 v164, 0x30, v0
    s_lshl_b32 s42, s36, 8
    s_add_u32 s42, s42, 155648
    v_add_u32 v164, s42, v164
    v_and_b32 v165, 15, v0
    v_lshlrev_b32 v165, 2, v165
    s_lshl_b32 s42, s38, 6
    s_add_u32 s42, s42, 158208
    v_add_u32 v165, s42, v165
    s_lshl_b32 s42, s3, 2
    s_add_u32 s42, s42, 159040
    v_mov_b32 v3, s42
    v_lshlrev_b32 v1, 2, v2
    v_add_u32 v1, 159040, v1
    v_xor_b32 v2, 64, v165
    s_lshl_b32 s44, s33, 1
    s_add_u32 s44, s44, s37
    s_mul_i32 s45, s44, 4224
    s_mul_i32 s46, s36, 3072
    s_add_u32 s46, s46, s45
    s_lshl_b32 s47, s36, 10
    s_add_u32 s47, s47, 1024
    s_add_u32 s47, s47, s45
    s_lshl_b32 s48, s36, 6
    s_add_u32 s48, s48, 4096
    s_add_u32 s48, s48, s45
    s_lshl_b32 s49, s44, 10
    s_lshl_b32 s52, s3, 11
    s_add_u32 s52, s52, 114688
    s_lshl_b32 s53, s3, 7
    s_lshl_b32 s43, s36, 6
    s_add_u32 s53, s53, s43
    s_add_u32 s53, s53, 159232
    s_mov_b32 s50, 159068
    s_waitcnt lgkmcnt(0)
    s_lshl_b32 s64, s28, 7
    s_lshl_b32 s65, s3, 5
    s_add_u32 s64, s64, s65
    s_lshl_b32 s42, s64, 11
    s_lshl_b32 s65, s29, 7
    s_add_u32 s42, s42, s65
    s_add_u32 s43, s42, 0x8000
    s_lshl_b32 s66, s44, 1
    s_add_u32 s66, s66, s36
    s_lshl_b32 s66, s66, 4
    s_add_u32 s66, s66, s32
    s_lshl_b32 s66, s66, 10

    s_mov_b32 s12, s4
    s_mov_b32 s13, s5
    s_mov_b32 s14, 0x400000
    s_mov_b32 s15, 0x00020000
    s_mov_b32 s16, s6
    s_mov_b32 s17, s7
    s_mov_b32 s18, 0x600000
    s_mov_b32 s19, 0x00020000
    s_mov_b32 s20, s8
    s_mov_b32 s21, s9
    s_mov_b32 s22, 0x200000
    s_mov_b32 s23, 0x00020000
    s_add_u32 s24, s72, 0x800000
    s_addc_u32 s25, s73, 0
    s_mov_b32 s26, 0x48000
    s_mov_b32 s27, 0x00020000
    s_add_u32 s84, s72, 0xa00000
    s_addc_u32 s85, s73, 0
    s_mov_b32 s86, 0x100000
    s_mov_b32 s87, 0x00020000
    s_barrier
    s_nop 0
    ds_read_b128 v[12:15], v4 offset:0
    ds_read_b64_tr_b16 v[44:45], v8 offset:0
    ds_read_b64_tr_b16 v[46:47], v8 offset:512
    ds_read_b128 v[16:19], v4 offset:2048
    ds_read_b128 v[20:23], v4 offset:4096
    ds_read_b128 v[24:27], v4 offset:6144
    ds_read_b64_tr_b16 v[48:49], v9 offset:0
    ds_read_b64_tr_b16 v[50:51], v9 offset:512
    ds_read_b64_tr_b16 v[52:53], v8 offset:8192
    ds_read_b64_tr_b16 v[54:55], v8 offset:8704
    ds_read_b64_tr_b16 v[56:57], v9 offset:8192
    ds_read_b64_tr_b16 v[58:59], v9 offset:8704
    s_waitcnt lgkmcnt(9)
    v_mfma_f32_16x16x32_bf16 v[100:103], v[12:15], v[44:47], 0
    ds_read_b128 v[28:31], v5 offset:0
    s_waitcnt lgkmcnt(9)
    v_mfma_f32_16x16x32_bf16 v[104:107], v[16:19], v[44:47], 0
    ds_read_b64_tr_b16 v[60:61], v8 offset:4096
    s_waitcnt lgkmcnt(9)
    v_mfma_f32_16x16x32_bf16 v[108:111], v[20:23], v[44:47], 0
    ds_read_b64_tr_b16 v[62:63], v8 offset:4608
    s_waitcnt lgkmcnt(9)
    v_mfma_f32_16x16x32_bf16 v[112:115], v[24:27], v[44:47], 0
    ds_read_b128 v[32:35], v5 offset:2048
    s_waitcnt lgkmcnt(8)
    s_nop 0
    v_mfma_f32_16x16x32_bf16 v[116:119], v[12:15], v[48:51], 0
    ds_read_b128 v[36:39], v5 offset:4096
    v_mfma_f32_16x16x32_bf16 v[120:123], v[16:19], v[48:51], 0
    ds_read_b128 v[40:43], v5 offset:6144
    v_mfma_f32_16x16x32_bf16 v[124:127], v[20:23], v[48:51], 0
    ds_read_b64_tr_b16 v[64:65], v9 offset:4096
    v_mfma_f32_16x16x32_bf16 v[128:131], v[24:27], v[48:51], 0
    ds_read_b64_tr_b16 v[66:67], v9 offset:4608
    s_waitcnt lgkmcnt(10)
    s_nop 0
    v_mfma_f32_16x16x32_bf16 v[132:135], v[12:15], v[52:55], 0
    ds_read_b64_tr_b16 v[44:45], v8 offset:12288
    v_mfma_f32_16x16x32_bf16 v[136:139], v[16:19], v[52:55], 0
    ds_read_b64_tr_b16 v[46:47], v8 offset:12800
    v_mfma_f32_16x16x32_bf16 v[140:143], v[20:23], v[52:55], 0
    ds_read_b64_tr_b16 v[48:49], v9 offset:12288
    v_mfma_f32_16x16x32_bf16 v[144:147], v[24:27], v[52:55], 0
    ds_read_b64_tr_b16 v[50:51], v9 offset:12800
    s_waitcnt lgkmcnt(12)
    v_mfma_f32_16x16x32_bf16 v[148:151], v[12:15], v[56:59], 0
    v_mfma_f32_16x16x32_bf16 v[152:155], v[16:19], v[56:59], 0
    v_mfma_f32_16x16x32_bf16 v[156:159], v[20:23], v[56:59], 0
    v_mfma_f32_16x16x32_bf16 v[160:163], v[24:27], v[56:59], 0
    s_waitcnt lgkmcnt(9)
    v_mfma_f32_16x16x32_bf16 v[100:103], v[28:31], v[60:63], v[100:103]
    s_waitcnt lgkmcnt(8)
    v_mfma_f32_16x16x32_bf16 v[104:107], v[32:35], v[60:63], v[104:107]
    s_waitcnt lgkmcnt(0)
    s_barrier
    s_nop 0
    v_mfma_f32_16x16x32_bf16 v[108:111], v[36:39], v[60:63], v[108:111]
    ds_read_b128 v[12:15], v4 offset:16384
    v_mfma_f32_16x16x32_bf16 v[112:115], v[40:43], v[60:63], v[112:115]
    ds_read_b64_tr_b16 v[52:53], v8 offset:16384
    v_mfma_f32_16x16x32_bf16 v[116:119], v[28:31], v[64:67], v[116:119]
    ds_read_b64_tr_b16 v[54:55], v8 offset:16896
    v_mfma_f32_16x16x32_bf16 v[120:123], v[32:35], v[64:67], v[120:123]
    ds_read_b128 v[16:19], v4 offset:18432
    v_mfma_f32_16x16x32_bf16 v[124:127], v[36:39], v[64:67], v[124:127]
    ds_read_b128 v[20:23], v4 offset:20480
    v_mfma_f32_16x16x32_bf16 v[128:131], v[40:43], v[64:67], v[128:131]
    ds_read_b128 v[24:27], v4 offset:22528
    v_mfma_f32_16x16x32_bf16 v[132:135], v[28:31], v[44:47], v[132:135]
    ds_read_b64_tr_b16 v[56:57], v9 offset:16384
    v_mfma_f32_16x16x32_bf16 v[136:139], v[32:35], v[44:47], v[136:139]
    ds_read_b64_tr_b16 v[58:59], v9 offset:16896
    v_mfma_f32_16x16x32_bf16 v[140:143], v[36:39], v[44:47], v[140:143]
    ds_read_b64_tr_b16 v[60:61], v8 offset:24576
    v_mfma_f32_16x16x32_bf16 v[144:147], v[40:43], v[44:47], v[144:147]
    ds_read_b64_tr_b16 v[62:63], v8 offset:25088
    v_mfma_f32_16x16x32_bf16 v[148:151], v[28:31], v[48:51], v[148:151]
    ds_read_b64_tr_b16 v[64:65], v9 offset:24576
    v_mfma_f32_16x16x32_bf16 v[152:155], v[32:35], v[48:51], v[152:155]
    ds_read_b64_tr_b16 v[66:67], v9 offset:25088
    v_mfma_f32_16x16x32_bf16 v[156:159], v[36:39], v[48:51], v[156:159]
    v_mfma_f32_16x16x32_bf16 v[160:163], v[40:43], v[48:51], v[160:163]
    s_waitcnt lgkmcnt(9)
    v_mfma_f32_16x16x32_bf16 v[100:103], v[12:15], v[52:55], v[100:103]
    ds_read_b128 v[28:31], v5 offset:16384
    s_waitcnt lgkmcnt(9)
    v_mfma_f32_16x16x32_bf16 v[104:107], v[16:19], v[52:55], v[104:107]
    ds_read_b64_tr_b16 v[44:45], v8 offset:20480
    s_waitcnt lgkmcnt(9)
    v_mfma_f32_16x16x32_bf16 v[108:111], v[20:23], v[52:55], v[108:111]
    ds_read_b64_tr_b16 v[46:47], v8 offset:20992
    s_waitcnt lgkmcnt(9)
    v_mfma_f32_16x16x32_bf16 v[112:115], v[24:27], v[52:55], v[112:115]
    ds_read_b128 v[32:35], v5 offset:18432
    s_waitcnt lgkmcnt(8)
    s_nop 0
    v_mfma_f32_16x16x32_bf16 v[116:119], v[12:15], v[56:59], v[116:119]
    ds_read_b128 v[36:39], v5 offset:20480
    v_mfma_f32_16x16x32_bf16 v[120:123], v[16:19], v[56:59], v[120:123]
    ds_read_b128 v[40:43], v5 offset:22528
    v_mfma_f32_16x16x32_bf16 v[124:127], v[20:23], v[56:59], v[124:127]
    ds_read_b64_tr_b16 v[48:49], v9 offset:20480
    v_mfma_f32_16x16x32_bf16 v[128:131], v[24:27], v[56:59], v[128:131]
    ds_read_b64_tr_b16 v[50:51], v9 offset:20992
    s_waitcnt lgkmcnt(10)
    s_nop 0
    v_mfma_f32_16x16x32_bf16 v[132:135], v[12:15], v[60:63], v[132:135]
    ds_read_b64_tr_b16 v[52:53], v8 offset:28672
    v_mfma_f32_16x16x32_bf16 v[136:139], v[16:19], v[60:63], v[136:139]
    ds_read_b64_tr_b16 v[54:55], v8 offset:29184
    v_mfma_f32_16x16x32_bf16 v[140:143], v[20:23], v[60:63], v[140:143]
    ds_read_b64_tr_b16 v[56:57], v9 offset:28672
    v_mfma_f32_16x16x32_bf16 v[144:147], v[24:27], v[60:63], v[144:147]
    ds_read_b64_tr_b16 v[58:59], v9 offset:29184
    s_waitcnt lgkmcnt(12)
    v_mfma_f32_16x16x32_bf16 v[148:151], v[12:15], v[64:67], v[148:151]
    v_mfma_f32_16x16x32_bf16 v[152:155], v[16:19], v[64:67], v[152:155]
    v_mfma_f32_16x16x32_bf16 v[156:159], v[20:23], v[64:67], v[156:159]
    v_mfma_f32_16x16x32_bf16 v[160:163], v[24:27], v[64:67], v[160:163]
    s_waitcnt lgkmcnt(9)
    v_mfma_f32_16x16x32_bf16 v[100:103], v[28:31], v[44:47], v[100:103]
    s_waitcnt lgkmcnt(8)
    v_mfma_f32_16x16x32_bf16 v[104:107], v[32:35], v[44:47], v[104:107]
    s_waitcnt lgkmcnt(0)
    s_barrier
    s_nop 0
    v_mfma_f32_16x16x32_bf16 v[108:111], v[36:39], v[44:47], v[108:111]
    ds_read_b128 v[12:15], v4 offset:32768
    v_mfma_f32_16x16x32_bf16 v[112:115], v[40:43], v[44:47], v[112:115]
    ds_read_b64_tr_b16 v[60:61], v10 offset:0
    v_mfma_f32_16x16x32_bf16 v[116:119], v[28:31], v[48:51], v[116:119]
    ds_read_b64_tr_b16 v[62:63], v10 offset:512
    v_mfma_f32_16x16x32_bf16 v[120:123], v[32:35], v[48:51], v[120:123]
    ds_read_b128 v[16:19], v4 offset:34816
    v_mfma_f32_16x16x32_bf16 v[124:127], v[36:39], v[48:51], v[124:127]
    ds_read_b128 v[20:23], v4 offset:36864
    v_mfma_f32_16x16x32_bf16 v[128:131], v[40:43], v[48:51], v[128:131]
    ds_read_b128 v[24:27], v4 offset:38912
    v_mfma_f32_16x16x32_bf16 v[132:135], v[28:31], v[52:55], v[132:135]
    ds_read_b64_tr_b16 v[64:65], v11 offset:0
    v_mfma_f32_16x16x32_bf16 v[136:139], v[32:35], v[52:55], v[136:139]
    ds_read_b64_tr_b16 v[66:67], v11 offset:512
    v_mfma_f32_16x16x32_bf16 v[140:143], v[36:39], v[52:55], v[140:143]
    ds_read_b64_tr_b16 v[44:45], v10 offset:8192
    v_mfma_f32_16x16x32_bf16 v[144:147], v[40:43], v[52:55], v[144:147]
    ds_read_b64_tr_b16 v[46:47], v10 offset:8704
    v_mfma_f32_16x16x32_bf16 v[148:151], v[28:31], v[56:59], v[148:151]
    ds_read_b64_tr_b16 v[48:49], v11 offset:8192
    v_mfma_f32_16x16x32_bf16 v[152:155], v[32:35], v[56:59], v[152:155]
    ds_read_b64_tr_b16 v[50:51], v11 offset:8704
    v_mfma_f32_16x16x32_bf16 v[156:159], v[36:39], v[56:59], v[156:159]
    v_mfma_f32_16x16x32_bf16 v[160:163], v[40:43], v[56:59], v[160:163]
    s_waitcnt lgkmcnt(9)
    v_mfma_f32_16x16x32_bf16 v[100:103], v[12:15], v[60:63], v[100:103]
    ds_read_b128 v[28:31], v5 offset:32768
    s_waitcnt lgkmcnt(9)
    v_mfma_f32_16x16x32_bf16 v[104:107], v[16:19], v[60:63], v[104:107]
    ds_read_b64_tr_b16 v[52:53], v10 offset:4096
    s_waitcnt lgkmcnt(9)
    v_mfma_f32_16x16x32_bf16 v[108:111], v[20:23], v[60:63], v[108:111]
    ds_read_b64_tr_b16 v[54:55], v10 offset:4608
    s_waitcnt lgkmcnt(9)
    v_mfma_f32_16x16x32_bf16 v[112:115], v[24:27], v[60:63], v[112:115]
    ds_read_b128 v[32:35], v5 offset:34816
    s_waitcnt lgkmcnt(8)
    s_nop 0
    v_mfma_f32_16x16x32_bf16 v[116:119], v[12:15], v[64:67], v[116:119]
    ds_read_b128 v[36:39], v5 offset:36864
    v_mfma_f32_16x16x32_bf16 v[120:123], v[16:19], v[64:67], v[120:123]
    ds_read_b128 v[40:43], v5 offset:38912
    v_mfma_f32_16x16x32_bf16 v[124:127], v[20:23], v[64:67], v[124:127]
    ds_read_b64_tr_b16 v[56:57], v11 offset:4096
    v_mfma_f32_16x16x32_bf16 v[128:131], v[24:27], v[64:67], v[128:131]
    ds_read_b64_tr_b16 v[58:59], v11 offset:4608
    s_waitcnt lgkmcnt(10)
    s_nop 0
    v_mfma_f32_16x16x32_bf16 v[132:135], v[12:15], v[44:47], v[132:135]
    ds_read_b64_tr_b16 v[60:61], v10 offset:12288
    v_mfma_f32_16x16x32_bf16 v[136:139], v[16:19], v[44:47], v[136:139]
    s_branch IW_s3
IW_w3:
    s_branch IW_r3
IW_s3:
    ds_read_b64_tr_b16 v[62:63], v10 offset:12800
    v_mfma_f32_16x16x32_bf16 v[140:143], v[20:23], v[44:47], v[140:143]
    ds_read_b64_tr_b16 v[64:65], v11 offset:12288
    v_mfma_f32_16x16x32_bf16 v[144:147], v[24:27], v[44:47], v[144:147]
    ds_read_b64_tr_b16 v[66:67], v11 offset:12800
    s_waitcnt lgkmcnt(12)
    v_mfma_f32_16x16x32_bf16 v[148:151], v[12:15], v[48:51], v[148:151]
    v_mfma_f32_16x16x32_bf16 v[152:155], v[16:19], v[48:51], v[152:155]
    v_mfma_f32_16x16x32_bf16 v[156:159], v[20:23], v[48:51], v[156:159]
    v_mfma_f32_16x16x32_bf16 v[160:163], v[24:27], v[48:51], v[160:163]
    s_waitcnt lgkmcnt(9)
    v_mfma_f32_16x16x32_bf16 v[100:103], v[28:31], v[52:55], v[100:103]
    s_waitcnt lgkmcnt(8)
    v_mfma_f32_16x16x32_bf16 v[104:107], v[32:35], v[52:55], v[104:107]
    s_waitcnt lgkmcnt(0)
    s_barrier
    s_nop 0
    v_mfma_f32_16x16x32_bf16 v[108:111], v[36:39], v[52:55], v[108:111]
    ds_read_b128 v[12:15], v4 offset:49152
    v_mfma_f32_16x16x32_bf16 v[112:115], v[40:43], v[52:55], v[112:115]
    ds_read_b64_tr_b16 v[44:45], v10 offset:32768
    v_mfma_f32_16x16x32_bf16 v[116:119], v[28:31], v[56:59], v[116:119]
    ds_read_b64_tr_b16 v[46:47], v10 offset:33280
    v_mfma_f32_16x16x32_bf16 v[120:123], v[32:35], v[56:59], v[120:123]
    ds_read_b128 v[16:19], v4 offset:51200
    v_mfma_f32_16x16x32_bf16 v[124:127], v[36:39], v[56:59], v[124:127]
    ds_read_b128 v[20:23], v4 offset:53248
    v_mfma_f32_16x16x32_bf16 v[128:131], v[40:43], v[56:59], v[128:131]
    ds_read_b128 v[24:27], v4 offset:55296
    v_mfma_f32_16x16x32_bf16 v[132:135], v[28:31], v[60:63], v[132:135]
    ds_read_b64_tr_b16 v[48:49], v11 offset:32768
    v_mfma_f32_16x16x32_bf16 v[136:139], v[32:35], v[60:63], v[136:139]
    ds_read_b64_tr_b16 v[50:51], v11 offset:33280
    v_mfma_f32_16x16x32_bf16 v[140:143], v[36:39], v[60:63], v[140:143]
    ds_read_b64_tr_b16 v[52:53], v8 offset:0
    v_mfma_f32_16x16x32_bf16 v[144:147], v[40:43], v[60:63], v[144:147]
    ds_read_b64_tr_b16 v[54:55], v8 offset:512
    v_mfma_f32_16x16x32_bf16 v[148:151], v[28:31], v[64:67], v[148:151]
    ds_read_b64_tr_b16 v[56:57], v9 offset:0
    v_mfma_f32_16x16x32_bf16 v[152:155], v[32:35], v[64:67], v[152:155]
    ds_read_b64_tr_b16 v[58:59], v9 offset:512
    v_mfma_f32_16x16x32_bf16 v[156:159], v[36:39], v[64:67], v[156:159]
    v_mfma_f32_16x16x32_bf16 v[160:163], v[40:43], v[64:67], v[160:163]
    s_waitcnt lgkmcnt(9)
    v_mfma_f32_16x16x32_bf16 v[100:103], v[12:15], v[44:47], v[100:103]
    ds_read_b128 v[28:31], v5 offset:49152
    s_waitcnt lgkmcnt(9)
    v_mfma_f32_16x16x32_bf16 v[104:107], v[16:19], v[44:47], v[104:107]
    ds_read_b64_tr_b16 v[60:61], v10 offset:36864
    s_waitcnt lgkmcnt(9)
    v_mfma_f32_16x16x32_bf16 v[108:111], v[20:23], v[44:47], v[108:111]
    ds_read_b64_tr_b16 v[62:63], v10 offset:37376
    s_waitcnt lgkmcnt(9)
    v_mfma_f32_16x16x32_bf16 v[112:115], v[24:27], v[44:47], v[112:115]
    ds_read_b128 v[32:35], v5 offset:51200
    s_waitcnt lgkmcnt(8)
    s_nop 0
    v_mfma_f32_16x16x32_bf16 v[116:119], v[12:15], v[48:51], v[116:119]
    ds_read_b128 v[36:39], v5 offset:53248
    v_mfma_f32_16x16x32_bf16 v[120:123], v[16:19], v[48:51], v[120:123]
    ds_read_b128 v[40:43], v5 offset:55296
    v_mfma_f32_16x16x32_bf16 v[124:127], v[20:23], v[48:51], v[124:127]
    ds_read_b64_tr_b16 v[64:65], v11 offset:36864
    v_mfma_f32_16x16x32_bf16 v[128:131], v[24:27], v[48:51], v[128:131]
    ds_read_b64_tr_b16 v[66:67], v11 offset:37376
    s_waitcnt lgkmcnt(10)
    s_nop 0
    v_mfma_f32_16x16x32_bf16 v[132:135], v[12:15], v[52:55], v[132:135]
    ds_read_b64_tr_b16 v[44:45], v8 offset:4096
    v_mfma_f32_16x16x32_bf16 v[136:139], v[16:19], v[52:55], v[136:139]
    ds_read_b64_tr_b16 v[46:47], v8 offset:4608
    v_mfma_f32_16x16x32_bf16 v[140:143], v[20:23], v[52:55], v[140:143]
    ds_read_b64_tr_b16 v[48:49], v9 offset:4096
    v_mfma_f32_16x16x32_bf16 v[144:147], v[24:27], v[52:55], v[144:147]
    ds_read_b64_tr_b16 v[50:51], v9 offset:4608
    s_waitcnt lgkmcnt(12)
    v_mfma_f32_16x16x32_bf16 v[148:151], v[12:15], v[56:59], v[148:151]
    v_mfma_f32_16x16x32_bf16 v[152:155], v[16:19], v[56:59], v[152:155]
    v_mfma_f32_16x16x32_bf16 v[156:159], v[20:23], v[56:59], v[156:159]
    v_mfma_f32_16x16x32_bf16 v[160:163], v[24:27], v[56:59], v[160:163]
    s_waitcnt lgkmcnt(9)
    v_mfma_f32_16x16x32_bf16 v[100:103], v[28:31], v[60:63], v[100:103]
    s_waitcnt lgkmcnt(8)
    v_mfma_f32_16x16x32_bf16 v[104:107], v[32:35], v[60:63], v[104:107]
    s_waitcnt lgkmcnt(0)
    s_barrier
    s_nop 0
    v_mfma_f32_16x16x32_bf16 v[108:111], v[36:39], v[60:63], v[108:111]
    ds_read_b128 v[12:15], v4 offset:0
    v_mfma_f32_16x16x32_bf16 v[112:115], v[40:43], v[60:63], v[112:115]
    ds_read_b64_tr_b16 v[52:53], v8 offset:8192
    v_mfma_f32_16x16x32_bf16 v[116:119], v[28:31], v[64:67], v[116:119]
    ds_read_b64_tr_b16 v[54:55], v8 offset:8704
    v_mfma_f32_16x16x32_bf16 v[120:123], v[32:35], v[64:67], v[120:123]
    ds_read_b128 v[16:19], v4 offset:2048
    v_mfma_f32_16x16x32_bf16 v[124:127], v[36:39], v[64:67], v[124:127]
    ds_read_b128 v[20:23], v4 offset:4096
    v_mfma_f32_16x16x32_bf16 v[128:131], v[40:43], v[64:67], v[128:131]
    ds_read_b128 v[24:27], v4 offset:6144
    v_mfma_f32_16x16x32_bf16 v[132:135], v[28:31], v[44:47], v[132:135]
    ds_read_b64_tr_b16 v[56:57], v9 offset:8192
    v_mfma_f32_16x16x32_bf16 v[136:139], v[32:35], v[44:47], v[136:139]
    ds_read_b64_tr_b16 v[58:59], v9 offset:8704
    v_mfma_f32_16x16x32_bf16 v[140:143], v[36:39], v[44:47], v[140:143]
    ds_read_b64_tr_b16 v[60:61], v8 offset:16384
    v_mfma_f32_16x16x32_bf16 v[144:147], v[40:43], v[44:47], v[144:147]
    ds_read_b64_tr_b16 v[62:63], v8 offset:16896
    v_mfma_f32_16x16x32_bf16 v[148:151], v[28:31], v[48:51], v[148:151]
    ds_read_b64_tr_b16 v[64:65], v9 offset:16384
    v_mfma_f32_16x16x32_bf16 v[152:155], v[32:35], v[48:51], v[152:155]
    ds_read_b64_tr_b16 v[66:67], v9 offset:16896
    v_mfma_f32_16x16x32_bf16 v[156:159], v[36:39], v[48:51], v[156:159]
    v_mfma_f32_16x16x32_bf16 v[160:163], v[40:43], v[48:51], v[160:163]
    s_waitcnt lgkmcnt(9)
    v_mfma_f32_16x16x32_bf16 v[100:103], v[12:15], v[52:55], v[100:103]
    ds_read_b128 v[28:31], v5 offset:0
    s_waitcnt lgkmcnt(9)
    v_mfma_f32_16x16x32_bf16 v[104:107], v[16:19], v[52:55], v[104:107]
    ds_read_b64_tr_b16 v[44:45], v8 offset:12288
    s_waitcnt lgkmcnt(9)
    v_mfma_f32_16x16x32_bf16 v[108:111], v[20:23], v[52:55], v[108:111]
    ds_read_b64_tr_b16 v[46:47], v8 offset:12800
    s_waitcnt lgkmcnt(9)
    v_mfma_f32_16x16x32_bf16 v[112:115], v[24:27], v[52:55], v[112:115]
    ds_read_b128 v[32:35], v5 offset:2048
    s_waitcnt lgkmcnt(8)
    s_nop 0
    v_mfma_f32_16x16x32_bf16 v[116:119], v[12:15], v[56:59], v[116:119]
    ds_read_b128 v[36:39], v5 offset:4096
    v_mfma_f32_16x16x32_bf16 v[120:123], v[16:19], v[56:59], v[120:123]
    ds_read_b128 v[40:43], v5 offset:6144
    v_mfma_f32_16x16x32_bf16 v[124:127], v[20:23], v[56:59], v[124:127]
    ds_read_b64_tr_b16 v[48:49], v9 offset:12288
    v_mfma_f32_16x16x32_bf16 v[128:131], v[24:27], v[56:59], v[128:131]
    ds_read_b64_tr_b16 v[50:51], v9 offset:12800
    s_waitcnt lgkmcnt(10)
    s_nop 0
    v_mfma_f32_16x16x32_bf16 v[132:135], v[12:15], v[60:63], v[132:135]
    ds_read_b64_tr_b16 v[52:53], v8 offset:20480
    v_mfma_f32_16x16x32_bf16 v[136:139], v[16:19], v[60:63], v[136:139]
    ds_read_b64_tr_b16 v[54:55], v8 offset:20992
    v_mfma_f32_16x16x32_bf16 v[140:143], v[20:23], v[60:63], v[140:143]
    ds_read_b64_tr_b16 v[56:57], v9 offset:20480
    v_mfma_f32_16x16x32_bf16 v[144:147], v[24:27], v[60:63], v[144:147]
    ds_read_b64_tr_b16 v[58:59], v9 offset:20992
    s_waitcnt lgkmcnt(12)
    v_mfma_f32_16x16x32_bf16 v[148:151], v[12:15], v[64:67], v[148:151]
    v_mfma_f32_16x16x32_bf16 v[152:155], v[16:19], v[64:67], v[152:155]
    v_mfma_f32_16x16x32_bf16 v[156:159], v[20:23], v[64:67], v[156:159]
    v_mfma_f32_16x16x32_bf16 v[160:163], v[24:27], v[64:67], v[160:163]
    s_waitcnt lgkmcnt(9)
    v_mfma_f32_16x16x32_bf16 v[100:103], v[28:31], v[44:47], v[100:103]
    s_waitcnt lgkmcnt(8)
    v_mfma_f32_16x16x32_bf16 v[104:107], v[32:35], v[44:47], v[104:107]
    s_waitcnt lgkmcnt(0)
    s_barrier
    s_nop 0
    v_mfma_f32_16x16x32_bf16 v[108:111], v[36:39], v[44:47], v[108:111]
    ds_read_b128 v[12:15], v4 offset:16384
    v_mfma_f32_16x16x32_bf16 v[112:115], v[40:43], v[44:47], v[112:115]
    ds_read_b64_tr_b16 v[60:61], v10 offset:0
    v_mfma_f32_16x16x32_bf16 v[116:119], v[28:31], v[48:51], v[116:119]
    ds_read_b64_tr_b16 v[62:63], v10 offset:512
    v_mfma_f32_16x16x32_bf16 v[120:123], v[32:35], v[48:51], v[120:123]
    ds_read_b128 v[16:19], v4 offset:18432
    v_mfma_f32_16x16x32_bf16 v[124:127], v[36:39], v[48:51], v[124:127]
    ds_read_b128 v[20:23], v4 offset:20480
    v_mfma_f32_16x16x32_bf16 v[128:131], v[40:43], v[48:51], v[128:131]
    ds_read_b128 v[24:27], v4 offset:22528
    v_mfma_f32_16x16x32_bf16 v[132:135], v[28:31], v[52:55], v[132:135]
    ds_read_b64_tr_b16 v[64:65], v11 offset:0
    v_mfma_f32_16x16x32_bf16 v[136:139], v[32:35], v[52:55], v[136:139]
    ds_read_b64_tr_b16 v[66:67], v11 offset:512
    v_mfma_f32_16x16x32_bf16 v[140:143], v[36:39], v[52:55], v[140:143]
    ds_read_b64_tr_b16 v[44:45], v10 offset:8192
    v_mfma_f32_16x16x32_bf16 v[144:147], v[40:43], v[52:55], v[144:147]
    ds_read_b64_tr_b16 v[46:47], v10 offset:8704
    v_mfma_f32_16x16x32_bf16 v[148:151], v[28:31], v[56:59], v[148:151]
    ds_read_b64_tr_b16 v[48:49], v11 offset:8192
    v_mfma_f32_16x16x32_bf16 v[152:155], v[32:35], v[56:59], v[152:155]
    ds_read_b64_tr_b16 v[50:51], v11 offset:8704
    v_mfma_f32_16x16x32_bf16 v[156:159], v[36:39], v[56:59], v[156:159]
    v_mfma_f32_16x16x32_bf16 v[160:163], v[40:43], v[56:59], v[160:163]
    s_waitcnt lgkmcnt(9)
    v_mfma_f32_16x16x32_bf16 v[100:103], v[12:15], v[60:63], v[100:103]
    ds_read_b128 v[28:31], v5 offset:16384
    s_waitcnt lgkmcnt(9)
    v_mfma_f32_16x16x32_bf16 v[104:107], v[16:19], v[60:63], v[104:107]
    ds_read_b64_tr_b16 v[52:53], v10 offset:4096
    s_waitcnt lgkmcnt(9)
    v_mfma_f32_16x16x32_bf16 v[108:111], v[20:23], v[60:63], v[108:111]
    ds_read_b64_tr_b16 v[54:55], v10 offset:4608
    s_waitcnt lgkmcnt(9)
    v_mfma_f32_16x16x32_bf16 v[112:115], v[24:27], v[60:63], v[112:115]
    ds_read_b128 v[32:35], v5 offset:18432
    s_waitcnt lgkmcnt(8)
    s_nop 0
    v_mfma_f32_16x16x32_bf16 v[116:119], v[12:15], v[64:67], v[116:119]
    ds_read_b128 v[36:39], v5 offset:20480
    v_mfma_f32_16x16x32_bf16 v[120:123], v[16:19], v[64:67], v[120:123]
    ds_read_b128 v[40:43], v5 offset:22528
    v_mfma_f32_16x16x32_bf16 v[124:127], v[20:23], v[64:67], v[124:127]
    ds_read_b64_tr_b16 v[56:57], v11 offset:4096
    v_mfma_f32_16x16x32_bf16 v[128:131], v[24:27], v[64:67], v[128:131]
    ds_read_b64_tr_b16 v[58:59], v11 offset:4608
    s_waitcnt lgkmcnt(10)
    s_nop 0
    v_mfma_f32_16x16x32_bf16 v[132:135], v[12:15], v[44:47], v[132:135]
    ds_read_b64_tr_b16 v[60:61], v10 offset:12288
    v_mfma_f32_16x16x32_bf16 v[136:139], v[16:19], v[44:47], v[136:139]
    ds_read_b64_tr_b16 v[62:63], v10 offset:12800
    v_mfma_f32_16x16x32_bf16 v[140:143], v[20:23], v[44:47], v[140:143]
    ds_read_b64_tr_b16 v[64:65], v11 offset:12288
    v_mfma_f32_16x16x32_bf16 v[144:147], v[24:27], v[44:47], v[144:147]
    ds_read_b64_tr_b16 v[66:67], v11 offset:12800
    s_waitcnt lgkmcnt(12)
    v_mfma_f32_16x16x32_bf16 v[148:151], v[12:15], v[48:51], v[148:151]
    v_mfma_f32_16x16x32_bf16 v[152:155], v[16:19], v[48:51], v[152:155]
    v_mfma_f32_16x16x32_bf16 v[156:159], v[20:23], v[48:51], v[156:159]
    v_mfma_f32_16x16x32_bf16 v[160:163], v[24:27], v[48:51], v[160:163]
    s_waitcnt lgkmcnt(9)
    v_mfma_f32_16x16x32_bf16 v[100:103], v[28:31], v[52:55], v[100:103]
    s_waitcnt lgkmcnt(8)
    v_mfma_f32_16x16x32_bf16 v[104:107], v[32:35], v[52:55], v[104:107]
    s_waitcnt lgkmcnt(0)
    s_barrier
    s_nop 0
    v_mfma_f32_16x16x32_bf16 v[108:111], v[36:39], v[52:55], v[108:111]
    ds_read_b128 v[12:15], v4 offset:32768
    v_mfma_f32_16x16x32_bf16 v[112:115], v[40:43], v[52:55], v[112:115]
    ds_read_b64_tr_b16 v[44:45], v8 offset:0
    v_mfma_f32_16x16x32_bf16 v[116:119], v[28:31], v[56:59], v[116:119]
    ds_read_b64_tr_b16 v[46:47], v8 offset:512
    v_mfma_f32_16x16x32_bf16 v[120:123], v[32:35], v[56:59], v[120:123]
    ds_read_b128 v[16:19], v4 offset:34816
    v_mfma_f32_16x16x32_bf16 v[124:127], v[36:39], v[56:59], v[124:127]
    ds_read_b128 v[20:23], v4 offset:36864
    v_mfma_f32_16x16x32_bf16 v[128:131], v[40:43], v[56:59], v[128:131]
    ds_read_b128 v[24:27], v4 offset:38912
    v_mfma_f32_16x16x32_bf16 v[132:135], v[28:31], v[60:63], v[132:135]
    ds_read_b64_tr_b16 v[48:49], v9 offset:0
    v_mfma_f32_16x16x32_bf16 v[136:139], v[32:35], v[60:63], v[136:139]
    ds_read_b64_tr_b16 v[50:51], v9 offset:512
    v_mfma_f32_16x16x32_bf16 v[140:143], v[36:39], v[60:63], v[140:143]
    ds_read_b64_tr_b16 v[52:53], v10 offset:16384
    v_mfma_f32_16x16x32_bf16 v[144:147], v[40:43], v[60:63], v[144:147]
    ds_read_b64_tr_b16 v[54:55], v10 offset:16896
    v_mfma_f32_16x16x32_bf16 v[148:151], v[28:31], v[64:67], v[148:151]
    ds_read_b64_tr_b16 v[56:57], v11 offset:16384
    v_mfma_f32_16x16x32_bf16 v[152:155], v[32:35], v[64:67], v[152:155]
    ds_read_b64_tr_b16 v[58:59], v11 offset:16896
    v_mfma_f32_16x16x32_bf16 v[156:159], v[36:39], v[64:67], v[156:159]
    v_mfma_f32_16x16x32_bf16 v[160:163], v[40:43], v[64:67], v[160:163]
    s_waitcnt lgkmcnt(9)
    v_mfma_f32_16x16x32_bf16 v[100:103], v[12:15], v[44:47], v[100:103]
    ds_read_b128 v[28:31], v5 offset:32768
    s_waitcnt lgkmcnt(9)
    v_mfma_f32_16x16x32_bf16 v[104:107], v[16:19], v[44:47], v[104:107]
    ds_read_b64_tr_b16 v[60:61], v8 offset:4096
    s_waitcnt lgkmcnt(9)
    v_mfma_f32_16x16x32_bf16 v[108:111], v[20:23], v[44:47], v[108:111]
    ds_read_b64_tr_b16 v[62:63], v8 offset:4608
    s_waitcnt lgkmcnt(9)
    v_mfma_f32_16x16x32_bf16 v[112:115], v[24:27], v[44:47], v[112:115]
    ds_read_b128 v[32:35], v5 offset:34816
    s_waitcnt lgkmcnt(8)
    s_nop 0
    v_mfma_f32_16x16x32_bf16 v[116:119], v[12:15], v[48:51], v[116:119]
    ds_read_b128 v[36:39], v5 offset:36864
    v_mfma_f32_16x16x32_bf16 v[120:123], v[16:19], v[48:51], v[120:123]
    ds_read_b128 v[40:43], v5 offset:38912
    v_mfma_f32_16x16x32_bf16 v[124:127], v[20:23], v[48:51], v[124:127]
    ds_read_b64_tr_b16 v[64:65], v9 offset:4096
    v_mfma_f32_16x16x32_bf16 v[128:131], v[24:27], v[48:51], v[128:131]
    ds_read_b64_tr_b16 v[66:67], v9 offset:4608
    s_waitcnt lgkmcnt(10)
    s_nop 0
    v_mfma_f32_16x16x32_bf16 v[132:135], v[12:15], v[52:55], v[132:135]
    ds_read_b64_tr_b16 v[44:45], v10 offset:20480
    v_mfma_f32_16x16x32_bf16 v[136:139], v[16:19], v[52:55], v[136:139]
    ds_read_b64_tr_b16 v[46:47], v10 offset:20992
    v_mfma_f32_16x16x32_bf16 v[140:143], v[20:23], v[52:55], v[140:143]
    ds_read_b64_tr_b16 v[48:49], v11 offset:20480
    v_mfma_f32_16x16x32_bf16 v[144:147], v[24:27], v[52:55], v[144:147]
    ds_read_b64_tr_b16 v[50:51], v11 offset:20992
    s_waitcnt lgkmcnt(12)
    v_mfma_f32_16x16x32_bf16 v[148:151], v[12:15], v[56:59], v[148:151]
    v_mfma_f32_16x16x32_bf16 v[152:155], v[16:19], v[56:59], v[152:155]
    v_mfma_f32_16x16x32_bf16 v[156:159], v[20:23], v[56:59], v[156:159]
    v_mfma_f32_16x16x32_bf16 v[160:163], v[24:27], v[56:59], v[160:163]
    s_waitcnt lgkmcnt(9)
    v_mfma_f32_16x16x32_bf16 v[100:103], v[28:31], v[60:63], v[100:103]
    s_waitcnt lgkmcnt(8)
    v_mfma_f32_16x16x32_bf16 v[104:107], v[32:35], v[60:63], v[104:107]
    s_waitcnt lgkmcnt(0)
    s_barrier
    s_nop 0
    v_mfma_f32_16x16x32_bf16 v[108:111], v[36:39], v[60:63], v[108:111]
    ds_read_b128 v[12:15], v4 offset:49152
    v_mfma_f32_16x16x32_bf16 v[112:115], v[40:43], v[60:63], v[112:115]
    ds_read_b64_tr_b16 v[52:53], v10 offset:24576
    v_mfma_f32_16x16x32_bf16 v[116:119], v[28:31], v[64:67], v[116:119]
    ds_read_b64_tr_b16 v[54:55], v10 offset:25088
    v_mfma_f32_16x16x32_bf16 v[120:123], v[32:35], v[64:67], v[120:123]
    ds_read_b128 v[16:19], v4 offset:51200
    v_mfma_f32_16x16x32_bf16 v[124:127], v[36:39], v[64:67], v[124:127]
    ds_read_b128 v[20:23], v4 offset:53248
    v_mfma_f32_16x16x32_bf16 v[128:131], v[40:43], v[64:67], v[128:131]
    ds_read_b128 v[24:27], v4 offset:55296
    v_mfma_f32_16x16x32_bf16 v[132:135], v[28:31], v[44:47], v[132:135]
    ds_read_b64_tr_b16 v[56:57], v11 offset:24576
    v_mfma_f32_16x16x32_bf16 v[136:139], v[32:35], v[44:47], v[136:139]
    ds_read_b64_tr_b16 v[58:59], v11 offset:25088
    v_mfma_f32_16x16x32_bf16 v[140:143], v[36:39], v[44:47], v[140:143]
    ds_read_b64_tr_b16 v[60:61], v10 offset:32768
    v_mfma_f32_16x16x32_bf16 v[144:147], v[40:43], v[44:47], v[144:147]
    ds_read_b64_tr_b16 v[62:63], v10 offset:33280
    v_mfma_f32_16x16x32_bf16 v[148:151], v[28:31], v[48:51], v[148:151]
    ds_read_b64_tr_b16 v[64:65], v11 offset:32768
    v_mfma_f32_16x16x32_bf16 v[152:155], v[32:35], v[48:51], v[152:155]
    ds_read_b64_tr_b16 v[66:67], v11 offset:33280
    v_mfma_f32_16x16x32_bf16 v[156:159], v[36:39], v[48:51], v[156:159]
    v_mfma_f32_16x16x32_bf16 v[160:163], v[40:43], v[48:51], v[160:163]
    s_waitcnt lgkmcnt(9)
    v_mfma_f32_16x16x32_bf16 v[100:103], v[12:15], v[52:55], v[100:103]
    ds_read_b128 v[28:31], v5 offset:49152
    s_waitcnt lgkmcnt(9)
    v_mfma_f32_16x16x32_bf16 v[104:107], v[16:19], v[52:55], v[104:107]
    ds_read_b64_tr_b16 v[44:45], v10 offset:28672
    s_waitcnt lgkmcnt(9)
    v_mfma_f32_16x16x32_bf16 v[108:111], v[20:23], v[52:55], v[108:111]
    ds_read_b64_tr_b16 v[46:47], v10 offset:29184
    s_waitcnt lgkmcnt(9)
    v_mfma_f32_16x16x32_bf16 v[112:115], v[24:27], v[52:55], v[112:115]
    ds_read_b128 v[32:35], v5 offset:51200
    s_waitcnt lgkmcnt(8)
    s_nop 0
    v_mfma_f32_16x16x32_bf16 v[116:119], v[12:15], v[56:59], v[116:119]
    ds_read_b128 v[36:39], v5 offset:53248
    v_mfma_f32_16x16x32_bf16 v[120:123], v[16:19], v[56:59], v[120:123]
    ds_read_b128 v[40:43], v5 offset:55296
    v_mfma_f32_16x16x32_bf16 v[124:127], v[20:23], v[56:59], v[124:127]
    ds_read_b64_tr_b16 v[48:49], v11 offset:28672
    v_mfma_f32_16x16x32_bf16 v[128:131], v[24:27], v[56:59], v[128:131]
    ds_read_b64_tr_b16 v[50:51], v11 offset:29184
    s_waitcnt lgkmcnt(10)
    s_nop 0
    v_mfma_f32_16x16x32_bf16 v[132:135], v[12:15], v[60:63], v[132:135]
    ds_read_b64_tr_b16 v[52:53], v10 offset:36864
    v_mfma_f32_16x16x32_bf16 v[136:139], v[16:19], v[60:63], v[136:139]
    ds_read_b64_tr_b16 v[54:55], v10 offset:37376
    v_mfma_f32_16x16x32_bf16 v[140:143], v[20:23], v[60:63], v[140:143]
    ds_read_b64_tr_b16 v[56:57], v11 offset:36864
    v_mfma_f32_16x16x32_bf16 v[144:147], v[24:27], v[60:63], v[144:147]
    ds_read_b64_tr_b16 v[58:59], v11 offset:37376
    s_waitcnt lgkmcnt(12)
    v_mfma_f32_16x16x32_bf16 v[148:151], v[12:15], v[64:67], v[148:151]
    v_mfma_f32_16x16x32_bf16 v[152:155], v[16:19], v[64:67], v[152:155]
    v_mfma_f32_16x16x32_bf16 v[156:159], v[20:23], v[64:67], v[156:159]
    v_mfma_f32_16x16x32_bf16 v[160:163], v[24:27], v[64:67], v[160:163]
    s_waitcnt lgkmcnt(9)
    v_mfma_f32_16x16x32_bf16 v[100:103], v[28:31], v[44:47], v[100:103]
    s_waitcnt lgkmcnt(8)
    v_mfma_f32_16x16x32_bf16 v[104:107], v[32:35], v[44:47], v[104:107]
    s_waitcnt lgkmcnt(0)
    s_barrier
    s_nop 0
    v_mfma_f32_16x16x32_bf16 v[108:111], v[36:39], v[44:47], v[108:111]
    ds_read_b128 v[12:15], v4 offset:0
    v_mfma_f32_16x16x32_bf16 v[112:115], v[40:43], v[44:47], v[112:115]
    ds_read_b64_tr_b16 v[60:61], v8 offset:8192
    v_mfma_f32_16x16x32_bf16 v[116:119], v[28:31], v[48:51], v[116:119]
    ds_read_b64_tr_b16 v[62:63], v8 offset:8704
    v_mfma_f32_16x16x32_bf16 v[120:123], v[32:35], v[48:51], v[120:123]
    ds_read_b128 v[16:19], v4 offset:2048
    v_mfma_f32_16x16x32_bf16 v[124:127], v[36:39], v[48:51], v[124:127]
    ds_read_b128 v[20:23], v4 offset:4096
    v_mfma_f32_16x16x32_bf16 v[128:131], v[40:43], v[48:51], v[128:131]
    ds_read_b128 v[24:27], v4 offset:6144
    v_mfma_f32_16x16x32_bf16 v[132:135], v[28:31], v[52:55], v[132:135]
    ds_read_b64_tr_b16 v[64:65], v9 offset:8192
    v_mfma_f32_16x16x32_bf16 v[136:139], v[32:35], v[52:55], v[136:139]
    ds_read_b64_tr_b16 v[66:67], v9 offset:8704
    v_mfma_f32_16x16x32_bf16 v[140:143], v[36:39], v[52:55], v[140:143]
    ds_read_b64_tr_b16 v[44:45], v8 offset:16384
    v_mfma_f32_16x16x32_bf16 v[144:147], v[40:43], v[52:55], v[144:147]
    ds_read_b64_tr_b16 v[46:47], v8 offset:16896
    v_mfma_f32_16x16x32_bf16 v[148:151], v[28:31], v[56:59], v[148:151]
    ds_read_b64_tr_b16 v[48:49], v9 offset:16384
    v_mfma_f32_16x16x32_bf16 v[152:155], v[32:35], v[56:59], v[152:155]
    ds_read_b64_tr_b16 v[50:51], v9 offset:16896
    v_mfma_f32_16x16x32_bf16 v[156:159], v[36:39], v[56:59], v[156:159]
    v_mfma_f32_16x16x32_bf16 v[160:163], v[40:43], v[56:59], v[160:163]
    s_waitcnt lgkmcnt(9)
    v_mfma_f32_16x16x32_bf16 v[100:103], v[12:15], v[60:63], v[100:103]
    ds_read_b128 v[28:31], v5 offset:0
    s_waitcnt lgkmcnt(9)
    v_mfma_f32_16x16x32_bf16 v[104:107], v[16:19], v[60:63], v[104:107]
    ds_read_b64_tr_b16 v[52:53], v8 offset:12288
    s_waitcnt lgkmcnt(9)
    v_mfma_f32_16x16x32_bf16 v[108:111], v[20:23], v[60:63], v[108:111]
    ds_read_b64_tr_b16 v[54:55], v8 offset:12800
    s_waitcnt lgkmcnt(9)
    v_mfma_f32_16x16x32_bf16 v[112:115], v[24:27], v[60:63], v[112:115]
    ds_read_b128 v[32:35], v5 offset:2048
    s_waitcnt lgkmcnt(8)
    s_nop 0
    v_mfma_f32_16x16x32_bf16 v[116:119], v[12:15], v[64:67], v[116:119]
    ds_read_b128 v[36:39], v5 offset:4096
    v_mfma_f32_16x16x32_bf16 v[120:123], v[16:19], v[64:67], v[120:123]
    ds_read_b128 v[40:43], v5 offset:6144
    v_mfma_f32_16x16x32_bf16 v[124:127], v[20:23], v[64:67], v[124:127]
    ds_read_b64_tr_b16 v[56:57], v9 offset:12288
    v_mfma_f32_16x16x32_bf16 v[128:131], v[24:27], v[64:67], v[128:131]
    ds_read_b64_tr_b16 v[58:59], v9 offset:12800
    s_waitcnt lgkmcnt(10)
    s_nop 0
    v_mfma_f32_16x16x32_bf16 v[132:135], v[12:15], v[44:47], v[132:135]
    ds_read_b64_tr_b16 v[60:61], v8 offset:20480
    v_mfma_f32_16x16x32_bf16 v[136:139], v[16:19], v[44:47], v[136:139]
    ds_read_b64_tr_b16 v[62:63], v8 offset:20992
    v_mfma_f32_16x16x32_bf16 v[140:143], v[20:23], v[44:47], v[140:143]
    ds_read_b64_tr_b16 v[64:65], v9 offset:20480
    v_mfma_f32_16x16x32_bf16 v[144:147], v[24:27], v[44:47], v[144:147]
    ds_read_b64_tr_b16 v[66:67], v9 offset:20992
    s_waitcnt lgkmcnt(12)
    v_mfma_f32_16x16x32_bf16 v[148:151], v[12:15], v[48:51], v[148:151]
    v_mfma_f32_16x16x32_bf16 v[152:155], v[16:19], v[48:51], v[152:155]
    v_mfma_f32_16x16x32_bf16 v[156:159], v[20:23], v[48:51], v[156:159]
    v_mfma_f32_16x16x32_bf16 v[160:163], v[24:27], v[48:51], v[160:163]
    s_waitcnt lgkmcnt(9)
    v_mfma_f32_16x16x32_bf16 v[100:103], v[28:31], v[52:55], v[100:103]
    s_waitcnt lgkmcnt(8)
    v_mfma_f32_16x16x32_bf16 v[104:107], v[32:35], v[52:55], v[104:107]
    s_waitcnt lgkmcnt(0)
    s_barrier
    s_nop 0
    v_mfma_f32_16x16x32_bf16 v[108:111], v[36:39], v[52:55], v[108:111]
    ds_read_b128 v[12:15], v4 offset:16384
    v_mfma_f32_16x16x32_bf16 v[112:115], v[40:43], v[52:55], v[112:115]
    ds_read_b64_tr_b16 v[44:45], v8 offset:24576
    v_mfma_f32_16x16x32_bf16 v[116:119], v[28:31], v[56:59], v[116:119]
    ds_read_b64_tr_b16 v[46:47], v8 offset:25088
    v_mfma_f32_16x16x32_bf16 v[120:123], v[32:35], v[56:59], v[120:123]
    ds_read_b128 v[16:19], v4 offset:18432
    v_mfma_f32_16x16x32_bf16 v[124:127], v[36:39], v[56:59], v[124:127]
    ds_read_b128 v[20:23], v4 offset:20480
    v_mfma_f32_16x16x32_bf16 v[128:131], v[40:43], v[56:59], v[128:131]
    ds_read_b128 v[24:27], v4 offset:22528
    v_mfma_f32_16x16x32_bf16 v[132:135], v[28:31], v[60:63], v[132:135]
    ds_read_b64_tr_b16 v[48:49], v9 offset:24576
    v_mfma_f32_16x16x32_bf16 v[136:139], v[32:35], v[60:63], v[136:139]
    ds_read_b64_tr_b16 v[50:51], v9 offset:25088
    v_mfma_f32_16x16x32_bf16 v[140:143], v[36:39], v[60:63], v[140:143]
    ds_read_b64_tr_b16 v[52:53], v10 offset:0
    v_mfma_f32_16x16x32_bf16 v[144:147], v[40:43], v[60:63], v[144:147]
    ds_read_b64_tr_b16 v[54:55], v10 offset:512
    v_mfma_f32_16x16x32_bf16 v[148:151], v[28:31], v[64:67], v[148:151]
    ds_read_b64_tr_b16 v[56:57], v11 offset:0
    v_mfma_f32_16x16x32_bf16 v[152:155], v[32:35], v[64:67], v[152:155]
    ds_read_b64_tr_b16 v[58:59], v11 offset:512
    v_mfma_f32_16x16x32_bf16 v[156:159], v[36:39], v[64:67], v[156:159]
    v_mfma_f32_16x16x32_bf16 v[160:163], v[40:43], v[64:67], v[160:163]
    s_waitcnt lgkmcnt(9)
    v_mfma_f32_16x16x32_bf16 v[100:103], v[12:15], v[44:47], v[100:103]
    ds_read_b128 v[28:31], v5 offset:16384
    s_waitcnt lgkmcnt(9)
    v_mfma_f32_16x16x32_bf16 v[104:107], v[16:19], v[44:47], v[104:107]
    ds_read_b64_tr_b16 v[60:61], v8 offset:28672
    s_waitcnt lgkmcnt(9)
    v_mfma_f32_16x16x32_bf16 v[108:111], v[20:23], v[44:47], v[108:111]
    ds_read_b64_tr_b16 v[62:63], v8 offset:29184
    s_waitcnt lgkmcnt(9)
    v_mfma_f32_16x16x32_bf16 v[112:115], v[24:27], v[44:47], v[112:115]
    ds_read_b128 v[32:35], v5 offset:18432
    s_waitcnt lgkmcnt(8)
    s_nop 0
    v_mfma_f32_16x16x32_bf16 v[116:119], v[12:15], v[48:51], v[116:119]
    ds_read_b128 v[36:39], v5 offset:20480
    v_mfma_f32_16x16x32_bf16 v[120:123], v[16:19], v[48:51], v[120:123]
    ds_read_b128 v[40:43], v5 offset:22528
    v_mfma_f32_16x16x32_bf16 v[124:127], v[20:23], v[48:51], v[124:127]
    ds_read_b64_tr_b16 v[64:65], v9 offset:28672
    v_mfma_f32_16x16x32_bf16 v[128:131], v[24:27], v[48:51], v[128:131]
    ds_read_b64_tr_b16 v[66:67], v9 offset:29184
    s_waitcnt lgkmcnt(10)
    s_nop 0
    v_mfma_f32_16x16x32_bf16 v[132:135], v[12:15], v[52:55], v[132:135]
    ds_read_b64_tr_b16 v[44:45], v10 offset:4096
    v_mfma_f32_16x16x32_bf16 v[136:139], v[16:19], v[52:55], v[136:139]
    ds_read_b64_tr_b16 v[46:47], v10 offset:4608
    v_mfma_f32_16x16x32_bf16 v[140:143], v[20:23], v[52:55], v[140:143]
    ds_read_b64_tr_b16 v[48:49], v11 offset:4096
    v_mfma_f32_16x16x32_bf16 v[144:147], v[24:27], v[52:55], v[144:147]
    ds_read_b64_tr_b16 v[50:51], v11 offset:4608
    s_waitcnt lgkmcnt(12)
    v_mfma_f32_16x16x32_bf16 v[148:151], v[12:15], v[56:59], v[148:151]
    v_mfma_f32_16x16x32_bf16 v[152:155], v[16:19], v[56:59], v[152:155]
    v_mfma_f32_16x16x32_bf16 v[156:159], v[20:23], v[56:59], v[156:159]
    v_mfma_f32_16x16x32_bf16 v[160:163], v[24:27], v[56:59], v[160:163]
    s_waitcnt lgkmcnt(9)
    v_mfma_f32_16x16x32_bf16 v[100:103], v[28:31], v[60:63], v[100:103]
    s_waitcnt lgkmcnt(8)
    v_mfma_f32_16x16x32_bf16 v[104:107], v[32:35], v[60:63], v[104:107]
    s_waitcnt lgkmcnt(0)
    s_barrier
    s_nop 0
    v_mfma_f32_16x16x32_bf16 v[108:111], v[36:39], v[60:63], v[108:111]
    ds_read_b128 v[12:15], v4 offset:32768
    v_mfma_f32_16x16x32_bf16 v[112:115], v[40:43], v[60:63], v[112:115]
    ds_read_b64_tr_b16 v[52:53], v8 offset:0
    v_mfma_f32_16x16x32_bf16 v[116:119], v[28:31], v[64:67], v[116:119]
    ds_read_b64_tr_b16 v[54:55], v8 offset:512
    v_mfma_f32_16x16x32_bf16 v[120:123], v[32:35], v[64:67], v[120:123]
    ds_read_b128 v[16:19], v4 offset:34816
    v_mfma_f32_16x16x32_bf16 v[124:127], v[36:39], v[64:67], v[124:127]
    ds_read_b128 v[20:23], v4 offset:36864
    v_mfma_f32_16x16x32_bf16 v[128:131], v[40:43], v[64:67], v[128:131]
    ds_read_b128 v[24:27], v4 offset:38912
    v_mfma_f32_16x16x32_bf16 v[132:135], v[28:31], v[44:47], v[132:135]
    ds_read_b64_tr_b16 v[56:57], v9 offset:0
    v_mfma_f32_16x16x32_bf16 v[136:139], v[32:35], v[44:47], v[136:139]
    ds_read_b64_tr_b16 v[58:59], v9 offset:512
    v_mfma_f32_16x16x32_bf16 v[140:143], v[36:39], v[44:47], v[140:143]
    ds_read_b64_tr_b16 v[60:61], v10 offset:16384
    v_mfma_f32_16x16x32_bf16 v[144:147], v[40:43], v[44:47], v[144:147]
    ds_read_b64_tr_b16 v[62:63], v10 offset:16896
    v_mfma_f32_16x16x32_bf16 v[148:151], v[28:31], v[48:51], v[148:151]
    ds_read_b64_tr_b16 v[64:65], v11 offset:16384
    v_mfma_f32_16x16x32_bf16 v[152:155], v[32:35], v[48:51], v[152:155]
    ds_read_b64_tr_b16 v[66:67], v11 offset:16896
    v_mfma_f32_16x16x32_bf16 v[156:159], v[36:39], v[48:51], v[156:159]
    v_mfma_f32_16x16x32_bf16 v[160:163], v[40:43], v[48:51], v[160:163]
    s_waitcnt lgkmcnt(9)
    v_mfma_f32_16x16x32_bf16 v[100:103], v[12:15], v[52:55], v[100:103]
    ds_read_b128 v[28:31], v5 offset:32768
    s_waitcnt lgkmcnt(9)
    v_mfma_f32_16x16x32_bf16 v[104:107], v[16:19], v[52:55], v[104:107]
    ds_read_b64_tr_b16 v[44:45], v8 offset:4096
    s_waitcnt lgkmcnt(9)
    v_mfma_f32_16x16x32_bf16 v[108:111], v[20:23], v[52:55], v[108:111]
    ds_read_b64_tr_b16 v[46:47], v8 offset:4608
    s_waitcnt lgkmcnt(9)
    v_mfma_f32_16x16x32_bf16 v[112:115], v[24:27], v[52:55], v[112:115]
    ds_read_b128 v[32:35], v5 offset:34816
    s_waitcnt lgkmcnt(8)
    s_nop 0
    v_mfma_f32_16x16x32_bf16 v[116:119], v[12:15], v[56:59], v[116:119]
    ds_read_b128 v[36:39], v5 offset:36864
    v_mfma_f32_16x16x32_bf16 v[120:123], v[16:19], v[56:59], v[120:123]
    ds_read_b128 v[40:43], v5 offset:38912
    v_mfma_f32_16x16x32_bf16 v[124:127], v[20:23], v[56:59], v[124:127]
    ds_read_b64_tr_b16 v[48:49], v9 offset:4096
    v_mfma_f32_16x16x32_bf16 v[128:131], v[24:27], v[56:59], v[128:131]
    ds_read_b64_tr_b16 v[50:51], v9 offset:4608
    s_waitcnt lgkmcnt(10)
    s_nop 0
    v_mfma_f32_16x16x32_bf16 v[132:135], v[12:15], v[60:63], v[132:135]
    ds_read_b64_tr_b16 v[52:53], v10 offset:20480
    v_mfma_f32_16x16x32_bf16 v[136:139], v[16:19], v[60:63], v[136:139]
    ds_read_b64_tr_b16 v[54:55], v10 offset:20992
    v_mfma_f32_16x16x32_bf16 v[140:143], v[20:23], v[60:63], v[140:143]
    ds_read_b64_tr_b16 v[56:57], v11 offset:20480
    v_mfma_f32_16x16x32_bf16 v[144:147], v[24:27], v[60:63], v[144:147]
    ds_read_b64_tr_b16 v[58:59], v11 offset:20992
    s_waitcnt lgkmcnt(12)
    v_mfma_f32_16x16x32_bf16 v[148:151], v[12:15], v[64:67], v[148:151]
    s_branch IW_s4
IW_w4:
    s_branch IW_r4
IW_s4:
    v_mfma_f32_16x16x32_bf16 v[152:155], v[16:19], v[64:67], v[152:155]
    v_mfma_f32_16x16x32_bf16 v[156:159], v[20:23], v[64:67], v[156:159]
    v_mfma_f32_16x16x32_bf16 v[160:163], v[24:27], v[64:67], v[160:163]
    s_waitcnt lgkmcnt(9)
    v_mfma_f32_16x16x32_bf16 v[100:103], v[28:31], v[44:47], v[100:103]
    s_waitcnt lgkmcnt(8)
    v_mfma_f32_16x16x32_bf16 v[104:107], v[32:35], v[44:47], v[104:107]
    s_waitcnt lgkmcnt(0)
    s_barrier
    s_nop 0
    v_mfma_f32_16x16x32_bf16 v[108:111], v[36:39], v[44:47], v[108:111]
    ds_read_b128 v[12:15], v4 offset:49152
    v_mfma_f32_16x16x32_bf16 v[112:115], v[40:43], v[44:47], v[112:115]
    ds_read_b64_tr_b16 v[60:61], v10 offset:24576
    v_mfma_f32_16x16x32_bf16 v[116:119], v[28:31], v[48:51], v[116:119]
    ds_read_b64_tr_b16 v[62:63], v10 offset:25088
    v_mfma_f32_16x16x32_bf16 v[120:123], v[32:35], v[48:51], v[120:123]
    ds_read_b128 v[16:19], v4 offset:51200
    v_mfma_f32_16x16x32_bf16 v[124:127], v[36:39], v[48:51], v[124:127]
    ds_read_b128 v[20:23], v4 offset:53248
    v_mfma_f32_16x16x32_bf16 v[128:131], v[40:43], v[48:51], v[128:131]
    ds_read_b128 v[24:27], v4 offset:55296
    v_mfma_f32_16x16x32_bf16 v[132:135], v[28:31], v[52:55], v[132:135]
    ds_read_b64_tr_b16 v[64:65], v11 offset:24576
    v_mfma_f32_16x16x32_bf16 v[136:139], v[32:35], v[52:55], v[136:139]
    ds_read_b64_tr_b16 v[66:67], v11 offset:25088
    v_mfma_f32_16x16x32_bf16 v[140:143], v[36:39], v[52:55], v[140:143]
    ds_read_b64_tr_b16 v[44:45], v10 offset:32768
    v_mfma_f32_16x16x32_bf16 v[144:147], v[40:43], v[52:55], v[144:147]
    ds_read_b64_tr_b16 v[46:47], v10 offset:33280
    v_mfma_f32_16x16x32_bf16 v[148:151], v[28:31], v[56:59], v[148:151]
    ds_read_b64_tr_b16 v[48:49], v11 offset:32768
    v_mfma_f32_16x16x32_bf16 v[152:155], v[32:35], v[56:59], v[152:155]
    ds_read_b64_tr_b16 v[50:51], v11 offset:33280
    v_mfma_f32_16x16x32_bf16 v[156:159], v[36:39], v[56:59], v[156:159]
    v_mfma_f32_16x16x32_bf16 v[160:163], v[40:43], v[56:59], v[160:163]
    s_waitcnt lgkmcnt(9)
    v_mfma_f32_16x16x32_bf16 v[100:103], v[12:15], v[60:63], v[100:103]
    ds_read_b128 v[28:31], v5 offset:49152
    s_waitcnt lgkmcnt(9)
    v_mfma_f32_16x16x32_bf16 v[104:107], v[16:19], v[60:63], v[104:107]
    ds_read_b64_tr_b16 v[52:53], v10 offset:28672
    s_waitcnt lgkmcnt(9)
    v_mfma_f32_16x16x32_bf16 v[108:111], v[20:23], v[60:63], v[108:111]
    ds_read_b64_tr_b16 v[54:55], v10 offset:29184
    s_waitcnt lgkmcnt(9)
    v_mfma_f32_16x16x32_bf16 v[112:115], v[24:27], v[60:63], v[112:115]
    ds_read_b128 v[32:35], v5 offset:51200
    s_waitcnt lgkmcnt(8)
    s_nop 0
    v_mfma_f32_16x16x32_bf16 v[116:119], v[12:15], v[64:67], v[116:119]
    ds_read_b128 v[36:39], v5 offset:53248
    v_mfma_f32_16x16x32_bf16 v[120:123], v[16:19], v[64:67], v[120:123]
    ds_read_b128 v[40:43], v5 offset:55296
    v_mfma_f32_16x16x32_bf16 v[124:127], v[20:23], v[64:67], v[124:127]
    ds_read_b64_tr_b16 v[56:57], v11 offset:28672
    v_mfma_f32_16x16x32_bf16 v[128:131], v[24:27], v[64:67], v[128:131]
    ds_read_b64_tr_b16 v[58:59], v11 offset:29184
    s_waitcnt lgkmcnt(10)
    s_nop 0
    v_mfma_f32_16x16x32_bf16 v[132:135], v[12:15], v[44:47], v[132:135]
    ds_read_b64_tr_b16 v[60:61], v10 offset:36864
    v_mfma_f32_16x16x32_bf16 v[136:139], v[16:19], v[44:47], v[136:139]
    ds_read_b64_tr_b16 v[62:63], v10 offset:37376
    v_mfma_f32_16x16x32_bf16 v[140:143], v[20:23], v[44:47], v[140:143]
    ds_read_b64_tr_b16 v[64:65], v11 offset:36864
    v_mfma_f32_16x16x32_bf16 v[144:147], v[24:27], v[44:47], v[144:147]
    ds_read_b64_tr_b16 v[66:67], v11 offset:37376
    s_waitcnt lgkmcnt(12)
    v_mfma_f32_16x16x32_bf16 v[148:151], v[12:15], v[48:51], v[148:151]
    v_mfma_f32_16x16x32_bf16 v[152:155], v[16:19], v[48:51], v[152:155]
    v_mfma_f32_16x16x32_bf16 v[156:159], v[20:23], v[48:51], v[156:159]
    v_mfma_f32_16x16x32_bf16 v[160:163], v[24:27], v[48:51], v[160:163]
    s_waitcnt lgkmcnt(9)
    v_mfma_f32_16x16x32_bf16 v[100:103], v[28:31], v[52:55], v[100:103]
    s_waitcnt lgkmcnt(8)
    v_mfma_f32_16x16x32_bf16 v[104:107], v[32:35], v[52:55], v[104:107]
    s_waitcnt lgkmcnt(0)
    s_barrier
    s_nop 0
    v_mfma_f32_16x16x32_bf16 v[108:111], v[36:39], v[52:55], v[108:111]
    ds_read_b128 v[12:15], v4 offset:0
    v_mfma_f32_16x16x32_bf16 v[112:115], v[40:43], v[52:55], v[112:115]
    ds_read_b64_tr_b16 v[44:45], v8 offset:8192
    v_mfma_f32_16x16x32_bf16 v[116:119], v[28:31], v[56:59], v[116:119]
    ds_read_b64_tr_b16 v[46:47], v8 offset:8704
    v_mfma_f32_16x16x32_bf16 v[120:123], v[32:35], v[56:59], v[120:123]
    ds_read_b128 v[16:19], v4 offset:2048
    v_mfma_f32_16x16x32_bf16 v[124:127], v[36:39], v[56:59], v[124:127]
    ds_read_b128 v[20:23], v4 offset:4096
    v_mfma_f32_16x16x32_bf16 v[128:131], v[40:43], v[56:59], v[128:131]
    ds_read_b128 v[24:27], v4 offset:6144
    v_mfma_f32_16x16x32_bf16 v[132:135], v[28:31], v[60:63], v[132:135]
    ds_read_b64_tr_b16 v[48:49], v9 offset:8192
    v_mfma_f32_16x16x32_bf16 v[136:139], v[32:35], v[60:63], v[136:139]
    ds_read_b64_tr_b16 v[50:51], v9 offset:8704
    v_mfma_f32_16x16x32_bf16 v[140:143], v[36:39], v[60:63], v[140:143]
    ds_read_b64_tr_b16 v[52:53], v8 offset:16384
    v_mfma_f32_16x16x32_bf16 v[144:147], v[40:43], v[60:63], v[144:147]
    ds_read_b64_tr_b16 v[54:55], v8 offset:16896
    v_mfma_f32_16x16x32_bf16 v[148:151], v[28:31], v[64:67], v[148:151]
    ds_read_b64_tr_b16 v[56:57], v9 offset:16384
    v_mfma_f32_16x16x32_bf16 v[152:155], v[32:35], v[64:67], v[152:155]
    ds_read_b64_tr_b16 v[58:59], v9 offset:16896
    v_mfma_f32_16x16x32_bf16 v[156:159], v[36:39], v[64:67], v[156:159]
    v_mfma_f32_16x16x32_bf16 v[160:163], v[40:43], v[64:67], v[160:163]
    s_waitcnt lgkmcnt(9)
    v_mfma_f32_16x16x32_bf16 v[100:103], v[12:15], v[44:47], v[100:103]
    ds_read_b128 v[28:31], v5 offset:0
    s_waitcnt lgkmcnt(9)
    v_mfma_f32_16x16x32_bf16 v[104:107], v[16:19], v[44:47], v[104:107]
    ds_read_b64_tr_b16 v[60:61], v8 offset:12288
    s_waitcnt lgkmcnt(9)
    v_mfma_f32_16x16x32_bf16 v[108:111], v[20:23], v[44:47], v[108:111]
    ds_read_b64_tr_b16 v[62:63], v8 offset:12800
    s_waitcnt lgkmcnt(9)
    v_mfma_f32_16x16x32_bf16 v[112:115], v[24:27], v[44:47], v[112:115]
    ds_read_b128 v[32:35], v5 offset:2048
    s_waitcnt lgkmcnt(8)
    s_nop 0
    v_mfma_f32_16x16x32_bf16 v[116:119], v[12:15], v[48:51], v[116:119]
    ds_read_b128 v[36:39], v5 offset:4096
    v_mfma_f32_16x16x32_bf16 v[120:123], v[16:19], v[48:51], v[120:123]
    ds_read_b128 v[40:43], v5 offset:6144
    v_mfma_f32_16x16x32_bf16 v[124:127], v[20:23], v[48:51], v[124:127]
    ds_read_b64_tr_b16 v[64:65], v9 offset:12288
    v_mfma_f32_16x16x32_bf16 v[128:131], v[24:27], v[48:51], v[128:131]
    ds_read_b64_tr_b16 v[66:67], v9 offset:12800
    s_waitcnt lgkmcnt(10)
    s_nop 0
    v_mfma_f32_16x16x32_bf16 v[132:135], v[12:15], v[52:55], v[132:135]
    ds_read_b64_tr_b16 v[44:45], v8 offset:20480
    v_mfma_f32_16x16x32_bf16 v[136:139], v[16:19], v[52:55], v[136:139]
    ds_read_b64_tr_b16 v[46:47], v8 offset:20992
    v_mfma_f32_16x16x32_bf16 v[140:143], v[20:23], v[52:55], v[140:143]
    ds_read_b64_tr_b16 v[48:49], v9 offset:20480
    v_mfma_f32_16x16x32_bf16 v[144:147], v[24:27], v[52:55], v[144:147]
    ds_read_b64_tr_b16 v[50:51], v9 offset:20992
    s_waitcnt lgkmcnt(12)
    v_mfma_f32_16x16x32_bf16 v[148:151], v[12:15], v[56:59], v[148:151]
    v_mfma_f32_16x16x32_bf16 v[152:155], v[16:19], v[56:59], v[152:155]
    v_mfma_f32_16x16x32_bf16 v[156:159], v[20:23], v[56:59], v[156:159]
    v_mfma_f32_16x16x32_bf16 v[160:163], v[24:27], v[56:59], v[160:163]
    s_waitcnt lgkmcnt(9)
    v_mfma_f32_16x16x32_bf16 v[100:103], v[28:31], v[60:63], v[100:103]
    s_waitcnt lgkmcnt(8)
    v_mfma_f32_16x16x32_bf16 v[104:107], v[32:35], v[60:63], v[104:107]
    s_waitcnt lgkmcnt(0)
    s_barrier
    s_nop 0
    v_mfma_f32_16x16x32_bf16 v[108:111], v[36:39], v[60:63], v[108:111]
    ds_read_b128 v[12:15], v4 offset:16384
    v_mfma_f32_16x16x32_bf16 v[112:115], v[40:43], v[60:63], v[112:115]
    ds_read_b64_tr_b16 v[52:53], v8 offset:24576
    v_mfma_f32_16x16x32_bf16 v[116:119], v[28:31], v[64:67], v[116:119]
    ds_read_b64_tr_b16 v[54:55], v8 offset:25088
    v_mfma_f32_16x16x32_bf16 v[120:123], v[32:35], v[64:67], v[120:123]
    ds_read_b128 v[16:19], v4 offset:18432
    v_mfma_f32_16x16x32_bf16 v[124:127], v[36:39], v[64:67], v[124:127]
    ds_read_b128 v[20:23], v4 offset:20480
    v_mfma_f32_16x16x32_bf16 v[128:131], v[40:43], v[64:67], v[128:131]
    ds_read_b128 v[24:27], v4 offset:22528
    v_mfma_f32_16x16x32_bf16 v[132:135], v[28:31], v[44:47], v[132:135]
    ds_read_b64_tr_b16 v[56:57], v9 offset:24576
    v_mfma_f32_16x16x32_bf16 v[136:139], v[32:35], v[44:47], v[136:139]
    ds_read_b64_tr_b16 v[58:59], v9 offset:25088
    v_mfma_f32_16x16x32_bf16 v[140:143], v[36:39], v[44:47], v[140:143]
    ds_read_b64_tr_b16 v[60:61], v10 offset:0
    v_mfma_f32_16x16x32_bf16 v[144:147], v[40:43], v[44:47], v[144:147]
    ds_read_b64_tr_b16 v[62:63], v10 offset:512
    v_mfma_f32_16x16x32_bf16 v[148:151], v[28:31], v[48:51], v[148:151]
    ds_read_b64_tr_b16 v[64:65], v11 offset:0
    v_mfma_f32_16x16x32_bf16 v[152:155], v[32:35], v[48:51], v[152:155]
    ds_read_b64_tr_b16 v[66:67], v11 offset:512
    v_mfma_f32_16x16x32_bf16 v[156:159], v[36:39], v[48:51], v[156:159]
    v_mfma_f32_16x16x32_bf16 v[160:163], v[40:43], v[48:51], v[160:163]
    s_waitcnt lgkmcnt(9)
    v_mfma_f32_16x16x32_bf16 v[100:103], v[12:15], v[52:55], v[100:103]
    ds_read_b128 v[28:31], v5 offset:16384
    s_waitcnt lgkmcnt(9)
    v_mfma_f32_16x16x32_bf16 v[104:107], v[16:19], v[52:55], v[104:107]
    ds_read_b64_tr_b16 v[44:45], v8 offset:28672
    s_waitcnt lgkmcnt(9)
    v_mfma_f32_16x16x32_bf16 v[108:111], v[20:23], v[52:55], v[108:111]
    ds_read_b64_tr_b16 v[46:47], v8 offset:29184
    s_waitcnt lgkmcnt(9)
    v_mfma_f32_16x16x32_bf16 v[112:115], v[24:27], v[52:55], v[112:115]
    ds_read_b128 v[32:35], v5 offset:18432
    s_waitcnt lgkmcnt(8)
    s_nop 0
    v_mfma_f32_16x16x32_bf16 v[116:119], v[12:15], v[56:59], v[116:119]
    ds_read_b128 v[36:39], v5 offset:20480
    v_mfma_f32_16x16x32_bf16 v[120:123], v[16:19], v[56:59], v[120:123]
    ds_read_b128 v[40:43], v5 offset:22528
    v_mfma_f32_16x16x32_bf16 v[124:127], v[20:23], v[56:59], v[124:127]
    ds_read_b64_tr_b16 v[48:49], v9 offset:28672
    v_mfma_f32_16x16x32_bf16 v[128:131], v[24:27], v[56:59], v[128:131]
    ds_read_b64_tr_b16 v[50:51], v9 offset:29184
    s_waitcnt lgkmcnt(10)
    s_nop 0
    v_mfma_f32_16x16x32_bf16 v[132:135], v[12:15], v[60:63], v[132:135]
    ds_read_b64_tr_b16 v[52:53], v10 offset:4096
    v_mfma_f32_16x16x32_bf16 v[136:139], v[16:19], v[60:63], v[136:139]
    ds_read_b64_tr_b16 v[54:55], v10 offset:4608
    v_mfma_f32_16x16x32_bf16 v[140:143], v[20:23], v[60:63], v[140:143]
    ds_read_b64_tr_b16 v[56:57], v11 offset:4096
    v_mfma_f32_16x16x32_bf16 v[144:147], v[24:27], v[60:63], v[144:147]
    ds_read_b64_tr_b16 v[58:59], v11 offset:4608
    s_waitcnt lgkmcnt(12)
    v_mfma_f32_16x16x32_bf16 v[148:151], v[12:15], v[64:67], v[148:151]
    v_mfma_f32_16x16x32_bf16 v[152:155], v[16:19], v[64:67], v[152:155]
    v_mfma_f32_16x16x32_bf16 v[156:159], v[20:23], v[64:67], v[156:159]
    v_mfma_f32_16x16x32_bf16 v[160:163], v[24:27], v[64:67], v[160:163]
    s_waitcnt lgkmcnt(9)
    v_mfma_f32_16x16x32_bf16 v[100:103], v[28:31], v[44:47], v[100:103]
    s_waitcnt lgkmcnt(8)
    v_mfma_f32_16x16x32_bf16 v[104:107], v[32:35], v[44:47], v[104:107]
    s_waitcnt lgkmcnt(0)
    s_barrier
    s_nop 0
    v_mfma_f32_16x16x32_bf16 v[108:111], v[36:39], v[44:47], v[108:111]
    ds_read_b128 v[12:15], v4 offset:32768
    v_mfma_f32_16x16x32_bf16 v[112:115], v[40:43], v[44:47], v[112:115]
    ds_read_b64_tr_b16 v[60:61], v8 offset:0
    v_mfma_f32_16x16x32_bf16 v[116:119], v[28:31], v[48:51], v[116:119]
    ds_read_b64_tr_b16 v[62:63], v8 offset:512
    v_mfma_f32_16x16x32_bf16 v[120:123], v[32:35], v[48:51], v[120:123]
    ds_read_b128 v[16:19], v4 offset:34816
    v_mfma_f32_16x16x32_bf16 v[124:127], v[36:39], v[48:51], v[124:127]
    ds_read_b128 v[20:23], v4 offset:36864
    v_mfma_f32_16x16x32_bf16 v[128:131], v[40:43], v[48:51], v[128:131]
    ds_read_b128 v[24:27], v4 offset:38912
    v_mfma_f32_16x16x32_bf16 v[132:135], v[28:31], v[52:55], v[132:135]
    ds_read_b64_tr_b16 v[64:65], v9 offset:0
    v_mfma_f32_16x16x32_bf16 v[136:139], v[32:35], v[52:55], v[136:139]
    ds_read_b64_tr_b16 v[66:67], v9 offset:512
    v_mfma_f32_16x16x32_bf16 v[140:143], v[36:39], v[52:55], v[140:143]
    ds_read_b64_tr_b16 v[44:45], v10 offset:8192
    v_mfma_f32_16x16x32_bf16 v[144:147], v[40:43], v[52:55], v[144:147]
    ds_read_b64_tr_b16 v[46:47], v10 offset:8704
    v_mfma_f32_16x16x32_bf16 v[148:151], v[28:31], v[56:59], v[148:151]
    ds_read_b64_tr_b16 v[48:49], v11 offset:8192
    v_mfma_f32_16x16x32_bf16 v[152:155], v[32:35], v[56:59], v[152:155]
    ds_read_b64_tr_b16 v[50:51], v11 offset:8704
    v_mfma_f32_16x16x32_bf16 v[156:159], v[36:39], v[56:59], v[156:159]
    v_mfma_f32_16x16x32_bf16 v[160:163], v[40:43], v[56:59], v[160:163]
    s_waitcnt lgkmcnt(9)
    v_mfma_f32_16x16x32_bf16 v[100:103], v[12:15], v[60:63], v[100:103]
    ds_read_b128 v[28:31], v5 offset:32768
    s_waitcnt lgkmcnt(9)
    v_mfma_f32_16x16x32_bf16 v[104:107], v[16:19], v[60:63], v[104:107]
    ds_read_b64_tr_b16 v[52:53], v8 offset:4096
    s_waitcnt lgkmcnt(9)
    v_mfma_f32_16x16x32_bf16 v[108:111], v[20:23], v[60:63], v[108:111]
    ds_read_b64_tr_b16 v[54:55], v8 offset:4608
    s_waitcnt lgkmcnt(9)
    v_mfma_f32_16x16x32_bf16 v[112:115], v[24:27], v[60:63], v[112:115]
    ds_read_b128 v[32:35], v5 offset:34816
    s_waitcnt lgkmcnt(8)
    s_nop 0
    v_mfma_f32_16x16x32_bf16 v[116:119], v[12:15], v[64:67], v[116:119]
    ds_read_b128 v[36:39], v5 offset:36864
    v_mfma_f32_16x16x32_bf16 v[120:123], v[16:19], v[64:67], v[120:123]
    ds_read_b128 v[40:43], v5 offset:38912
    v_mfma_f32_16x16x32_bf16 v[124:127], v[20:23], v[64:67], v[124:127]
    ds_read_b64_tr_b16 v[56:57], v9 offset:4096
    v_mfma_f32_16x16x32_bf16 v[128:131], v[24:27], v[64:67], v[128:131]
    ds_read_b64_tr_b16 v[58:59], v9 offset:4608
    s_waitcnt lgkmcnt(10)
    s_nop 0
    v_mfma_f32_16x16x32_bf16 v[132:135], v[12:15], v[44:47], v[132:135]
    ds_read_b64_tr_b16 v[60:61], v10 offset:12288
    v_mfma_f32_16x16x32_bf16 v[136:139], v[16:19], v[44:47], v[136:139]
    ds_read_b64_tr_b16 v[62:63], v10 offset:12800
    v_mfma_f32_16x16x32_bf16 v[140:143], v[20:23], v[44:47], v[140:143]
    ds_read_b64_tr_b16 v[64:65], v11 offset:12288
    v_mfma_f32_16x16x32_bf16 v[144:147], v[24:27], v[44:47], v[144:147]
    ds_read_b64_tr_b16 v[66:67], v11 offset:12800
    s_waitcnt lgkmcnt(12)
    v_mfma_f32_16x16x32_bf16 v[148:151], v[12:15], v[48:51], v[148:151]
    v_mfma_f32_16x16x32_bf16 v[152:155], v[16:19], v[48:51], v[152:155]
    v_mfma_f32_16x16x32_bf16 v[156:159], v[20:23], v[48:51], v[156:159]
    v_mfma_f32_16x16x32_bf16 v[160:163], v[24:27], v[48:51], v[160:163]
    s_waitcnt lgkmcnt(9)
    v_mfma_f32_16x16x32_bf16 v[100:103], v[28:31], v[52:55], v[100:103]
    s_waitcnt lgkmcnt(8)
    v_mfma_f32_16x16x32_bf16 v[104:107], v[32:35], v[52:55], v[104:107]
    s_waitcnt lgkmcnt(0)
    s_barrier
    s_nop 0
    v_mfma_f32_16x16x32_bf16 v[108:111], v[36:39], v[52:55], v[108:111]
    ds_read_b128 v[12:15], v4 offset:49152
    v_mfma_f32_16x16x32_bf16 v[112:115], v[40:43], v[52:55], v[112:115]
    ds_read_b64_tr_b16 v[44:45], v10 offset:16384
    v_mfma_f32_16x16x32_bf16 v[116:119], v[28:31], v[56:59], v[116:119]
    ds_read_b64_tr_b16 v[46:47], v10 offset:16896
    v_mfma_f32_16x16x32_bf16 v[120:123], v[32:35], v[56:59], v[120:123]
    ds_read_b128 v[16:19], v4 offset:51200
    v_mfma_f32_16x16x32_bf16 v[124:127], v[36:39], v[56:59], v[124:127]
    ds_read_b128 v[20:23], v4 offset:53248
    v_mfma_f32_16x16x32_bf16 v[128:131], v[40:43], v[56:59], v[128:131]
    ds_read_b128 v[24:27], v4 offset:55296
    v_mfma_f32_16x16x32_bf16 v[132:135], v[28:31], v[60:63], v[132:135]
    ds_read_b64_tr_b16 v[48:49], v11 offset:16384
    v_mfma_f32_16x16x32_bf16 v[136:139], v[32:35], v[60:63], v[136:139]
    ds_read_b64_tr_b16 v[50:51], v11 offset:16896
    v_mfma_f32_16x16x32_bf16 v[140:143], v[36:39], v[60:63], v[140:143]
    ds_read_b64_tr_b16 v[52:53], v10 offset:24576
    v_mfma_f32_16x16x32_bf16 v[144:147], v[40:43], v[60:63], v[144:147]
    ds_read_b64_tr_b16 v[54:55], v10 offset:25088
    v_mfma_f32_16x16x32_bf16 v[148:151], v[28:31], v[64:67], v[148:151]
    ds_read_b64_tr_b16 v[56:57], v11 offset:24576
    v_mfma_f32_16x16x32_bf16 v[152:155], v[32:35], v[64:67], v[152:155]
    ds_read_b64_tr_b16 v[58:59], v11 offset:25088
    v_mfma_f32_16x16x32_bf16 v[156:159], v[36:39], v[64:67], v[156:159]
    v_mfma_f32_16x16x32_bf16 v[160:163], v[40:43], v[64:67], v[160:163]
    ds_read_b32 v68, v1 offset:48
    s_waitcnt lgkmcnt(10)
    v_mfma_f32_16x16x32_bf16 v[100:103], v[12:15], v[44:47], v[100:103]
    ds_read_b128 v[28:31], v5 offset:49152
    s_waitcnt lgkmcnt(10)
    v_mfma_f32_16x16x32_bf16 v[104:107], v[16:19], v[44:47], v[104:107]
    ds_read_b64_tr_b16 v[60:61], v10 offset:20480
    s_waitcnt lgkmcnt(10)
    v_mfma_f32_16x16x32_bf16 v[108:111], v[20:23], v[44:47], v[108:111]
    ds_read_b64_tr_b16 v[62:63], v10 offset:20992
    s_waitcnt lgkmcnt(10)
    v_mfma_f32_16x16x32_bf16 v[112:115], v[24:27], v[44:47], v[112:115]
    ds_read_b128 v[32:35], v5 offset:51200
    s_waitcnt lgkmcnt(9)
    s_nop 0
    v_mfma_f32_16x16x32_bf16 v[116:119], v[12:15], v[48:51], v[116:119]
    ds_read_b128 v[36:39], v5 offset:53248
    v_mfma_f32_16x16x32_bf16 v[120:123], v[16:19], v[48:51], v[120:123]
    ds_read_b128 v[40:43], v5 offset:55296
    v_mfma_f32_16x16x32_bf16 v[124:127], v[20:23], v[48:51], v[124:127]
    ds_read_b64_tr_b16 v[64:65], v11 offset:20480
    v_mfma_f32_16x16x32_bf16 v[128:131], v[24:27], v[48:51], v[128:131]
    ds_read_b64_tr_b16 v[66:67], v11 offset:20992
    s_waitcnt lgkmcnt(11)
    s_nop 0
    v_mfma_f32_16x16x32_bf16 v[132:135], v[12:15], v[52:55], v[132:135]
    ds_read_b64_tr_b16 v[44:45], v10 offset:28672
    v_mfma_f32_16x16x32_bf16 v[136:139], v[16:19], v[52:55], v[136:139]
    ds_read_b64_tr_b16 v[46:47], v10 offset:29184
    v_mfma_f32_16x16x32_bf16 v[140:143], v[20:23], v[52:55], v[140:143]
    ds_read_b64_tr_b16 v[48:49], v11 offset:28672
    v_mfma_f32_16x16x32_bf16 v[144:147], v[24:27], v[52:55], v[144:147]
    ds_read_b64_tr_b16 v[50:51], v11 offset:29184
    s_waitcnt lgkmcnt(13)
    v_mfma_f32_16x16x32_bf16 v[148:151], v[12:15], v[56:59], v[148:151]
    v_mfma_f32_16x16x32_bf16 v[152:155], v[16:19], v[56:59], v[152:155]
    v_mfma_f32_16x16x32_bf16 v[156:159], v[20:23], v[56:59], v[156:159]
    v_mfma_f32_16x16x32_bf16 v[160:163], v[24:27], v[56:59], v[160:163]
    s_waitcnt lgkmcnt(9)
    v_mfma_f32_16x16x32_bf16 v[100:103], v[28:31], v[60:63], v[100:103]
    v_lshlrev_b32 v18, 4, v0
    v_add_u32 v12, s52, v18
    s_waitcnt lgkmcnt(8)
    v_mfma_f32_16x16x32_bf16 v[104:107], v[32:35], v[60:63], v[104:107]
    v_xor_b32 v13, 4096, v12
    v_and_b32 v14, 0x30, v0
    s_waitcnt lgkmcnt(0)
    s_barrier
    v_cmp_gt_u32 vcc, 1, v68
    s_nop 0
    s_and_b32 vcc_lo, vcc_lo, 3
    s_cbranch_scc0 SCK_15
    v_and_b32 v69, 1, v0
    v_lshlrev_b32 v69, 2, v69
    v_add_u32 v69, 159088, v69
    ds_read_b32 v68, v69 offset:0
FW_16:
    s_waitcnt lgkmcnt(0)
    v_cmp_gt_u32 vcc, 1, v68
    s_cbranch_vccz FO_17
    ds_read_b32 v68, v69 offset:0
    s_branch FW_16
FO_17:
SCK_15:
    v_mfma_f32_16x16x32_bf16 v[108:111], v[36:39], v[60:63], v[108:111]
    ds_read_b128 v[68:71], v164 offset:0
    v_add_u32 v14, s53, v14
    v_mfma_f32_16x16x32_bf16 v[112:115], v[40:43], v[60:63], v[112:115]
    ds_read2_b32 v[52:53], v165 offset0:64 offset1:64
    v_xor_b32 v15, 64, v14
    v_mfma_f32_16x16x32_bf16 v[116:119], v[28:31], v[64:67], v[116:119]
    ds_read2_b32 v[54:55], v2 offset0:64 offset1:64
    v_lshlrev_b32 v19, 2, v0
    v_mfma_f32_16x16x32_bf16 v[120:123], v[32:35], v[64:67], v[120:123]
    ds_read2_b32 v[56:57], v165 offset0:128 offset1:128
    v_add_u32 v16, s53, v19
    v_mfma_f32_16x16x32_bf16 v[124:127], v[36:39], v[64:67], v[124:127]
    ds_read2_b32 v[58:59], v2 offset0:128 offset1:128
    v_xor_b32 v17, 256, v16
    v_mfma_f32_16x16x32_bf16 v[128:131], v[40:43], v[64:67], v[128:131]
    ds_read_b128 v[72:75], v164 offset:1024
    v_xor_b32_e64 v18, 8, v3
    v_mfma_f32_16x16x32_bf16 v[132:135], v[28:31], v[44:47], v[132:135]
    ds_read_b128 v[76:79], v164 offset:64
    v_writelane_b32 v18, s50, 1
    v_mfma_f32_16x16x32_bf16 v[136:139], v[32:35], v[44:47], v[136:139]
    ds_read_b128 v[80:83], v164 offset:1088
    v_mov_b32 v20, 0x3f803f80
    v_mfma_f32_16x16x32_bf16 v[140:143], v[36:39], v[44:47], v[140:143]
    ds_read_b128 v[84:87], v164 offset:128
    v_mov_b32 v21, 0x3f803f80
    v_mfma_f32_16x16x32_bf16 v[144:147], v[40:43], v[44:47], v[144:147]
    ds_read_b128 v[88:91], v164 offset:1152
    v_mov_b32 v22, 0x3f803f80
    v_mfma_f32_16x16x32_bf16 v[148:151], v[28:31], v[48:51], v[148:151]
    ds_read_b128 v[92:95], v164 offset:192
    v_mov_b32 v23, 0x3f803f80
    v_mfma_f32_16x16x32_bf16 v[152:155], v[32:35], v[48:51], v[152:155]
    ds_read_b128 v[96:99], v164 offset:1216
    v_mov_b32 v24, 1
    v_and_b32 v4, 15, v0
    v_mfma_f32_16x16x32_bf16 v[156:159], v[36:39], v[48:51], v[156:159]
    v_bfe_u32 v5, v0, 4, 1
    v_lshlrev_b32 v5, 5, v5
    v_mfma_f32_16x16x32_bf16 v[160:163], v[40:43], v[48:51], v[160:163]
    v_lshrrev_b32 v6, 5, v0
    v_lshl_add_u32 v5, v6, 4, v5
    v_lshl_add_u32 v7, v4, 11, v5
    v_lshlrev_b32 v6, 4, v0
    s_waitcnt lgkmcnt(10)
    v_pk_fma_f32 v[100:101], v[68:69], v[52:53], v[100:101]
    v_pk_fma_f32 v[102:103], v[70:71], v[52:53], v[102:103]
    s_waitcnt lgkmcnt(9)
    v_pk_fma_f32 v[116:117], v[68:69], v[54:55], v[116:117]
    v_pk_fma_f32 v[118:119], v[70:71], v[54:55], v[118:119]
    s_waitcnt lgkmcnt(8)
    v_pk_fma_f32 v[132:133], v[68:69], v[56:57], v[132:133]
    v_pk_fma_f32 v[134:135], v[70:71], v[56:57], v[134:135]
    s_waitcnt lgkmcnt(7)
    v_pk_fma_f32 v[148:149], v[68:69], v[58:59], v[148:149]
    v_pk_fma_f32 v[150:151], v[70:71], v[58:59], v[150:151]
    s_waitcnt lgkmcnt(6)
    v_pk_mul_f32 v[100:101], v[100:101], v[72:73]
    v_pk_mul_f32 v[102:103], v[102:103], v[74:75]
    v_pk_mul_f32 v[116:117], v[116:117], v[72:73]
    v_pk_mul_f32 v[118:119], v[118:119], v[74:75]
    v_pk_mul_f32 v[132:133], v[132:133], v[72:73]
    v_pk_mul_f32 v[134:135], v[134:135], v[74:75]
    v_pk_mul_f32 v[148:149], v[148:149], v[72:73]
    v_pk_mul_f32 v[150:151], v[150:151], v[74:75]
    v_exp_f32 v28, v100 clamp
    v_exp_f32 v29, v101 clamp
    v_exp_f32 v30, v102 clamp
    v_exp_f32 v31, v103 clamp
    v_exp_f32 v32, v116 clamp
    v_exp_f32 v33, v117 clamp
    v_exp_f32 v34, v118 clamp
    v_exp_f32 v35, v119 clamp
    v_cvt_pk_bf16_f32 v132, v132, v133
    v_cvt_pk_bf16_f32 v133, v134, v135
    v_cvt_pk_bf16_f32 v148, v148, v149
    v_cvt_pk_bf16_f32 v149, v150, v151
    v_pk_mul_f32 v[100:101], v[100:101], s[40:41] clamp
    v_pk_mul_f32 v[102:103], v[102:103], s[40:41] clamp
    v_pk_mul_f32 v[116:117], v[116:117], s[40:41] clamp
    v_pk_mul_f32 v[118:119], v[118:119], s[40:41] clamp
    v_pk_add_f32 v[28:29], v[28:29], s[74:75]
    v_pk_add_f32 v[30:31], v[30:31], s[74:75]
    v_pk_add_f32 v[32:33], v[32:33], s[74:75]
    v_pk_add_f32 v[34:35], v[34:35], s[74:75]
    v_pk_fma_f32 v[100:101], v[100:101], s[76:77], v[28:29]
    v_pk_fma_f32 v[102:103], v[102:103], s[76:77], v[30:31]
    v_pk_fma_f32 v[116:117], v[116:117], s[76:77], v[32:33]
    v_pk_fma_f32 v[118:119], v[118:119], s[76:77], v[34:35]
    v_cvt_pk_bf16_f32 v100, v100, v101
    v_cvt_pk_bf16_f32 v101, v102, v103
    v_cvt_pk_bf16_f32 v116, v116, v117
    v_cvt_pk_bf16_f32 v117, v118, v119
    s_waitcnt lgkmcnt(5)
    s_nop 0
    v_pk_fma_f32 v[104:105], v[76:77], v[52:53], v[104:105]
    v_pk_fma_f32 v[106:107], v[78:79], v[52:53], v[106:107]
    v_pk_fma_f32 v[120:121], v[76:77], v[54:55], v[120:121]
    v_pk_fma_f32 v[122:123], v[78:79], v[54:55], v[122:123]
    v_pk_fma_f32 v[136:137], v[76:77], v[56:57], v[136:137]
    v_pk_fma_f32 v[138:139], v[78:79], v[56:57], v[138:139]
    v_pk_fma_f32 v[152:153], v[76:77], v[58:59], v[152:153]
    v_pk_fma_f32 v[154:155], v[78:79], v[58:59], v[154:155]
    s_waitcnt lgkmcnt(4)
    s_nop 0
    v_pk_mul_f32 v[104:105], v[104:105], v[80:81]
    v_pk_mul_f32 v[106:107], v[106:107], v[82:83]
    v_pk_mul_f32 v[120:121], v[120:121], v[80:81]
    v_pk_mul_f32 v[122:123], v[122:123], v[82:83]
    v_pk_mul_f32 v[136:137], v[136:137], v[80:81]
    v_pk_mul_f32 v[138:139], v[138:139], v[82:83]
    v_pk_mul_f32 v[152:153], v[152:153], v[80:81]
    v_pk_mul_f32 v[154:155], v[154:155], v[82:83]
    v_exp_f32 v36, v104 clamp
    v_exp_f32 v37, v105 clamp
    v_exp_f32 v38, v106 clamp
    v_exp_f32 v39, v107 clamp
    v_exp_f32 v40, v120 clamp
    v_exp_f32 v41, v121 clamp
    v_exp_f32 v42, v122 clamp
    v_exp_f32 v43, v123 clamp
    v_cvt_pk_bf16_f32 v134, v136, v137
    v_cvt_pk_bf16_f32 v135, v138, v139
    v_cvt_pk_bf16_f32 v150, v152, v153
    v_cvt_pk_bf16_f32 v151, v154, v155
    v_pk_mul_f32 v[104:105], v[104:105], s[40:41] clamp
    v_pk_mul_f32 v[106:107], v[106:107], s[40:41] clamp
    v_pk_mul_f32 v[120:121], v[120:121], s[40:41] clamp
    v_pk_mul_f32 v[122:123], v[122:123], s[40:41] clamp
    v_pk_add_f32 v[36:37], v[36:37], s[74:75]
    v_pk_add_f32 v[38:39], v[38:39], s[74:75]
    v_pk_add_f32 v[40:41], v[40:41], s[74:75]
    v_pk_add_f32 v[42:43], v[42:43], s[74:75]
    v_pk_fma_f32 v[104:105], v[104:105], s[76:77], v[36:37]
    v_pk_fma_f32 v[106:107], v[106:107], s[76:77], v[38:39]
    v_pk_fma_f32 v[120:121], v[120:121], s[76:77], v[40:41]
    v_pk_fma_f32 v[122:123], v[122:123], s[76:77], v[42:43]
    v_cvt_pk_bf16_f32 v102, v104, v105
    v_cvt_pk_bf16_f32 v103, v106, v107
    v_cvt_pk_bf16_f32 v118, v120, v121
    v_cvt_pk_bf16_f32 v119, v122, v123
    s_waitcnt lgkmcnt(3)
    s_nop 0
    v_pk_fma_f32 v[108:109], v[84:85], v[52:53], v[108:109]
    v_pk_fma_f32 v[110:111], v[86:87], v[52:53], v[110:111]
    v_pk_fma_f32 v[124:125], v[84:85], v[54:55], v[124:125]
    v_pk_fma_f32 v[126:127], v[86:87], v[54:55], v[126:127]
    v_pk_fma_f32 v[140:141], v[84:85], v[56:57], v[140:141]
    v_pk_fma_f32 v[142:143], v[86:87], v[56:57], v[142:143]
    v_pk_fma_f32 v[156:157], v[84:85], v[58:59], v[156:157]
    v_pk_fma_f32 v[158:159], v[86:87], v[58:59], v[158:159]
    s_waitcnt lgkmcnt(2)
    s_nop 0
    v_pk_mul_f32 v[108:109], v[108:109], v[88:89]
    v_pk_mul_f32 v[110:111], v[110:111], v[90:91]
    v_pk_mul_f32 v[124:125], v[124:125], v[88:89]
    v_pk_mul_f32 v[126:127], v[126:127], v[90:91]
    v_pk_mul_f32 v[140:141], v[140:141], v[88:89]
    v_pk_mul_f32 v[142:143], v[142:143], v[90:91]
    v_pk_mul_f32 v[156:157], v[156:157], v[88:89]
    v_pk_mul_f32 v[158:159], v[158:159], v[90:91]
    v_mfma_f32_16x16x32_bf16 v[60:63], v[100:103], v[148:151], 0
    v_exp_f32 v28, v108 clamp
    v_exp_f32 v29, v109 clamp
    v_mfma_f32_16x16x32_bf16 v[64:67], v[116:119], v[148:151], 0
    v_exp_f32 v30, v110 clamp
    v_exp_f32 v31, v111 clamp
    v_mfma_f32_16x16x32_bf16 v[68:71], v[100:103], v[20:23], 0
    v_exp_f32 v32, v124 clamp
    v_exp_f32 v33, v125 clamp
    v_exp_f32 v34, v126 clamp
    v_exp_f32 v35, v127 clamp
    v_cvt_pk_bf16_f32 v136, v140, v141
    v_cvt_pk_bf16_f32 v137, v142, v143
    v_cvt_pk_bf16_f32 v152, v156, v157
    v_cvt_pk_bf16_f32 v153, v158, v159
    v_pk_mul_f32 v[108:109], v[108:109], s[40:41] clamp
    v_pk_mul_f32 v[110:111], v[110:111], s[40:41] clamp
    v_pk_mul_f32 v[124:125], v[124:125], s[40:41] clamp
    v_pk_mul_f32 v[126:127], v[126:127], s[40:41] clamp
    v_pk_add_f32 v[28:29], v[28:29], s[74:75]
    v_pk_add_f32 v[30:31], v[30:31], s[74:75]
    v_pk_add_f32 v[32:33], v[32:33], s[74:75]
    v_pk_add_f32 v[34:35], v[34:35], s[74:75]
    v_pk_fma_f32 v[108:109], v[108:109], s[76:77], v[28:29]
    v_pk_fma_f32 v[110:111], v[110:111], s[76:77], v[30:31]
    v_pk_fma_f32 v[124:125], v[124:125], s[76:77], v[32:33]
    v_pk_fma_f32 v[126:127], v[126:127], s[76:77], v[34:35]
    s_branch IW_s5
IW_w5:
    s_branch IW_r5
IW_s5:
    v_cvt_pk_bf16_f32 v104, v108, v109
    v_cvt_pk_bf16_f32 v105, v110, v111
    v_cvt_pk_bf16_f32 v120, v124, v125
    v_cvt_pk_bf16_f32 v121, v126, v127
    s_waitcnt lgkmcnt(1)
    s_nop 0
    v_pk_fma_f32 v[112:113], v[92:93], v[52:53], v[112:113]
    v_pk_fma_f32 v[114:115], v[94:95], v[52:53], v[114:115]
    v_pk_fma_f32 v[128:129], v[92:93], v[54:55], v[128:129]
    v_pk_fma_f32 v[130:131], v[94:95], v[54:55], v[130:131]
    v_pk_fma_f32 v[144:145], v[92:93], v[56:57], v[144:145]
    v_pk_fma_f32 v[146:147], v[94:95], v[56:57], v[146:147]
    v_pk_fma_f32 v[160:161], v[92:93], v[58:59], v[160:161]
    v_pk_fma_f32 v[162:163], v[94:95], v[58:59], v[162:163]
    s_waitcnt lgkmcnt(0)
    s_nop 0
    v_pk_mul_f32 v[112:113], v[112:113], v[96:97]
    v_pk_mul_f32 v[114:115], v[114:115], v[98:99]
    v_pk_mul_f32 v[128:129], v[128:129], v[96:97]
    v_pk_mul_f32 v[130:131], v[130:131], v[98:99]
    v_pk_mul_f32 v[144:145], v[144:145], v[96:97]
    v_pk_mul_f32 v[146:147], v[146:147], v[98:99]
    v_pk_mul_f32 v[160:161], v[160:161], v[96:97]
    v_pk_mul_f32 v[162:163], v[162:163], v[98:99]
    v_mfma_f32_16x16x32_bf16 v[72:75], v[116:119], v[20:23], 0
    v_exp_f32 v36, v112 clamp
    v_exp_f32 v37, v113 clamp
    v_mfma_f32_16x16x32_bf16 v[44:47], v[100:103], v[132:135], 0
    v_exp_f32 v38, v114 clamp
    v_exp_f32 v39, v115 clamp
    v_mfma_f32_16x16x32_bf16 v[48:51], v[116:119], v[132:135], 0
    v_exp_f32 v40, v128 clamp
    v_exp_f32 v41, v129 clamp
    v_exp_f32 v42, v130 clamp
    v_exp_f32 v43, v131 clamp
    v_cvt_pk_bf16_f32 v138, v144, v145
    v_cvt_pk_bf16_f32 v139, v146, v147
    v_cvt_pk_bf16_f32 v154, v160, v161
    v_cvt_pk_bf16_f32 v155, v162, v163
    v_pk_mul_f32 v[112:113], v[112:113], s[40:41] clamp
    v_pk_mul_f32 v[114:115], v[114:115], s[40:41] clamp
    v_pk_mul_f32 v[128:129], v[128:129], s[40:41] clamp
    v_pk_mul_f32 v[130:131], v[130:131], s[40:41] clamp
    v_pk_add_f32 v[36:37], v[36:37], s[74:75]
    v_pk_add_f32 v[38:39], v[38:39], s[74:75]
    v_pk_add_f32 v[40:41], v[40:41], s[74:75]
    v_pk_add_f32 v[42:43], v[42:43], s[74:75]
    v_pk_fma_f32 v[112:113], v[112:113], s[76:77], v[36:37]
    v_pk_fma_f32 v[114:115], v[114:115], s[76:77], v[38:39]
    v_pk_fma_f32 v[128:129], v[128:129], s[76:77], v[40:41]
    v_pk_fma_f32 v[130:131], v[130:131], s[76:77], v[42:43]
    v_cvt_pk_bf16_f32 v106, v112, v113
    v_cvt_pk_bf16_f32 v107, v114, v115
    v_cvt_pk_bf16_f32 v122, v128, v129
    v_cvt_pk_bf16_f32 v123, v130, v131
    v_mfma_f32_16x16x32_bf16 v[60:63], v[104:107], v[152:155], v[60:63]
    s_nop 0
    s_nop 0
    v_mfma_f32_16x16x32_bf16 v[64:67], v[120:123], v[152:155], v[64:67]
    v_mfma_f32_16x16x32_bf16 v[68:71], v[104:107], v[20:23], v[68:71]
    v_mfma_f32_16x16x32_bf16 v[72:75], v[120:123], v[20:23], v[72:75]
    v_mfma_f32_16x16x32_bf16 v[44:47], v[104:107], v[136:139], v[44:47]
    v_mfma_f32_16x16x32_bf16 v[48:51], v[120:123], v[136:139], v[48:51]
    buffer_load_dwordx4 v[140:143], v7, s[12:15], s42 offen offset:0
    buffer_load_dwordx4 v[144:147], v7, s[12:15], s42 offen offset:64
    buffer_load_dwordx4 v[156:159], v7, s[12:15], s43 offen offset:0
    buffer_load_dwordx4 v[160:163], v7, s[12:15], s43 offen offset:64
    ds_write_b128 v12, v[60:63] offset:0
    ds_write_b128 v12, v[64:67] offset:1024
    s_mov_b32 exec_lo, 0x10001
    s_mov_b32 exec_hi, 0x10001
    ds_write_b128 v14, v[68:71]
    ds_write_b128 v15, v[72:75]
    s_mov_b64 exec, 1
    ds_write_b32 v3, v24 offset:32
    s_mov_b64 exec, -1
F_xw:
    ds_read_b32 v25, v18 offset:32
    ds_read_b128 v[28:31], v13 offset:1024
    ds_read_b128 v[32:35], v13
    ds_read_b32 v26, v16
    ds_read_b32 v27, v17
    s_waitcnt lgkmcnt(4)
    v_cmp_eq_u32 vcc, 0, v25
    s_cbranch_vccz F_xx
    s_waitcnt lgkmcnt(0)
    s_branch F_xw
F_xx:
    s_waitcnt lgkmcnt(3)
    v_add_f32 v44, v44, v28
    v_add_f32 v45, v45, v29
    v_add_f32 v46, v46, v30
    v_add_f32 v47, v47, v31
    buffer_atomic_add_f32 v44, v19, s[24:27], s46 offen offset:0
    buffer_atomic_add_f32 v45, v19, s[24:27], s46 offen offset:256
    buffer_atomic_add_f32 v46, v19, s[24:27], s46 offen offset:512
    buffer_atomic_add_f32 v47, v19, s[24:27], s46 offen offset:768
    s_waitcnt lgkmcnt(2)
    v_add_f32 v48, v48, v32
    v_add_f32 v49, v49, v33
    v_add_f32 v50, v50, v34
    v_add_f32 v51, v51, v35
    buffer_atomic_add_f32 v48, v19, s[24:27], s47 offen offset:0
    buffer_atomic_add_f32 v49, v19, s[24:27], s47 offen offset:256
    buffer_atomic_add_f32 v50, v19, s[24:27], s47 offen offset:512
    buffer_atomic_add_f32 v51, v19, s[24:27], s47 offen offset:768
    s_waitcnt lgkmcnt(0)
    v_add_f32 v26, v26, v27
    s_mov_b64 exec, 0xffff
    buffer_atomic_add_f32 v26, v19, s[24:27], s48 offen
    s_mov_b64 exec, 1
    ds_add_u32 v3, v24 offset:32
    s_mov_b64 exec, -1
    s_setprio 2
    v_mov_b32 v2, v7
    s_lshl_b32 s47, s3, 7
    s_add_u32 s47, s47, 157184
    v_lshlrev_b32 v5, 2, v4
    v_add_u32 v5, s47, v5
    ds_read2_b32 v[76:77], v5 offset0:0 offset1:128
    ds_read2_b32 v[78:79], v5 offset0:16 offset1:144
    v_lshrrev_b32 v4, 3, v0
    v_and_b32 v5, 7, v0
    v_lshrrev_b32 v6, 1, v4
    v_lshlrev_b32 v7, 1, v6
    v_xor_b32 v7, v5, v7
    v_lshlrev_b32 v7, 4, v7
    v_lshl_add_u32 v40, v4, 11, v7
    v_and_b32 v6, 1, v6
    v_lshlrev_b32 v6, 1, v6
    v_xor_b32 v41, v5, v6
    v_xor_b32 v42, 4, v41
    v_lshlrev_b32 v41, 4, v41
    v_lshlrev_b32 v42, 4, v42
    v_mul_u32_u24 v7, 6144, v4
    v_add_u32 v41, v41, v7
    v_add_u32 v42, v42, v7
    v_add_u32 v42, 49152, v42
    s_mul_i32 s56, s3, 98304
    s_lshl_b32 s47, s10, 7
    s_add_u32 s56, s56, s47
    s_lshl_b32 s57, s29, 7
    s_lshl_b32 s47, s3, 15
    s_add_u32 s57, s57, s47
    s_and_b32 s81, s28, 3
    s_mul_i32 s81, s81, 4
    s_lshr_b32 s47, s28, 2
    s_mul_i32 s47, s47, 1
    s_add_u32 s81, s81, s47
    s_lshl_b32 s78, s3, 11
    s_lshl_b32 s44, s10, 1
    s_add_u32 s44, s44, s37
    s_mul_i32 s45, s44, 4224
    s_mov_b32 s52, s45
    s_add_u32 s53, s45, 4096
    s_lshl_b32 s51, s44, 3
    s_and_b32 s47, s32, 3
    s_add_u32 s51, s51, s47
    s_lshl_b32 s51, s51, 7
    v_xor_b32 v18, 8, v3
    v_mov_b32 v25, 0

    s_add_u32 s54, s51, 0x82d000
    s_add_u32 s54, s72, s54
    s_addc_u32 s55, s73, 0
    s_add_u32 s82, s49, 0x82d000
    s_add_u32 s82, s72, s82
    s_addc_u32 s83, s73, 0
    s_lshl_b32 s57, s29, 7
    s_and_b32 s47, s3, 1
    s_lshl_b32 s79, s47, 12
    s_lshl_b32 s47, s47, 16
    s_add_u32 s57, s57, s47

    s_setprio 2
    s_waitcnt lgkmcnt(0)
    v_mul_f32 v76, v76, v77
    v_add_f32 v77, 1.0, v77
    v_mul_f32 v78, v78, v79
    v_add_f32 v79, 1.0, v79
    s_waitcnt vmcnt(9)
    v_lshlrev_b32 v100, 16, v140
    v_and_b32 v101, 0xffff0000, v140
    v_lshlrev_b32 v102, 16, v141
    v_and_b32 v103, 0xffff0000, v141
    v_lshlrev_b32 v104, 16, v142
    v_and_b32 v105, 0xffff0000, v142
    v_lshlrev_b32 v106, 16, v143
    v_and_b32 v107, 0xffff0000, v143
    v_fma_f32 v100, v100, v77, v76
    v_fma_f32 v101, v101, v77, v76
    v_fma_f32 v102, v102, v77, v76
    v_fma_f32 v103, v103, v77, v76
    v_fma_f32 v104, v104, v77, v76
    v_fma_f32 v105, v105, v77, v76
    v_fma_f32 v106, v106, v77, v76
    v_fma_f32 v107, v107, v77, v76
    v_lshlrev_b32 v108, 16, v144
    v_and_b32 v109, 0xffff0000, v144
    v_lshlrev_b32 v110, 16, v145
    v_and_b32 v111, 0xffff0000, v145
    v_lshlrev_b32 v112, 16, v146
    v_and_b32 v113, 0xffff0000, v146
    v_lshlrev_b32 v114, 16, v147
    v_and_b32 v115, 0xffff0000, v147
    v_fma_f32 v108, v108, v77, v76
    v_fma_f32 v109, v109, v77, v76
    v_fma_f32 v110, v110, v77, v76
    v_fma_f32 v111, v111, v77, v76
    v_fma_f32 v112, v112, v77, v76
    v_fma_f32 v113, v113, v77, v76
    v_fma_f32 v114, v114, v77, v76
    v_fma_f32 v115, v115, v77, v76
    v_lshlrev_b32 v116, 16, v156
    v_and_b32 v117, 0xffff0000, v156
    v_lshlrev_b32 v118, 16, v157
    v_and_b32 v119, 0xffff0000, v157
    v_lshlrev_b32 v120, 16, v158
    v_and_b32 v121, 0xffff0000, v158
    v_lshlrev_b32 v122, 16, v159
    v_and_b32 v123, 0xffff0000, v159
    v_fma_f32 v116, v116, v79, v78
    v_fma_f32 v117, v117, v79, v78
    v_fma_f32 v118, v118, v79, v78
    v_fma_f32 v119, v119, v79, v78
    v_fma_f32 v120, v120, v79, v78
    v_fma_f32 v121, v121, v79, v78
    v_fma_f32 v122, v122, v79, v78
    v_fma_f32 v123, v123, v79, v78
    v_lshlrev_b32 v124, 16, v160
    v_and_b32 v125, 0xffff0000, v160
    v_lshlrev_b32 v126, 16, v161
    v_and_b32 v127, 0xffff0000, v161
    v_lshlrev_b32 v128, 16, v162
    v_and_b32 v129, 0xffff0000, v162
    v_lshlrev_b32 v130, 16, v163
    v_and_b32 v131, 0xffff0000, v163
    v_fma_f32 v124, v124, v79, v78
    v_fma_f32 v125, v125, v79, v78
    v_fma_f32 v126, v126, v79, v78
    v_fma_f32 v127, v127, v79, v78
    v_fma_f32 v128, v128, v79, v78
    v_fma_f32 v129, v129, v79, v78
    v_fma_f32 v130, v130, v79, v78
    v_fma_f32 v131, v131, v79, v78
    v_permlane16_swap_b32 v100, v104
    v_permlane16_swap_b32 v101, v105
    v_permlane16_swap_b32 v102, v106
    v_permlane16_swap_b32 v103, v107
    v_permlane16_swap_b32 v108, v112
    v_permlane16_swap_b32 v109, v113
    v_permlane16_swap_b32 v110, v114
    v_permlane16_swap_b32 v111, v115
    v_permlane16_swap_b32 v116, v120
    v_permlane16_swap_b32 v117, v121
    v_permlane16_swap_b32 v118, v122
    v_permlane16_swap_b32 v119, v123
    v_permlane16_swap_b32 v124, v128
    v_permlane16_swap_b32 v125, v129
    v_permlane16_swap_b32 v126, v130
    v_permlane16_swap_b32 v127, v131
    s_setprio 2
    s_cmp_lt_u32 s3, 2
    s_cbranch_scc1 F_w0
    v_cmp_gt_u32 vcc, 1, v25
    s_cbranch_vccz CW_18
    ds_read_b32 v25, v1 offset:0
FW_19:
    s_waitcnt lgkmcnt(0)
    v_cmp_gt_u32 vcc, 1, v25
    s_cbranch_vccz FO_20
    s_sleep 2
    ds_read_b32 v25, v1 offset:0
    s_branch FW_19
FO_20:
CW_18:
    s_add_u32 s47, s81, 0
    s_and_b32 s47, s47, 15
    s_lshl_b32 s47, s47, 17
    s_add_u32 m0, s79, 147456
    s_add_u32 s47, s47, s57
    buffer_load_dwordx4 v40, s[20:23], s47 offen lds
    s_add_u32 m0, m0, 1024
    s_add_u32 s47, s47, 16384
    buffer_load_dwordx4 v40, s[20:23], s47 offen lds
    s_add_u32 m0, m0, 1024
    s_add_u32 s47, s47, 16384
    buffer_load_dwordx4 v40, s[20:23], s47 offen lds
    s_add_u32 m0, m0, 1024
    s_add_u32 s47, s47, 16384
    buffer_load_dwordx4 v40, s[20:23], s47 offen lds
    v_cmp_gt_u32 vcc, 2, v25
    s_cbranch_vccz CW_21
    ds_read_b32 v25, v1 offset:0
FW_22:
    s_waitcnt lgkmcnt(0)
    v_cmp_gt_u32 vcc, 2, v25
    s_cbranch_vccz FO_23
    s_sleep 2
    ds_read_b32 v25, v1 offset:0
    s_branch FW_22
FO_23:
CW_21:
    s_add_u32 s47, s81, 1
    s_and_b32 s47, s47, 15
    s_lshl_b32 s47, s47, 17
    s_add_u32 m0, s79, 0
    s_add_u32 s47, s47, s57
    buffer_load_dwordx4 v40, s[20:23], s47 offen lds
    s_add_u32 m0, m0, 1024
    s_add_u32 s47, s47, 16384
    buffer_load_dwordx4 v40, s[20:23], s47 offen lds
    s_add_u32 m0, m0, 1024
    s_add_u32 s47, s47, 16384
    buffer_load_dwordx4 v40, s[20:23], s47 offen lds
    s_add_u32 m0, m0, 1024
    s_add_u32 s47, s47, 16384
    buffer_load_dwordx4 v40, s[20:23], s47 offen lds
    s_waitcnt vmcnt(8)
    s_branch F_w1
F_w0:
    s_waitcnt vmcnt(0)
F_w1:
    s_mov_b32 s49, 1
    s_atomic_add s49, s[82:83], 0x0
    s_atomic_add s49, s[82:83], 0x80
    s_atomic_add s49, s[82:83], 0x100
    s_atomic_add s49, s[82:83], 0x180
    v_mov_b32 v26, 3
    s_mov_b64 exec, 1
    ds_write_b32 v3, v26 offset:32
    s_mov_b64 exec, -1
    s_cmp_ge_u32 s3, 2
    s_cbranch_scc1 F_wo
    ds_read_b32 v26, v18 offset:32
FW_24:
    s_waitcnt lgkmcnt(0)
    v_cmp_gt_u32 vcc, 2, v26
    s_cbranch_vccz FO_25
    ds_read_b32 v26, v18 offset:32
    s_branch FW_24
FO_25:
    v_cmp_gt_u32 vcc, 4, v25
    s_cbranch_vccz CW_26
    ds_read_b32 v25, v1 offset:0
FW_27:
    s_waitcnt lgkmcnt(0)
    v_cmp_gt_u32 vcc, 4, v25
    s_cbranch_vccz FO_28
    s_sleep 2
    ds_read_b32 v25, v1 offset:0
    s_branch FW_27
FO_28:
CW_26:
    v_lshlrev_b32 v9, 4, v0
    s_lshl_b32 s50, s3, 7
    s_add_u32 s50, s50, 159232
    s_add_u32 m0, s78, 32768
SP_29:
    s_load_dword s58, s[54:55], 0 glc
    s_waitcnt lgkmcnt(0)
    s_cmp_ge_u32 s58, 32
    s_cbranch_scc1 SD_30
    s_sleep 1
    s_branch SP_29
SD_30:
    buffer_load_dwordx4 v9, s[24:27], s52 offen offset:0 sc1 lds
    buffer_load_dwordx4 v9, s[24:27], s52 offen offset:1024 sc1 lds
    s_add_u32 m0, m0, 2048
    s_nop 0
    buffer_load_dwordx4 v9, s[24:27], s52 offen offset:2048 sc1 lds
    buffer_load_dwordx4 v9, s[24:27], s52 offen offset:3072 sc1 lds
    s_mov_b32 m0, s50
    s_mov_b32 exec_hi, 0
    buffer_load_dword v19, s[24:27], s53 offen sc1 lds
    s_mov_b64 exec, 1
    s_lshl_b32 s50, s3, 2
    s_add_u32 m0, s50, 159168
    s_add_u32 s51, s51, 184320
    buffer_load_dword v19, s[24:27], s51 offen sc1 lds
    s_waitcnt vmcnt(0)
    s_mov_b64 exec, 1
    v_mov_b32 v26, 32
    ds_write_b32 v3, v26 offset:128
    s_mov_b64 exec, -1
    s_branch F_wj
F_wo:
    v_cmp_gt_u32 vcc, 2, v25
    s_cbranch_vccz CW_31
    ds_read_b32 v25, v1 offset:0
FW_32:
    s_waitcnt lgkmcnt(0)
    v_cmp_gt_u32 vcc, 2, v25
    s_cbranch_vccz FO_33
    s_sleep 2
    ds_read_b32 v25, v1 offset:0
    s_branch FW_32
FO_33:
CW_31:
    s_add_u32 s47, s81, 2
    s_and_b32 s47, s47, 15
    s_lshl_b32 s47, s47, 17
    s_add_u32 m0, s79, 8192
    s_add_u32 s47, s47, s57
    buffer_load_dwordx4 v40, s[20:23], s47 offen lds
    s_add_u32 m0, m0, 1024
    s_add_u32 s47, s47, 16384
    buffer_load_dwordx4 v40, s[20:23], s47 offen lds
    s_add_u32 m0, m0, 1024
    s_add_u32 s47, s47, 16384
    buffer_load_dwordx4 v40, s[20:23], s47 offen lds
    s_add_u32 m0, m0, 1024
    s_add_u32 s47, s47, 16384
    buffer_load_dwordx4 v40, s[20:23], s47 offen lds
    v_cmp_gt_u32 vcc, 2, v25
    s_cbranch_vccz CW_34
    ds_read_b32 v25, v1 offset:0
FW_35:
    s_waitcnt lgkmcnt(0)
    v_cmp_gt_u32 vcc, 2, v25
    s_cbranch_vccz FO_36
    s_sleep 2
    ds_read_b32 v25, v1 offset:0
    s_branch FW_35
FO_36:
CW_34:
    s_add_u32 s47, s81, 3
    s_and_b32 s47, s47, 15
    s_lshl_b32 s47, s47, 17
    s_add_u32 m0, s79, 139264
    s_add_u32 s47, s47, s57
    s_nop 0
    buffer_load_dwordx4 v40, s[20:23], s47 offen lds
    s_add_u32 m0, m0, 1024
    s_add_u32 s47, s47, 16384
    buffer_load_dwordx4 v40, s[20:23], s47 offen lds
    s_add_u32 m0, m0, 1024
    s_add_u32 s47, s47, 16384
    buffer_load_dwordx4 v40, s[20:23], s47 offen lds
    s_add_u32 m0, m0, 1024
    s_add_u32 s47, s47, 16384
    buffer_load_dwordx4 v40, s[20:23], s47 offen lds
    v_cmp_gt_u32 vcc, 3, v25
    s_cbranch_vccz CW_37
    ds_read_b32 v25, v1 offset:0
FW_38:
    s_waitcnt lgkmcnt(0)
    v_cmp_gt_u32 vcc, 3, v25
    s_cbranch_vccz FO_39
    s_sleep 2
    ds_read_b32 v25, v1 offset:0
    s_branch FW_38
FO_39:
CW_37:
    s_waitcnt vmcnt(12)
    s_add_u32 s47, s81, 4
    s_and_b32 s47, s47, 15
    s_lshl_b32 s47, s47, 17
    s_add_u32 m0, s79, 16384
    s_add_u32 s47, s47, s57
    buffer_load_dwordx4 v40, s[20:23], s47 offen lds
    s_add_u32 m0, m0, 1024
    s_add_u32 s47, s47, 16384
    buffer_load_dwordx4 v40, s[20:23], s47 offen lds
    s_add_u32 m0, m0, 1024
    s_add_u32 s47, s47, 16384
    buffer_load_dwordx4 v40, s[20:23], s47 offen lds
    s_add_u32 m0, m0, 1024
    s_add_u32 s47, s47, 16384
    buffer_load_dwordx4 v40, s[20:23], s47 offen lds
    v_cmp_gt_u32 vcc, 3, v25
    s_cbranch_vccz CW_40
    ds_read_b32 v25, v1 offset:0
FW_41:
    s_waitcnt lgkmcnt(0)
    v_cmp_gt_u32 vcc, 3, v25
    s_cbranch_vccz FO_42
    s_sleep 2
    ds_read_b32 v25, v1 offset:0
    s_branch FW_41
FO_42:
CW_40:
    s_waitcnt vmcnt(12)
    s_add_u32 s47, s81, 5
    s_and_b32 s47, s47, 15
    s_lshl_b32 s47, s47, 17
    s_add_u32 m0, s79, 24576
    s_add_u32 s47, s47, s57
    buffer_load_dwordx4 v40, s[20:23], s47 offen lds
    s_add_u32 m0, m0, 1024
    s_add_u32 s47, s47, 16384
    buffer_load_dwordx4 v40, s[20:23], s47 offen lds
    s_add_u32 m0, m0, 1024
    s_add_u32 s47, s47, 16384
    buffer_load_dwordx4 v40, s[20:23], s47 offen lds
    s_add_u32 m0, m0, 1024
    s_add_u32 s47, s47, 16384
    buffer_load_dwordx4 v40, s[20:23], s47 offen lds
    v_cmp_gt_u32 vcc, 3, v25
    s_cbranch_vccz CW_43
    ds_read_b32 v25, v1 offset:0
FW_44:
    s_waitcnt lgkmcnt(0)
    v_cmp_gt_u32 vcc, 3, v25
    s_cbranch_vccz FO_45
    s_sleep 2
    ds_read_b32 v25, v1 offset:0
    s_branch FW_44
FO_45:
CW_43:
    s_waitcnt vmcnt(12)
    s_add_u32 s47, s81, 6
    s_and_b32 s47, s47, 15
    s_lshl_b32 s47, s47, 17
    s_add_u32 m0, s79, 131072
    s_add_u32 s47, s47, s57
    buffer_load_dwordx4 v40, s[20:23], s47 offen lds
    s_add_u32 m0, m0, 1024
    s_add_u32 s47, s47, 16384
    buffer_load_dwordx4 v40, s[20:23], s47 offen lds
    s_add_u32 m0, m0, 1024
    s_add_u32 s47, s47, 16384
    buffer_load_dwordx4 v40, s[20:23], s47 offen lds
    s_add_u32 m0, m0, 1024
    s_add_u32 s47, s47, 16384
    buffer_load_dwordx4 v40, s[20:23], s47 offen lds
    v_cmp_gt_u32 vcc, 4, v25
    s_cbranch_vccz CW_46
    ds_read_b32 v25, v1 offset:0
FW_47:
    s_waitcnt lgkmcnt(0)
    v_cmp_gt_u32 vcc, 4, v25
    s_cbranch_vccz FO_48
    s_sleep 2
    ds_read_b32 v25, v1 offset:0
    s_branch FW_47
FO_48:
CW_46:
    s_waitcnt vmcnt(12)
    s_add_u32 s47, s81, 7
    s_and_b32 s47, s47, 15
    s_lshl_b32 s47, s47, 17
    s_add_u32 m0, s79, 40960
    s_add_u32 s47, s47, s57
    buffer_load_dwordx4 v40, s[20:23], s47 offen lds
    s_add_u32 m0, m0, 1024
    s_add_u32 s47, s47, 16384
    buffer_load_dwordx4 v40, s[20:23], s47 offen lds
    s_add_u32 m0, m0, 1024
    s_add_u32 s47, s47, 16384
    buffer_load_dwordx4 v40, s[20:23], s47 offen lds
    s_add_u32 m0, m0, 1024
    s_add_u32 s47, s47, 16384
    buffer_load_dwordx4 v40, s[20:23], s47 offen lds
    v_cmp_gt_u32 vcc, 5, v25
    s_cbranch_vccz CW_49
    ds_read_b32 v25, v1 offset:0
FW_50:
    s_waitcnt lgkmcnt(0)
    v_cmp_gt_u32 vcc, 5, v25
    s_cbranch_vccz FO_51
    s_sleep 2
    ds_read_b32 v25, v1 offset:0
    s_branch FW_50
FO_51:
CW_49:
    s_waitcnt vmcnt(12)
    s_add_u32 s47, s81, 8
    s_and_b32 s47, s47, 15
    s_lshl_b32 s47, s47, 17
    s_add_u32 m0, s79, 49152
    s_add_u32 s47, s47, s57
    buffer_load_dwordx4 v40, s[20:23], s47 offen lds
    s_add_u32 m0, m0, 1024
    s_add_u32 s47, s47, 16384
    buffer_load_dwordx4 v40, s[20:23], s47 offen lds
    s_add_u32 m0, m0, 1024
    s_add_u32 s47, s47, 16384
    buffer_load_dwordx4 v40, s[20:23], s47 offen lds
    s_add_u32 m0, m0, 1024
    s_add_u32 s47, s47, 16384
    buffer_load_dwordx4 v40, s[20:23], s47 offen lds
    v_cmp_gt_u32 vcc, 5, v25
    s_cbranch_vccz CW_52
    ds_read_b32 v25, v1 offset:0
FW_53:
    s_waitcnt lgkmcnt(0)
    v_cmp_gt_u32 vcc, 5, v25
    s_cbranch_vccz FO_54
    s_sleep 2
    ds_read_b32 v25, v1 offset:0
    s_branch FW_53
FO_54:
CW_52:
    s_waitcnt vmcnt(12)
    s_add_u32 s47, s81, 9
    s_and_b32 s47, s47, 15
    s_lshl_b32 s47, s47, 17
    s_add_u32 m0, s79, 57344
    s_add_u32 s47, s47, s57
    buffer_load_dwordx4 v40, s[20:23], s47 offen lds
    s_add_u32 m0, m0, 1024
    s_add_u32 s47, s47, 16384
    buffer_load_dwordx4 v40, s[20:23], s47 offen lds
    s_add_u32 m0, m0, 1024
    s_add_u32 s47, s47, 16384
    buffer_load_dwordx4 v40, s[20:23], s47 offen lds
    s_add_u32 m0, m0, 1024
    s_add_u32 s47, s47, 16384
    buffer_load_dwordx4 v40, s[20:23], s47 offen lds
    v_cmp_gt_u32 vcc, 5, v25
    s_cbranch_vccz CW_55
    ds_read_b32 v25, v1 offset:0
FW_56:
    s_waitcnt lgkmcnt(0)
    v_cmp_gt_u32 vcc, 5, v25
    s_cbranch_vccz FO_57
    s_sleep 2
    ds_read_b32 v25, v1 offset:0
    s_branch FW_56
FO_57:
CW_55:
    s_waitcnt vmcnt(12)
    s_add_u32 s47, s81, 10
    s_and_b32 s47, s47, 15
    s_lshl_b32 s47, s47, 17
    s_add_u32 m0, s79, 73728
    s_add_u32 s47, s47, s57
    buffer_load_dwordx4 v40, s[20:23], s47 offen lds
    s_add_u32 m0, m0, 1024
    s_add_u32 s47, s47, 16384
    buffer_load_dwordx4 v40, s[20:23], s47 offen lds
    s_add_u32 m0, m0, 1024
    s_add_u32 s47, s47, 16384
    buffer_load_dwordx4 v40, s[20:23], s47 offen lds
    s_add_u32 m0, m0, 1024
    s_add_u32 s47, s47, 16384
    buffer_load_dwordx4 v40, s[20:23], s47 offen lds
    v_cmp_gt_u32 vcc, 6, v25
    s_cbranch_vccz CW_58
    ds_read_b32 v25, v1 offset:0
FW_59:
    s_waitcnt lgkmcnt(0)
    v_cmp_gt_u32 vcc, 6, v25
    s_cbranch_vccz FO_60
    s_sleep 2
    ds_read_b32 v25, v1 offset:0
    s_branch FW_59
FO_60:
CW_58:
    s_waitcnt vmcnt(12)
    s_add_u32 s47, s81, 11
    s_and_b32 s47, s47, 15
    s_lshl_b32 s47, s47, 17
    s_add_u32 m0, s79, 98304
    s_add_u32 s47, s47, s57
    buffer_load_dwordx4 v40, s[20:23], s47 offen lds
    s_add_u32 m0, m0, 1024
    s_add_u32 s47, s47, 16384
    buffer_load_dwordx4 v40, s[20:23], s47 offen lds
    s_add_u32 m0, m0, 1024
    s_add_u32 s47, s47, 16384
    buffer_load_dwordx4 v40, s[20:23], s47 offen lds
    s_add_u32 m0, m0, 1024
    s_add_u32 s47, s47, 16384
    buffer_load_dwordx4 v40, s[20:23], s47 offen lds
    v_cmp_gt_u32 vcc, 7, v25
    s_cbranch_vccz CW_61
    ds_read_b32 v25, v1 offset:0
FW_62:
    s_waitcnt lgkmcnt(0)
    v_cmp_gt_u32 vcc, 7, v25
    s_cbranch_vccz FO_63
    s_sleep 2
    ds_read_b32 v25, v1 offset:0
    s_branch FW_62
FO_63:
CW_61:
    s_waitcnt vmcnt(12)
    s_add_u32 s47, s81, 12
    s_and_b32 s47, s47, 15
    s_lshl_b32 s47, s47, 17
    s_add_u32 m0, s79, 90112
    s_add_u32 s47, s47, s57
    buffer_load_dwordx4 v40, s[20:23], s47 offen lds
    s_add_u32 m0, m0, 1024
    s_add_u32 s47, s47, 16384
    buffer_load_dwordx4 v40, s[20:23], s47 offen lds
    s_add_u32 m0, m0, 1024
    s_add_u32 s47, s47, 16384
    buffer_load_dwordx4 v40, s[20:23], s47 offen lds
    s_add_u32 m0, m0, 1024
    s_add_u32 s47, s47, 16384
    buffer_load_dwordx4 v40, s[20:23], s47 offen lds
    v_cmp_gt_u32 vcc, 8, v25
    s_cbranch_vccz CW_64
    ds_read_b32 v25, v1 offset:0
FW_65:
    s_waitcnt lgkmcnt(0)
    v_cmp_gt_u32 vcc, 8, v25
    s_cbranch_vccz FO_66
    s_sleep 2
    ds_read_b32 v25, v1 offset:0
    s_branch FW_65
FO_66:
CW_64:
    s_waitcnt vmcnt(12)
    s_add_u32 s47, s81, 13
    s_and_b32 s47, s47, 15
    s_lshl_b32 s47, s47, 17
    s_add_u32 m0, s79, 106496
    s_add_u32 s47, s47, s57
    buffer_load_dwordx4 v40, s[20:23], s47 offen lds
    s_add_u32 m0, m0, 1024
    s_add_u32 s47, s47, 16384
    buffer_load_dwordx4 v40, s[20:23], s47 offen lds
    s_add_u32 m0, m0, 1024
    s_add_u32 s47, s47, 16384
    buffer_load_dwordx4 v40, s[20:23], s47 offen lds
    s_add_u32 m0, m0, 1024
    s_add_u32 s47, s47, 16384
    buffer_load_dwordx4 v40, s[20:23], s47 offen lds
    v_cmp_gt_u32 vcc, 9, v25
    s_cbranch_vccz CW_67
    ds_read_b32 v25, v1 offset:0
FW_68:
    s_waitcnt lgkmcnt(0)
    v_cmp_gt_u32 vcc, 9, v25
    s_cbranch_vccz FO_69
    s_sleep 2
    ds_read_b32 v25, v1 offset:0
    s_branch IW_s6
IW_w6:
    s_branch IW_r6
IW_s6:
    s_branch FW_68
FO_69:
CW_67:
    s_waitcnt vmcnt(12)
    s_add_u32 s47, s81, 14
    s_and_b32 s47, s47, 15
    s_lshl_b32 s47, s47, 17
    s_add_u32 m0, s79, 65536
    s_add_u32 s47, s47, s57
    buffer_load_dwordx4 v40, s[20:23], s47 offen lds
    s_add_u32 m0, m0, 1024
    s_add_u32 s47, s47, 16384
    buffer_load_dwordx4 v40, s[20:23], s47 offen lds
    s_add_u32 m0, m0, 1024
    s_add_u32 s47, s47, 16384
    buffer_load_dwordx4 v40, s[20:23], s47 offen lds
    s_add_u32 m0, m0, 1024
    s_add_u32 s47, s47, 16384
    buffer_load_dwordx4 v40, s[20:23], s47 offen lds
    v_cmp_gt_u32 vcc, 10, v25
    s_cbranch_vccz CW_70
    ds_read_b32 v25, v1 offset:0
FW_71:
    s_waitcnt lgkmcnt(0)
    v_cmp_gt_u32 vcc, 10, v25
    s_cbranch_vccz FO_72
    s_sleep 2
    ds_read_b32 v25, v1 offset:0
    s_branch FW_71
FO_72:
CW_70:
    s_waitcnt vmcnt(12)
    s_add_u32 s47, s81, 15
    s_and_b32 s47, s47, 15
    s_lshl_b32 s47, s47, 17
    s_add_u32 m0, s79, 122880
    s_add_u32 s47, s47, s57
    buffer_load_dwordx4 v40, s[20:23], s47 offen lds
    s_add_u32 m0, m0, 1024
    s_add_u32 s47, s47, 16384
    buffer_load_dwordx4 v40, s[20:23], s47 offen lds
    s_add_u32 m0, m0, 1024
    s_add_u32 s47, s47, 16384
    buffer_load_dwordx4 v40, s[20:23], s47 offen lds
    s_add_u32 m0, m0, 1024
    s_add_u32 s47, s47, 16384
    buffer_load_dwordx4 v40, s[20:23], s47 offen lds
F_wj:
    v_mov_b32 v5, 159096
    ds_read_b32 v6, v5 offset:0
FW_73:
    s_waitcnt lgkmcnt(0)
    v_cmp_gt_u32 vcc, 1, v6
    s_cbranch_vccz FO_74
    s_sleep 1
    ds_read_b32 v6, v5 offset:0
    s_branch FW_73
FO_74:
    v_and_b32 v5, 7, v0
    v_lshlrev_b32 v5, 2, v5
    v_add_u32 v5, 158976, v5
    ds_read_b32 v5, v5
    s_lshr_b32 s47, s64, 5
    s_sub_u32 s47, 63, s47
    s_mov_b64 s[60:61], 0
    s_waitcnt lgkmcnt(0)
    v_bfe_u32 v5, v5, 5, 6
    v_cmp_eq_u32 vcc, s47, v5
    s_cbranch_vccz F_ns

    v_mov_b32 v5, 158976
    ds_read_b128 v[44:47], v5
    ds_read_b128 v[48:51], v5 offset:16
    v_and_b32 v6, 15, v0
    v_add_u32 v6, s64, v6
    v_sub_u32 v6, 2047, v6
    v_subrev_u32 v7, 16, v6
    v_mov_b32 v164, 0
    v_mov_b32 v165, 0
    s_waitcnt lgkmcnt(0)
    v_and_b32 v5, 0x7ff, v44
    v_or_b32 v44, 0x4000, v44
    v_cmp_eq_u32 vcc, v5, v6
    v_cmp_eq_u32 s[62:63], v5, v7
    s_nop 0
    v_cndmask_b32 v164, v164, v44, vcc
    v_cndmask_b32 v165, v165, v44, s[62:63]
    v_and_b32 v5, 0x7ff, v45
    v_or_b32 v45, 0x4800, v45
    v_cmp_eq_u32 vcc, v5, v6
    v_cmp_eq_u32 s[62:63], v5, v7
    s_nop 0
    v_cndmask_b32 v164, v164, v45, vcc
    v_cndmask_b32 v165, v165, v45, s[62:63]
    v_and_b32 v5, 0x7ff, v46
    v_or_b32 v46, 0x5000, v46
    v_cmp_eq_u32 vcc, v5, v6
    v_cmp_eq_u32 s[62:63], v5, v7
    s_nop 0
    v_cndmask_b32 v164, v164, v46, vcc
    v_cndmask_b32 v165, v165, v46, s[62:63]
    v_and_b32 v5, 0x7ff, v47
    v_or_b32 v47, 0x5800, v47
    v_cmp_eq_u32 vcc, v5, v6
    v_cmp_eq_u32 s[62:63], v5, v7
    s_nop 0
    v_cndmask_b32 v164, v164, v47, vcc
    v_cndmask_b32 v165, v165, v47, s[62:63]
    v_and_b32 v5, 0x7ff, v48
    v_or_b32 v48, 0x6000, v48
    v_cmp_eq_u32 vcc, v5, v6
    v_cmp_eq_u32 s[62:63], v5, v7
    s_nop 0
    v_cndmask_b32 v164, v164, v48, vcc
    v_cndmask_b32 v165, v165, v48, s[62:63]
    v_and_b32 v5, 0x7ff, v49
    v_or_b32 v49, 0x6800, v49
    v_cmp_eq_u32 vcc, v5, v6
    v_cmp_eq_u32 s[62:63], v5, v7
    s_nop 0
    v_cndmask_b32 v164, v164, v49, vcc
    v_cndmask_b32 v165, v165, v49, s[62:63]
    v_and_b32 v5, 0x7ff, v50
    v_or_b32 v50, 0x7000, v50
    v_cmp_eq_u32 vcc, v5, v6
    v_cmp_eq_u32 s[62:63], v5, v7
    s_nop 0
    v_cndmask_b32 v164, v164, v50, vcc
    v_cndmask_b32 v165, v165, v50, s[62:63]
    v_and_b32 v5, 0x7ff, v51
    v_or_b32 v51, 0x7800, v51
    v_cmp_eq_u32 vcc, v5, v6
    v_cmp_eq_u32 s[62:63], v5, v7
    s_nop 0
    v_cndmask_b32 v164, v164, v51, vcc
    v_cndmask_b32 v165, v165, v51, s[62:63]
    s_mov_b64 s[60:61], 1
F_ns:
    s_lshl_b32 s51, s28, 2
    s_add_u32 s51, s51, s3
    s_lshl_b32 s51, s51, 3
    s_and_b32 s47, s29, 3
    s_add_u32 s51, s51, s47
    s_lshl_b32 s51, s51, 7

    s_add_u32 s54, s51, 0x835000
    s_add_u32 s54, s72, s54
    s_addc_u32 s55, s73, 0
    v_lshlrev_b32 v98, 4, v0
    v_lshrrev_b32 v16, 4, v0
    v_bfe_u32 v17, v0, 2, 2
    v_lshl_add_u32 v17, v16, 2, v17
    v_bfe_u32 v16, v17, 1, 2
    v_lshlrev_b32 v16, 5, v16
    v_lshl_add_u32 v16, v17, 7, v16
    v_and_b32 v17, 3, v0
    v_lshl_add_u32 v4, v17, 3, v16
    v_xor_b32 v5, 32, v4
    v_xor_b32 v6, 64, v4
    v_xor_b32 v7, 96, v4
    s_lshl_b32 s79, s28, 18
    s_lshl_b32 s80, s3, 16
    s_add_u32 s79, s79, s80
    s_lshl_b32 s81, s81, 11
    v_mov_b32_e64 v99, 1

    v_add_u32 v8, 57344, v4
    v_add_u32 v9, 57344, v5
    v_add_u32 v10, 57344, v6
    v_add_u32 v11, 57344, v7
    v_add_u32 v12, 114688, v4
    v_add_u32 v13, 114688, v5
    v_add_u32 v14, 114688, v6
    v_add_u32 v15, 114688, v7
    s_add_u32 s16, s72, 0x400000
    s_addc_u32 s17, s73, 0
    s_mov_b32 s18, 0x400000
    s_mov_b32 s19, 0x00020000
    s_mov_b32 s12, s68
    s_mov_b32 s13, s69
    s_mov_b32 s14, 0x400000
    s_mov_b32 s15, 0x00020000
    s_add_u32 s80, s81, 0
    s_and_b32 s80, s80, 0x7fff
    s_add_u32 s4, s80, s79
    s_add_u32 s80, s81, 2048
    s_and_b32 s80, s80, 0x7fff
    s_add_u32 s5, s80, s79
    s_add_u32 s80, s81, 4096
    s_and_b32 s80, s80, 0x7fff
    s_add_u32 s6, s80, s79
    s_add_u32 s80, s81, 6144
    s_and_b32 s80, s80, 0x7fff
    s_add_u32 s7, s80, s79
    s_add_u32 s80, s81, 8192
    s_and_b32 s80, s80, 0x7fff
    s_add_u32 s8, s80, s79
    s_add_u32 s80, s81, 10240
    s_and_b32 s80, s80, 0x7fff
    s_add_u32 s9, s80, s79
    s_add_u32 s80, s81, 12288
    s_and_b32 s80, s80, 0x7fff
    s_add_u32 s10, s80, s79
    s_add_u32 s80, s81, 14336
    s_and_b32 s80, s80, 0x7fff
    s_add_u32 s11, s80, s79
    s_add_u32 s80, s81, 16384
    s_and_b32 s80, s80, 0x7fff
    s_add_u32 s30, s80, s79
    s_add_u32 s80, s81, 18432
    s_and_b32 s80, s80, 0x7fff
    s_add_u32 s31, s80, s79
    s_add_u32 s80, s81, 20480
    s_and_b32 s80, s80, 0x7fff
    s_add_u32 s32, s80, s79
    s_add_u32 s80, s81, 22528
    s_and_b32 s80, s80, 0x7fff
    s_add_u32 s33, s80, s79
    s_add_u32 s80, s81, 24576
    s_and_b32 s80, s80, 0x7fff
    s_add_u32 s34, s80, s79
    s_add_u32 s80, s81, 26624
    s_and_b32 s80, s80, 0x7fff
    s_add_u32 s35, s80, s79
    s_add_u32 s80, s81, 28672
    s_and_b32 s80, s80, 0x7fff
    s_add_u32 s36, s80, s79
    s_add_u32 s80, s81, 30720
    s_and_b32 s80, s80, 0x7fff
    s_add_u32 s37, s80, s79
    v_add_u32 v97, 0x8000, v98
    s_setprio 2
    s_mov_b32 s50, 0
F_op:
    s_load_dword s47, s[54:55], 0 glc
    s_getreg_b32 s51, hwreg(HW_REG_IB_STS)
    s_and_b32 s51, s51, 0xc0000f
    s_or_b32 s51, s51, s50
    s_cbranch_scc1 F_oq
    s_mov_b64 exec, 1
    ds_write_b32 v3, v99 offset:160
    s_mov_b64 exec, -1
    s_mov_b32 s50, 1
F_oq:
    s_waitcnt lgkmcnt(0)
    s_cmp_lt_u32 s47, 16
    s_cbranch_scc1 F_op
    s_nop 0
    buffer_load_dwordx4 v[48:51], v98, s[16:19], s4 offen offset:0 sc1
    buffer_load_dwordx4 v[52:55], v97, s[16:19], s4 offen offset:0 sc1
    buffer_load_dwordx4 v[56:59], v98, s[16:19], s4 offen offset:1024 sc1
    buffer_load_dwordx4 v[60:63], v97, s[16:19], s4 offen offset:1024 sc1
    buffer_load_dwordx4 v[64:67], v98, s[16:19], s5 offen offset:0 sc1
    buffer_load_dwordx4 v[68:71], v97, s[16:19], s5 offen offset:0 sc1
    buffer_load_dwordx4 v[72:75], v98, s[16:19], s5 offen offset:1024 sc1
    buffer_load_dwordx4 v[76:79], v97, s[16:19], s5 offen offset:1024 sc1
    buffer_load_dwordx4 v[80:83], v98, s[16:19], s6 offen offset:0 sc1
    buffer_load_dwordx4 v[84:87], v97, s[16:19], s6 offen offset:0 sc1
    buffer_load_dwordx4 v[88:91], v98, s[16:19], s6 offen offset:1024 sc1
    buffer_load_dwordx4 v[92:95], v97, s[16:19], s6 offen offset:1024 sc1
    s_cmp_lg_u32 s50, 0
    s_cbranch_scc1 F_or
    s_waitcnt vmcnt(12)
    s_mov_b64 exec, 1
    ds_write_b32 v3, v99 offset:160
    s_mov_b64 exec, -1
F_or:
    v_or_b32 v17, 8, v1
    ds_read_b32 v16, v17 offset:160
FW_75:
    s_waitcnt lgkmcnt(0)
    v_cmp_gt_u32 vcc, 1, v16
    s_cbranch_vccz FO_76
    ds_read_b32 v16, v17 offset:160
    s_branch FW_75
FO_76:
    v_and_b32 v1, 0x3fff, v2
    v_bfe_u32 v99, v0, 3, 1
    v_lshl_add_u32 v1, v99, 6, v1
    ds_read_b64_tr_b16 v[16:17], v12 offset:32768
    ds_read_b64_tr_b16 v[18:19], v12 offset:34816
    ds_read_b64_tr_b16 v[20:21], v13 offset:32768
    ds_read_b64_tr_b16 v[22:23], v13 offset:34816
    ds_read_b64_tr_b16 v[24:25], v14 offset:32768
    ds_read_b64_tr_b16 v[26:27], v14 offset:34816
    ds_read_b64_tr_b16 v[28:29], v15 offset:32768
    ds_read_b64_tr_b16 v[30:31], v15 offset:34816
    s_waitcnt vmcnt(10) lgkmcnt(0)
    s_nop 0
    v_mfma_f32_16x16x32_bf16 v[100:103], v[16:19], v[48:51], v[100:103]
    ds_read_b64_tr_b16 v[32:33], v12 offset:36864
    ds_read_b64_tr_b16 v[34:35], v12 offset:38912
    v_mfma_f32_16x16x32_bf16 v[116:119], v[16:19], v[52:55], v[116:119]
    ds_read_b64_tr_b16 v[36:37], v13 offset:36864
    ds_read_b64_tr_b16 v[38:39], v13 offset:38912
    v_mfma_f32_16x16x32_bf16 v[104:107], v[20:23], v[48:51], v[104:107]
    ds_read_b64_tr_b16 v[40:41], v14 offset:36864
    ds_read_b64_tr_b16 v[42:43], v14 offset:38912
    v_mfma_f32_16x16x32_bf16 v[120:123], v[20:23], v[52:55], v[120:123]
    ds_read_b64_tr_b16 v[44:45], v15 offset:36864
    ds_read_b64_tr_b16 v[46:47], v15 offset:38912
    v_mfma_f32_16x16x32_bf16 v[108:111], v[24:27], v[48:51], v[108:111]
    buffer_load_dwordx4 v[132:135], v98, s[16:19], s7 offen offset:0 sc1
    v_mfma_f32_16x16x32_bf16 v[124:127], v[24:27], v[52:55], v[124:127]
    v_mfma_f32_16x16x32_bf16 v[112:115], v[28:31], v[48:51], v[112:115]
    buffer_load_dwordx4 v[136:139], v97, s[16:19], s7 offen offset:0 sc1
    v_mfma_f32_16x16x32_bf16 v[128:131], v[28:31], v[52:55], v[128:131]
    s_waitcnt vmcnt(10) lgkmcnt(0)
    s_nop 0
    v_mfma_f32_16x16x32_bf16 v[100:103], v[32:35], v[56:59], v[100:103]
    ds_read_b64_tr_b16 v[16:17], v4 offset:0
    ds_read_b64_tr_b16 v[18:19], v4 offset:2048
    v_mfma_f32_16x16x32_bf16 v[116:119], v[32:35], v[60:63], v[116:119]
    ds_read_b64_tr_b16 v[20:21], v5 offset:0
    ds_read_b64_tr_b16 v[22:23], v5 offset:2048
    v_mfma_f32_16x16x32_bf16 v[104:107], v[36:39], v[56:59], v[104:107]
    ds_read_b64_tr_b16 v[24:25], v6 offset:0
    ds_read_b64_tr_b16 v[26:27], v6 offset:2048
    v_mfma_f32_16x16x32_bf16 v[120:123], v[36:39], v[60:63], v[120:123]
    ds_read_b64_tr_b16 v[28:29], v7 offset:0
    ds_read_b64_tr_b16 v[30:31], v7 offset:2048
    v_mfma_f32_16x16x32_bf16 v[108:111], v[40:43], v[56:59], v[108:111]
    buffer_load_dwordx4 v[48:51], v98, s[16:19], s7 offen offset:1024 sc1
    v_mfma_f32_16x16x32_bf16 v[124:127], v[40:43], v[60:63], v[124:127]
    v_mfma_f32_16x16x32_bf16 v[112:115], v[44:47], v[56:59], v[112:115]
    buffer_load_dwordx4 v[52:55], v97, s[16:19], s7 offen offset:1024 sc1
    v_mfma_f32_16x16x32_bf16 v[128:131], v[44:47], v[60:63], v[128:131]
    s_waitcnt vmcnt(10) lgkmcnt(0)
    s_nop 0
    v_mfma_f32_16x16x32_bf16 v[100:103], v[16:19], v[64:67], v[100:103]
    ds_read_b64_tr_b16 v[32:33], v4 offset:4096
    ds_read_b64_tr_b16 v[34:35], v4 offset:6144
    v_mfma_f32_16x16x32_bf16 v[116:119], v[16:19], v[68:71], v[116:119]
    ds_read_b64_tr_b16 v[36:37], v5 offset:4096
    ds_read_b64_tr_b16 v[38:39], v5 offset:6144
    v_mfma_f32_16x16x32_bf16 v[104:107], v[20:23], v[64:67], v[104:107]
    ds_read_b64_tr_b16 v[40:41], v6 offset:4096
    ds_read_b64_tr_b16 v[42:43], v6 offset:6144
    v_mfma_f32_16x16x32_bf16 v[120:123], v[20:23], v[68:71], v[120:123]
    ds_read_b64_tr_b16 v[44:45], v7 offset:4096
    ds_read_b64_tr_b16 v[46:47], v7 offset:6144
    v_mfma_f32_16x16x32_bf16 v[108:111], v[24:27], v[64:67], v[108:111]
    buffer_load_dwordx4 v[56:59], v98, s[16:19], s8 offen offset:0 sc1
    v_mfma_f32_16x16x32_bf16 v[124:127], v[24:27], v[68:71], v[124:127]
    v_mfma_f32_16x16x32_bf16 v[112:115], v[28:31], v[64:67], v[112:115]
    buffer_load_dwordx4 v[60:63], v97, s[16:19], s8 offen offset:0 sc1
    v_mfma_f32_16x16x32_bf16 v[128:131], v[28:31], v[68:71], v[128:131]
    s_waitcnt vmcnt(10) lgkmcnt(0)
    s_nop 0
    v_mfma_f32_16x16x32_bf16 v[100:103], v[32:35], v[72:75], v[100:103]
    ds_read_b64_tr_b16 v[16:17], v4 offset:8192
    ds_read_b64_tr_b16 v[18:19], v4 offset:10240
    v_mfma_f32_16x16x32_bf16 v[116:119], v[32:35], v[76:79], v[116:119]
    ds_read_b64_tr_b16 v[20:21], v5 offset:8192
    ds_read_b64_tr_b16 v[22:23], v5 offset:10240
    v_mfma_f32_16x16x32_bf16 v[104:107], v[36:39], v[72:75], v[104:107]
    ds_read_b64_tr_b16 v[24:25], v6 offset:8192
    ds_read_b64_tr_b16 v[26:27], v6 offset:10240
    v_mfma_f32_16x16x32_bf16 v[120:123], v[36:39], v[76:79], v[120:123]
    ds_read_b64_tr_b16 v[28:29], v7 offset:8192
    ds_read_b64_tr_b16 v[30:31], v7 offset:10240
    v_mfma_f32_16x16x32_bf16 v[108:111], v[40:43], v[72:75], v[108:111]
    buffer_load_dwordx4 v[64:67], v98, s[16:19], s8 offen offset:1024 sc1
    v_mfma_f32_16x16x32_bf16 v[124:127], v[40:43], v[76:79], v[124:127]
    v_mfma_f32_16x16x32_bf16 v[112:115], v[44:47], v[72:75], v[112:115]
    buffer_load_dwordx4 v[68:71], v97, s[16:19], s8 offen offset:1024 sc1
    v_mfma_f32_16x16x32_bf16 v[128:131], v[44:47], v[76:79], v[128:131]
    s_waitcnt vmcnt(10) lgkmcnt(0)
    s_nop 0
    v_mfma_f32_16x16x32_bf16 v[100:103], v[16:19], v[80:83], v[100:103]
    ds_read_b64_tr_b16 v[32:33], v4 offset:12288
    ds_read_b64_tr_b16 v[34:35], v4 offset:14336
    v_mfma_f32_16x16x32_bf16 v[116:119], v[16:19], v[84:87], v[116:119]
    ds_read_b64_tr_b16 v[36:37], v5 offset:12288
    ds_read_b64_tr_b16 v[38:39], v5 offset:14336
    v_mfma_f32_16x16x32_bf16 v[104:107], v[20:23], v[80:83], v[104:107]
    ds_read_b64_tr_b16 v[40:41], v6 offset:12288
    ds_read_b64_tr_b16 v[42:43], v6 offset:14336
    v_mfma_f32_16x16x32_bf16 v[120:123], v[20:23], v[84:87], v[120:123]
    ds_read_b64_tr_b16 v[44:45], v7 offset:12288
    ds_read_b64_tr_b16 v[46:47], v7 offset:14336
    v_mfma_f32_16x16x32_bf16 v[108:111], v[24:27], v[80:83], v[108:111]
    buffer_load_dwordx4 v[72:75], v98, s[16:19], s9 offen offset:0 sc1
    v_mfma_f32_16x16x32_bf16 v[124:127], v[24:27], v[84:87], v[124:127]
    v_mfma_f32_16x16x32_bf16 v[112:115], v[28:31], v[80:83], v[112:115]
    buffer_load_dwordx4 v[76:79], v97, s[16:19], s9 offen offset:0 sc1
    v_mfma_f32_16x16x32_bf16 v[128:131], v[28:31], v[84:87], v[128:131]
    s_waitcnt vmcnt(10) lgkmcnt(0)
    s_nop 0
    v_mfma_f32_16x16x32_bf16 v[100:103], v[32:35], v[88:91], v[100:103]
    ds_read_b64_tr_b16 v[16:17], v12 offset:24576
    ds_read_b64_tr_b16 v[18:19], v12 offset:26624
    v_mfma_f32_16x16x32_bf16 v[116:119], v[32:35], v[92:95], v[116:119]
    ds_read_b64_tr_b16 v[20:21], v13 offset:24576
    ds_read_b64_tr_b16 v[22:23], v13 offset:26624
    v_mfma_f32_16x16x32_bf16 v[104:107], v[36:39], v[88:91], v[104:107]
    ds_read_b64_tr_b16 v[24:25], v14 offset:24576
    ds_read_b64_tr_b16 v[26:27], v14 offset:26624
    v_mfma_f32_16x16x32_bf16 v[120:123], v[36:39], v[92:95], v[120:123]
    ds_read_b64_tr_b16 v[28:29], v15 offset:24576
    ds_read_b64_tr_b16 v[30:31], v15 offset:26624
    v_mfma_f32_16x16x32_bf16 v[108:111], v[40:43], v[88:91], v[108:111]
    buffer_load_dwordx4 v[80:83], v98, s[16:19], s9 offen offset:1024 sc1
    v_mfma_f32_16x16x32_bf16 v[124:127], v[40:43], v[92:95], v[124:127]
    v_mfma_f32_16x16x32_bf16 v[112:115], v[44:47], v[88:91], v[112:115]
    buffer_load_dwordx4 v[84:87], v97, s[16:19], s9 offen offset:1024 sc1
    v_mfma_f32_16x16x32_bf16 v[128:131], v[44:47], v[92:95], v[128:131]
    s_waitcnt vmcnt(10) lgkmcnt(0)
    s_nop 0
    v_mfma_f32_16x16x32_bf16 v[100:103], v[16:19], v[132:135], v[100:103]
    ds_read_b64_tr_b16 v[32:33], v12 offset:28672
    ds_read_b64_tr_b16 v[34:35], v12 offset:30720
    v_mfma_f32_16x16x32_bf16 v[116:119], v[16:19], v[136:139], v[116:119]
    ds_read_b64_tr_b16 v[36:37], v13 offset:28672
    ds_read_b64_tr_b16 v[38:39], v13 offset:30720
    v_mfma_f32_16x16x32_bf16 v[104:107], v[20:23], v[132:135], v[104:107]
    ds_read_b64_tr_b16 v[40:41], v14 offset:28672
    ds_read_b64_tr_b16 v[42:43], v14 offset:30720
    v_mfma_f32_16x16x32_bf16 v[120:123], v[20:23], v[136:139], v[120:123]
    ds_read_b64_tr_b16 v[44:45], v15 offset:28672
    ds_read_b64_tr_b16 v[46:47], v15 offset:30720
    v_mfma_f32_16x16x32_bf16 v[108:111], v[24:27], v[132:135], v[108:111]
    buffer_load_dwordx4 v[88:91], v98, s[16:19], s10 offen offset:0 sc1
    v_mfma_f32_16x16x32_bf16 v[124:127], v[24:27], v[136:139], v[124:127]
    v_mfma_f32_16x16x32_bf16 v[112:115], v[28:31], v[132:135], v[112:115]
    buffer_load_dwordx4 v[92:95], v97, s[16:19], s10 offen offset:0 sc1
    v_mfma_f32_16x16x32_bf16 v[128:131], v[28:31], v[136:139], v[128:131]
    s_waitcnt vmcnt(10) lgkmcnt(0)
    s_nop 0
    v_mfma_f32_16x16x32_bf16 v[100:103], v[32:35], v[48:51], v[100:103]
    ds_read_b64_tr_b16 v[16:17], v4 offset:16384
    ds_read_b64_tr_b16 v[18:19], v4 offset:18432
    v_mfma_f32_16x16x32_bf16 v[116:119], v[32:35], v[52:55], v[116:119]
    ds_read_b64_tr_b16 v[20:21], v5 offset:16384
    ds_read_b64_tr_b16 v[22:23], v5 offset:18432
    v_mfma_f32_16x16x32_bf16 v[104:107], v[36:39], v[48:51], v[104:107]
    ds_read_b64_tr_b16 v[24:25], v6 offset:16384
    ds_read_b64_tr_b16 v[26:27], v6 offset:18432
    v_mfma_f32_16x16x32_bf16 v[120:123], v[36:39], v[52:55], v[120:123]
    ds_read_b64_tr_b16 v[28:29], v7 offset:16384
    ds_read_b64_tr_b16 v[30:31], v7 offset:18432
    v_mfma_f32_16x16x32_bf16 v[108:111], v[40:43], v[48:51], v[108:111]
    buffer_load_dwordx4 v[132:135], v98, s[16:19], s10 offen offset:1024 sc1
    v_mfma_f32_16x16x32_bf16 v[124:127], v[40:43], v[52:55], v[124:127]
    v_mfma_f32_16x16x32_bf16 v[112:115], v[44:47], v[48:51], v[112:115]
    buffer_load_dwordx4 v[136:139], v97, s[16:19], s10 offen offset:1024 sc1
    v_mfma_f32_16x16x32_bf16 v[128:131], v[44:47], v[52:55], v[128:131]
    s_waitcnt vmcnt(10) lgkmcnt(0)
    s_nop 0
    v_mfma_f32_16x16x32_bf16 v[100:103], v[16:19], v[56:59], v[100:103]
    ds_read_b64_tr_b16 v[32:33], v4 offset:20480
    ds_read_b64_tr_b16 v[34:35], v4 offset:22528
    v_mfma_f32_16x16x32_bf16 v[116:119], v[16:19], v[60:63], v[116:119]
    ds_read_b64_tr_b16 v[36:37], v5 offset:20480
    ds_read_b64_tr_b16 v[38:39], v5 offset:22528
    v_mfma_f32_16x16x32_bf16 v[104:107], v[20:23], v[56:59], v[104:107]
    ds_read_b64_tr_b16 v[40:41], v6 offset:20480
    ds_read_b64_tr_b16 v[42:43], v6 offset:22528
    v_mfma_f32_16x16x32_bf16 v[120:123], v[20:23], v[60:63], v[120:123]
    ds_read_b64_tr_b16 v[44:45], v7 offset:20480
    ds_read_b64_tr_b16 v[46:47], v7 offset:22528
    v_mfma_f32_16x16x32_bf16 v[108:111], v[24:27], v[56:59], v[108:111]
    buffer_load_dwordx4 v[48:51], v98, s[16:19], s11 offen offset:0 sc1
    v_mfma_f32_16x16x32_bf16 v[124:127], v[24:27], v[60:63], v[124:127]
    v_mfma_f32_16x16x32_bf16 v[112:115], v[28:31], v[56:59], v[112:115]
    buffer_load_dwordx4 v[52:55], v97, s[16:19], s11 offen offset:0 sc1
    v_mfma_f32_16x16x32_bf16 v[128:131], v[28:31], v[60:63], v[128:131]
    s_waitcnt vmcnt(10) lgkmcnt(0)
    s_nop 0
    v_mfma_f32_16x16x32_bf16 v[100:103], v[32:35], v[64:67], v[100:103]
    ds_read_b64_tr_b16 v[16:17], v4 offset:24576
    ds_read_b64_tr_b16 v[18:19], v4 offset:26624
    v_mfma_f32_16x16x32_bf16 v[116:119], v[32:35], v[68:71], v[116:119]
    ds_read_b64_tr_b16 v[20:21], v5 offset:24576
    ds_read_b64_tr_b16 v[22:23], v5 offset:26624
    v_mfma_f32_16x16x32_bf16 v[104:107], v[36:39], v[64:67], v[104:107]
    ds_read_b64_tr_b16 v[24:25], v6 offset:24576
    ds_read_b64_tr_b16 v[26:27], v6 offset:26624
    v_mfma_f32_16x16x32_bf16 v[120:123], v[36:39], v[68:71], v[120:123]
    ds_read_b64_tr_b16 v[28:29], v7 offset:24576
    ds_read_b64_tr_b16 v[30:31], v7 offset:26624
    v_mfma_f32_16x16x32_bf16 v[108:111], v[40:43], v[64:67], v[108:111]
    buffer_load_dwordx4 v[56:59], v98, s[16:19], s11 offen offset:1024 sc1
    v_mfma_f32_16x16x32_bf16 v[124:127], v[40:43], v[68:71], v[124:127]
    v_mfma_f32_16x16x32_bf16 v[112:115], v[44:47], v[64:67], v[112:115]
    buffer_load_dwordx4 v[60:63], v97, s[16:19], s11 offen offset:1024 sc1
    v_mfma_f32_16x16x32_bf16 v[128:131], v[44:47], v[68:71], v[128:131]
    s_waitcnt vmcnt(10) lgkmcnt(0)
    s_nop 0
    v_mfma_f32_16x16x32_bf16 v[100:103], v[16:19], v[72:75], v[100:103]
    ds_read_b64_tr_b16 v[32:33], v4 offset:28672
    ds_read_b64_tr_b16 v[34:35], v4 offset:30720
    v_mfma_f32_16x16x32_bf16 v[116:119], v[16:19], v[76:79], v[116:119]
    ds_read_b64_tr_b16 v[36:37], v5 offset:28672
    ds_read_b64_tr_b16 v[38:39], v5 offset:30720
    v_mfma_f32_16x16x32_bf16 v[104:107], v[20:23], v[72:75], v[104:107]
    ds_read_b64_tr_b16 v[40:41], v6 offset:28672
    ds_read_b64_tr_b16 v[42:43], v6 offset:30720
    v_mfma_f32_16x16x32_bf16 v[120:123], v[20:23], v[76:79], v[120:123]
    ds_read_b64_tr_b16 v[44:45], v7 offset:28672
    ds_read_b64_tr_b16 v[46:47], v7 offset:30720
    v_mfma_f32_16x16x32_bf16 v[108:111], v[24:27], v[72:75], v[108:111]
    buffer_load_dwordx4 v[64:67], v98, s[16:19], s30 offen offset:0 sc1
    v_mfma_f32_16x16x32_bf16 v[124:127], v[24:27], v[76:79], v[124:127]
    v_mfma_f32_16x16x32_bf16 v[112:115], v[28:31], v[72:75], v[112:115]
    buffer_load_dwordx4 v[68:71], v97, s[16:19], s30 offen offset:0 sc1
    v_mfma_f32_16x16x32_bf16 v[128:131], v[28:31], v[76:79], v[128:131]
    s_waitcnt vmcnt(10) lgkmcnt(0)
    s_nop 0
    v_mfma_f32_16x16x32_bf16 v[100:103], v[32:35], v[80:83], v[100:103]
    ds_read_b64_tr_b16 v[16:17], v12 offset:16384
    ds_read_b64_tr_b16 v[18:19], v12 offset:18432
    v_mfma_f32_16x16x32_bf16 v[116:119], v[32:35], v[84:87], v[116:119]
    ds_read_b64_tr_b16 v[20:21], v13 offset:16384
    ds_read_b64_tr_b16 v[22:23], v13 offset:18432
    v_mfma_f32_16x16x32_bf16 v[104:107], v[36:39], v[80:83], v[104:107]
    ds_read_b64_tr_b16 v[24:25], v14 offset:16384
    ds_read_b64_tr_b16 v[26:27], v14 offset:18432
    v_mfma_f32_16x16x32_bf16 v[120:123], v[36:39], v[84:87], v[120:123]
    ds_read_b64_tr_b16 v[28:29], v15 offset:16384
    ds_read_b64_tr_b16 v[30:31], v15 offset:18432
    v_mfma_f32_16x16x32_bf16 v[108:111], v[40:43], v[80:83], v[108:111]
    buffer_load_dwordx4 v[72:75], v98, s[16:19], s30 offen offset:1024 sc1
    v_mfma_f32_16x16x32_bf16 v[124:127], v[40:43], v[84:87], v[124:127]
    v_mfma_f32_16x16x32_bf16 v[112:115], v[44:47], v[80:83], v[112:115]
    buffer_load_dwordx4 v[76:79], v97, s[16:19], s30 offen offset:1024 sc1
    v_mfma_f32_16x16x32_bf16 v[128:131], v[44:47], v[84:87], v[128:131]
    s_waitcnt vmcnt(10) lgkmcnt(0)
    s_nop 0
    v_mfma_f32_16x16x32_bf16 v[100:103], v[16:19], v[88:91], v[100:103]
    ds_read_b64_tr_b16 v[32:33], v12 offset:20480
    ds_read_b64_tr_b16 v[34:35], v12 offset:22528
    v_mfma_f32_16x16x32_bf16 v[116:119], v[16:19], v[92:95], v[116:119]
    ds_read_b64_tr_b16 v[36:37], v13 offset:20480
    ds_read_b64_tr_b16 v[38:39], v13 offset:22528
    v_mfma_f32_16x16x32_bf16 v[104:107], v[20:23], v[88:91], v[104:107]
    ds_read_b64_tr_b16 v[40:41], v14 offset:20480
    ds_read_b64_tr_b16 v[42:43], v14 offset:22528
    v_mfma_f32_16x16x32_bf16 v[120:123], v[20:23], v[92:95], v[120:123]
    ds_read_b64_tr_b16 v[44:45], v15 offset:20480
    ds_read_b64_tr_b16 v[46:47], v15 offset:22528
    v_mfma_f32_16x16x32_bf16 v[108:111], v[24:27], v[88:91], v[108:111]
    buffer_load_dwordx4 v[80:83], v98, s[16:19], s31 offen offset:0 sc1
    v_mfma_f32_16x16x32_bf16 v[124:127], v[24:27], v[92:95], v[124:127]
    v_mfma_f32_16x16x32_bf16 v[112:115], v[28:31], v[88:91], v[112:115]
    buffer_load_dwordx4 v[84:87], v97, s[16:19], s31 offen offset:0 sc1
    v_mfma_f32_16x16x32_bf16 v[128:131], v[28:31], v[92:95], v[128:131]
    s_waitcnt vmcnt(10) lgkmcnt(0)
    s_nop 0
    v_mfma_f32_16x16x32_bf16 v[100:103], v[32:35], v[132:135], v[100:103]
    ds_read_b64_tr_b16 v[16:17], v4 offset:40960
    ds_read_b64_tr_b16 v[18:19], v4 offset:43008
    v_mfma_f32_16x16x32_bf16 v[116:119], v[32:35], v[136:139], v[116:119]
    ds_read_b64_tr_b16 v[20:21], v5 offset:40960
    ds_read_b64_tr_b16 v[22:23], v5 offset:43008
    v_mfma_f32_16x16x32_bf16 v[104:107], v[36:39], v[132:135], v[104:107]
    ds_read_b64_tr_b16 v[24:25], v6 offset:40960
    ds_read_b64_tr_b16 v[26:27], v6 offset:43008
    v_mfma_f32_16x16x32_bf16 v[120:123], v[36:39], v[136:139], v[120:123]
    ds_read_b64_tr_b16 v[28:29], v7 offset:40960
    ds_read_b64_tr_b16 v[30:31], v7 offset:43008
    v_mfma_f32_16x16x32_bf16 v[108:111], v[40:43], v[132:135], v[108:111]
    buffer_load_dwordx4 v[88:91], v98, s[16:19], s31 offen offset:1024 sc1
    v_mfma_f32_16x16x32_bf16 v[124:127], v[40:43], v[136:139], v[124:127]
    v_mfma_f32_16x16x32_bf16 v[112:115], v[44:47], v[132:135], v[112:115]
    buffer_load_dwordx4 v[92:95], v97, s[16:19], s31 offen offset:1024 sc1
    v_mfma_f32_16x16x32_bf16 v[128:131], v[44:47], v[136:139], v[128:131]
    s_waitcnt vmcnt(10) lgkmcnt(0)
    s_nop 0
    v_mfma_f32_16x16x32_bf16 v[100:103], v[16:19], v[48:51], v[100:103]
    ds_read_b64_tr_b16 v[32:33], v4 offset:45056
    ds_read_b64_tr_b16 v[34:35], v4 offset:47104
    v_mfma_f32_16x16x32_bf16 v[116:119], v[16:19], v[52:55], v[116:119]
    ds_read_b64_tr_b16 v[36:37], v5 offset:45056
    ds_read_b64_tr_b16 v[38:39], v5 offset:47104
    v_mfma_f32_16x16x32_bf16 v[104:107], v[20:23], v[48:51], v[104:107]
    ds_read_b64_tr_b16 v[40:41], v6 offset:45056
    ds_read_b64_tr_b16 v[42:43], v6 offset:47104
    v_mfma_f32_16x16x32_bf16 v[120:123], v[20:23], v[52:55], v[120:123]
    ds_read_b64_tr_b16 v[44:45], v7 offset:45056
    ds_read_b64_tr_b16 v[46:47], v7 offset:47104
    v_mfma_f32_16x16x32_bf16 v[108:111], v[24:27], v[48:51], v[108:111]
    buffer_load_dwordx4 v[132:135], v98, s[16:19], s32 offen offset:0 sc1
    v_mfma_f32_16x16x32_bf16 v[124:127], v[24:27], v[52:55], v[124:127]
    v_mfma_f32_16x16x32_bf16 v[112:115], v[28:31], v[48:51], v[112:115]
    buffer_load_dwordx4 v[136:139], v97, s[16:19], s32 offen offset:0 sc1
    v_mfma_f32_16x16x32_bf16 v[128:131], v[28:31], v[52:55], v[128:131]
    s_waitcnt vmcnt(10) lgkmcnt(0)
    s_nop 0
    v_mfma_f32_16x16x32_bf16 v[100:103], v[32:35], v[56:59], v[100:103]
    ds_read_b64_tr_b16 v[16:17], v4 offset:49152
    ds_read_b64_tr_b16 v[18:19], v4 offset:51200
    v_mfma_f32_16x16x32_bf16 v[116:119], v[32:35], v[60:63], v[116:119]
    ds_read_b64_tr_b16 v[20:21], v5 offset:49152
    ds_read_b64_tr_b16 v[22:23], v5 offset:51200
    v_mfma_f32_16x16x32_bf16 v[104:107], v[36:39], v[56:59], v[104:107]
    ds_read_b64_tr_b16 v[24:25], v6 offset:49152
    ds_read_b64_tr_b16 v[26:27], v6 offset:51200
    v_mfma_f32_16x16x32_bf16 v[120:123], v[36:39], v[60:63], v[120:123]
    ds_read_b64_tr_b16 v[28:29], v7 offset:49152
    ds_read_b64_tr_b16 v[30:31], v7 offset:51200
    v_mfma_f32_16x16x32_bf16 v[108:111], v[40:43], v[56:59], v[108:111]
    buffer_load_dwordx4 v[48:51], v98, s[16:19], s32 offen offset:1024 sc1
    v_mfma_f32_16x16x32_bf16 v[124:127], v[40:43], v[60:63], v[124:127]
    v_mfma_f32_16x16x32_bf16 v[112:115], v[44:47], v[56:59], v[112:115]
    s_branch IW_s7
IW_w7:
    s_branch IW_r7
IW_s7:
    buffer_load_dwordx4 v[52:55], v97, s[16:19], s32 offen offset:1024 sc1
    v_mfma_f32_16x16x32_bf16 v[128:131], v[44:47], v[60:63], v[128:131]
    s_waitcnt vmcnt(10) lgkmcnt(0)
    s_nop 0
    v_mfma_f32_16x16x32_bf16 v[100:103], v[16:19], v[64:67], v[100:103]
    ds_read_b64_tr_b16 v[32:33], v4 offset:53248
    ds_read_b64_tr_b16 v[34:35], v4 offset:55296
    v_mfma_f32_16x16x32_bf16 v[116:119], v[16:19], v[68:71], v[116:119]
    ds_read_b64_tr_b16 v[36:37], v5 offset:53248
    ds_read_b64_tr_b16 v[38:39], v5 offset:55296
    v_mfma_f32_16x16x32_bf16 v[104:107], v[20:23], v[64:67], v[104:107]
    ds_read_b64_tr_b16 v[40:41], v6 offset:53248
    ds_read_b64_tr_b16 v[42:43], v6 offset:55296
    v_mfma_f32_16x16x32_bf16 v[120:123], v[20:23], v[68:71], v[120:123]
    ds_read_b64_tr_b16 v[44:45], v7 offset:53248
    ds_read_b64_tr_b16 v[46:47], v7 offset:55296
    v_mfma_f32_16x16x32_bf16 v[108:111], v[24:27], v[64:67], v[108:111]
    buffer_load_dwordx4 v[56:59], v98, s[16:19], s33 offen offset:0 sc1
    v_mfma_f32_16x16x32_bf16 v[124:127], v[24:27], v[68:71], v[124:127]
    v_mfma_f32_16x16x32_bf16 v[112:115], v[28:31], v[64:67], v[112:115]
    buffer_load_dwordx4 v[60:63], v97, s[16:19], s33 offen offset:0 sc1
    v_mfma_f32_16x16x32_bf16 v[128:131], v[28:31], v[68:71], v[128:131]
    s_waitcnt vmcnt(10) lgkmcnt(0)
    s_nop 0
    v_mfma_f32_16x16x32_bf16 v[100:103], v[32:35], v[72:75], v[100:103]
    ds_read_b64_tr_b16 v[16:17], v8 offset:0
    ds_read_b64_tr_b16 v[18:19], v8 offset:2048
    v_mfma_f32_16x16x32_bf16 v[116:119], v[32:35], v[76:79], v[116:119]
    ds_read_b64_tr_b16 v[20:21], v9 offset:0
    ds_read_b64_tr_b16 v[22:23], v9 offset:2048
    v_mfma_f32_16x16x32_bf16 v[104:107], v[36:39], v[72:75], v[104:107]
    ds_read_b64_tr_b16 v[24:25], v10 offset:0
    ds_read_b64_tr_b16 v[26:27], v10 offset:2048
    v_mfma_f32_16x16x32_bf16 v[120:123], v[36:39], v[76:79], v[120:123]
    ds_read_b64_tr_b16 v[28:29], v11 offset:0
    ds_read_b64_tr_b16 v[30:31], v11 offset:2048
    v_mfma_f32_16x16x32_bf16 v[108:111], v[40:43], v[72:75], v[108:111]
    buffer_load_dwordx4 v[64:67], v98, s[16:19], s33 offen offset:1024 sc1
    v_mfma_f32_16x16x32_bf16 v[124:127], v[40:43], v[76:79], v[124:127]
    v_mfma_f32_16x16x32_bf16 v[112:115], v[44:47], v[72:75], v[112:115]
    buffer_load_dwordx4 v[68:71], v97, s[16:19], s33 offen offset:1024 sc1
    v_mfma_f32_16x16x32_bf16 v[128:131], v[44:47], v[76:79], v[128:131]
    s_waitcnt vmcnt(10) lgkmcnt(0)
    s_nop 0
    v_mfma_f32_16x16x32_bf16 v[100:103], v[16:19], v[80:83], v[100:103]
    ds_read_b64_tr_b16 v[32:33], v8 offset:4096
    ds_read_b64_tr_b16 v[34:35], v8 offset:6144
    v_mfma_f32_16x16x32_bf16 v[116:119], v[16:19], v[84:87], v[116:119]
    ds_read_b64_tr_b16 v[36:37], v9 offset:4096
    ds_read_b64_tr_b16 v[38:39], v9 offset:6144
    v_mfma_f32_16x16x32_bf16 v[104:107], v[20:23], v[80:83], v[104:107]
    ds_read_b64_tr_b16 v[40:41], v10 offset:4096
    ds_read_b64_tr_b16 v[42:43], v10 offset:6144
    v_mfma_f32_16x16x32_bf16 v[120:123], v[20:23], v[84:87], v[120:123]
    ds_read_b64_tr_b16 v[44:45], v11 offset:4096
    ds_read_b64_tr_b16 v[46:47], v11 offset:6144
    v_mfma_f32_16x16x32_bf16 v[108:111], v[24:27], v[80:83], v[108:111]
    buffer_load_dwordx4 v[72:75], v98, s[16:19], s34 offen offset:0 sc1
    v_mfma_f32_16x16x32_bf16 v[124:127], v[24:27], v[84:87], v[124:127]
    v_mfma_f32_16x16x32_bf16 v[112:115], v[28:31], v[80:83], v[112:115]
    buffer_load_dwordx4 v[76:79], v97, s[16:19], s34 offen offset:0 sc1
    v_mfma_f32_16x16x32_bf16 v[128:131], v[28:31], v[84:87], v[128:131]
    s_waitcnt vmcnt(10) lgkmcnt(0)
    s_nop 0
    v_mfma_f32_16x16x32_bf16 v[100:103], v[32:35], v[88:91], v[100:103]
    ds_read_b64_tr_b16 v[16:17], v8 offset:16384
    ds_read_b64_tr_b16 v[18:19], v8 offset:18432
    v_mfma_f32_16x16x32_bf16 v[116:119], v[32:35], v[92:95], v[116:119]
    ds_read_b64_tr_b16 v[20:21], v9 offset:16384
    ds_read_b64_tr_b16 v[22:23], v9 offset:18432
    v_mfma_f32_16x16x32_bf16 v[104:107], v[36:39], v[88:91], v[104:107]
    ds_read_b64_tr_b16 v[24:25], v10 offset:16384
    ds_read_b64_tr_b16 v[26:27], v10 offset:18432
    v_mfma_f32_16x16x32_bf16 v[120:123], v[36:39], v[92:95], v[120:123]
    ds_read_b64_tr_b16 v[28:29], v11 offset:16384
    ds_read_b64_tr_b16 v[30:31], v11 offset:18432
    v_mfma_f32_16x16x32_bf16 v[108:111], v[40:43], v[88:91], v[108:111]
    buffer_load_dwordx4 v[80:83], v98, s[16:19], s34 offen offset:1024 sc1
    v_mfma_f32_16x16x32_bf16 v[124:127], v[40:43], v[92:95], v[124:127]
    v_mfma_f32_16x16x32_bf16 v[112:115], v[44:47], v[88:91], v[112:115]
    buffer_load_dwordx4 v[84:87], v97, s[16:19], s34 offen offset:1024 sc1
    v_mfma_f32_16x16x32_bf16 v[128:131], v[44:47], v[92:95], v[128:131]
    s_waitcnt vmcnt(10) lgkmcnt(0)
    s_nop 0
    v_mfma_f32_16x16x32_bf16 v[100:103], v[16:19], v[132:135], v[100:103]
    ds_read_b64_tr_b16 v[32:33], v8 offset:20480
    ds_read_b64_tr_b16 v[34:35], v8 offset:22528
    v_mfma_f32_16x16x32_bf16 v[116:119], v[16:19], v[136:139], v[116:119]
    ds_read_b64_tr_b16 v[36:37], v9 offset:20480
    ds_read_b64_tr_b16 v[38:39], v9 offset:22528
    v_mfma_f32_16x16x32_bf16 v[104:107], v[20:23], v[132:135], v[104:107]
    ds_read_b64_tr_b16 v[40:41], v10 offset:20480
    ds_read_b64_tr_b16 v[42:43], v10 offset:22528
    v_mfma_f32_16x16x32_bf16 v[120:123], v[20:23], v[136:139], v[120:123]
    ds_read_b64_tr_b16 v[44:45], v11 offset:20480
    ds_read_b64_tr_b16 v[46:47], v11 offset:22528
    v_mfma_f32_16x16x32_bf16 v[108:111], v[24:27], v[132:135], v[108:111]
    buffer_load_dwordx4 v[88:91], v98, s[16:19], s35 offen offset:0 sc1
    v_mfma_f32_16x16x32_bf16 v[124:127], v[24:27], v[136:139], v[124:127]
    v_mfma_f32_16x16x32_bf16 v[112:115], v[28:31], v[132:135], v[112:115]
    buffer_load_dwordx4 v[92:95], v97, s[16:19], s35 offen offset:0 sc1
    v_mfma_f32_16x16x32_bf16 v[128:131], v[28:31], v[136:139], v[128:131]
    s_waitcnt vmcnt(10) lgkmcnt(0)
    s_nop 0
    v_mfma_f32_16x16x32_bf16 v[100:103], v[32:35], v[48:51], v[100:103]
    ds_read_b64_tr_b16 v[16:17], v8 offset:40960
    ds_read_b64_tr_b16 v[18:19], v8 offset:43008
    v_mfma_f32_16x16x32_bf16 v[116:119], v[32:35], v[52:55], v[116:119]
    ds_read_b64_tr_b16 v[20:21], v9 offset:40960
    ds_read_b64_tr_b16 v[22:23], v9 offset:43008
    v_mfma_f32_16x16x32_bf16 v[104:107], v[36:39], v[48:51], v[104:107]
    ds_read_b64_tr_b16 v[24:25], v10 offset:40960
    ds_read_b64_tr_b16 v[26:27], v10 offset:43008
    v_mfma_f32_16x16x32_bf16 v[120:123], v[36:39], v[52:55], v[120:123]
    ds_read_b64_tr_b16 v[28:29], v11 offset:40960
    ds_read_b64_tr_b16 v[30:31], v11 offset:43008
    v_mfma_f32_16x16x32_bf16 v[108:111], v[40:43], v[48:51], v[108:111]
    buffer_load_dwordx4 v[132:135], v98, s[16:19], s35 offen offset:1024 sc1
    v_mfma_f32_16x16x32_bf16 v[124:127], v[40:43], v[52:55], v[124:127]
    v_mfma_f32_16x16x32_bf16 v[112:115], v[44:47], v[48:51], v[112:115]
    buffer_load_dwordx4 v[136:139], v97, s[16:19], s35 offen offset:1024 sc1
    v_mfma_f32_16x16x32_bf16 v[128:131], v[44:47], v[52:55], v[128:131]
    s_waitcnt vmcnt(10) lgkmcnt(0)
    s_nop 0
    v_mfma_f32_16x16x32_bf16 v[100:103], v[16:19], v[56:59], v[100:103]
    ds_read_b64_tr_b16 v[32:33], v8 offset:45056
    ds_read_b64_tr_b16 v[34:35], v8 offset:47104
    v_mfma_f32_16x16x32_bf16 v[116:119], v[16:19], v[60:63], v[116:119]
    ds_read_b64_tr_b16 v[36:37], v9 offset:45056
    ds_read_b64_tr_b16 v[38:39], v9 offset:47104
    v_mfma_f32_16x16x32_bf16 v[104:107], v[20:23], v[56:59], v[104:107]
    ds_read_b64_tr_b16 v[40:41], v10 offset:45056
    ds_read_b64_tr_b16 v[42:43], v10 offset:47104
    v_mfma_f32_16x16x32_bf16 v[120:123], v[20:23], v[60:63], v[120:123]
    ds_read_b64_tr_b16 v[44:45], v11 offset:45056
    ds_read_b64_tr_b16 v[46:47], v11 offset:47104
    v_mfma_f32_16x16x32_bf16 v[108:111], v[24:27], v[56:59], v[108:111]
    buffer_load_dwordx4 v[48:51], v98, s[16:19], s36 offen offset:0 sc1
    v_mfma_f32_16x16x32_bf16 v[124:127], v[24:27], v[60:63], v[124:127]
    v_mfma_f32_16x16x32_bf16 v[112:115], v[28:31], v[56:59], v[112:115]
    buffer_load_dwordx4 v[52:55], v97, s[16:19], s36 offen offset:0 sc1
    v_mfma_f32_16x16x32_bf16 v[128:131], v[28:31], v[60:63], v[128:131]
    s_waitcnt vmcnt(10) lgkmcnt(0)
    s_nop 0
    v_mfma_f32_16x16x32_bf16 v[100:103], v[32:35], v[64:67], v[100:103]
    ds_read_b64_tr_b16 v[16:17], v8 offset:32768
    ds_read_b64_tr_b16 v[18:19], v8 offset:34816
    v_mfma_f32_16x16x32_bf16 v[116:119], v[32:35], v[68:71], v[116:119]
    ds_read_b64_tr_b16 v[20:21], v9 offset:32768
    ds_read_b64_tr_b16 v[22:23], v9 offset:34816
    v_mfma_f32_16x16x32_bf16 v[104:107], v[36:39], v[64:67], v[104:107]
    ds_read_b64_tr_b16 v[24:25], v10 offset:32768
    ds_read_b64_tr_b16 v[26:27], v10 offset:34816
    v_mfma_f32_16x16x32_bf16 v[120:123], v[36:39], v[68:71], v[120:123]
    ds_read_b64_tr_b16 v[28:29], v11 offset:32768
    ds_read_b64_tr_b16 v[30:31], v11 offset:34816
    v_mfma_f32_16x16x32_bf16 v[108:111], v[40:43], v[64:67], v[108:111]
    buffer_load_dwordx4 v[56:59], v98, s[16:19], s36 offen offset:1024 sc1
    v_mfma_f32_16x16x32_bf16 v[124:127], v[40:43], v[68:71], v[124:127]
    v_mfma_f32_16x16x32_bf16 v[112:115], v[44:47], v[64:67], v[112:115]
    buffer_load_dwordx4 v[60:63], v97, s[16:19], s36 offen offset:1024 sc1
    v_mfma_f32_16x16x32_bf16 v[128:131], v[44:47], v[68:71], v[128:131]
    s_waitcnt vmcnt(10) lgkmcnt(0)
    s_nop 0
    v_mfma_f32_16x16x32_bf16 v[100:103], v[16:19], v[72:75], v[100:103]
    ds_read_b64_tr_b16 v[32:33], v8 offset:36864
    ds_read_b64_tr_b16 v[34:35], v8 offset:38912
    v_mfma_f32_16x16x32_bf16 v[116:119], v[16:19], v[76:79], v[116:119]
    ds_read_b64_tr_b16 v[36:37], v9 offset:36864
    ds_read_b64_tr_b16 v[38:39], v9 offset:38912
    v_mfma_f32_16x16x32_bf16 v[104:107], v[20:23], v[72:75], v[104:107]
    ds_read_b64_tr_b16 v[40:41], v10 offset:36864
    ds_read_b64_tr_b16 v[42:43], v10 offset:38912
    v_mfma_f32_16x16x32_bf16 v[120:123], v[20:23], v[76:79], v[120:123]
    ds_read_b64_tr_b16 v[44:45], v11 offset:36864
    ds_read_b64_tr_b16 v[46:47], v11 offset:38912
    v_mfma_f32_16x16x32_bf16 v[108:111], v[24:27], v[72:75], v[108:111]
    buffer_load_dwordx4 v[64:67], v98, s[16:19], s37 offen offset:0 sc1
    v_mfma_f32_16x16x32_bf16 v[124:127], v[24:27], v[76:79], v[124:127]
    v_mfma_f32_16x16x32_bf16 v[112:115], v[28:31], v[72:75], v[112:115]
    buffer_load_dwordx4 v[68:71], v97, s[16:19], s37 offen offset:0 sc1
    v_mfma_f32_16x16x32_bf16 v[128:131], v[28:31], v[76:79], v[128:131]
    s_waitcnt vmcnt(10) lgkmcnt(0)
    s_nop 0
    v_mfma_f32_16x16x32_bf16 v[100:103], v[32:35], v[80:83], v[100:103]
    ds_read_b64_tr_b16 v[16:17], v8 offset:49152
    ds_read_b64_tr_b16 v[18:19], v8 offset:51200
    v_mfma_f32_16x16x32_bf16 v[116:119], v[32:35], v[84:87], v[116:119]
    ds_read_b64_tr_b16 v[20:21], v9 offset:49152
    ds_read_b64_tr_b16 v[22:23], v9 offset:51200
    v_mfma_f32_16x16x32_bf16 v[104:107], v[36:39], v[80:83], v[104:107]
    ds_read_b64_tr_b16 v[24:25], v10 offset:49152
    ds_read_b64_tr_b16 v[26:27], v10 offset:51200
    v_mfma_f32_16x16x32_bf16 v[120:123], v[36:39], v[84:87], v[120:123]
    ds_read_b64_tr_b16 v[28:29], v11 offset:49152
    ds_read_b64_tr_b16 v[30:31], v11 offset:51200
    v_mfma_f32_16x16x32_bf16 v[108:111], v[40:43], v[80:83], v[108:111]
    buffer_load_dwordx4 v[72:75], v98, s[16:19], s37 offen offset:1024 sc1
    v_mfma_f32_16x16x32_bf16 v[124:127], v[40:43], v[84:87], v[124:127]
    v_mfma_f32_16x16x32_bf16 v[112:115], v[44:47], v[80:83], v[112:115]
    buffer_load_dwordx4 v[76:79], v97, s[16:19], s37 offen offset:1024 sc1
    v_mfma_f32_16x16x32_bf16 v[128:131], v[44:47], v[84:87], v[128:131]
    s_waitcnt vmcnt(10) lgkmcnt(0)
    s_nop 0
    v_mfma_f32_16x16x32_bf16 v[100:103], v[16:19], v[88:91], v[100:103]
    ds_read_b64_tr_b16 v[32:33], v8 offset:53248
    ds_read_b64_tr_b16 v[34:35], v8 offset:55296
    v_mfma_f32_16x16x32_bf16 v[116:119], v[16:19], v[92:95], v[116:119]
    ds_read_b64_tr_b16 v[36:37], v9 offset:53248
    ds_read_b64_tr_b16 v[38:39], v9 offset:55296
    v_mfma_f32_16x16x32_bf16 v[104:107], v[20:23], v[88:91], v[104:107]
    ds_read_b64_tr_b16 v[40:41], v10 offset:53248
    ds_read_b64_tr_b16 v[42:43], v10 offset:55296
    v_mfma_f32_16x16x32_bf16 v[120:123], v[20:23], v[92:95], v[120:123]
    ds_read_b64_tr_b16 v[44:45], v11 offset:53248
    ds_read_b64_tr_b16 v[46:47], v11 offset:55296
    v_mfma_f32_16x16x32_bf16 v[108:111], v[24:27], v[88:91], v[108:111]
    v_mfma_f32_16x16x32_bf16 v[124:127], v[24:27], v[92:95], v[124:127]
    v_mfma_f32_16x16x32_bf16 v[112:115], v[28:31], v[88:91], v[112:115]
    v_mfma_f32_16x16x32_bf16 v[128:131], v[28:31], v[92:95], v[128:131]
    s_waitcnt vmcnt(8) lgkmcnt(0)
    s_nop 0
    v_mfma_f32_16x16x32_bf16 v[100:103], v[32:35], v[132:135], v[100:103]
    ds_read_b64_tr_b16 v[16:17], v8 offset:8192
    ds_read_b64_tr_b16 v[18:19], v8 offset:10240
    v_mfma_f32_16x16x32_bf16 v[116:119], v[32:35], v[136:139], v[116:119]
    ds_read_b64_tr_b16 v[20:21], v9 offset:8192
    ds_read_b64_tr_b16 v[22:23], v9 offset:10240
    v_mfma_f32_16x16x32_bf16 v[104:107], v[36:39], v[132:135], v[104:107]
    ds_read_b64_tr_b16 v[24:25], v10 offset:8192
    ds_read_b64_tr_b16 v[26:27], v10 offset:10240
    v_mfma_f32_16x16x32_bf16 v[120:123], v[36:39], v[136:139], v[120:123]
    ds_read_b64_tr_b16 v[28:29], v11 offset:8192
    ds_read_b64_tr_b16 v[30:31], v11 offset:10240
    v_mfma_f32_16x16x32_bf16 v[108:111], v[40:43], v[132:135], v[108:111]
    v_mfma_f32_16x16x32_bf16 v[124:127], v[40:43], v[136:139], v[124:127]
    v_mfma_f32_16x16x32_bf16 v[112:115], v[44:47], v[132:135], v[112:115]
    v_mfma_f32_16x16x32_bf16 v[128:131], v[44:47], v[136:139], v[128:131]
    s_waitcnt vmcnt(6) lgkmcnt(0)
    s_nop 0
    v_mfma_f32_16x16x32_bf16 v[100:103], v[16:19], v[48:51], v[100:103]
    ds_read_b64_tr_b16 v[32:33], v8 offset:12288
    ds_read_b64_tr_b16 v[34:35], v8 offset:14336
    v_mfma_f32_16x16x32_bf16 v[116:119], v[16:19], v[52:55], v[116:119]
    ds_read_b64_tr_b16 v[36:37], v9 offset:12288
    ds_read_b64_tr_b16 v[38:39], v9 offset:14336
    v_mfma_f32_16x16x32_bf16 v[104:107], v[20:23], v[48:51], v[104:107]
    ds_read_b64_tr_b16 v[40:41], v10 offset:12288
    ds_read_b64_tr_b16 v[42:43], v10 offset:14336
    v_mfma_f32_16x16x32_bf16 v[120:123], v[20:23], v[52:55], v[120:123]
    ds_read_b64_tr_b16 v[44:45], v11 offset:12288
    ds_read_b64_tr_b16 v[46:47], v11 offset:14336
    v_mfma_f32_16x16x32_bf16 v[108:111], v[24:27], v[48:51], v[108:111]
    v_mfma_f32_16x16x32_bf16 v[124:127], v[24:27], v[52:55], v[124:127]
    v_mfma_f32_16x16x32_bf16 v[112:115], v[28:31], v[48:51], v[112:115]
    v_mfma_f32_16x16x32_bf16 v[128:131], v[28:31], v[52:55], v[128:131]
    s_waitcnt vmcnt(4) lgkmcnt(0)
    s_nop 0
    v_mfma_f32_16x16x32_bf16 v[100:103], v[32:35], v[56:59], v[100:103]
    ds_read_b64_tr_b16 v[16:17], v12 offset:8192
    ds_read_b64_tr_b16 v[18:19], v12 offset:10240
    v_mfma_f32_16x16x32_bf16 v[116:119], v[32:35], v[60:63], v[116:119]
    ds_read_b64_tr_b16 v[20:21], v13 offset:8192
    ds_read_b64_tr_b16 v[22:23], v13 offset:10240
    v_mfma_f32_16x16x32_bf16 v[104:107], v[36:39], v[56:59], v[104:107]
    ds_read_b64_tr_b16 v[24:25], v14 offset:8192
    ds_read_b64_tr_b16 v[26:27], v14 offset:10240
    v_mfma_f32_16x16x32_bf16 v[120:123], v[36:39], v[60:63], v[120:123]
    ds_read_b64_tr_b16 v[28:29], v15 offset:8192
    ds_read_b64_tr_b16 v[30:31], v15 offset:10240
    v_mfma_f32_16x16x32_bf16 v[108:111], v[40:43], v[56:59], v[108:111]
    v_mfma_f32_16x16x32_bf16 v[124:127], v[40:43], v[60:63], v[124:127]
    v_mfma_f32_16x16x32_bf16 v[112:115], v[44:47], v[56:59], v[112:115]
    v_mfma_f32_16x16x32_bf16 v[128:131], v[44:47], v[60:63], v[128:131]
    s_waitcnt vmcnt(2) lgkmcnt(0)
    s_nop 0
    v_mfma_f32_16x16x32_bf16 v[100:103], v[16:19], v[64:67], v[100:103]
    ds_read_b64_tr_b16 v[32:33], v12 offset:12288
    ds_read_b64_tr_b16 v[34:35], v12 offset:14336
    v_mfma_f32_16x16x32_bf16 v[116:119], v[16:19], v[68:71], v[116:119]
    ds_read_b64_tr_b16 v[36:37], v13 offset:12288
    ds_read_b64_tr_b16 v[38:39], v13 offset:14336
    v_mfma_f32_16x16x32_bf16 v[104:107], v[20:23], v[64:67], v[104:107]
    ds_read_b64_tr_b16 v[40:41], v14 offset:12288
    ds_read_b64_tr_b16 v[42:43], v14 offset:14336
    v_mfma_f32_16x16x32_bf16 v[120:123], v[20:23], v[68:71], v[120:123]
    ds_read_b64_tr_b16 v[44:45], v15 offset:12288
    ds_read_b64_tr_b16 v[46:47], v15 offset:14336
    v_mfma_f32_16x16x32_bf16 v[108:111], v[24:27], v[64:67], v[108:111]
    v_mfma_f32_16x16x32_bf16 v[124:127], v[24:27], v[68:71], v[124:127]
    v_mfma_f32_16x16x32_bf16 v[112:115], v[28:31], v[64:67], v[112:115]
    v_mfma_f32_16x16x32_bf16 v[128:131], v[28:31], v[68:71], v[128:131]
    s_waitcnt vmcnt(0) lgkmcnt(0)
    s_nop 0
    v_mfma_f32_16x16x32_bf16 v[100:103], v[32:35], v[72:75], v[100:103]
    v_mfma_f32_16x16x32_bf16 v[116:119], v[32:35], v[76:79], v[116:119]
    v_mfma_f32_16x16x32_bf16 v[104:107], v[36:39], v[72:75], v[104:107]
    v_mfma_f32_16x16x32_bf16 v[120:123], v[36:39], v[76:79], v[120:123]
    v_mfma_f32_16x16x32_bf16 v[108:111], v[40:43], v[72:75], v[108:111]
    v_mfma_f32_16x16x32_bf16 v[124:127], v[40:43], v[76:79], v[124:127]
    v_mfma_f32_16x16x32_bf16 v[112:115], v[44:47], v[72:75], v[112:115]
    v_mfma_f32_16x16x32_bf16 v[128:131], v[44:47], v[76:79], v[128:131]
    s_nop 2
    v_permlane16_swap_b32 v100, v104
    v_permlane16_swap_b32 v101, v105
    v_permlane16_swap_b32 v102, v106
    v_permlane16_swap_b32 v103, v107
    v_permlane16_swap_b32 v108, v112
    v_permlane16_swap_b32 v109, v113
    v_permlane16_swap_b32 v110, v114
    v_permlane16_swap_b32 v111, v115
    v_permlane16_swap_b32 v116, v120
    v_permlane16_swap_b32 v117, v121
    v_permlane16_swap_b32 v118, v122
    v_permlane16_swap_b32 v119, v123
    v_permlane16_swap_b32 v124, v128
    v_permlane16_swap_b32 v125, v129
    v_permlane16_swap_b32 v126, v130
    v_permlane16_swap_b32 v127, v131
    s_cmp_eq_u64 s[60:61], 0
    s_cbranch_scc1 F_fin
    s_mov_b32 s48, 0xbfb8aa3b
    v_and_b32 v7, 0x3f, v2
    v_lshlrev_b32 v7, 1, v7
    v_add_u32 v7, 159744, v7
    v_mov_b32 v6, 159136

    ds_read_b32 v5, v6 offset:0
FW_77:
    s_waitcnt lgkmcnt(0)
    v_cmp_gt_u32 vcc, 1, v5
    s_cbranch_vccz FO_78
    ds_read_b32 v5, v6 offset:0
    s_branch FW_77
FO_78:
    v_bfe_u32 v4, v164, 11, 3
    v_lshl_add_u32 v4, v4, 8, v7
    v_cmp_ne_u32 vcc, 0, v164
    s_nop 0
    s_and_saveexec_b64 s[50:51], vcc
    s_cbranch_execz F_rb_79
    ds_read_b128 v[16:19], v4 offset:0
    ds_read_b128 v[20:23], v4 offset:16
    ds_read_b128 v[24:27], v4 offset:128
    ds_read_b128 v[28:31], v4 offset:144
    v_and_b32 v5, 0xffff0000, v164
    v_ashrrev_i32 v6, 31, v5
    v_not_b32 v6, v6
    v_or_b32 v6, 0x80000000, v6
    v_xor_b32 v5, v5, v6
    v_and_b32 v5, 0xffff0000, v5
    v_mul_f32 v5, s48, v5
    v_exp_f32 v5, v5
    s_nop 0
    v_add_f32 v5, 1.0, v5
    v_rcp_f32 v5, v5
    s_nop 0
    v_cvt_pk_bf16_f32 v5, v5, v5
    v_lshlrev_b32 v5, 16, v5
    s_waitcnt lgkmcnt(0)
    v_fmac_f32 v100, v16, v5
    v_fmac_f32 v101, v17, v5
    v_fmac_f32 v102, v18, v5
    v_fmac_f32 v103, v19, v5
    v_fmac_f32 v104, v20, v5
    v_fmac_f32 v105, v21, v5
    v_fmac_f32 v106, v22, v5
    v_fmac_f32 v107, v23, v5
    v_fmac_f32 v108, v24, v5
    v_fmac_f32 v109, v25, v5
    v_fmac_f32 v110, v26, v5
    v_fmac_f32 v111, v27, v5
    v_fmac_f32 v112, v28, v5
    v_fmac_f32 v113, v29, v5
    v_fmac_f32 v114, v30, v5
    v_fmac_f32 v115, v31, v5
F_rb_79:
    s_mov_b64 exec, s[50:51]
    v_bfe_u32 v4, v165, 11, 3
    v_lshl_add_u32 v4, v4, 8, v7
    v_cmp_ne_u32 vcc, 0, v165
    s_nop 0
    s_and_saveexec_b64 s[50:51], vcc
    s_cbranch_execz F_rb_80
    ds_read_b128 v[16:19], v4 offset:0
    ds_read_b128 v[20:23], v4 offset:16
    ds_read_b128 v[24:27], v4 offset:128
    ds_read_b128 v[28:31], v4 offset:144
    v_and_b32 v5, 0xffff0000, v165
    v_ashrrev_i32 v6, 31, v5
    v_not_b32 v6, v6
    v_or_b32 v6, 0x80000000, v6
    v_xor_b32 v5, v5, v6
    v_and_b32 v5, 0xffff0000, v5
    v_mul_f32 v5, s48, v5
    v_exp_f32 v5, v5
    s_nop 0
    v_add_f32 v5, 1.0, v5
    v_rcp_f32 v5, v5
    s_nop 0
    v_cvt_pk_bf16_f32 v5, v5, v5
    v_lshlrev_b32 v5, 16, v5
    s_waitcnt lgkmcnt(0)
    v_fmac_f32 v116, v16, v5
    v_fmac_f32 v117, v17, v5
    v_fmac_f32 v118, v18, v5
    v_fmac_f32 v119, v19, v5
    v_fmac_f32 v120, v20, v5
    v_fmac_f32 v121, v21, v5
    v_fmac_f32 v122, v22, v5
    v_fmac_f32 v123, v23, v5
    v_fmac_f32 v124, v24, v5
    v_fmac_f32 v125, v25, v5
    v_fmac_f32 v126, v26, v5
    v_fmac_f32 v127, v27, v5
    v_fmac_f32 v128, v28, v5
    v_fmac_f32 v129, v29, v5
    v_fmac_f32 v130, v30, v5
    v_fmac_f32 v131, v31, v5
F_rb_80:
    s_mov_b64 exec, s[50:51]
F_fin:
    s_nop 0
    v_cvt_pk_bf16_f32 v48, v100, v101
    v_cvt_pk_bf16_f32 v49, v102, v103
    v_cvt_pk_bf16_f32 v50, v104, v105
    v_cvt_pk_bf16_f32 v51, v106, v107
    v_cvt_pk_bf16_f32 v52, v108, v109
    v_cvt_pk_bf16_f32 v53, v110, v111
    v_cvt_pk_bf16_f32 v54, v112, v113
    v_cvt_pk_bf16_f32 v55, v114, v115
    v_mov_b32 v64, v48
    v_mov_b32 v65, v49
    v_mov_b32 v66, v50
    v_mov_b32 v67, v51
    v_mov_b32_dpp v48, v52 row_ror:8 row_mask:0xf bank_mask:0xc
    v_mov_b32_dpp v49, v53 row_ror:8 row_mask:0xf bank_mask:0xc
    v_mov_b32_dpp v50, v54 row_ror:8 row_mask:0xf bank_mask:0xc
    v_mov_b32_dpp v51, v55 row_ror:8 row_mask:0xf bank_mask:0xc
    v_mov_b32_dpp v52, v64 row_ror:8 row_mask:0xf bank_mask:0x3
    v_mov_b32_dpp v53, v65 row_ror:8 row_mask:0xf bank_mask:0x3
    v_mov_b32_dpp v54, v66 row_ror:8 row_mask:0xf bank_mask:0x3
    v_mov_b32_dpp v55, v67 row_ror:8 row_mask:0xf bank_mask:0x3
    s_add_u32 s44, s42, 0x4000
    buffer_store_dwordx4 v[48:51], v1, s[12:15], s42 offen sc1
    buffer_store_dwordx4 v[52:55], v1, s[12:15], s44 offen sc1
    v_cvt_pk_bf16_f32 v56, v116, v117
    v_cvt_pk_bf16_f32 v57, v118, v119
    v_cvt_pk_bf16_f32 v58, v120, v121
    v_cvt_pk_bf16_f32 v59, v122, v123
    v_cvt_pk_bf16_f32 v60, v124, v125
    v_cvt_pk_bf16_f32 v61, v126, v127
    v_cvt_pk_bf16_f32 v62, v128, v129
    v_cvt_pk_bf16_f32 v63, v130, v131
    v_mov_b32 v64, v56
    v_mov_b32 v65, v57
    v_mov_b32 v66, v58
    v_mov_b32 v67, v59
    v_mov_b32_dpp v56, v60 row_ror:8 row_mask:0xf bank_mask:0xc
    v_mov_b32_dpp v57, v61 row_ror:8 row_mask:0xf bank_mask:0xc
    v_mov_b32_dpp v58, v62 row_ror:8 row_mask:0xf bank_mask:0xc
    v_mov_b32_dpp v59, v63 row_ror:8 row_mask:0xf bank_mask:0xc
    v_mov_b32_dpp v60, v64 row_ror:8 row_mask:0xf bank_mask:0x3
    v_mov_b32_dpp v61, v65 row_ror:8 row_mask:0xf bank_mask:0x3
    v_mov_b32_dpp v62, v66 row_ror:8 row_mask:0xf bank_mask:0x3
    v_mov_b32_dpp v63, v67 row_ror:8 row_mask:0xf bank_mask:0x3
    s_add_u32 s44, s43, 0x4000
    buffer_store_dwordx4 v[56:59], v1, s[12:15], s43 offen sc1
    buffer_store_dwordx4 v[60:63], v1, s[12:15], s44 offen sc1
    s_endpgm
F_aux:
    s_setprio 3
    s_sub_u32 s3, s3, 8
    s_mov_b32 s88, s3
    v_lshrrev_b32 v5, 4, v0
    s_cmp_eq_u32 s3, 1
    s_mov_b32 s45, 73728
    s_cselect_b32 s45, 65536, s45
    s_cmp_eq_u32 s3, 2
    s_cselect_b32 s45, 147456, s45
    v_bfe_u32 v60, v0, 2, 2
    v_lshl_add_u32 v62, v5, 3, v60
    v_lshrrev_b32 v60, 1, v60
    v_and_b32 v63, 1, v5
    v_lshl_add_u32 v60, v63, 1, v60
    v_lshlrev_b32 v60, 5, v60
    v_lshl_add_u32 v60, v62, 7, v60
    v_and_b32 v63, 3, v0
    v_lshl_add_u32 v60, v63, 3, v60
    v_add_u32 v62, s45, v60
    v_xor_b32 v63, 32, v62
    v_xor_b32 v64, 64, v62
    v_xor_b32 v65, 96, v62
    v_lshlrev_b32 v2, 4, v0
    v_lshlrev_b32 v3, 2, v0
    v_and_b32 v7, 15, v0
    v_and_b32 v8, 7, v0
    v_lshlrev_b32 v8, 4, v8
    v_lshl_add_u32 v8, v5, 7, v8
    v_bfe_u32 v9, v0, 3, 1
    v_lshl_add_u32 v4, v9, 11, v8
    v_and_b32 v9, 1, v0
    v_lshlrev_b32 v59, 2, v7
    s_lshl_b32 s76, s32, 4
    s_add_u32 s76, s76, s33
    s_lshl_b32 s77, s76, 3
    s_lshl_b32 s44, s3, 1
    s_add_u32 s77, s77, s44
    v_mov_b32 v12, 0
    v_mov_b32 v13, 0
    v_mov_b32 v14, 0
    v_mov_b32 v15, 0
    s_lshl_b32 s75, s3, 4
    s_add_u32 s75, s75, s33
    s_lshl_b32 s44, s3, 2
    s_add_u32 s44, s44, 159040
    v_mov_b32 v10, s44

    v_mov_b32 v32, 0x3f803f80
    v_mov_b32 v33, 0x3f803f80
    v_mov_b32 v34, 0x3f803f80
    v_mov_b32 v35, 0x3f803f80
    v_mov_b32 v36, 0x3f803f80
    v_mov_b32 v37, 0x3f803f80
    v_mov_b32 v38, 0x3f803f80
    v_mov_b32 v39, 0x3f803f80
    v_mov_b32 v40, 0x3f803f80
    v_mov_b32 v41, 0x3f803f80
    v_mov_b32 v42, 0x3f803f80
    v_mov_b32 v43, 0x3f803f80
    v_mov_b32 v44, 0x3f803f80
    v_mov_b32 v45, 0x3f803f80
    v_mov_b32 v46, 0x3f803f80
    v_mov_b32 v47, 0x3f803f80
    s_waitcnt lgkmcnt(0)
    s_mov_b32 s20, s4
    s_mov_b32 s21, s5
    s_mov_b32 s22, 0x400000
    s_mov_b32 s23, 0x00020000
    s_mov_b32 s19, 0x20000
    s_add_u32 s40, s72, 0x850000
    s_addc_u32 s41, s73, 0
    s_mov_b32 s42, 0xd000
    s_mov_b32 s43, 0x00020000
    s_cmp_lg_u32 s3, 0
    s_cbranch_scc1 F_z0
    s_getpc_b64 s[46:47]
F_pc:
    s_sub_u32 s46, s46, F_pc-parallel_sum__linear_attn_block__moe_arch_mod__prompt_kernel
    s_subb_u32 s47, s47, 0
    s_and_b32 s44, s31, 7
    s_lshl_b32 s44, s44, 13
    v_lshlrev_b32 v67, 7, v0
    v_add_u32 v67, s44, v67
    v_min_u32 v67, F_codeend-parallel_sum__linear_attn_block__moe_arch_mod__prompt_kernel-4, v67
    global_load_dword v61, v67, s[46:47]
    s_cmp_lg_u32 s75, 0
    s_cbranch_scc1 F_z0
    s_lshl_b32 s44, s32, 9
    s_add_u32 s44, s44, 32768
    s_mov_b32 exec_hi, 0
    buffer_store_dwordx4 v[12:15], v2, s[40:43], s44 offen sc0 sc1
    s_mul_i32 s44, s32, 768
    s_add_u32 s44, s44, 40960
    s_mov_b32 exec_hi, 0xffff
    buffer_store_dwordx4 v[12:15], v2, s[40:43], s44 offen sc0 sc1
    s_mov_b64 exec, -1
F_z0:

    s_barrier
    s_bitcmp0_b32 s3, 0
    s_cbranch_scc1 F_cs1
    ds_read_b64_tr_b16 v[72:73], v62 offset:0
    ds_read_b64_tr_b16 v[74:75], v62 offset:512
    ds_read_b64_tr_b16 v[76:77], v62 offset:4096
    ds_read_b64_tr_b16 v[78:79], v62 offset:4608
    ds_read_b64_tr_b16 v[80:81], v63 offset:0
    ds_read_b64_tr_b16 v[82:83], v63 offset:512
    ds_read_b64_tr_b16 v[84:85], v63 offset:4096
    ds_read_b64_tr_b16 v[86:87], v63 offset:4608
    s_waitcnt lgkmcnt(4)
    s_nop 0
    ds_read_b64_tr_b16 v[88:89], v64 offset:0
    ds_read_b64_tr_b16 v[90:91], v64 offset:512
    ds_read_b64_tr_b16 v[92:93], v64 offset:4096
    ds_read_b64_tr_b16 v[94:95], v64 offset:4608
    ds_read_b64_tr_b16 v[96:97], v65 offset:0
    ds_read_b64_tr_b16 v[98:99], v65 offset:512
    ds_read_b64_tr_b16 v[100:101], v65 offset:4096
    ds_read_b64_tr_b16 v[102:103], v65 offset:4608
    s_branch F_cs2
F_cs1:
    v_add_u32 v60, 159040, v3
    s_mov_b32 exec_hi, 0xffff
    ds_write_b32 v60, v12
    s_mov_b64 exec, -1
F_cs2:
    s_add_u32 s24, s72, 0x800000
    s_addc_u32 s25, s73, 0
    s_mov_b32 s26, 0x48000
    s_mov_b32 s27, 0x00020000
    s_mov_b32 s48, s70
    s_mov_b32 s49, s71
    s_mov_b32 s50, 0x100
    s_mov_b32 s51, 0x00020000
    s_lshl_b32 s47, s32, 9
    s_add_u32 s56, s47, 0x858000
    s_add_u32 s56, s72, s56
    s_addc_u32 s57, s73, 0
    s_lshl_b32 s47, s33, 9
    s_add_u32 s58, s47, 0x858100
    s_add_u32 s58, s72, s58
    s_addc_u32 s59, s73, 0
    v_mov_b32 v68, 0x3f803f80
    v_mov_b32 v69, 0x3f803f80
    v_mov_b32 v70, 0x3f803f80
    v_mov_b32 v71, 0x3f803f80
    s_waitcnt lgkmcnt(0)
    s_cmp_lg_u32 s75, 0
    s_cbranch_scc1 F_z4
    s_lshl_b32 s45, s32, 2
    s_add_u32 s44, s70, s45
    s_addc_u32 s45, s71, 0
    s_mov_b32 s46, 1
    s_waitcnt vmcnt(0)
    s_atomic_add s46, s[44:45], 0
F_z4:

    s_branch IW_s8
IW_w8:
    s_branch IW_r8
IW_s8:
    s_bitcmp0_b32 s3, 0
    s_cbranch_scc1 F_c2a
    s_nop 0
    v_mfma_f32_16x16x32_bf16 v[104:107], v[68:71], v[72:75], 0
    v_mfma_f32_16x16x32_bf16 v[108:111], v[68:71], v[80:83], 0
    v_mfma_f32_16x16x32_bf16 v[112:115], v[68:71], v[88:91], 0
    v_mfma_f32_16x16x32_bf16 v[116:119], v[68:71], v[96:99], 0
    v_mfma_f32_16x16x32_bf16 v[104:107], v[68:71], v[76:79], v[104:107]
    v_mfma_f32_16x16x32_bf16 v[108:111], v[68:71], v[84:87], v[108:111]
    v_mfma_f32_16x16x32_bf16 v[112:115], v[68:71], v[92:95], v[112:115]
    v_mfma_f32_16x16x32_bf16 v[116:119], v[68:71], v[100:103], v[116:119]
    v_cmp_eq_u32 vcc, 1, v5
    s_nop 4
    v_cndmask_b32 v66, v104, v108, vcc
    v_cmp_eq_u32 vcc, 2, v5
    s_nop 1
    v_cndmask_b32 v66, v66, v112, vcc
    v_cmp_eq_u32 vcc, 3, v5
    s_nop 1
    v_cndmask_b32 v66, v66, v116, vcc

F_c2a:
    s_barrier
    s_cmp_lg_u32 s3, 2
    s_cbranch_scc1 F_cs3
    ds_read_b64_tr_b16 v[72:73], v62 offset:0
    ds_read_b64_tr_b16 v[74:75], v62 offset:512
    ds_read_b64_tr_b16 v[76:77], v62 offset:4096
    ds_read_b64_tr_b16 v[78:79], v62 offset:4608
    ds_read_b64_tr_b16 v[80:81], v63 offset:0
    ds_read_b64_tr_b16 v[82:83], v63 offset:512
    ds_read_b64_tr_b16 v[84:85], v63 offset:4096
    ds_read_b64_tr_b16 v[86:87], v63 offset:4608
    s_waitcnt lgkmcnt(4)
    s_nop 0
    ds_read_b64_tr_b16 v[88:89], v64 offset:0
    ds_read_b64_tr_b16 v[90:91], v64 offset:512
    ds_read_b64_tr_b16 v[92:93], v64 offset:4096
    ds_read_b64_tr_b16 v[94:95], v64 offset:4608
    ds_read_b64_tr_b16 v[96:97], v65 offset:0
    ds_read_b64_tr_b16 v[98:99], v65 offset:512
    ds_read_b64_tr_b16 v[100:101], v65 offset:4096
    ds_read_b64_tr_b16 v[102:103], v65 offset:4608
    s_waitcnt lgkmcnt(0)
F_cs3:
    s_cmp_lg_u32 s3, 0
    s_cbranch_scc1 EV_82
    s_branch IW_w8
IW_r8:
EV_82:
    s_cmp_lg_u32 s3, 1
    s_cbranch_scc1 EV_83
    s_branch IW_w0
IW_r0:
EV_83:
    s_cmp_lg_u32 s3, 2
    s_cbranch_scc1 EV_84
    s_branch IW_w1
IW_r1:
EV_84:
    s_cmp_lg_u32 s3, 3
    s_cbranch_scc1 EV_85
    s_branch IW_w3
IW_r3:
EV_85:
    s_barrier
    s_cmp_lg_u32 s3, 2
    s_cbranch_scc1 F_c2b
    v_mfma_f32_16x16x32_bf16 v[104:107], v[68:71], v[72:75], 0
    v_mfma_f32_16x16x32_bf16 v[108:111], v[68:71], v[80:83], 0
    v_mfma_f32_16x16x32_bf16 v[112:115], v[68:71], v[88:91], 0
    v_mfma_f32_16x16x32_bf16 v[116:119], v[68:71], v[96:99], 0
    v_mfma_f32_16x16x32_bf16 v[104:107], v[68:71], v[76:79], v[104:107]
    v_mfma_f32_16x16x32_bf16 v[108:111], v[68:71], v[84:87], v[108:111]
    v_mfma_f32_16x16x32_bf16 v[112:115], v[68:71], v[92:95], v[112:115]
    v_mfma_f32_16x16x32_bf16 v[116:119], v[68:71], v[100:103], v[116:119]
    v_cmp_eq_u32 vcc, 1, v5
    s_nop 4
    v_cndmask_b32 v66, v104, v108, vcc
    v_cmp_eq_u32 vcc, 2, v5
    s_nop 1
    v_cndmask_b32 v66, v66, v112, vcc
    v_cmp_eq_u32 vcc, 3, v5
    s_nop 1
    v_cndmask_b32 v66, v66, v116, vcc

F_c2b:
    s_cmp_lg_u32 s3, 0
    s_cbranch_scc1 F_r1
    buffer_load_dword v11, v59, s[48:51], 0 offen sc0 sc1
F_r1:
    s_cmp_lg_u32 s3, 0
    s_cbranch_scc1 EV_87
    s_branch IW_w4
IW_r4:
EV_87:
    s_cmp_lg_u32 s3, 1
    s_cbranch_scc1 EV_88
    s_branch IW_w9
IW_r9:
EV_88:
    s_cmp_lg_u32 s3, 2
    s_cbranch_scc1 EV_89
    s_branch IW_w10
IW_r10:
EV_89:
    s_cmp_lg_u32 s3, 3
    s_cbranch_scc1 EV_90
    s_nop 0
EV_90:
    s_barrier
    s_cmp_lt_u32 s3, 2
    s_mov_b32 s44, 114688
    s_cselect_b32 s44, 114688, s44
    s_lshl_b32 s45, s3, 12
    s_add_u32 s44, s44, s45
    v_add_u32 v4, s44, v4
    v_add_u32 v8, 161792, v8
    ds_read_b128 v[16:19], v4 offset:0
    ds_read_b128 v[20:23], v4 offset:512
    ds_read_b128 v[24:27], v4 offset:1024
    ds_read_b128 v[28:31], v4 offset:1536
    s_mov_b32 exec_lo, 0x00ff00ff
    s_mov_b32 exec_hi, 0x00ff00ff
    ds_read_b128 v[32:35], v8 offset:0
    ds_read_b128 v[36:39], v8 offset:512
    ds_read_b128 v[40:43], v8 offset:1024
    ds_read_b128 v[44:47], v8 offset:1536
    s_mov_b64 exec, -1
    s_waitcnt lgkmcnt(0)
    v_mfma_f32_16x16x32_bf16 v[120:123], v[16:19], v[16:19], 0
    v_mfma_f32_16x16x32_bf16 v[124:127], v[16:19], v[32:35], 0
    v_mfma_f32_16x16x32_bf16 v[128:131], v[32:35], v[32:35], 0
    v_mfma_f32_16x16x32_bf16 v[120:123], v[20:23], v[20:23], v[120:123]
    v_mfma_f32_16x16x32_bf16 v[124:127], v[20:23], v[36:39], v[124:127]
    v_mfma_f32_16x16x32_bf16 v[128:131], v[36:39], v[36:39], v[128:131]
    v_mfma_f32_16x16x32_bf16 v[120:123], v[24:27], v[24:27], v[120:123]
    v_mfma_f32_16x16x32_bf16 v[124:127], v[24:27], v[40:43], v[124:127]
    v_mfma_f32_16x16x32_bf16 v[128:131], v[40:43], v[40:43], v[128:131]
    v_mfma_f32_16x16x32_bf16 v[120:123], v[28:31], v[28:31], v[120:123]
    v_mfma_f32_16x16x32_bf16 v[124:127], v[28:31], v[44:47], v[124:127]
    v_mfma_f32_16x16x32_bf16 v[128:131], v[44:47], v[44:47], v[128:131]
    v_and_b32 v52, 3, v0
    v_cmp_eq_u32 vcc, 1, v52
    s_nop 3
    v_cndmask_b32 v120, v120, v121, vcc
    v_cndmask_b32 v124, v124, v125, vcc
    v_cndmask_b32 v128, v128, v129, vcc
    v_cmp_eq_u32 vcc, 2, v52
    s_nop 1
    v_cndmask_b32 v120, v120, v122, vcc
    v_cndmask_b32 v124, v124, v126, vcc
    v_cndmask_b32 v128, v128, v130, vcc
    v_cmp_eq_u32 vcc, 3, v52
    s_nop 1
    v_cndmask_b32 v120, v120, v123, vcc
    v_cndmask_b32 v124, v124, v127, vcc
    v_cndmask_b32 v128, v128, v131, vcc
    v_add_f32_dpp v120, v120, v120 quad_perm:[1,0,3,2] row_mask:0xf bank_mask:0xf
    v_add_f32_dpp v124, v124, v124 quad_perm:[1,0,3,2] row_mask:0xf bank_mask:0xf
    v_add_f32_dpp v128, v128, v128 quad_perm:[1,0,3,2] row_mask:0xf bank_mask:0xf
    v_add_f32_dpp v120, v120, v120 quad_perm:[2,3,0,1] row_mask:0xf bank_mask:0xf
    v_add_f32_dpp v124, v124, v124 quad_perm:[2,3,0,1] row_mask:0xf bank_mask:0xf
    v_add_f32_dpp v128, v128, v128 quad_perm:[2,3,0,1] row_mask:0xf bank_mask:0xf
    v_readlane_b32 s44, v124, 8
    v_readlane_b32 s45, v124, 24
    v_readlane_b32 s46, v124, 40
    v_readlane_b32 s47, v124, 56
    v_mov_b32 v48, s44
    v_mov_b32 v52, s45
    s_nop 0
    v_writelane_b32 v48, s46, 1
    v_writelane_b32 v52, s47, 1
    v_readlane_b32 s44, v120, 0
    v_readlane_b32 s45, v120, 20
    v_readlane_b32 s46, v120, 40
    v_readlane_b32 s47, v120, 60
    v_mov_b32 v49, s44
    v_mov_b32 v53, s45
    s_nop 0
    v_writelane_b32 v49, s46, 1
    v_writelane_b32 v53, s47, 1
    v_readlane_b32 s44, v124, 0
    v_readlane_b32 s45, v124, 20
    v_readlane_b32 s46, v124, 32
    v_readlane_b32 s47, v124, 52
    v_mov_b32 v50, s44
    v_mov_b32 v54, s45
    s_nop 0
    v_writelane_b32 v50, s46, 1
    v_writelane_b32 v54, s47, 1
    v_readlane_b32 s44, v128, 8
    v_readlane_b32 s45, v128, 24
    v_readlane_b32 s46, v128, 8
    v_readlane_b32 s47, v128, 24
    v_mov_b32 v51, s44
    v_mov_b32 v55, s45
    s_nop 0
    v_writelane_b32 v51, s46, 1
    v_writelane_b32 v55, s47, 1
    v_add_f32 v48, v48, v52
    v_add_f32 v49, v49, v53
    v_add_f32 v50, v50, v54
    v_add_f32 v51, v51, v55
    v_mul_f32 v48, 0x3a800000, v48
    v_mul_f32 v49, 0x3a800000, v49
    v_fma_f32 v49, -v48, v48, v49
    v_max_f32 v49, 0, v49
    v_cvt_pk_bf16_f32 v52, v48, v49
    v_lshlrev_b32 v48, 16, v52
    v_and_b32 v49, 0xffff0000, v52
    v_add_f32 v49, 0x3727c5ac, v49
    v_cvt_pk_bf16_f32 v49, v49, v49
    v_lshlrev_b32 v49, 16, v49
    v_sqrt_f32 v49, v49
    s_nop 0
    v_cvt_pk_bf16_f32 v49, v49, v49
    v_lshlrev_b32 v49, 16, v49
    v_rcp_f32 v49, v49
    v_xor_b32 v48, 0x80000000, v48
    v_fma_f32 v50, v48, v51, v50
    v_mul_f32 v50, v50, v49
    v_cvt_pk_bf16_f32 v50, v50, v50
    v_and_b32 v50, 0xffff0000, v50
    v_ashrrev_i32 v51, 31, v50
    v_or_b32 v51, 0x80000000, v51
    v_xor_b32 v50, v50, v51
    v_and_b32 v50, 0xffff0000, v50
    s_sub_u32 s44, 2047, s77
    v_sub_u32 v51, s44, v9
    v_or_b32 v50, v50, v51
    s_lshl_b32 s44, s3, 1
    v_add_u32 v52, s44, v9
    v_lshlrev_b32 v53, 3, v52
    v_lshlrev_b32 v52, 2, v52
    v_add_u32 v53, 159744, v53
    v_add_u32 v52, 159808, v52
    s_mov_b64 exec, 3
    ds_write_b64 v53, v[48:49]
    ds_write_b32 v52, v50
    s_mov_b64 exec, -1
    s_waitcnt lgkmcnt(0)

    s_cmp_lg_u32 s3, 0
    s_cbranch_scc1 F_a0r
F_a0p:
    s_waitcnt vmcnt(0)
    v_cmp_eq_u32 vcc, 0, v11
    s_cbranch_vccz F_a0r
    s_sleep 4
    buffer_load_dword v11, v59, s[48:51], 0 offen sc0 sc1
    s_branch F_a0p
F_a0r:
    s_barrier
    s_cmp_eq_u32 s3, 0
    s_cbranch_scc1 F_ax0
    s_mul_i32 s44, s33, 768
    s_add_u32 s44, s44, 40960
    s_add_u32 s45, s3, 1
    s_lshr_b32 s45, s45, 1
    s_cmp_eq_u32 s3, 2
    s_cselect_b32 s45, 0, s45
    s_lshl_b32 s45, s45, 8
    s_add_u32 s44, s44, s45
    buffer_atomic_add_f32 v66, v3, s[40:43], s44 offen
    s_mul_i32 s44, s2, 1152
    s_mul_i32 s45, s3, 384
    s_add_u32 s44, s44, s45
    s_sub_u32 s44, s44, 384
    s_mov_b64 exec, 0xffffff
    buffer_store_dwordx4 v[12:15], v2, s[24:27], s44 offen sc0 sc1
    s_mov_b64 exec, -1
    s_branch F_s1
F_ax0:
    v_add_u32 v60, 159744, v3
    ds_read_b32 v60, v60
    s_lshl_b32 s44, s76, 7
    s_mov_b32 exec_hi, 0
    s_waitcnt lgkmcnt(0)
    buffer_store_dword v60, v3, s[40:43], s44 offen sc0 sc1
    s_mov_b64 exec, -1
F_s1:

    s_barrier
    v_mov_b32 v4, 159144
    v_mov_b32 v8, 1
    s_lshr_b32 s47, s32, 2
    s_lshl_b32 s47, s47, 11
    s_add_u32 s54, s47, 0x858180
    s_add_u32 s54, s72, s54
    s_addc_u32 s55, s73, 0
    s_waitcnt vmcnt(0)
    s_mov_b64 exec, 1
    ds_add_rtn_u32 v9, v4, v8
    s_waitcnt lgkmcnt(0)
    v_readfirstlane_b32 s44, v9
    s_mov_b64 exec, -1
    s_cmp_lg_u32 s44, 3
    s_cbranch_scc1 F_a0s
    s_mov_b32 s74, 1
    s_atomic_add s74, s[54:55], 0
    s_atomic_add s74, s[56:57], 0
    s_atomic_add s74, s[58:59], 0
F_a0s:

    s_barrier
    s_and_b32 s89, s2, 0xdd
    s_bfe_u32 s44, s2, 0x10005
    s_lshl_b32 s44, s44, 1
    s_or_b32 s89, s89, s44
    s_bfe_u32 s44, s2, 0x10001
    s_xor_b32 s44, s44, 1
    s_lshl_b32 s44, s44, 5
    s_or_b32 s89, s89, s44
    s_xor_b32 s89, s89, 0

    s_and_b32 s36, s89, 3
    s_bfe_u32 s37, s89, 0x10002
    s_lshr_b32 s38, s89, 3
    s_cmp_eq_u32 s37, 0
    s_cselect_b32 s16, s62, s64
    s_cselect_b32 s17, s63, s65
    s_cmp_lt_u32 s89, 224
    s_cselect_b32 s18, 7340032, 0
    v_mul_u32_u24 v6, 57344, v5
    v_lshl_add_u32 v6, v7, 4, v6
    s_lshl_b32 s44, s36, 2
    s_add_u32 s44, s44, s3
    s_waitcnt lgkmcnt(0)
    s_mul_i32 s54, s44, 458752
    s_lshl_b32 s45, s38, 8
    s_add_u32 s54, s54, s45
    s_lshl_b32 s55, s44, 7

    s_add_u32 s39, s35, 2
    s_and_b32 s39, s39, 7
    s_lshl_b32 s10, s34, 3
    s_add_u32 s10, s10, s30

    s_mul_i32 s10, s10, 112
    s_mul_i32 s79, s3, 28
    s_add_u32 s10, s10, s79
    s_lshl_b32 s78, s10, 11
    s_lshl_b32 s79, s39, 8
    s_add_u32 s78, s78, s79
    v_mul_u32_u24 v160, 14336, v5
    v_lshl_add_u32 v160, v7, 4, v160

    s_mov_b32 s80, s66
    s_mov_b32 s81, s67
    s_mov_b32 s82, 0x700000
    s_mov_b32 s83, 0x00020000
    s_mul_i32 s53, s2, 37
    s_and_b32 s53, s53, 255
    s_mul_i32 s53, s53, 4
    s_lshr_b32 s53, s53, 8
    s_branch F_swx
F_sw0:
    s_add_u32 s91, s54, 0
    buffer_load_dwordx4 v[72:75], v6, s[16:19], s91 offen nt
    s_add_u32 s91, s54, 7168
    buffer_load_dwordx4 v[76:79], v6, s[16:19], s91 offen nt
    s_add_u32 s91, s54, 14336
    buffer_load_dwordx4 v[80:83], v6, s[16:19], s91 offen nt
    s_add_u32 s91, s54, 21504
    buffer_load_dwordx4 v[84:87], v6, s[16:19], s91 offen nt
    s_add_u32 s91, s54, 28672
    buffer_load_dwordx4 v[88:91], v6, s[16:19], s91 offen nt
    s_add_u32 s91, s54, 35840
    buffer_load_dwordx4 v[92:95], v6, s[16:19], s91 offen nt
    s_add_u32 s91, s54, 43008
    buffer_load_dwordx4 v[96:99], v6, s[16:19], s91 offen nt
    s_add_u32 s91, s54, 50176
    buffer_load_dwordx4 v[100:103], v6, s[16:19], s91 offen nt
    s_setpc_b64 s[34:35]
F_swx:
    s_cmp_eq_u32 s3, 2
    s_cbranch_scc1 F_ax2
    s_cmp_eq_u32 s3, 1
    s_cbranch_scc1 F_ax1
    s_cmp_eq_u32 s3, 0
    s_cbranch_scc1 F_ax0b
    s_barrier
    s_cmp_lg_u32 s53, 0
    s_cbranch_scc1 SW_91
    s_call_b64 s[34:35], F_sw0
SW_91:
    s_branch IW_w5
IW_r5:
    s_barrier
    s_cmp_lg_u32 s53, 1
    s_cbranch_scc1 SW_92
    s_call_b64 s[34:35], F_sw0
SW_92:
    s_branch IW_w7
IW_r7:
    s_barrier
    s_cmp_lg_u32 s53, 2
    s_cbranch_scc1 SW_93
    s_call_b64 s[34:35], F_sw0
SW_93:
    s_nop 0
    s_barrier
    s_cmp_lg_u32 s53, 3
    s_cbranch_scc1 SW_94
    s_call_b64 s[34:35], F_sw0
SW_94:
    s_nop 0
    s_barrier
    s_nop 0
    s_barrier
    s_nop 0
    s_barrier
    s_add_u32 s91, s54, 229376
    buffer_load_dwordx4 v[104:107], v6, s[16:19], s91 offen nt
    s_add_u32 s91, s54, 236544
    buffer_load_dwordx4 v[108:111], v6, s[16:19], s91 offen nt
    s_add_u32 s91, s54, 243712
    buffer_load_dwordx4 v[112:115], v6, s[16:19], s91 offen nt
    s_add_u32 s91, s54, 250880
    buffer_load_dwordx4 v[116:119], v6, s[16:19], s91 offen nt
    s_nop 0
    s_load_dword s76, s[56:57], 0 glc
    s_barrier
    s_add_u32 s91, s54, 258048
    buffer_load_dwordx4 v[120:123], v6, s[16:19], s91 offen nt
    s_add_u32 s91, s54, 265216
    buffer_load_dwordx4 v[124:127], v6, s[16:19], s91 offen nt
    s_add_u32 s91, s54, 272384
    buffer_load_dwordx4 v[128:131], v6, s[16:19], s91 offen nt
    s_add_u32 s91, s54, 279552
    buffer_load_dwordx4 v[132:135], v6, s[16:19], s91 offen nt
    s_waitcnt lgkmcnt(0)
    s_cmp_lt_u32 s76, 1000
    s_cbranch_scc1 F_g3
    v_mov_b32 v4, 1
    s_mov_b64 exec, 1
    ds_write_b32 v10, v4 offset:48
    s_mov_b64 exec, -1
    s_mov_b32 s88, 0
F_g3:
    s_barrier
    s_branch F_aj
F_ax1:
    s_barrier
    s_cmp_lg_u32 s53, 0
    s_cbranch_scc1 SW_95
    s_call_b64 s[34:35], F_sw0
SW_95:
    s_branch IW_w6
IW_r6:
    s_barrier
    s_cmp_lg_u32 s53, 1
    s_cbranch_scc1 SW_96
    s_call_b64 s[34:35], F_sw0
SW_96:
    s_nop 0
    s_barrier
    s_cmp_lg_u32 s53, 2
    s_cbranch_scc1 SW_97
    s_call_b64 s[34:35], F_sw0
SW_97:
    s_nop 0
    s_mul_i32 s44, s33, 768
    s_add_u32 s44, s44, 40960
    s_barrier
    s_cmp_lg_u32 s53, 3
    s_cbranch_scc1 SW_98
    s_call_b64 s[34:35], F_sw0
SW_98:
    s_load_dword s76, s[58:59], 0 glc
    s_barrier
    s_waitcnt lgkmcnt(0)
    s_cmp_ge_u32 s76, 16
    s_cbranch_scc1 GC_99
SP_100:
    s_load_dword s76, s[58:59], 0 glc
    s_waitcnt lgkmcnt(0)
    s_cmp_ge_u32 s76, 16
    s_cbranch_scc1 SD_101
    s_sleep 3
    s_branch SP_100
SD_101:
GC_99:
    s_barrier
    s_sleep 4
    s_mov_b32 m0, 158208
    s_mov_b32 exec_hi, 0xffff
    buffer_load_dwordx4 v2, s[40:43], s44 offen sc0 sc1 lds
    s_mov_b64 exec, -1
    s_barrier
    s_add_u32 s91, s54, 229376
    buffer_load_dwordx4 v[104:107], v6, s[16:19], s91 offen nt
    s_add_u32 s91, s54, 236544
    buffer_load_dwordx4 v[108:111], v6, s[16:19], s91 offen nt
    s_add_u32 s91, s54, 243712
    buffer_load_dwordx4 v[112:115], v6, s[16:19], s91 offen nt
    s_add_u32 s91, s54, 250880
    buffer_load_dwordx4 v[116:119], v6, s[16:19], s91 offen nt
    s_barrier
    s_nop 0
    s_add_u32 s91, s54, 258048
    buffer_load_dwordx4 v[120:123], v6, s[16:19], s91 offen nt
    s_add_u32 s91, s54, 265216
    buffer_load_dwordx4 v[124:127], v6, s[16:19], s91 offen nt
    s_add_u32 s91, s54, 272384
    buffer_load_dwordx4 v[128:131], v6, s[16:19], s91 offen nt
    s_add_u32 s91, s54, 279552
    buffer_load_dwordx4 v[132:135], v6, s[16:19], s91 offen nt
    s_waitcnt vmcnt(8)
    v_mov_b32 v4, 1
    s_mov_b64 exec, 1
    ds_write_b32 v10, v4 offset:48
    s_mov_b64 exec, -1
    s_barrier
    s_branch F_aj
IW_w9:
    s_branch IW_r9
F_ax0b:
    s_barrier
    s_cmp_lg_u32 s53, 0
    s_cbranch_scc1 SW_102
    s_call_b64 s[34:35], F_sw0
SW_102:
    s_branch IW_w2
IW_r2:
    s_barrier
    s_cmp_lg_u32 s53, 1
    s_cbranch_scc1 SW_103
    s_call_b64 s[34:35], F_sw0
SW_103:
    s_nop 0
    s_barrier
    s_cmp_lg_u32 s53, 2
    s_cbranch_scc1 SW_104
    s_call_b64 s[34:35], F_sw0
SW_104:
    s_nop 0
    s_lshl_b32 s47, s28, 9
    s_add_u32 s58, s47, 0x858000
    s_add_u32 s58, s72, s58
    s_addc_u32 s59, s73, 0
    s_lshl_b32 s44, s32, 11
    s_lshl_b32 s45, s28, 11
    v_lshrrev_b32 v11, 2, v0
    v_and_b32 v9, 3, v0
    v_lshlrev_b32 v9, 4, v9
    v_lshl_add_u32 v11, v11, 7, v9

    s_barrier
    s_cmp_lg_u32 s53, 3
    s_cbranch_scc1 SW_105
    s_call_b64 s[34:35], F_sw0
SW_105:
    s_load_dword s76, s[56:57], 0 glc
    s_load_dword s77, s[58:59], 0 glc
    s_barrier
    s_waitcnt lgkmcnt(0)
    s_cmp_ge_u32 s76, 16
    s_cbranch_scc1 GC_106
SP_107:
    s_load_dword s76, s[56:57], 0 glc
    s_waitcnt lgkmcnt(0)
    s_cmp_ge_u32 s76, 16
    s_cbranch_scc1 SD_108
    s_sleep 3
    s_branch SP_107
SD_108:
GC_106:
    s_cmp_ge_u32 s77, 16
    s_cbranch_scc1 GC_109
SP_110:
    s_load_dword s77, s[58:59], 0 glc
    s_waitcnt lgkmcnt(0)
    s_cmp_ge_u32 s77, 16
    s_cbranch_scc1 SD_111
    s_sleep 3
    s_branch SP_110
SD_111:
GC_109:
    s_barrier
    s_sleep 4
    buffer_load_dwordx4 v[32:35], v11, s[40:43], s44 offen sc0 sc1
    buffer_load_dwordx4 v[36:39], v11, s[40:43], s45 offen sc0 sc1
    v_lshlrev_b32 v9, 3, v0
    v_add_u32 v9, 155648, v9
    s_mov_b32 s44, 0x3fb8aa3b

    s_barrier
    s_add_u32 s91, s54, 229376
    buffer_load_dwordx4 v[104:107], v6, s[16:19], s91 offen nt
    s_add_u32 s91, s54, 236544
    buffer_load_dwordx4 v[108:111], v6, s[16:19], s91 offen nt
    s_add_u32 s91, s54, 243712
    buffer_load_dwordx4 v[112:115], v6, s[16:19], s91 offen nt
    s_add_u32 s91, s54, 250880
    buffer_load_dwordx4 v[116:119], v6, s[16:19], s91 offen nt
    s_barrier
    s_nop 0
    s_add_u32 s91, s54, 258048
    buffer_load_dwordx4 v[120:123], v6, s[16:19], s91 offen nt
    s_add_u32 s91, s54, 265216
    buffer_load_dwordx4 v[124:127], v6, s[16:19], s91 offen nt
    s_add_u32 s91, s54, 272384
    buffer_load_dwordx4 v[128:131], v6, s[16:19], s91 offen nt
    s_add_u32 s91, s54, 279552
    buffer_load_dwordx4 v[132:135], v6, s[16:19], s91 offen nt
    s_waitcnt vmcnt(8)
    v_swap_b32 v33, v34
    v_swap_b32 v37, v38
    v_mul_f32 v40, s44, v34
    v_mul_f32 v41, s44, v35
    ds_write_b64 v9, v[32:33]
    ds_write_b64 v9, v[40:41] offset:1024
    ds_write_b64 v9, v[36:37] offset:1536
    ds_write_b64 v9, v[38:39] offset:2048

    v_mov_b32 v4, 1
    s_mov_b64 exec, 1
    ds_write_b32 v10, v4 offset:48
    s_mov_b64 exec, -1
    s_barrier
    s_branch F_aj
F_ax2:
    s_cmp_lg_u32 s2, 248
    s_cbranch_scc1 F_a2n
    s_waitcnt lgkmcnt(0)
    s_mov_b32 s74, 7
    v_lshrrev_b32 v11, 1, v0
    v_and_b32 v9, 1, v0
    v_lshlrev_b32 v9, 4, v9
    v_lshl_add_u32 v11, v11, 7, v9
    v_lshlrev_b32 v9, 9, v0
    v_mov_b32 v8, 1000
F_a2l:

    s_load_dword s60, s[40:41], 0x8180 glc
    s_load_dword s61, s[40:41], 0x8980 glc
    s_load_dword s62, s[40:41], 0x9180 glc
    s_load_dword s63, s[40:41], 0x9980 glc
    s_waitcnt lgkmcnt(0)
    s_add_u32 s60, s60, s61
    s_add_u32 s62, s62, s63
    s_add_u32 s60, s60, s62
    s_cmp_ge_u32 s60, 256
    s_cbranch_scc1 F_a2t

    s_cmp_ge_u32 s74, 17
    s_cbranch_scc1 DB_112
    s_barrier
    s_add_u32 s74, s74, 1
DB_112:
    s_branch F_a2l
F_a2t:
    s_movk_i32 s44, 0
    buffer_load_dwordx4 v[16:19], v11, s[40:43], s44 offen offset:64 sc0 sc1
    s_movk_i32 s44, 4096
    buffer_load_dwordx4 v[20:23], v11, s[40:43], s44 offen offset:64 sc0 sc1
    s_movk_i32 s44, 8192
    buffer_load_dwordx4 v[24:27], v11, s[40:43], s44 offen offset:64 sc0 sc1
    s_movk_i32 s44, 12288
    buffer_load_dwordx4 v[28:31], v11, s[40:43], s44 offen offset:64 sc0 sc1
    s_movk_i32 s44, 16384
    buffer_load_dwordx4 v[32:35], v11, s[40:43], s44 offen offset:64 sc0 sc1
    s_movk_i32 s44, 20480
    buffer_load_dwordx4 v[36:39], v11, s[40:43], s44 offen offset:64 sc0 sc1
    s_movk_i32 s44, 24576
    buffer_load_dwordx4 v[40:43], v11, s[40:43], s44 offen offset:64 sc0 sc1
    s_movk_i32 s44, 28672
    buffer_load_dwordx4 v[44:47], v11, s[40:43], s44 offen offset:64 sc0 sc1
    s_mov_b32 s44, 32768
    s_mov_b64 exec, 0xffff
    buffer_atomic_add v8, v9, s[40:43], s44 offen
    s_mov_b64 exec, -1

    s_cmp_ge_u32 s74, 17
    s_cbranch_scc1 DB_113
    s_barrier
    s_add_u32 s74, s74, 1
DB_113:
    s_waitcnt vmcnt(1)
    v_max3_u32 v48, v16, v17, v18
    v_med3_u32 v49, v16, v17, v18
    v_min3_u32 v50, v16, v17, v18
    v_med3_u32 v50, v49, v50, v19
    v_med3_u32 v49, v48, v49, v19
    v_max_u32 v48, v48, v19
    v_med3_u32 v50, v49, v50, v20
    v_med3_u32 v49, v48, v49, v20
    v_max_u32 v48, v48, v20
    v_med3_u32 v50, v49, v50, v21
    v_med3_u32 v49, v48, v49, v21
    v_max_u32 v48, v48, v21
    v_med3_u32 v50, v49, v50, v22
    v_med3_u32 v49, v48, v49, v22
    v_max_u32 v48, v48, v22
    v_med3_u32 v50, v49, v50, v23
    v_med3_u32 v49, v48, v49, v23
    v_max_u32 v48, v48, v23
    v_med3_u32 v50, v49, v50, v24
    v_med3_u32 v49, v48, v49, v24
    v_max_u32 v48, v48, v24
    v_med3_u32 v50, v49, v50, v25
    v_med3_u32 v49, v48, v49, v25
    v_max_u32 v48, v48, v25
    v_med3_u32 v50, v49, v50, v26
    v_med3_u32 v49, v48, v49, v26
    v_max_u32 v48, v48, v26
    v_med3_u32 v50, v49, v50, v27
    v_med3_u32 v49, v48, v49, v27
    v_max_u32 v48, v48, v27
    v_med3_u32 v50, v49, v50, v28
    v_med3_u32 v49, v48, v49, v28
    v_max_u32 v48, v48, v28
    v_med3_u32 v50, v49, v50, v29
    v_med3_u32 v49, v48, v49, v29
    v_max_u32 v48, v48, v29
    v_med3_u32 v50, v49, v50, v30
    v_med3_u32 v49, v48, v49, v30
    v_max_u32 v48, v48, v30
    v_med3_u32 v50, v49, v50, v31
    v_med3_u32 v49, v48, v49, v31
    v_max_u32 v48, v48, v31
    v_med3_u32 v50, v49, v50, v32
    v_med3_u32 v49, v48, v49, v32
    v_max_u32 v48, v48, v32
    v_med3_u32 v50, v49, v50, v33
    v_med3_u32 v49, v48, v49, v33
    v_max_u32 v48, v48, v33
    v_med3_u32 v50, v49, v50, v34
    v_med3_u32 v49, v48, v49, v34
    v_max_u32 v48, v48, v34
    v_med3_u32 v50, v49, v50, v35
    v_med3_u32 v49, v48, v49, v35
    v_max_u32 v48, v48, v35
    v_med3_u32 v50, v49, v50, v36
    v_med3_u32 v49, v48, v49, v36
    v_max_u32 v48, v48, v36
    v_med3_u32 v50, v49, v50, v37
    v_med3_u32 v49, v48, v49, v37
    v_max_u32 v48, v48, v37
    v_med3_u32 v50, v49, v50, v38
    v_med3_u32 v49, v48, v49, v38
    v_max_u32 v48, v48, v38
    v_med3_u32 v50, v49, v50, v39
    v_med3_u32 v49, v48, v49, v39
    v_max_u32 v48, v48, v39
    v_med3_u32 v50, v49, v50, v40
    v_med3_u32 v49, v48, v49, v40
    v_max_u32 v48, v48, v40
    v_med3_u32 v50, v49, v50, v41
    v_med3_u32 v49, v48, v49, v41
    v_max_u32 v48, v48, v41
    v_med3_u32 v50, v49, v50, v42
    v_med3_u32 v49, v48, v49, v42
    v_max_u32 v48, v48, v42
    v_med3_u32 v50, v49, v50, v43
    v_med3_u32 v49, v48, v49, v43
    v_max_u32 v48, v48, v43
    v_med3_u32 v50, v49, v50, v44
    v_med3_u32 v49, v48, v49, v44
    v_max_u32 v48, v48, v44
    v_med3_u32 v50, v49, v50, v45
    v_med3_u32 v49, v48, v49, v45
    v_max_u32 v48, v48, v45
    v_med3_u32 v50, v49, v50, v46
    v_med3_u32 v49, v48, v49, v46
    v_max_u32 v48, v48, v46
    v_med3_u32 v50, v49, v50, v47
    v_med3_u32 v49, v48, v49, v47
    v_max_u32 v48, v48, v47
    s_mov_b32 s53, 0
    v_max_u32 v4, v48, v49
    s_nop 1
    v_max_u32_dpp v4, v4, v4 row_shr:1 row_mask:0xf bank_mask:0xf bound_ctrl:0
    s_nop 1
    v_max_u32_dpp v4, v4, v4 row_shr:2 row_mask:0xf bank_mask:0xf bound_ctrl:0
    s_nop 1
    v_max_u32_dpp v4, v4, v4 row_shr:4 row_mask:0xf bank_mask:0xf bound_ctrl:0
    s_nop 1
    v_max_u32_dpp v4, v4, v4 row_shr:8 row_mask:0xf bank_mask:0xf bound_ctrl:0
    s_nop 1
    v_max_u32_dpp v4, v4, v4 row_bcast:15 row_mask:0xa bank_mask:0xf
    s_nop 1
    v_max_u32_dpp v4, v4, v4 row_bcast:31 row_mask:0xc bank_mask:0xf
    s_nop 0
    v_readlane_b32 s52, v4, 63
    s_nop 0
    s_add_u32 s53, s53, s52
    v_writelane_b32 v13, s53, 0
    v_subrev_u32 v48, s52, v48
    v_subrev_u32 v49, s52, v49
    v_max_u32 v4, v48, v49
    s_nop 1
    v_max_u32_dpp v4, v4, v4 row_shr:1 row_mask:0xf bank_mask:0xf bound_ctrl:0
    s_nop 1
    v_max_u32_dpp v4, v4, v4 row_shr:2 row_mask:0xf bank_mask:0xf bound_ctrl:0
    s_nop 1
    v_max_u32_dpp v4, v4, v4 row_shr:4 row_mask:0xf bank_mask:0xf bound_ctrl:0
    s_nop 1
    v_max_u32_dpp v4, v4, v4 row_shr:8 row_mask:0xf bank_mask:0xf bound_ctrl:0
    s_nop 1
    v_max_u32_dpp v4, v4, v4 row_bcast:15 row_mask:0xa bank_mask:0xf
    s_nop 1
    v_max_u32_dpp v4, v4, v4 row_bcast:31 row_mask:0xc bank_mask:0xf
    s_nop 0
    v_readlane_b32 s52, v4, 63
    s_nop 0
    s_add_u32 s53, s53, s52
    v_writelane_b32 v13, s53, 1
    v_subrev_u32 v48, s52, v48
    v_subrev_u32 v49, s52, v49
    v_max_u32 v4, v48, v49
    s_nop 1
    v_max_u32_dpp v4, v4, v4 row_shr:1 row_mask:0xf bank_mask:0xf bound_ctrl:0
    s_nop 1
    v_max_u32_dpp v4, v4, v4 row_shr:2 row_mask:0xf bank_mask:0xf bound_ctrl:0
    s_nop 1
    v_max_u32_dpp v4, v4, v4 row_shr:4 row_mask:0xf bank_mask:0xf bound_ctrl:0
    s_nop 1
    v_max_u32_dpp v4, v4, v4 row_shr:8 row_mask:0xf bank_mask:0xf bound_ctrl:0
    s_nop 1
    v_max_u32_dpp v4, v4, v4 row_bcast:15 row_mask:0xa bank_mask:0xf
    s_nop 1
    v_max_u32_dpp v4, v4, v4 row_bcast:31 row_mask:0xc bank_mask:0xf
    s_nop 0
    v_readlane_b32 s52, v4, 63
    s_nop 0
    s_add_u32 s53, s53, s52
    v_writelane_b32 v13, s53, 2
    v_subrev_u32 v48, s52, v48
    v_subrev_u32 v49, s52, v49
    v_max_u32 v4, v48, v49
    s_nop 1
    v_max_u32_dpp v4, v4, v4 row_shr:1 row_mask:0xf bank_mask:0xf bound_ctrl:0
    s_nop 1
    v_max_u32_dpp v4, v4, v4 row_shr:2 row_mask:0xf bank_mask:0xf bound_ctrl:0
    s_nop 1
    v_max_u32_dpp v4, v4, v4 row_shr:4 row_mask:0xf bank_mask:0xf bound_ctrl:0
    s_nop 1
    v_max_u32_dpp v4, v4, v4 row_shr:8 row_mask:0xf bank_mask:0xf bound_ctrl:0
    s_nop 1
    v_max_u32_dpp v4, v4, v4 row_bcast:15 row_mask:0xa bank_mask:0xf
    s_nop 1
    v_max_u32_dpp v4, v4, v4 row_bcast:31 row_mask:0xc bank_mask:0xf
    s_nop 0
    v_readlane_b32 s52, v4, 63
    s_nop 0
    s_add_u32 s53, s53, s52
    v_writelane_b32 v13, s53, 3
    v_subrev_u32 v48, s52, v48
    v_subrev_u32 v49, s52, v49
    v_max_u32 v4, v48, v49
    s_nop 1
    v_max_u32_dpp v4, v4, v4 row_shr:1 row_mask:0xf bank_mask:0xf bound_ctrl:0
    s_nop 1
    v_max_u32_dpp v4, v4, v4 row_shr:2 row_mask:0xf bank_mask:0xf bound_ctrl:0
    s_nop 1
    v_max_u32_dpp v4, v4, v4 row_shr:4 row_mask:0xf bank_mask:0xf bound_ctrl:0
    s_nop 1
    v_max_u32_dpp v4, v4, v4 row_shr:8 row_mask:0xf bank_mask:0xf bound_ctrl:0
    s_nop 1
    v_max_u32_dpp v4, v4, v4 row_bcast:15 row_mask:0xa bank_mask:0xf
    s_nop 1
    v_max_u32_dpp v4, v4, v4 row_bcast:31 row_mask:0xc bank_mask:0xf
    s_nop 0
    v_readlane_b32 s52, v4, 63
    s_nop 0
    s_add_u32 s53, s53, s52
    v_writelane_b32 v13, s53, 4
    v_subrev_u32 v48, s52, v48
    v_subrev_u32 v49, s52, v49
    v_max_u32 v4, v48, v49
    s_nop 1
    v_max_u32_dpp v4, v4, v4 row_shr:1 row_mask:0xf bank_mask:0xf bound_ctrl:0
    s_nop 1
    v_max_u32_dpp v4, v4, v4 row_shr:2 row_mask:0xf bank_mask:0xf bound_ctrl:0
    s_nop 1
    v_max_u32_dpp v4, v4, v4 row_shr:4 row_mask:0xf bank_mask:0xf bound_ctrl:0
    s_nop 1
    v_max_u32_dpp v4, v4, v4 row_shr:8 row_mask:0xf bank_mask:0xf bound_ctrl:0
    s_nop 1
    v_max_u32_dpp v4, v4, v4 row_bcast:15 row_mask:0xa bank_mask:0xf
    s_nop 1
    v_max_u32_dpp v4, v4, v4 row_bcast:31 row_mask:0xc bank_mask:0xf
    s_nop 0
    v_readlane_b32 s52, v4, 63
    s_nop 0
    s_add_u32 s53, s53, s52
    v_writelane_b32 v13, s53, 5
    v_subrev_u32 v48, s52, v48
    v_subrev_u32 v49, s52, v49
    v_max_u32 v4, v48, v49
    s_nop 1
    v_max_u32_dpp v4, v4, v4 row_shr:1 row_mask:0xf bank_mask:0xf bound_ctrl:0
    s_nop 1
    v_max_u32_dpp v4, v4, v4 row_shr:2 row_mask:0xf bank_mask:0xf bound_ctrl:0
    s_nop 1
    v_max_u32_dpp v4, v4, v4 row_shr:4 row_mask:0xf bank_mask:0xf bound_ctrl:0
    s_nop 1
    v_max_u32_dpp v4, v4, v4 row_shr:8 row_mask:0xf bank_mask:0xf bound_ctrl:0
    s_nop 1
    v_max_u32_dpp v4, v4, v4 row_bcast:15 row_mask:0xa bank_mask:0xf
    s_nop 1
    v_max_u32_dpp v4, v4, v4 row_bcast:31 row_mask:0xc bank_mask:0xf
    s_nop 0
    v_readlane_b32 s52, v4, 63
    s_nop 0
    s_add_u32 s53, s53, s52
    v_writelane_b32 v13, s53, 6
    v_subrev_u32 v48, s52, v48
    v_subrev_u32 v49, s52, v49
    v_max_u32 v4, v48, v49
    s_nop 1
    v_max_u32_dpp v4, v4, v4 row_shr:1 row_mask:0xf bank_mask:0xf bound_ctrl:0
    s_nop 1
    v_max_u32_dpp v4, v4, v4 row_shr:2 row_mask:0xf bank_mask:0xf bound_ctrl:0
    s_nop 1
    v_max_u32_dpp v4, v4, v4 row_shr:4 row_mask:0xf bank_mask:0xf bound_ctrl:0
    s_nop 1
    v_max_u32_dpp v4, v4, v4 row_shr:8 row_mask:0xf bank_mask:0xf bound_ctrl:0
    s_nop 1
    v_max_u32_dpp v4, v4, v4 row_bcast:15 row_mask:0xa bank_mask:0xf
    s_nop 1
    v_max_u32_dpp v4, v4, v4 row_bcast:31 row_mask:0xc bank_mask:0xf
    s_nop 0
    v_readlane_b32 s52, v4, 63
    s_nop 0
    s_add_u32 s53, s53, s52
    v_writelane_b32 v13, s53, 7
    v_cmp_lt_u32 vcc, s53, v50
    s_cbranch_vccz F_a2k
    s_mov_b32 s53, 0
    s_mov_b32 s52, 0
    s_mov_b32 s64, 0
F_a2f:
    v_subrev_u32 v16, s52, v16
    v_subrev_u32 v17, s52, v17
    v_subrev_u32 v18, s52, v18
    v_subrev_u32 v19, s52, v19
    v_subrev_u32 v20, s52, v20
    v_subrev_u32 v21, s52, v21
    v_subrev_u32 v22, s52, v22
    v_subrev_u32 v23, s52, v23
    v_subrev_u32 v24, s52, v24
    v_subrev_u32 v25, s52, v25
    v_subrev_u32 v26, s52, v26
    v_subrev_u32 v27, s52, v27
    v_subrev_u32 v28, s52, v28
    v_subrev_u32 v29, s52, v29
    v_subrev_u32 v30, s52, v30
    v_subrev_u32 v31, s52, v31
    v_subrev_u32 v32, s52, v32
    v_subrev_u32 v33, s52, v33
    v_subrev_u32 v34, s52, v34
    v_subrev_u32 v35, s52, v35
    v_subrev_u32 v36, s52, v36
    v_subrev_u32 v37, s52, v37
    v_subrev_u32 v38, s52, v38
    v_subrev_u32 v39, s52, v39
    v_subrev_u32 v40, s52, v40
    v_subrev_u32 v41, s52, v41
    v_subrev_u32 v42, s52, v42
    v_subrev_u32 v43, s52, v43
    v_subrev_u32 v44, s52, v44
    v_subrev_u32 v45, s52, v45
    v_subrev_u32 v46, s52, v46
    v_subrev_u32 v47, s52, v47
    v_max3_u32 v4, v16, v17, v18
    v_max3_u32 v12, v19, v20, v21
    v_max3_u32 v4, v4, v22, v23
    v_max3_u32 v12, v12, v24, v25
    v_max3_u32 v4, v4, v26, v27
    v_max3_u32 v12, v12, v28, v29
    v_max3_u32 v4, v4, v30, v31
    v_max3_u32 v12, v12, v32, v33
    v_max3_u32 v4, v4, v34, v35
    v_max3_u32 v12, v12, v36, v37
    v_max3_u32 v4, v4, v38, v39
    v_max3_u32 v12, v12, v40, v41
    v_max3_u32 v4, v4, v42, v43
    v_max3_u32 v12, v12, v44, v45
    v_max3_u32 v4, v4, v46, v47
    v_max_u32 v4, v4, v12
    s_nop 1
    v_max_u32_dpp v4, v4, v4 row_shr:1 row_mask:0xf bank_mask:0xf bound_ctrl:0
    s_nop 1
    v_max_u32_dpp v4, v4, v4 row_shr:2 row_mask:0xf bank_mask:0xf bound_ctrl:0
    s_nop 1
    v_max_u32_dpp v4, v4, v4 row_shr:4 row_mask:0xf bank_mask:0xf bound_ctrl:0
    s_nop 1
    v_max_u32_dpp v4, v4, v4 row_shr:8 row_mask:0xf bank_mask:0xf bound_ctrl:0
    s_nop 1
    v_max_u32_dpp v4, v4, v4 row_bcast:15 row_mask:0xa bank_mask:0xf
    s_nop 1
    v_max_u32_dpp v4, v4, v4 row_bcast:31 row_mask:0xc bank_mask:0xf
    s_nop 0
    v_readlane_b32 s52, v4, 63
    s_nop 0
    s_add_u32 s53, s53, s52
    s_mov_b32 m0, s64
    v_writelane_b32 v13, s53, m0
    s_cmp_ge_u32 s74, 17
    s_cbranch_scc1 DB_114
    s_barrier
    s_add_u32 s74, s74, 1
DB_114:
    s_add_u32 s64, s64, 1
    s_cmp_lt_u32 s64, 8
    s_cbranch_scc1 F_a2f
F_a2k:
    v_and_b32 v4, 7, v0
    v_lshlrev_b32 v4, 2, v4
    ds_bpermute_b32 v12, v4, v13
    v_lshrrev_b32 v9, 3, v0
    v_lshl_add_u32 v4, v9, 9, v4
    s_mov_b32 s44, 32896
    s_mov_b32 s45, 36992
    s_waitcnt lgkmcnt(0)
    v_or_b32 v12, 0x8000, v12
    buffer_store_dword v12, v4, s[40:43], s44 offen sc0 sc1
    buffer_store_dword v12, v4, s[40:43], s45 offen sc0 sc1

F_a2m:
    s_cmp_ge_u32 s74, 17
    s_cbranch_scc1 DB_115
    s_barrier
    s_add_u32 s74, s74, 1
DB_115:
    s_cmp_lt_u32 s74, 17
    s_cbranch_scc1 F_a2m
    s_add_u32 s91, s54, 0
    s_nop 0
    buffer_load_dwordx4 v[72:75], v6, s[16:19], s91 offen nt
    s_add_u32 s91, s54, 7168
    buffer_load_dwordx4 v[76:79], v6, s[16:19], s91 offen nt
    s_add_u32 s91, s54, 14336
    buffer_load_dwordx4 v[80:83], v6, s[16:19], s91 offen nt
    s_add_u32 s91, s54, 21504
    buffer_load_dwordx4 v[84:87], v6, s[16:19], s91 offen nt
    s_add_u32 s91, s54, 28672
    buffer_load_dwordx4 v[88:91], v6, s[16:19], s91 offen nt
    s_add_u32 s91, s54, 35840
    buffer_load_dwordx4 v[92:95], v6, s[16:19], s91 offen nt
    s_add_u32 s91, s54, 43008
    buffer_load_dwordx4 v[96:99], v6, s[16:19], s91 offen nt
    s_add_u32 s91, s54, 50176
    buffer_load_dwordx4 v[100:103], v6, s[16:19], s91 offen nt
    s_add_u32 s91, s54, 229376
    buffer_load_dwordx4 v[104:107], v6, s[16:19], s91 offen nt
    s_add_u32 s91, s54, 236544
    buffer_load_dwordx4 v[108:111], v6, s[16:19], s91 offen nt
    s_add_u32 s91, s54, 243712
    buffer_load_dwordx4 v[112:115], v6, s[16:19], s91 offen nt
    s_add_u32 s91, s54, 250880
    buffer_load_dwordx4 v[116:119], v6, s[16:19], s91 offen nt
    s_add_u32 s91, s54, 258048
    buffer_load_dwordx4 v[120:123], v6, s[16:19], s91 offen nt
    s_add_u32 s91, s54, 265216
    buffer_load_dwordx4 v[124:127], v6, s[16:19], s91 offen nt
    s_add_u32 s91, s54, 272384
    buffer_load_dwordx4 v[128:131], v6, s[16:19], s91 offen nt
    s_add_u32 s91, s54, 279552
    buffer_load_dwordx4 v[132:135], v6, s[16:19], s91 offen nt
    s_branch F_aj2
IW_w10:
    s_branch IW_r10
F_a2n:
    s_barrier
    s_cmp_lg_u32 s53, 0
    s_cbranch_scc1 SW_116
    s_call_b64 s[34:35], F_sw0
SW_116:
    s_branch IW_w11
IW_r11:
    s_barrier
    s_cmp_lg_u32 s53, 1
    s_cbranch_scc1 SW_117
    s_call_b64 s[34:35], F_sw0
SW_117:
    s_nop 0
    s_barrier
    s_cmp_lg_u32 s53, 2
    s_cbranch_scc1 SW_118
    s_call_b64 s[34:35], F_sw0
SW_118:
    s_nop 0
    s_barrier
    s_cmp_lg_u32 s53, 3
    s_cbranch_scc1 SW_119
    s_call_b64 s[34:35], F_sw0
SW_119:
    s_nop 0
    s_barrier
    s_nop 0
    s_barrier
    s_nop 0
    s_barrier
    s_nop 0
    s_add_u32 s91, s54, 229376
    buffer_load_dwordx4 v[104:107], v6, s[16:19], s91 offen nt
    s_add_u32 s91, s54, 236544
    buffer_load_dwordx4 v[108:111], v6, s[16:19], s91 offen nt
    s_add_u32 s91, s54, 243712
    buffer_load_dwordx4 v[112:115], v6, s[16:19], s91 offen nt
    s_add_u32 s91, s54, 250880
    buffer_load_dwordx4 v[116:119], v6, s[16:19], s91 offen nt
    s_nop 0
    s_load_dwordx8 s[60:67], s[56:57], 128 glc
    s_barrier
    s_add_u32 s91, s54, 258048
    buffer_load_dwordx4 v[120:123], v6, s[16:19], s91 offen nt
    s_add_u32 s91, s54, 265216
    buffer_load_dwordx4 v[124:127], v6, s[16:19], s91 offen nt
    s_add_u32 s91, s54, 272384
    buffer_load_dwordx4 v[128:131], v6, s[16:19], s91 offen nt
    s_add_u32 s91, s54, 279552
    buffer_load_dwordx4 v[132:135], v6, s[16:19], s91 offen nt
    s_waitcnt lgkmcnt(0)
    s_and_b64 s[44:45], s[60:61], s[62:63]
    s_and_b64 s[44:45], s[44:45], s[64:65]
    s_and_b64 s[44:45], s[44:45], s[66:67]
    s_and_b32 s44, s44, s45
    s_bitcmp1_b32 s44, 15
    s_cbranch_scc0 F_a2q
    s_nop 0
    s_andn2_b32 s60, s60, 0x8000
    v_writelane_b32 v12, s60, 0
    s_andn2_b32 s61, s61, 0x8000
    v_writelane_b32 v12, s61, 1
    s_andn2_b32 s62, s62, 0x8000
    v_writelane_b32 v12, s62, 2
    s_andn2_b32 s63, s63, 0x8000
    v_writelane_b32 v12, s63, 3
    s_andn2_b32 s64, s64, 0x8000
    v_writelane_b32 v12, s64, 4
    s_andn2_b32 s65, s65, 0x8000
    v_writelane_b32 v12, s65, 5
    s_andn2_b32 s66, s66, 0x8000
    v_writelane_b32 v12, s66, 6
    s_andn2_b32 s67, s67, 0x8000
    v_writelane_b32 v12, s67, 7
    v_add_u32 v4, 158976, v3
    s_mov_b64 exec, 0xff
    ds_write_b32 v4, v12
    s_mov_b64 exec, -1
    v_mov_b32 v4, 1
    s_mov_b64 exec, 1
    ds_write_b32 v10, v4 offset:48
    s_mov_b64 exec, -1
    s_waitcnt lgkmcnt(0)
    s_mov_b32 s88, 1
F_a2q:
    s_barrier
F_aj:
    s_mov_b32 s74, 0
F_aj2:
    v_and_b32 v13, 3, v0
    v_lshlrev_b32 v13, 2, v13
    v_add_u32 v13, 159040, v13

    s_cmp_lt_u32 s3, 2
    s_mov_b32 s75, 114688
    s_cselect_b32 s75, 81920, s75
    s_and_b32 s44, s3, 1
    s_lshl_b32 s44, s44, 12
    s_add_u32 s75, s75, s44
    s_add_u32 s12, s72, 0x900000
    s_addc_u32 s13, s73, 0
    s_mov_b32 s14, 0xe0000
    s_mov_b32 s15, 0x00020000
    s_mov_b32 s47, s10
    v_mov_b32 v4, 159096
    ds_read_b32 v9, v4
    s_waitcnt lgkmcnt(0)
    v_readfirstlane_b32 s79, v9
    s_nop 0
    s_cmp_eq_u32 s79, 0
    s_cbranch_scc1 F_xe
    v_and_b32 v4, 7, v0
    v_lshlrev_b32 v4, 2, v4
    v_add_u32 v4, 158976, v4
    ds_read_b32 v4, v4
    s_waitcnt lgkmcnt(0)
    v_and_b32 v4, 0x7ff, v4
    v_sub_u32 v4, 2047, v4
    v_and_b32 v11, 7, v4
    v_lshrrev_b32 v9, 3, v4
    v_lshlrev_b32 v9, 7, v9
    v_lshl_add_u32 v9, v11, 3, v9
    v_lshlrev_b32 v4, 11, v4
    v_lshl_add_u32 v4, v5, 4, v4
    buffer_load_dwordx4 v[64:67], v4, s[20:23], s55 offen
    buffer_load_dwordx4 v[68:71], v4, s[20:23], s55 offen offset:64
    buffer_load_dwordx2 v[14:15], v9, s[40:43], 0 offen sc0 sc1

F_xe:
    s_cmp_lg_u32 s74, 0
    s_cbranch_scc1 JB_120
    s_barrier
JB_120:
    s_cmp_lg_u32 s88, 3
    s_cbranch_scc1 F_g4
SP_121:
    s_load_dword s76, s[56:57], 0 glc
    s_waitcnt lgkmcnt(0)
    s_cmp_ge_u32 s76, 1000
    s_cbranch_scc1 SD_122
    s_sleep 3
    s_branch SP_121
SD_122:
    v_mov_b32 v4, 1
    s_mov_b64 exec, 1
    ds_write_b32 v10, v4 offset:48
    s_mov_b64 exec, -1
F_g4:
    s_setprio 1
    s_cmp_lg_u32 s79, 0
    s_cbranch_scc1 F_xd
    s_cmp_lg_u32 s88, 2
    s_cbranch_scc1 F_se
F_sc:
    s_load_dwordx8 s[60:67], s[56:57], 128 glc
    s_waitcnt lgkmcnt(0)
    s_and_b64 s[44:45], s[60:61], s[62:63]
    s_and_b64 s[44:45], s[44:45], s[64:65]
    s_and_b64 s[44:45], s[44:45], s[66:67]
    s_and_b32 s44, s44, s45
    s_bitcmp1_b32 s44, 15
    s_cbranch_scc1 F_sd
    s_sleep 4
    s_branch F_sc
F_sd:
    s_andn2_b32 s60, s60, 0x8000
    v_writelane_b32 v12, s60, 0
    s_andn2_b32 s61, s61, 0x8000
    v_writelane_b32 v12, s61, 1
    s_andn2_b32 s62, s62, 0x8000
    v_writelane_b32 v12, s62, 2
    s_andn2_b32 s63, s63, 0x8000
    v_writelane_b32 v12, s63, 3
    s_andn2_b32 s64, s64, 0x8000
    v_writelane_b32 v12, s64, 4
    s_andn2_b32 s65, s65, 0x8000
    v_writelane_b32 v12, s65, 5
    s_andn2_b32 s66, s66, 0x8000
    v_writelane_b32 v12, s66, 6
    s_andn2_b32 s67, s67, 0x8000
    v_writelane_b32 v12, s67, 7
    v_add_u32 v4, 158976, v3
    s_mov_b64 exec, 0xff
    ds_write_b32 v4, v12
    s_mov_b64 exec, -1
    v_mov_b32 v4, 1
    s_mov_b64 exec, 1
    ds_write_b32 v10, v4 offset:48
    s_mov_b64 exec, -1
F_se:
    v_mov_b32 v4, 159096
    ds_read_b32 v9, v4 offset:0
FW_123:
    s_waitcnt lgkmcnt(0)
    v_cmp_gt_u32 vcc, 1, v9
    s_cbranch_vccz FO_124
    s_sleep 1
    ds_read_b32 v9, v4 offset:0
    s_branch FW_123
FO_124:
    v_and_b32 v4, 7, v0
    v_lshlrev_b32 v4, 2, v4
    v_add_u32 v4, 158976, v4
    ds_read_b32 v4, v4
    s_waitcnt lgkmcnt(0)
    v_and_b32 v4, 0x7ff, v4
    v_sub_u32 v4, 2047, v4
    v_and_b32 v11, 7, v4
    v_lshrrev_b32 v9, 3, v4
    v_lshlrev_b32 v9, 7, v9
    v_lshl_add_u32 v9, v11, 3, v9
    v_lshlrev_b32 v4, 11, v4
    v_lshl_add_u32 v4, v5, 4, v4
    buffer_load_dwordx4 v[64:67], v4, s[20:23], s55 offen
    buffer_load_dwordx4 v[68:71], v4, s[20:23], s55 offen offset:64
    buffer_load_dwordx2 v[14:15], v9, s[40:43], 0 offen sc0 sc1

F_xd:
    s_mov_b32 s52, 0x05040100
    s_mov_b32 s53, 0x07060302
    s_setprio 1
    s_cmp_ge_u32 s89, 224
    s_cbranch_scc1 F_adown
    s_waitcnt vmcnt(0)
    v_lshlrev_b32 v34, 16, v64
    v_and_b32 v35, 0xffff0000, v64
    v_lshlrev_b32 v36, 16, v65
    v_and_b32 v37, 0xffff0000, v65
    v_lshlrev_b32 v38, 16, v66
    v_and_b32 v39, 0xffff0000, v66
    v_lshlrev_b32 v40, 16, v67
    v_and_b32 v41, 0xffff0000, v67
    v_lshlrev_b32 v42, 16, v68
    v_and_b32 v43, 0xffff0000, v68
    v_lshlrev_b32 v44, 16, v69
    v_and_b32 v45, 0xffff0000, v69
    v_lshlrev_b32 v46, 16, v70
    v_and_b32 v47, 0xffff0000, v70
    v_lshlrev_b32 v48, 16, v71
    v_and_b32 v49, 0xffff0000, v71
    v_add_f32 v34, v34, v14
    v_add_f32 v35, v35, v14
    v_add_f32 v36, v36, v14
    v_add_f32 v37, v37, v14
    v_add_f32 v38, v38, v14
    v_add_f32 v39, v39, v14
    v_add_f32 v40, v40, v14
    v_add_f32 v41, v41, v14
    v_add_f32 v42, v42, v14
    v_add_f32 v43, v43, v14
    v_add_f32 v44, v44, v14
    v_add_f32 v45, v45, v14
    v_add_f32 v46, v46, v14
    v_add_f32 v47, v47, v14
    v_add_f32 v48, v48, v14
    v_add_f32_e64 v49, v49, v14
    v_cvt_pk_bf16_f32 v64, v34, v35
    v_cvt_pk_bf16_f32 v65, v36, v37
    v_cvt_pk_bf16_f32 v66, v38, v39
    v_cvt_pk_bf16_f32 v67, v40, v41
    v_cvt_pk_bf16_f32 v68, v42, v43
    v_cvt_pk_bf16_f32 v69, v44, v45
    v_cvt_pk_bf16_f32 v70, v46, v47
    v_cvt_pk_bf16_f32 v71, v48, v49
    v_lshlrev_b32 v34, 16, v64
    v_and_b32 v35, 0xffff0000, v64
    v_lshlrev_b32 v36, 16, v65
    v_and_b32 v37, 0xffff0000, v65
    v_lshlrev_b32 v38, 16, v66
    v_and_b32 v39, 0xffff0000, v66
    v_lshlrev_b32 v40, 16, v67
    v_and_b32 v41, 0xffff0000, v67
    v_lshlrev_b32 v42, 16, v68
    v_and_b32 v43, 0xffff0000, v68
    v_lshlrev_b32 v44, 16, v69
    v_and_b32 v45, 0xffff0000, v69
    v_lshlrev_b32 v46, 16, v70
    v_and_b32 v47, 0xffff0000, v70
    v_lshlrev_b32 v48, 16, v71
    v_and_b32 v49, 0xffff0000, v71
    v_mul_f32 v34, v34, v15
    v_mul_f32 v35, v35, v15
    v_mul_f32 v36, v36, v15
    v_mul_f32 v37, v37, v15
    v_mul_f32 v38, v38, v15
    v_mul_f32 v39, v39, v15
    v_mul_f32 v40, v40, v15
    v_mul_f32 v41, v41, v15
    v_mul_f32 v42, v42, v15
    v_mul_f32 v43, v43, v15
    v_mul_f32 v44, v44, v15
    v_mul_f32 v45, v45, v15
    v_mul_f32 v46, v46, v15
    v_mul_f32 v47, v47, v15
    v_mul_f32 v48, v48, v15
    v_mul_f32 v49, v49, v15
    v_cvt_pk_bf16_f32 v64, v34, v35
    v_cvt_pk_bf16_f32 v65, v36, v37
    v_cvt_pk_bf16_f32 v66, v38, v39
    v_cvt_pk_bf16_f32 v67, v40, v41
    v_cvt_pk_bf16_f32 v68, v42, v43
    v_cvt_pk_bf16_f32 v69, v44, v45
    v_cvt_pk_bf16_f32 v70, v46, v47
    v_cvt_pk_bf16_f32 v71, v48, v49
    s_waitcnt vmcnt(0)
    v_perm_b32 v136, v76, v72, s52
    v_perm_b32 v137, v84, v80, s52
    v_perm_b32 v138, v92, v88, s52
    v_perm_b32 v139, v100, v96, s52
    s_nop 1
    v_mfma_f32_16x16x32_bf16 v[32:35], v[64:67], v[136:139], 0
    v_perm_b32 v140, v76, v72, s53
    v_perm_b32 v141, v84, v80, s53
    v_perm_b32 v142, v92, v88, s53
    v_perm_b32 v143, v100, v96, s53
    s_nop 1
    v_mfma_f32_16x16x32_bf16 v[36:39], v[64:67], v[140:143], 0
    v_perm_b32 v136, v77, v73, s52
    v_perm_b32 v137, v85, v81, s52
    v_perm_b32 v138, v93, v89, s52
    v_perm_b32 v139, v101, v97, s52
    s_nop 1
    v_mfma_f32_16x16x32_bf16 v[40:43], v[64:67], v[136:139], 0
    v_perm_b32 v140, v77, v73, s53
    v_perm_b32 v141, v85, v81, s53
    v_perm_b32 v142, v93, v89, s53
    v_perm_b32 v143, v101, v97, s53
    s_nop 1
    v_mfma_f32_16x16x32_bf16 v[44:47], v[64:67], v[140:143], 0
    v_perm_b32 v136, v78, v74, s52
    v_perm_b32 v137, v86, v82, s52
    v_perm_b32 v138, v94, v90, s52
    v_perm_b32 v139, v102, v98, s52
    s_nop 1
    v_mfma_f32_16x16x32_bf16 v[48:51], v[64:67], v[136:139], 0
    v_perm_b32 v140, v78, v74, s53
    v_perm_b32 v141, v86, v82, s53
    v_perm_b32 v142, v94, v90, s53
    v_perm_b32 v143, v102, v98, s53
    s_nop 1
    v_mfma_f32_16x16x32_bf16 v[52:55], v[64:67], v[140:143], 0
    v_perm_b32 v136, v79, v75, s52
    v_perm_b32 v137, v87, v83, s52
    v_perm_b32 v138, v95, v91, s52
    v_perm_b32 v139, v103, v99, s52
    s_nop 1
    v_mfma_f32_16x16x32_bf16 v[56:59], v[64:67], v[136:139], 0
    v_perm_b32 v140, v79, v75, s53
    v_perm_b32 v141, v87, v83, s53
    v_perm_b32 v142, v95, v91, s53
    v_perm_b32 v143, v103, v99, s53
    s_nop 1
    v_mfma_f32_16x16x32_bf16 v[60:63], v[64:67], v[140:143], 0
    s_waitcnt vmcnt(0)
    v_perm_b32 v136, v108, v104, s52
    v_perm_b32 v137, v116, v112, s52
    v_perm_b32 v138, v124, v120, s52
    v_perm_b32 v139, v132, v128, s52
    s_nop 1
    v_mfma_f32_16x16x32_bf16 v[32:35], v[68:71], v[136:139], v[32:35]
    v_perm_b32 v140, v108, v104, s53
    v_perm_b32 v141, v116, v112, s53
    v_perm_b32 v142, v124, v120, s53
    v_perm_b32 v143, v132, v128, s53
    s_nop 1
    v_mfma_f32_16x16x32_bf16 v[36:39], v[68:71], v[140:143], v[36:39]
    v_perm_b32 v136, v109, v105, s52
    v_perm_b32 v137, v117, v113, s52
    v_perm_b32 v138, v125, v121, s52
    v_perm_b32 v139, v133, v129, s52
    s_nop 1
    v_mfma_f32_16x16x32_bf16 v[40:43], v[68:71], v[136:139], v[40:43]
    v_perm_b32 v140, v109, v105, s53
    v_perm_b32 v141, v117, v113, s53
    v_perm_b32 v142, v125, v121, s53
    v_perm_b32 v143, v133, v129, s53
    s_nop 1
    v_mfma_f32_16x16x32_bf16 v[44:47], v[68:71], v[140:143], v[44:47]
    v_perm_b32 v136, v110, v106, s52
    v_perm_b32 v137, v118, v114, s52
    v_perm_b32 v138, v126, v122, s52
    v_perm_b32 v139, v134, v130, s52
    s_nop 1
    v_mfma_f32_16x16x32_bf16 v[48:51], v[68:71], v[136:139], v[48:51]
    v_perm_b32 v140, v110, v106, s53
    v_perm_b32 v141, v118, v114, s53
    v_perm_b32 v142, v126, v122, s53
    v_perm_b32 v143, v134, v130, s53
    s_nop 1
    v_mfma_f32_16x16x32_bf16 v[52:55], v[68:71], v[140:143], v[52:55]
    v_perm_b32 v136, v111, v107, s52
    v_perm_b32 v137, v119, v115, s52
    v_perm_b32 v138, v127, v123, s52
    v_perm_b32 v139, v135, v131, s52
    s_nop 1
    v_mfma_f32_16x16x32_bf16 v[56:59], v[68:71], v[136:139], v[56:59]
    v_perm_b32 v140, v111, v107, s53
    v_perm_b32 v141, v119, v115, s53
    v_perm_b32 v142, v127, v123, s53
    v_perm_b32 v143, v135, v131, s53
    s_nop 1
    v_mfma_f32_16x16x32_bf16 v[60:63], v[68:71], v[140:143], v[60:63]
    s_setprio 3
    s_and_b32 s44, s3, 1
    s_lshl_b32 s44, s44, 12
    s_add_u32 s44, s44, 114688
    v_xor_b32 v4, v7, v5
    v_lshlrev_b32 v4, 4, v4
    v_lshl_add_u32 v4, v5, 8, v4
    v_add_u32 v72, s44, v4
    v_add_u32 v8, 8, v10

    v_xor_b32 v73, 32, v72
    v_xor_b32 v74, 64, v72
    v_xor_b32 v75, 96, v72
    v_xor_b32 v76, 128, v72
    v_xor_b32 v77, 160, v72
    v_xor_b32 v78, 192, v72
    v_xor_b32 v79, 224, v72
    ds_read_b32 v12, v13 offset:32
FW_125:
    s_waitcnt lgkmcnt(0)
    v_cmp_gt_u32 vcc, 2, v12
    s_cbranch_vccz FO_126
    s_sleep 1
    ds_read_b32 v12, v13 offset:32
    s_branch FW_125
FO_126:
    s_add_u32 s45, s78, 0
    s_nop 0
    buffer_load_dwordx4 v[16:19], v160, s[80:83], s45 offen nt
    s_add_u32 s45, s78, 2048
    buffer_load_dwordx4 v[20:23], v160, s[80:83], s45 offen nt
    s_add_u32 s45, s78, 4096
    s_branch IW_s11
IW_w11:
    s_branch IW_r11
IW_s11:
    buffer_load_dwordx4 v[24:27], v160, s[80:83], s45 offen nt
    s_add_u32 s45, s78, 6144
    buffer_load_dwordx4 v[28:31], v160, s[80:83], s45 offen nt
    s_add_u32 s45, s78, 8192
    buffer_load_dwordx4 v[144:147], v160, s[80:83], s45 offen nt
    s_add_u32 s45, s78, 10240
    buffer_load_dwordx4 v[148:151], v160, s[80:83], s45 offen nt
    s_add_u32 s45, s78, 12288
    buffer_load_dwordx4 v[152:155], v160, s[80:83], s45 offen nt
    s_cmp_lt_u32 s3, 2
    s_cbranch_scc1 F_t1
    ds_read_b32 v12, v13 offset:32
FW_127:
    s_waitcnt lgkmcnt(0)
    v_cmp_gt_u32 vcc, 2, v12
    s_cbranch_vccz FO_128
    s_sleep 1
    ds_read_b32 v12, v13 offset:32
    s_branch FW_127
FO_128:
    s_branch F_t2
F_t1:
    ds_read_b32 v12, v8 offset:64
FW_129:
    s_waitcnt lgkmcnt(0)
    v_cmp_gt_u32 vcc, 1, v12
    s_cbranch_vccz FO_130
    s_sleep 1
    ds_read_b32 v12, v8 offset:64
    s_branch FW_129
FO_130:
    s_nop 0
    ds_read_b128 v[80:83], v72 offset:0
    ds_read_b128 v[84:87], v73 offset:512
    ds_read_b128 v[88:91], v74 offset:1024
    ds_read_b128 v[92:95], v75 offset:1536
    ds_read_b128 v[96:99], v76 offset:2048
    ds_read_b128 v[100:103], v77 offset:2560
    ds_read_b128 v[104:107], v78 offset:3072
    ds_read_b128 v[108:111], v79 offset:3584
    s_waitcnt lgkmcnt(7)
    v_add_f32 v32, v32, v80
    v_add_f32 v33, v33, v81
    v_add_f32 v34, v34, v82
    v_add_f32 v35, v35, v83
    s_waitcnt lgkmcnt(6)
    v_add_f32 v36, v36, v84
    v_add_f32 v37, v37, v85
    v_add_f32 v38, v38, v86
    v_add_f32 v39, v39, v87
    s_waitcnt lgkmcnt(5)
    v_add_f32 v40, v40, v88
    v_add_f32 v41, v41, v89
    v_add_f32 v42, v42, v90
    v_add_f32 v43, v43, v91
    s_waitcnt lgkmcnt(4)
    v_add_f32 v44, v44, v92
    v_add_f32 v45, v45, v93
    v_add_f32 v46, v46, v94
    v_add_f32 v47, v47, v95
    s_waitcnt lgkmcnt(3)
    v_add_f32 v48, v48, v96
    v_add_f32 v49, v49, v97
    v_add_f32 v50, v50, v98
    v_add_f32 v51, v51, v99
    s_waitcnt lgkmcnt(2)
    v_add_f32 v52, v52, v100
    v_add_f32 v53, v53, v101
    v_add_f32 v54, v54, v102
    v_add_f32 v55, v55, v103
    s_waitcnt lgkmcnt(1)
    v_add_f32 v56, v56, v104
    v_add_f32 v57, v57, v105
    v_add_f32 v58, v58, v106
    v_add_f32 v59, v59, v107
    s_waitcnt lgkmcnt(0)
    v_add_f32 v60, v60, v108
    v_add_f32 v61, v61, v109
    v_add_f32 v62, v62, v110
    v_add_f32 v63, v63, v111
F_t2:
    s_mov_b32 exec_hi, 0
    s_nop 0
    ds_write_b128 v72, v[32:35] offset:0
    ds_write_b128 v73, v[36:39] offset:512
    ds_write_b128 v74, v[40:43] offset:1024
    ds_write_b128 v75, v[44:47] offset:1536
    ds_write_b128 v76, v[48:51] offset:2048
    ds_write_b128 v77, v[52:55] offset:2560
    ds_write_b128 v78, v[56:59] offset:3072
    ds_write_b128 v79, v[60:63] offset:3584
    s_mov_b64 exec, -1
    v_mov_b32 v4, 1
    s_mov_b64 exec, 1
    ds_write_b32 v10, v4 offset:64
    s_mov_b64 exec, -1
    s_lshl_b32 s44, s3, 2
    v_add_u32 v4, s44, v5
    v_xor_b32 v4, v4, v7
    v_lshlrev_b32 v4, 4, v4
    v_lshl_add_u32 v4, v7, 8, v4
    v_add_u32 v4, 114688, v4
    s_lshl_b32 s44, s3, 10
    s_lshl_b32 s77, s36, 1
    s_add_u32 s77, s77, s37
    s_mul_i32 s77, s77, 114688
    s_lshl_b32 s46, s38, 12
    s_add_u32 s77, s77, s46
    s_add_u32 s77, s77, s44
    s_lshl_b32 s46, s38, 9
    v_mov_b32 v9, 159148
    v_mov_b32 v11, 1

    s_add_u32 s56, s46, 0x829000
    s_add_u32 s56, s72, s56
    s_addc_u32 s57, s73, 0
    ds_read_b32 v12, v13 offset:64
FW_131:
    s_waitcnt lgkmcnt(0)
    v_cmp_gt_u32 vcc, 1, v12
    s_cbranch_vccz FO_132
    ds_read_b32 v12, v13 offset:64
    s_branch FW_131
FO_132:
    ds_read_b128 v[72:75], v4
    ds_read_b128 v[76:79], v4 offset:4096
    s_waitcnt lgkmcnt(0)
    v_add_f32 v72, v72, v76
    v_add_f32 v73, v73, v77
    v_add_f32 v74, v74, v78
    v_add_f32 v75, v75, v79
    buffer_store_dwordx4 v[72:75], v2, s[12:15], s77 offen sc0 sc1
    v_mov_b32 v4, 2
    s_mov_b64 exec, 1
    ds_write_b32 v10, v4 offset:64
    s_mov_b64 exec, -1
    s_waitcnt vmcnt(0)
    s_mov_b64 exec, 1
    ds_add_rtn_u32 v9, v9, v11
    s_waitcnt lgkmcnt(0)
    v_readfirstlane_b32 s44, v9
    s_mov_b64 exec, -1
    s_cmp_lg_u32 s44, 3
    s_cbranch_scc1 F_ad2

    s_mov_b32 s74, 1
    s_atomic_add s74, s[56:57], 0x0
    s_atomic_add s74, s[56:57], 0x80
    s_atomic_add s74, s[56:57], 0x100
    s_atomic_add s74, s[56:57], 0x180
    s_branch F_ad2
F_adown:
    s_add_u32 s45, s78, 0
    buffer_load_dwordx4 v[16:19], v160, s[80:83], s45 offen nt
    s_add_u32 s45, s78, 2048
    buffer_load_dwordx4 v[20:23], v160, s[80:83], s45 offen nt
    s_add_u32 s45, s78, 4096
    buffer_load_dwordx4 v[24:27], v160, s[80:83], s45 offen nt
    s_add_u32 s45, s78, 6144
    buffer_load_dwordx4 v[28:31], v160, s[80:83], s45 offen nt
    s_add_u32 s45, s78, 8192
    buffer_load_dwordx4 v[144:147], v160, s[80:83], s45 offen nt
    s_add_u32 s45, s78, 10240
    buffer_load_dwordx4 v[148:151], v160, s[80:83], s45 offen nt
    s_add_u32 s45, s78, 12288
    buffer_load_dwordx4 v[152:155], v160, s[80:83], s45 offen nt
    v_mov_b32 v4, 2
    s_mov_b64 exec, 1
    ds_write_b32 v10, v4 offset:64
    s_mov_b64 exec, -1
F_ad2:
    s_setprio 3
    v_min_u32 v4, 55, v0
    v_lshlrev_b32 v4, 4, v4
    s_lshl_b32 s38, s47, 5
    s_and_b32 s46, s39, 3
    s_lshr_b32 s44, s47, 7
    s_lshl_b32 s44, s44, 2
    s_add_u32 s44, s44, s46
    s_lshl_b32 s44, s44, 7
    s_add_u32 s45, s47, 111
    s_lshr_b32 s45, s45, 7
    s_lshl_b32 s45, s45, 2
    s_add_u32 s45, s45, s46
    s_lshl_b32 s45, s45, 7
    s_waitcnt lgkmcnt(0)

    s_add_u32 s56, s44, 0x829000
    s_add_u32 s56, s72, s56
    s_addc_u32 s57, s73, 0
    s_add_u32 s58, s45, 0x829000
    s_add_u32 s58, s72, s58
    s_addc_u32 s59, s73, 0
    v_mov_b32 v156, 0
    v_mov_b32 v157, 0
    v_mov_b32 v158, 0
    v_mov_b32 v159, 0
    s_mov_b32 s48, 0xbfb8aa3b
    ds_read_b32 v12, v13 offset:0
FW_133:
    s_waitcnt lgkmcnt(0)
    v_cmp_gt_u32 vcc, 4, v12
    s_cbranch_vccz FO_134
    s_sleep 1
    ds_read_b32 v12, v13 offset:0
    s_branch FW_133
FO_134:
    ds_read_b32 v12, v13 offset:64
FW_135:
    s_waitcnt lgkmcnt(0)
    v_cmp_gt_u32 vcc, 2, v12
    s_cbranch_vccz FO_136
    s_sleep 1
    ds_read_b32 v12, v13 offset:64
    s_branch FW_135
FO_136:
    ds_read_b32 v12, v13 offset:32
FW_137:
    s_waitcnt lgkmcnt(0)
    v_cmp_gt_u32 vcc, 2, v12
    s_cbranch_vccz FO_138
    s_sleep 1
    ds_read_b32 v12, v13 offset:32
    s_branch FW_137
FO_138:
    s_mov_b32 s44, s75
    v_lshlrev_b32 v9, 3, v0
    v_add_u32 v9, s44, v9
    ds_write_b64 v9, v[156:157]
    v_lshrrev_b32 v11, 1, v0
    v_mul_u32_u24 v9, 37, v11
    v_lshrrev_b32 v9, 8, v9
    v_add_u32 v11, v11, v9
    v_lshlrev_b32 v11, 1, v11
    v_and_b32 v9, 1, v0
    v_lshl_add_u32 v11, v9, 8, v11
    v_add_u32 v11, s44, v11
    v_and_b32 v9, 7, v0
    v_lshlrev_b32 v9, 6, v9
    v_lshl_add_u32 v9, v5, 4, v9
    v_add_u32 v9, s44, v9

    s_cmp_lg_u32 s3, 0
    s_cbranch_scc1 F_pp
SP_139:
    s_load_dword s76, s[56:57], 0 glc
    s_waitcnt lgkmcnt(0)
    s_cmp_ge_u32 s76, 8
    s_cbranch_scc1 SD_140
    s_sleep 2
    s_branch SP_139
SD_140:
SP_141:
    s_load_dword s76, s[58:59], 0 glc
    s_waitcnt lgkmcnt(0)
    s_cmp_ge_u32 s76, 8
    s_cbranch_scc1 SD_142
    s_sleep 2
    s_branch SP_141
SD_142:
    v_mov_b32 v12, 3
    s_mov_b64 exec, 1
    ds_write_b32 v10, v12 offset:64
    s_mov_b64 exec, -1
F_pp:
    v_mov_b32 v8, 159104
    ds_read_b32 v12, v8 offset:0
FW_143:
    s_waitcnt lgkmcnt(0)
    v_cmp_gt_u32 vcc, 3, v12
    s_cbranch_vccz FO_144
    s_sleep 1
    ds_read_b32 v12, v8 offset:0
    s_branch FW_143
FO_144:
    s_add_u32 s45, s38, 0
    buffer_load_dwordx4 v[32:35], v4, s[12:15], s45 offen sc0 sc1
    s_add_u32 s45, s38, 114688
    buffer_load_dwordx4 v[36:39], v4, s[12:15], s45 offen sc0 sc1
    s_add_u32 s45, s38, 229376
    buffer_load_dwordx4 v[40:43], v4, s[12:15], s45 offen sc0 sc1
    s_add_u32 s45, s38, 344064
    buffer_load_dwordx4 v[44:47], v4, s[12:15], s45 offen sc0 sc1
    s_add_u32 s45, s38, 458752
    buffer_load_dwordx4 v[48:51], v4, s[12:15], s45 offen sc0 sc1
    s_add_u32 s45, s38, 573440
    buffer_load_dwordx4 v[52:55], v4, s[12:15], s45 offen sc0 sc1
    s_add_u32 s45, s38, 688128
    buffer_load_dwordx4 v[56:59], v4, s[12:15], s45 offen sc0 sc1
    s_add_u32 s45, s38, 802816
    buffer_load_dwordx4 v[60:63], v4, s[12:15], s45 offen sc0 sc1
    s_waitcnt vmcnt(0)
    v_add_f32 v32, v32, v40
    v_add_f32 v48, v48, v56
    v_add_f32 v33, v33, v41
    v_add_f32 v49, v49, v57
    v_add_f32 v34, v34, v42
    v_add_f32 v50, v50, v58
    v_add_f32 v35, v35, v43
    v_add_f32 v51, v51, v59
    v_add_f32 v32, v32, v48
    v_add_f32 v33, v33, v49
    v_add_f32 v34, v34, v50
    v_add_f32 v35, v35, v51
    v_add_f32 v36, v36, v44
    v_add_f32 v52, v52, v60
    v_add_f32 v37, v37, v45
    v_add_f32 v53, v53, v61
    v_add_f32 v38, v38, v46
    v_add_f32 v54, v54, v62
    v_add_f32 v39, v39, v47
    v_add_f32 v55, v55, v63
    v_add_f32 v36, v36, v52
    v_add_f32 v37, v37, v53
    v_add_f32 v38, v38, v54
    v_add_f32 v39, v39, v55
    v_cvt_pk_bf16_f32 v40, v32, v36
    v_cvt_pk_bf16_f32 v41, v33, v37
    v_cvt_pk_bf16_f32 v42, v34, v38
    v_cvt_pk_bf16_f32 v43, v35, v39
    v_lshlrev_b32 v32, 16, v40
    v_and_b32 v36, 0xffff0000, v40
    v_lshlrev_b32 v33, 16, v41
    v_and_b32 v37, 0xffff0000, v41
    v_lshlrev_b32 v34, 16, v42
    v_and_b32 v38, 0xffff0000, v42
    v_lshlrev_b32 v35, 16, v43
    v_and_b32 v39, 0xffff0000, v43
    v_mul_f32 v40, s48, v32
    v_mul_f32 v41, s48, v33
    v_mul_f32 v42, s48, v34
    v_mul_f32 v43, s48, v35
    v_exp_f32 v40, v40
    v_exp_f32 v41, v41
    v_exp_f32 v42, v42
    v_exp_f32 v43, v43
    v_add_f32 v40, 1.0, v40
    v_add_f32 v41, 1.0, v41
    v_add_f32 v42, 1.0, v42
    v_add_f32 v43, 1.0, v43
    v_rcp_f32 v40, v40
    v_rcp_f32 v41, v41
    v_rcp_f32 v42, v42
    v_rcp_f32 v43, v43
    v_mul_f32 v32, v32, v40
    v_mul_f32 v33, v33, v41
    v_mul_f32 v34, v34, v42
    v_mul_f32 v35, v35, v43
    v_cvt_pk_bf16_f32 v32, v32, v32
    v_cvt_pk_bf16_f32 v33, v33, v33
    v_cvt_pk_bf16_f32 v34, v34, v34
    v_cvt_pk_bf16_f32 v35, v35, v35
    v_lshlrev_b32 v32, 16, v32
    v_lshlrev_b32 v33, 16, v33
    v_lshlrev_b32 v34, 16, v34
    v_lshlrev_b32 v35, 16, v35
    v_mul_f32 v32, v32, v36
    v_mul_f32 v33, v33, v37
    v_mul_f32 v34, v34, v38
    v_mul_f32 v35, v35, v39
    v_cvt_pk_bf16_f32 v32, v32, v32
    v_cvt_pk_bf16_f32 v33, v33, v33
    v_cvt_pk_bf16_f32 v34, v34, v34
    v_cvt_pk_bf16_f32 v35, v35, v35
    v_cmp_gt_u32 vcc, 56, v0
    s_nop 0
    s_and_saveexec_b64 s[44:45], vcc
    ds_write_b16 v11, v32 offset:0
    ds_write_b16 v11, v33 offset:64
    ds_write_b16 v11, v34 offset:128
    ds_write_b16 v11, v35 offset:192
    s_mov_b64 exec, s[44:45]
    ds_read_b128 v[64:67], v9
    s_waitcnt lgkmcnt(0)
    v_perm_b32 v136, v20, v16, s52
    v_perm_b32 v137, v28, v24, s52
    v_perm_b32 v138, v148, v144, s52
    v_perm_b32 v139, v156, v152, s52
    s_nop 1
    v_mfma_f32_16x16x32_bf16 v[104:107], v[64:67], v[136:139], 0
    v_perm_b32 v140, v20, v16, s53
    v_perm_b32 v141, v28, v24, s53
    v_perm_b32 v142, v148, v144, s53
    v_perm_b32 v143, v156, v152, s53
    s_nop 1
    v_mfma_f32_16x16x32_bf16 v[108:111], v[64:67], v[140:143], 0
    v_perm_b32 v136, v21, v17, s52
    v_perm_b32 v137, v29, v25, s52
    v_perm_b32 v138, v149, v145, s52
    v_perm_b32 v139, v157, v153, s52
    s_nop 1
    v_mfma_f32_16x16x32_bf16 v[112:115], v[64:67], v[136:139], 0
    v_perm_b32 v140, v21, v17, s53
    v_perm_b32 v141, v29, v25, s53
    v_perm_b32 v142, v149, v145, s53
    v_perm_b32 v143, v157, v153, s53
    s_nop 1
    v_mfma_f32_16x16x32_bf16 v[116:119], v[64:67], v[140:143], 0
    v_perm_b32 v136, v22, v18, s52
    v_perm_b32 v137, v30, v26, s52
    v_perm_b32 v138, v150, v146, s52
    v_perm_b32 v139, v158, v154, s52
    s_nop 1
    v_mfma_f32_16x16x32_bf16 v[120:123], v[64:67], v[136:139], 0
    v_perm_b32 v140, v22, v18, s53
    v_perm_b32 v141, v30, v26, s53
    v_perm_b32 v142, v150, v146, s53
    v_perm_b32 v143, v158, v154, s53
    s_nop 1
    v_mfma_f32_16x16x32_bf16 v[124:127], v[64:67], v[140:143], 0
    v_perm_b32 v136, v23, v19, s52
    v_perm_b32 v137, v31, v27, s52
    v_perm_b32 v138, v151, v147, s52
    v_perm_b32 v139, v159, v155, s52
    s_nop 1
    v_mfma_f32_16x16x32_bf16 v[128:131], v[64:67], v[136:139], 0
    v_perm_b32 v140, v23, v19, s53
    v_perm_b32 v141, v31, v27, s53
    v_perm_b32 v142, v151, v147, s53
    v_perm_b32 v143, v159, v155, s53
    s_nop 1
    v_mfma_f32_16x16x32_bf16 v[132:135], v[64:67], v[140:143], 0
    s_mov_b32 s44, s75
    v_and_b32 v4, 1, v5
    v_lshlrev_b32 v4, 11, v4
    v_lshl_add_u32 v4, v7, 5, v4
    v_lshrrev_b32 v8, 1, v5
    v_lshl_add_u32 v4, v8, 4, v4
    v_add_u32 v4, s44, v4
    v_cmp_gt_u32 vcc, 32, v0

    s_nop 1
    v_cndmask_b32 v72, v120, v104, vcc
    v_cndmask_b32 v73, v124, v108, vcc
    v_cndmask_b32 v74, v128, v112, vcc
    v_cndmask_b32 v75, v132, v116, vcc
    ds_write_b128 v4, v[72:75] offset:0
    v_cndmask_b32 v76, v121, v105, vcc
    v_cndmask_b32 v77, v125, v109, vcc
    v_cndmask_b32 v78, v129, v113, vcc
    v_cndmask_b32 v79, v133, v117, vcc
    ds_write_b128 v4, v[76:79] offset:512
    v_cndmask_b32 v80, v122, v106, vcc
    v_cndmask_b32 v81, v126, v110, vcc
    v_cndmask_b32 v82, v130, v114, vcc
    v_cndmask_b32 v83, v134, v118, vcc
    ds_write_b128 v4, v[80:83] offset:1024
    v_cndmask_b32 v84, v123, v107, vcc
    v_cndmask_b32 v85, v127, v111, vcc
    v_cndmask_b32 v86, v131, v115, vcc
    v_cndmask_b32 v87, v135, v119, vcc
    ds_write_b128 v4, v[84:87] offset:1536
    v_mov_b32 v4, 1
    s_mov_b64 exec, 1
    ds_write_b32 v10, v4 offset:80
    s_mov_b64 exec, -1
    ds_read_b32 v12, v13 offset:80
FW_145:
    s_waitcnt lgkmcnt(0)
    v_cmp_gt_u32 vcc, 1, v12
    s_cbranch_vccz FO_146
    s_sleep 1
    ds_read_b32 v12, v13 offset:80
    s_branch FW_145
FO_146:
    s_lshl_b32 s44, s3, 10
    s_add_u32 s44, s44, 81920
    v_add_u32_e64 v4, s44, v3
    ds_read_b32 v32, v4 offset:0
    ds_read_b32 v33, v4 offset:256
    ds_read_b32 v34, v4 offset:512
    ds_read_b32 v35, v4 offset:768
    ds_read_b32 v36, v4 offset:4096
    ds_read_b32 v37, v4 offset:4352
    ds_read_b32 v38, v4 offset:4608
    ds_read_b32 v39, v4 offset:4864
    ds_read_b32 v40, v4 offset:32768
    ds_read_b32 v41, v4 offset:33024
    ds_read_b32 v42, v4 offset:33280
    ds_read_b32 v43, v4 offset:33536
    ds_read_b32 v44, v4 offset:36864
    ds_read_b32 v45, v4 offset:37120
    ds_read_b32 v46, v4 offset:37376
    s_waitcnt lgkmcnt(8)
    ds_read_b32 v47, v4 offset:37632
    s_lshl_b32 s44, s3, 13
    s_lshl_b32 s45, s39, 9
    s_add_u32 s44, s44, s45
    s_add_u32 s44, s44, 135168
    s_add_u32 s45, s44, 4096
    s_lshl_b32 s46, s39, 9
    s_waitcnt lgkmcnt(0)

    s_add_u32 s56, s46, 0x845000
    s_add_u32 s56, s72, s56
    s_addc_u32 s57, s73, 0
    v_add_f32 v32, v32, v36
    v_add_f32 v40, v40, v44
    v_add_f32 v33, v33, v37
    v_add_f32 v41, v41, v45
    v_add_f32 v34, v34, v38
    v_add_f32 v42, v42, v46
    v_add_f32 v35, v35, v39
    v_add_f32 v43, v43, v47
    v_add_f32 v32, v32, v40
    buffer_atomic_add_f32 v32, v3, s[24:27], s44 offen offset:0
    v_add_f32 v33, v33, v41
    buffer_atomic_add_f32 v33, v3, s[24:27], s44 offen offset:256
    v_add_f32 v34, v34, v42
    buffer_atomic_add_f32 v34, v3, s[24:27], s45 offen offset:0
    v_add_f32 v35, v35, v43
    buffer_atomic_add_f32 v35, v3, s[24:27], s45 offen offset:256
    v_mov_b32 v4, 159140
    v_mov_b32 v8, 1
    s_waitcnt vmcnt(0)
    s_mov_b64 exec, 1
    ds_add_rtn_u32 v9, v4, v8
    s_waitcnt lgkmcnt(0)
    v_readfirstlane_b32 s44, v9
    s_mov_b64 exec, -1
    s_cmp_lg_u32 s44, 3
    s_cbranch_scc1 F_ye
    s_mov_b32 s44, 1
    s_atomic_add s44, s[56:57], 0
    s_atomic_add s44, s[56:57], 0x80
    s_atomic_add s44, s[56:57], 0x100
    s_atomic_add s44, s[56:57], 0x180
F_ye:

    s_endpgm
F_codeend:
.section .rodata,"a"
.p2align 6
.amdhsa_kernel parallel_sum__linear_attn_block__moe_arch_mod__prompt_kernel
  .amdhsa_next_free_vgpr 168
  .amdhsa_next_free_sgpr 98
  .amdhsa_accum_offset 168
  .amdhsa_group_segment_fixed_size 0
  .amdhsa_kernarg_size 88
  .amdhsa_user_sgpr_count 2
  .amdhsa_user_sgpr_kernarg_segment_ptr 1
  .amdhsa_system_sgpr_workgroup_id_x 1
  .amdhsa_float_denorm_mode_32 3
  .amdhsa_float_denorm_mode_16_64 3
.end_amdhsa_kernel
```

```asm
; @launch grid=(256,1,1) block=(768,1,1) lds=163840
.amdgcn_target "amdgcn-amd-amdhsa--gfx950"
.text
.globl parallel_sum__linear_attn_block__moe_arch_mod__prompt_kernel
.p2align 12
.p2align 8
.type parallel_sum__linear_attn_block__moe_arch_mod__prompt_kernel,@function
parallel_sum__linear_attn_block__moe_arch_mod__prompt_kernel:
    s_load_dwordx4 s[4:7], s[0:1], 0
    s_load_dwordx2 s[8:9], s[0:1], 16
    s_load_dwordx8 s[60:67], s[0:1], 32
    s_load_dwordx4 s[68:71], s[0:1], 64
    s_load_dwordx2 s[72:73], s[0:1], 80
    s_cmp_ge_u32 s2, 256
    s_cbranch_scc1 F_end
    v_lshrrev_b32 v1, 6, v0
    v_and_b32 v0, 63, v0
    s_and_b32 s30, s2, 7
    v_readfirstlane_b32 s3, v1
    s_lshr_b32 s31, s2, 3
    s_and_b32 s36, s30, 1
    s_lshl_b32 s32, s36, 3
    s_and_b32 s35, s31, 7
    s_add_u32 s32, s32, s35
    s_lshr_b32 s37, s30, 1
    s_lshl_b32 s33, s37, 2
    s_lshr_b32 s34, s31, 3
    s_add_u32 s33, s33, s34
    s_add_u32 s10, s33, 0
    s_and_b32 s10, s10, 15
    s_add_u32 s11, s35, s34
    s_and_b32 s11, s11, 3
    s_and_b32 s28, s32, 11
    s_and_b32 s29, s37, 1
    s_lshl_b32 s29, s29, 2
    s_add_u32 s28, s28, s29
    s_lshr_b32 s29, s37, 1
    s_lshl_b32 s29, s29, 3
    s_and_b32 s38, s35, 4
    s_add_u32 s29, s29, s38
    s_add_u32 s38, s34, 1
    s_and_b32 s38, s38, 3
    s_add_u32 s29, s29, s38

    s_lshl_b32 s11, s34, 1
    s_add_u32 s11, s11, s35
    s_and_b32 s11, s11, 7
    s_mul_i32 s89, s36, 8
    s_mul_i32 s38, s37, 2
    s_add_u32 s89, s89, s38

    s_mov_b32 s94, 0x73156420
    s_mov_b32 s95, 0xfb9dea8c
    s_cmp_eq_u32 s11, 1
    s_cselect_b32 s94, 0x62047531, s94
    s_cselect_b32 s95, 0xea8cfb9d, s95
    s_cmp_eq_u32 s11, 2
    s_cselect_b32 s94, 0x53710642, s94
    s_cselect_b32 s95, 0xdbf9cae8, s95
    s_cmp_eq_u32 s11, 3
    s_cselect_b32 s94, 0x42601753, s94
    s_cselect_b32 s95, 0xcae8dbf9, s95
    s_cmp_eq_u32 s11, 4
    s_cselect_b32 s94, 0x58320164, s94
    s_cselect_b32 s95, 0xfdbec9a7, s95
    s_cmp_eq_u32 s11, 5
    s_cselect_b32 s94, 0x49231075, s94
    s_cselect_b32 s95, 0xecafd8b6, s95
    s_cmp_eq_u32 s11, 6
    s_cselect_b32 s94, 0xa5143206, s94
    s_cselect_b32 s95, 0xfd9ebc87, s95
    s_cmp_eq_u32 s11, 7
    s_cselect_b32 s94, 0xb4052317, s94
    s_cselect_b32 s95, 0xec8fad96, s95
    s_cmp_ge_u32 s3, 8
    s_cbranch_scc1 F_aux
    s_cmp_ge_u32 s3, 4
    s_cbranch_scc1 F_nl
    v_lshrrev_b32 v2, 3, v0
    v_and_b32 v3, 7, v0
    v_lshrrev_b32 v4, 1, v2
    v_xor_b32 v5, v3, v4
    v_xor_b32 v6, 4, v5
    v_lshlrev_b32 v5, 4, v5
    v_lshlrev_b32 v6, 4, v6
    v_lshlrev_b32 v7, 11, v2
    v_add_u32 v5, v5, v7
    v_add_u32 v6, v6, v7
    v_and_b32 v4, 1, v4
    v_lshlrev_b32 v4, 1, v4
    v_xor_b32 v8, v3, v4
    v_xor_b32 v9, 4, v8
    v_lshlrev_b32 v8, 4, v8
    v_lshlrev_b32 v9, 4, v9
    v_mul_u32_u24 v7, 6144, v2
    v_add_u32 v8, v8, v7
    v_add_u32 v9, v9, v7
    v_add_u32 v9, 49152, v9
    s_lshl_b32 s36, s32, 18
    s_lshl_b32 s37, s3, 16
    s_add_u32 s36, s36, s37
    s_lshl_b32 s38, s33, 7
    s_mul_i32 s37, s3, 98304
    s_add_u32 s38, s38, s37
    s_lshl_b32 s47, s10, 7
    s_add_u32 s47, s47, s37
    s_lshl_b32 s44, s3, 12
    s_lshl_b32 s45, s3, 11
    s_add_u32 s43, s45, 1024
    s_mov_b32 s14, 4194304
    s_mov_b32 s15, 0x20000
    s_mov_b32 s18, 6291456
    s_mov_b32 s19, 0x20000
    s_waitcnt lgkmcnt(0)
    s_mov_b32 s12, s4
    s_mov_b32 s13, s5
    s_mov_b32 s16, s6
    s_mov_b32 s17, s7

    s_setprio 3
    s_bfe_u32 s40, s94, 0x40000
    s_add_u32 s40, s89, s40
    s_and_b32 s40, s40, 15
    s_mul_i32 s41, s40, 393216
    s_lshl_b32 s40, s40, 7
    s_add_u32 s40, s40, s36
    s_add_u32 s42, s41, s47
    s_add_u32 s41, s41, s38
    s_add_u32 m0, s44, 0
    s_add_u32 s46, s40, 0
    buffer_load_dwordx4 v5, s[12:15], s46 offen lds
    s_add_u32 m0, s44, 1024
    s_add_u32 s46, s40, 16384
    buffer_load_dwordx4 v6, s[12:15], s46 offen lds
    s_add_u32 m0, s44, 2048
    s_add_u32 s46, s40, 32768
    buffer_load_dwordx4 v5, s[12:15], s46 offen lds
    s_add_u32 m0, s44, 3072
    s_add_u32 s46, s40, 49152
    buffer_load_dwordx4 v6, s[12:15], s46 offen lds
    s_add_u32 m0, s45, 65536
    s_add_u32 s46, s41, 2048
    buffer_load_dwordx4 v8, s[16:19], s46 offen lds
    s_add_u32 m0, s43, 65536
    s_add_u32 s46, s41, 2048
    buffer_load_dwordx4 v9, s[16:19], s46 offen lds
    s_add_u32 m0, s45, 73728
    s_add_u32 s46, s41, 4096
    buffer_load_dwordx4 v8, s[16:19], s46 offen lds
    s_add_u32 m0, s43, 73728
    s_add_u32 s46, s41, 4096
    buffer_load_dwordx4 v9, s[16:19], s46 offen lds
    s_add_u32 m0, s45, 147456
    s_nop 0
    buffer_load_dwordx4 v8, s[16:19], s42 offen lds
    s_add_u32 m0, s43, 147456
    s_nop 0
    buffer_load_dwordx4 v9, s[16:19], s42 offen lds
    s_bfe_u32 s40, s94, 0x40004
    s_add_u32 s40, s89, s40
    s_and_b32 s40, s40, 15
    s_mul_i32 s41, s40, 393216
    s_lshl_b32 s40, s40, 7
    s_add_u32 s40, s40, s36
    s_add_u32 s42, s41, s47
    s_add_u32 s41, s41, s38
    s_add_u32 m0, s44, 16384
    s_add_u32 s46, s40, 0
    buffer_load_dwordx4 v5, s[12:15], s46 offen lds
    s_add_u32 m0, s44, 17408
    s_add_u32 s46, s40, 16384
    buffer_load_dwordx4 v6, s[12:15], s46 offen lds
    s_add_u32 m0, s44, 18432
    s_add_u32 s46, s40, 32768
    buffer_load_dwordx4 v5, s[12:15], s46 offen lds
    s_add_u32 m0, s44, 19456
    s_add_u32 s46, s40, 49152
    buffer_load_dwordx4 v6, s[12:15], s46 offen lds
    s_add_u32 m0, s45, 81920
    s_add_u32 s46, s41, 2048
    buffer_load_dwordx4 v8, s[16:19], s46 offen lds
    s_add_u32 m0, s43, 81920
    s_add_u32 s46, s41, 2048
    buffer_load_dwordx4 v9, s[16:19], s46 offen lds
    v_and_b32 v1, 15, v0
    v_lshrrev_b32 v7, 4, v0
    v_lshrrev_b32 v3, 1, v1
    v_xor_b32 v3, v3, v7
    v_lshlrev_b32 v3, 4, v3
    v_lshlrev_b32 v1, 7, v1
    v_add3_u32 v2, v1, v3, s44
    v_xor_b32 v3, 64, v2
    v_add_u32 v14, 0x10000, v2
    v_add_u32 v15, 0x10000, v3
    v_bfe_u32 v1, v0, 2, 2
    v_lshl_add_u32 v4, v7, 3, v1
    v_lshrrev_b32 v1, 1, v1
    v_and_b32 v7, 1, v7
    v_lshl_add_u32 v1, v7, 1, v1
    v_lshlrev_b32 v1, 5, v1
    v_lshl_add_u32 v1, v4, 7, v1
    v_and_b32 v7, 3, v0
    v_lshl_add_u32 v1, v7, 3, v1
    v_add_u32 v10, 90112, v1
    v_xor_b32 v11, 32, v10
    v_xor_b32 v12, 64, v10
    v_xor_b32 v13, 96, v10
    v_lshlrev_b32 v1, 2, v7
    v_add_u32 v1, 159040, v1
    s_lshl_b32 s50, s3, 2
    s_add_u32 s50, s50, 159040
    v_mov_b32 v4, s50
    v_mov_b32 v164, 1

    s_waitcnt vmcnt(8)
    s_barrier
    s_add_u32 m0, s45, 90112
    s_add_u32 s46, s41, 4096
    buffer_load_dwordx4 v8, s[16:19], s46 offen lds
    ds_read_b128 v[48:51], v2 offset:0
    s_add_u32 m0, s43, 90112
    s_add_u32 s46, s41, 4096
    buffer_load_dwordx4 v9, s[16:19], s46 offen lds
    ds_read_b128 v[52:55], v2 offset:2048
    s_lshl_b32 s51, s32, 4
    s_add_u32 s51, s51, s33
    s_lshl_b32 s51, s51, 14
    s_add_u32 s51, s51, s45
    v_lshlrev_b32 v165, 4, v0
    s_mov_b32 s20, s60
    s_mov_b32 s21, s61
    s_mov_b32 s22, 0x800
    s_mov_b32 s23, 0x00020000
    s_add_u32 m0, s45, 98304
    s_add_u32 s46, s51, 0
    buffer_load_dwordx4 v165, s[12:15], s46 offen lds
    ds_read_b128 v[56:59], v3 offset:0
    s_add_u32 m0, s45, 99328
    s_add_u32 s46, s51, 1024
    buffer_load_dwordx4 v165, s[12:15], s46 offen lds
    ds_read_b128 v[60:63], v3 offset:2048
    s_and_b32 s46, s3, 1
    s_lshl_b32 s46, s46, 10
    s_add_u32 m0, s46, 161792
    s_nop 0
    buffer_load_dwordx4 v165, s[20:23], s46 offen lds
    s_add_u32 m0, s45, 106496
    s_add_u32 s46, s51, 8192
    buffer_load_dwordx4 v165, s[12:15], s46 offen lds
    s_add_u32 m0, s45, 107520
    s_add_u32 s46, s51, 9216
    buffer_load_dwordx4 v165, s[12:15], s46 offen lds
    s_bfe_u32 s40, s94, 0x40008
    s_add_u32 s40, s89, s40
    s_and_b32 s40, s40, 15
    s_mul_i32 s41, s40, 393216
    s_lshl_b32 s40, s40, 7
    s_add_u32 s40, s40, s36
    s_add_u32 s42, s41, s47
    s_add_u32 s41, s41, s38
    s_add_u32 m0, s44, 32768
    s_add_u32 s46, s40, 0
    buffer_load_dwordx4 v5, s[12:15], s46 offen lds
    s_add_u32 m0, s44, 33792
    s_add_u32 s46, s40, 16384
    buffer_load_dwordx4 v6, s[12:15], s46 offen lds
    s_add_u32 m0, s44, 34816
    s_add_u32 s46, s40, 32768
    buffer_load_dwordx4 v5, s[12:15], s46 offen lds
    s_add_u32 m0, s44, 35840
    s_add_u32 s46, s40, 49152
    buffer_load_dwordx4 v6, s[12:15], s46 offen lds
    s_waitcnt vmcnt(9) lgkmcnt(0)
    s_barrier
    s_add_u32 m0, s45, 114688
    s_add_u32 s46, s41, 2048
    buffer_load_dwordx4 v8, s[16:19], s46 offen lds
    ds_read_b64_tr_b16 v[64:65], v10 offset:57344
    ds_read_b64_tr_b16 v[66:67], v10 offset:57856
    s_add_u32 m0, s43, 114688
    s_add_u32 s46, s41, 2048
    buffer_load_dwordx4 v9, s[16:19], s46 offen lds
    ds_read_b128 v[68:71], v2 offset:16384
    s_add_u32 m0, s45, 122880
    s_add_u32 s46, s41, 4096
    buffer_load_dwordx4 v8, s[16:19], s46 offen lds
    ds_read_b64_tr_b16 v[72:73], v11 offset:57344
    ds_read_b64_tr_b16 v[74:75], v11 offset:57856
    s_add_u32 m0, s43, 122880
    s_add_u32 s46, s41, 4096
    buffer_load_dwordx4 v9, s[16:19], s46 offen lds
    ds_read_b128 v[76:79], v2 offset:18432
    s_bfe_u32 s40, s94, 0x40004
    s_add_u32 s40, s89, s40
    s_and_b32 s40, s40, 15
    s_mul_i32 s41, s40, 393216
    s_lshl_b32 s40, s40, 7
    s_add_u32 s40, s40, s36
    s_add_u32 s42, s41, s47
    s_add_u32 s41, s41, s38
    s_add_u32 m0, s45, 139264
    s_nop 0
    buffer_load_dwordx4 v8, s[16:19], s42 offen lds
    ds_read_b64_tr_b16 v[80:81], v12 offset:57344
    ds_read_b64_tr_b16 v[82:83], v12 offset:57856
    s_add_u32 m0, s43, 139264
    s_nop 0
    buffer_load_dwordx4 v9, s[16:19], s42 offen lds
    ds_read_b128 v[84:87], v3 offset:16384
    s_bfe_u32 s40, s94, 0x4000c
    s_add_u32 s40, s89, s40
    s_and_b32 s40, s40, 15
    s_mul_i32 s41, s40, 393216
    s_lshl_b32 s40, s40, 7
    s_add_u32 s40, s40, s36
    s_add_u32 s42, s41, s47
    s_add_u32 s41, s41, s38
    s_add_u32 m0, s44, 49152
    s_add_u32 s46, s40, 0
    buffer_load_dwordx4 v5, s[12:15], s46 offen lds
    ds_read_b64_tr_b16 v[88:89], v13 offset:57344
    ds_read_b64_tr_b16 v[90:91], v13 offset:57856
    s_add_u32 m0, s44, 50176
    s_add_u32 s46, s40, 16384
    buffer_load_dwordx4 v6, s[12:15], s46 offen lds
    ds_read_b128 v[92:95], v3 offset:18432
    s_add_u32 m0, s44, 51200
    s_add_u32 s46, s40, 32768
    buffer_load_dwordx4 v5, s[12:15], s46 offen lds
    s_add_u32 m0, s44, 52224
    s_add_u32 s46, s40, 49152
    buffer_load_dwordx4 v6, s[12:15], s46 offen lds
    s_add_u32 m0, s45, 131072
    s_add_u32 s46, s41, 2048
    buffer_load_dwordx4 v8, s[16:19], s46 offen lds
    s_waitcnt vmcnt(5) lgkmcnt(0)
    s_barrier
    s_add_u32 m0, s43, 131072
    s_add_u32 s46, s41, 2048
    buffer_load_dwordx4 v9, s[16:19], s46 offen lds
    v_mfma_f32_16x16x32_bf16 v[16:19], v[64:67], v[48:51], 0
    ds_read_b64_tr_b16 v[96:97], v10 offset:61440
    ds_read_b64_tr_b16 v[98:99], v10 offset:61952
    s_add_u32 m0, s45, 65536
    s_add_u32 s46, s41, 4096
    buffer_load_dwordx4 v8, s[16:19], s46 offen lds
    v_mfma_f32_16x16x32_bf16 v[32:35], v[64:67], v[52:55], 0
    ds_read_b128 v[100:103], v2 offset:32768
    s_add_u32 m0, s43, 65536
    s_add_u32 s46, s41, 4096
    buffer_load_dwordx4 v9, s[16:19], s46 offen lds
    v_mfma_f32_16x16x32_bf16 v[20:23], v[72:75], v[48:51], 0
    ds_read_b64_tr_b16 v[104:105], v11 offset:61440
    ds_read_b64_tr_b16 v[106:107], v11 offset:61952
    s_bfe_u32 s40, s94, 0x40008
    s_add_u32 s40, s89, s40
    s_and_b32 s40, s40, 15
    s_mul_i32 s41, s40, 393216
    s_lshl_b32 s40, s40, 7
    s_add_u32 s40, s40, s36
    s_add_u32 s42, s41, s47
    s_add_u32 s41, s41, s38
    s_add_u32 m0, s45, 90112
    s_nop 0
    buffer_load_dwordx4 v8, s[16:19], s42 offen lds
    v_mfma_f32_16x16x32_bf16 v[36:39], v[72:75], v[52:55], 0
    ds_read_b128 v[108:111], v2 offset:34816
    s_add_u32 m0, s43, 90112
    s_nop 0
    buffer_load_dwordx4 v9, s[16:19], s42 offen lds
    v_mfma_f32_16x16x32_bf16 v[24:27], v[80:83], v[48:51], 0
    ds_read_b64_tr_b16 v[112:113], v12 offset:61440
    ds_read_b64_tr_b16 v[114:115], v12 offset:61952
    s_bfe_u32 s40, s94, 0x40010
    s_add_u32 s40, s89, s40
    s_and_b32 s40, s40, 15
    s_mul_i32 s41, s40, 393216
    s_lshl_b32 s40, s40, 7
    s_add_u32 s40, s40, s36
    s_add_u32 s42, s41, s47
    s_add_u32 s41, s41, s38
    s_add_u32 m0, s44, 0
    s_add_u32 s46, s40, 0
    buffer_load_dwordx4 v5, s[12:15], s46 offen lds
    v_mfma_f32_16x16x32_bf16 v[40:43], v[80:83], v[52:55], 0
    ds_read_b128 v[116:119], v3 offset:32768
    s_add_u32 m0, s44, 1024
    s_add_u32 s46, s40, 16384
    buffer_load_dwordx4 v6, s[12:15], s46 offen lds
    v_mfma_f32_16x16x32_bf16 v[28:31], v[88:91], v[48:51], 0
    ds_read_b64_tr_b16 v[120:121], v13 offset:61440
    ds_read_b64_tr_b16 v[122:123], v13 offset:61952
    s_add_u32 m0, s44, 2048
    s_add_u32 s46, s40, 32768
    buffer_load_dwordx4 v5, s[12:15], s46 offen lds
    v_mfma_f32_16x16x32_bf16 v[44:47], v[88:91], v[52:55], 0
    ds_read_b128 v[124:127], v3 offset:34816
    s_add_u32 m0, s44, 3072
    s_add_u32 s46, s40, 49152
    buffer_load_dwordx4 v6, s[12:15], s46 offen lds
    ds_read_b64_tr_b16 v[128:129], v10 offset:49152
    ds_read_b64_tr_b16 v[130:131], v10 offset:49664
    s_add_u32 m0, s45, 73728
    s_add_u32 s46, s41, 2048
    buffer_load_dwordx4 v8, s[16:19], s46 offen lds
    ds_read_b64_tr_b16 v[132:133], v11 offset:49152
    s_waitcnt lgkmcnt(8)
    ds_read_b64_tr_b16 v[134:135], v11 offset:49664
    s_add_u32 m0, s43, 73728
    s_add_u32 s46, s41, 2048
    buffer_load_dwordx4 v9, s[16:19], s46 offen lds
    ds_read_b64_tr_b16 v[136:137], v12 offset:49152
    ds_read_b64_tr_b16 v[138:139], v12 offset:49664
    ds_read_b64_tr_b16 v[140:141], v13 offset:49152
    ds_read_b64_tr_b16 v[142:143], v13 offset:49664
    s_waitcnt vmcnt(6) lgkmcnt(0)
    s_barrier
    s_add_u32 m0, s45, 81920
    s_add_u32 s46, s41, 4096
    buffer_load_dwordx4 v8, s[16:19], s46 offen lds
    v_mfma_f32_16x16x32_bf16 v[16:19], v[96:99], v[56:59], v[16:19]
    ds_read_b64_tr_b16 v[144:145], v10 offset:53248
    ds_read_b64_tr_b16 v[146:147], v10 offset:53760
    s_add_u32 m0, s43, 81920
    s_add_u32 s46, s41, 4096
    buffer_load_dwordx4 v9, s[16:19], s46 offen lds
    v_mfma_f32_16x16x32_bf16 v[32:35], v[96:99], v[60:63], v[32:35]
    ds_read_b128 v[148:151], v2 offset:49152
    s_bfe_u32 s40, s94, 0x40014
    s_add_u32 s40, s89, s40
    s_and_b32 s40, s40, 15
    s_mul_i32 s41, s40, 393216
    s_lshl_b32 s40, s40, 7
    s_add_u32 s40, s40, s36
    s_add_u32 s42, s41, s47
    s_add_u32 s41, s41, s38
    s_add_u32 m0, s44, 16384
    s_add_u32 s46, s40, 0
    buffer_load_dwordx4 v5, s[12:15], s46 offen lds
    v_mfma_f32_16x16x32_bf16 v[20:23], v[104:107], v[56:59], v[20:23]
    ds_read_b64_tr_b16 v[152:153], v11 offset:53248
    ds_read_b64_tr_b16 v[154:155], v11 offset:53760
    s_add_u32 m0, s44, 17408
    s_add_u32 s46, s40, 16384
    buffer_load_dwordx4 v6, s[12:15], s46 offen lds
    v_mfma_f32_16x16x32_bf16 v[36:39], v[104:107], v[60:63], v[36:39]
    ds_read_b128 v[156:159], v2 offset:51200
    s_add_u32 m0, s44, 18432
    s_add_u32 s46, s40, 32768
    buffer_load_dwordx4 v5, s[12:15], s46 offen lds
    v_mfma_f32_16x16x32_bf16 v[24:27], v[112:115], v[56:59], v[24:27]
    ds_read_b64_tr_b16 v[160:161], v12 offset:53248
    ds_read_b64_tr_b16 v[162:163], v12 offset:53760
    s_add_u32 m0, s44, 19456
    s_add_u32 s46, s40, 49152
    buffer_load_dwordx4 v6, s[12:15], s46 offen lds
    v_mfma_f32_16x16x32_bf16 v[40:43], v[112:115], v[60:63], v[40:43]
    ds_read_b128 v[64:67], v3 offset:49152
    s_add_u32 m0, s45, 98304
    s_add_u32 s46, s41, 2048
    buffer_load_dwordx4 v8, s[16:19], s46 offen lds
    v_mfma_f32_16x16x32_bf16 v[28:31], v[120:123], v[56:59], v[28:31]
    ds_read_b64_tr_b16 v[72:73], v13 offset:53248
    ds_read_b64_tr_b16 v[74:75], v13 offset:53760
    s_add_u32 m0, s43, 98304
    s_add_u32 s46, s41, 2048
    buffer_load_dwordx4 v9, s[16:19], s46 offen lds
    v_mfma_f32_16x16x32_bf16 v[44:47], v[120:123], v[60:63], v[44:47]
    ds_read_b128 v[80:83], v3 offset:51200
    s_add_u32 m0, s45, 106496
    s_add_u32 s46, s41, 4096
    buffer_load_dwordx4 v8, s[16:19], s46 offen lds
    v_mfma_f32_16x16x32_bf16 v[16:19], v[128:131], v[68:71], v[16:19]
    ds_read_b64_tr_b16 v[48:49], v10 offset:0
    ds_read_b64_tr_b16 v[50:51], v10 offset:512
    s_add_u32 m0, s43, 106496
    s_add_u32 s46, s41, 4096
    buffer_load_dwordx4 v9, s[16:19], s46 offen lds
    v_mfma_f32_16x16x32_bf16 v[32:35], v[128:131], v[76:79], v[32:35]
    ds_read_b64_tr_b16 v[88:89], v11 offset:0
    s_waitcnt lgkmcnt(8)
    ds_read_b64_tr_b16 v[90:91], v11 offset:512
    s_bfe_u32 s40, s94, 0x4000c
    s_add_u32 s40, s89, s40
    s_and_b32 s40, s40, 15
    s_mul_i32 s41, s40, 393216
    s_lshl_b32 s40, s40, 7
    s_add_u32 s40, s40, s36
    s_add_u32 s42, s41, s47
    s_add_u32 s41, s41, s38
    s_add_u32 m0, s45, 147456
    s_nop 0
    buffer_load_dwordx4 v8, s[16:19], s42 offen lds
    v_mfma_f32_16x16x32_bf16 v[20:23], v[132:135], v[68:71], v[20:23]
    ds_read_b64_tr_b16 v[52:53], v12 offset:0
    ds_read_b64_tr_b16 v[54:55], v12 offset:512
    v_mfma_f32_16x16x32_bf16 v[36:39], v[132:135], v[76:79], v[36:39]
    ds_read_b64_tr_b16 v[96:97], v13 offset:0
    ds_read_b64_tr_b16 v[98:99], v13 offset:512
    v_mfma_f32_16x16x32_bf16 v[24:27], v[136:139], v[68:71], v[24:27]
    v_mfma_f32_16x16x32_bf16 v[40:43], v[136:139], v[76:79], v[40:43]
    v_mfma_f32_16x16x32_bf16 v[28:31], v[140:143], v[68:71], v[28:31]
    v_mfma_f32_16x16x32_bf16 v[44:47], v[140:143], v[76:79], v[44:47]
    s_waitcnt vmcnt(9) lgkmcnt(0)
    s_barrier
    s_add_u32 m0, s43, 147456
    s_nop 0
    buffer_load_dwordx4 v9, s[16:19], s42 offen lds
    v_mfma_f32_16x16x32_bf16 v[16:19], v[144:147], v[84:87], v[16:19]
    ds_read_b64_tr_b16 v[104:105], v10 offset:4096
    ds_read_b64_tr_b16 v[106:107], v10 offset:4608
    s_bfe_u32 s40, s94, 0x40018
    s_add_u32 s40, s89, s40
    s_and_b32 s40, s40, 15
    s_mul_i32 s41, s40, 393216
    s_lshl_b32 s40, s40, 7
    s_add_u32 s40, s40, s36
    s_add_u32 s42, s41, s47
    s_add_u32 s41, s41, s38
    s_add_u32 m0, s44, 32768
    s_add_u32 s46, s40, 0
    buffer_load_dwordx4 v5, s[12:15], s46 offen lds
    v_mfma_f32_16x16x32_bf16 v[32:35], v[144:147], v[92:95], v[32:35]
    ds_read_b128 v[112:115], v2 offset:0
    s_add_u32 m0, s44, 33792
    s_add_u32 s46, s40, 16384
    s_branch IW_s0
IW_w0:
    s_branch IW_r0
IW_s0:
    buffer_load_dwordx4 v6, s[12:15], s46 offen lds
    v_mfma_f32_16x16x32_bf16 v[20:23], v[152:155], v[84:87], v[20:23]
    ds_read_b64_tr_b16 v[56:57], v11 offset:4096
    ds_read_b64_tr_b16 v[58:59], v11 offset:4608
    s_add_u32 m0, s44, 34816
    s_add_u32 s46, s40, 32768
    buffer_load_dwordx4 v5, s[12:15], s46 offen lds
    v_mfma_f32_16x16x32_bf16 v[36:39], v[152:155], v[92:95], v[36:39]
    ds_read_b128 v[120:123], v2 offset:2048
    s_add_u32 m0, s44, 35840
    s_add_u32 s46, s40, 49152
    buffer_load_dwordx4 v6, s[12:15], s46 offen lds
    v_mfma_f32_16x16x32_bf16 v[24:27], v[160:163], v[84:87], v[24:27]
    ds_read_b64_tr_b16 v[60:61], v12 offset:4096
    ds_read_b64_tr_b16 v[62:63], v12 offset:4608
    s_add_u32 m0, s45, 114688
    s_add_u32 s46, s41, 2048
    buffer_load_dwordx4 v8, s[16:19], s46 offen lds
    v_mfma_f32_16x16x32_bf16 v[40:43], v[160:163], v[92:95], v[40:43]
    ds_read_b128 v[128:131], v3 offset:0
    s_add_u32 m0, s43, 114688
    s_add_u32 s46, s41, 2048
    buffer_load_dwordx4 v9, s[16:19], s46 offen lds
    v_mfma_f32_16x16x32_bf16 v[28:31], v[72:75], v[84:87], v[28:31]
    ds_read_b64_tr_b16 v[132:133], v13 offset:4096
    ds_read_b64_tr_b16 v[134:135], v13 offset:4608
    s_add_u32 m0, s45, 122880
    s_add_u32 s46, s41, 4096
    buffer_load_dwordx4 v8, s[16:19], s46 offen lds
    v_mfma_f32_16x16x32_bf16 v[44:47], v[72:75], v[92:95], v[44:47]
    ds_read_b128 v[136:139], v3 offset:2048
    s_add_u32 m0, s43, 122880
    s_add_u32 s46, s41, 4096
    buffer_load_dwordx4 v9, s[16:19], s46 offen lds
    v_mfma_f32_16x16x32_bf16 v[16:19], v[48:51], v[100:103], v[16:19]
    s_bfe_u32 s40, s94, 0x4001c
    s_add_u32 s40, s89, s40
    s_and_b32 s40, s40, 15
    s_mul_i32 s41, s40, 393216
    s_lshl_b32 s40, s40, 7
    s_add_u32 s40, s40, s36
    s_add_u32 s42, s41, s47
    s_add_u32 s41, s41, s38
    s_add_u32 m0, s44, 49152
    s_add_u32 s46, s40, 0
    buffer_load_dwordx4 v5, s[12:15], s46 offen lds
    v_mfma_f32_16x16x32_bf16 v[32:35], v[48:51], v[108:111], v[32:35]
    s_add_u32 m0, s44, 50176
    s_add_u32 s46, s40, 16384
    buffer_load_dwordx4 v6, s[12:15], s46 offen lds
    v_mfma_f32_16x16x32_bf16 v[20:23], v[88:91], v[100:103], v[20:23]
    v_mfma_f32_16x16x32_bf16 v[36:39], v[88:91], v[108:111], v[36:39]
    v_mfma_f32_16x16x32_bf16 v[24:27], v[52:55], v[100:103], v[24:27]
    v_mfma_f32_16x16x32_bf16 v[40:43], v[52:55], v[108:111], v[40:43]
    v_mfma_f32_16x16x32_bf16 v[28:31], v[96:99], v[100:103], v[28:31]
    v_mfma_f32_16x16x32_bf16 v[44:47], v[96:99], v[108:111], v[44:47]
    s_waitcnt vmcnt(10) lgkmcnt(0)
    s_barrier
    s_add_u32 m0, s44, 51200
    s_add_u32 s46, s40, 32768
    buffer_load_dwordx4 v5, s[12:15], s46 offen lds
    v_mfma_f32_16x16x32_bf16 v[16:19], v[104:107], v[116:119], v[16:19]
    ds_read_b64_tr_b16 v[68:69], v10 offset:57344
    ds_read_b64_tr_b16 v[70:71], v10 offset:57856
    s_add_u32 m0, s44, 52224
    s_add_u32 s46, s40, 49152
    buffer_load_dwordx4 v6, s[12:15], s46 offen lds
    v_mfma_f32_16x16x32_bf16 v[32:35], v[104:107], v[124:127], v[32:35]
    ds_read_b128 v[140:143], v2 offset:16384
    s_add_u32 m0, s45, 65536
    s_add_u32 s46, s41, 2048
    buffer_load_dwordx4 v8, s[16:19], s46 offen lds
    v_mfma_f32_16x16x32_bf16 v[20:23], v[56:59], v[116:119], v[20:23]
    ds_read_b64_tr_b16 v[76:77], v11 offset:57344
    ds_read_b64_tr_b16 v[78:79], v11 offset:57856
    s_add_u32 m0, s43, 65536
    s_add_u32 s46, s41, 2048
    buffer_load_dwordx4 v9, s[16:19], s46 offen lds
    v_mfma_f32_16x16x32_bf16 v[36:39], v[56:59], v[124:127], v[36:39]
    ds_read_b128 v[144:147], v2 offset:18432
    s_add_u32 m0, s45, 131072
    s_add_u32 s46, s41, 4096
    buffer_load_dwordx4 v8, s[16:19], s46 offen lds
    v_mfma_f32_16x16x32_bf16 v[24:27], v[60:63], v[116:119], v[24:27]
    ds_read_b64_tr_b16 v[152:153], v12 offset:57344
    ds_read_b64_tr_b16 v[154:155], v12 offset:57856
    s_add_u32 m0, s43, 131072
    s_add_u32 s46, s41, 4096
    buffer_load_dwordx4 v9, s[16:19], s46 offen lds
    v_mfma_f32_16x16x32_bf16 v[40:43], v[60:63], v[124:127], v[40:43]
    ds_read_b128 v[160:163], v3 offset:16384
    s_bfe_u32 s40, s94, 0x40010
    s_add_u32 s40, s89, s40
    s_and_b32 s40, s40, 15
    s_mul_i32 s41, s40, 393216
    s_lshl_b32 s40, s40, 7
    s_add_u32 s40, s40, s36
    s_add_u32 s42, s41, s47
    s_add_u32 s41, s41, s38
    s_add_u32 m0, s45, 139264
    s_nop 0
    buffer_load_dwordx4 v8, s[16:19], s42 offen lds
    v_mfma_f32_16x16x32_bf16 v[28:31], v[132:135], v[116:119], v[28:31]
    ds_read_b64_tr_b16 v[84:85], v13 offset:57344
    ds_read_b64_tr_b16 v[86:87], v13 offset:57856
    s_add_u32 m0, s43, 139264
    s_nop 0
    buffer_load_dwordx4 v9, s[16:19], s42 offen lds
    v_mfma_f32_16x16x32_bf16 v[44:47], v[132:135], v[124:127], v[44:47]
    ds_read_b128 v[72:75], v3 offset:18432
    s_bfe_u32 s40, s95, 0x40000
    s_add_u32 s40, s89, s40
    s_and_b32 s40, s40, 15
    s_mul_i32 s41, s40, 393216
    s_lshl_b32 s40, s40, 7
    s_add_u32 s40, s40, s36
    s_add_u32 s42, s41, s47
    s_add_u32 s41, s41, s38
    s_add_u32 m0, s44, 0
    s_add_u32 s46, s40, 0
    buffer_load_dwordx4 v5, s[12:15], s46 offen lds
    s_add_u32 m0, s44, 1024
    s_add_u32 s46, s40, 16384
    buffer_load_dwordx4 v6, s[12:15], s46 offen lds
    s_add_u32 m0, s44, 2048
    s_add_u32 s46, s40, 32768
    buffer_load_dwordx4 v5, s[12:15], s46 offen lds
    s_waitcnt vmcnt(13) lgkmcnt(0)
    s_barrier
    s_add_u32 m0, s44, 3072
    s_add_u32 s46, s40, 49152
    buffer_load_dwordx4 v6, s[12:15], s46 offen lds
    v_mfma_f32_16x16x32_bf16 v[16:19], v[68:71], v[148:151], v[16:19]
    ds_read_b64_tr_b16 v[92:93], v10 offset:61440
    ds_read_b64_tr_b16 v[94:95], v10 offset:61952
    s_add_u32 m0, s45, 73728
    s_add_u32 s46, s41, 2048
    buffer_load_dwordx4 v8, s[16:19], s46 offen lds
    v_mfma_f32_16x16x32_bf16 v[32:35], v[68:71], v[156:159], v[32:35]
    ds_read_b128 v[48:51], v2 offset:32768
    s_add_u32 m0, s43, 73728
    s_add_u32 s46, s41, 2048
    buffer_load_dwordx4 v9, s[16:19], s46 offen lds
    v_mfma_f32_16x16x32_bf16 v[20:23], v[76:79], v[148:151], v[20:23]
    ds_read_b64_tr_b16 v[88:89], v11 offset:61440
    ds_read_b64_tr_b16 v[90:91], v11 offset:61952
    s_add_u32 m0, s45, 81920
    s_add_u32 s46, s41, 4096
    buffer_load_dwordx4 v8, s[16:19], s46 offen lds
    v_mfma_f32_16x16x32_bf16 v[36:39], v[76:79], v[156:159], v[36:39]
    ds_read_b128 v[52:55], v2 offset:34816
    s_add_u32 m0, s43, 81920
    s_add_u32 s46, s41, 4096
    buffer_load_dwordx4 v9, s[16:19], s46 offen lds
    v_mfma_f32_16x16x32_bf16 v[24:27], v[152:155], v[148:151], v[24:27]
    ds_read_b64_tr_b16 v[100:101], v12 offset:61440
    ds_read_b64_tr_b16 v[102:103], v12 offset:61952
    s_bfe_u32 s40, s95, 0x40004
    s_add_u32 s40, s89, s40
    s_and_b32 s40, s40, 15
    s_mul_i32 s41, s40, 393216
    s_lshl_b32 s40, s40, 7
    s_add_u32 s40, s40, s36
    s_add_u32 s42, s41, s47
    s_add_u32 s41, s41, s38
    s_add_u32 m0, s44, 16384
    s_add_u32 s46, s40, 0
    buffer_load_dwordx4 v5, s[12:15], s46 offen lds
    v_mfma_f32_16x16x32_bf16 v[40:43], v[152:155], v[156:159], v[40:43]
    ds_read_b128 v[96:99], v3 offset:32768
    s_add_u32 m0, s44, 17408
    s_add_u32 s46, s40, 16384
    buffer_load_dwordx4 v6, s[12:15], s46 offen lds
    v_mfma_f32_16x16x32_bf16 v[28:31], v[84:87], v[148:151], v[28:31]
    ds_read_b64_tr_b16 v[108:109], v13 offset:61440
    ds_read_b64_tr_b16 v[110:111], v13 offset:61952
    s_add_u32 m0, s44, 18432
    s_add_u32 s46, s40, 32768
    buffer_load_dwordx4 v5, s[12:15], s46 offen lds
    v_mfma_f32_16x16x32_bf16 v[44:47], v[84:87], v[156:159], v[44:47]
    ds_read_b128 v[104:107], v3 offset:34816
    s_add_u32 m0, s44, 19456
    s_add_u32 s46, s40, 49152
    buffer_load_dwordx4 v6, s[12:15], s46 offen lds
    s_add_u32 m0, s45, 90112
    s_add_u32 s46, s41, 2048
    buffer_load_dwordx4 v8, s[16:19], s46 offen lds
    s_add_u32 m0, s43, 90112
    s_add_u32 s46, s41, 2048
    buffer_load_dwordx4 v9, s[16:19], s46 offen lds
    s_waitcnt vmcnt(14) lgkmcnt(0)
    s_barrier
    s_add_u32 m0, s45, 98304
    s_add_u32 s46, s41, 4096
    buffer_load_dwordx4 v8, s[16:19], s46 offen lds
    v_mfma_f32_16x16x32_bf16 v[16:19], v[92:95], v[64:67], v[16:19]
    ds_read_b64_tr_b16 v[56:57], v10 offset:49152
    ds_read_b64_tr_b16 v[58:59], v10 offset:49664
    s_add_u32 m0, s43, 98304
    s_add_u32 s46, s41, 4096
    buffer_load_dwordx4 v9, s[16:19], s46 offen lds
    v_mfma_f32_16x16x32_bf16 v[32:35], v[92:95], v[80:83], v[32:35]
    ds_read_b128 v[60:63], v2 offset:49152
    s_bfe_u32 s40, s94, 0x40014
    s_add_u32 s40, s89, s40
    s_and_b32 s40, s40, 15
    s_mul_i32 s41, s40, 393216
    s_lshl_b32 s40, s40, 7
    s_add_u32 s40, s40, s36
    s_add_u32 s42, s41, s47
    s_add_u32 s41, s41, s38
    s_add_u32 m0, s45, 106496
    s_nop 0
    buffer_load_dwordx4 v8, s[16:19], s42 offen lds
    v_mfma_f32_16x16x32_bf16 v[20:23], v[88:91], v[64:67], v[20:23]
    ds_read_b64_tr_b16 v[116:117], v11 offset:49152
    ds_read_b64_tr_b16 v[118:119], v11 offset:49664
    s_add_u32 m0, s43, 106496
    s_nop 0
    buffer_load_dwordx4 v9, s[16:19], s42 offen lds
    v_mfma_f32_16x16x32_bf16 v[36:39], v[88:91], v[80:83], v[36:39]
    ds_read_b128 v[132:135], v2 offset:51200
    s_bfe_u32 s40, s95, 0x40008
    s_add_u32 s40, s89, s40
    s_and_b32 s40, s40, 15
    s_mul_i32 s41, s40, 393216
    s_lshl_b32 s40, s40, 7
    s_add_u32 s40, s40, s36
    s_add_u32 s42, s41, s47
    s_add_u32 s41, s41, s38
    s_add_u32 m0, s44, 32768
    s_add_u32 s46, s40, 0
    buffer_load_dwordx4 v5, s[12:15], s46 offen lds
    v_mfma_f32_16x16x32_bf16 v[24:27], v[100:103], v[64:67], v[24:27]
    ds_read_b64_tr_b16 v[124:125], v12 offset:49152
    ds_read_b64_tr_b16 v[126:127], v12 offset:49664
    s_add_u32 m0, s44, 33792
    s_add_u32 s46, s40, 16384
    buffer_load_dwordx4 v6, s[12:15], s46 offen lds
    v_mfma_f32_16x16x32_bf16 v[40:43], v[100:103], v[80:83], v[40:43]
    ds_read_b128 v[68:71], v3 offset:49152
    s_add_u32 m0, s44, 34816
    s_add_u32 s46, s40, 32768
    buffer_load_dwordx4 v5, s[12:15], s46 offen lds
    v_mfma_f32_16x16x32_bf16 v[28:31], v[108:111], v[64:67], v[28:31]
    ds_read_b64_tr_b16 v[76:77], v13 offset:49152
    ds_read_b64_tr_b16 v[78:79], v13 offset:49664
    s_add_u32 m0, s44, 35840
    s_add_u32 s46, s40, 49152
    buffer_load_dwordx4 v6, s[12:15], s46 offen lds
    v_mfma_f32_16x16x32_bf16 v[44:47], v[108:111], v[80:83], v[44:47]
    ds_read_b128 v[152:155], v3 offset:51200
    s_add_u32 m0, s45, 114688
    s_add_u32 s46, s41, 2048
    buffer_load_dwordx4 v8, s[16:19], s46 offen lds
    s_add_u32 m0, s43, 114688
    s_add_u32 s46, s41, 2048
    buffer_load_dwordx4 v9, s[16:19], s46 offen lds
    s_add_u32 m0, s45, 122880
    s_add_u32 s46, s41, 4096
    buffer_load_dwordx4 v8, s[16:19], s46 offen lds
    s_waitcnt vmcnt(17) lgkmcnt(0)
    s_barrier
    s_add_u32 m0, s43, 122880
    s_add_u32 s46, s41, 4096
    buffer_load_dwordx4 v9, s[16:19], s46 offen lds
    v_mfma_f32_16x16x32_bf16 v[16:19], v[56:59], v[112:115], v[16:19]
    ds_read_b64_tr_b16 v[148:149], v10 offset:53248
    ds_read_b64_tr_b16 v[150:151], v10 offset:53760
    s_bfe_u32 s40, s95, 0x4000c
    s_add_u32 s40, s89, s40
    s_and_b32 s40, s40, 15
    s_mul_i32 s41, s40, 393216
    s_lshl_b32 s40, s40, 7
    s_add_u32 s40, s40, s36
    s_add_u32 s42, s41, s47
    s_add_u32 s41, s41, s38
    s_add_u32 m0, s44, 49152
    s_add_u32 s46, s40, 0
    buffer_load_dwordx4 v5, s[12:15], s46 offen lds
    v_mfma_f32_16x16x32_bf16 v[32:35], v[56:59], v[120:123], v[32:35]
    ds_read_b128 v[84:87], v2 offset:0
    s_add_u32 m0, s44, 50176
    s_add_u32 s46, s40, 16384
    buffer_load_dwordx4 v6, s[12:15], s46 offen lds
    v_mfma_f32_16x16x32_bf16 v[20:23], v[116:119], v[112:115], v[20:23]
    ds_read_b64_tr_b16 v[156:157], v11 offset:53248
    ds_read_b64_tr_b16 v[158:159], v11 offset:53760
    s_add_u32 m0, s44, 51200
    s_add_u32 s46, s40, 32768
    buffer_load_dwordx4 v5, s[12:15], s46 offen lds
    v_mfma_f32_16x16x32_bf16 v[36:39], v[116:119], v[120:123], v[36:39]
    ds_read_b128 v[92:95], v2 offset:2048
    s_add_u32 m0, s44, 52224
    s_add_u32 s46, s40, 49152
    buffer_load_dwordx4 v6, s[12:15], s46 offen lds
    v_mfma_f32_16x16x32_bf16 v[24:27], v[124:127], v[112:115], v[24:27]
    ds_read_b64_tr_b16 v[88:89], v12 offset:53248
    ds_read_b64_tr_b16 v[90:91], v12 offset:53760
    s_add_u32 m0, s45, 65536
    s_add_u32 s46, s41, 2048
    buffer_load_dwordx4 v8, s[16:19], s46 offen lds
    v_mfma_f32_16x16x32_bf16 v[40:43], v[124:127], v[120:123], v[40:43]
    ds_read_b128 v[100:103], v3 offset:0
    s_add_u32 m0, s43, 65536
    s_add_u32 s46, s41, 2048
    buffer_load_dwordx4 v9, s[16:19], s46 offen lds
    v_mfma_f32_16x16x32_bf16 v[28:31], v[76:79], v[112:115], v[28:31]
    ds_read_b64_tr_b16 v[64:65], v13 offset:53248
    ds_read_b64_tr_b16 v[66:67], v13 offset:53760
    s_add_u32 m0, s45, 131072
    s_add_u32 s46, s41, 4096
    buffer_load_dwordx4 v8, s[16:19], s46 offen lds
    v_mfma_f32_16x16x32_bf16 v[44:47], v[76:79], v[120:123], v[44:47]
    ds_read_b128 v[108:111], v3 offset:2048
    s_add_u32 m0, s43, 131072
    s_add_u32 s46, s41, 4096
    buffer_load_dwordx4 v9, s[16:19], s46 offen lds
    s_waitcnt vmcnt(16) lgkmcnt(0)
    s_barrier
    s_bfe_u32 s40, s95, 0x40010
    s_add_u32 s40, s89, s40
    s_and_b32 s40, s40, 15
    s_mul_i32 s41, s40, 393216
    s_lshl_b32 s40, s40, 7
    s_add_u32 s40, s40, s36
    s_add_u32 s42, s41, s47
    s_add_u32 s41, s41, s38
    s_add_u32 m0, s44, 0
    s_add_u32 s46, s40, 0
    buffer_load_dwordx4 v5, s[12:15], s46 offen lds
    v_mfma_f32_16x16x32_bf16 v[16:19], v[148:151], v[128:131], v[16:19]
    ds_read_b64_tr_b16 v[80:81], v10 offset:16384
    ds_read_b64_tr_b16 v[82:83], v10 offset:16896
    s_add_u32 m0, s44, 1024
    s_add_u32 s46, s40, 16384
    buffer_load_dwordx4 v6, s[12:15], s46 offen lds
    v_mfma_f32_16x16x32_bf16 v[32:35], v[148:151], v[136:139], v[32:35]
    ds_read_b128 v[56:59], v2 offset:16384
    s_add_u32 m0, s44, 2048
    s_add_u32 s46, s40, 32768
    buffer_load_dwordx4 v5, s[12:15], s46 offen lds
    v_mfma_f32_16x16x32_bf16 v[20:23], v[156:159], v[128:131], v[20:23]
    ds_read_b64_tr_b16 v[116:117], v11 offset:16384
    ds_read_b64_tr_b16 v[118:119], v11 offset:16896
    s_add_u32 m0, s44, 3072
    s_add_u32 s46, s40, 49152
    buffer_load_dwordx4 v6, s[12:15], s46 offen lds
    v_mfma_f32_16x16x32_bf16 v[36:39], v[156:159], v[136:139], v[36:39]
    ds_read_b128 v[124:127], v2 offset:18432
    s_add_u32 m0, s45, 73728
    s_add_u32 s46, s41, 2048
    buffer_load_dwordx4 v8, s[16:19], s46 offen lds
    v_mfma_f32_16x16x32_bf16 v[24:27], v[88:91], v[128:131], v[24:27]
    ds_read_b64_tr_b16 v[112:113], v12 offset:16384
    ds_read_b64_tr_b16 v[114:115], v12 offset:16896
    s_add_u32 m0, s43, 73728
    s_add_u32 s46, s41, 2048
    buffer_load_dwordx4 v9, s[16:19], s46 offen lds
    v_mfma_f32_16x16x32_bf16 v[40:43], v[88:91], v[136:139], v[40:43]
    ds_read_b128 v[76:79], v3 offset:16384
    s_add_u32 m0, s45, 81920
    s_add_u32 s46, s41, 4096
    buffer_load_dwordx4 v8, s[16:19], s46 offen lds
    v_mfma_f32_16x16x32_bf16 v[28:31], v[64:67], v[128:131], v[28:31]
    ds_read_b64_tr_b16 v[120:121], v13 offset:16384
    ds_read_b64_tr_b16 v[122:123], v13 offset:16896
    s_add_u32 m0, s43, 81920
    s_add_u32 s46, s41, 4096
    buffer_load_dwordx4 v9, s[16:19], s46 offen lds
    v_mfma_f32_16x16x32_bf16 v[44:47], v[64:67], v[136:139], v[44:47]
    ds_read_b128 v[148:151], v3 offset:18432
    s_waitcnt vmcnt(16) lgkmcnt(0)
    s_barrier
    s_bfe_u32 s40, s95, 0x40014
    s_add_u32 s40, s89, s40
    s_and_b32 s40, s40, 15
    s_mul_i32 s41, s40, 393216
    s_lshl_b32 s40, s40, 7
    s_add_u32 s40, s40, s36
    s_add_u32 s42, s41, s47
    s_add_u32 s41, s41, s38
    s_add_u32 m0, s44, 16384
    s_add_u32 s46, s40, 0
    buffer_load_dwordx4 v5, s[12:15], s46 offen lds
    v_mfma_f32_16x16x32_bf16 v[16:19], v[80:83], v[140:143], v[16:19]
    ds_read_b64_tr_b16 v[156:157], v10 offset:20480
    ds_read_b64_tr_b16 v[158:159], v10 offset:20992
    s_add_u32 m0, s44, 17408
    s_add_u32 s46, s40, 16384
    buffer_load_dwordx4 v6, s[12:15], s46 offen lds
    v_mfma_f32_16x16x32_bf16 v[32:35], v[80:83], v[144:147], v[32:35]
    ds_read_b128 v[88:91], v2 offset:32768
    s_add_u32 m0, s44, 18432
    s_add_u32 s46, s40, 32768
    buffer_load_dwordx4 v5, s[12:15], s46 offen lds
    v_mfma_f32_16x16x32_bf16 v[20:23], v[116:119], v[140:143], v[20:23]
    ds_read_b64_tr_b16 v[128:129], v11 offset:20480
    ds_read_b64_tr_b16 v[130:131], v11 offset:20992
    s_add_u32 m0, s44, 19456
    s_add_u32 s46, s40, 49152
    buffer_load_dwordx4 v6, s[12:15], s46 offen lds
    v_mfma_f32_16x16x32_bf16 v[36:39], v[116:119], v[144:147], v[36:39]
    ds_read_b128 v[64:67], v2 offset:34816
    s_add_u32 m0, s45, 90112
    s_add_u32 s46, s41, 2048
    buffer_load_dwordx4 v8, s[16:19], s46 offen lds
    v_mfma_f32_16x16x32_bf16 v[24:27], v[112:115], v[140:143], v[24:27]
    ds_read_b64_tr_b16 v[136:137], v12 offset:20480
    ds_read_b64_tr_b16 v[138:139], v12 offset:20992
    s_add_u32 m0, s43, 90112
    s_add_u32 s46, s41, 2048
    buffer_load_dwordx4 v9, s[16:19], s46 offen lds
    v_mfma_f32_16x16x32_bf16 v[40:43], v[112:115], v[144:147], v[40:43]
    ds_read_b128 v[80:83], v3 offset:32768
    s_add_u32 m0, s45, 98304
    s_add_u32 s46, s41, 4096
    buffer_load_dwordx4 v8, s[16:19], s46 offen lds
    v_mfma_f32_16x16x32_bf16 v[28:31], v[120:123], v[140:143], v[28:31]
    ds_read_b64_tr_b16 v[116:117], v13 offset:20480
    ds_read_b64_tr_b16 v[118:119], v13 offset:20992
    s_add_u32 m0, s43, 98304
    s_add_u32 s46, s41, 4096
    buffer_load_dwordx4 v9, s[16:19], s46 offen lds
    v_mfma_f32_16x16x32_bf16 v[44:47], v[120:123], v[144:147], v[44:47]
    ds_read_b128 v[112:115], v3 offset:34816
    s_waitcnt vmcnt(16) lgkmcnt(0)
    s_barrier
    s_bfe_u32 s40, s95, 0x40018
    s_add_u32 s40, s89, s40
    s_and_b32 s40, s40, 15
    s_mul_i32 s41, s40, 393216
    s_lshl_b32 s40, s40, 7
    s_add_u32 s40, s40, s36
    s_add_u32 s42, s41, s47
    s_add_u32 s41, s41, s38
    s_add_u32 m0, s44, 32768
    s_add_u32 s46, s40, 0
    buffer_load_dwordx4 v5, s[12:15], s46 offen lds
    v_mfma_f32_16x16x32_bf16 v[16:19], v[156:159], v[160:163], v[16:19]
    ds_read_b128 v[140:143], v2 offset:49152
    s_add_u32 m0, s44, 33792
    s_add_u32 s46, s40, 16384
    buffer_load_dwordx4 v6, s[12:15], s46 offen lds
    v_mfma_f32_16x16x32_bf16 v[32:35], v[156:159], v[72:75], v[32:35]
    ds_read_b128 v[120:123], v2 offset:51200
    s_add_u32 m0, s44, 34816
    s_add_u32 s46, s40, 32768
    buffer_load_dwordx4 v5, s[12:15], s46 offen lds
    v_mfma_f32_16x16x32_bf16 v[20:23], v[128:131], v[160:163], v[20:23]
    ds_read_b128 v[144:147], v3 offset:49152
    s_add_u32 m0, s44, 35840
    s_add_u32 s46, s40, 49152
    buffer_load_dwordx4 v6, s[12:15], s46 offen lds
    v_mfma_f32_16x16x32_bf16 v[36:39], v[128:131], v[72:75], v[36:39]
    ds_read_b128 v[156:159], v3 offset:51200
    s_add_u32 m0, s45, 106496
    s_add_u32 s46, s41, 2048
    buffer_load_dwordx4 v8, s[16:19], s46 offen lds
    v_mfma_f32_16x16x32_bf16 v[24:27], v[136:139], v[160:163], v[24:27]
    s_add_u32 m0, s43, 106496
    s_add_u32 s46, s41, 2048
    buffer_load_dwordx4 v9, s[16:19], s46 offen lds
    v_mfma_f32_16x16x32_bf16 v[40:43], v[136:139], v[72:75], v[40:43]
    s_add_u32 m0, s45, 114688
    s_add_u32 s46, s41, 4096
    buffer_load_dwordx4 v8, s[16:19], s46 offen lds
    v_mfma_f32_16x16x32_bf16 v[28:31], v[116:119], v[160:163], v[28:31]
    s_add_u32 m0, s43, 114688
    s_add_u32 s46, s41, 4096
    buffer_load_dwordx4 v9, s[16:19], s46 offen lds
    v_mfma_f32_16x16x32_bf16 v[44:47], v[116:119], v[72:75], v[44:47]
    s_waitcnt vmcnt(16) lgkmcnt(0)
    s_barrier
    s_bfe_u32 s40, s95, 0x4001c
    s_add_u32 s40, s89, s40
    s_and_b32 s40, s40, 15
    s_mul_i32 s41, s40, 393216
    s_lshl_b32 s40, s40, 7
    s_add_u32 s40, s40, s36
    s_add_u32 s42, s41, s47
    s_add_u32 s41, s41, s38
    s_add_u32 m0, s44, 49152
    s_add_u32 s46, s40, 0
    buffer_load_dwordx4 v5, s[12:15], s46 offen lds
    s_add_u32 m0, s44, 50176
    s_add_u32 s46, s40, 16384
    buffer_load_dwordx4 v6, s[12:15], s46 offen lds
    s_add_u32 m0, s44, 51200
    s_add_u32 s46, s40, 32768
    buffer_load_dwordx4 v5, s[12:15], s46 offen lds
    s_add_u32 m0, s44, 52224
    s_add_u32 s46, s40, 49152
    buffer_load_dwordx4 v6, s[12:15], s46 offen lds
    s_add_u32 m0, s45, 65536
    s_add_u32 s46, s41, 2048
    buffer_load_dwordx4 v8, s[16:19], s46 offen lds
    s_add_u32 m0, s43, 65536
    s_add_u32 s46, s41, 2048
    buffer_load_dwordx4 v9, s[16:19], s46 offen lds
    s_add_u32 m0, s45, 122880
    s_add_u32 s46, s41, 4096
    buffer_load_dwordx4 v8, s[16:19], s46 offen lds
    s_add_u32 m0, s43, 122880
    s_add_u32 s46, s41, 4096
    buffer_load_dwordx4 v9, s[16:19], s46 offen lds
    s_waitcnt vmcnt(16)
    s_barrier
    s_bfe_u32 s40, s94, 0x40018
    s_add_u32 s40, s89, s40
    s_and_b32 s40, s40, 15
    s_mul_i32 s41, s40, 393216
    s_lshl_b32 s40, s40, 7
    s_add_u32 s40, s40, s36
    s_add_u32 s42, s41, s47
    s_add_u32 s41, s41, s38
    s_add_u32 m0, s45, 147456
    s_nop 0
    buffer_load_dwordx4 v8, s[16:19], s42 offen lds
    s_add_u32 m0, s43, 147456
    s_nop 0
    buffer_load_dwordx4 v9, s[16:19], s42 offen lds
    s_waitcnt vmcnt(10)
    s_barrier
    s_bfe_u32 s40, s95, 0x40010
    s_add_u32 s40, s89, s40
    s_and_b32 s40, s40, 15
    s_mul_i32 s41, s40, 393216
    s_lshl_b32 s40, s40, 7
    s_add_u32 s40, s40, s36
    s_add_u32 s42, s41, s47
    s_add_u32 s41, s41, s38
    s_add_u32 m0, s45, 139264
    s_nop 0
    buffer_load_dwordx4 v8, s[16:19], s42 offen lds
    s_add_u32 m0, s43, 139264
    s_nop 0
    buffer_load_dwordx4 v9, s[16:19], s42 offen lds
    s_waitcnt vmcnt(4)
    s_barrier
    s_bfe_u32 s40, s95, 0x40014
    s_add_u32 s40, s89, s40
    s_and_b32 s40, s40, 15
    s_mul_i32 s41, s40, 393216
    s_lshl_b32 s40, s40, 7
    s_add_u32 s40, s40, s36
    s_add_u32 s42, s41, s47
    s_add_u32 s41, s41, s38
    s_add_u32 m0, s45, 131072
    s_nop 0
    buffer_load_dwordx4 v8, s[16:19], s42 offen lds
    s_add_u32 m0, s43, 131072
    s_nop 0
    buffer_load_dwordx4 v9, s[16:19], s42 offen lds
    s_waitcnt vmcnt(6)
    s_barrier
    s_bfe_u32 s40, s95, 0x40018
    s_add_u32 s40, s89, s40
    s_and_b32 s40, s40, 15
    s_mul_i32 s41, s40, 393216
    s_lshl_b32 s40, s40, 7
    s_add_u32 s40, s40, s36
    s_add_u32 s42, s41, s47
    s_add_u32 s41, s41, s38
    s_add_u32 m0, s45, 81920
    s_nop 0
    buffer_load_dwordx4 v8, s[16:19], s42 offen lds
    s_add_u32 m0, s43, 81920
    s_nop 0
    buffer_load_dwordx4 v9, s[16:19], s42 offen lds
    s_bfe_u32 s40, s95, 0x4001c
    s_add_u32 s40, s89, s40
    s_and_b32 s40, s40, 15
    s_mul_i32 s41, s40, 393216
    s_lshl_b32 s40, s40, 7
    s_add_u32 s40, s40, s36
    s_add_u32 s42, s41, s47
    s_add_u32 s41, s41, s38
    s_add_u32 m0, s45, 73728
    s_nop 0
    buffer_load_dwordx4 v8, s[16:19], s42 offen lds
    s_add_u32 m0, s43, 73728
    s_nop 0
    s_branch IW_s1
IW_w1:
    s_branch IW_r1
IW_s1:
    buffer_load_dwordx4 v9, s[16:19], s42 offen lds
    s_bfe_u32 s40, s94, 0x4001c
    s_add_u32 s40, s89, s40
    s_and_b32 s40, s40, 15
    s_mul_i32 s41, s40, 393216
    s_lshl_b32 s40, s40, 7
    s_add_u32 s40, s40, s36
    s_add_u32 s42, s41, s47
    s_add_u32 s41, s41, s38
    s_add_u32 m0, s45, 98304
    s_nop 0
    buffer_load_dwordx4 v8, s[16:19], s42 offen lds
    s_add_u32 m0, s43, 98304
    s_nop 0
    buffer_load_dwordx4 v9, s[16:19], s42 offen lds
    s_bfe_u32 s40, s95, 0x40000
    s_add_u32 s40, s89, s40
    s_and_b32 s40, s40, 15
    s_mul_i32 s41, s40, 393216
    s_lshl_b32 s40, s40, 7
    s_add_u32 s40, s40, s36
    s_add_u32 s42, s41, s47
    s_add_u32 s41, s41, s38
    s_add_u32 m0, s45, 90112
    s_nop 0
    buffer_load_dwordx4 v8, s[16:19], s42 offen lds
    s_add_u32 m0, s43, 90112
    s_nop 0
    buffer_load_dwordx4 v9, s[16:19], s42 offen lds
    s_bfe_u32 s40, s95, 0x40004
    s_add_u32 s40, s89, s40
    s_and_b32 s40, s40, 15
    s_mul_i32 s41, s40, 393216
    s_lshl_b32 s40, s40, 7
    s_add_u32 s40, s40, s36
    s_add_u32 s42, s41, s47
    s_add_u32 s41, s41, s38
    s_add_u32 m0, s45, 114688
    s_nop 0
    buffer_load_dwordx4 v8, s[16:19], s42 offen lds
    s_add_u32 m0, s43, 114688
    s_nop 0
    buffer_load_dwordx4 v9, s[16:19], s42 offen lds
    s_bfe_u32 s40, s95, 0x40008
    s_add_u32 s40, s89, s40
    s_and_b32 s40, s40, 15
    s_mul_i32 s41, s40, 393216
    s_lshl_b32 s40, s40, 7
    s_add_u32 s40, s40, s36
    s_add_u32 s42, s41, s47
    s_add_u32 s41, s41, s38
    s_add_u32 m0, s45, 106496
    s_nop 0
    buffer_load_dwordx4 v8, s[16:19], s42 offen lds
    s_add_u32 m0, s43, 106496
    s_nop 0
    buffer_load_dwordx4 v9, s[16:19], s42 offen lds
    s_bfe_u32 s40, s95, 0x4000c
    s_add_u32 s40, s89, s40
    s_and_b32 s40, s40, 15
    s_mul_i32 s41, s40, 393216
    s_lshl_b32 s40, s40, 7
    s_add_u32 s40, s40, s36
    s_add_u32 s42, s41, s47
    s_add_u32 s41, s41, s38
    s_add_u32 m0, s45, 122880
    s_nop 0
    buffer_load_dwordx4 v8, s[16:19], s42 offen lds
    s_add_u32 m0, s43, 122880
    s_nop 0
    buffer_load_dwordx4 v9, s[16:19], s42 offen lds
    s_setprio 1
    v_subrev_u32 v5, 24576, v10
    v_subrev_u32 v6, 24576, v11
    v_subrev_u32 v8, 24576, v12
    v_subrev_u32 v9, 24576, v13
    s_add_u32 s16, s72, 0x400000
    s_addc_u32 s17, s73, 0
    s_mov_b32 s18, 0x400000
    s_mov_b32 s19, 0x00020000
    s_add_u32 s24, s72, 0x800000
    s_addc_u32 s25, s73, 0
    s_mov_b32 s26, 0x48000
    s_mov_b32 s27, 0x00020000
    s_waitcnt vmcnt(8)
    s_mov_b64 exec, 1
    ds_add_u32 v4, v164 offset:112
    s_mov_b64 exec, -1
    ds_read_b32 v7, v1 offset:32
FW_1:
    s_waitcnt lgkmcnt(0)
    v_cmp_gt_u32 vcc, 1, v7
    s_cbranch_vccz FO_2
    s_sleep 2
    ds_read_b32 v7, v1 offset:32
    s_branch FW_1
FO_2:
    ds_read_b32 v7, v1 offset:112
FW_3:
    s_waitcnt lgkmcnt(0)
    v_cmp_gt_u32 vcc, 1, v7
    s_cbranch_vccz FO_4
    ds_read_b32 v7, v1 offset:112
    s_branch FW_3
FO_4:
    ds_read_b64_tr_b16 v[128:129], v10 offset:57344
    ds_read_b64_tr_b16 v[130:131], v10 offset:57856
    ds_read_b64_tr_b16 v[136:137], v11 offset:57344
    ds_read_b64_tr_b16 v[138:139], v11 offset:57856
    ds_read_b64_tr_b16 v[160:161], v12 offset:57344
    ds_read_b64_tr_b16 v[162:163], v12 offset:57856
    ds_read_b64_tr_b16 v[116:117], v13 offset:57344
    ds_read_b64_tr_b16 v[118:119], v13 offset:57856
    ds_read_b64_tr_b16 v[72:73], v10 offset:61440
    ds_read_b64_tr_b16 v[74:75], v10 offset:61952
    s_waitcnt lgkmcnt(8)
    v_mfma_f32_16x16x32_bf16 v[16:19], v[128:131], v[48:51], v[16:19]
    v_mfma_f32_16x16x32_bf16 v[32:35], v[128:131], v[52:55], v[32:35]
    ds_read_b64_tr_b16 v[128:129], v11 offset:61440
    ds_read_b64_tr_b16 v[130:131], v11 offset:61952
    s_waitcnt lgkmcnt(8)
    v_mfma_f32_16x16x32_bf16 v[20:23], v[136:139], v[48:51], v[20:23]
    v_mfma_f32_16x16x32_bf16 v[36:39], v[136:139], v[52:55], v[36:39]
    ds_read_b64_tr_b16 v[136:137], v12 offset:61440
    ds_read_b64_tr_b16 v[138:139], v12 offset:61952
    s_waitcnt lgkmcnt(8)
    v_mfma_f32_16x16x32_bf16 v[24:27], v[160:163], v[48:51], v[24:27]
    v_mfma_f32_16x16x32_bf16 v[40:43], v[160:163], v[52:55], v[40:43]
    ds_read_b64_tr_b16 v[160:161], v13 offset:61440
    ds_read_b64_tr_b16 v[162:163], v13 offset:61952
    s_waitcnt lgkmcnt(8)
    v_mfma_f32_16x16x32_bf16 v[28:31], v[116:119], v[48:51], v[28:31]
    ds_read_b128 v[48:51], v2 offset:0
    v_mfma_f32_16x16x32_bf16 v[44:47], v[116:119], v[52:55], v[44:47]
    ds_read_b64_tr_b16 v[116:117], v10 offset:49152
    ds_read_b64_tr_b16 v[118:119], v10 offset:49664
    s_waitcnt lgkmcnt(9)
    v_mfma_f32_16x16x32_bf16 v[16:19], v[72:75], v[96:99], v[16:19]
    ds_read_b128 v[52:55], v2 offset:2048
    v_mfma_f32_16x16x32_bf16 v[32:35], v[72:75], v[104:107], v[32:35]
    ds_read_b64_tr_b16 v[72:73], v11 offset:49152
    ds_read_b64_tr_b16 v[74:75], v11 offset:49664
    s_waitcnt lgkmcnt(10)
    v_mfma_f32_16x16x32_bf16 v[20:23], v[128:131], v[96:99], v[20:23]
    v_mfma_f32_16x16x32_bf16 v[36:39], v[128:131], v[104:107], v[36:39]
    ds_read_b64_tr_b16 v[128:129], v12 offset:49152
    ds_read_b64_tr_b16 v[130:131], v12 offset:49664
    s_waitcnt lgkmcnt(10)
    v_mfma_f32_16x16x32_bf16 v[24:27], v[136:139], v[96:99], v[24:27]
    v_mfma_f32_16x16x32_bf16 v[40:43], v[136:139], v[104:107], v[40:43]
    ds_read_b64_tr_b16 v[136:137], v13 offset:49152
    ds_read_b64_tr_b16 v[138:139], v13 offset:49664
    s_waitcnt lgkmcnt(10)
    v_mfma_f32_16x16x32_bf16 v[28:31], v[160:163], v[96:99], v[28:31]
    ds_read_b128 v[96:99], v3 offset:0
    v_mfma_f32_16x16x32_bf16 v[44:47], v[160:163], v[104:107], v[44:47]
    ds_read_b64_tr_b16 v[160:161], v10 offset:53248
    ds_read_b64_tr_b16 v[162:163], v10 offset:53760
    s_waitcnt lgkmcnt(10)
    v_mfma_f32_16x16x32_bf16 v[16:19], v[116:119], v[48:51], v[16:19]
    ds_read_b128 v[104:107], v3 offset:2048
    s_waitcnt lgkmcnt(10)
    v_mfma_f32_16x16x32_bf16 v[32:35], v[116:119], v[52:55], v[32:35]
    ds_read_b64_tr_b16 v[116:117], v11 offset:53248
    ds_read_b64_tr_b16 v[118:119], v11 offset:53760
    s_waitcnt lgkmcnt(10)
    v_mfma_f32_16x16x32_bf16 v[20:23], v[72:75], v[48:51], v[20:23]
    v_mfma_f32_16x16x32_bf16 v[36:39], v[72:75], v[52:55], v[36:39]
    ds_read_b64_tr_b16 v[72:73], v12 offset:53248
    ds_read_b64_tr_b16 v[74:75], v12 offset:53760
    s_waitcnt lgkmcnt(10)
    v_mfma_f32_16x16x32_bf16 v[24:27], v[128:131], v[48:51], v[24:27]
    v_mfma_f32_16x16x32_bf16 v[40:43], v[128:131], v[52:55], v[40:43]
    ds_read_b64_tr_b16 v[128:129], v13 offset:53248
    ds_read_b64_tr_b16 v[130:131], v13 offset:53760
    s_waitcnt lgkmcnt(10)
    v_mfma_f32_16x16x32_bf16 v[28:31], v[136:139], v[48:51], v[28:31]
    ds_read_b128 v[48:51], v2 offset:16384
    v_mfma_f32_16x16x32_bf16 v[44:47], v[136:139], v[52:55], v[44:47]
    ds_read_b64_tr_b16 v[136:137], v10 offset:40960
    ds_read_b64_tr_b16 v[138:139], v10 offset:41472
    s_waitcnt lgkmcnt(10)
    v_mfma_f32_16x16x32_bf16 v[16:19], v[160:163], v[96:99], v[16:19]
    ds_read_b128 v[52:55], v2 offset:18432
    s_waitcnt lgkmcnt(10)
    v_mfma_f32_16x16x32_bf16 v[32:35], v[160:163], v[104:107], v[32:35]
    ds_read_b64_tr_b16 v[160:161], v11 offset:40960
    ds_read_b64_tr_b16 v[162:163], v11 offset:41472
    s_waitcnt lgkmcnt(10)
    v_mfma_f32_16x16x32_bf16 v[20:23], v[116:119], v[96:99], v[20:23]
    v_mfma_f32_16x16x32_bf16 v[36:39], v[116:119], v[104:107], v[36:39]
    ds_read_b64_tr_b16 v[116:117], v12 offset:40960
    ds_read_b64_tr_b16 v[118:119], v12 offset:41472
    s_waitcnt lgkmcnt(10)
    v_mfma_f32_16x16x32_bf16 v[24:27], v[72:75], v[96:99], v[24:27]
    v_mfma_f32_16x16x32_bf16 v[40:43], v[72:75], v[104:107], v[40:43]
    ds_read_b64_tr_b16 v[72:73], v13 offset:40960
    ds_read_b64_tr_b16 v[74:75], v13 offset:41472
    s_waitcnt lgkmcnt(10)
    v_mfma_f32_16x16x32_bf16 v[28:31], v[128:131], v[96:99], v[28:31]
    ds_read_b128 v[96:99], v3 offset:16384
    v_mfma_f32_16x16x32_bf16 v[44:47], v[128:131], v[104:107], v[44:47]
    ds_read_b64_tr_b16 v[128:129], v10 offset:45056
    ds_read_b64_tr_b16 v[130:131], v10 offset:45568
    s_waitcnt lgkmcnt(10)
    v_mfma_f32_16x16x32_bf16 v[16:19], v[136:139], v[48:51], v[16:19]
    ds_read_b128 v[104:107], v3 offset:18432
    s_waitcnt lgkmcnt(10)
    v_mfma_f32_16x16x32_bf16 v[32:35], v[136:139], v[52:55], v[32:35]
    ds_read_b64_tr_b16 v[136:137], v11 offset:45056
    ds_read_b64_tr_b16 v[138:139], v11 offset:45568
    s_waitcnt lgkmcnt(10)
    v_mfma_f32_16x16x32_bf16 v[20:23], v[160:163], v[48:51], v[20:23]
    v_mfma_f32_16x16x32_bf16 v[36:39], v[160:163], v[52:55], v[36:39]
    ds_read_b64_tr_b16 v[160:161], v12 offset:45056
    ds_read_b64_tr_b16 v[162:163], v12 offset:45568
    s_waitcnt lgkmcnt(10)
    v_mfma_f32_16x16x32_bf16 v[24:27], v[116:119], v[48:51], v[24:27]
    v_mfma_f32_16x16x32_bf16 v[40:43], v[116:119], v[52:55], v[40:43]
    ds_read_b64_tr_b16 v[116:117], v13 offset:45056
    ds_read_b64_tr_b16 v[118:119], v13 offset:45568
    s_waitcnt lgkmcnt(10)
    v_mfma_f32_16x16x32_bf16 v[28:31], v[72:75], v[48:51], v[28:31]
    ds_read_b128 v[48:51], v2 offset:32768
    v_mfma_f32_16x16x32_bf16 v[44:47], v[72:75], v[52:55], v[44:47]
    ds_read_b64_tr_b16 v[72:73], v5 offset:16384
    ds_read_b64_tr_b16 v[74:75], v5 offset:16896
    s_waitcnt lgkmcnt(10)
    v_mfma_f32_16x16x32_bf16 v[16:19], v[128:131], v[96:99], v[16:19]
    ds_read_b128 v[52:55], v2 offset:34816
    s_waitcnt lgkmcnt(10)
    v_mfma_f32_16x16x32_bf16 v[32:35], v[128:131], v[104:107], v[32:35]
    ds_read_b64_tr_b16 v[128:129], v6 offset:16384
    ds_read_b64_tr_b16 v[130:131], v6 offset:16896
    s_waitcnt lgkmcnt(10)
    v_mfma_f32_16x16x32_bf16 v[20:23], v[136:139], v[96:99], v[20:23]
    v_mfma_f32_16x16x32_bf16 v[36:39], v[136:139], v[104:107], v[36:39]
    ds_read_b64_tr_b16 v[136:137], v8 offset:16384
    ds_read_b64_tr_b16 v[138:139], v8 offset:16896
    s_waitcnt lgkmcnt(10)
    v_mfma_f32_16x16x32_bf16 v[24:27], v[160:163], v[96:99], v[24:27]
    v_mfma_f32_16x16x32_bf16 v[40:43], v[160:163], v[104:107], v[40:43]
    ds_read_b64_tr_b16 v[160:161], v9 offset:16384
    ds_read_b64_tr_b16 v[162:163], v9 offset:16896
    s_waitcnt lgkmcnt(10)
    v_mfma_f32_16x16x32_bf16 v[28:31], v[116:119], v[96:99], v[28:31]
    ds_read_b128 v[96:99], v3 offset:32768
    v_mfma_f32_16x16x32_bf16 v[44:47], v[116:119], v[104:107], v[44:47]
    ds_read_b64_tr_b16 v[116:117], v5 offset:20480
    ds_read_b64_tr_b16 v[118:119], v5 offset:20992
    s_waitcnt lgkmcnt(10)
    v_mfma_f32_16x16x32_bf16 v[16:19], v[72:75], v[48:51], v[16:19]
    ds_read_b128 v[104:107], v3 offset:34816
    s_waitcnt lgkmcnt(10)
    v_mfma_f32_16x16x32_bf16 v[32:35], v[72:75], v[52:55], v[32:35]
    ds_read_b64_tr_b16 v[72:73], v6 offset:20480
    ds_read_b64_tr_b16 v[74:75], v6 offset:20992
    s_waitcnt lgkmcnt(10)
    v_mfma_f32_16x16x32_bf16 v[20:23], v[128:131], v[48:51], v[20:23]
    v_mfma_f32_16x16x32_bf16 v[36:39], v[128:131], v[52:55], v[36:39]
    ds_read_b64_tr_b16 v[128:129], v8 offset:20480
    ds_read_b64_tr_b16 v[130:131], v8 offset:20992
    s_waitcnt lgkmcnt(10)
    v_mfma_f32_16x16x32_bf16 v[24:27], v[136:139], v[48:51], v[24:27]
    v_mfma_f32_16x16x32_bf16 v[40:43], v[136:139], v[52:55], v[40:43]
    ds_read_b64_tr_b16 v[136:137], v9 offset:20480
    ds_read_b64_tr_b16 v[138:139], v9 offset:20992
    s_waitcnt lgkmcnt(10)
    v_mfma_f32_16x16x32_bf16 v[28:31], v[160:163], v[48:51], v[28:31]
    s_waitcnt vmcnt(0)
    s_mov_b64 exec, 1
    ds_add_u32 v4, v164 offset:112
    s_mov_b64 exec, -1
    ds_read_b128 v[48:51], v2 offset:49152
    v_mfma_f32_16x16x32_bf16 v[44:47], v[160:163], v[52:55], v[44:47]
    ds_read_b64_tr_b16 v[160:161], v5 offset:8192
    ds_read_b64_tr_b16 v[162:163], v5 offset:8704
    s_waitcnt lgkmcnt(11)
    v_mfma_f32_16x16x32_bf16 v[16:19], v[116:119], v[96:99], v[16:19]
    ds_read_b128 v[52:55], v2 offset:51200
    s_waitcnt lgkmcnt(11)
    v_mfma_f32_16x16x32_bf16 v[32:35], v[116:119], v[104:107], v[32:35]
    ds_read_b64_tr_b16 v[116:117], v6 offset:8192
    ds_read_b64_tr_b16 v[118:119], v6 offset:8704
    s_waitcnt lgkmcnt(11)
    v_mfma_f32_16x16x32_bf16 v[20:23], v[72:75], v[96:99], v[20:23]
    v_mfma_f32_16x16x32_bf16 v[36:39], v[72:75], v[104:107], v[36:39]
    ds_read_b64_tr_b16 v[72:73], v8 offset:8192
    ds_read_b64_tr_b16 v[74:75], v8 offset:8704
    s_waitcnt lgkmcnt(9)
    v_mov_b32 v165, 4
    s_mov_b64 exec, 1
    ds_write_b32 v4, v165 offset:0
    s_mov_b64 exec, -1
    v_mfma_f32_16x16x32_bf16 v[24:27], v[128:131], v[96:99], v[24:27]
    v_mfma_f32_16x16x32_bf16 v[40:43], v[128:131], v[104:107], v[40:43]
    ds_read_b64_tr_b16 v[128:129], v9 offset:8192
    ds_read_b64_tr_b16 v[130:131], v9 offset:8704
    v_mfma_f32_16x16x32_bf16 v[28:31], v[136:139], v[96:99], v[28:31]
    ds_read_b128 v[96:99], v3 offset:49152
    v_mfma_f32_16x16x32_bf16 v[44:47], v[136:139], v[104:107], v[44:47]
    ds_read_b64_tr_b16 v[136:137], v5 offset:12288
    ds_read_b64_tr_b16 v[138:139], v5 offset:12800
    s_waitcnt lgkmcnt(11)
    v_mfma_f32_16x16x32_bf16 v[16:19], v[160:163], v[48:51], v[16:19]
    ds_read_b128 v[104:107], v3 offset:51200
    s_waitcnt lgkmcnt(11)
    v_mfma_f32_16x16x32_bf16 v[32:35], v[160:163], v[52:55], v[32:35]
    ds_read_b64_tr_b16 v[160:161], v6 offset:12288
    ds_read_b64_tr_b16 v[162:163], v6 offset:12800
    s_waitcnt lgkmcnt(11)
    v_mfma_f32_16x16x32_bf16 v[20:23], v[116:119], v[48:51], v[20:23]
    v_mfma_f32_16x16x32_bf16 v[36:39], v[116:119], v[52:55], v[36:39]
    ds_read_b64_tr_b16 v[116:117], v8 offset:12288
    ds_read_b64_tr_b16 v[118:119], v8 offset:12800
    s_waitcnt lgkmcnt(11)
    v_mfma_f32_16x16x32_bf16 v[24:27], v[72:75], v[48:51], v[24:27]
    v_mfma_f32_16x16x32_bf16 v[40:43], v[72:75], v[52:55], v[40:43]
    ds_read_b64_tr_b16 v[72:73], v9 offset:12288
    ds_read_b64_tr_b16 v[74:75], v9 offset:12800
    s_waitcnt lgkmcnt(10)
    v_mfma_f32_16x16x32_bf16 v[28:31], v[128:131], v[48:51], v[28:31]
    ds_read_b64_tr_b16 v[48:49], v10 offset:8192
    v_mfma_f32_16x16x32_bf16 v[44:47], v[128:131], v[52:55], v[44:47]
    ds_read_b64_tr_b16 v[50:51], v10 offset:8704
    ds_read_b64_tr_b16 v[128:129], v11 offset:8192
    s_waitcnt lgkmcnt(10)
    v_mfma_f32_16x16x32_bf16 v[16:19], v[136:139], v[96:99], v[16:19]
    ds_read_b64_tr_b16 v[130:131], v11 offset:8704
    s_waitcnt lgkmcnt(10)
    v_mfma_f32_16x16x32_bf16 v[32:35], v[136:139], v[104:107], v[32:35]
    ds_read_b64_tr_b16 v[52:53], v12 offset:8192
    ds_read_b64_tr_b16 v[54:55], v12 offset:8704
    s_waitcnt lgkmcnt(10)
    v_mfma_f32_16x16x32_bf16 v[20:23], v[160:163], v[96:99], v[20:23]
    ds_read_b64_tr_b16 v[136:137], v13 offset:8192
    v_mfma_f32_16x16x32_bf16 v[36:39], v[160:163], v[104:107], v[36:39]
    ds_read_b64_tr_b16 v[138:139], v13 offset:8704
    ds_read_b64_tr_b16 v[160:161], v10 offset:12288
    s_waitcnt lgkmcnt(11)
    v_mfma_f32_16x16x32_bf16 v[24:27], v[116:119], v[96:99], v[24:27]
    ds_read_b64_tr_b16 v[162:163], v10 offset:12800
    v_mfma_f32_16x16x32_bf16 v[40:43], v[116:119], v[104:107], v[40:43]
    ds_read_b64_tr_b16 v[116:117], v11 offset:12288
    ds_read_b64_tr_b16 v[118:119], v11 offset:12800
    s_waitcnt lgkmcnt(12)
    v_mfma_f32_16x16x32_bf16 v[28:31], v[72:75], v[96:99], v[28:31]
    ds_read_b64_tr_b16 v[96:97], v12 offset:12288
    v_mfma_f32_16x16x32_bf16 v[44:47], v[72:75], v[104:107], v[44:47]
    ds_read_b64_tr_b16 v[98:99], v12 offset:12800
    ds_read_b64_tr_b16 v[72:73], v13 offset:12288
    s_waitcnt lgkmcnt(13)
    v_mfma_f32_16x16x32_bf16 v[16:19], v[48:51], v[60:63], v[16:19]
    ds_read_b64_tr_b16 v[74:75], v13 offset:12800
    v_mfma_f32_16x16x32_bf16 v[32:35], v[48:51], v[132:135], v[32:35]
    ds_read_b32 v7, v1 offset:112
FW_5:
    s_waitcnt lgkmcnt(0)
    v_cmp_gt_u32 vcc, 2, v7
    s_cbranch_vccz FO_6
    ds_read_b32 v7, v1 offset:112
    s_branch FW_5
FO_6:
    ds_read_b64_tr_b16 v[104:105], v10 offset:0
    ds_read_b64_tr_b16 v[106:107], v10 offset:512
    v_mfma_f32_16x16x32_bf16 v[20:23], v[128:131], v[60:63], v[20:23]
    ds_read_b64_tr_b16 v[48:49], v11 offset:0
    v_mfma_f32_16x16x32_bf16 v[36:39], v[128:131], v[132:135], v[36:39]
    ds_read_b64_tr_b16 v[50:51], v11 offset:512
    ds_read_b64_tr_b16 v[128:129], v12 offset:0
    v_mfma_f32_16x16x32_bf16 v[24:27], v[52:55], v[60:63], v[24:27]
    ds_read_b64_tr_b16 v[130:131], v12 offset:512
    v_mfma_f32_16x16x32_bf16 v[40:43], v[52:55], v[132:135], v[40:43]
    ds_read_b64_tr_b16 v[52:53], v13 offset:0
    ds_read_b64_tr_b16 v[54:55], v13 offset:512
    v_mfma_f32_16x16x32_bf16 v[28:31], v[136:139], v[60:63], v[28:31]
    v_mfma_f32_16x16x32_bf16 v[44:47], v[136:139], v[132:135], v[44:47]
    v_mfma_f32_16x16x32_bf16 v[16:19], v[160:163], v[68:71], v[16:19]
    ds_read_b64_tr_b16 v[60:61], v10 offset:4096
    v_mfma_f32_16x16x32_bf16 v[32:35], v[160:163], v[152:155], v[32:35]
    ds_read_b64_tr_b16 v[62:63], v10 offset:4608
    ds_read_b64_tr_b16 v[136:137], v11 offset:4096
    v_mfma_f32_16x16x32_bf16 v[20:23], v[116:119], v[68:71], v[20:23]
    ds_read_b64_tr_b16 v[138:139], v11 offset:4608
    v_mfma_f32_16x16x32_bf16 v[36:39], v[116:119], v[152:155], v[36:39]
    ds_read_b64_tr_b16 v[132:133], v12 offset:4096
    ds_read_b64_tr_b16 v[134:135], v12 offset:4608
    v_mfma_f32_16x16x32_bf16 v[24:27], v[96:99], v[68:71], v[24:27]
    ds_read_b64_tr_b16 v[160:161], v13 offset:4096
    v_mfma_f32_16x16x32_bf16 v[40:43], v[96:99], v[152:155], v[40:43]
    s_waitcnt lgkmcnt(8)
    ds_read_b64_tr_b16 v[162:163], v13 offset:4608
    v_mfma_f32_16x16x32_bf16 v[28:31], v[72:75], v[68:71], v[28:31]
    v_mfma_f32_16x16x32_bf16 v[44:47], v[72:75], v[152:155], v[44:47]
    s_waitcnt lgkmcnt(14)
    v_mfma_f32_16x16x32_bf16 v[16:19], v[104:107], v[84:87], v[16:19]
    ds_read_b64_tr_b16 v[116:117], v10 offset:24576
    v_mfma_f32_16x16x32_bf16 v[32:35], v[104:107], v[92:95], v[32:35]
    ds_read_b64_tr_b16 v[118:119], v10 offset:25088
    ds_read_b64_tr_b16 v[96:97], v11 offset:24576
    s_waitcnt lgkmcnt(15)
    v_mfma_f32_16x16x32_bf16 v[20:23], v[48:51], v[84:87], v[20:23]
    ds_read_b64_tr_b16 v[98:99], v11 offset:25088
    v_mfma_f32_16x16x32_bf16 v[36:39], v[48:51], v[92:95], v[36:39]
    ds_read_b64_tr_b16 v[68:69], v12 offset:24576
    ds_read_b64_tr_b16 v[70:71], v12 offset:25088
    s_waitcnt lgkmcnt(15)
    v_mfma_f32_16x16x32_bf16 v[24:27], v[128:131], v[84:87], v[24:27]
    s_waitcnt lgkmcnt(8)
    ds_read_b64_tr_b16 v[72:73], v13 offset:24576
    v_mfma_f32_16x16x32_bf16 v[40:43], v[128:131], v[92:95], v[40:43]
    ds_read_b64_tr_b16 v[74:75], v13 offset:25088
    s_waitcnt lgkmcnt(15)
    v_mfma_f32_16x16x32_bf16 v[28:31], v[52:55], v[84:87], v[28:31]
    v_mfma_f32_16x16x32_bf16 v[44:47], v[52:55], v[92:95], v[44:47]
    s_waitcnt lgkmcnt(14)
    v_mfma_f32_16x16x32_bf16 v[16:19], v[60:63], v[100:103], v[16:19]
    ds_read_b64_tr_b16 v[152:153], v10 offset:28672
    v_mfma_f32_16x16x32_bf16 v[32:35], v[60:63], v[108:111], v[32:35]
    ds_read_b64_tr_b16 v[154:155], v10 offset:29184
    ds_read_b64_tr_b16 v[104:105], v11 offset:28672
    s_waitcnt lgkmcnt(15)
    v_mfma_f32_16x16x32_bf16 v[20:23], v[136:139], v[100:103], v[20:23]
    ds_read_b64_tr_b16 v[106:107], v11 offset:29184
    v_mfma_f32_16x16x32_bf16 v[36:39], v[136:139], v[108:111], v[36:39]
    ds_read_b64_tr_b16 v[48:49], v12 offset:28672
    s_waitcnt lgkmcnt(8)
    ds_read_b64_tr_b16 v[50:51], v12 offset:29184
    s_waitcnt lgkmcnt(15)
    v_mfma_f32_16x16x32_bf16 v[24:27], v[132:135], v[100:103], v[24:27]
    ds_read_b64_tr_b16 v[128:129], v13 offset:28672
    v_mfma_f32_16x16x32_bf16 v[40:43], v[132:135], v[108:111], v[40:43]
    ds_read_b64_tr_b16 v[130:131], v13 offset:29184
    s_waitcnt lgkmcnt(15)
    v_mfma_f32_16x16x32_bf16 v[28:31], v[160:163], v[100:103], v[28:31]
    v_mfma_f32_16x16x32_bf16 v[44:47], v[160:163], v[108:111], v[44:47]
    s_waitcnt lgkmcnt(14)
    v_mfma_f32_16x16x32_bf16 v[16:19], v[116:119], v[56:59], v[16:19]
    ds_read_b64_tr_b16 v[84:85], v10 offset:16384
    v_mfma_f32_16x16x32_bf16 v[32:35], v[116:119], v[124:127], v[32:35]
    ds_read_b64_tr_b16 v[86:87], v10 offset:16896
    ds_read_b64_tr_b16 v[52:53], v11 offset:16384
    s_waitcnt lgkmcnt(15)
    v_mfma_f32_16x16x32_bf16 v[20:23], v[96:99], v[56:59], v[20:23]
    ds_read_b64_tr_b16 v[54:55], v11 offset:16896
    v_mfma_f32_16x16x32_bf16 v[36:39], v[96:99], v[124:127], v[36:39]
    s_waitcnt lgkmcnt(8)
    ds_read_b64_tr_b16 v[92:93], v12 offset:16384
    ds_read_b64_tr_b16 v[94:95], v12 offset:16896
    s_waitcnt lgkmcnt(15)
    v_mfma_f32_16x16x32_bf16 v[24:27], v[68:71], v[56:59], v[24:27]
    ds_read_b64_tr_b16 v[60:61], v13 offset:16384
    v_mfma_f32_16x16x32_bf16 v[40:43], v[68:71], v[124:127], v[40:43]
    ds_read_b64_tr_b16 v[62:63], v13 offset:16896
    s_waitcnt lgkmcnt(15)
    v_mfma_f32_16x16x32_bf16 v[28:31], v[72:75], v[56:59], v[28:31]
    v_mfma_f32_16x16x32_bf16 v[44:47], v[72:75], v[124:127], v[44:47]
    s_waitcnt lgkmcnt(14)
    v_mfma_f32_16x16x32_bf16 v[16:19], v[152:155], v[76:79], v[16:19]
    ds_read_b64_tr_b16 v[136:137], v10 offset:20480
    v_mfma_f32_16x16x32_bf16 v[32:35], v[152:155], v[148:151], v[32:35]
    ds_read_b64_tr_b16 v[138:139], v10 offset:20992
    ds_read_b64_tr_b16 v[132:133], v11 offset:20480
    s_waitcnt lgkmcnt(15)
    v_mfma_f32_16x16x32_bf16 v[20:23], v[104:107], v[76:79], v[20:23]
    s_waitcnt lgkmcnt(8)
    ds_read_b64_tr_b16 v[134:135], v11 offset:20992
    v_mfma_f32_16x16x32_bf16 v[36:39], v[104:107], v[148:151], v[36:39]
    ds_read_b64_tr_b16 v[100:101], v12 offset:20480
    ds_read_b64_tr_b16 v[102:103], v12 offset:20992
    s_waitcnt lgkmcnt(15)
    v_mfma_f32_16x16x32_bf16 v[24:27], v[48:51], v[76:79], v[24:27]
    ds_read_b64_tr_b16 v[160:161], v13 offset:20480
    v_mfma_f32_16x16x32_bf16 v[40:43], v[48:51], v[148:151], v[40:43]
    ds_read_b64_tr_b16 v[162:163], v13 offset:20992
    s_waitcnt lgkmcnt(15)
    v_mfma_f32_16x16x32_bf16 v[28:31], v[128:131], v[76:79], v[28:31]
    v_mfma_f32_16x16x32_bf16 v[44:47], v[128:131], v[148:151], v[44:47]
    s_waitcnt lgkmcnt(14)
    v_mfma_f32_16x16x32_bf16 v[16:19], v[84:87], v[88:91], v[16:19]
    ds_read_b64_tr_b16 v[108:109], v10 offset:32768
    v_mfma_f32_16x16x32_bf16 v[32:35], v[84:87], v[64:67], v[32:35]
    ds_read_b64_tr_b16 v[110:111], v10 offset:33280
    s_waitcnt lgkmcnt(8)
    ds_read_b64_tr_b16 v[116:117], v11 offset:32768
    s_waitcnt lgkmcnt(15)
    v_mfma_f32_16x16x32_bf16 v[20:23], v[52:55], v[88:91], v[20:23]
    ds_read_b64_tr_b16 v[118:119], v11 offset:33280
    v_mfma_f32_16x16x32_bf16 v[36:39], v[52:55], v[64:67], v[36:39]
    ds_read_b64_tr_b16 v[96:97], v12 offset:32768
    ds_read_b64_tr_b16 v[98:99], v12 offset:33280
    s_waitcnt lgkmcnt(15)
    v_mfma_f32_16x16x32_bf16 v[24:27], v[92:95], v[88:91], v[24:27]
    ds_read_b64_tr_b16 v[68:69], v13 offset:32768
    v_mfma_f32_16x16x32_bf16 v[40:43], v[92:95], v[64:67], v[40:43]
    ds_read_b64_tr_b16 v[70:71], v13 offset:33280
    s_waitcnt lgkmcnt(15)
    v_mfma_f32_16x16x32_bf16 v[28:31], v[60:63], v[88:91], v[28:31]
    v_mfma_f32_16x16x32_bf16 v[44:47], v[60:63], v[64:67], v[44:47]
    s_waitcnt lgkmcnt(14)
    v_mfma_f32_16x16x32_bf16 v[16:19], v[136:139], v[80:83], v[16:19]
    ds_read_b64_tr_b16 v[56:57], v10 offset:36864
    v_mfma_f32_16x16x32_bf16 v[32:35], v[136:139], v[112:115], v[32:35]
    s_waitcnt lgkmcnt(8)
    ds_read_b64_tr_b16 v[58:59], v10 offset:37376
    ds_read_b64_tr_b16 v[72:73], v11 offset:36864
    s_waitcnt lgkmcnt(15)
    v_mfma_f32_16x16x32_bf16 v[20:23], v[132:135], v[80:83], v[20:23]
    ds_read_b64_tr_b16 v[74:75], v11 offset:37376
    v_mfma_f32_16x16x32_bf16 v[36:39], v[132:135], v[112:115], v[36:39]
    ds_read_b64_tr_b16 v[124:125], v12 offset:36864
    ds_read_b64_tr_b16 v[126:127], v12 offset:37376
    s_waitcnt lgkmcnt(15)
    v_mfma_f32_16x16x32_bf16 v[24:27], v[100:103], v[80:83], v[24:27]
    ds_read_b64_tr_b16 v[152:153], v13 offset:36864
    v_mfma_f32_16x16x32_bf16 v[40:43], v[100:103], v[112:115], v[40:43]
    ds_read_b64_tr_b16 v[154:155], v13 offset:37376
    s_waitcnt lgkmcnt(15)
    v_mfma_f32_16x16x32_bf16 v[28:31], v[160:163], v[80:83], v[28:31]
    v_mfma_f32_16x16x32_bf16 v[44:47], v[160:163], v[112:115], v[44:47]
    s_waitcnt lgkmcnt(14)
    v_mfma_f32_16x16x32_bf16 v[16:19], v[108:111], v[140:143], v[16:19]
    v_mfma_f32_16x16x32_bf16 v[32:35], v[108:111], v[120:123], v[32:35]
    s_waitcnt lgkmcnt(12)
    v_mfma_f32_16x16x32_bf16 v[20:23], v[116:119], v[140:143], v[20:23]
    s_waitcnt lgkmcnt(0)
    v_mov_b32 v165, 10
    s_mov_b64 exec, 1
    ds_write_b32 v4, v165 offset:0
    s_mov_b64 exec, -1
    v_mfma_f32_16x16x32_bf16 v[36:39], v[116:119], v[120:123], v[36:39]
    v_mfma_f32_16x16x32_bf16 v[24:27], v[96:99], v[140:143], v[24:27]
    v_mfma_f32_16x16x32_bf16 v[40:43], v[96:99], v[120:123], v[40:43]
    v_mfma_f32_16x16x32_bf16 v[28:31], v[68:71], v[140:143], v[28:31]
    v_mfma_f32_16x16x32_bf16 v[44:47], v[68:71], v[120:123], v[44:47]
    v_mfma_f32_16x16x32_bf16 v[16:19], v[56:59], v[144:147], v[16:19]
    v_mfma_f32_16x16x32_bf16 v[32:35], v[56:59], v[156:159], v[32:35]
    v_mfma_f32_16x16x32_bf16 v[20:23], v[72:75], v[144:147], v[20:23]
    v_mfma_f32_16x16x32_bf16 v[36:39], v[72:75], v[156:159], v[36:39]
    v_mfma_f32_16x16x32_bf16 v[24:27], v[124:127], v[144:147], v[24:27]
    v_mfma_f32_16x16x32_bf16 v[40:43], v[124:127], v[156:159], v[40:43]
    v_mfma_f32_16x16x32_bf16 v[28:31], v[152:155], v[144:147], v[28:31]
    v_mfma_f32_16x16x32_bf16 v[44:47], v[152:155], v[156:159], v[44:47]
    s_setprio 3
    s_mov_b32 s40, 0x21317218
    s_mov_b32 s41, s40
    s_mov_b32 s74, 0x358637bd
    s_mov_b32 s75, s74
    s_mov_b32 s76, 0x5d800000
    s_mov_b32 s77, s76
    v_and_b32 v2, 15, v0
    v_lshlrev_b32 v2, 2, v2
    s_lshl_b32 s42, s3, 7
    s_add_u32 s42, s42, 155648
    v_add_u32 v2, s42, v2
    v_add_u32 v3, 1024, v2
    v_and_b32 v5, 0x30, v0
    v_add_u32 v5, 158208, v5

    ds_read2_b32 v[48:49], v2 offset0:0 offset1:0
    ds_read2_b32 v[50:51], v2 offset0:16 offset1:16
    ds_read_b128 v[56:59], v5 offset:0
    ds_read_b128 v[60:63], v5 offset:64
    ds_read_b128 v[64:67], v5 offset:128
    ds_read_b128 v[68:71], v5 offset:192
    ds_read2_b32 v[52:53], v3 offset0:0 offset1:0
    ds_read2_b32 v[54:55], v3 offset0:16 offset1:16
    v_lshlrev_b32 v6, 4, v0
    v_lshlrev_b32 v8, 2, v0
    v_add_u32 v8, 40960, v8
    s_lshl_b32 s79, s32, 18
    s_lshl_b32 s80, s3, 16
    s_add_u32 s79, s79, s80
    s_lshl_b32 s80, s10, 11
    s_add_u32 s79, s79, s80
    s_add_u32 s80, s79, 0x8000
    s_lshl_b32 s45, s32, 2
    s_add_u32 s45, s45, s3
    s_lshl_b32 s45, s45, 10
    s_mov_b32 s46, 0x3fb8aa3b
    v_mov_b32 v11, 0x35c1a2a0

    s_add_u32 s54, s45, 0x835000
    s_add_u32 s54, s72, s54
    s_addc_u32 s55, s73, 0
    s_waitcnt lgkmcnt(5)
    v_pk_fma_f32 v[16:17], v[56:57], v[48:49], v[16:17]
    v_pk_fma_f32 v[18:19], v[58:59], v[48:49], v[18:19]
    v_pk_fma_f32 v[32:33], v[56:57], v[50:51], v[32:33]
    v_pk_fma_f32 v[34:35], v[58:59], v[50:51], v[34:35]
    s_waitcnt lgkmcnt(4)
    v_pk_fma_f32 v[20:21], v[60:61], v[48:49], v[20:21]
    v_pk_fma_f32 v[22:23], v[62:63], v[48:49], v[22:23]
    v_pk_fma_f32 v[36:37], v[60:61], v[50:51], v[36:37]
    v_pk_fma_f32 v[38:39], v[62:63], v[50:51], v[38:39]
    s_waitcnt lgkmcnt(3)
    v_pk_fma_f32 v[24:25], v[64:65], v[48:49], v[24:25]
    v_pk_fma_f32 v[26:27], v[66:67], v[48:49], v[26:27]
    v_pk_fma_f32 v[40:41], v[64:65], v[50:51], v[40:41]
    v_pk_fma_f32 v[42:43], v[66:67], v[50:51], v[42:43]
    s_waitcnt lgkmcnt(2)
    v_pk_fma_f32 v[28:29], v[68:69], v[48:49], v[28:29]
    v_pk_fma_f32 v[30:31], v[70:71], v[48:49], v[30:31]
    v_pk_fma_f32 v[44:45], v[68:69], v[50:51], v[44:45]
    v_pk_fma_f32 v[46:47], v[70:71], v[50:51], v[46:47]
    s_waitcnt lgkmcnt(1)
    v_pk_mul_f32 v[16:17], v[16:17], v[52:53]
    s_branch IW_s2
IW_w2:
    s_branch IW_r2
IW_s2:
    v_pk_mul_f32 v[18:19], v[18:19], v[52:53]
    v_pk_mul_f32 v[20:21], v[20:21], v[52:53]
    v_pk_mul_f32 v[22:23], v[22:23], v[52:53]
    v_pk_mul_f32 v[24:25], v[24:25], v[52:53]
    v_pk_mul_f32 v[26:27], v[26:27], v[52:53]
    v_pk_mul_f32 v[28:29], v[28:29], v[52:53]
    v_pk_mul_f32 v[30:31], v[30:31], v[52:53]
    s_waitcnt lgkmcnt(0)
    v_pk_mul_f32 v[32:33], v[32:33], v[54:55]
    v_pk_mul_f32 v[34:35], v[34:35], v[54:55]
    v_pk_mul_f32 v[36:37], v[36:37], v[54:55]
    v_pk_mul_f32 v[38:39], v[38:39], v[54:55]
    v_pk_mul_f32 v[40:41], v[40:41], v[54:55]
    v_pk_mul_f32 v[42:43], v[42:43], v[54:55]
    v_pk_mul_f32 v[44:45], v[44:45], v[54:55]
    v_pk_mul_f32 v[46:47], v[46:47], v[54:55]
    v_exp_f32 v80, v16 clamp
    v_exp_f32 v81, v17 clamp
    v_exp_f32 v82, v18 clamp
    v_exp_f32 v83, v19 clamp
    v_exp_f32 v84, v20 clamp
    v_exp_f32 v85, v21 clamp
    v_exp_f32 v86, v22 clamp
    v_exp_f32 v87, v23 clamp
    v_exp_f32 v88, v24 clamp
    v_exp_f32 v89, v25 clamp
    v_exp_f32 v90, v26 clamp
    v_exp_f32 v91, v27 clamp
    v_exp_f32 v92, v28 clamp
    v_exp_f32 v93, v29 clamp
    v_exp_f32 v94, v30 clamp
    v_exp_f32 v95, v31 clamp
    v_exp_f32 v96, v32 clamp
    v_exp_f32 v97, v33 clamp
    v_exp_f32 v98, v34 clamp
    v_exp_f32 v99, v35 clamp
    v_exp_f32 v100, v36 clamp
    v_exp_f32 v101, v37 clamp
    v_exp_f32 v102, v38 clamp
    v_exp_f32 v103, v39 clamp
    v_exp_f32 v104, v40 clamp
    v_exp_f32 v105, v41 clamp
    v_exp_f32 v106, v42 clamp
    v_exp_f32 v107, v43 clamp
    v_exp_f32 v108, v44 clamp
    v_exp_f32 v109, v45 clamp
    v_exp_f32 v110, v46 clamp
    v_exp_f32 v111, v47 clamp
    v_pk_mul_f32 v[16:17], v[16:17], s[40:41] clamp
    v_pk_mul_f32 v[18:19], v[18:19], s[40:41] clamp
    v_pk_mul_f32 v[20:21], v[20:21], s[40:41] clamp
    v_pk_mul_f32 v[22:23], v[22:23], s[40:41] clamp
    v_pk_mul_f32 v[24:25], v[24:25], s[40:41] clamp
    v_pk_mul_f32 v[26:27], v[26:27], s[40:41] clamp
    v_pk_mul_f32 v[28:29], v[28:29], s[40:41] clamp
    v_pk_mul_f32 v[30:31], v[30:31], s[40:41] clamp
    v_pk_mul_f32 v[32:33], v[32:33], s[40:41] clamp
    v_pk_mul_f32 v[34:35], v[34:35], s[40:41] clamp
    v_pk_mul_f32 v[36:37], v[36:37], s[40:41] clamp
    v_pk_mul_f32 v[38:39], v[38:39], s[40:41] clamp
    v_pk_mul_f32 v[40:41], v[40:41], s[40:41] clamp
    v_pk_mul_f32 v[42:43], v[42:43], s[40:41] clamp
    v_pk_mul_f32 v[44:45], v[44:45], s[40:41] clamp
    v_pk_mul_f32 v[46:47], v[46:47], s[40:41] clamp
    v_pk_add_f32 v[80:81], v[80:81], s[74:75]
    v_pk_add_f32 v[82:83], v[82:83], s[74:75]
    v_pk_add_f32 v[84:85], v[84:85], s[74:75]
    v_pk_add_f32 v[86:87], v[86:87], s[74:75]
    v_pk_add_f32 v[88:89], v[88:89], s[74:75]
    v_pk_add_f32 v[90:91], v[90:91], s[74:75]
    v_pk_add_f32 v[92:93], v[92:93], s[74:75]
    v_pk_add_f32 v[94:95], v[94:95], s[74:75]
    v_pk_add_f32 v[96:97], v[96:97], s[74:75]
    v_pk_add_f32 v[98:99], v[98:99], s[74:75]
    v_pk_add_f32 v[100:101], v[100:101], s[74:75]
    v_pk_add_f32 v[102:103], v[102:103], s[74:75]
    v_pk_add_f32 v[104:105], v[104:105], s[74:75]
    v_pk_add_f32 v[106:107], v[106:107], s[74:75]
    v_pk_add_f32 v[108:109], v[108:109], s[74:75]
    v_pk_add_f32 v[110:111], v[110:111], s[74:75]
    v_pk_fma_f32 v[16:17], v[16:17], s[76:77], v[80:81]
    v_pk_fma_f32 v[18:19], v[18:19], s[76:77], v[82:83]
    v_pk_fma_f32 v[20:21], v[20:21], s[76:77], v[84:85]
    v_pk_fma_f32 v[22:23], v[22:23], s[76:77], v[86:87]
    v_pk_fma_f32 v[24:25], v[24:25], s[76:77], v[88:89]
    v_pk_fma_f32 v[26:27], v[26:27], s[76:77], v[90:91]
    v_pk_fma_f32 v[28:29], v[28:29], s[76:77], v[92:93]
    v_pk_fma_f32 v[30:31], v[30:31], s[76:77], v[94:95]
    v_pk_fma_f32 v[32:33], v[32:33], s[76:77], v[96:97]
    v_pk_fma_f32 v[34:35], v[34:35], s[76:77], v[98:99]
    v_pk_fma_f32 v[36:37], v[36:37], s[76:77], v[100:101]
    v_pk_fma_f32 v[38:39], v[38:39], s[76:77], v[102:103]
    v_pk_fma_f32 v[40:41], v[40:41], s[76:77], v[104:105]
    v_pk_fma_f32 v[42:43], v[42:43], s[76:77], v[106:107]
    v_pk_fma_f32 v[44:45], v[44:45], s[76:77], v[108:109]
    v_pk_fma_f32 v[46:47], v[46:47], s[76:77], v[110:111]
    v_cvt_pk_bf16_f32 v112, v16, v17
    v_cvt_pk_bf16_f32 v113, v18, v19
    v_cvt_pk_bf16_f32 v114, v20, v21
    v_cvt_pk_bf16_f32 v115, v22, v23
    v_cvt_pk_bf16_f32 v116, v24, v25
    v_cvt_pk_bf16_f32 v117, v26, v27
    v_cvt_pk_bf16_f32 v118, v28, v29
    v_cvt_pk_bf16_f32 v119, v30, v31
    v_cvt_pk_bf16_f32 v120, v32, v33
    v_cvt_pk_bf16_f32 v121, v34, v35
    v_cvt_pk_bf16_f32 v122, v36, v37
    v_cvt_pk_bf16_f32 v123, v38, v39
    v_cvt_pk_bf16_f32 v124, v40, v41
    v_cvt_pk_bf16_f32 v125, v42, v43
    v_cvt_pk_bf16_f32 v126, v44, v45
    v_cvt_pk_bf16_f32 v127, v46, v47
    v_and_b32 v9, 0xfffffff7, v1
    v_and_b32 v5, 0x30, v0
    v_add_u32 v5, 159232, v5
    ds_read_b32 v7, v9 offset:128
FW_7:
    s_waitcnt lgkmcnt(0)
    v_cmp_gt_u32 vcc, 1, v7
    s_cbranch_vccz FO_8
    s_sleep 1
    ds_read_b32 v7, v9 offset:128
    s_branch FW_7
FO_8:
    ds_read_b32 v7, v9 offset:128
FW_9:
    s_waitcnt lgkmcnt(0)
    v_cmp_gt_u32 vcc, 2, v7
    s_cbranch_vccz FO_10
    ds_read_b32 v7, v9 offset:128
    s_branch FW_9
FO_10:
    ds_read_b128 v[32:35], v5 offset:0
    ds_read_b128 v[36:39], v5 offset:64
    ds_read2st64_b32 v[16:17], v8 offset0:0 offset1:1
    ds_read2st64_b32 v[18:19], v8 offset0:2 offset1:3
    ds_read2st64_b32 v[20:21], v8 offset0:4 offset1:5
    ds_read2st64_b32 v[22:23], v8 offset0:6 offset1:7
    ds_read2st64_b32 v[24:25], v8 offset0:16 offset1:17
    ds_read2st64_b32 v[26:27], v8 offset0:18 offset1:19
    ds_read2st64_b32 v[28:29], v8 offset0:20 offset1:21
    ds_read2st64_b32 v[30:31], v8 offset0:22 offset1:23
    s_waitcnt lgkmcnt(5)
    ds_read_b128 v[56:59], v5 offset:128
    ds_read_b128 v[60:63], v5 offset:192
    ds_read2st64_b32 v[40:41], v8 offset0:8 offset1:9
    ds_read2st64_b32 v[42:43], v8 offset0:10 offset1:11
    ds_read2st64_b32 v[44:45], v8 offset0:12 offset1:13
    ds_read2st64_b32 v[46:47], v8 offset0:14 offset1:15
    ds_read2st64_b32 v[48:49], v8 offset0:24 offset1:25
    ds_read2st64_b32 v[50:51], v8 offset0:26 offset1:27
    ds_read2st64_b32 v[52:53], v8 offset0:28 offset1:29
    ds_read2st64_b32 v[54:55], v8 offset0:30 offset1:31
    s_waitcnt lgkmcnt(10)
    v_cvt_pk_bf16_f32 v136, v32, v33
    v_cvt_pk_bf16_f32 v137, v34, v35
    v_cvt_pk_bf16_f32 v138, v36, v37
    v_cvt_pk_bf16_f32 v139, v38, v39
    s_nop 1
    v_mfma_f32_16x16x32_bf16 v[72:75], v[136:139], v[112:115], 0
    v_mfma_f32_16x16x32_bf16 v[84:87], v[136:139], v[120:123], 0
    v_cvt_pk_bf16_f32 v128, v16, v17
    v_cvt_pk_bf16_f32 v129, v18, v19
    v_cvt_pk_bf16_f32 v130, v20, v21
    v_cvt_pk_bf16_f32 v131, v22, v23
    s_nop 1
    v_mfma_f32_16x16x32_bf16 v[64:67], v[128:131], v[112:115], 0
    v_mfma_f32_16x16x32_bf16 v[76:79], v[128:131], v[120:123], 0
    v_cvt_pk_bf16_f32 v132, v24, v25
    v_cvt_pk_bf16_f32 v133, v26, v27
    v_cvt_pk_bf16_f32 v134, v28, v29
    v_cvt_pk_bf16_f32 v135, v30, v31
    s_nop 1
    v_mfma_f32_16x16x32_bf16 v[68:71], v[132:135], v[112:115], 0
    v_mfma_f32_16x16x32_bf16 v[80:83], v[132:135], v[120:123], 0
    s_waitcnt lgkmcnt(0)
    v_cvt_pk_bf16_f32 v148, v56, v57
    v_cvt_pk_bf16_f32 v149, v58, v59
    v_cvt_pk_bf16_f32 v150, v60, v61
    v_cvt_pk_bf16_f32 v151, v62, v63
    v_fma_f32 v72, v72, s46, v11
    v_rcp_f32 v72, v72
    v_fma_f32 v84, v84, s46, v11
    v_rcp_f32 v84, v84
    v_mfma_f32_16x16x32_bf16 v[96:99], v[148:151], v[116:119], 0
    v_mfma_f32_16x16x32_bf16 v[108:111], v[148:151], v[124:127], 0
    v_cvt_pk_bf16_f32 v140, v40, v41
    v_cvt_pk_bf16_f32 v141, v42, v43
    v_cvt_pk_bf16_f32 v142, v44, v45
    v_cvt_pk_bf16_f32 v143, v46, v47
    s_nop 1
    v_mfma_f32_16x16x32_bf16 v[88:91], v[140:143], v[116:119], 0
    v_mfma_f32_16x16x32_bf16 v[100:103], v[140:143], v[124:127], 0
    v_mul_f32 v64, v64, v72
    v_mul_f32 v65, v65, v72
    v_mul_f32 v66, v66, v72
    v_mul_f32 v67, v67, v72
    v_mul_f32 v68, v68, v72
    v_mul_f32 v69, v69, v72
    v_mul_f32 v70, v70, v72
    v_mul_f32 v71, v71, v72
    v_cvt_pk_bf16_f32 v16, v64, v65
    v_cvt_pk_bf16_f32 v17, v66, v67
    v_cvt_pk_bf16_f32 v18, v68, v69
    v_cvt_pk_bf16_f32 v19, v70, v71
    buffer_store_dwordx4 v[16:19], v6, s[16:19], s79 offen offset:0 sc0 sc1
    v_cvt_pk_bf16_f32 v144, v48, v49
    v_cvt_pk_bf16_f32 v145, v50, v51
    v_cvt_pk_bf16_f32 v146, v52, v53
    v_cvt_pk_bf16_f32 v147, v54, v55
    s_nop 1
    v_mfma_f32_16x16x32_bf16 v[92:95], v[144:147], v[116:119], 0
    v_mfma_f32_16x16x32_bf16 v[104:107], v[144:147], v[124:127], 0
    v_mul_f32 v76, v76, v84
    v_mul_f32 v77, v77, v84
    v_mul_f32 v78, v78, v84
    v_mul_f32 v79, v79, v84
    v_mul_f32 v80, v80, v84
    v_mul_f32 v81, v81, v84
    v_mul_f32 v82, v82, v84
    v_mul_f32 v83, v83, v84
    v_cvt_pk_bf16_f32 v20, v76, v77
    v_cvt_pk_bf16_f32 v21, v78, v79
    v_cvt_pk_bf16_f32 v22, v80, v81
    v_cvt_pk_bf16_f32 v23, v82, v83
    buffer_store_dwordx4 v[20:23], v6, s[16:19], s80 offen offset:0 sc0 sc1
    v_fma_f32 v96, v96, s46, v11
    v_rcp_f32 v96, v96
    v_fma_f32 v108, v108, s46, v11
    v_rcp_f32 v108, v108
    v_mul_f32 v88, v88, v96
    v_mul_f32 v89, v89, v96
    v_mul_f32 v90, v90, v96
    v_mul_f32 v91, v91, v96
    v_mul_f32 v92, v92, v96
    v_mul_f32 v93, v93, v96
    v_mul_f32 v94, v94, v96
    v_mul_f32 v95, v95, v96
    v_cvt_pk_bf16_f32 v24, v88, v89
    v_cvt_pk_bf16_f32 v25, v90, v91
    v_cvt_pk_bf16_f32 v26, v92, v93
    v_cvt_pk_bf16_f32 v27, v94, v95
    buffer_store_dwordx4 v[24:27], v6, s[16:19], s79 offen offset:1024 sc0 sc1
    v_mul_f32 v100, v100, v108
    v_mul_f32 v101, v101, v108
    v_mul_f32 v102, v102, v108
    v_mul_f32 v103, v103, v108
    v_mul_f32 v104, v104, v108
    v_mul_f32 v105, v105, v108
    v_mul_f32 v106, v106, v108
    v_mul_f32 v107, v107, v108
    v_cvt_pk_bf16_f32 v28, v100, v101
    v_cvt_pk_bf16_f32 v29, v102, v103
    v_cvt_pk_bf16_f32 v30, v104, v105
    v_cvt_pk_bf16_f32 v31, v106, v107
    buffer_store_dwordx4 v[28:31], v6, s[16:19], s80 offen offset:1024 sc0 sc1
    s_mov_b64 exec, 1
    ds_write_b32 v4, v164 offset:144
    s_waitcnt vmcnt(0)
    s_mov_b32 s45, 1
    s_atomic_add s45, s[54:55], 0x0
    s_atomic_add s45, s[54:55], 0x80
    s_atomic_add s45, s[54:55], 0x100
    s_atomic_add s45, s[54:55], 0x180
    ds_add_u32 v4, v164 offset:144
    s_mov_b64 exec, -1
    s_cmp_lg_u32 s3, 0
    s_cbranch_scc1 F_end
    s_setprio 3
    s_lshr_b32 s50, s29, 1
    s_lshl_b32 s50, s50, 2
    s_and_b32 s51, s28, 3
    s_add_u32 s50, s50, s51
    s_lshl_b32 s50, s50, 7
    s_add_u32 s56, s50, 0x845000
    s_add_u32 s56, s72, s56
    s_addc_u32 s57, s73, 0
    v_mov_b32 v2, 159096
    ds_read_b32 v7, v2 offset:0
FW_11:
    s_waitcnt lgkmcnt(0)
    v_cmp_gt_u32 vcc, 1, v7
    s_cbranch_vccz FO_12
    s_sleep 2
    ds_read_b32 v7, v2 offset:0
    s_branch FW_11
FO_12:
    v_and_b32 v2, 7, v0
    v_lshlrev_b32 v2, 2, v2
    v_add_u32 v2, 158976, v2
    ds_read_b32 v2, v2
    s_sub_u32 s51, 15, s28
    s_waitcnt lgkmcnt(0)
    v_bfe_u32 v2, v2, 7, 4
    v_cmp_eq_u32 vcc, s51, v2
    s_cbranch_vccz F_ny

    v_lshrrev_b32 v2, 4, v0
    v_and_b32 v6, 15, v0
    v_lshlrev_b32 v6, 4, v6
    v_lshl_add_u32 v2, v2, 12, v6
    s_lshl_b32 s50, s29, 8
    s_add_u32 s50, s50, 135168

SP_13:
    s_load_dword s58, s[56:57], 0 glc
    s_waitcnt lgkmcnt(0)
    s_cmp_ge_u32 s58, 32
    s_cbranch_scc1 SD_14
    s_sleep 2
    s_branch SP_13
SD_14:
    s_mov_b32 m0, 159744
    s_nop 0
    buffer_load_dwordx4 v2, s[24:27], s50 offen sc0 sc1 lds
    s_add_u32 s50, s50, 16384
    s_add_u32 m0, m0, 1024
    s_nop 0
    buffer_load_dwordx4 v2, s[24:27], s50 offen sc0 sc1 lds
    s_waitcnt vmcnt(0)
    v_mov_b32 v7, 1
    s_mov_b64 exec, 1
    ds_write_b32 v4, v7 offset:96
    s_mov_b64 exec, -1
F_ny:
F_end:
    s_endpgm
F_nl:
    s_sub_u32 s3, s3, 4
    s_setprio 2
    s_lshr_b32 s36, s3, 1
    s_and_b32 s37, s3, 1
    v_and_b32 v1, 15, v0
    v_lshrrev_b32 v2, 4, v0
    v_lshrrev_b32 v3, 1, v1
    v_xor_b32 v3, v3, v2
    v_lshlrev_b32 v3, 4, v3
    v_lshlrev_b32 v1, 7, v1
    s_lshl_b32 s38, s36, 13
    v_add3_u32 v4, v1, v3, s38
    v_xor_b32 v5, 64, v4
    v_add_u32 v6, 0x10000, v4
    v_add_u32 v7, 0x10000, v5
    v_bfe_u32 v1, v0, 2, 2
    v_lshl_add_u32 v3, v2, 3, v1
    v_lshrrev_b32 v1, 1, v1
    v_and_b32 v2, 1, v2
    v_lshl_add_u32 v1, v2, 1, v1
    s_lshl_b32 s38, s37, 1
    s_add_u32 s38, s38, s36
    v_xor_b32 v1, s38, v1
    v_lshlrev_b32 v1, 5, v1
    v_lshl_add_u32 v1, v3, 7, v1
    v_and_b32 v2, 3, v0
    v_lshl_add_u32 v1, v2, 3, v1
    v_add_u32 v8, 0x10000, v1
    v_xor_b32 v9, 32, v8
    v_add_u32 v10, 0x8000, v8
    v_add_u32 v11, 0x8000, v9
    s_mov_b32 s40, 0x21317218
    s_mov_b32 s41, s40
    s_mov_b32 s74, 0x358637bd
    s_mov_b32 s75, s74
    s_mov_b32 s76, 0x5d800000
    s_mov_b32 s77, s76
    v_and_b32 v164, 0x30, v0
    s_lshl_b32 s42, s36, 8
    s_add_u32 s42, s42, 155648
    v_add_u32 v164, s42, v164
    v_and_b32 v165, 15, v0
    v_lshlrev_b32 v165, 2, v165
    s_lshl_b32 s42, s38, 6
    s_add_u32 s42, s42, 158208
    v_add_u32 v165, s42, v165
    s_lshl_b32 s42, s3, 2
    s_add_u32 s42, s42, 159040
    v_mov_b32 v3, s42
    v_lshlrev_b32 v1, 2, v2
    v_add_u32 v1, 159040, v1
    v_xor_b32 v2, 64, v165
    s_lshl_b32 s44, s33, 1
    s_add_u32 s44, s44, s37
    s_mul_i32 s45, s44, 4224
    s_mul_i32 s46, s36, 3072
    s_add_u32 s46, s46, s45
    s_lshl_b32 s47, s36, 10
    s_add_u32 s47, s47, 1024
    s_add_u32 s47, s47, s45
    s_lshl_b32 s48, s36, 6
    s_add_u32 s48, s48, 4096
    s_add_u32 s48, s48, s45
    s_lshl_b32 s49, s44, 10
    s_lshl_b32 s52, s3, 11
    s_add_u32 s52, s52, 65536
    s_lshl_b32 s53, s3, 7
    s_lshl_b32 s43, s36, 6
    s_add_u32 s53, s53, s43
    s_add_u32 s53, s53, 159232
    s_mov_b32 s50, 159068
    s_waitcnt lgkmcnt(0)
    s_lshl_b32 s64, s28, 7
    s_lshl_b32 s65, s3, 5
    s_add_u32 s64, s64, s65
    s_lshl_b32 s42, s64, 11
    s_lshl_b32 s65, s29, 7
    s_add_u32 s42, s42, s65
    s_add_u32 s43, s42, 0x8000
    s_lshl_b32 s66, s44, 1
    s_add_u32 s66, s66, s36
    s_lshl_b32 s66, s66, 4
    s_add_u32 s66, s66, s32
    s_lshl_b32 s66, s66, 10

    s_mov_b32 s12, s4
    s_mov_b32 s13, s5
    s_mov_b32 s14, 0x400000
    s_mov_b32 s15, 0x00020000
    s_mov_b32 s16, s6
    s_mov_b32 s17, s7
    s_mov_b32 s18, 0x600000
    s_mov_b32 s19, 0x00020000
    s_mov_b32 s20, s8
    s_mov_b32 s21, s9
    s_mov_b32 s22, 0x200000
    s_mov_b32 s23, 0x00020000
    s_add_u32 s24, s72, 0x800000
    s_addc_u32 s25, s73, 0
    s_mov_b32 s26, 0x48000
    s_mov_b32 s27, 0x00020000
    s_add_u32 s84, s72, 0xa00000
    s_addc_u32 s85, s73, 0
    s_mov_b32 s86, 0x100000
    s_mov_b32 s87, 0x00020000
    s_barrier
    ds_read_b128 v[12:15], v4 offset:0
    ds_read_b64_tr_b16 v[44:45], v8 offset:0
    ds_read_b64_tr_b16 v[46:47], v8 offset:512
    ds_read_b128 v[16:19], v4 offset:2048
    ds_read_b128 v[20:23], v4 offset:4096
    ds_read_b128 v[24:27], v4 offset:6144
    ds_read_b64_tr_b16 v[48:49], v9 offset:0
    ds_read_b64_tr_b16 v[50:51], v9 offset:512
    ds_read_b64_tr_b16 v[52:53], v8 offset:8192
    ds_read_b64_tr_b16 v[54:55], v8 offset:8704
    ds_read_b64_tr_b16 v[56:57], v9 offset:8192
    ds_read_b64_tr_b16 v[58:59], v9 offset:8704
    s_waitcnt lgkmcnt(9)
    v_mfma_f32_16x16x32_bf16 v[100:103], v[12:15], v[44:47], 0
    ds_read_b128 v[28:31], v5 offset:0
    s_waitcnt lgkmcnt(9)
    v_mfma_f32_16x16x32_bf16 v[104:107], v[16:19], v[44:47], 0
    ds_read_b64_tr_b16 v[60:61], v8 offset:4096
    s_waitcnt lgkmcnt(9)
    v_mfma_f32_16x16x32_bf16 v[108:111], v[20:23], v[44:47], 0
    ds_read_b64_tr_b16 v[62:63], v8 offset:4608
    s_waitcnt lgkmcnt(9)
    v_mfma_f32_16x16x32_bf16 v[112:115], v[24:27], v[44:47], 0
    ds_read_b128 v[32:35], v5 offset:2048
    s_waitcnt lgkmcnt(8)
    v_mfma_f32_16x16x32_bf16 v[116:119], v[12:15], v[48:51], 0
    ds_read_b128 v[36:39], v5 offset:4096
    v_mfma_f32_16x16x32_bf16 v[120:123], v[16:19], v[48:51], 0
    ds_read_b128 v[40:43], v5 offset:6144
    v_mfma_f32_16x16x32_bf16 v[124:127], v[20:23], v[48:51], 0
    ds_read_b64_tr_b16 v[64:65], v9 offset:4096
    v_mfma_f32_16x16x32_bf16 v[128:131], v[24:27], v[48:51], 0
    ds_read_b64_tr_b16 v[66:67], v9 offset:4608
    s_waitcnt lgkmcnt(10)
    v_mfma_f32_16x16x32_bf16 v[132:135], v[12:15], v[52:55], 0
    ds_read_b64_tr_b16 v[44:45], v8 offset:12288
    v_mfma_f32_16x16x32_bf16 v[136:139], v[16:19], v[52:55], 0
    ds_read_b64_tr_b16 v[46:47], v8 offset:12800
    v_mfma_f32_16x16x32_bf16 v[140:143], v[20:23], v[52:55], 0
    ds_read_b64_tr_b16 v[48:49], v9 offset:12288
    v_mfma_f32_16x16x32_bf16 v[144:147], v[24:27], v[52:55], 0
    ds_read_b64_tr_b16 v[50:51], v9 offset:12800
    s_waitcnt lgkmcnt(12)
    v_mfma_f32_16x16x32_bf16 v[148:151], v[12:15], v[56:59], 0
    v_mfma_f32_16x16x32_bf16 v[152:155], v[16:19], v[56:59], 0
    v_mfma_f32_16x16x32_bf16 v[156:159], v[20:23], v[56:59], 0
    v_mfma_f32_16x16x32_bf16 v[160:163], v[24:27], v[56:59], 0
    s_waitcnt lgkmcnt(9)
    v_mfma_f32_16x16x32_bf16 v[100:103], v[28:31], v[60:63], v[100:103]
    s_waitcnt lgkmcnt(8)
    v_mfma_f32_16x16x32_bf16 v[104:107], v[32:35], v[60:63], v[104:107]
    s_waitcnt lgkmcnt(0)
    s_barrier
    v_mfma_f32_16x16x32_bf16 v[108:111], v[36:39], v[60:63], v[108:111]
    ds_read_b128 v[12:15], v4 offset:16384
    v_mfma_f32_16x16x32_bf16 v[112:115], v[40:43], v[60:63], v[112:115]
    ds_read_b64_tr_b16 v[52:53], v8 offset:16384
    v_mfma_f32_16x16x32_bf16 v[116:119], v[28:31], v[64:67], v[116:119]
    ds_read_b64_tr_b16 v[54:55], v8 offset:16896
    v_mfma_f32_16x16x32_bf16 v[120:123], v[32:35], v[64:67], v[120:123]
    ds_read_b128 v[16:19], v4 offset:18432
    v_mfma_f32_16x16x32_bf16 v[124:127], v[36:39], v[64:67], v[124:127]
    ds_read_b128 v[20:23], v4 offset:20480
    v_mfma_f32_16x16x32_bf16 v[128:131], v[40:43], v[64:67], v[128:131]
    ds_read_b128 v[24:27], v4 offset:22528
    v_mfma_f32_16x16x32_bf16 v[132:135], v[28:31], v[44:47], v[132:135]
    ds_read_b64_tr_b16 v[56:57], v9 offset:16384
    v_mfma_f32_16x16x32_bf16 v[136:139], v[32:35], v[44:47], v[136:139]
    ds_read_b64_tr_b16 v[58:59], v9 offset:16896
    v_mfma_f32_16x16x32_bf16 v[140:143], v[36:39], v[44:47], v[140:143]
    ds_read_b64_tr_b16 v[60:61], v8 offset:24576
    v_mfma_f32_16x16x32_bf16 v[144:147], v[40:43], v[44:47], v[144:147]
    ds_read_b64_tr_b16 v[62:63], v8 offset:25088
    v_mfma_f32_16x16x32_bf16 v[148:151], v[28:31], v[48:51], v[148:151]
    ds_read_b64_tr_b16 v[64:65], v9 offset:24576
    v_mfma_f32_16x16x32_bf16 v[152:155], v[32:35], v[48:51], v[152:155]
    ds_read_b64_tr_b16 v[66:67], v9 offset:25088
    v_mfma_f32_16x16x32_bf16 v[156:159], v[36:39], v[48:51], v[156:159]
    v_mfma_f32_16x16x32_bf16 v[160:163], v[40:43], v[48:51], v[160:163]
    s_waitcnt lgkmcnt(9)
    v_mfma_f32_16x16x32_bf16 v[100:103], v[12:15], v[52:55], v[100:103]
    ds_read_b128 v[28:31], v5 offset:16384
    s_waitcnt lgkmcnt(9)
    v_mfma_f32_16x16x32_bf16 v[104:107], v[16:19], v[52:55], v[104:107]
    ds_read_b64_tr_b16 v[44:45], v8 offset:20480
    s_waitcnt lgkmcnt(9)
    v_mfma_f32_16x16x32_bf16 v[108:111], v[20:23], v[52:55], v[108:111]
    ds_read_b64_tr_b16 v[46:47], v8 offset:20992
    s_waitcnt lgkmcnt(9)
    v_mfma_f32_16x16x32_bf16 v[112:115], v[24:27], v[52:55], v[112:115]
    ds_read_b128 v[32:35], v5 offset:18432
    s_waitcnt lgkmcnt(8)
    v_mfma_f32_16x16x32_bf16 v[116:119], v[12:15], v[56:59], v[116:119]
    ds_read_b128 v[36:39], v5 offset:20480
    v_mfma_f32_16x16x32_bf16 v[120:123], v[16:19], v[56:59], v[120:123]
    ds_read_b128 v[40:43], v5 offset:22528
    v_mfma_f32_16x16x32_bf16 v[124:127], v[20:23], v[56:59], v[124:127]
    ds_read_b64_tr_b16 v[48:49], v9 offset:20480
    v_mfma_f32_16x16x32_bf16 v[128:131], v[24:27], v[56:59], v[128:131]
    ds_read_b64_tr_b16 v[50:51], v9 offset:20992
    s_waitcnt lgkmcnt(10)
    v_mfma_f32_16x16x32_bf16 v[132:135], v[12:15], v[60:63], v[132:135]
    ds_read_b64_tr_b16 v[52:53], v8 offset:28672
    v_mfma_f32_16x16x32_bf16 v[136:139], v[16:19], v[60:63], v[136:139]
    ds_read_b64_tr_b16 v[54:55], v8 offset:29184
    v_mfma_f32_16x16x32_bf16 v[140:143], v[20:23], v[60:63], v[140:143]
    ds_read_b64_tr_b16 v[56:57], v9 offset:28672
    v_mfma_f32_16x16x32_bf16 v[144:147], v[24:27], v[60:63], v[144:147]
    ds_read_b64_tr_b16 v[58:59], v9 offset:29184
    s_waitcnt lgkmcnt(12)
    v_mfma_f32_16x16x32_bf16 v[148:151], v[12:15], v[64:67], v[148:151]
    v_mfma_f32_16x16x32_bf16 v[152:155], v[16:19], v[64:67], v[152:155]
    v_mfma_f32_16x16x32_bf16 v[156:159], v[20:23], v[64:67], v[156:159]
    v_mfma_f32_16x16x32_bf16 v[160:163], v[24:27], v[64:67], v[160:163]
    s_waitcnt lgkmcnt(9)
    v_mfma_f32_16x16x32_bf16 v[100:103], v[28:31], v[44:47], v[100:103]
    s_waitcnt lgkmcnt(8)
    v_mfma_f32_16x16x32_bf16 v[104:107], v[32:35], v[44:47], v[104:107]
    s_waitcnt lgkmcnt(0)
    s_barrier
    v_mfma_f32_16x16x32_bf16 v[108:111], v[36:39], v[44:47], v[108:111]
    ds_read_b128 v[12:15], v4 offset:32768
    v_mfma_f32_16x16x32_bf16 v[112:115], v[40:43], v[44:47], v[112:115]
    ds_read_b64_tr_b16 v[60:61], v10 offset:16384
    v_mfma_f32_16x16x32_bf16 v[116:119], v[28:31], v[48:51], v[116:119]
    ds_read_b64_tr_b16 v[62:63], v10 offset:16896
    v_mfma_f32_16x16x32_bf16 v[120:123], v[32:35], v[48:51], v[120:123]
    ds_read_b128 v[16:19], v4 offset:34816
    v_mfma_f32_16x16x32_bf16 v[124:127], v[36:39], v[48:51], v[124:127]
    ds_read_b128 v[20:23], v4 offset:36864
    v_mfma_f32_16x16x32_bf16 v[128:131], v[40:43], v[48:51], v[128:131]
    ds_read_b128 v[24:27], v4 offset:38912
    v_mfma_f32_16x16x32_bf16 v[132:135], v[28:31], v[52:55], v[132:135]
    ds_read_b64_tr_b16 v[64:65], v11 offset:16384
    v_mfma_f32_16x16x32_bf16 v[136:139], v[32:35], v[52:55], v[136:139]
    ds_read_b64_tr_b16 v[66:67], v11 offset:16896
    v_mfma_f32_16x16x32_bf16 v[140:143], v[36:39], v[52:55], v[140:143]
    ds_read_b64_tr_b16 v[44:45], v10 offset:24576
    v_mfma_f32_16x16x32_bf16 v[144:147], v[40:43], v[52:55], v[144:147]
    ds_read_b64_tr_b16 v[46:47], v10 offset:25088
    v_mfma_f32_16x16x32_bf16 v[148:151], v[28:31], v[56:59], v[148:151]
    ds_read_b64_tr_b16 v[48:49], v11 offset:24576
    v_mfma_f32_16x16x32_bf16 v[152:155], v[32:35], v[56:59], v[152:155]
    ds_read_b64_tr_b16 v[50:51], v11 offset:25088
    v_mfma_f32_16x16x32_bf16 v[156:159], v[36:39], v[56:59], v[156:159]
    v_mfma_f32_16x16x32_bf16 v[160:163], v[40:43], v[56:59], v[160:163]
    s_waitcnt lgkmcnt(9)
    v_mfma_f32_16x16x32_bf16 v[100:103], v[12:15], v[60:63], v[100:103]
    ds_read_b128 v[28:31], v5 offset:32768
    s_waitcnt lgkmcnt(9)
    v_mfma_f32_16x16x32_bf16 v[104:107], v[16:19], v[60:63], v[104:107]
    ds_read_b64_tr_b16 v[52:53], v10 offset:20480
    s_waitcnt lgkmcnt(9)
    v_mfma_f32_16x16x32_bf16 v[108:111], v[20:23], v[60:63], v[108:111]
    ds_read_b64_tr_b16 v[54:55], v10 offset:20992
    s_waitcnt lgkmcnt(9)
    v_mfma_f32_16x16x32_bf16 v[112:115], v[24:27], v[60:63], v[112:115]
    ds_read_b128 v[32:35], v5 offset:34816
    s_waitcnt lgkmcnt(8)
    v_mfma_f32_16x16x32_bf16 v[116:119], v[12:15], v[64:67], v[116:119]
    ds_read_b128 v[36:39], v5 offset:36864
    v_mfma_f32_16x16x32_bf16 v[120:123], v[16:19], v[64:67], v[120:123]
    ds_read_b128 v[40:43], v5 offset:38912
    v_mfma_f32_16x16x32_bf16 v[124:127], v[20:23], v[64:67], v[124:127]
    ds_read_b64_tr_b16 v[56:57], v11 offset:20480
    v_mfma_f32_16x16x32_bf16 v[128:131], v[24:27], v[64:67], v[128:131]
    ds_read_b64_tr_b16 v[58:59], v11 offset:20992
    s_waitcnt lgkmcnt(10)
    v_mfma_f32_16x16x32_bf16 v[132:135], v[12:15], v[44:47], v[132:135]
    ds_read_b64_tr_b16 v[60:61], v10 offset:28672
    v_mfma_f32_16x16x32_bf16 v[136:139], v[16:19], v[44:47], v[136:139]
    ds_read_b64_tr_b16 v[62:63], v10 offset:29184
    v_mfma_f32_16x16x32_bf16 v[140:143], v[20:23], v[44:47], v[140:143]
    ds_read_b64_tr_b16 v[64:65], v11 offset:28672
    v_mfma_f32_16x16x32_bf16 v[144:147], v[24:27], v[44:47], v[144:147]
    ds_read_b64_tr_b16 v[66:67], v11 offset:29184
    s_waitcnt lgkmcnt(12)
    v_mfma_f32_16x16x32_bf16 v[148:151], v[12:15], v[48:51], v[148:151]
    v_mfma_f32_16x16x32_bf16 v[152:155], v[16:19], v[48:51], v[152:155]
    v_mfma_f32_16x16x32_bf16 v[156:159], v[20:23], v[48:51], v[156:159]
    v_mfma_f32_16x16x32_bf16 v[160:163], v[24:27], v[48:51], v[160:163]
    s_waitcnt lgkmcnt(9)
    v_mfma_f32_16x16x32_bf16 v[100:103], v[28:31], v[52:55], v[100:103]
    s_waitcnt lgkmcnt(8)
    v_mfma_f32_16x16x32_bf16 v[104:107], v[32:35], v[52:55], v[104:107]
    s_waitcnt lgkmcnt(0)
    s_barrier
    v_mfma_f32_16x16x32_bf16 v[108:111], v[36:39], v[52:55], v[108:111]
    ds_read_b128 v[12:15], v4 offset:49152
    v_mfma_f32_16x16x32_bf16 v[112:115], v[40:43], v[52:55], v[112:115]
    s_branch IW_s3
IW_w3:
    s_branch IW_r3
IW_s3:
    ds_read_b64_tr_b16 v[44:45], v10 offset:32768
    v_mfma_f32_16x16x32_bf16 v[116:119], v[28:31], v[56:59], v[116:119]
    ds_read_b64_tr_b16 v[46:47], v10 offset:33280
    v_mfma_f32_16x16x32_bf16 v[120:123], v[32:35], v[56:59], v[120:123]
    ds_read_b128 v[16:19], v4 offset:51200
    v_mfma_f32_16x16x32_bf16 v[124:127], v[36:39], v[56:59], v[124:127]
    ds_read_b128 v[20:23], v4 offset:53248
    v_mfma_f32_16x16x32_bf16 v[128:131], v[40:43], v[56:59], v[128:131]
    ds_read_b128 v[24:27], v4 offset:55296
    v_mfma_f32_16x16x32_bf16 v[132:135], v[28:31], v[60:63], v[132:135]
    ds_read_b64_tr_b16 v[48:49], v11 offset:32768
    v_mfma_f32_16x16x32_bf16 v[136:139], v[32:35], v[60:63], v[136:139]
    ds_read_b64_tr_b16 v[50:51], v11 offset:33280
    v_mfma_f32_16x16x32_bf16 v[140:143], v[36:39], v[60:63], v[140:143]
    ds_read_b64_tr_b16 v[52:53], v8 offset:0
    v_mfma_f32_16x16x32_bf16 v[144:147], v[40:43], v[60:63], v[144:147]
    ds_read_b64_tr_b16 v[54:55], v8 offset:512
    v_mfma_f32_16x16x32_bf16 v[148:151], v[28:31], v[64:67], v[148:151]
    ds_read_b64_tr_b16 v[56:57], v9 offset:0
    v_mfma_f32_16x16x32_bf16 v[152:155], v[32:35], v[64:67], v[152:155]
    ds_read_b64_tr_b16 v[58:59], v9 offset:512
    v_mfma_f32_16x16x32_bf16 v[156:159], v[36:39], v[64:67], v[156:159]
    v_mfma_f32_16x16x32_bf16 v[160:163], v[40:43], v[64:67], v[160:163]
    s_waitcnt lgkmcnt(9)
    v_mfma_f32_16x16x32_bf16 v[100:103], v[12:15], v[44:47], v[100:103]
    ds_read_b128 v[28:31], v5 offset:49152
    s_waitcnt lgkmcnt(9)
    v_mfma_f32_16x16x32_bf16 v[104:107], v[16:19], v[44:47], v[104:107]
    ds_read_b64_tr_b16 v[60:61], v10 offset:36864
    s_waitcnt lgkmcnt(9)
    v_mfma_f32_16x16x32_bf16 v[108:111], v[20:23], v[44:47], v[108:111]
    ds_read_b64_tr_b16 v[62:63], v10 offset:37376
    s_waitcnt lgkmcnt(9)
    v_mfma_f32_16x16x32_bf16 v[112:115], v[24:27], v[44:47], v[112:115]
    ds_read_b128 v[32:35], v5 offset:51200
    s_waitcnt lgkmcnt(8)
    v_mfma_f32_16x16x32_bf16 v[116:119], v[12:15], v[48:51], v[116:119]
    ds_read_b128 v[36:39], v5 offset:53248
    v_mfma_f32_16x16x32_bf16 v[120:123], v[16:19], v[48:51], v[120:123]
    ds_read_b128 v[40:43], v5 offset:55296
    v_mfma_f32_16x16x32_bf16 v[124:127], v[20:23], v[48:51], v[124:127]
    ds_read_b64_tr_b16 v[64:65], v11 offset:36864
    v_mfma_f32_16x16x32_bf16 v[128:131], v[24:27], v[48:51], v[128:131]
    ds_read_b64_tr_b16 v[66:67], v11 offset:37376
    s_waitcnt lgkmcnt(10)
    v_mfma_f32_16x16x32_bf16 v[132:135], v[12:15], v[52:55], v[132:135]
    ds_read_b64_tr_b16 v[44:45], v8 offset:4096
    v_mfma_f32_16x16x32_bf16 v[136:139], v[16:19], v[52:55], v[136:139]
    ds_read_b64_tr_b16 v[46:47], v8 offset:4608
    v_mfma_f32_16x16x32_bf16 v[140:143], v[20:23], v[52:55], v[140:143]
    ds_read_b64_tr_b16 v[48:49], v9 offset:4096
    v_mfma_f32_16x16x32_bf16 v[144:147], v[24:27], v[52:55], v[144:147]
    ds_read_b64_tr_b16 v[50:51], v9 offset:4608
    s_waitcnt lgkmcnt(12)
    v_mfma_f32_16x16x32_bf16 v[148:151], v[12:15], v[56:59], v[148:151]
    v_mfma_f32_16x16x32_bf16 v[152:155], v[16:19], v[56:59], v[152:155]
    v_mfma_f32_16x16x32_bf16 v[156:159], v[20:23], v[56:59], v[156:159]
    v_mfma_f32_16x16x32_bf16 v[160:163], v[24:27], v[56:59], v[160:163]
    s_waitcnt lgkmcnt(9)
    v_mfma_f32_16x16x32_bf16 v[100:103], v[28:31], v[60:63], v[100:103]
    s_waitcnt lgkmcnt(8)
    v_mfma_f32_16x16x32_bf16 v[104:107], v[32:35], v[60:63], v[104:107]
    s_waitcnt lgkmcnt(0)
    s_barrier
    v_mfma_f32_16x16x32_bf16 v[108:111], v[36:39], v[60:63], v[108:111]
    ds_read_b128 v[12:15], v4 offset:0
    v_mfma_f32_16x16x32_bf16 v[112:115], v[40:43], v[60:63], v[112:115]
    ds_read_b64_tr_b16 v[52:53], v8 offset:8192
    v_mfma_f32_16x16x32_bf16 v[116:119], v[28:31], v[64:67], v[116:119]
    ds_read_b64_tr_b16 v[54:55], v8 offset:8704
    v_mfma_f32_16x16x32_bf16 v[120:123], v[32:35], v[64:67], v[120:123]
    ds_read_b128 v[16:19], v4 offset:2048
    v_mfma_f32_16x16x32_bf16 v[124:127], v[36:39], v[64:67], v[124:127]
    ds_read_b128 v[20:23], v4 offset:4096
    v_mfma_f32_16x16x32_bf16 v[128:131], v[40:43], v[64:67], v[128:131]
    ds_read_b128 v[24:27], v4 offset:6144
    v_mfma_f32_16x16x32_bf16 v[132:135], v[28:31], v[44:47], v[132:135]
    ds_read_b64_tr_b16 v[56:57], v9 offset:8192
    v_mfma_f32_16x16x32_bf16 v[136:139], v[32:35], v[44:47], v[136:139]
    ds_read_b64_tr_b16 v[58:59], v9 offset:8704
    v_mfma_f32_16x16x32_bf16 v[140:143], v[36:39], v[44:47], v[140:143]
    ds_read_b64_tr_b16 v[60:61], v8 offset:16384
    v_mfma_f32_16x16x32_bf16 v[144:147], v[40:43], v[44:47], v[144:147]
    ds_read_b64_tr_b16 v[62:63], v8 offset:16896
    v_mfma_f32_16x16x32_bf16 v[148:151], v[28:31], v[48:51], v[148:151]
    ds_read_b64_tr_b16 v[64:65], v9 offset:16384
    v_mfma_f32_16x16x32_bf16 v[152:155], v[32:35], v[48:51], v[152:155]
    ds_read_b64_tr_b16 v[66:67], v9 offset:16896
    v_mfma_f32_16x16x32_bf16 v[156:159], v[36:39], v[48:51], v[156:159]
    v_mfma_f32_16x16x32_bf16 v[160:163], v[40:43], v[48:51], v[160:163]
    s_waitcnt lgkmcnt(9)
    v_mfma_f32_16x16x32_bf16 v[100:103], v[12:15], v[52:55], v[100:103]
    ds_read_b128 v[28:31], v5 offset:0
    s_waitcnt lgkmcnt(9)
    v_mfma_f32_16x16x32_bf16 v[104:107], v[16:19], v[52:55], v[104:107]
    ds_read_b64_tr_b16 v[44:45], v8 offset:12288
    s_waitcnt lgkmcnt(9)
    v_mfma_f32_16x16x32_bf16 v[108:111], v[20:23], v[52:55], v[108:111]
    ds_read_b64_tr_b16 v[46:47], v8 offset:12800
    s_waitcnt lgkmcnt(9)
    v_mfma_f32_16x16x32_bf16 v[112:115], v[24:27], v[52:55], v[112:115]
    ds_read_b128 v[32:35], v5 offset:2048
    s_waitcnt lgkmcnt(8)
    v_mfma_f32_16x16x32_bf16 v[116:119], v[12:15], v[56:59], v[116:119]
    ds_read_b128 v[36:39], v5 offset:4096
    v_mfma_f32_16x16x32_bf16 v[120:123], v[16:19], v[56:59], v[120:123]
    ds_read_b128 v[40:43], v5 offset:6144
    v_mfma_f32_16x16x32_bf16 v[124:127], v[20:23], v[56:59], v[124:127]
    ds_read_b64_tr_b16 v[48:49], v9 offset:12288
    v_mfma_f32_16x16x32_bf16 v[128:131], v[24:27], v[56:59], v[128:131]
    ds_read_b64_tr_b16 v[50:51], v9 offset:12800
    s_waitcnt lgkmcnt(10)
    v_mfma_f32_16x16x32_bf16 v[132:135], v[12:15], v[60:63], v[132:135]
    ds_read_b64_tr_b16 v[52:53], v8 offset:20480
    v_mfma_f32_16x16x32_bf16 v[136:139], v[16:19], v[60:63], v[136:139]
    ds_read_b64_tr_b16 v[54:55], v8 offset:20992
    v_mfma_f32_16x16x32_bf16 v[140:143], v[20:23], v[60:63], v[140:143]
    ds_read_b64_tr_b16 v[56:57], v9 offset:20480
    v_mfma_f32_16x16x32_bf16 v[144:147], v[24:27], v[60:63], v[144:147]
    ds_read_b64_tr_b16 v[58:59], v9 offset:20992
    s_waitcnt lgkmcnt(12)
    v_mfma_f32_16x16x32_bf16 v[148:151], v[12:15], v[64:67], v[148:151]
    v_mfma_f32_16x16x32_bf16 v[152:155], v[16:19], v[64:67], v[152:155]
    v_mfma_f32_16x16x32_bf16 v[156:159], v[20:23], v[64:67], v[156:159]
    v_mfma_f32_16x16x32_bf16 v[160:163], v[24:27], v[64:67], v[160:163]
    s_waitcnt lgkmcnt(9)
    v_mfma_f32_16x16x32_bf16 v[100:103], v[28:31], v[44:47], v[100:103]
    s_waitcnt lgkmcnt(8)
    v_mfma_f32_16x16x32_bf16 v[104:107], v[32:35], v[44:47], v[104:107]
    s_waitcnt lgkmcnt(0)
    s_barrier
    v_mfma_f32_16x16x32_bf16 v[108:111], v[36:39], v[44:47], v[108:111]
    ds_read_b128 v[12:15], v4 offset:16384
    v_mfma_f32_16x16x32_bf16 v[112:115], v[40:43], v[44:47], v[112:115]
    ds_read_b64_tr_b16 v[60:61], v10 offset:0
    v_mfma_f32_16x16x32_bf16 v[116:119], v[28:31], v[48:51], v[116:119]
    ds_read_b64_tr_b16 v[62:63], v10 offset:512
    v_mfma_f32_16x16x32_bf16 v[120:123], v[32:35], v[48:51], v[120:123]
    ds_read_b128 v[16:19], v4 offset:18432
    v_mfma_f32_16x16x32_bf16 v[124:127], v[36:39], v[48:51], v[124:127]
    ds_read_b128 v[20:23], v4 offset:20480
    v_mfma_f32_16x16x32_bf16 v[128:131], v[40:43], v[48:51], v[128:131]
    ds_read_b128 v[24:27], v4 offset:22528
    v_mfma_f32_16x16x32_bf16 v[132:135], v[28:31], v[52:55], v[132:135]
    ds_read_b64_tr_b16 v[64:65], v11 offset:0
    v_mfma_f32_16x16x32_bf16 v[136:139], v[32:35], v[52:55], v[136:139]
    ds_read_b64_tr_b16 v[66:67], v11 offset:512
    v_mfma_f32_16x16x32_bf16 v[140:143], v[36:39], v[52:55], v[140:143]
    ds_read_b64_tr_b16 v[44:45], v10 offset:8192
    v_mfma_f32_16x16x32_bf16 v[144:147], v[40:43], v[52:55], v[144:147]
    ds_read_b64_tr_b16 v[46:47], v10 offset:8704
    v_mfma_f32_16x16x32_bf16 v[148:151], v[28:31], v[56:59], v[148:151]
    ds_read_b64_tr_b16 v[48:49], v11 offset:8192
    v_mfma_f32_16x16x32_bf16 v[152:155], v[32:35], v[56:59], v[152:155]
    ds_read_b64_tr_b16 v[50:51], v11 offset:8704
    v_mfma_f32_16x16x32_bf16 v[156:159], v[36:39], v[56:59], v[156:159]
    v_mfma_f32_16x16x32_bf16 v[160:163], v[40:43], v[56:59], v[160:163]
    s_waitcnt lgkmcnt(9)
    v_mfma_f32_16x16x32_bf16 v[100:103], v[12:15], v[60:63], v[100:103]
    ds_read_b128 v[28:31], v5 offset:16384
    s_waitcnt lgkmcnt(9)
    v_mfma_f32_16x16x32_bf16 v[104:107], v[16:19], v[60:63], v[104:107]
    ds_read_b64_tr_b16 v[52:53], v10 offset:4096
    s_waitcnt lgkmcnt(9)
    v_mfma_f32_16x16x32_bf16 v[108:111], v[20:23], v[60:63], v[108:111]
    ds_read_b64_tr_b16 v[54:55], v10 offset:4608
    s_waitcnt lgkmcnt(9)
    v_mfma_f32_16x16x32_bf16 v[112:115], v[24:27], v[60:63], v[112:115]
    ds_read_b128 v[32:35], v5 offset:18432
    s_waitcnt lgkmcnt(8)
    v_mfma_f32_16x16x32_bf16 v[116:119], v[12:15], v[64:67], v[116:119]
    ds_read_b128 v[36:39], v5 offset:20480
    v_mfma_f32_16x16x32_bf16 v[120:123], v[16:19], v[64:67], v[120:123]
    ds_read_b128 v[40:43], v5 offset:22528
    v_mfma_f32_16x16x32_bf16 v[124:127], v[20:23], v[64:67], v[124:127]
    ds_read_b64_tr_b16 v[56:57], v11 offset:4096
    v_mfma_f32_16x16x32_bf16 v[128:131], v[24:27], v[64:67], v[128:131]
    ds_read_b64_tr_b16 v[58:59], v11 offset:4608
    s_waitcnt lgkmcnt(10)
    v_mfma_f32_16x16x32_bf16 v[132:135], v[12:15], v[44:47], v[132:135]
    ds_read_b64_tr_b16 v[60:61], v10 offset:12288
    v_mfma_f32_16x16x32_bf16 v[136:139], v[16:19], v[44:47], v[136:139]
    ds_read_b64_tr_b16 v[62:63], v10 offset:12800
    v_mfma_f32_16x16x32_bf16 v[140:143], v[20:23], v[44:47], v[140:143]
    ds_read_b64_tr_b16 v[64:65], v11 offset:12288
    v_mfma_f32_16x16x32_bf16 v[144:147], v[24:27], v[44:47], v[144:147]
    ds_read_b64_tr_b16 v[66:67], v11 offset:12800
    s_waitcnt lgkmcnt(12)
    v_mfma_f32_16x16x32_bf16 v[148:151], v[12:15], v[48:51], v[148:151]
    v_mfma_f32_16x16x32_bf16 v[152:155], v[16:19], v[48:51], v[152:155]
    v_mfma_f32_16x16x32_bf16 v[156:159], v[20:23], v[48:51], v[156:159]
    v_mfma_f32_16x16x32_bf16 v[160:163], v[24:27], v[48:51], v[160:163]
    s_waitcnt lgkmcnt(9)
    v_mfma_f32_16x16x32_bf16 v[100:103], v[28:31], v[52:55], v[100:103]
    s_waitcnt lgkmcnt(8)
    v_mfma_f32_16x16x32_bf16 v[104:107], v[32:35], v[52:55], v[104:107]
    s_waitcnt lgkmcnt(0)
    s_barrier
    v_mfma_f32_16x16x32_bf16 v[108:111], v[36:39], v[52:55], v[108:111]
    ds_read_b128 v[12:15], v4 offset:32768
    v_mfma_f32_16x16x32_bf16 v[112:115], v[40:43], v[52:55], v[112:115]
    ds_read_b64_tr_b16 v[44:45], v10 offset:16384
    v_mfma_f32_16x16x32_bf16 v[116:119], v[28:31], v[56:59], v[116:119]
    ds_read_b64_tr_b16 v[46:47], v10 offset:16896
    v_mfma_f32_16x16x32_bf16 v[120:123], v[32:35], v[56:59], v[120:123]
    ds_read_b128 v[16:19], v4 offset:34816
    v_mfma_f32_16x16x32_bf16 v[124:127], v[36:39], v[56:59], v[124:127]
    ds_read_b128 v[20:23], v4 offset:36864
    v_mfma_f32_16x16x32_bf16 v[128:131], v[40:43], v[56:59], v[128:131]
    ds_read_b128 v[24:27], v4 offset:38912
    v_mfma_f32_16x16x32_bf16 v[132:135], v[28:31], v[60:63], v[132:135]
    ds_read_b64_tr_b16 v[48:49], v11 offset:16384
    v_mfma_f32_16x16x32_bf16 v[136:139], v[32:35], v[60:63], v[136:139]
    ds_read_b64_tr_b16 v[50:51], v11 offset:16896
    v_mfma_f32_16x16x32_bf16 v[140:143], v[36:39], v[60:63], v[140:143]
    ds_read_b64_tr_b16 v[52:53], v10 offset:24576
    v_mfma_f32_16x16x32_bf16 v[144:147], v[40:43], v[60:63], v[144:147]
    ds_read_b64_tr_b16 v[54:55], v10 offset:25088
    v_mfma_f32_16x16x32_bf16 v[148:151], v[28:31], v[64:67], v[148:151]
    ds_read_b64_tr_b16 v[56:57], v11 offset:24576
    v_mfma_f32_16x16x32_bf16 v[152:155], v[32:35], v[64:67], v[152:155]
    ds_read_b64_tr_b16 v[58:59], v11 offset:25088
    v_mfma_f32_16x16x32_bf16 v[156:159], v[36:39], v[64:67], v[156:159]
    v_mfma_f32_16x16x32_bf16 v[160:163], v[40:43], v[64:67], v[160:163]
    s_waitcnt lgkmcnt(9)
    v_mfma_f32_16x16x32_bf16 v[100:103], v[12:15], v[44:47], v[100:103]
    ds_read_b128 v[28:31], v5 offset:32768
    s_waitcnt lgkmcnt(9)
    v_mfma_f32_16x16x32_bf16 v[104:107], v[16:19], v[44:47], v[104:107]
    ds_read_b64_tr_b16 v[60:61], v10 offset:20480
    s_waitcnt lgkmcnt(9)
    v_mfma_f32_16x16x32_bf16 v[108:111], v[20:23], v[44:47], v[108:111]
    ds_read_b64_tr_b16 v[62:63], v10 offset:20992
    s_waitcnt lgkmcnt(9)
    v_mfma_f32_16x16x32_bf16 v[112:115], v[24:27], v[44:47], v[112:115]
    ds_read_b128 v[32:35], v5 offset:34816
    s_waitcnt lgkmcnt(8)
    v_mfma_f32_16x16x32_bf16 v[116:119], v[12:15], v[48:51], v[116:119]
    ds_read_b128 v[36:39], v5 offset:36864
    v_mfma_f32_16x16x32_bf16 v[120:123], v[16:19], v[48:51], v[120:123]
    ds_read_b128 v[40:43], v5 offset:38912
    v_mfma_f32_16x16x32_bf16 v[124:127], v[20:23], v[48:51], v[124:127]
    ds_read_b64_tr_b16 v[64:65], v11 offset:20480
    v_mfma_f32_16x16x32_bf16 v[128:131], v[24:27], v[48:51], v[128:131]
    ds_read_b64_tr_b16 v[66:67], v11 offset:20992
    s_waitcnt lgkmcnt(10)
    v_mfma_f32_16x16x32_bf16 v[132:135], v[12:15], v[52:55], v[132:135]
    ds_read_b64_tr_b16 v[44:45], v10 offset:28672
    v_mfma_f32_16x16x32_bf16 v[136:139], v[16:19], v[52:55], v[136:139]
    ds_read_b64_tr_b16 v[46:47], v10 offset:29184
    v_mfma_f32_16x16x32_bf16 v[140:143], v[20:23], v[52:55], v[140:143]
    ds_read_b64_tr_b16 v[48:49], v11 offset:28672
    v_mfma_f32_16x16x32_bf16 v[144:147], v[24:27], v[52:55], v[144:147]
    ds_read_b64_tr_b16 v[50:51], v11 offset:29184
    s_waitcnt lgkmcnt(12)
    v_mfma_f32_16x16x32_bf16 v[148:151], v[12:15], v[56:59], v[148:151]
    v_mfma_f32_16x16x32_bf16 v[152:155], v[16:19], v[56:59], v[152:155]
    v_mfma_f32_16x16x32_bf16 v[156:159], v[20:23], v[56:59], v[156:159]
    v_mfma_f32_16x16x32_bf16 v[160:163], v[24:27], v[56:59], v[160:163]
    s_waitcnt lgkmcnt(9)
    v_mfma_f32_16x16x32_bf16 v[100:103], v[28:31], v[60:63], v[100:103]
    s_waitcnt lgkmcnt(8)
    v_mfma_f32_16x16x32_bf16 v[104:107], v[32:35], v[60:63], v[104:107]
    s_waitcnt lgkmcnt(0)
    s_barrier
    v_mfma_f32_16x16x32_bf16 v[108:111], v[36:39], v[60:63], v[108:111]
    ds_read_b128 v[12:15], v4 offset:49152
    v_mfma_f32_16x16x32_bf16 v[112:115], v[40:43], v[60:63], v[112:115]
    ds_read_b64_tr_b16 v[52:53], v8 offset:0
    v_mfma_f32_16x16x32_bf16 v[116:119], v[28:31], v[64:67], v[116:119]
    ds_read_b64_tr_b16 v[54:55], v8 offset:512
    v_mfma_f32_16x16x32_bf16 v[120:123], v[32:35], v[64:67], v[120:123]
    ds_read_b128 v[16:19], v4 offset:51200
    v_mfma_f32_16x16x32_bf16 v[124:127], v[36:39], v[64:67], v[124:127]
    ds_read_b128 v[20:23], v4 offset:53248
    v_mfma_f32_16x16x32_bf16 v[128:131], v[40:43], v[64:67], v[128:131]
    ds_read_b128 v[24:27], v4 offset:55296
    v_mfma_f32_16x16x32_bf16 v[132:135], v[28:31], v[44:47], v[132:135]
    ds_read_b64_tr_b16 v[56:57], v9 offset:0
    v_mfma_f32_16x16x32_bf16 v[136:139], v[32:35], v[44:47], v[136:139]
    ds_read_b64_tr_b16 v[58:59], v9 offset:512
    v_mfma_f32_16x16x32_bf16 v[140:143], v[36:39], v[44:47], v[140:143]
    ds_read_b64_tr_b16 v[60:61], v10 offset:32768
    v_mfma_f32_16x16x32_bf16 v[144:147], v[40:43], v[44:47], v[144:147]
    ds_read_b64_tr_b16 v[62:63], v10 offset:33280
    v_mfma_f32_16x16x32_bf16 v[148:151], v[28:31], v[48:51], v[148:151]
    ds_read_b64_tr_b16 v[64:65], v11 offset:32768
    v_mfma_f32_16x16x32_bf16 v[152:155], v[32:35], v[48:51], v[152:155]
    ds_read_b64_tr_b16 v[66:67], v11 offset:33280
    v_mfma_f32_16x16x32_bf16 v[156:159], v[36:39], v[48:51], v[156:159]
    v_mfma_f32_16x16x32_bf16 v[160:163], v[40:43], v[48:51], v[160:163]
    s_waitcnt lgkmcnt(9)
    v_mfma_f32_16x16x32_bf16 v[100:103], v[12:15], v[52:55], v[100:103]
    ds_read_b128 v[28:31], v5 offset:49152
    s_waitcnt lgkmcnt(9)
    v_mfma_f32_16x16x32_bf16 v[104:107], v[16:19], v[52:55], v[104:107]
    ds_read_b64_tr_b16 v[44:45], v8 offset:4096
    s_waitcnt lgkmcnt(9)
    v_mfma_f32_16x16x32_bf16 v[108:111], v[20:23], v[52:55], v[108:111]
    ds_read_b64_tr_b16 v[46:47], v8 offset:4608
    s_waitcnt lgkmcnt(9)
    v_mfma_f32_16x16x32_bf16 v[112:115], v[24:27], v[52:55], v[112:115]
    ds_read_b128 v[32:35], v5 offset:51200
    s_waitcnt lgkmcnt(8)
    v_mfma_f32_16x16x32_bf16 v[116:119], v[12:15], v[56:59], v[116:119]
    ds_read_b128 v[36:39], v5 offset:53248
    v_mfma_f32_16x16x32_bf16 v[120:123], v[16:19], v[56:59], v[120:123]
    ds_read_b128 v[40:43], v5 offset:55296
    v_mfma_f32_16x16x32_bf16 v[124:127], v[20:23], v[56:59], v[124:127]
    ds_read_b64_tr_b16 v[48:49], v9 offset:4096
    v_mfma_f32_16x16x32_bf16 v[128:131], v[24:27], v[56:59], v[128:131]
    ds_read_b64_tr_b16 v[50:51], v9 offset:4608
    s_waitcnt lgkmcnt(10)
    v_mfma_f32_16x16x32_bf16 v[132:135], v[12:15], v[60:63], v[132:135]
    ds_read_b64_tr_b16 v[52:53], v10 offset:36864
    v_mfma_f32_16x16x32_bf16 v[136:139], v[16:19], v[60:63], v[136:139]
    ds_read_b64_tr_b16 v[54:55], v10 offset:37376
    v_mfma_f32_16x16x32_bf16 v[140:143], v[20:23], v[60:63], v[140:143]
    ds_read_b64_tr_b16 v[56:57], v11 offset:36864
    v_mfma_f32_16x16x32_bf16 v[144:147], v[24:27], v[60:63], v[144:147]
    ds_read_b64_tr_b16 v[58:59], v11 offset:37376
    s_waitcnt lgkmcnt(12)
    v_mfma_f32_16x16x32_bf16 v[148:151], v[12:15], v[64:67], v[148:151]
    v_mfma_f32_16x16x32_bf16 v[152:155], v[16:19], v[64:67], v[152:155]
    v_mfma_f32_16x16x32_bf16 v[156:159], v[20:23], v[64:67], v[156:159]
    v_mfma_f32_16x16x32_bf16 v[160:163], v[24:27], v[64:67], v[160:163]
    s_waitcnt lgkmcnt(9)
    v_mfma_f32_16x16x32_bf16 v[100:103], v[28:31], v[44:47], v[100:103]
    s_waitcnt lgkmcnt(8)
    v_mfma_f32_16x16x32_bf16 v[104:107], v[32:35], v[44:47], v[104:107]
    s_waitcnt lgkmcnt(0)
    s_barrier
    v_mfma_f32_16x16x32_bf16 v[108:111], v[36:39], v[44:47], v[108:111]
    ds_read_b128 v[12:15], v4 offset:0
    v_mfma_f32_16x16x32_bf16 v[112:115], v[40:43], v[44:47], v[112:115]
    ds_read_b64_tr_b16 v[60:61], v8 offset:8192
    v_mfma_f32_16x16x32_bf16 v[116:119], v[28:31], v[48:51], v[116:119]
    ds_read_b64_tr_b16 v[62:63], v8 offset:8704
    v_mfma_f32_16x16x32_bf16 v[120:123], v[32:35], v[48:51], v[120:123]
    ds_read_b128 v[16:19], v4 offset:2048
    v_mfma_f32_16x16x32_bf16 v[124:127], v[36:39], v[48:51], v[124:127]
    ds_read_b128 v[20:23], v4 offset:4096
    v_mfma_f32_16x16x32_bf16 v[128:131], v[40:43], v[48:51], v[128:131]
    ds_read_b128 v[24:27], v4 offset:6144
    v_mfma_f32_16x16x32_bf16 v[132:135], v[28:31], v[52:55], v[132:135]
    ds_read_b64_tr_b16 v[64:65], v9 offset:8192
    v_mfma_f32_16x16x32_bf16 v[136:139], v[32:35], v[52:55], v[136:139]
    ds_read_b64_tr_b16 v[66:67], v9 offset:8704
    v_mfma_f32_16x16x32_bf16 v[140:143], v[36:39], v[52:55], v[140:143]
    ds_read_b64_tr_b16 v[44:45], v8 offset:16384
    v_mfma_f32_16x16x32_bf16 v[144:147], v[40:43], v[52:55], v[144:147]
    ds_read_b64_tr_b16 v[46:47], v8 offset:16896
    v_mfma_f32_16x16x32_bf16 v[148:151], v[28:31], v[56:59], v[148:151]
    ds_read_b64_tr_b16 v[48:49], v9 offset:16384
    v_mfma_f32_16x16x32_bf16 v[152:155], v[32:35], v[56:59], v[152:155]
    ds_read_b64_tr_b16 v[50:51], v9 offset:16896
    v_mfma_f32_16x16x32_bf16 v[156:159], v[36:39], v[56:59], v[156:159]
    v_mfma_f32_16x16x32_bf16 v[160:163], v[40:43], v[56:59], v[160:163]
    s_waitcnt lgkmcnt(9)
    v_mfma_f32_16x16x32_bf16 v[100:103], v[12:15], v[60:63], v[100:103]
    ds_read_b128 v[28:31], v5 offset:0
    s_waitcnt lgkmcnt(9)
    v_mfma_f32_16x16x32_bf16 v[104:107], v[16:19], v[60:63], v[104:107]
    ds_read_b64_tr_b16 v[52:53], v8 offset:12288
    s_waitcnt lgkmcnt(9)
    v_mfma_f32_16x16x32_bf16 v[108:111], v[20:23], v[60:63], v[108:111]
    ds_read_b64_tr_b16 v[54:55], v8 offset:12800
    s_waitcnt lgkmcnt(9)
    v_mfma_f32_16x16x32_bf16 v[112:115], v[24:27], v[60:63], v[112:115]
    ds_read_b128 v[32:35], v5 offset:2048
    s_waitcnt lgkmcnt(8)
    v_mfma_f32_16x16x32_bf16 v[116:119], v[12:15], v[64:67], v[116:119]
    ds_read_b128 v[36:39], v5 offset:4096
    v_mfma_f32_16x16x32_bf16 v[120:123], v[16:19], v[64:67], v[120:123]
    ds_read_b128 v[40:43], v5 offset:6144
    v_mfma_f32_16x16x32_bf16 v[124:127], v[20:23], v[64:67], v[124:127]
    ds_read_b64_tr_b16 v[56:57], v9 offset:12288
    v_mfma_f32_16x16x32_bf16 v[128:131], v[24:27], v[64:67], v[128:131]
    ds_read_b64_tr_b16 v[58:59], v9 offset:12800
    s_waitcnt lgkmcnt(10)
    v_mfma_f32_16x16x32_bf16 v[132:135], v[12:15], v[44:47], v[132:135]
    ds_read_b64_tr_b16 v[60:61], v8 offset:20480
    v_mfma_f32_16x16x32_bf16 v[136:139], v[16:19], v[44:47], v[136:139]
    ds_read_b64_tr_b16 v[62:63], v8 offset:20992
    v_mfma_f32_16x16x32_bf16 v[140:143], v[20:23], v[44:47], v[140:143]
    ds_read_b64_tr_b16 v[64:65], v9 offset:20480
    v_mfma_f32_16x16x32_bf16 v[144:147], v[24:27], v[44:47], v[144:147]
    ds_read_b64_tr_b16 v[66:67], v9 offset:20992
    s_waitcnt lgkmcnt(12)
    v_mfma_f32_16x16x32_bf16 v[148:151], v[12:15], v[48:51], v[148:151]
    v_mfma_f32_16x16x32_bf16 v[152:155], v[16:19], v[48:51], v[152:155]
    v_mfma_f32_16x16x32_bf16 v[156:159], v[20:23], v[48:51], v[156:159]
    v_mfma_f32_16x16x32_bf16 v[160:163], v[24:27], v[48:51], v[160:163]
    s_waitcnt lgkmcnt(9)
    v_mfma_f32_16x16x32_bf16 v[100:103], v[28:31], v[52:55], v[100:103]
    s_waitcnt lgkmcnt(8)
    v_mfma_f32_16x16x32_bf16 v[104:107], v[32:35], v[52:55], v[104:107]
    s_waitcnt lgkmcnt(0)
    s_barrier
    v_mfma_f32_16x16x32_bf16 v[108:111], v[36:39], v[52:55], v[108:111]
    ds_read_b128 v[12:15], v4 offset:16384
    v_mfma_f32_16x16x32_bf16 v[112:115], v[40:43], v[52:55], v[112:115]
    ds_read_b64_tr_b16 v[44:45], v8 offset:24576
    v_mfma_f32_16x16x32_bf16 v[116:119], v[28:31], v[56:59], v[116:119]
    ds_read_b64_tr_b16 v[46:47], v8 offset:25088
    v_mfma_f32_16x16x32_bf16 v[120:123], v[32:35], v[56:59], v[120:123]
    ds_read_b128 v[16:19], v4 offset:18432
    v_mfma_f32_16x16x32_bf16 v[124:127], v[36:39], v[56:59], v[124:127]
    ds_read_b128 v[20:23], v4 offset:20480
    v_mfma_f32_16x16x32_bf16 v[128:131], v[40:43], v[56:59], v[128:131]
    ds_read_b128 v[24:27], v4 offset:22528
    v_mfma_f32_16x16x32_bf16 v[132:135], v[28:31], v[60:63], v[132:135]
    ds_read_b64_tr_b16 v[48:49], v9 offset:24576
    v_mfma_f32_16x16x32_bf16 v[136:139], v[32:35], v[60:63], v[136:139]
    ds_read_b64_tr_b16 v[50:51], v9 offset:25088
    v_mfma_f32_16x16x32_bf16 v[140:143], v[36:39], v[60:63], v[140:143]
    ds_read_b64_tr_b16 v[52:53], v10 offset:0
    v_mfma_f32_16x16x32_bf16 v[144:147], v[40:43], v[60:63], v[144:147]
    ds_read_b64_tr_b16 v[54:55], v10 offset:512
    v_mfma_f32_16x16x32_bf16 v[148:151], v[28:31], v[64:67], v[148:151]
    ds_read_b64_tr_b16 v[56:57], v11 offset:0
    v_mfma_f32_16x16x32_bf16 v[152:155], v[32:35], v[64:67], v[152:155]
    ds_read_b64_tr_b16 v[58:59], v11 offset:512
    v_mfma_f32_16x16x32_bf16 v[156:159], v[36:39], v[64:67], v[156:159]
    v_mfma_f32_16x16x32_bf16 v[160:163], v[40:43], v[64:67], v[160:163]
    s_waitcnt lgkmcnt(9)
    v_mfma_f32_16x16x32_bf16 v[100:103], v[12:15], v[44:47], v[100:103]
    ds_read_b128 v[28:31], v5 offset:16384
    s_waitcnt lgkmcnt(9)
    v_mfma_f32_16x16x32_bf16 v[104:107], v[16:19], v[44:47], v[104:107]
    ds_read_b64_tr_b16 v[60:61], v8 offset:28672
    s_waitcnt lgkmcnt(9)
    v_mfma_f32_16x16x32_bf16 v[108:111], v[20:23], v[44:47], v[108:111]
    ds_read_b64_tr_b16 v[62:63], v8 offset:29184
    s_waitcnt lgkmcnt(9)
    v_mfma_f32_16x16x32_bf16 v[112:115], v[24:27], v[44:47], v[112:115]
    ds_read_b128 v[32:35], v5 offset:18432
    s_waitcnt lgkmcnt(8)
    v_mfma_f32_16x16x32_bf16 v[116:119], v[12:15], v[48:51], v[116:119]
    ds_read_b128 v[36:39], v5 offset:20480
    v_mfma_f32_16x16x32_bf16 v[120:123], v[16:19], v[48:51], v[120:123]
    ds_read_b128 v[40:43], v5 offset:22528
    v_mfma_f32_16x16x32_bf16 v[124:127], v[20:23], v[48:51], v[124:127]
    ds_read_b64_tr_b16 v[64:65], v9 offset:28672
    v_mfma_f32_16x16x32_bf16 v[128:131], v[24:27], v[48:51], v[128:131]
    ds_read_b64_tr_b16 v[66:67], v9 offset:29184
    s_waitcnt lgkmcnt(10)
    v_mfma_f32_16x16x32_bf16 v[132:135], v[12:15], v[52:55], v[132:135]
    ds_read_b64_tr_b16 v[44:45], v10 offset:4096
    v_mfma_f32_16x16x32_bf16 v[136:139], v[16:19], v[52:55], v[136:139]
    ds_read_b64_tr_b16 v[46:47], v10 offset:4608
    v_mfma_f32_16x16x32_bf16 v[140:143], v[20:23], v[52:55], v[140:143]
    ds_read_b64_tr_b16 v[48:49], v11 offset:4096
    v_mfma_f32_16x16x32_bf16 v[144:147], v[24:27], v[52:55], v[144:147]
    ds_read_b64_tr_b16 v[50:51], v11 offset:4608
    s_waitcnt lgkmcnt(12)
    v_mfma_f32_16x16x32_bf16 v[148:151], v[12:15], v[56:59], v[148:151]
    v_mfma_f32_16x16x32_bf16 v[152:155], v[16:19], v[56:59], v[152:155]
    v_mfma_f32_16x16x32_bf16 v[156:159], v[20:23], v[56:59], v[156:159]
    v_mfma_f32_16x16x32_bf16 v[160:163], v[24:27], v[56:59], v[160:163]
    s_waitcnt lgkmcnt(9)
    v_mfma_f32_16x16x32_bf16 v[100:103], v[28:31], v[60:63], v[100:103]
    s_waitcnt lgkmcnt(8)
    v_mfma_f32_16x16x32_bf16 v[104:107], v[32:35], v[60:63], v[104:107]
    s_waitcnt lgkmcnt(0)
    s_barrier
    v_mfma_f32_16x16x32_bf16 v[108:111], v[36:39], v[60:63], v[108:111]
    ds_read_b128 v[12:15], v4 offset:32768
    v_mfma_f32_16x16x32_bf16 v[112:115], v[40:43], v[60:63], v[112:115]
    ds_read_b64_tr_b16 v[52:53], v10 offset:16384
    v_mfma_f32_16x16x32_bf16 v[116:119], v[28:31], v[64:67], v[116:119]
    ds_read_b64_tr_b16 v[54:55], v10 offset:16896
    v_mfma_f32_16x16x32_bf16 v[120:123], v[32:35], v[64:67], v[120:123]
    ds_read_b128 v[16:19], v4 offset:34816
    v_mfma_f32_16x16x32_bf16 v[124:127], v[36:39], v[64:67], v[124:127]
    ds_read_b128 v[20:23], v4 offset:36864
    v_mfma_f32_16x16x32_bf16 v[128:131], v[40:43], v[64:67], v[128:131]
    ds_read_b128 v[24:27], v4 offset:38912
    v_mfma_f32_16x16x32_bf16 v[132:135], v[28:31], v[44:47], v[132:135]
    ds_read_b64_tr_b16 v[56:57], v11 offset:16384
    v_mfma_f32_16x16x32_bf16 v[136:139], v[32:35], v[44:47], v[136:139]
    ds_read_b64_tr_b16 v[58:59], v11 offset:16896
    v_mfma_f32_16x16x32_bf16 v[140:143], v[36:39], v[44:47], v[140:143]
    ds_read_b64_tr_b16 v[60:61], v10 offset:24576
    v_mfma_f32_16x16x32_bf16 v[144:147], v[40:43], v[44:47], v[144:147]
    ds_read_b64_tr_b16 v[62:63], v10 offset:25088
    v_mfma_f32_16x16x32_bf16 v[148:151], v[28:31], v[48:51], v[148:151]
    ds_read_b64_tr_b16 v[64:65], v11 offset:24576
    v_mfma_f32_16x16x32_bf16 v[152:155], v[32:35], v[48:51], v[152:155]
    ds_read_b64_tr_b16 v[66:67], v11 offset:25088
    v_mfma_f32_16x16x32_bf16 v[156:159], v[36:39], v[48:51], v[156:159]
    v_mfma_f32_16x16x32_bf16 v[160:163], v[40:43], v[48:51], v[160:163]
    s_waitcnt lgkmcnt(9)
    v_mfma_f32_16x16x32_bf16 v[100:103], v[12:15], v[52:55], v[100:103]
    ds_read_b128 v[28:31], v5 offset:32768
    s_waitcnt lgkmcnt(9)
    v_mfma_f32_16x16x32_bf16 v[104:107], v[16:19], v[52:55], v[104:107]
    ds_read_b64_tr_b16 v[44:45], v10 offset:20480
    s_waitcnt lgkmcnt(9)
    v_mfma_f32_16x16x32_bf16 v[108:111], v[20:23], v[52:55], v[108:111]
    ds_read_b64_tr_b16 v[46:47], v10 offset:20992
    s_waitcnt lgkmcnt(9)
    v_mfma_f32_16x16x32_bf16 v[112:115], v[24:27], v[52:55], v[112:115]
    ds_read_b128 v[32:35], v5 offset:34816
    s_waitcnt lgkmcnt(8)
    v_mfma_f32_16x16x32_bf16 v[116:119], v[12:15], v[56:59], v[116:119]
    ds_read_b128 v[36:39], v5 offset:36864
    v_mfma_f32_16x16x32_bf16 v[120:123], v[16:19], v[56:59], v[120:123]
    ds_read_b128 v[40:43], v5 offset:38912
    v_mfma_f32_16x16x32_bf16 v[124:127], v[20:23], v[56:59], v[124:127]
    ds_read_b64_tr_b16 v[48:49], v11 offset:20480
    v_mfma_f32_16x16x32_bf16 v[128:131], v[24:27], v[56:59], v[128:131]
    ds_read_b64_tr_b16 v[50:51], v11 offset:20992
    s_waitcnt lgkmcnt(10)
    v_mfma_f32_16x16x32_bf16 v[132:135], v[12:15], v[60:63], v[132:135]
    ds_read_b64_tr_b16 v[52:53], v10 offset:28672
    v_mfma_f32_16x16x32_bf16 v[136:139], v[16:19], v[60:63], v[136:139]
    ds_read_b64_tr_b16 v[54:55], v10 offset:29184
    v_mfma_f32_16x16x32_bf16 v[140:143], v[20:23], v[60:63], v[140:143]
    ds_read_b64_tr_b16 v[56:57], v11 offset:28672
    v_mfma_f32_16x16x32_bf16 v[144:147], v[24:27], v[60:63], v[144:147]
    ds_read_b64_tr_b16 v[58:59], v11 offset:29184
    s_waitcnt lgkmcnt(12)
    v_mfma_f32_16x16x32_bf16 v[148:151], v[12:15], v[64:67], v[148:151]
    v_mfma_f32_16x16x32_bf16 v[152:155], v[16:19], v[64:67], v[152:155]
    v_mfma_f32_16x16x32_bf16 v[156:159], v[20:23], v[64:67], v[156:159]
    v_mfma_f32_16x16x32_bf16 v[160:163], v[24:27], v[64:67], v[160:163]
    s_waitcnt lgkmcnt(9)
    v_mfma_f32_16x16x32_bf16 v[100:103], v[28:31], v[44:47], v[100:103]
    s_waitcnt lgkmcnt(8)
    v_mfma_f32_16x16x32_bf16 v[104:107], v[32:35], v[44:47], v[104:107]
    s_waitcnt lgkmcnt(0)
    s_barrier
    v_mfma_f32_16x16x32_bf16 v[108:111], v[36:39], v[44:47], v[108:111]
    ds_read_b128 v[12:15], v4 offset:49152
    v_mfma_f32_16x16x32_bf16 v[112:115], v[40:43], v[44:47], v[112:115]
    ds_read_b64_tr_b16 v[60:61], v8 offset:0
    v_mfma_f32_16x16x32_bf16 v[116:119], v[28:31], v[48:51], v[116:119]
    ds_read_b64_tr_b16 v[62:63], v8 offset:512
    v_mfma_f32_16x16x32_bf16 v[120:123], v[32:35], v[48:51], v[120:123]
    ds_read_b128 v[16:19], v4 offset:51200
    v_mfma_f32_16x16x32_bf16 v[124:127], v[36:39], v[48:51], v[124:127]
    ds_read_b128 v[20:23], v4 offset:53248
    v_mfma_f32_16x16x32_bf16 v[128:131], v[40:43], v[48:51], v[128:131]
    ds_read_b128 v[24:27], v4 offset:55296
    v_mfma_f32_16x16x32_bf16 v[132:135], v[28:31], v[52:55], v[132:135]
    ds_read_b64_tr_b16 v[64:65], v9 offset:0
    v_mfma_f32_16x16x32_bf16 v[136:139], v[32:35], v[52:55], v[136:139]
    ds_read_b64_tr_b16 v[66:67], v9 offset:512
    v_mfma_f32_16x16x32_bf16 v[140:143], v[36:39], v[52:55], v[140:143]
    ds_read_b64_tr_b16 v[44:45], v10 offset:32768
    v_mfma_f32_16x16x32_bf16 v[144:147], v[40:43], v[52:55], v[144:147]
    ds_read_b64_tr_b16 v[46:47], v10 offset:33280
    v_mfma_f32_16x16x32_bf16 v[148:151], v[28:31], v[56:59], v[148:151]
    ds_read_b64_tr_b16 v[48:49], v11 offset:32768
    s_branch IW_s4
IW_w4:
    s_branch IW_r4
IW_s4:
    v_mfma_f32_16x16x32_bf16 v[152:155], v[32:35], v[56:59], v[152:155]
    ds_read_b64_tr_b16 v[50:51], v11 offset:33280
    v_mfma_f32_16x16x32_bf16 v[156:159], v[36:39], v[56:59], v[156:159]
    v_mfma_f32_16x16x32_bf16 v[160:163], v[40:43], v[56:59], v[160:163]
    s_waitcnt lgkmcnt(9)
    v_mfma_f32_16x16x32_bf16 v[100:103], v[12:15], v[60:63], v[100:103]
    ds_read_b128 v[28:31], v5 offset:49152
    s_waitcnt lgkmcnt(9)
    v_mfma_f32_16x16x32_bf16 v[104:107], v[16:19], v[60:63], v[104:107]
    ds_read_b64_tr_b16 v[52:53], v8 offset:4096
    s_waitcnt lgkmcnt(9)
    v_mfma_f32_16x16x32_bf16 v[108:111], v[20:23], v[60:63], v[108:111]
    ds_read_b64_tr_b16 v[54:55], v8 offset:4608
    s_waitcnt lgkmcnt(9)
    v_mfma_f32_16x16x32_bf16 v[112:115], v[24:27], v[60:63], v[112:115]
    ds_read_b128 v[32:35], v5 offset:51200
    s_waitcnt lgkmcnt(8)
    v_mfma_f32_16x16x32_bf16 v[116:119], v[12:15], v[64:67], v[116:119]
    ds_read_b128 v[36:39], v5 offset:53248
    v_mfma_f32_16x16x32_bf16 v[120:123], v[16:19], v[64:67], v[120:123]
    ds_read_b128 v[40:43], v5 offset:55296
    v_mfma_f32_16x16x32_bf16 v[124:127], v[20:23], v[64:67], v[124:127]
    ds_read_b64_tr_b16 v[56:57], v9 offset:4096
    v_mfma_f32_16x16x32_bf16 v[128:131], v[24:27], v[64:67], v[128:131]
    ds_read_b64_tr_b16 v[58:59], v9 offset:4608
    s_waitcnt lgkmcnt(10)
    v_mfma_f32_16x16x32_bf16 v[132:135], v[12:15], v[44:47], v[132:135]
    ds_read_b64_tr_b16 v[60:61], v10 offset:36864
    v_mfma_f32_16x16x32_bf16 v[136:139], v[16:19], v[44:47], v[136:139]
    ds_read_b64_tr_b16 v[62:63], v10 offset:37376
    v_mfma_f32_16x16x32_bf16 v[140:143], v[20:23], v[44:47], v[140:143]
    ds_read_b64_tr_b16 v[64:65], v11 offset:36864
    v_mfma_f32_16x16x32_bf16 v[144:147], v[24:27], v[44:47], v[144:147]
    ds_read_b64_tr_b16 v[66:67], v11 offset:37376
    s_waitcnt lgkmcnt(12)
    v_mfma_f32_16x16x32_bf16 v[148:151], v[12:15], v[48:51], v[148:151]
    v_mfma_f32_16x16x32_bf16 v[152:155], v[16:19], v[48:51], v[152:155]
    v_mfma_f32_16x16x32_bf16 v[156:159], v[20:23], v[48:51], v[156:159]
    v_mfma_f32_16x16x32_bf16 v[160:163], v[24:27], v[48:51], v[160:163]
    s_waitcnt lgkmcnt(9)
    v_mfma_f32_16x16x32_bf16 v[100:103], v[28:31], v[52:55], v[100:103]
    s_waitcnt lgkmcnt(8)
    v_mfma_f32_16x16x32_bf16 v[104:107], v[32:35], v[52:55], v[104:107]
    s_waitcnt lgkmcnt(0)
    s_barrier
    v_mfma_f32_16x16x32_bf16 v[108:111], v[36:39], v[52:55], v[108:111]
    ds_read_b128 v[12:15], v4 offset:0
    v_mfma_f32_16x16x32_bf16 v[112:115], v[40:43], v[52:55], v[112:115]
    ds_read_b64_tr_b16 v[44:45], v8 offset:8192
    v_mfma_f32_16x16x32_bf16 v[116:119], v[28:31], v[56:59], v[116:119]
    ds_read_b64_tr_b16 v[46:47], v8 offset:8704
    v_mfma_f32_16x16x32_bf16 v[120:123], v[32:35], v[56:59], v[120:123]
    ds_read_b128 v[16:19], v4 offset:2048
    v_mfma_f32_16x16x32_bf16 v[124:127], v[36:39], v[56:59], v[124:127]
    ds_read_b128 v[20:23], v4 offset:4096
    v_mfma_f32_16x16x32_bf16 v[128:131], v[40:43], v[56:59], v[128:131]
    ds_read_b128 v[24:27], v4 offset:6144
    v_mfma_f32_16x16x32_bf16 v[132:135], v[28:31], v[60:63], v[132:135]
    ds_read_b64_tr_b16 v[48:49], v9 offset:8192
    v_mfma_f32_16x16x32_bf16 v[136:139], v[32:35], v[60:63], v[136:139]
    ds_read_b64_tr_b16 v[50:51], v9 offset:8704
    v_mfma_f32_16x16x32_bf16 v[140:143], v[36:39], v[60:63], v[140:143]
    ds_read_b64_tr_b16 v[52:53], v8 offset:16384
    v_mfma_f32_16x16x32_bf16 v[144:147], v[40:43], v[60:63], v[144:147]
    ds_read_b64_tr_b16 v[54:55], v8 offset:16896
    v_mfma_f32_16x16x32_bf16 v[148:151], v[28:31], v[64:67], v[148:151]
    ds_read_b64_tr_b16 v[56:57], v9 offset:16384
    v_mfma_f32_16x16x32_bf16 v[152:155], v[32:35], v[64:67], v[152:155]
    ds_read_b64_tr_b16 v[58:59], v9 offset:16896
    v_mfma_f32_16x16x32_bf16 v[156:159], v[36:39], v[64:67], v[156:159]
    v_mfma_f32_16x16x32_bf16 v[160:163], v[40:43], v[64:67], v[160:163]
    s_waitcnt lgkmcnt(9)
    v_mfma_f32_16x16x32_bf16 v[100:103], v[12:15], v[44:47], v[100:103]
    ds_read_b128 v[28:31], v5 offset:0
    s_waitcnt lgkmcnt(9)
    v_mfma_f32_16x16x32_bf16 v[104:107], v[16:19], v[44:47], v[104:107]
    ds_read_b64_tr_b16 v[60:61], v8 offset:12288
    s_waitcnt lgkmcnt(9)
    v_mfma_f32_16x16x32_bf16 v[108:111], v[20:23], v[44:47], v[108:111]
    ds_read_b64_tr_b16 v[62:63], v8 offset:12800
    s_waitcnt lgkmcnt(9)
    v_mfma_f32_16x16x32_bf16 v[112:115], v[24:27], v[44:47], v[112:115]
    ds_read_b128 v[32:35], v5 offset:2048
    s_waitcnt lgkmcnt(8)
    v_mfma_f32_16x16x32_bf16 v[116:119], v[12:15], v[48:51], v[116:119]
    ds_read_b128 v[36:39], v5 offset:4096
    v_mfma_f32_16x16x32_bf16 v[120:123], v[16:19], v[48:51], v[120:123]
    ds_read_b128 v[40:43], v5 offset:6144
    v_mfma_f32_16x16x32_bf16 v[124:127], v[20:23], v[48:51], v[124:127]
    ds_read_b64_tr_b16 v[64:65], v9 offset:12288
    v_mfma_f32_16x16x32_bf16 v[128:131], v[24:27], v[48:51], v[128:131]
    ds_read_b64_tr_b16 v[66:67], v9 offset:12800
    s_waitcnt lgkmcnt(10)
    v_mfma_f32_16x16x32_bf16 v[132:135], v[12:15], v[52:55], v[132:135]
    ds_read_b64_tr_b16 v[44:45], v8 offset:20480
    v_mfma_f32_16x16x32_bf16 v[136:139], v[16:19], v[52:55], v[136:139]
    ds_read_b64_tr_b16 v[46:47], v8 offset:20992
    v_mfma_f32_16x16x32_bf16 v[140:143], v[20:23], v[52:55], v[140:143]
    ds_read_b64_tr_b16 v[48:49], v9 offset:20480
    v_mfma_f32_16x16x32_bf16 v[144:147], v[24:27], v[52:55], v[144:147]
    ds_read_b64_tr_b16 v[50:51], v9 offset:20992
    s_waitcnt lgkmcnt(12)
    v_mfma_f32_16x16x32_bf16 v[148:151], v[12:15], v[56:59], v[148:151]
    v_mfma_f32_16x16x32_bf16 v[152:155], v[16:19], v[56:59], v[152:155]
    v_mfma_f32_16x16x32_bf16 v[156:159], v[20:23], v[56:59], v[156:159]
    v_mfma_f32_16x16x32_bf16 v[160:163], v[24:27], v[56:59], v[160:163]
    s_waitcnt lgkmcnt(9)
    v_mfma_f32_16x16x32_bf16 v[100:103], v[28:31], v[60:63], v[100:103]
    s_waitcnt lgkmcnt(8)
    v_mfma_f32_16x16x32_bf16 v[104:107], v[32:35], v[60:63], v[104:107]
    s_waitcnt lgkmcnt(0)
    s_barrier
    v_mfma_f32_16x16x32_bf16 v[108:111], v[36:39], v[60:63], v[108:111]
    ds_read_b128 v[12:15], v4 offset:16384
    v_mfma_f32_16x16x32_bf16 v[112:115], v[40:43], v[60:63], v[112:115]
    ds_read_b64_tr_b16 v[52:53], v8 offset:24576
    v_mfma_f32_16x16x32_bf16 v[116:119], v[28:31], v[64:67], v[116:119]
    ds_read_b64_tr_b16 v[54:55], v8 offset:25088
    v_mfma_f32_16x16x32_bf16 v[120:123], v[32:35], v[64:67], v[120:123]
    ds_read_b128 v[16:19], v4 offset:18432
    v_mfma_f32_16x16x32_bf16 v[124:127], v[36:39], v[64:67], v[124:127]
    ds_read_b128 v[20:23], v4 offset:20480
    v_mfma_f32_16x16x32_bf16 v[128:131], v[40:43], v[64:67], v[128:131]
    ds_read_b128 v[24:27], v4 offset:22528
    v_mfma_f32_16x16x32_bf16 v[132:135], v[28:31], v[44:47], v[132:135]
    ds_read_b64_tr_b16 v[56:57], v9 offset:24576
    v_mfma_f32_16x16x32_bf16 v[136:139], v[32:35], v[44:47], v[136:139]
    ds_read_b64_tr_b16 v[58:59], v9 offset:25088
    v_mfma_f32_16x16x32_bf16 v[140:143], v[36:39], v[44:47], v[140:143]
    ds_read_b64_tr_b16 v[60:61], v10 offset:0
    v_mfma_f32_16x16x32_bf16 v[144:147], v[40:43], v[44:47], v[144:147]
    ds_read_b64_tr_b16 v[62:63], v10 offset:512
    v_mfma_f32_16x16x32_bf16 v[148:151], v[28:31], v[48:51], v[148:151]
    ds_read_b64_tr_b16 v[64:65], v11 offset:0
    v_mfma_f32_16x16x32_bf16 v[152:155], v[32:35], v[48:51], v[152:155]
    ds_read_b64_tr_b16 v[66:67], v11 offset:512
    v_mfma_f32_16x16x32_bf16 v[156:159], v[36:39], v[48:51], v[156:159]
    v_mfma_f32_16x16x32_bf16 v[160:163], v[40:43], v[48:51], v[160:163]
    s_waitcnt lgkmcnt(9)
    v_mfma_f32_16x16x32_bf16 v[100:103], v[12:15], v[52:55], v[100:103]
    ds_read_b128 v[28:31], v5 offset:16384
    s_waitcnt lgkmcnt(9)
    v_mfma_f32_16x16x32_bf16 v[104:107], v[16:19], v[52:55], v[104:107]
    ds_read_b64_tr_b16 v[44:45], v8 offset:28672
    s_waitcnt lgkmcnt(9)
    v_mfma_f32_16x16x32_bf16 v[108:111], v[20:23], v[52:55], v[108:111]
    ds_read_b64_tr_b16 v[46:47], v8 offset:29184
    s_waitcnt lgkmcnt(9)
    v_mfma_f32_16x16x32_bf16 v[112:115], v[24:27], v[52:55], v[112:115]
    ds_read_b128 v[32:35], v5 offset:18432
    s_waitcnt lgkmcnt(8)
    v_mfma_f32_16x16x32_bf16 v[116:119], v[12:15], v[56:59], v[116:119]
    ds_read_b128 v[36:39], v5 offset:20480
    v_mfma_f32_16x16x32_bf16 v[120:123], v[16:19], v[56:59], v[120:123]
    ds_read_b128 v[40:43], v5 offset:22528
    v_mfma_f32_16x16x32_bf16 v[124:127], v[20:23], v[56:59], v[124:127]
    ds_read_b64_tr_b16 v[48:49], v9 offset:28672
    v_mfma_f32_16x16x32_bf16 v[128:131], v[24:27], v[56:59], v[128:131]
    ds_read_b64_tr_b16 v[50:51], v9 offset:29184
    s_waitcnt lgkmcnt(10)
    v_mfma_f32_16x16x32_bf16 v[132:135], v[12:15], v[60:63], v[132:135]
    ds_read_b64_tr_b16 v[52:53], v10 offset:4096
    v_mfma_f32_16x16x32_bf16 v[136:139], v[16:19], v[60:63], v[136:139]
    ds_read_b64_tr_b16 v[54:55], v10 offset:4608
    v_mfma_f32_16x16x32_bf16 v[140:143], v[20:23], v[60:63], v[140:143]
    ds_read_b64_tr_b16 v[56:57], v11 offset:4096
    v_mfma_f32_16x16x32_bf16 v[144:147], v[24:27], v[60:63], v[144:147]
    ds_read_b64_tr_b16 v[58:59], v11 offset:4608
    s_waitcnt lgkmcnt(12)
    v_mfma_f32_16x16x32_bf16 v[148:151], v[12:15], v[64:67], v[148:151]
    v_mfma_f32_16x16x32_bf16 v[152:155], v[16:19], v[64:67], v[152:155]
    v_mfma_f32_16x16x32_bf16 v[156:159], v[20:23], v[64:67], v[156:159]
    v_mfma_f32_16x16x32_bf16 v[160:163], v[24:27], v[64:67], v[160:163]
    s_waitcnt lgkmcnt(9)
    v_mfma_f32_16x16x32_bf16 v[100:103], v[28:31], v[44:47], v[100:103]
    s_waitcnt lgkmcnt(8)
    v_mfma_f32_16x16x32_bf16 v[104:107], v[32:35], v[44:47], v[104:107]
    s_waitcnt lgkmcnt(0)
    s_barrier
    v_mfma_f32_16x16x32_bf16 v[108:111], v[36:39], v[44:47], v[108:111]
    ds_read_b128 v[12:15], v4 offset:32768
    v_mfma_f32_16x16x32_bf16 v[112:115], v[40:43], v[44:47], v[112:115]
    ds_read_b64_tr_b16 v[60:61], v10 offset:8192
    v_mfma_f32_16x16x32_bf16 v[116:119], v[28:31], v[48:51], v[116:119]
    ds_read_b64_tr_b16 v[62:63], v10 offset:8704
    v_mfma_f32_16x16x32_bf16 v[120:123], v[32:35], v[48:51], v[120:123]
    ds_read_b128 v[16:19], v4 offset:34816
    v_mfma_f32_16x16x32_bf16 v[124:127], v[36:39], v[48:51], v[124:127]
    ds_read_b128 v[20:23], v4 offset:36864
    v_mfma_f32_16x16x32_bf16 v[128:131], v[40:43], v[48:51], v[128:131]
    ds_read_b128 v[24:27], v4 offset:38912
    v_mfma_f32_16x16x32_bf16 v[132:135], v[28:31], v[52:55], v[132:135]
    ds_read_b64_tr_b16 v[64:65], v11 offset:8192
    v_mfma_f32_16x16x32_bf16 v[136:139], v[32:35], v[52:55], v[136:139]
    ds_read_b64_tr_b16 v[66:67], v11 offset:8704
    v_mfma_f32_16x16x32_bf16 v[140:143], v[36:39], v[52:55], v[140:143]
    ds_read_b64_tr_b16 v[44:45], v10 offset:16384
    v_mfma_f32_16x16x32_bf16 v[144:147], v[40:43], v[52:55], v[144:147]
    ds_read_b64_tr_b16 v[46:47], v10 offset:16896
    v_mfma_f32_16x16x32_bf16 v[148:151], v[28:31], v[56:59], v[148:151]
    ds_read_b64_tr_b16 v[48:49], v11 offset:16384
    v_mfma_f32_16x16x32_bf16 v[152:155], v[32:35], v[56:59], v[152:155]
    ds_read_b64_tr_b16 v[50:51], v11 offset:16896
    v_mfma_f32_16x16x32_bf16 v[156:159], v[36:39], v[56:59], v[156:159]
    v_mfma_f32_16x16x32_bf16 v[160:163], v[40:43], v[56:59], v[160:163]
    s_waitcnt lgkmcnt(9)
    v_mfma_f32_16x16x32_bf16 v[100:103], v[12:15], v[60:63], v[100:103]
    ds_read_b128 v[28:31], v5 offset:32768
    s_waitcnt lgkmcnt(9)
    v_mfma_f32_16x16x32_bf16 v[104:107], v[16:19], v[60:63], v[104:107]
    ds_read_b64_tr_b16 v[52:53], v10 offset:12288
    s_waitcnt lgkmcnt(9)
    v_mfma_f32_16x16x32_bf16 v[108:111], v[20:23], v[60:63], v[108:111]
    ds_read_b64_tr_b16 v[54:55], v10 offset:12800
    s_waitcnt lgkmcnt(9)
    v_mfma_f32_16x16x32_bf16 v[112:115], v[24:27], v[60:63], v[112:115]
    ds_read_b128 v[32:35], v5 offset:34816
    s_waitcnt lgkmcnt(8)
    v_mfma_f32_16x16x32_bf16 v[116:119], v[12:15], v[64:67], v[116:119]
    ds_read_b128 v[36:39], v5 offset:36864
    v_mfma_f32_16x16x32_bf16 v[120:123], v[16:19], v[64:67], v[120:123]
    ds_read_b128 v[40:43], v5 offset:38912
    v_mfma_f32_16x16x32_bf16 v[124:127], v[20:23], v[64:67], v[124:127]
    ds_read_b64_tr_b16 v[56:57], v11 offset:12288
    v_mfma_f32_16x16x32_bf16 v[128:131], v[24:27], v[64:67], v[128:131]
    ds_read_b64_tr_b16 v[58:59], v11 offset:12800
    s_waitcnt lgkmcnt(10)
    v_mfma_f32_16x16x32_bf16 v[132:135], v[12:15], v[44:47], v[132:135]
    ds_read_b64_tr_b16 v[60:61], v10 offset:20480
    v_mfma_f32_16x16x32_bf16 v[136:139], v[16:19], v[44:47], v[136:139]
    ds_read_b64_tr_b16 v[62:63], v10 offset:20992
    v_mfma_f32_16x16x32_bf16 v[140:143], v[20:23], v[44:47], v[140:143]
    ds_read_b64_tr_b16 v[64:65], v11 offset:20480
    v_mfma_f32_16x16x32_bf16 v[144:147], v[24:27], v[44:47], v[144:147]
    ds_read_b64_tr_b16 v[66:67], v11 offset:20992
    s_waitcnt lgkmcnt(12)
    v_mfma_f32_16x16x32_bf16 v[148:151], v[12:15], v[48:51], v[148:151]
    v_mfma_f32_16x16x32_bf16 v[152:155], v[16:19], v[48:51], v[152:155]
    v_mfma_f32_16x16x32_bf16 v[156:159], v[20:23], v[48:51], v[156:159]
    v_mfma_f32_16x16x32_bf16 v[160:163], v[24:27], v[48:51], v[160:163]
    s_waitcnt lgkmcnt(9)
    v_mfma_f32_16x16x32_bf16 v[100:103], v[28:31], v[52:55], v[100:103]
    s_waitcnt lgkmcnt(8)
    v_mfma_f32_16x16x32_bf16 v[104:107], v[32:35], v[52:55], v[104:107]
    s_waitcnt lgkmcnt(0)
    s_barrier
    v_mfma_f32_16x16x32_bf16 v[108:111], v[36:39], v[52:55], v[108:111]
    ds_read_b128 v[12:15], v4 offset:49152
    v_mfma_f32_16x16x32_bf16 v[112:115], v[40:43], v[52:55], v[112:115]
    ds_read_b64_tr_b16 v[44:45], v8 offset:0
    v_mfma_f32_16x16x32_bf16 v[116:119], v[28:31], v[56:59], v[116:119]
    ds_read_b64_tr_b16 v[46:47], v8 offset:512
    v_mfma_f32_16x16x32_bf16 v[120:123], v[32:35], v[56:59], v[120:123]
    ds_read_b128 v[16:19], v4 offset:51200
    v_mfma_f32_16x16x32_bf16 v[124:127], v[36:39], v[56:59], v[124:127]
    ds_read_b128 v[20:23], v4 offset:53248
    v_mfma_f32_16x16x32_bf16 v[128:131], v[40:43], v[56:59], v[128:131]
    ds_read_b128 v[24:27], v4 offset:55296
    v_mfma_f32_16x16x32_bf16 v[132:135], v[28:31], v[60:63], v[132:135]
    ds_read_b64_tr_b16 v[48:49], v9 offset:0
    v_mfma_f32_16x16x32_bf16 v[136:139], v[32:35], v[60:63], v[136:139]
    ds_read_b64_tr_b16 v[50:51], v9 offset:512
    v_mfma_f32_16x16x32_bf16 v[140:143], v[36:39], v[60:63], v[140:143]
    ds_read_b64_tr_b16 v[52:53], v10 offset:24576
    v_mfma_f32_16x16x32_bf16 v[144:147], v[40:43], v[60:63], v[144:147]
    ds_read_b64_tr_b16 v[54:55], v10 offset:25088
    v_mfma_f32_16x16x32_bf16 v[148:151], v[28:31], v[64:67], v[148:151]
    ds_read_b64_tr_b16 v[56:57], v11 offset:24576
    v_mfma_f32_16x16x32_bf16 v[152:155], v[32:35], v[64:67], v[152:155]
    ds_read_b64_tr_b16 v[58:59], v11 offset:25088
    v_mfma_f32_16x16x32_bf16 v[156:159], v[36:39], v[64:67], v[156:159]
    v_mfma_f32_16x16x32_bf16 v[160:163], v[40:43], v[64:67], v[160:163]
    ds_read_b32 v68, v1 offset:48
    s_waitcnt lgkmcnt(10)
    v_mfma_f32_16x16x32_bf16 v[100:103], v[12:15], v[44:47], v[100:103]
    ds_read_b128 v[28:31], v5 offset:49152
    s_waitcnt lgkmcnt(10)
    v_mfma_f32_16x16x32_bf16 v[104:107], v[16:19], v[44:47], v[104:107]
    ds_read_b64_tr_b16 v[60:61], v8 offset:4096
    s_waitcnt lgkmcnt(10)
    v_mfma_f32_16x16x32_bf16 v[108:111], v[20:23], v[44:47], v[108:111]
    ds_read_b64_tr_b16 v[62:63], v8 offset:4608
    s_waitcnt lgkmcnt(10)
    v_mfma_f32_16x16x32_bf16 v[112:115], v[24:27], v[44:47], v[112:115]
    ds_read_b128 v[32:35], v5 offset:51200
    s_waitcnt lgkmcnt(9)
    v_mfma_f32_16x16x32_bf16 v[116:119], v[12:15], v[48:51], v[116:119]
    ds_read_b128 v[36:39], v5 offset:53248
    v_mfma_f32_16x16x32_bf16 v[120:123], v[16:19], v[48:51], v[120:123]
    ds_read_b128 v[40:43], v5 offset:55296
    v_mfma_f32_16x16x32_bf16 v[124:127], v[20:23], v[48:51], v[124:127]
    ds_read_b64_tr_b16 v[64:65], v9 offset:4096
    v_mfma_f32_16x16x32_bf16 v[128:131], v[24:27], v[48:51], v[128:131]
    ds_read_b64_tr_b16 v[66:67], v9 offset:4608
    s_waitcnt lgkmcnt(11)
    v_mfma_f32_16x16x32_bf16 v[132:135], v[12:15], v[52:55], v[132:135]
    ds_read_b64_tr_b16 v[44:45], v10 offset:28672
    v_mfma_f32_16x16x32_bf16 v[136:139], v[16:19], v[52:55], v[136:139]
    ds_read_b64_tr_b16 v[46:47], v10 offset:29184
    v_mfma_f32_16x16x32_bf16 v[140:143], v[20:23], v[52:55], v[140:143]
    ds_read_b64_tr_b16 v[48:49], v11 offset:28672
    v_mfma_f32_16x16x32_bf16 v[144:147], v[24:27], v[52:55], v[144:147]
    ds_read_b64_tr_b16 v[50:51], v11 offset:29184
    s_waitcnt lgkmcnt(13)
    v_mfma_f32_16x16x32_bf16 v[148:151], v[12:15], v[56:59], v[148:151]
    v_mfma_f32_16x16x32_bf16 v[152:155], v[16:19], v[56:59], v[152:155]
    v_mfma_f32_16x16x32_bf16 v[156:159], v[20:23], v[56:59], v[156:159]
    v_mfma_f32_16x16x32_bf16 v[160:163], v[24:27], v[56:59], v[160:163]
    s_waitcnt lgkmcnt(9)
    v_mfma_f32_16x16x32_bf16 v[100:103], v[28:31], v[60:63], v[100:103]
    v_lshlrev_b32 v18, 4, v0
    v_add_u32 v12, s52, v18
    s_waitcnt lgkmcnt(8)
    v_mfma_f32_16x16x32_bf16 v[104:107], v[32:35], v[60:63], v[104:107]
    v_xor_b32 v13, 4096, v12
    v_and_b32 v14, 0x30, v0
    s_waitcnt lgkmcnt(0)
    s_barrier
    v_cmp_gt_u32 vcc, 1, v68
    s_nop 0
    s_and_b32 vcc_lo, vcc_lo, 3
    s_cbranch_scc0 SCK_15
    v_and_b32 v69, 1, v0
    v_lshlrev_b32 v69, 2, v69
    v_add_u32 v69, 159088, v69
    ds_read_b32 v68, v69 offset:0
FW_16:
    s_waitcnt lgkmcnt(0)
    v_cmp_gt_u32 vcc, 1, v68
    s_cbranch_vccz FO_17
    ds_read_b32 v68, v69 offset:0
    s_branch FW_16
FO_17:
SCK_15:
    v_mfma_f32_16x16x32_bf16 v[108:111], v[36:39], v[60:63], v[108:111]
    ds_read_b128 v[68:71], v164 offset:0
    v_add_u32 v14, s53, v14
    v_mfma_f32_16x16x32_bf16 v[112:115], v[40:43], v[60:63], v[112:115]
    ds_read2_b32 v[52:53], v165 offset0:64 offset1:64
    v_xor_b32 v15, 64, v14
    v_mfma_f32_16x16x32_bf16 v[116:119], v[28:31], v[64:67], v[116:119]
    ds_read2_b32 v[54:55], v2 offset0:64 offset1:64
    v_lshlrev_b32 v19, 2, v0
    v_mfma_f32_16x16x32_bf16 v[120:123], v[32:35], v[64:67], v[120:123]
    ds_read2_b32 v[56:57], v165 offset0:128 offset1:128
    v_add_u32 v16, s53, v19
    v_mfma_f32_16x16x32_bf16 v[124:127], v[36:39], v[64:67], v[124:127]
    ds_read2_b32 v[58:59], v2 offset0:128 offset1:128
    v_xor_b32 v17, 256, v16
    v_mfma_f32_16x16x32_bf16 v[128:131], v[40:43], v[64:67], v[128:131]
    ds_read_b128 v[72:75], v164 offset:1024
    v_xor_b32 v18, 8, v3
    v_mfma_f32_16x16x32_bf16 v[132:135], v[28:31], v[44:47], v[132:135]
    ds_read_b128 v[76:79], v164 offset:64
    v_writelane_b32 v18, s50, 1
    v_mfma_f32_16x16x32_bf16 v[136:139], v[32:35], v[44:47], v[136:139]
    ds_read_b128 v[80:83], v164 offset:1088
    v_mov_b32 v20, 0x3f803f80
    v_mfma_f32_16x16x32_bf16 v[140:143], v[36:39], v[44:47], v[140:143]
    ds_read_b128 v[84:87], v164 offset:128
    v_mov_b32 v21, 0x3f803f80
    v_mfma_f32_16x16x32_bf16 v[144:147], v[40:43], v[44:47], v[144:147]
    ds_read_b128 v[88:91], v164 offset:1152
    v_mov_b32 v22, 0x3f803f80
    v_mfma_f32_16x16x32_bf16 v[148:151], v[28:31], v[48:51], v[148:151]
    ds_read_b128 v[92:95], v164 offset:192
    v_mov_b32 v23, 0x3f803f80
    v_mfma_f32_16x16x32_bf16 v[152:155], v[32:35], v[48:51], v[152:155]
    ds_read_b128 v[96:99], v164 offset:1216
    v_mov_b32 v24, 1
    v_and_b32 v4, 15, v0
    v_mfma_f32_16x16x32_bf16 v[156:159], v[36:39], v[48:51], v[156:159]
    v_bfe_u32 v5, v0, 4, 1
    v_lshlrev_b32 v5, 5, v5
    v_mfma_f32_16x16x32_bf16 v[160:163], v[40:43], v[48:51], v[160:163]
    v_lshrrev_b32 v6, 5, v0
    v_lshl_add_u32 v5, v6, 4, v5
    v_lshl_add_u32 v7, v4, 11, v5
    v_lshlrev_b32 v6, 4, v0
    s_waitcnt lgkmcnt(10)
    v_pk_fma_f32 v[100:101], v[68:69], v[52:53], v[100:101]
    v_pk_fma_f32 v[102:103], v[70:71], v[52:53], v[102:103]
    s_waitcnt lgkmcnt(9)
    v_pk_fma_f32 v[116:117], v[68:69], v[54:55], v[116:117]
    v_pk_fma_f32 v[118:119], v[70:71], v[54:55], v[118:119]
    s_waitcnt lgkmcnt(8)
    v_pk_fma_f32 v[132:133], v[68:69], v[56:57], v[132:133]
    v_pk_fma_f32 v[134:135], v[70:71], v[56:57], v[134:135]
    s_waitcnt lgkmcnt(7)
    v_pk_fma_f32 v[148:149], v[68:69], v[58:59], v[148:149]
    v_pk_fma_f32 v[150:151], v[70:71], v[58:59], v[150:151]
    s_waitcnt lgkmcnt(6)
    v_pk_mul_f32 v[100:101], v[100:101], v[72:73]
    v_pk_mul_f32 v[102:103], v[102:103], v[74:75]
    v_pk_mul_f32 v[116:117], v[116:117], v[72:73]
    v_pk_mul_f32 v[118:119], v[118:119], v[74:75]
    v_pk_mul_f32 v[132:133], v[132:133], v[72:73]
    v_pk_mul_f32 v[134:135], v[134:135], v[74:75]
    v_pk_mul_f32 v[148:149], v[148:149], v[72:73]
    v_pk_mul_f32 v[150:151], v[150:151], v[74:75]
    v_exp_f32 v28, v100 clamp
    v_exp_f32 v29, v101 clamp
    v_exp_f32 v30, v102 clamp
    v_exp_f32 v31, v103 clamp
    v_exp_f32 v32, v116 clamp
    v_exp_f32 v33, v117 clamp
    v_exp_f32 v34, v118 clamp
    v_exp_f32 v35, v119 clamp
    v_cvt_pk_bf16_f32 v132, v132, v133
    v_cvt_pk_bf16_f32 v133, v134, v135
    v_cvt_pk_bf16_f32 v148, v148, v149
    v_cvt_pk_bf16_f32 v149, v150, v151
    v_pk_mul_f32 v[100:101], v[100:101], s[40:41] clamp
    v_pk_mul_f32 v[102:103], v[102:103], s[40:41] clamp
    v_pk_mul_f32 v[116:117], v[116:117], s[40:41] clamp
    v_pk_mul_f32 v[118:119], v[118:119], s[40:41] clamp
    v_pk_add_f32 v[28:29], v[28:29], s[74:75]
    v_pk_add_f32 v[30:31], v[30:31], s[74:75]
    v_pk_add_f32 v[32:33], v[32:33], s[74:75]
    v_pk_add_f32 v[34:35], v[34:35], s[74:75]
    v_pk_fma_f32 v[100:101], v[100:101], s[76:77], v[28:29]
    v_pk_fma_f32 v[102:103], v[102:103], s[76:77], v[30:31]
    v_pk_fma_f32 v[116:117], v[116:117], s[76:77], v[32:33]
    v_pk_fma_f32 v[118:119], v[118:119], s[76:77], v[34:35]
    v_cvt_pk_bf16_f32 v100, v100, v101
    v_cvt_pk_bf16_f32 v101, v102, v103
    v_cvt_pk_bf16_f32 v116, v116, v117
    v_cvt_pk_bf16_f32 v117, v118, v119
    s_waitcnt lgkmcnt(5)
    v_pk_fma_f32 v[104:105], v[76:77], v[52:53], v[104:105]
    v_pk_fma_f32 v[106:107], v[78:79], v[52:53], v[106:107]
    v_pk_fma_f32 v[120:121], v[76:77], v[54:55], v[120:121]
    v_pk_fma_f32 v[122:123], v[78:79], v[54:55], v[122:123]
    v_pk_fma_f32 v[136:137], v[76:77], v[56:57], v[136:137]
    v_pk_fma_f32 v[138:139], v[78:79], v[56:57], v[138:139]
    v_pk_fma_f32 v[152:153], v[76:77], v[58:59], v[152:153]
    v_pk_fma_f32 v[154:155], v[78:79], v[58:59], v[154:155]
    s_waitcnt lgkmcnt(4)
    v_pk_mul_f32 v[104:105], v[104:105], v[80:81]
    v_pk_mul_f32 v[106:107], v[106:107], v[82:83]
    v_pk_mul_f32 v[120:121], v[120:121], v[80:81]
    v_pk_mul_f32 v[122:123], v[122:123], v[82:83]
    v_pk_mul_f32 v[136:137], v[136:137], v[80:81]
    v_pk_mul_f32 v[138:139], v[138:139], v[82:83]
    v_pk_mul_f32 v[152:153], v[152:153], v[80:81]
    v_pk_mul_f32 v[154:155], v[154:155], v[82:83]
    v_exp_f32 v36, v104 clamp
    v_exp_f32 v37, v105 clamp
    v_exp_f32 v38, v106 clamp
    v_exp_f32 v39, v107 clamp
    v_exp_f32 v40, v120 clamp
    v_exp_f32 v41, v121 clamp
    v_exp_f32 v42, v122 clamp
    v_exp_f32 v43, v123 clamp
    v_cvt_pk_bf16_f32 v134, v136, v137
    v_cvt_pk_bf16_f32 v135, v138, v139
    v_cvt_pk_bf16_f32 v150, v152, v153
    v_cvt_pk_bf16_f32 v151, v154, v155
    v_pk_mul_f32 v[104:105], v[104:105], s[40:41] clamp
    v_pk_mul_f32 v[106:107], v[106:107], s[40:41] clamp
    v_pk_mul_f32 v[120:121], v[120:121], s[40:41] clamp
    v_pk_mul_f32 v[122:123], v[122:123], s[40:41] clamp
    v_pk_add_f32 v[36:37], v[36:37], s[74:75]
    v_pk_add_f32 v[38:39], v[38:39], s[74:75]
    v_pk_add_f32 v[40:41], v[40:41], s[74:75]
    v_pk_add_f32 v[42:43], v[42:43], s[74:75]
    v_pk_fma_f32 v[104:105], v[104:105], s[76:77], v[36:37]
    v_pk_fma_f32 v[106:107], v[106:107], s[76:77], v[38:39]
    v_pk_fma_f32 v[120:121], v[120:121], s[76:77], v[40:41]
    v_pk_fma_f32 v[122:123], v[122:123], s[76:77], v[42:43]
    v_cvt_pk_bf16_f32 v102, v104, v105
    v_cvt_pk_bf16_f32 v103, v106, v107
    v_cvt_pk_bf16_f32 v118, v120, v121
    v_cvt_pk_bf16_f32 v119, v122, v123
    s_waitcnt lgkmcnt(3)
    v_pk_fma_f32 v[108:109], v[84:85], v[52:53], v[108:109]
    v_pk_fma_f32 v[110:111], v[86:87], v[52:53], v[110:111]
    v_pk_fma_f32 v[124:125], v[84:85], v[54:55], v[124:125]
    v_pk_fma_f32 v[126:127], v[86:87], v[54:55], v[126:127]
    v_pk_fma_f32 v[140:141], v[84:85], v[56:57], v[140:141]
    v_pk_fma_f32 v[142:143], v[86:87], v[56:57], v[142:143]
    v_pk_fma_f32 v[156:157], v[84:85], v[58:59], v[156:157]
    v_pk_fma_f32 v[158:159], v[86:87], v[58:59], v[158:159]
    s_waitcnt lgkmcnt(2)
    v_pk_mul_f32 v[108:109], v[108:109], v[88:89]
    v_pk_mul_f32 v[110:111], v[110:111], v[90:91]
    v_pk_mul_f32 v[124:125], v[124:125], v[88:89]
    v_pk_mul_f32 v[126:127], v[126:127], v[90:91]
    v_pk_mul_f32 v[140:141], v[140:141], v[88:89]
    v_pk_mul_f32 v[142:143], v[142:143], v[90:91]
    v_pk_mul_f32 v[156:157], v[156:157], v[88:89]
    v_pk_mul_f32 v[158:159], v[158:159], v[90:91]
    v_mfma_f32_16x16x32_bf16 v[60:63], v[100:103], v[148:151], 0
    v_exp_f32 v28, v108 clamp
    v_exp_f32 v29, v109 clamp
    v_mfma_f32_16x16x32_bf16 v[64:67], v[116:119], v[148:151], 0
    v_exp_f32 v30, v110 clamp
    v_exp_f32 v31, v111 clamp
    v_mfma_f32_16x16x32_bf16 v[68:71], v[100:103], v[20:23], 0
    v_exp_f32 v32, v124 clamp
    v_exp_f32 v33, v125 clamp
    v_exp_f32 v34, v126 clamp
    v_exp_f32 v35, v127 clamp
    v_cvt_pk_bf16_f32 v136, v140, v141
    v_cvt_pk_bf16_f32 v137, v142, v143
    v_cvt_pk_bf16_f32 v152, v156, v157
    v_cvt_pk_bf16_f32 v153, v158, v159
    v_pk_mul_f32 v[108:109], v[108:109], s[40:41] clamp
    v_pk_mul_f32 v[110:111], v[110:111], s[40:41] clamp
    v_pk_mul_f32 v[124:125], v[124:125], s[40:41] clamp
    v_pk_mul_f32 v[126:127], v[126:127], s[40:41] clamp
    v_pk_add_f32 v[28:29], v[28:29], s[74:75]
    v_pk_add_f32 v[30:31], v[30:31], s[74:75]
    v_pk_add_f32 v[32:33], v[32:33], s[74:75]
    v_pk_add_f32 v[34:35], v[34:35], s[74:75]
    v_pk_fma_f32 v[108:109], v[108:109], s[76:77], v[28:29]
    v_pk_fma_f32 v[110:111], v[110:111], s[76:77], v[30:31]
    v_pk_fma_f32 v[124:125], v[124:125], s[76:77], v[32:33]
    v_pk_fma_f32 v[126:127], v[126:127], s[76:77], v[34:35]
    v_cvt_pk_bf16_f32 v104, v108, v109
    v_cvt_pk_bf16_f32 v105, v110, v111
    v_cvt_pk_bf16_f32 v120, v124, v125
    v_cvt_pk_bf16_f32 v121, v126, v127
    s_waitcnt lgkmcnt(1)
    v_pk_fma_f32 v[112:113], v[92:93], v[52:53], v[112:113]
    v_pk_fma_f32 v[114:115], v[94:95], v[52:53], v[114:115]
    v_pk_fma_f32 v[128:129], v[92:93], v[54:55], v[128:129]
    v_pk_fma_f32 v[130:131], v[94:95], v[54:55], v[130:131]
    v_pk_fma_f32 v[144:145], v[92:93], v[56:57], v[144:145]
    v_pk_fma_f32 v[146:147], v[94:95], v[56:57], v[146:147]
    v_pk_fma_f32 v[160:161], v[92:93], v[58:59], v[160:161]
    v_pk_fma_f32 v[162:163], v[94:95], v[58:59], v[162:163]
    s_waitcnt lgkmcnt(0)
    v_pk_mul_f32 v[112:113], v[112:113], v[96:97]
    v_pk_mul_f32 v[114:115], v[114:115], v[98:99]
    v_pk_mul_f32 v[128:129], v[128:129], v[96:97]
    v_pk_mul_f32 v[130:131], v[130:131], v[98:99]
    v_pk_mul_f32 v[144:145], v[144:145], v[96:97]
    v_pk_mul_f32 v[146:147], v[146:147], v[98:99]
    v_pk_mul_f32 v[160:161], v[160:161], v[96:97]
    v_pk_mul_f32 v[162:163], v[162:163], v[98:99]
    v_mfma_f32_16x16x32_bf16 v[72:75], v[116:119], v[20:23], 0
    v_exp_f32 v36, v112 clamp
    v_exp_f32 v37, v113 clamp
    v_mfma_f32_16x16x32_bf16 v[44:47], v[100:103], v[132:135], 0
    v_exp_f32 v38, v114 clamp
    v_exp_f32 v39, v115 clamp
    v_mfma_f32_16x16x32_bf16 v[48:51], v[116:119], v[132:135], 0
    v_exp_f32 v40, v128 clamp
    v_exp_f32 v41, v129 clamp
    v_exp_f32 v42, v130 clamp
    v_exp_f32 v43, v131 clamp
    v_cvt_pk_bf16_f32 v138, v144, v145
    v_cvt_pk_bf16_f32 v139, v146, v147
    v_cvt_pk_bf16_f32 v154, v160, v161
    v_cvt_pk_bf16_f32 v155, v162, v163
    v_pk_mul_f32 v[112:113], v[112:113], s[40:41] clamp
    v_pk_mul_f32 v[114:115], v[114:115], s[40:41] clamp
    s_branch IW_s5
IW_w5:
    s_branch IW_r5
IW_s5:
    v_pk_mul_f32 v[128:129], v[128:129], s[40:41] clamp
    v_pk_mul_f32 v[130:131], v[130:131], s[40:41] clamp
    v_pk_add_f32 v[36:37], v[36:37], s[74:75]
    v_pk_add_f32 v[38:39], v[38:39], s[74:75]
    v_pk_add_f32 v[40:41], v[40:41], s[74:75]
    v_pk_add_f32 v[42:43], v[42:43], s[74:75]
    v_pk_fma_f32 v[112:113], v[112:113], s[76:77], v[36:37]
    v_pk_fma_f32 v[114:115], v[114:115], s[76:77], v[38:39]
    v_pk_fma_f32 v[128:129], v[128:129], s[76:77], v[40:41]
    v_pk_fma_f32 v[130:131], v[130:131], s[76:77], v[42:43]
    v_cvt_pk_bf16_f32 v106, v112, v113
    v_cvt_pk_bf16_f32 v107, v114, v115
    v_cvt_pk_bf16_f32 v122, v128, v129
    v_cvt_pk_bf16_f32 v123, v130, v131
    v_mfma_f32_16x16x32_bf16 v[60:63], v[104:107], v[152:155], v[60:63]
    s_nop 0
    v_mfma_f32_16x16x32_bf16 v[64:67], v[120:123], v[152:155], v[64:67]
    v_mfma_f32_16x16x32_bf16 v[68:71], v[104:107], v[20:23], v[68:71]
    v_mfma_f32_16x16x32_bf16 v[72:75], v[120:123], v[20:23], v[72:75]
    v_mfma_f32_16x16x32_bf16 v[44:47], v[104:107], v[136:139], v[44:47]
    v_mfma_f32_16x16x32_bf16 v[48:51], v[120:123], v[136:139], v[48:51]
    buffer_load_dwordx4 v[140:143], v7, s[12:15], s42 offen offset:0
    buffer_load_dwordx4 v[144:147], v7, s[12:15], s42 offen offset:64
    buffer_load_dwordx4 v[156:159], v7, s[12:15], s43 offen offset:0
    buffer_load_dwordx4 v[160:163], v7, s[12:15], s43 offen offset:64
    ds_write_b128 v12, v[60:63] offset:0
    ds_write_b128 v12, v[64:67] offset:1024
    s_mov_b32 exec_lo, 0x10001
    s_mov_b32 exec_hi, 0x10001
    ds_write_b128 v14, v[68:71]
    ds_write_b128 v15, v[72:75]
    s_mov_b64 exec, 1
    ds_write_b32 v3, v24 offset:32
    s_mov_b64 exec, -1
F_xw:
    ds_read_b32 v25, v18 offset:32
    ds_read_b128 v[28:31], v13 offset:1024
    ds_read_b128 v[32:35], v13
    ds_read_b32 v26, v16
    ds_read_b32 v27, v17
    s_waitcnt lgkmcnt(4)
    v_cmp_eq_u32 vcc, 0, v25
    s_cbranch_vccz F_xx
    s_waitcnt lgkmcnt(0)
    s_branch F_xw
F_xx:
    s_waitcnt lgkmcnt(3)
    v_add_f32 v44, v44, v28
    v_add_f32 v45, v45, v29
    v_add_f32 v46, v46, v30
    v_add_f32 v47, v47, v31
    buffer_atomic_add_f32 v44, v19, s[24:27], s46 offen offset:0
    buffer_atomic_add_f32 v45, v19, s[24:27], s46 offen offset:256
    buffer_atomic_add_f32 v46, v19, s[24:27], s46 offen offset:512
    buffer_atomic_add_f32 v47, v19, s[24:27], s46 offen offset:768
    s_waitcnt lgkmcnt(2)
    v_add_f32 v48, v48, v32
    v_add_f32 v49, v49, v33
    v_add_f32 v50, v50, v34
    v_add_f32 v51, v51, v35
    buffer_atomic_add_f32 v48, v19, s[24:27], s47 offen offset:0
    buffer_atomic_add_f32 v49, v19, s[24:27], s47 offen offset:256
    buffer_atomic_add_f32 v50, v19, s[24:27], s47 offen offset:512
    buffer_atomic_add_f32 v51, v19, s[24:27], s47 offen offset:768
    s_waitcnt lgkmcnt(0)
    v_add_f32 v26, v26, v27
    s_mov_b64 exec, 0xffff
    buffer_atomic_add_f32 v26, v19, s[24:27], s48 offen
    s_mov_b64 exec, 1
    ds_add_u32 v3, v24 offset:32
    s_mov_b64 exec, -1
    s_setprio 2
    v_mov_b32 v2, v7
    s_lshl_b32 s47, s3, 7
    s_add_u32 s47, s47, 157184
    v_lshlrev_b32 v5, 2, v4
    v_add_u32 v5, s47, v5
    ds_read2_b32 v[76:77], v5 offset0:0 offset1:128
    ds_read2_b32 v[78:79], v5 offset0:16 offset1:144
    v_lshrrev_b32 v4, 3, v0
    v_and_b32 v5, 7, v0
    v_lshrrev_b32 v6, 1, v4
    v_lshlrev_b32 v7, 1, v6
    v_xor_b32 v7, v5, v7
    v_lshlrev_b32 v7, 4, v7
    v_lshl_add_u32 v40, v4, 11, v7
    v_and_b32 v6, 1, v6
    v_lshlrev_b32 v6, 1, v6
    v_xor_b32 v41, v5, v6
    v_xor_b32 v42, 4, v41
    v_lshlrev_b32 v41, 4, v41
    v_lshlrev_b32 v42, 4, v42
    v_mul_u32_u24 v7, 6144, v4
    v_add_u32 v41, v41, v7
    v_add_u32 v42, v42, v7
    v_add_u32 v42, 49152, v42
    s_mul_i32 s56, s3, 98304
    s_lshl_b32 s47, s10, 7
    s_add_u32 s56, s56, s47
    s_lshl_b32 s57, s29, 7
    s_lshl_b32 s47, s3, 15
    s_add_u32 s57, s57, s47
    s_and_b32 s81, s28, 3
    s_mul_i32 s81, s81, 4
    s_lshr_b32 s47, s28, 2
    s_mul_i32 s47, s47, 1
    s_add_u32 s81, s81, s47
    s_lshl_b32 s78, s3, 11
    s_lshl_b32 s44, s10, 1
    s_add_u32 s44, s44, s37
    s_mul_i32 s45, s44, 4224
    s_mov_b32 s52, s45
    s_add_u32 s53, s45, 4096
    s_lshl_b32 s51, s44, 3
    s_and_b32 s47, s32, 3
    s_add_u32 s51, s51, s47
    s_lshl_b32 s51, s51, 7
    v_xor_b32 v18, 8, v3
    v_mov_b32 v25, 0

    s_add_u32 s54, s51, 0x82d000
    s_add_u32 s54, s72, s54
    s_addc_u32 s55, s73, 0
    s_add_u32 s82, s49, 0x82d000
    s_add_u32 s82, s72, s82
    s_addc_u32 s83, s73, 0
    s_lshl_b32 s57, s29, 7
    s_and_b32 s47, s3, 1
    s_lshl_b32 s79, s47, 12
    s_lshl_b32 s47, s47, 16
    s_add_u32 s57, s57, s47

    s_setprio 2
    s_waitcnt lgkmcnt(0)
    v_mul_f32 v76, v76, v77
    v_add_f32 v77, 1.0, v77
    v_mul_f32 v78, v78, v79
    v_add_f32 v79, 1.0, v79
    s_waitcnt vmcnt(9)
    v_lshlrev_b32 v100, 16, v140
    v_and_b32 v101, 0xffff0000, v140
    v_lshlrev_b32 v102, 16, v141
    v_and_b32 v103, 0xffff0000, v141
    v_lshlrev_b32 v104, 16, v142
    v_and_b32 v105, 0xffff0000, v142
    v_lshlrev_b32 v106, 16, v143
    v_and_b32 v107, 0xffff0000, v143
    v_fma_f32 v100, v100, v77, v76
    v_fma_f32 v101, v101, v77, v76
    v_fma_f32 v102, v102, v77, v76
    v_fma_f32 v103, v103, v77, v76
    v_fma_f32 v104, v104, v77, v76
    v_fma_f32 v105, v105, v77, v76
    v_fma_f32 v106, v106, v77, v76
    v_fma_f32 v107, v107, v77, v76
    v_lshlrev_b32 v108, 16, v144
    v_and_b32 v109, 0xffff0000, v144
    v_lshlrev_b32 v110, 16, v145
    v_and_b32 v111, 0xffff0000, v145
    v_lshlrev_b32 v112, 16, v146
    v_and_b32 v113, 0xffff0000, v146
    v_lshlrev_b32 v114, 16, v147
    v_and_b32 v115, 0xffff0000, v147
    v_fma_f32 v108, v108, v77, v76
    v_fma_f32 v109, v109, v77, v76
    v_fma_f32 v110, v110, v77, v76
    v_fma_f32 v111, v111, v77, v76
    v_fma_f32 v112, v112, v77, v76
    v_fma_f32 v113, v113, v77, v76
    v_fma_f32 v114, v114, v77, v76
    v_fma_f32 v115, v115, v77, v76
    v_lshlrev_b32 v116, 16, v156
    v_and_b32 v117, 0xffff0000, v156
    v_lshlrev_b32 v118, 16, v157
    v_and_b32 v119, 0xffff0000, v157
    v_lshlrev_b32 v120, 16, v158
    v_and_b32 v121, 0xffff0000, v158
    v_lshlrev_b32 v122, 16, v159
    v_and_b32 v123, 0xffff0000, v159
    v_fma_f32 v116, v116, v79, v78
    v_fma_f32 v117, v117, v79, v78
    v_fma_f32 v118, v118, v79, v78
    v_fma_f32 v119, v119, v79, v78
    v_fma_f32 v120, v120, v79, v78
    v_fma_f32 v121, v121, v79, v78
    v_fma_f32 v122, v122, v79, v78
    v_fma_f32 v123, v123, v79, v78
    v_lshlrev_b32 v124, 16, v160
    v_and_b32 v125, 0xffff0000, v160
    v_lshlrev_b32 v126, 16, v161
    v_and_b32 v127, 0xffff0000, v161
    v_lshlrev_b32 v128, 16, v162
    v_and_b32 v129, 0xffff0000, v162
    v_lshlrev_b32 v130, 16, v163
    v_and_b32 v131, 0xffff0000, v163
    v_fma_f32 v124, v124, v79, v78
    v_fma_f32 v125, v125, v79, v78
    v_fma_f32 v126, v126, v79, v78
    v_fma_f32 v127, v127, v79, v78
    v_fma_f32 v128, v128, v79, v78
    v_fma_f32 v129, v129, v79, v78
    v_fma_f32 v130, v130, v79, v78
    v_fma_f32 v131, v131, v79, v78
    v_permlane16_swap_b32 v100, v104
    v_permlane16_swap_b32 v101, v105
    v_permlane16_swap_b32 v102, v106
    v_permlane16_swap_b32 v103, v107
    v_permlane16_swap_b32 v108, v112
    v_permlane16_swap_b32 v109, v113
    v_permlane16_swap_b32 v110, v114
    v_permlane16_swap_b32 v111, v115
    v_permlane16_swap_b32 v116, v120
    v_permlane16_swap_b32 v117, v121
    v_permlane16_swap_b32 v118, v122
    v_permlane16_swap_b32 v119, v123
    v_permlane16_swap_b32 v124, v128
    v_permlane16_swap_b32 v125, v129
    v_permlane16_swap_b32 v126, v130
    v_permlane16_swap_b32 v127, v131
    s_setprio 2
    s_cmp_lt_u32 s3, 2
    s_cbranch_scc1 F_w0
    v_cmp_gt_u32 vcc, 1, v25
    s_cbranch_vccz CW_18
    ds_read_b32 v25, v1 offset:0
FW_19:
    s_waitcnt lgkmcnt(0)
    v_cmp_gt_u32 vcc, 1, v25
    s_cbranch_vccz FO_20
    s_sleep 2
    ds_read_b32 v25, v1 offset:0
    s_branch FW_19
FO_20:
CW_18:
    s_add_u32 s47, s81, 0
    s_and_b32 s47, s47, 15
    s_lshl_b32 s47, s47, 17
    s_add_u32 m0, s79, 147456
    s_add_u32 s47, s47, s57
    buffer_load_dwordx4 v40, s[20:23], s47 offen lds
    s_add_u32 m0, m0, 1024
    s_add_u32 s47, s47, 16384
    buffer_load_dwordx4 v40, s[20:23], s47 offen lds
    s_add_u32 m0, m0, 1024
    s_add_u32 s47, s47, 16384
    buffer_load_dwordx4 v40, s[20:23], s47 offen lds
    s_add_u32 m0, m0, 1024
    s_add_u32 s47, s47, 16384
    buffer_load_dwordx4 v40, s[20:23], s47 offen lds
    v_cmp_gt_u32 vcc, 2, v25
    s_cbranch_vccz CW_21
    ds_read_b32 v25, v1 offset:0
FW_22:
    s_waitcnt lgkmcnt(0)
    v_cmp_gt_u32 vcc, 2, v25
    s_cbranch_vccz FO_23
    s_sleep 2
    ds_read_b32 v25, v1 offset:0
    s_branch FW_22
FO_23:
CW_21:
    s_add_u32 s47, s81, 1
    s_and_b32 s47, s47, 15
    s_lshl_b32 s47, s47, 17
    s_add_u32 m0, s79, 0
    s_add_u32 s47, s47, s57
    buffer_load_dwordx4 v40, s[20:23], s47 offen lds
    s_add_u32 m0, m0, 1024
    s_add_u32 s47, s47, 16384
    buffer_load_dwordx4 v40, s[20:23], s47 offen lds
    s_add_u32 m0, m0, 1024
    s_add_u32 s47, s47, 16384
    buffer_load_dwordx4 v40, s[20:23], s47 offen lds
    s_add_u32 m0, m0, 1024
    s_add_u32 s47, s47, 16384
    buffer_load_dwordx4 v40, s[20:23], s47 offen lds
    s_waitcnt vmcnt(8)
    s_branch F_w1
F_w0:
    s_waitcnt vmcnt(0)
F_w1:
    s_mov_b32 s49, 1
    s_atomic_add s49, s[82:83], 0x0
    s_atomic_add s49, s[82:83], 0x80
    s_atomic_add s49, s[82:83], 0x100
    s_atomic_add s49, s[82:83], 0x180
    v_mov_b32 v26, 3
    s_mov_b64 exec, 1
    ds_write_b32 v3, v26 offset:32
    s_mov_b64 exec, -1
    s_cmp_ge_u32 s3, 2
    s_cbranch_scc1 F_wo
    ds_read_b32 v26, v18 offset:32
FW_24:
    s_waitcnt lgkmcnt(0)
    v_cmp_gt_u32 vcc, 2, v26
    s_cbranch_vccz FO_25
    ds_read_b32 v26, v18 offset:32
    s_branch FW_24
FO_25:
    v_cmp_gt_u32 vcc, 4, v25
    s_cbranch_vccz CW_26
    ds_read_b32 v25, v1 offset:0
FW_27:
    s_waitcnt lgkmcnt(0)
    v_cmp_gt_u32 vcc, 4, v25
    s_cbranch_vccz FO_28
    s_sleep 2
    ds_read_b32 v25, v1 offset:0
    s_branch FW_27
FO_28:
CW_26:
    v_lshlrev_b32 v9, 4, v0
    s_lshl_b32 s50, s3, 7
    s_add_u32 s50, s50, 159232
    s_add_u32 m0, s78, 40960
SP_29:
    s_load_dword s58, s[54:55], 0 glc
    s_waitcnt lgkmcnt(0)
    s_cmp_ge_u32 s58, 32
    s_cbranch_scc1 SD_30
    s_sleep 1
    s_branch SP_29
SD_30:
    buffer_load_dwordx4 v9, s[24:27], s52 offen offset:0 sc1 lds
    buffer_load_dwordx4 v9, s[24:27], s52 offen offset:1024 sc1 lds
    s_add_u32 m0, m0, 2048
    s_nop 0
    buffer_load_dwordx4 v9, s[24:27], s52 offen offset:2048 sc1 lds
    buffer_load_dwordx4 v9, s[24:27], s52 offen offset:3072 sc1 lds
    s_mov_b32 m0, s50
    s_mov_b32 exec_hi, 0
    buffer_load_dword v19, s[24:27], s53 offen sc1 lds
    s_mov_b64 exec, 1
    s_lshl_b32 s50, s3, 2
    s_add_u32 m0, s50, 159168
    s_add_u32 s51, s51, 184320
    buffer_load_dword v19, s[24:27], s51 offen sc1 lds
    s_waitcnt vmcnt(0)
    s_mov_b64 exec, 1
    v_mov_b32 v26, 32
    ds_write_b32 v3, v26 offset:128
    s_mov_b64 exec, -1
    s_branch F_wj
F_wo:
    v_cmp_gt_u32 vcc, 2, v25
    s_cbranch_vccz CW_31
    ds_read_b32 v25, v1 offset:0
FW_32:
    s_waitcnt lgkmcnt(0)
    v_cmp_gt_u32 vcc, 2, v25
    s_cbranch_vccz FO_33
    s_sleep 2
    ds_read_b32 v25, v1 offset:0
    s_branch FW_32
FO_33:
CW_31:
    s_add_u32 s47, s81, 2
    s_and_b32 s47, s47, 15
    s_lshl_b32 s47, s47, 17
    s_add_u32 m0, s79, 8192
    s_add_u32 s47, s47, s57
    buffer_load_dwordx4 v40, s[20:23], s47 offen lds
    s_add_u32 m0, m0, 1024
    s_add_u32 s47, s47, 16384
    buffer_load_dwordx4 v40, s[20:23], s47 offen lds
    s_add_u32 m0, m0, 1024
    s_add_u32 s47, s47, 16384
    buffer_load_dwordx4 v40, s[20:23], s47 offen lds
    s_add_u32 m0, m0, 1024
    s_add_u32 s47, s47, 16384
    buffer_load_dwordx4 v40, s[20:23], s47 offen lds
    v_cmp_gt_u32 vcc, 2, v25
    s_cbranch_vccz CW_34
    ds_read_b32 v25, v1 offset:0
FW_35:
    s_waitcnt lgkmcnt(0)
    v_cmp_gt_u32 vcc, 2, v25
    s_cbranch_vccz FO_36
    s_sleep 2
    ds_read_b32 v25, v1 offset:0
    s_branch FW_35
FO_36:
CW_34:
    s_waitcnt vmcnt(8)
    s_add_u32 s47, s81, 3
    s_and_b32 s47, s47, 15
    s_lshl_b32 s47, s47, 17
    s_add_u32 m0, s79, 139264
    s_add_u32 s47, s47, s57
    buffer_load_dwordx4 v40, s[20:23], s47 offen lds
    s_add_u32 m0, m0, 1024
    s_add_u32 s47, s47, 16384
    buffer_load_dwordx4 v40, s[20:23], s47 offen lds
    s_add_u32 m0, m0, 1024
    s_add_u32 s47, s47, 16384
    buffer_load_dwordx4 v40, s[20:23], s47 offen lds
    s_add_u32 m0, m0, 1024
    s_add_u32 s47, s47, 16384
    buffer_load_dwordx4 v40, s[20:23], s47 offen lds
    v_cmp_gt_u32 vcc, 3, v25
    s_cbranch_vccz CW_37
    ds_read_b32 v25, v1 offset:0
FW_38:
    s_waitcnt lgkmcnt(0)
    v_cmp_gt_u32 vcc, 3, v25
    s_cbranch_vccz FO_39
    s_sleep 2
    ds_read_b32 v25, v1 offset:0
    s_branch FW_38
FO_39:
CW_37:
    s_waitcnt vmcnt(8)
    s_add_u32 s47, s81, 4
    s_and_b32 s47, s47, 15
    s_lshl_b32 s47, s47, 17
    s_add_u32 m0, s79, 16384
    s_add_u32 s47, s47, s57
    buffer_load_dwordx4 v40, s[20:23], s47 offen lds
    s_add_u32 m0, m0, 1024
    s_add_u32 s47, s47, 16384
    buffer_load_dwordx4 v40, s[20:23], s47 offen lds
    s_add_u32 m0, m0, 1024
    s_add_u32 s47, s47, 16384
    buffer_load_dwordx4 v40, s[20:23], s47 offen lds
    s_add_u32 m0, m0, 1024
    s_add_u32 s47, s47, 16384
    buffer_load_dwordx4 v40, s[20:23], s47 offen lds
    v_cmp_gt_u32 vcc, 3, v25
    s_cbranch_vccz CW_40
    ds_read_b32 v25, v1 offset:0
FW_41:
    s_waitcnt lgkmcnt(0)
    v_cmp_gt_u32 vcc, 3, v25
    s_cbranch_vccz FO_42
    s_sleep 2
    ds_read_b32 v25, v1 offset:0
    s_branch FW_41
FO_42:
CW_40:
    s_waitcnt vmcnt(8)
    s_add_u32 s47, s81, 5
    s_and_b32 s47, s47, 15
    s_lshl_b32 s47, s47, 17
    s_add_u32 m0, s79, 24576
    s_add_u32 s47, s47, s57
    buffer_load_dwordx4 v40, s[20:23], s47 offen lds
    s_add_u32 m0, m0, 1024
    s_add_u32 s47, s47, 16384
    buffer_load_dwordx4 v40, s[20:23], s47 offen lds
    s_add_u32 m0, m0, 1024
    s_add_u32 s47, s47, 16384
    buffer_load_dwordx4 v40, s[20:23], s47 offen lds
    s_add_u32 m0, m0, 1024
    s_add_u32 s47, s47, 16384
    buffer_load_dwordx4 v40, s[20:23], s47 offen lds
    v_cmp_gt_u32 vcc, 3, v25
    s_cbranch_vccz CW_43
    ds_read_b32 v25, v1 offset:0
FW_44:
    s_waitcnt lgkmcnt(0)
    v_cmp_gt_u32 vcc, 3, v25
    s_cbranch_vccz FO_45
    s_sleep 2
    ds_read_b32 v25, v1 offset:0
    s_branch FW_44
FO_45:
CW_43:
    s_waitcnt vmcnt(8)
    s_add_u32 s47, s81, 6
    s_and_b32 s47, s47, 15
    s_lshl_b32 s47, s47, 17
    s_add_u32 m0, s79, 131072
    s_add_u32 s47, s47, s57
    buffer_load_dwordx4 v40, s[20:23], s47 offen lds
    s_add_u32 m0, m0, 1024
    s_add_u32 s47, s47, 16384
    buffer_load_dwordx4 v40, s[20:23], s47 offen lds
    s_add_u32 m0, m0, 1024
    s_add_u32 s47, s47, 16384
    buffer_load_dwordx4 v40, s[20:23], s47 offen lds
    s_add_u32 m0, m0, 1024
    s_add_u32 s47, s47, 16384
    buffer_load_dwordx4 v40, s[20:23], s47 offen lds
    v_cmp_gt_u32 vcc, 4, v25
    s_cbranch_vccz CW_46
    ds_read_b32 v25, v1 offset:0
FW_47:
    s_waitcnt lgkmcnt(0)
    v_cmp_gt_u32 vcc, 4, v25
    s_cbranch_vccz FO_48
    s_sleep 2
    ds_read_b32 v25, v1 offset:0
    s_branch FW_47
FO_48:
CW_46:
    s_waitcnt vmcnt(8)
    s_add_u32 s47, s81, 7
    s_and_b32 s47, s47, 15
    s_lshl_b32 s47, s47, 17
    s_add_u32 m0, s79, 81920
    s_add_u32 s47, s47, s57
    buffer_load_dwordx4 v40, s[20:23], s47 offen lds
    s_add_u32 m0, m0, 1024
    s_add_u32 s47, s47, 16384
    buffer_load_dwordx4 v40, s[20:23], s47 offen lds
    s_add_u32 m0, m0, 1024
    s_add_u32 s47, s47, 16384
    buffer_load_dwordx4 v40, s[20:23], s47 offen lds
    s_add_u32 m0, m0, 1024
    s_add_u32 s47, s47, 16384
    buffer_load_dwordx4 v40, s[20:23], s47 offen lds
    v_cmp_gt_u32 vcc, 5, v25
    s_cbranch_vccz CW_49
    ds_read_b32 v25, v1 offset:0
FW_50:
    s_waitcnt lgkmcnt(0)
    v_cmp_gt_u32 vcc, 5, v25
    s_cbranch_vccz FO_51
    s_sleep 2
    ds_read_b32 v25, v1 offset:0
    s_branch FW_50
FO_51:
CW_49:
    s_waitcnt vmcnt(8)
    s_add_u32 s47, s81, 8
    s_and_b32 s47, s47, 15
    s_lshl_b32 s47, s47, 17
    s_add_u32 m0, s79, 49152
    s_add_u32 s47, s47, s57
    buffer_load_dwordx4 v40, s[20:23], s47 offen lds
    s_add_u32 m0, m0, 1024
    s_add_u32 s47, s47, 16384
    buffer_load_dwordx4 v40, s[20:23], s47 offen lds
    s_add_u32 m0, m0, 1024
    s_add_u32 s47, s47, 16384
    buffer_load_dwordx4 v40, s[20:23], s47 offen lds
    s_add_u32 m0, m0, 1024
    s_add_u32 s47, s47, 16384
    buffer_load_dwordx4 v40, s[20:23], s47 offen lds
    v_cmp_gt_u32 vcc, 5, v25
    s_cbranch_vccz CW_52
    ds_read_b32 v25, v1 offset:0
FW_53:
    s_waitcnt lgkmcnt(0)
    v_cmp_gt_u32 vcc, 5, v25
    s_cbranch_vccz FO_54
    s_sleep 2
    ds_read_b32 v25, v1 offset:0
    s_branch FW_53
FO_54:
CW_52:
    s_waitcnt vmcnt(8)
    s_add_u32 s47, s81, 9
    s_and_b32 s47, s47, 15
    s_lshl_b32 s47, s47, 17
    s_add_u32 m0, s79, 57344
    s_add_u32 s47, s47, s57
    buffer_load_dwordx4 v40, s[20:23], s47 offen lds
    s_add_u32 m0, m0, 1024
    s_add_u32 s47, s47, 16384
    buffer_load_dwordx4 v40, s[20:23], s47 offen lds
    s_add_u32 m0, m0, 1024
    s_add_u32 s47, s47, 16384
    buffer_load_dwordx4 v40, s[20:23], s47 offen lds
    s_add_u32 m0, m0, 1024
    s_add_u32 s47, s47, 16384
    buffer_load_dwordx4 v40, s[20:23], s47 offen lds
    v_cmp_gt_u32 vcc, 5, v25
    s_cbranch_vccz CW_55
    ds_read_b32 v25, v1 offset:0
FW_56:
    s_waitcnt lgkmcnt(0)
    v_cmp_gt_u32 vcc, 5, v25
    s_cbranch_vccz FO_57
    s_sleep 2
    ds_read_b32 v25, v1 offset:0
    s_branch FW_56
FO_57:
CW_55:
    s_waitcnt vmcnt(8)
    s_add_u32 s47, s81, 10
    s_and_b32 s47, s47, 15
    s_lshl_b32 s47, s47, 17
    s_add_u32 m0, s79, 73728
    s_add_u32 s47, s47, s57
    buffer_load_dwordx4 v40, s[20:23], s47 offen lds
    s_add_u32 m0, m0, 1024
    s_add_u32 s47, s47, 16384
    buffer_load_dwordx4 v40, s[20:23], s47 offen lds
    s_add_u32 m0, m0, 1024
    s_add_u32 s47, s47, 16384
    buffer_load_dwordx4 v40, s[20:23], s47 offen lds
    s_add_u32 m0, m0, 1024
    s_add_u32 s47, s47, 16384
    buffer_load_dwordx4 v40, s[20:23], s47 offen lds
    v_cmp_gt_u32 vcc, 6, v25
    s_cbranch_vccz CW_58
    ds_read_b32 v25, v1 offset:0
FW_59:
    s_waitcnt lgkmcnt(0)
    v_cmp_gt_u32 vcc, 6, v25
    s_cbranch_vccz FO_60
    s_sleep 2
    ds_read_b32 v25, v1 offset:0
    s_branch FW_59
FO_60:
CW_58:
    s_waitcnt vmcnt(8)
    s_add_u32 s47, s81, 11
    s_and_b32 s47, s47, 15
    s_lshl_b32 s47, s47, 17
    s_add_u32 m0, s79, 98304
    s_add_u32 s47, s47, s57
    buffer_load_dwordx4 v40, s[20:23], s47 offen lds
    s_add_u32 m0, m0, 1024
    s_add_u32 s47, s47, 16384
    buffer_load_dwordx4 v40, s[20:23], s47 offen lds
    s_add_u32 m0, m0, 1024
    s_add_u32 s47, s47, 16384
    buffer_load_dwordx4 v40, s[20:23], s47 offen lds
    s_add_u32 m0, m0, 1024
    s_add_u32 s47, s47, 16384
    buffer_load_dwordx4 v40, s[20:23], s47 offen lds
    v_cmp_gt_u32 vcc, 7, v25
    s_cbranch_vccz CW_61
    ds_read_b32 v25, v1 offset:0
FW_62:
    s_waitcnt lgkmcnt(0)
    v_cmp_gt_u32 vcc, 7, v25
    s_cbranch_vccz FO_63
    s_sleep 2
    ds_read_b32 v25, v1 offset:0
    s_branch FW_62
FO_63:
CW_61:
    s_waitcnt vmcnt(8)
    s_add_u32 s47, s81, 12
    s_and_b32 s47, s47, 15
    s_lshl_b32 s47, s47, 17
    s_add_u32 m0, s79, 90112
    s_add_u32 s47, s47, s57
    buffer_load_dwordx4 v40, s[20:23], s47 offen lds
    s_add_u32 m0, m0, 1024
    s_add_u32 s47, s47, 16384
    buffer_load_dwordx4 v40, s[20:23], s47 offen lds
    s_add_u32 m0, m0, 1024
    s_add_u32 s47, s47, 16384
    buffer_load_dwordx4 v40, s[20:23], s47 offen lds
    s_add_u32 m0, m0, 1024
    s_add_u32 s47, s47, 16384
    buffer_load_dwordx4 v40, s[20:23], s47 offen lds
    v_cmp_gt_u32 vcc, 8, v25
    s_cbranch_vccz CW_64
    ds_read_b32 v25, v1 offset:0
FW_65:
    s_waitcnt lgkmcnt(0)
    v_cmp_gt_u32 vcc, 8, v25
    s_cbranch_vccz FO_66
    s_sleep 2
    ds_read_b32 v25, v1 offset:0
    s_branch FW_65
FO_66:
CW_64:
    s_waitcnt vmcnt(8)
    s_add_u32 s47, s81, 13
    s_and_b32 s47, s47, 15
    s_lshl_b32 s47, s47, 17
    s_add_u32 m0, s79, 114688
    s_add_u32 s47, s47, s57
    buffer_load_dwordx4 v40, s[20:23], s47 offen lds
    s_add_u32 m0, m0, 1024
    s_add_u32 s47, s47, 16384
    buffer_load_dwordx4 v40, s[20:23], s47 offen lds
    s_add_u32 m0, m0, 1024
    s_add_u32 s47, s47, 16384
    buffer_load_dwordx4 v40, s[20:23], s47 offen lds
    s_add_u32 m0, m0, 1024
    s_add_u32 s47, s47, 16384
    buffer_load_dwordx4 v40, s[20:23], s47 offen lds
    v_cmp_gt_u32 vcc, 9, v25
    s_cbranch_vccz CW_67
    ds_read_b32 v25, v1 offset:0
FW_68:
    s_waitcnt lgkmcnt(0)
    v_cmp_gt_u32 vcc, 9, v25
    s_cbranch_vccz FO_69
    s_sleep 2
    ds_read_b32 v25, v1 offset:0
    s_branch FW_68
FO_69:
CW_67:
    s_waitcnt vmcnt(8)
    s_add_u32 s47, s81, 14
    s_and_b32 s47, s47, 15
    s_lshl_b32 s47, s47, 17
    s_add_u32 m0, s79, 106496
    s_add_u32 s47, s47, s57
    buffer_load_dwordx4 v40, s[20:23], s47 offen lds
    s_add_u32 m0, m0, 1024
    s_add_u32 s47, s47, 16384
    buffer_load_dwordx4 v40, s[20:23], s47 offen lds
    s_add_u32 m0, m0, 1024
    s_add_u32 s47, s47, 16384
    buffer_load_dwordx4 v40, s[20:23], s47 offen lds
    s_add_u32 m0, m0, 1024
    s_add_u32 s47, s47, 16384
    buffer_load_dwordx4 v40, s[20:23], s47 offen lds
    v_cmp_gt_u32 vcc, 10, v25
    s_cbranch_vccz CW_70
    ds_read_b32 v25, v1 offset:0
FW_71:
    s_waitcnt lgkmcnt(0)
    v_cmp_gt_u32 vcc, 10, v25
    s_cbranch_vccz FO_72
    s_sleep 2
    ds_read_b32 v25, v1 offset:0
    s_branch FW_71
FO_72:
CW_70:
    s_waitcnt vmcnt(8)
    s_add_u32 s47, s81, 15
    s_and_b32 s47, s47, 15
    s_lshl_b32 s47, s47, 17
    s_add_u32 m0, s79, 122880
    s_add_u32 s47, s47, s57
    buffer_load_dwordx4 v40, s[20:23], s47 offen lds
    s_add_u32 m0, m0, 1024
    s_add_u32 s47, s47, 16384
    buffer_load_dwordx4 v40, s[20:23], s47 offen lds
    s_add_u32 m0, m0, 1024
    s_add_u32 s47, s47, 16384
    buffer_load_dwordx4 v40, s[20:23], s47 offen lds
    s_add_u32 m0, m0, 1024
    s_add_u32 s47, s47, 16384
    buffer_load_dwordx4 v40, s[20:23], s47 offen lds
F_wj:
    v_mov_b32 v5, 159096
    ds_read_b32 v6, v5 offset:0
FW_73:
    s_waitcnt lgkmcnt(0)
    v_cmp_gt_u32 vcc, 1, v6
    s_cbranch_vccz FO_74
    s_sleep 1
    ds_read_b32 v6, v5 offset:0
    s_branch FW_73
FO_74:
    v_and_b32 v5, 7, v0
    v_lshlrev_b32 v5, 2, v5
    s_branch IW_s6
IW_w6:
    s_branch IW_r6
IW_s6:
    v_add_u32 v5, 158976, v5
    ds_read_b32 v5, v5
    s_lshr_b32 s47, s64, 5
    s_sub_u32 s47, 63, s47
    s_mov_b64 s[60:61], 0
    s_waitcnt lgkmcnt(0)
    v_bfe_u32 v5, v5, 5, 6
    v_cmp_eq_u32 vcc, s47, v5
    s_cbranch_vccz F_ns

    v_mov_b32 v5, 158976
    ds_read_b128 v[44:47], v5
    ds_read_b128 v[48:51], v5 offset:16
    v_and_b32 v6, 15, v0
    v_add_u32 v6, s64, v6
    v_sub_u32 v6, 2047, v6
    v_subrev_u32 v7, 16, v6
    v_mov_b32 v164, 0
    v_mov_b32 v165, 0
    s_waitcnt lgkmcnt(0)
    v_and_b32 v5, 0x7ff, v44
    v_or_b32 v44, 0x4000, v44
    v_cmp_eq_u32 vcc, v5, v6
    v_cmp_eq_u32 s[62:63], v5, v7
    s_nop 0
    v_cndmask_b32 v164, v164, v44, vcc
    v_cndmask_b32 v165, v165, v44, s[62:63]
    v_and_b32 v5, 0x7ff, v45
    v_or_b32 v45, 0x4800, v45
    v_cmp_eq_u32 vcc, v5, v6
    v_cmp_eq_u32 s[62:63], v5, v7
    s_nop 0
    v_cndmask_b32 v164, v164, v45, vcc
    v_cndmask_b32 v165, v165, v45, s[62:63]
    v_and_b32 v5, 0x7ff, v46
    v_or_b32 v46, 0x5000, v46
    v_cmp_eq_u32 vcc, v5, v6
    v_cmp_eq_u32 s[62:63], v5, v7
    s_nop 0
    v_cndmask_b32 v164, v164, v46, vcc
    v_cndmask_b32 v165, v165, v46, s[62:63]
    v_and_b32 v5, 0x7ff, v47
    v_or_b32 v47, 0x5800, v47
    v_cmp_eq_u32 vcc, v5, v6
    v_cmp_eq_u32 s[62:63], v5, v7
    s_nop 0
    v_cndmask_b32 v164, v164, v47, vcc
    v_cndmask_b32 v165, v165, v47, s[62:63]
    v_and_b32 v5, 0x7ff, v48
    v_or_b32 v48, 0x6000, v48
    v_cmp_eq_u32 vcc, v5, v6
    v_cmp_eq_u32 s[62:63], v5, v7
    s_nop 0
    v_cndmask_b32 v164, v164, v48, vcc
    v_cndmask_b32 v165, v165, v48, s[62:63]
    v_and_b32 v5, 0x7ff, v49
    v_or_b32 v49, 0x6800, v49
    v_cmp_eq_u32 vcc, v5, v6
    v_cmp_eq_u32 s[62:63], v5, v7
    s_nop 0
    v_cndmask_b32 v164, v164, v49, vcc
    v_cndmask_b32 v165, v165, v49, s[62:63]
    v_and_b32 v5, 0x7ff, v50
    v_or_b32 v50, 0x7000, v50
    v_cmp_eq_u32 vcc, v5, v6
    v_cmp_eq_u32 s[62:63], v5, v7
    s_nop 0
    v_cndmask_b32 v164, v164, v50, vcc
    v_cndmask_b32 v165, v165, v50, s[62:63]
    v_and_b32 v5, 0x7ff, v51
    v_or_b32 v51, 0x7800, v51
    v_cmp_eq_u32 vcc, v5, v6
    v_cmp_eq_u32 s[62:63], v5, v7
    s_nop 0
    v_cndmask_b32 v164, v164, v51, vcc
    v_cndmask_b32 v165, v165, v51, s[62:63]
    s_mov_b64 s[60:61], 1
F_ns:
    s_lshl_b32 s51, s28, 2
    s_add_u32 s51, s51, s3
    s_lshl_b32 s51, s51, 3
    s_and_b32 s47, s29, 3
    s_add_u32 s51, s51, s47
    s_lshl_b32 s51, s51, 7

    s_add_u32 s54, s51, 0x835000
    s_add_u32 s54, s72, s54
    s_addc_u32 s55, s73, 0
    v_lshlrev_b32 v98, 4, v0
    v_lshrrev_b32 v16, 4, v0
    v_bfe_u32 v17, v0, 2, 2
    v_lshl_add_u32 v17, v16, 2, v17
    v_bfe_u32 v16, v17, 1, 2
    v_lshlrev_b32 v16, 5, v16
    v_lshl_add_u32 v16, v17, 7, v16
    v_and_b32 v17, 3, v0
    v_lshl_add_u32 v4, v17, 3, v16
    v_xor_b32 v5, 32, v4
    v_xor_b32 v6, 64, v4
    v_xor_b32 v7, 96, v4
    s_lshl_b32 s79, s28, 18
    s_lshl_b32 s80, s3, 16
    s_add_u32 s79, s79, s80
    s_lshl_b32 s81, s81, 11
    v_mov_b32 v99, 1

    v_add_u32 v8, 57344, v4
    v_add_u32 v9, 57344, v5
    v_add_u32 v10, 57344, v6
    v_add_u32 v11, 57344, v7
    v_add_u32 v12, 114688, v4
    v_add_u32 v13, 114688, v5
    v_add_u32 v14, 114688, v6
    v_add_u32 v15, 114688, v7
    s_add_u32 s16, s72, 0x400000
    s_addc_u32 s17, s73, 0
    s_mov_b32 s18, 0x400000
    s_mov_b32 s19, 0x00020000
    s_mov_b32 s12, s68
    s_mov_b32 s13, s69
    s_mov_b32 s14, 0x400000
    s_mov_b32 s15, 0x00020000
    s_add_u32 s80, s81, 0
    s_and_b32 s80, s80, 0x7fff
    s_add_u32 s4, s80, s79
    s_add_u32 s80, s81, 2048
    s_and_b32 s80, s80, 0x7fff
    s_add_u32 s5, s80, s79
    s_add_u32 s80, s81, 4096
    s_and_b32 s80, s80, 0x7fff
    s_add_u32 s6, s80, s79
    s_add_u32 s80, s81, 6144
    s_and_b32 s80, s80, 0x7fff
    s_add_u32 s7, s80, s79
    s_add_u32 s80, s81, 8192
    s_and_b32 s80, s80, 0x7fff
    s_add_u32 s8, s80, s79
    s_add_u32 s80, s81, 10240
    s_and_b32 s80, s80, 0x7fff
    s_add_u32 s9, s80, s79
    s_add_u32 s80, s81, 12288
    s_and_b32 s80, s80, 0x7fff
    s_add_u32 s10, s80, s79
    s_add_u32 s80, s81, 14336
    s_and_b32 s80, s80, 0x7fff
    s_add_u32 s11, s80, s79
    s_add_u32 s80, s81, 16384
    s_and_b32 s80, s80, 0x7fff
    s_add_u32 s30, s80, s79
    s_add_u32 s80, s81, 18432
    s_and_b32 s80, s80, 0x7fff
    s_add_u32 s31, s80, s79
    s_add_u32 s80, s81, 20480
    s_and_b32 s80, s80, 0x7fff
    s_add_u32 s32, s80, s79
    s_add_u32 s80, s81, 22528
    s_and_b32 s80, s80, 0x7fff
    s_add_u32 s33, s80, s79
    s_add_u32 s80, s81, 24576
    s_and_b32 s80, s80, 0x7fff
    s_add_u32 s34, s80, s79
    s_add_u32 s80, s81, 26624
    s_and_b32 s80, s80, 0x7fff
    s_add_u32 s35, s80, s79
    s_add_u32 s80, s81, 28672
    s_and_b32 s80, s80, 0x7fff
    s_add_u32 s36, s80, s79
    s_add_u32 s80, s81, 30720
    s_and_b32 s80, s80, 0x7fff
    s_add_u32 s37, s80, s79
    v_add_u32 v97, 0x8000, v98
    s_setprio 2
    s_mov_b32 s50, 0
F_op:
    s_load_dword s47, s[54:55], 0 glc
    s_getreg_b32 s51, hwreg(HW_REG_IB_STS)
    s_and_b32 s51, s51, 0xc0000f
    s_or_b32 s51, s51, s50
    s_cbranch_scc1 F_oq
    s_mov_b64 exec, 1
    ds_write_b32 v3, v99 offset:160
    s_mov_b64 exec, -1
    s_mov_b32 s50, 1
F_oq:
    s_waitcnt lgkmcnt(0)
    s_cmp_lt_u32 s47, 16
    s_cbranch_scc1 F_op
    buffer_load_dwordx4 v[48:51], v98, s[16:19], s4 offen offset:0 sc1
    buffer_load_dwordx4 v[52:55], v97, s[16:19], s4 offen offset:0 sc1
    buffer_load_dwordx4 v[56:59], v98, s[16:19], s4 offen offset:1024 sc1
    buffer_load_dwordx4 v[60:63], v97, s[16:19], s4 offen offset:1024 sc1
    buffer_load_dwordx4 v[64:67], v98, s[16:19], s5 offen offset:0 sc1
    buffer_load_dwordx4 v[68:71], v97, s[16:19], s5 offen offset:0 sc1
    buffer_load_dwordx4 v[72:75], v98, s[16:19], s5 offen offset:1024 sc1
    buffer_load_dwordx4 v[76:79], v97, s[16:19], s5 offen offset:1024 sc1
    buffer_load_dwordx4 v[80:83], v98, s[16:19], s6 offen offset:0 sc1
    buffer_load_dwordx4 v[84:87], v97, s[16:19], s6 offen offset:0 sc1
    buffer_load_dwordx4 v[88:91], v98, s[16:19], s6 offen offset:1024 sc1
    buffer_load_dwordx4 v[92:95], v97, s[16:19], s6 offen offset:1024 sc1
    s_cmp_lg_u32 s50, 0
    s_cbranch_scc1 F_or
    s_waitcnt vmcnt(12)
    s_mov_b64 exec, 1
    ds_write_b32 v3, v99 offset:160
    s_mov_b64 exec, -1
F_or:
    v_or_b32 v17, 8, v1
    ds_read_b32 v16, v17 offset:160
FW_75:
    s_waitcnt lgkmcnt(0)
    v_cmp_gt_u32 vcc, 1, v16
    s_cbranch_vccz FO_76
    ds_read_b32 v16, v17 offset:160
    s_branch FW_75
FO_76:
    v_and_b32 v1, 0x3fff, v2
    v_bfe_u32 v99, v0, 3, 1
    v_lshl_add_u32 v1, v99, 6, v1
    ds_read_b64_tr_b16 v[16:17], v12 offset:32768
    ds_read_b64_tr_b16 v[18:19], v12 offset:34816
    ds_read_b64_tr_b16 v[20:21], v13 offset:32768
    ds_read_b64_tr_b16 v[22:23], v13 offset:34816
    ds_read_b64_tr_b16 v[24:25], v14 offset:32768
    ds_read_b64_tr_b16 v[26:27], v14 offset:34816
    ds_read_b64_tr_b16 v[28:29], v15 offset:32768
    ds_read_b64_tr_b16 v[30:31], v15 offset:34816
    s_waitcnt vmcnt(10) lgkmcnt(0)
    v_mfma_f32_16x16x32_bf16 v[100:103], v[16:19], v[48:51], v[100:103]
    ds_read_b64_tr_b16 v[32:33], v12 offset:36864
    ds_read_b64_tr_b16 v[34:35], v12 offset:38912
    v_mfma_f32_16x16x32_bf16 v[116:119], v[16:19], v[52:55], v[116:119]
    ds_read_b64_tr_b16 v[36:37], v13 offset:36864
    ds_read_b64_tr_b16 v[38:39], v13 offset:38912
    v_mfma_f32_16x16x32_bf16 v[104:107], v[20:23], v[48:51], v[104:107]
    ds_read_b64_tr_b16 v[40:41], v14 offset:36864
    ds_read_b64_tr_b16 v[42:43], v14 offset:38912
    v_mfma_f32_16x16x32_bf16 v[120:123], v[20:23], v[52:55], v[120:123]
    ds_read_b64_tr_b16 v[44:45], v15 offset:36864
    ds_read_b64_tr_b16 v[46:47], v15 offset:38912
    v_mfma_f32_16x16x32_bf16 v[108:111], v[24:27], v[48:51], v[108:111]
    buffer_load_dwordx4 v[132:135], v98, s[16:19], s7 offen offset:0 sc1
    v_mfma_f32_16x16x32_bf16 v[124:127], v[24:27], v[52:55], v[124:127]
    v_mfma_f32_16x16x32_bf16 v[112:115], v[28:31], v[48:51], v[112:115]
    buffer_load_dwordx4 v[136:139], v97, s[16:19], s7 offen offset:0 sc1
    v_mfma_f32_16x16x32_bf16 v[128:131], v[28:31], v[52:55], v[128:131]
    s_waitcnt vmcnt(10) lgkmcnt(0)
    v_mfma_f32_16x16x32_bf16 v[100:103], v[32:35], v[56:59], v[100:103]
    ds_read_b64_tr_b16 v[16:17], v4 offset:0
    ds_read_b64_tr_b16 v[18:19], v4 offset:2048
    v_mfma_f32_16x16x32_bf16 v[116:119], v[32:35], v[60:63], v[116:119]
    ds_read_b64_tr_b16 v[20:21], v5 offset:0
    ds_read_b64_tr_b16 v[22:23], v5 offset:2048
    v_mfma_f32_16x16x32_bf16 v[104:107], v[36:39], v[56:59], v[104:107]
    ds_read_b64_tr_b16 v[24:25], v6 offset:0
    ds_read_b64_tr_b16 v[26:27], v6 offset:2048
    v_mfma_f32_16x16x32_bf16 v[120:123], v[36:39], v[60:63], v[120:123]
    ds_read_b64_tr_b16 v[28:29], v7 offset:0
    ds_read_b64_tr_b16 v[30:31], v7 offset:2048
    v_mfma_f32_16x16x32_bf16 v[108:111], v[40:43], v[56:59], v[108:111]
    buffer_load_dwordx4 v[48:51], v98, s[16:19], s7 offen offset:1024 sc1
    v_mfma_f32_16x16x32_bf16 v[124:127], v[40:43], v[60:63], v[124:127]
    v_mfma_f32_16x16x32_bf16 v[112:115], v[44:47], v[56:59], v[112:115]
    buffer_load_dwordx4 v[52:55], v97, s[16:19], s7 offen offset:1024 sc1
    v_mfma_f32_16x16x32_bf16 v[128:131], v[44:47], v[60:63], v[128:131]
    s_waitcnt vmcnt(10) lgkmcnt(0)
    v_mfma_f32_16x16x32_bf16 v[100:103], v[16:19], v[64:67], v[100:103]
    ds_read_b64_tr_b16 v[32:33], v4 offset:4096
    ds_read_b64_tr_b16 v[34:35], v4 offset:6144
    v_mfma_f32_16x16x32_bf16 v[116:119], v[16:19], v[68:71], v[116:119]
    ds_read_b64_tr_b16 v[36:37], v5 offset:4096
    ds_read_b64_tr_b16 v[38:39], v5 offset:6144
    v_mfma_f32_16x16x32_bf16 v[104:107], v[20:23], v[64:67], v[104:107]
    ds_read_b64_tr_b16 v[40:41], v6 offset:4096
    ds_read_b64_tr_b16 v[42:43], v6 offset:6144
    v_mfma_f32_16x16x32_bf16 v[120:123], v[20:23], v[68:71], v[120:123]
    ds_read_b64_tr_b16 v[44:45], v7 offset:4096
    ds_read_b64_tr_b16 v[46:47], v7 offset:6144
    v_mfma_f32_16x16x32_bf16 v[108:111], v[24:27], v[64:67], v[108:111]
    buffer_load_dwordx4 v[56:59], v98, s[16:19], s8 offen offset:0 sc1
    v_mfma_f32_16x16x32_bf16 v[124:127], v[24:27], v[68:71], v[124:127]
    v_mfma_f32_16x16x32_bf16 v[112:115], v[28:31], v[64:67], v[112:115]
    buffer_load_dwordx4 v[60:63], v97, s[16:19], s8 offen offset:0 sc1
    v_mfma_f32_16x16x32_bf16 v[128:131], v[28:31], v[68:71], v[128:131]
    s_waitcnt vmcnt(10) lgkmcnt(0)
    v_mfma_f32_16x16x32_bf16 v[100:103], v[32:35], v[72:75], v[100:103]
    ds_read_b64_tr_b16 v[16:17], v4 offset:8192
    ds_read_b64_tr_b16 v[18:19], v4 offset:10240
    v_mfma_f32_16x16x32_bf16 v[116:119], v[32:35], v[76:79], v[116:119]
    ds_read_b64_tr_b16 v[20:21], v5 offset:8192
    ds_read_b64_tr_b16 v[22:23], v5 offset:10240
    v_mfma_f32_16x16x32_bf16 v[104:107], v[36:39], v[72:75], v[104:107]
    ds_read_b64_tr_b16 v[24:25], v6 offset:8192
    ds_read_b64_tr_b16 v[26:27], v6 offset:10240
    v_mfma_f32_16x16x32_bf16 v[120:123], v[36:39], v[76:79], v[120:123]
    ds_read_b64_tr_b16 v[28:29], v7 offset:8192
    ds_read_b64_tr_b16 v[30:31], v7 offset:10240
    v_mfma_f32_16x16x32_bf16 v[108:111], v[40:43], v[72:75], v[108:111]
    buffer_load_dwordx4 v[64:67], v98, s[16:19], s8 offen offset:1024 sc1
    v_mfma_f32_16x16x32_bf16 v[124:127], v[40:43], v[76:79], v[124:127]
    v_mfma_f32_16x16x32_bf16 v[112:115], v[44:47], v[72:75], v[112:115]
    buffer_load_dwordx4 v[68:71], v97, s[16:19], s8 offen offset:1024 sc1
    v_mfma_f32_16x16x32_bf16 v[128:131], v[44:47], v[76:79], v[128:131]
    s_waitcnt vmcnt(10) lgkmcnt(0)
    v_mfma_f32_16x16x32_bf16 v[100:103], v[16:19], v[80:83], v[100:103]
    ds_read_b64_tr_b16 v[32:33], v4 offset:12288
    ds_read_b64_tr_b16 v[34:35], v4 offset:14336
    v_mfma_f32_16x16x32_bf16 v[116:119], v[16:19], v[84:87], v[116:119]
    ds_read_b64_tr_b16 v[36:37], v5 offset:12288
    ds_read_b64_tr_b16 v[38:39], v5 offset:14336
    v_mfma_f32_16x16x32_bf16 v[104:107], v[20:23], v[80:83], v[104:107]
    ds_read_b64_tr_b16 v[40:41], v6 offset:12288
    ds_read_b64_tr_b16 v[42:43], v6 offset:14336
    v_mfma_f32_16x16x32_bf16 v[120:123], v[20:23], v[84:87], v[120:123]
    ds_read_b64_tr_b16 v[44:45], v7 offset:12288
    ds_read_b64_tr_b16 v[46:47], v7 offset:14336
    v_mfma_f32_16x16x32_bf16 v[108:111], v[24:27], v[80:83], v[108:111]
    buffer_load_dwordx4 v[72:75], v98, s[16:19], s9 offen offset:0 sc1
    v_mfma_f32_16x16x32_bf16 v[124:127], v[24:27], v[84:87], v[124:127]
    v_mfma_f32_16x16x32_bf16 v[112:115], v[28:31], v[80:83], v[112:115]
    buffer_load_dwordx4 v[76:79], v97, s[16:19], s9 offen offset:0 sc1
    v_mfma_f32_16x16x32_bf16 v[128:131], v[28:31], v[84:87], v[128:131]
    s_waitcnt vmcnt(10) lgkmcnt(0)
    v_mfma_f32_16x16x32_bf16 v[100:103], v[32:35], v[88:91], v[100:103]
    ds_read_b64_tr_b16 v[16:17], v12 offset:24576
    ds_read_b64_tr_b16 v[18:19], v12 offset:26624
    v_mfma_f32_16x16x32_bf16 v[116:119], v[32:35], v[92:95], v[116:119]
    ds_read_b64_tr_b16 v[20:21], v13 offset:24576
    ds_read_b64_tr_b16 v[22:23], v13 offset:26624
    v_mfma_f32_16x16x32_bf16 v[104:107], v[36:39], v[88:91], v[104:107]
    ds_read_b64_tr_b16 v[24:25], v14 offset:24576
    ds_read_b64_tr_b16 v[26:27], v14 offset:26624
    v_mfma_f32_16x16x32_bf16 v[120:123], v[36:39], v[92:95], v[120:123]
    ds_read_b64_tr_b16 v[28:29], v15 offset:24576
    ds_read_b64_tr_b16 v[30:31], v15 offset:26624
    v_mfma_f32_16x16x32_bf16 v[108:111], v[40:43], v[88:91], v[108:111]
    buffer_load_dwordx4 v[80:83], v98, s[16:19], s9 offen offset:1024 sc1
    v_mfma_f32_16x16x32_bf16 v[124:127], v[40:43], v[92:95], v[124:127]
    v_mfma_f32_16x16x32_bf16 v[112:115], v[44:47], v[88:91], v[112:115]
    buffer_load_dwordx4 v[84:87], v97, s[16:19], s9 offen offset:1024 sc1
    v_mfma_f32_16x16x32_bf16 v[128:131], v[44:47], v[92:95], v[128:131]
    s_waitcnt vmcnt(10) lgkmcnt(0)
    v_mfma_f32_16x16x32_bf16 v[100:103], v[16:19], v[132:135], v[100:103]
    ds_read_b64_tr_b16 v[32:33], v12 offset:28672
    ds_read_b64_tr_b16 v[34:35], v12 offset:30720
    v_mfma_f32_16x16x32_bf16 v[116:119], v[16:19], v[136:139], v[116:119]
    ds_read_b64_tr_b16 v[36:37], v13 offset:28672
    ds_read_b64_tr_b16 v[38:39], v13 offset:30720
    v_mfma_f32_16x16x32_bf16 v[104:107], v[20:23], v[132:135], v[104:107]
    ds_read_b64_tr_b16 v[40:41], v14 offset:28672
    ds_read_b64_tr_b16 v[42:43], v14 offset:30720
    v_mfma_f32_16x16x32_bf16 v[120:123], v[20:23], v[136:139], v[120:123]
    ds_read_b64_tr_b16 v[44:45], v15 offset:28672
    ds_read_b64_tr_b16 v[46:47], v15 offset:30720
    v_mfma_f32_16x16x32_bf16 v[108:111], v[24:27], v[132:135], v[108:111]
    buffer_load_dwordx4 v[88:91], v98, s[16:19], s10 offen offset:0 sc1
    v_mfma_f32_16x16x32_bf16 v[124:127], v[24:27], v[136:139], v[124:127]
    v_mfma_f32_16x16x32_bf16 v[112:115], v[28:31], v[132:135], v[112:115]
    buffer_load_dwordx4 v[92:95], v97, s[16:19], s10 offen offset:0 sc1
    v_mfma_f32_16x16x32_bf16 v[128:131], v[28:31], v[136:139], v[128:131]
    s_waitcnt vmcnt(10) lgkmcnt(0)
    v_mfma_f32_16x16x32_bf16 v[100:103], v[32:35], v[48:51], v[100:103]
    ds_read_b64_tr_b16 v[16:17], v4 offset:16384
    ds_read_b64_tr_b16 v[18:19], v4 offset:18432
    v_mfma_f32_16x16x32_bf16 v[116:119], v[32:35], v[52:55], v[116:119]
    ds_read_b64_tr_b16 v[20:21], v5 offset:16384
    ds_read_b64_tr_b16 v[22:23], v5 offset:18432
    v_mfma_f32_16x16x32_bf16 v[104:107], v[36:39], v[48:51], v[104:107]
    ds_read_b64_tr_b16 v[24:25], v6 offset:16384
    ds_read_b64_tr_b16 v[26:27], v6 offset:18432
    v_mfma_f32_16x16x32_bf16 v[120:123], v[36:39], v[52:55], v[120:123]
    ds_read_b64_tr_b16 v[28:29], v7 offset:16384
    ds_read_b64_tr_b16 v[30:31], v7 offset:18432
    v_mfma_f32_16x16x32_bf16 v[108:111], v[40:43], v[48:51], v[108:111]
    buffer_load_dwordx4 v[132:135], v98, s[16:19], s10 offen offset:1024 sc1
    v_mfma_f32_16x16x32_bf16 v[124:127], v[40:43], v[52:55], v[124:127]
    v_mfma_f32_16x16x32_bf16 v[112:115], v[44:47], v[48:51], v[112:115]
    buffer_load_dwordx4 v[136:139], v97, s[16:19], s10 offen offset:1024 sc1
    v_mfma_f32_16x16x32_bf16 v[128:131], v[44:47], v[52:55], v[128:131]
    s_waitcnt vmcnt(10) lgkmcnt(0)
    v_mfma_f32_16x16x32_bf16 v[100:103], v[16:19], v[56:59], v[100:103]
    ds_read_b64_tr_b16 v[32:33], v4 offset:20480
    ds_read_b64_tr_b16 v[34:35], v4 offset:22528
    v_mfma_f32_16x16x32_bf16 v[116:119], v[16:19], v[60:63], v[116:119]
    ds_read_b64_tr_b16 v[36:37], v5 offset:20480
    ds_read_b64_tr_b16 v[38:39], v5 offset:22528
    v_mfma_f32_16x16x32_bf16 v[104:107], v[20:23], v[56:59], v[104:107]
    ds_read_b64_tr_b16 v[40:41], v6 offset:20480
    ds_read_b64_tr_b16 v[42:43], v6 offset:22528
    v_mfma_f32_16x16x32_bf16 v[120:123], v[20:23], v[60:63], v[120:123]
    ds_read_b64_tr_b16 v[44:45], v7 offset:20480
    ds_read_b64_tr_b16 v[46:47], v7 offset:22528
    v_mfma_f32_16x16x32_bf16 v[108:111], v[24:27], v[56:59], v[108:111]
    buffer_load_dwordx4 v[48:51], v98, s[16:19], s11 offen offset:0 sc1
    v_mfma_f32_16x16x32_bf16 v[124:127], v[24:27], v[60:63], v[124:127]
    v_mfma_f32_16x16x32_bf16 v[112:115], v[28:31], v[56:59], v[112:115]
    buffer_load_dwordx4 v[52:55], v97, s[16:19], s11 offen offset:0 sc1
    v_mfma_f32_16x16x32_bf16 v[128:131], v[28:31], v[60:63], v[128:131]
    s_waitcnt vmcnt(10) lgkmcnt(0)
    v_mfma_f32_16x16x32_bf16 v[100:103], v[32:35], v[64:67], v[100:103]
    ds_read_b64_tr_b16 v[16:17], v4 offset:24576
    ds_read_b64_tr_b16 v[18:19], v4 offset:26624
    v_mfma_f32_16x16x32_bf16 v[116:119], v[32:35], v[68:71], v[116:119]
    ds_read_b64_tr_b16 v[20:21], v5 offset:24576
    ds_read_b64_tr_b16 v[22:23], v5 offset:26624
    v_mfma_f32_16x16x32_bf16 v[104:107], v[36:39], v[64:67], v[104:107]
    ds_read_b64_tr_b16 v[24:25], v6 offset:24576
    ds_read_b64_tr_b16 v[26:27], v6 offset:26624
    v_mfma_f32_16x16x32_bf16 v[120:123], v[36:39], v[68:71], v[120:123]
    ds_read_b64_tr_b16 v[28:29], v7 offset:24576
    ds_read_b64_tr_b16 v[30:31], v7 offset:26624
    v_mfma_f32_16x16x32_bf16 v[108:111], v[40:43], v[64:67], v[108:111]
    buffer_load_dwordx4 v[56:59], v98, s[16:19], s11 offen offset:1024 sc1
    v_mfma_f32_16x16x32_bf16 v[124:127], v[40:43], v[68:71], v[124:127]
    v_mfma_f32_16x16x32_bf16 v[112:115], v[44:47], v[64:67], v[112:115]
    buffer_load_dwordx4 v[60:63], v97, s[16:19], s11 offen offset:1024 sc1
    v_mfma_f32_16x16x32_bf16 v[128:131], v[44:47], v[68:71], v[128:131]
    s_waitcnt vmcnt(10) lgkmcnt(0)
    v_mfma_f32_16x16x32_bf16 v[100:103], v[16:19], v[72:75], v[100:103]
    ds_read_b64_tr_b16 v[32:33], v4 offset:28672
    ds_read_b64_tr_b16 v[34:35], v4 offset:30720
    v_mfma_f32_16x16x32_bf16 v[116:119], v[16:19], v[76:79], v[116:119]
    ds_read_b64_tr_b16 v[36:37], v5 offset:28672
    ds_read_b64_tr_b16 v[38:39], v5 offset:30720
    v_mfma_f32_16x16x32_bf16 v[104:107], v[20:23], v[72:75], v[104:107]
    ds_read_b64_tr_b16 v[40:41], v6 offset:28672
    ds_read_b64_tr_b16 v[42:43], v6 offset:30720
    v_mfma_f32_16x16x32_bf16 v[120:123], v[20:23], v[76:79], v[120:123]
    ds_read_b64_tr_b16 v[44:45], v7 offset:28672
    ds_read_b64_tr_b16 v[46:47], v7 offset:30720
    v_mfma_f32_16x16x32_bf16 v[108:111], v[24:27], v[72:75], v[108:111]
    buffer_load_dwordx4 v[64:67], v98, s[16:19], s30 offen offset:0 sc1
    v_mfma_f32_16x16x32_bf16 v[124:127], v[24:27], v[76:79], v[124:127]
    v_mfma_f32_16x16x32_bf16 v[112:115], v[28:31], v[72:75], v[112:115]
    buffer_load_dwordx4 v[68:71], v97, s[16:19], s30 offen offset:0 sc1
    v_mfma_f32_16x16x32_bf16 v[128:131], v[28:31], v[76:79], v[128:131]
    s_waitcnt vmcnt(10) lgkmcnt(0)
    v_mfma_f32_16x16x32_bf16 v[100:103], v[32:35], v[80:83], v[100:103]
    ds_read_b64_tr_b16 v[16:17], v12 offset:16384
    ds_read_b64_tr_b16 v[18:19], v12 offset:18432
    v_mfma_f32_16x16x32_bf16 v[116:119], v[32:35], v[84:87], v[116:119]
    ds_read_b64_tr_b16 v[20:21], v13 offset:16384
    ds_read_b64_tr_b16 v[22:23], v13 offset:18432
    v_mfma_f32_16x16x32_bf16 v[104:107], v[36:39], v[80:83], v[104:107]
    ds_read_b64_tr_b16 v[24:25], v14 offset:16384
    ds_read_b64_tr_b16 v[26:27], v14 offset:18432
    v_mfma_f32_16x16x32_bf16 v[120:123], v[36:39], v[84:87], v[120:123]
    ds_read_b64_tr_b16 v[28:29], v15 offset:16384
    ds_read_b64_tr_b16 v[30:31], v15 offset:18432
    v_mfma_f32_16x16x32_bf16 v[108:111], v[40:43], v[80:83], v[108:111]
    buffer_load_dwordx4 v[72:75], v98, s[16:19], s30 offen offset:1024 sc1
    v_mfma_f32_16x16x32_bf16 v[124:127], v[40:43], v[84:87], v[124:127]
    v_mfma_f32_16x16x32_bf16 v[112:115], v[44:47], v[80:83], v[112:115]
    buffer_load_dwordx4 v[76:79], v97, s[16:19], s30 offen offset:1024 sc1
    v_mfma_f32_16x16x32_bf16 v[128:131], v[44:47], v[84:87], v[128:131]
    s_waitcnt vmcnt(10) lgkmcnt(0)
    v_mfma_f32_16x16x32_bf16 v[100:103], v[16:19], v[88:91], v[100:103]
    ds_read_b64_tr_b16 v[32:33], v12 offset:20480
    ds_read_b64_tr_b16 v[34:35], v12 offset:22528
    v_mfma_f32_16x16x32_bf16 v[116:119], v[16:19], v[92:95], v[116:119]
    ds_read_b64_tr_b16 v[36:37], v13 offset:20480
    ds_read_b64_tr_b16 v[38:39], v13 offset:22528
    v_mfma_f32_16x16x32_bf16 v[104:107], v[20:23], v[88:91], v[104:107]
    ds_read_b64_tr_b16 v[40:41], v14 offset:20480
    ds_read_b64_tr_b16 v[42:43], v14 offset:22528
    v_mfma_f32_16x16x32_bf16 v[120:123], v[20:23], v[92:95], v[120:123]
    ds_read_b64_tr_b16 v[44:45], v15 offset:20480
    ds_read_b64_tr_b16 v[46:47], v15 offset:22528
    v_mfma_f32_16x16x32_bf16 v[108:111], v[24:27], v[88:91], v[108:111]
    buffer_load_dwordx4 v[80:83], v98, s[16:19], s31 offen offset:0 sc1
    v_mfma_f32_16x16x32_bf16 v[124:127], v[24:27], v[92:95], v[124:127]
    v_mfma_f32_16x16x32_bf16 v[112:115], v[28:31], v[88:91], v[112:115]
    buffer_load_dwordx4 v[84:87], v97, s[16:19], s31 offen offset:0 sc1
    v_mfma_f32_16x16x32_bf16 v[128:131], v[28:31], v[92:95], v[128:131]
    s_waitcnt vmcnt(10) lgkmcnt(0)
    v_mfma_f32_16x16x32_bf16 v[100:103], v[32:35], v[132:135], v[100:103]
    ds_read_b64_tr_b16 v[16:17], v8 offset:24576
    ds_read_b64_tr_b16 v[18:19], v8 offset:26624
    v_mfma_f32_16x16x32_bf16 v[116:119], v[32:35], v[136:139], v[116:119]
    ds_read_b64_tr_b16 v[20:21], v9 offset:24576
    ds_read_b64_tr_b16 v[22:23], v9 offset:26624
    v_mfma_f32_16x16x32_bf16 v[104:107], v[36:39], v[132:135], v[104:107]
    ds_read_b64_tr_b16 v[24:25], v10 offset:24576
    ds_read_b64_tr_b16 v[26:27], v10 offset:26624
    v_mfma_f32_16x16x32_bf16 v[120:123], v[36:39], v[136:139], v[120:123]
    ds_read_b64_tr_b16 v[28:29], v11 offset:24576
    ds_read_b64_tr_b16 v[30:31], v11 offset:26624
    v_mfma_f32_16x16x32_bf16 v[108:111], v[40:43], v[132:135], v[108:111]
    buffer_load_dwordx4 v[88:91], v98, s[16:19], s31 offen offset:1024 sc1
    v_mfma_f32_16x16x32_bf16 v[124:127], v[40:43], v[136:139], v[124:127]
    v_mfma_f32_16x16x32_bf16 v[112:115], v[44:47], v[132:135], v[112:115]
    buffer_load_dwordx4 v[92:95], v97, s[16:19], s31 offen offset:1024 sc1
    v_mfma_f32_16x16x32_bf16 v[128:131], v[44:47], v[136:139], v[128:131]
    s_waitcnt vmcnt(10) lgkmcnt(0)
    v_mfma_f32_16x16x32_bf16 v[100:103], v[16:19], v[48:51], v[100:103]
    ds_read_b64_tr_b16 v[32:33], v8 offset:28672
    ds_read_b64_tr_b16 v[34:35], v8 offset:30720
    v_mfma_f32_16x16x32_bf16 v[116:119], v[16:19], v[52:55], v[116:119]
    ds_read_b64_tr_b16 v[36:37], v9 offset:28672
    ds_read_b64_tr_b16 v[38:39], v9 offset:30720
    v_mfma_f32_16x16x32_bf16 v[104:107], v[20:23], v[48:51], v[104:107]
    ds_read_b64_tr_b16 v[40:41], v10 offset:28672
    ds_read_b64_tr_b16 v[42:43], v10 offset:30720
    v_mfma_f32_16x16x32_bf16 v[120:123], v[20:23], v[52:55], v[120:123]
    ds_read_b64_tr_b16 v[44:45], v11 offset:28672
    ds_read_b64_tr_b16 v[46:47], v11 offset:30720
    v_mfma_f32_16x16x32_bf16 v[108:111], v[24:27], v[48:51], v[108:111]
    buffer_load_dwordx4 v[132:135], v98, s[16:19], s32 offen offset:0 sc1
    v_mfma_f32_16x16x32_bf16 v[124:127], v[24:27], v[52:55], v[124:127]
    v_mfma_f32_16x16x32_bf16 v[112:115], v[28:31], v[48:51], v[112:115]
    buffer_load_dwordx4 v[136:139], v97, s[16:19], s32 offen offset:0 sc1
    v_mfma_f32_16x16x32_bf16 v[128:131], v[28:31], v[52:55], v[128:131]
    s_waitcnt vmcnt(10) lgkmcnt(0)
    v_mfma_f32_16x16x32_bf16 v[100:103], v[32:35], v[56:59], v[100:103]
    ds_read_b64_tr_b16 v[16:17], v4 offset:49152
    ds_read_b64_tr_b16 v[18:19], v4 offset:51200
    v_mfma_f32_16x16x32_bf16 v[116:119], v[32:35], v[60:63], v[116:119]
    ds_read_b64_tr_b16 v[20:21], v5 offset:49152
    ds_read_b64_tr_b16 v[22:23], v5 offset:51200
    v_mfma_f32_16x16x32_bf16 v[104:107], v[36:39], v[56:59], v[104:107]
    ds_read_b64_tr_b16 v[24:25], v6 offset:49152
    ds_read_b64_tr_b16 v[26:27], v6 offset:51200
    v_mfma_f32_16x16x32_bf16 v[120:123], v[36:39], v[60:63], v[120:123]
    ds_read_b64_tr_b16 v[28:29], v7 offset:49152
    ds_read_b64_tr_b16 v[30:31], v7 offset:51200
    v_mfma_f32_16x16x32_bf16 v[108:111], v[40:43], v[56:59], v[108:111]
    buffer_load_dwordx4 v[48:51], v98, s[16:19], s32 offen offset:1024 sc1
    v_mfma_f32_16x16x32_bf16 v[124:127], v[40:43], v[60:63], v[124:127]
    v_mfma_f32_16x16x32_bf16 v[112:115], v[44:47], v[56:59], v[112:115]
    buffer_load_dwordx4 v[52:55], v97, s[16:19], s32 offen offset:1024 sc1
    v_mfma_f32_16x16x32_bf16 v[128:131], v[44:47], v[60:63], v[128:131]
    s_waitcnt vmcnt(10) lgkmcnt(0)
    v_mfma_f32_16x16x32_bf16 v[100:103], v[16:19], v[64:67], v[100:103]
    ds_read_b64_tr_b16 v[32:33], v4 offset:53248
    ds_read_b64_tr_b16 v[34:35], v4 offset:55296
    v_mfma_f32_16x16x32_bf16 v[116:119], v[16:19], v[68:71], v[116:119]
    ds_read_b64_tr_b16 v[36:37], v5 offset:53248
    ds_read_b64_tr_b16 v[38:39], v5 offset:55296
    v_mfma_f32_16x16x32_bf16 v[104:107], v[20:23], v[64:67], v[104:107]
    ds_read_b64_tr_b16 v[40:41], v6 offset:53248
    ds_read_b64_tr_b16 v[42:43], v6 offset:55296
    v_mfma_f32_16x16x32_bf16 v[120:123], v[20:23], v[68:71], v[120:123]
    ds_read_b64_tr_b16 v[44:45], v7 offset:53248
    ds_read_b64_tr_b16 v[46:47], v7 offset:55296
    v_mfma_f32_16x16x32_bf16 v[108:111], v[24:27], v[64:67], v[108:111]
    buffer_load_dwordx4 v[56:59], v98, s[16:19], s33 offen offset:0 sc1
    v_mfma_f32_16x16x32_bf16 v[124:127], v[24:27], v[68:71], v[124:127]
    v_mfma_f32_16x16x32_bf16 v[112:115], v[28:31], v[64:67], v[112:115]
    buffer_load_dwordx4 v[60:63], v97, s[16:19], s33 offen offset:0 sc1
    v_mfma_f32_16x16x32_bf16 v[128:131], v[28:31], v[68:71], v[128:131]
    s_waitcnt vmcnt(10) lgkmcnt(0)
    v_mfma_f32_16x16x32_bf16 v[100:103], v[32:35], v[72:75], v[100:103]
    ds_read_b64_tr_b16 v[16:17], v8 offset:0
    ds_read_b64_tr_b16 v[18:19], v8 offset:2048
    v_mfma_f32_16x16x32_bf16 v[116:119], v[32:35], v[76:79], v[116:119]
    ds_read_b64_tr_b16 v[20:21], v9 offset:0
    ds_read_b64_tr_b16 v[22:23], v9 offset:2048
    v_mfma_f32_16x16x32_bf16 v[104:107], v[36:39], v[72:75], v[104:107]
    ds_read_b64_tr_b16 v[24:25], v10 offset:0
    ds_read_b64_tr_b16 v[26:27], v10 offset:2048
    v_mfma_f32_16x16x32_bf16 v[120:123], v[36:39], v[76:79], v[120:123]
    ds_read_b64_tr_b16 v[28:29], v11 offset:0
    ds_read_b64_tr_b16 v[30:31], v11 offset:2048
    v_mfma_f32_16x16x32_bf16 v[108:111], v[40:43], v[72:75], v[108:111]
    buffer_load_dwordx4 v[64:67], v98, s[16:19], s33 offen offset:1024 sc1
    v_mfma_f32_16x16x32_bf16 v[124:127], v[40:43], v[76:79], v[124:127]
    v_mfma_f32_16x16x32_bf16 v[112:115], v[44:47], v[72:75], v[112:115]
    buffer_load_dwordx4 v[68:71], v97, s[16:19], s33 offen offset:1024 sc1
    v_mfma_f32_16x16x32_bf16 v[128:131], v[44:47], v[76:79], v[128:131]
    s_waitcnt vmcnt(10) lgkmcnt(0)
    v_mfma_f32_16x16x32_bf16 v[100:103], v[16:19], v[80:83], v[100:103]
    ds_read_b64_tr_b16 v[32:33], v8 offset:4096
    ds_read_b64_tr_b16 v[34:35], v8 offset:6144
    v_mfma_f32_16x16x32_bf16 v[116:119], v[16:19], v[84:87], v[116:119]
    ds_read_b64_tr_b16 v[36:37], v9 offset:4096
    ds_read_b64_tr_b16 v[38:39], v9 offset:6144
    v_mfma_f32_16x16x32_bf16 v[104:107], v[20:23], v[80:83], v[104:107]
    ds_read_b64_tr_b16 v[40:41], v10 offset:4096
    ds_read_b64_tr_b16 v[42:43], v10 offset:6144
    s_branch IW_s7
IW_w7:
    s_branch IW_r7
IW_s7:
    v_mfma_f32_16x16x32_bf16 v[120:123], v[20:23], v[84:87], v[120:123]
    ds_read_b64_tr_b16 v[44:45], v11 offset:4096
    ds_read_b64_tr_b16 v[46:47], v11 offset:6144
    v_mfma_f32_16x16x32_bf16 v[108:111], v[24:27], v[80:83], v[108:111]
    buffer_load_dwordx4 v[72:75], v98, s[16:19], s34 offen offset:0 sc1
    v_mfma_f32_16x16x32_bf16 v[124:127], v[24:27], v[84:87], v[124:127]
    v_mfma_f32_16x16x32_bf16 v[112:115], v[28:31], v[80:83], v[112:115]
    buffer_load_dwordx4 v[76:79], v97, s[16:19], s34 offen offset:0 sc1
    v_mfma_f32_16x16x32_bf16 v[128:131], v[28:31], v[84:87], v[128:131]
    s_waitcnt vmcnt(10) lgkmcnt(0)
    v_mfma_f32_16x16x32_bf16 v[100:103], v[32:35], v[88:91], v[100:103]
    ds_read_b64_tr_b16 v[16:17], v8 offset:16384
    ds_read_b64_tr_b16 v[18:19], v8 offset:18432
    v_mfma_f32_16x16x32_bf16 v[116:119], v[32:35], v[92:95], v[116:119]
    ds_read_b64_tr_b16 v[20:21], v9 offset:16384
    ds_read_b64_tr_b16 v[22:23], v9 offset:18432
    v_mfma_f32_16x16x32_bf16 v[104:107], v[36:39], v[88:91], v[104:107]
    ds_read_b64_tr_b16 v[24:25], v10 offset:16384
    ds_read_b64_tr_b16 v[26:27], v10 offset:18432
    v_mfma_f32_16x16x32_bf16 v[120:123], v[36:39], v[92:95], v[120:123]
    ds_read_b64_tr_b16 v[28:29], v11 offset:16384
    ds_read_b64_tr_b16 v[30:31], v11 offset:18432
    v_mfma_f32_16x16x32_bf16 v[108:111], v[40:43], v[88:91], v[108:111]
    buffer_load_dwordx4 v[80:83], v98, s[16:19], s34 offen offset:1024 sc1
    v_mfma_f32_16x16x32_bf16 v[124:127], v[40:43], v[92:95], v[124:127]
    v_mfma_f32_16x16x32_bf16 v[112:115], v[44:47], v[88:91], v[112:115]
    buffer_load_dwordx4 v[84:87], v97, s[16:19], s34 offen offset:1024 sc1
    v_mfma_f32_16x16x32_bf16 v[128:131], v[44:47], v[92:95], v[128:131]
    s_waitcnt vmcnt(10) lgkmcnt(0)
    v_mfma_f32_16x16x32_bf16 v[100:103], v[16:19], v[132:135], v[100:103]
    ds_read_b64_tr_b16 v[32:33], v8 offset:20480
    ds_read_b64_tr_b16 v[34:35], v8 offset:22528
    v_mfma_f32_16x16x32_bf16 v[116:119], v[16:19], v[136:139], v[116:119]
    ds_read_b64_tr_b16 v[36:37], v9 offset:20480
    ds_read_b64_tr_b16 v[38:39], v9 offset:22528
    v_mfma_f32_16x16x32_bf16 v[104:107], v[20:23], v[132:135], v[104:107]
    ds_read_b64_tr_b16 v[40:41], v10 offset:20480
    ds_read_b64_tr_b16 v[42:43], v10 offset:22528
    v_mfma_f32_16x16x32_bf16 v[120:123], v[20:23], v[136:139], v[120:123]
    ds_read_b64_tr_b16 v[44:45], v11 offset:20480
    ds_read_b64_tr_b16 v[46:47], v11 offset:22528
    v_mfma_f32_16x16x32_bf16 v[108:111], v[24:27], v[132:135], v[108:111]
    buffer_load_dwordx4 v[88:91], v98, s[16:19], s35 offen offset:0 sc1
    v_mfma_f32_16x16x32_bf16 v[124:127], v[24:27], v[136:139], v[124:127]
    v_mfma_f32_16x16x32_bf16 v[112:115], v[28:31], v[132:135], v[112:115]
    buffer_load_dwordx4 v[92:95], v97, s[16:19], s35 offen offset:0 sc1
    v_mfma_f32_16x16x32_bf16 v[128:131], v[28:31], v[136:139], v[128:131]
    s_waitcnt vmcnt(10) lgkmcnt(0)
    v_mfma_f32_16x16x32_bf16 v[100:103], v[32:35], v[48:51], v[100:103]
    ds_read_b64_tr_b16 v[16:17], v8 offset:40960
    ds_read_b64_tr_b16 v[18:19], v8 offset:43008
    v_mfma_f32_16x16x32_bf16 v[116:119], v[32:35], v[52:55], v[116:119]
    ds_read_b64_tr_b16 v[20:21], v9 offset:40960
    ds_read_b64_tr_b16 v[22:23], v9 offset:43008
    v_mfma_f32_16x16x32_bf16 v[104:107], v[36:39], v[48:51], v[104:107]
    ds_read_b64_tr_b16 v[24:25], v10 offset:40960
    ds_read_b64_tr_b16 v[26:27], v10 offset:43008
    v_mfma_f32_16x16x32_bf16 v[120:123], v[36:39], v[52:55], v[120:123]
    ds_read_b64_tr_b16 v[28:29], v11 offset:40960
    ds_read_b64_tr_b16 v[30:31], v11 offset:43008
    v_mfma_f32_16x16x32_bf16 v[108:111], v[40:43], v[48:51], v[108:111]
    buffer_load_dwordx4 v[132:135], v98, s[16:19], s35 offen offset:1024 sc1
    v_mfma_f32_16x16x32_bf16 v[124:127], v[40:43], v[52:55], v[124:127]
    v_mfma_f32_16x16x32_bf16 v[112:115], v[44:47], v[48:51], v[112:115]
    buffer_load_dwordx4 v[136:139], v97, s[16:19], s35 offen offset:1024 sc1
    v_mfma_f32_16x16x32_bf16 v[128:131], v[44:47], v[52:55], v[128:131]
    s_waitcnt vmcnt(10) lgkmcnt(0)
    v_mfma_f32_16x16x32_bf16 v[100:103], v[16:19], v[56:59], v[100:103]
    ds_read_b64_tr_b16 v[32:33], v8 offset:45056
    ds_read_b64_tr_b16 v[34:35], v8 offset:47104
    v_mfma_f32_16x16x32_bf16 v[116:119], v[16:19], v[60:63], v[116:119]
    ds_read_b64_tr_b16 v[36:37], v9 offset:45056
    ds_read_b64_tr_b16 v[38:39], v9 offset:47104
    v_mfma_f32_16x16x32_bf16 v[104:107], v[20:23], v[56:59], v[104:107]
    ds_read_b64_tr_b16 v[40:41], v10 offset:45056
    ds_read_b64_tr_b16 v[42:43], v10 offset:47104
    v_mfma_f32_16x16x32_bf16 v[120:123], v[20:23], v[60:63], v[120:123]
    ds_read_b64_tr_b16 v[44:45], v11 offset:45056
    ds_read_b64_tr_b16 v[46:47], v11 offset:47104
    v_mfma_f32_16x16x32_bf16 v[108:111], v[24:27], v[56:59], v[108:111]
    buffer_load_dwordx4 v[48:51], v98, s[16:19], s36 offen offset:0 sc1
    v_mfma_f32_16x16x32_bf16 v[124:127], v[24:27], v[60:63], v[124:127]
    v_mfma_f32_16x16x32_bf16 v[112:115], v[28:31], v[56:59], v[112:115]
    buffer_load_dwordx4 v[52:55], v97, s[16:19], s36 offen offset:0 sc1
    v_mfma_f32_16x16x32_bf16 v[128:131], v[28:31], v[60:63], v[128:131]
    s_waitcnt vmcnt(10) lgkmcnt(0)
    v_mfma_f32_16x16x32_bf16 v[100:103], v[32:35], v[64:67], v[100:103]
    ds_read_b64_tr_b16 v[16:17], v8 offset:32768
    ds_read_b64_tr_b16 v[18:19], v8 offset:34816
    v_mfma_f32_16x16x32_bf16 v[116:119], v[32:35], v[68:71], v[116:119]
    ds_read_b64_tr_b16 v[20:21], v9 offset:32768
    ds_read_b64_tr_b16 v[22:23], v9 offset:34816
    v_mfma_f32_16x16x32_bf16 v[104:107], v[36:39], v[64:67], v[104:107]
    ds_read_b64_tr_b16 v[24:25], v10 offset:32768
    ds_read_b64_tr_b16 v[26:27], v10 offset:34816
    v_mfma_f32_16x16x32_bf16 v[120:123], v[36:39], v[68:71], v[120:123]
    ds_read_b64_tr_b16 v[28:29], v11 offset:32768
    ds_read_b64_tr_b16 v[30:31], v11 offset:34816
    v_mfma_f32_16x16x32_bf16 v[108:111], v[40:43], v[64:67], v[108:111]
    buffer_load_dwordx4 v[56:59], v98, s[16:19], s36 offen offset:1024 sc1
    v_mfma_f32_16x16x32_bf16 v[124:127], v[40:43], v[68:71], v[124:127]
    v_mfma_f32_16x16x32_bf16 v[112:115], v[44:47], v[64:67], v[112:115]
    buffer_load_dwordx4 v[60:63], v97, s[16:19], s36 offen offset:1024 sc1
    v_mfma_f32_16x16x32_bf16 v[128:131], v[44:47], v[68:71], v[128:131]
    s_waitcnt vmcnt(10) lgkmcnt(0)
    v_mfma_f32_16x16x32_bf16 v[100:103], v[16:19], v[72:75], v[100:103]
    ds_read_b64_tr_b16 v[32:33], v8 offset:36864
    ds_read_b64_tr_b16 v[34:35], v8 offset:38912
    v_mfma_f32_16x16x32_bf16 v[116:119], v[16:19], v[76:79], v[116:119]
    ds_read_b64_tr_b16 v[36:37], v9 offset:36864
    ds_read_b64_tr_b16 v[38:39], v9 offset:38912
    v_mfma_f32_16x16x32_bf16 v[104:107], v[20:23], v[72:75], v[104:107]
    ds_read_b64_tr_b16 v[40:41], v10 offset:36864
    ds_read_b64_tr_b16 v[42:43], v10 offset:38912
    v_mfma_f32_16x16x32_bf16 v[120:123], v[20:23], v[76:79], v[120:123]
    ds_read_b64_tr_b16 v[44:45], v11 offset:36864
    ds_read_b64_tr_b16 v[46:47], v11 offset:38912
    v_mfma_f32_16x16x32_bf16 v[108:111], v[24:27], v[72:75], v[108:111]
    buffer_load_dwordx4 v[64:67], v98, s[16:19], s37 offen offset:0 sc1
    v_mfma_f32_16x16x32_bf16 v[124:127], v[24:27], v[76:79], v[124:127]
    v_mfma_f32_16x16x32_bf16 v[112:115], v[28:31], v[72:75], v[112:115]
    buffer_load_dwordx4 v[68:71], v97, s[16:19], s37 offen offset:0 sc1
    v_mfma_f32_16x16x32_bf16 v[128:131], v[28:31], v[76:79], v[128:131]
    s_waitcnt vmcnt(10) lgkmcnt(0)
    v_mfma_f32_16x16x32_bf16 v[100:103], v[32:35], v[80:83], v[100:103]
    ds_read_b64_tr_b16 v[16:17], v12 offset:0
    ds_read_b64_tr_b16 v[18:19], v12 offset:2048
    v_mfma_f32_16x16x32_bf16 v[116:119], v[32:35], v[84:87], v[116:119]
    ds_read_b64_tr_b16 v[20:21], v13 offset:0
    ds_read_b64_tr_b16 v[22:23], v13 offset:2048
    v_mfma_f32_16x16x32_bf16 v[104:107], v[36:39], v[80:83], v[104:107]
    ds_read_b64_tr_b16 v[24:25], v14 offset:0
    ds_read_b64_tr_b16 v[26:27], v14 offset:2048
    v_mfma_f32_16x16x32_bf16 v[120:123], v[36:39], v[84:87], v[120:123]
    ds_read_b64_tr_b16 v[28:29], v15 offset:0
    ds_read_b64_tr_b16 v[30:31], v15 offset:2048
    v_mfma_f32_16x16x32_bf16 v[108:111], v[40:43], v[80:83], v[108:111]
    buffer_load_dwordx4 v[72:75], v98, s[16:19], s37 offen offset:1024 sc1
    v_mfma_f32_16x16x32_bf16 v[124:127], v[40:43], v[84:87], v[124:127]
    v_mfma_f32_16x16x32_bf16 v[112:115], v[44:47], v[80:83], v[112:115]
    buffer_load_dwordx4 v[76:79], v97, s[16:19], s37 offen offset:1024 sc1
    v_mfma_f32_16x16x32_bf16 v[128:131], v[44:47], v[84:87], v[128:131]
    s_waitcnt vmcnt(10) lgkmcnt(0)
    v_mfma_f32_16x16x32_bf16 v[100:103], v[16:19], v[88:91], v[100:103]
    ds_read_b64_tr_b16 v[32:33], v12 offset:4096
    ds_read_b64_tr_b16 v[34:35], v12 offset:6144
    v_mfma_f32_16x16x32_bf16 v[116:119], v[16:19], v[92:95], v[116:119]
    ds_read_b64_tr_b16 v[36:37], v13 offset:4096
    ds_read_b64_tr_b16 v[38:39], v13 offset:6144
    v_mfma_f32_16x16x32_bf16 v[104:107], v[20:23], v[88:91], v[104:107]
    ds_read_b64_tr_b16 v[40:41], v14 offset:4096
    ds_read_b64_tr_b16 v[42:43], v14 offset:6144
    v_mfma_f32_16x16x32_bf16 v[120:123], v[20:23], v[92:95], v[120:123]
    ds_read_b64_tr_b16 v[44:45], v15 offset:4096
    ds_read_b64_tr_b16 v[46:47], v15 offset:6144
    v_mfma_f32_16x16x32_bf16 v[108:111], v[24:27], v[88:91], v[108:111]
    v_mfma_f32_16x16x32_bf16 v[124:127], v[24:27], v[92:95], v[124:127]
    v_mfma_f32_16x16x32_bf16 v[112:115], v[28:31], v[88:91], v[112:115]
    v_mfma_f32_16x16x32_bf16 v[128:131], v[28:31], v[92:95], v[128:131]
    s_waitcnt vmcnt(8) lgkmcnt(0)
    v_mfma_f32_16x16x32_bf16 v[100:103], v[32:35], v[132:135], v[100:103]
    ds_read_b64_tr_b16 v[16:17], v8 offset:49152
    ds_read_b64_tr_b16 v[18:19], v8 offset:51200
    v_mfma_f32_16x16x32_bf16 v[116:119], v[32:35], v[136:139], v[116:119]
    ds_read_b64_tr_b16 v[20:21], v9 offset:49152
    ds_read_b64_tr_b16 v[22:23], v9 offset:51200
    v_mfma_f32_16x16x32_bf16 v[104:107], v[36:39], v[132:135], v[104:107]
    ds_read_b64_tr_b16 v[24:25], v10 offset:49152
    ds_read_b64_tr_b16 v[26:27], v10 offset:51200
    v_mfma_f32_16x16x32_bf16 v[120:123], v[36:39], v[136:139], v[120:123]
    ds_read_b64_tr_b16 v[28:29], v11 offset:49152
    ds_read_b64_tr_b16 v[30:31], v11 offset:51200
    v_mfma_f32_16x16x32_bf16 v[108:111], v[40:43], v[132:135], v[108:111]
    v_mfma_f32_16x16x32_bf16 v[124:127], v[40:43], v[136:139], v[124:127]
    v_mfma_f32_16x16x32_bf16 v[112:115], v[44:47], v[132:135], v[112:115]
    v_mfma_f32_16x16x32_bf16 v[128:131], v[44:47], v[136:139], v[128:131]
    s_waitcnt vmcnt(6) lgkmcnt(0)
    v_mfma_f32_16x16x32_bf16 v[100:103], v[16:19], v[48:51], v[100:103]
    ds_read_b64_tr_b16 v[32:33], v8 offset:53248
    ds_read_b64_tr_b16 v[34:35], v8 offset:55296
    v_mfma_f32_16x16x32_bf16 v[116:119], v[16:19], v[52:55], v[116:119]
    ds_read_b64_tr_b16 v[36:37], v9 offset:53248
    ds_read_b64_tr_b16 v[38:39], v9 offset:55296
    v_mfma_f32_16x16x32_bf16 v[104:107], v[20:23], v[48:51], v[104:107]
    ds_read_b64_tr_b16 v[40:41], v10 offset:53248
    ds_read_b64_tr_b16 v[42:43], v10 offset:55296
    v_mfma_f32_16x16x32_bf16 v[120:123], v[20:23], v[52:55], v[120:123]
    ds_read_b64_tr_b16 v[44:45], v11 offset:53248
    ds_read_b64_tr_b16 v[46:47], v11 offset:55296
    v_mfma_f32_16x16x32_bf16 v[108:111], v[24:27], v[48:51], v[108:111]
    v_mfma_f32_16x16x32_bf16 v[124:127], v[24:27], v[52:55], v[124:127]
    v_mfma_f32_16x16x32_bf16 v[112:115], v[28:31], v[48:51], v[112:115]
    v_mfma_f32_16x16x32_bf16 v[128:131], v[28:31], v[52:55], v[128:131]
    s_waitcnt vmcnt(4) lgkmcnt(0)
    v_mfma_f32_16x16x32_bf16 v[100:103], v[32:35], v[56:59], v[100:103]
    ds_read_b64_tr_b16 v[16:17], v12 offset:8192
    ds_read_b64_tr_b16 v[18:19], v12 offset:10240
    v_mfma_f32_16x16x32_bf16 v[116:119], v[32:35], v[60:63], v[116:119]
    ds_read_b64_tr_b16 v[20:21], v13 offset:8192
    ds_read_b64_tr_b16 v[22:23], v13 offset:10240
    v_mfma_f32_16x16x32_bf16 v[104:107], v[36:39], v[56:59], v[104:107]
    ds_read_b64_tr_b16 v[24:25], v14 offset:8192
    ds_read_b64_tr_b16 v[26:27], v14 offset:10240
    v_mfma_f32_16x16x32_bf16 v[120:123], v[36:39], v[60:63], v[120:123]
    ds_read_b64_tr_b16 v[28:29], v15 offset:8192
    ds_read_b64_tr_b16 v[30:31], v15 offset:10240
    v_mfma_f32_16x16x32_bf16 v[108:111], v[40:43], v[56:59], v[108:111]
    v_mfma_f32_16x16x32_bf16 v[124:127], v[40:43], v[60:63], v[124:127]
    v_mfma_f32_16x16x32_bf16 v[112:115], v[44:47], v[56:59], v[112:115]
    v_mfma_f32_16x16x32_bf16 v[128:131], v[44:47], v[60:63], v[128:131]
    s_waitcnt vmcnt(2) lgkmcnt(0)
    v_mfma_f32_16x16x32_bf16 v[100:103], v[16:19], v[64:67], v[100:103]
    ds_read_b64_tr_b16 v[32:33], v12 offset:12288
    ds_read_b64_tr_b16 v[34:35], v12 offset:14336
    v_mfma_f32_16x16x32_bf16 v[116:119], v[16:19], v[68:71], v[116:119]
    ds_read_b64_tr_b16 v[36:37], v13 offset:12288
    ds_read_b64_tr_b16 v[38:39], v13 offset:14336
    v_mfma_f32_16x16x32_bf16 v[104:107], v[20:23], v[64:67], v[104:107]
    ds_read_b64_tr_b16 v[40:41], v14 offset:12288
    ds_read_b64_tr_b16 v[42:43], v14 offset:14336
    v_mfma_f32_16x16x32_bf16 v[120:123], v[20:23], v[68:71], v[120:123]
    ds_read_b64_tr_b16 v[44:45], v15 offset:12288
    ds_read_b64_tr_b16 v[46:47], v15 offset:14336
    v_mfma_f32_16x16x32_bf16 v[108:111], v[24:27], v[64:67], v[108:111]
    v_mfma_f32_16x16x32_bf16 v[124:127], v[24:27], v[68:71], v[124:127]
    v_mfma_f32_16x16x32_bf16 v[112:115], v[28:31], v[64:67], v[112:115]
    v_mfma_f32_16x16x32_bf16 v[128:131], v[28:31], v[68:71], v[128:131]
    s_waitcnt vmcnt(0) lgkmcnt(0)
    v_mfma_f32_16x16x32_bf16 v[100:103], v[32:35], v[72:75], v[100:103]
    v_mfma_f32_16x16x32_bf16 v[116:119], v[32:35], v[76:79], v[116:119]
    v_mfma_f32_16x16x32_bf16 v[104:107], v[36:39], v[72:75], v[104:107]
    v_mfma_f32_16x16x32_bf16 v[120:123], v[36:39], v[76:79], v[120:123]
    v_mfma_f32_16x16x32_bf16 v[108:111], v[40:43], v[72:75], v[108:111]
    v_mfma_f32_16x16x32_bf16 v[124:127], v[40:43], v[76:79], v[124:127]
    v_mfma_f32_16x16x32_bf16 v[112:115], v[44:47], v[72:75], v[112:115]
    v_mfma_f32_16x16x32_bf16 v[128:131], v[44:47], v[76:79], v[128:131]
    s_nop 2
    v_permlane16_swap_b32 v100, v104
    v_permlane16_swap_b32 v101, v105
    v_permlane16_swap_b32 v102, v106
    v_permlane16_swap_b32 v103, v107
    v_permlane16_swap_b32 v108, v112
    v_permlane16_swap_b32 v109, v113
    v_permlane16_swap_b32 v110, v114
    v_permlane16_swap_b32 v111, v115
    v_permlane16_swap_b32 v116, v120
    v_permlane16_swap_b32 v117, v121
    v_permlane16_swap_b32 v118, v122
    v_permlane16_swap_b32 v119, v123
    v_permlane16_swap_b32 v124, v128
    v_permlane16_swap_b32 v125, v129
    v_permlane16_swap_b32 v126, v130
    v_permlane16_swap_b32 v127, v131
    s_cmp_eq_u64 s[60:61], 0
    s_cbranch_scc1 F_fin
    s_mov_b32 s48, 0xbfb8aa3b
    v_and_b32 v7, 0x3f, v2
    v_lshlrev_b32 v7, 1, v7
    v_add_u32 v7, 159744, v7
    v_mov_b32 v6, 159136

    ds_read_b32 v5, v6 offset:0
FW_77:
    s_waitcnt lgkmcnt(0)
    v_cmp_gt_u32 vcc, 1, v5
    s_cbranch_vccz FO_78
    ds_read_b32 v5, v6 offset:0
    s_branch FW_77
FO_78:
    v_bfe_u32 v4, v164, 11, 3
    v_lshl_add_u32 v4, v4, 8, v7
    v_cmp_ne_u32 vcc, 0, v164
    s_nop 0
    s_and_saveexec_b64 s[50:51], vcc
    s_cbranch_execz F_rb_79
    ds_read_b128 v[16:19], v4 offset:0
    ds_read_b128 v[20:23], v4 offset:16
    ds_read_b128 v[24:27], v4 offset:128
    ds_read_b128 v[28:31], v4 offset:144
    v_and_b32 v5, 0xffff0000, v164
    v_ashrrev_i32 v6, 31, v5
    v_not_b32 v6, v6
    v_or_b32 v6, 0x80000000, v6
    v_xor_b32 v5, v5, v6
    v_and_b32 v5, 0xffff0000, v5
    v_mul_f32 v5, s48, v5
    v_exp_f32 v5, v5
    s_nop 0
    v_add_f32 v5, 1.0, v5
    v_rcp_f32 v5, v5
    s_nop 0
    v_cvt_pk_bf16_f32 v5, v5, v5
    v_lshlrev_b32 v5, 16, v5
    s_waitcnt lgkmcnt(0)
    v_fmac_f32 v100, v16, v5
    v_fmac_f32 v101, v17, v5
    v_fmac_f32 v102, v18, v5
    v_fmac_f32 v103, v19, v5
    v_fmac_f32 v104, v20, v5
    v_fmac_f32 v105, v21, v5
    v_fmac_f32 v106, v22, v5
    v_fmac_f32 v107, v23, v5
    v_fmac_f32 v108, v24, v5
    v_fmac_f32 v109, v25, v5
    v_fmac_f32 v110, v26, v5
    v_fmac_f32 v111, v27, v5
    v_fmac_f32 v112, v28, v5
    v_fmac_f32 v113, v29, v5
    v_fmac_f32 v114, v30, v5
    v_fmac_f32 v115, v31, v5
F_rb_79:
    s_mov_b64 exec, s[50:51]
    v_bfe_u32 v4, v165, 11, 3
    v_lshl_add_u32 v4, v4, 8, v7
    v_cmp_ne_u32 vcc, 0, v165
    s_nop 0
    s_and_saveexec_b64 s[50:51], vcc
    s_cbranch_execz F_rb_80
    ds_read_b128 v[16:19], v4 offset:0
    ds_read_b128 v[20:23], v4 offset:16
    ds_read_b128 v[24:27], v4 offset:128
    ds_read_b128 v[28:31], v4 offset:144
    v_and_b32 v5, 0xffff0000, v165
    v_ashrrev_i32 v6, 31, v5
    v_not_b32 v6, v6
    v_or_b32 v6, 0x80000000, v6
    v_xor_b32 v5, v5, v6
    v_and_b32 v5, 0xffff0000, v5
    v_mul_f32 v5, s48, v5
    v_exp_f32 v5, v5
    s_nop 0
    v_add_f32 v5, 1.0, v5
    v_rcp_f32 v5, v5
    s_nop 0
    v_cvt_pk_bf16_f32 v5, v5, v5
    v_lshlrev_b32 v5, 16, v5
    s_waitcnt lgkmcnt(0)
    v_fmac_f32 v116, v16, v5
    v_fmac_f32 v117, v17, v5
    v_fmac_f32 v118, v18, v5
    v_fmac_f32 v119, v19, v5
    v_fmac_f32 v120, v20, v5
    v_fmac_f32 v121, v21, v5
    v_fmac_f32 v122, v22, v5
    v_fmac_f32 v123, v23, v5
    v_fmac_f32 v124, v24, v5
    v_fmac_f32 v125, v25, v5
    v_fmac_f32 v126, v26, v5
    v_fmac_f32 v127, v27, v5
    v_fmac_f32 v128, v28, v5
    v_fmac_f32 v129, v29, v5
    v_fmac_f32 v130, v30, v5
    v_fmac_f32 v131, v31, v5
F_rb_80:
    s_mov_b64 exec, s[50:51]
F_fin:
    v_cvt_pk_bf16_f32 v48, v100, v101
    v_cvt_pk_bf16_f32 v49, v102, v103
    v_cvt_pk_bf16_f32 v50, v104, v105
    v_cvt_pk_bf16_f32 v51, v106, v107
    v_cvt_pk_bf16_f32 v52, v108, v109
    v_cvt_pk_bf16_f32 v53, v110, v111
    v_cvt_pk_bf16_f32 v54, v112, v113
    v_cvt_pk_bf16_f32 v55, v114, v115
    v_mov_b32 v64, v48
    v_mov_b32 v65, v49
    v_mov_b32 v66, v50
    v_mov_b32 v67, v51
    v_mov_b32_dpp v48, v52 row_ror:8 row_mask:0xf bank_mask:0xc
    v_mov_b32_dpp v49, v53 row_ror:8 row_mask:0xf bank_mask:0xc
    v_mov_b32_dpp v50, v54 row_ror:8 row_mask:0xf bank_mask:0xc
    v_mov_b32_dpp v51, v55 row_ror:8 row_mask:0xf bank_mask:0xc
    v_mov_b32_dpp v52, v64 row_ror:8 row_mask:0xf bank_mask:0x3
    v_mov_b32_dpp v53, v65 row_ror:8 row_mask:0xf bank_mask:0x3
    v_mov_b32_dpp v54, v66 row_ror:8 row_mask:0xf bank_mask:0x3
    v_mov_b32_dpp v55, v67 row_ror:8 row_mask:0xf bank_mask:0x3
    s_add_u32 s44, s42, 0x4000
    buffer_store_dwordx4 v[48:51], v1, s[12:15], s42 offen sc1
    buffer_store_dwordx4 v[52:55], v1, s[12:15], s44 offen sc1
    v_cvt_pk_bf16_f32 v56, v116, v117
    v_cvt_pk_bf16_f32 v57, v118, v119
    v_cvt_pk_bf16_f32 v58, v120, v121
    v_cvt_pk_bf16_f32 v59, v122, v123
    v_cvt_pk_bf16_f32 v60, v124, v125
    v_cvt_pk_bf16_f32 v61, v126, v127
    v_cvt_pk_bf16_f32 v62, v128, v129
    v_cvt_pk_bf16_f32 v63, v130, v131
    v_mov_b32 v64, v56
    v_mov_b32 v65, v57
    v_mov_b32 v66, v58
    v_mov_b32 v67, v59
    v_mov_b32_dpp v56, v60 row_ror:8 row_mask:0xf bank_mask:0xc
    v_mov_b32_dpp v57, v61 row_ror:8 row_mask:0xf bank_mask:0xc
    v_mov_b32_dpp v58, v62 row_ror:8 row_mask:0xf bank_mask:0xc
    v_mov_b32_dpp v59, v63 row_ror:8 row_mask:0xf bank_mask:0xc
    v_mov_b32_dpp v60, v64 row_ror:8 row_mask:0xf bank_mask:0x3
    v_mov_b32_dpp v61, v65 row_ror:8 row_mask:0xf bank_mask:0x3
    v_mov_b32_dpp v62, v66 row_ror:8 row_mask:0xf bank_mask:0x3
    v_mov_b32_dpp v63, v67 row_ror:8 row_mask:0xf bank_mask:0x3
    s_add_u32 s44, s43, 0x4000
    buffer_store_dwordx4 v[56:59], v1, s[12:15], s43 offen sc1
    buffer_store_dwordx4 v[60:63], v1, s[12:15], s44 offen sc1
    s_endpgm
F_aux:
    s_setprio 3
    s_sub_u32 s3, s3, 8
    s_mov_b32 s88, s3
    v_lshrrev_b32 v5, 4, v0
    s_cmp_eq_u32 s3, 1
    s_mov_b32 s45, 73728
    s_cselect_b32 s45, 65536, s45
    s_cmp_eq_u32 s3, 2
    s_cselect_b32 s45, 147456, s45
    v_bfe_u32 v60, v0, 2, 2
    v_lshl_add_u32 v62, v5, 3, v60
    v_lshrrev_b32 v60, 1, v60
    v_and_b32 v63, 1, v5
    v_lshl_add_u32 v60, v63, 1, v60
    v_lshlrev_b32 v60, 5, v60
    v_lshl_add_u32 v60, v62, 7, v60
    v_and_b32 v63, 3, v0
    v_lshl_add_u32 v60, v63, 3, v60
    v_add_u32 v62, s45, v60
    v_xor_b32 v63, 32, v62
    v_xor_b32 v64, 64, v62
    v_xor_b32 v65, 96, v62
    v_lshlrev_b32 v2, 4, v0
    v_lshlrev_b32 v3, 2, v0
    v_and_b32 v7, 15, v0
    v_and_b32 v8, 7, v0
    v_lshlrev_b32 v8, 4, v8
    v_lshl_add_u32 v8, v5, 7, v8
    v_bfe_u32 v9, v0, 3, 1
    v_lshl_add_u32 v4, v9, 11, v8
    v_and_b32 v9, 1, v0
    v_lshlrev_b32 v59, 2, v7
    s_lshl_b32 s76, s32, 4
    s_add_u32 s76, s76, s33
    s_lshl_b32 s77, s76, 3
    s_lshl_b32 s44, s3, 1
    s_add_u32 s77, s77, s44
    v_mov_b32 v12, 0
    v_mov_b32 v13, 0
    v_mov_b32 v14, 0
    v_mov_b32 v15, 0
    s_lshl_b32 s75, s3, 4
    s_add_u32 s75, s75, s33
    s_lshl_b32 s44, s3, 2
    s_add_u32 s44, s44, 159040
    v_mov_b32 v10, s44

    v_mov_b32 v32, 0x3f803f80
    v_mov_b32 v33, 0x3f803f80
    v_mov_b32 v34, 0x3f803f80
    v_mov_b32 v35, 0x3f803f80
    v_mov_b32 v36, 0x3f803f80
    v_mov_b32 v37, 0x3f803f80
    v_mov_b32 v38, 0x3f803f80
    v_mov_b32 v39, 0x3f803f80
    v_mov_b32 v40, 0x3f803f80
    v_mov_b32 v41, 0x3f803f80
    v_mov_b32 v42, 0x3f803f80
    v_mov_b32 v43, 0x3f803f80
    v_mov_b32 v44, 0x3f803f80
    v_mov_b32 v45, 0x3f803f80
    v_mov_b32 v46, 0x3f803f80
    v_mov_b32 v47, 0x3f803f80
    s_waitcnt lgkmcnt(0)
    s_mov_b32 s20, s4
    s_mov_b32 s21, s5
    s_mov_b32 s22, 0x400000
    s_mov_b32 s23, 0x00020000
    s_mov_b32 s19, 0x20000
    s_add_u32 s40, s72, 0x850000
    s_addc_u32 s41, s73, 0
    s_mov_b32 s42, 0xd000
    s_mov_b32 s43, 0x00020000
    s_cmp_lg_u32 s3, 0
    s_cbranch_scc1 F_z0
    s_getpc_b64 s[46:47]
F_pc:
    s_sub_u32 s46, s46, F_pc-parallel_sum__linear_attn_block__moe_arch_mod__prompt_kernel
    s_subb_u32 s47, s47, 0
    s_and_b32 s44, s31, 7
    s_lshl_b32 s44, s44, 13
    v_lshlrev_b32 v67, 7, v0
    v_add_u32 v67, s44, v67
    v_min_u32 v67, F_codeend-parallel_sum__linear_attn_block__moe_arch_mod__prompt_kernel-4, v67
    global_load_dword v61, v67, s[46:47]
    s_cmp_lg_u32 s75, 0
    s_cbranch_scc1 F_z0
    s_lshl_b32 s44, s32, 9
    s_add_u32 s44, s44, 32768
    s_mov_b32 exec_hi, 0
    buffer_store_dwordx4 v[12:15], v2, s[40:43], s44 offen sc0 sc1
    s_mul_i32 s44, s32, 768
    s_add_u32 s44, s44, 40960
    s_mov_b32 exec_hi, 0xffff
    buffer_store_dwordx4 v[12:15], v2, s[40:43], s44 offen sc0 sc1
    s_mov_b64 exec, -1
F_z0:

    s_barrier
    s_bitcmp0_b32 s3, 0
    s_cbranch_scc1 F_cs1
    ds_read_b64_tr_b16 v[72:73], v62 offset:0
    ds_read_b64_tr_b16 v[74:75], v62 offset:512
    ds_read_b64_tr_b16 v[76:77], v62 offset:4096
    ds_read_b64_tr_b16 v[78:79], v62 offset:4608
    ds_read_b64_tr_b16 v[80:81], v63 offset:0
    ds_read_b64_tr_b16 v[82:83], v63 offset:512
    ds_read_b64_tr_b16 v[84:85], v63 offset:4096
    ds_read_b64_tr_b16 v[86:87], v63 offset:4608
    s_waitcnt lgkmcnt(4)
    ds_read_b64_tr_b16 v[88:89], v64 offset:0
    ds_read_b64_tr_b16 v[90:91], v64 offset:512
    ds_read_b64_tr_b16 v[92:93], v64 offset:4096
    ds_read_b64_tr_b16 v[94:95], v64 offset:4608
    ds_read_b64_tr_b16 v[96:97], v65 offset:0
    ds_read_b64_tr_b16 v[98:99], v65 offset:512
    ds_read_b64_tr_b16 v[100:101], v65 offset:4096
    ds_read_b64_tr_b16 v[102:103], v65 offset:4608
    s_branch F_cs2
F_cs1:
    v_add_u32 v60, 159040, v3
    s_mov_b32 exec_hi, 0xffff
    ds_write_b32 v60, v12
    s_mov_b64 exec, -1
F_cs2:
    s_add_u32 s24, s72, 0x800000
    s_addc_u32 s25, s73, 0
    s_mov_b32 s26, 0x48000
    s_mov_b32 s27, 0x00020000
    s_mov_b32 s48, s70
    s_mov_b32 s49, s71
    s_mov_b32 s50, 0x100
    s_mov_b32 s51, 0x00020000
    s_lshl_b32 s47, s32, 9
    s_add_u32 s56, s47, 0x858000
    s_add_u32 s56, s72, s56
    s_addc_u32 s57, s73, 0
    s_lshl_b32 s47, s33, 9
    s_add_u32 s58, s47, 0x858100
    s_add_u32 s58, s72, s58
    s_addc_u32 s59, s73, 0
    v_mov_b32 v68, 0x3f803f80
    v_mov_b32 v69, 0x3f803f80
    v_mov_b32 v70, 0x3f803f80
    v_mov_b32 v71, 0x3f803f80
    s_waitcnt lgkmcnt(0)
    s_cmp_lg_u32 s75, 0
    s_cbranch_scc1 F_z4
    s_lshl_b32 s45, s32, 2
    s_add_u32 s44, s70, s45
    s_addc_u32 s45, s71, 0
    s_mov_b32 s46, 1
    s_waitcnt vmcnt(0)
    s_atomic_add s46, s[44:45], 0
F_z4:

    s_bitcmp0_b32 s3, 0
    s_cbranch_scc1 F_c2a
    v_mfma_f32_16x16x32_bf16 v[104:107], v[68:71], v[72:75], 0
    v_mfma_f32_16x16x32_bf16 v[108:111], v[68:71], v[80:83], 0
    v_mfma_f32_16x16x32_bf16 v[112:115], v[68:71], v[88:91], 0
    v_mfma_f32_16x16x32_bf16 v[116:119], v[68:71], v[96:99], 0
    v_mfma_f32_16x16x32_bf16 v[104:107], v[68:71], v[76:79], v[104:107]
    v_mfma_f32_16x16x32_bf16 v[108:111], v[68:71], v[84:87], v[108:111]
    v_mfma_f32_16x16x32_bf16 v[112:115], v[68:71], v[92:95], v[112:115]
    v_mfma_f32_16x16x32_bf16 v[116:119], v[68:71], v[100:103], v[116:119]
    v_cmp_eq_u32 vcc, 1, v5
    s_nop 4
    v_cndmask_b32 v66, v104, v108, vcc
    v_cmp_eq_u32 vcc, 2, v5
    s_nop 1
    v_cndmask_b32 v66, v66, v112, vcc
    v_cmp_eq_u32 vcc, 3, v5
    s_nop 1
    v_cndmask_b32 v66, v66, v116, vcc

F_c2a:
    s_barrier
    s_cmp_lg_u32 s3, 2
    s_cbranch_scc1 F_cs3
    ds_read_b64_tr_b16 v[72:73], v62 offset:0
    ds_read_b64_tr_b16 v[74:75], v62 offset:512
    ds_read_b64_tr_b16 v[76:77], v62 offset:4096
    ds_read_b64_tr_b16 v[78:79], v62 offset:4608
    ds_read_b64_tr_b16 v[80:81], v63 offset:0
    ds_read_b64_tr_b16 v[82:83], v63 offset:512
    ds_read_b64_tr_b16 v[84:85], v63 offset:4096
    ds_read_b64_tr_b16 v[86:87], v63 offset:4608
    s_waitcnt lgkmcnt(4)
    ds_read_b64_tr_b16 v[88:89], v64 offset:0
    ds_read_b64_tr_b16 v[90:91], v64 offset:512
    ds_read_b64_tr_b16 v[92:93], v64 offset:4096
    ds_read_b64_tr_b16 v[94:95], v64 offset:4608
    ds_read_b64_tr_b16 v[96:97], v65 offset:0
    ds_read_b64_tr_b16 v[98:99], v65 offset:512
    ds_read_b64_tr_b16 v[100:101], v65 offset:4096
    ds_read_b64_tr_b16 v[102:103], v65 offset:4608
    s_waitcnt lgkmcnt(0)
F_cs3:
    s_cmp_lg_u32 s3, 0
    s_cbranch_scc1 EV_82
    s_branch IW_w8
IW_r8:
EV_82:
    s_cmp_lg_u32 s3, 1
    s_cbranch_scc1 EV_83
    s_branch IW_w0
IW_r0:
EV_83:
    s_cmp_lg_u32 s3, 2
    s_cbranch_scc1 EV_84
    s_branch IW_w1
IW_r1:
EV_84:
    s_cmp_lg_u32 s3, 3
    s_cbranch_scc1 EV_85
    s_branch IW_w3
IW_r3:
EV_85:
    s_barrier
    s_cmp_lt_u32 s3, 2
    s_mov_b32 s44, 98304
    s_cselect_b32 s44, 98304, s44
    s_lshl_b32 s45, s3, 12
    s_add_u32 s44, s44, s45
    v_add_u32 v4, s44, v4
    v_add_u32 v8, 161792, v8
    ds_read_b128 v[16:19], v4 offset:0
    ds_read_b128 v[20:23], v4 offset:512
    ds_read_b128 v[24:27], v4 offset:1024
    ds_read_b128 v[28:31], v4 offset:1536
    s_mov_b32 exec_lo, 0x00ff00ff
    s_mov_b32 exec_hi, 0x00ff00ff
    ds_read_b128 v[32:35], v8 offset:0
    ds_read_b128 v[36:39], v8 offset:512
    ds_read_b128 v[40:43], v8 offset:1024
    ds_read_b128 v[44:47], v8 offset:1536
    s_mov_b64 exec, -1
    s_waitcnt lgkmcnt(0)
    v_mfma_f32_16x16x32_bf16 v[120:123], v[16:19], v[16:19], 0
    v_mfma_f32_16x16x32_bf16 v[124:127], v[16:19], v[32:35], 0
    v_mfma_f32_16x16x32_bf16 v[128:131], v[32:35], v[32:35], 0
    v_mfma_f32_16x16x32_bf16 v[120:123], v[20:23], v[20:23], v[120:123]
    s_branch IW_s8
IW_w8:
    s_branch IW_r8
IW_s8:
    v_mfma_f32_16x16x32_bf16 v[124:127], v[20:23], v[36:39], v[124:127]
    v_mfma_f32_16x16x32_bf16 v[128:131], v[36:39], v[36:39], v[128:131]
    v_mfma_f32_16x16x32_bf16 v[120:123], v[24:27], v[24:27], v[120:123]
    v_mfma_f32_16x16x32_bf16 v[124:127], v[24:27], v[40:43], v[124:127]
    v_mfma_f32_16x16x32_bf16 v[128:131], v[40:43], v[40:43], v[128:131]
    v_mfma_f32_16x16x32_bf16 v[120:123], v[28:31], v[28:31], v[120:123]
    v_mfma_f32_16x16x32_bf16 v[124:127], v[28:31], v[44:47], v[124:127]
    v_mfma_f32_16x16x32_bf16 v[128:131], v[44:47], v[44:47], v[128:131]
    s_cmp_lg_u32 s3, 2
    s_cbranch_scc1 F_c2b
    v_mfma_f32_16x16x32_bf16 v[104:107], v[68:71], v[72:75], 0
    v_mfma_f32_16x16x32_bf16 v[108:111], v[68:71], v[80:83], 0
    v_mfma_f32_16x16x32_bf16 v[112:115], v[68:71], v[88:91], 0
    v_mfma_f32_16x16x32_bf16 v[116:119], v[68:71], v[96:99], 0
    v_mfma_f32_16x16x32_bf16 v[104:107], v[68:71], v[76:79], v[104:107]
    v_mfma_f32_16x16x32_bf16 v[108:111], v[68:71], v[84:87], v[108:111]
    v_mfma_f32_16x16x32_bf16 v[112:115], v[68:71], v[92:95], v[112:115]
    v_mfma_f32_16x16x32_bf16 v[116:119], v[68:71], v[100:103], v[116:119]
    v_cmp_eq_u32 vcc, 1, v5
    s_nop 4
    v_cndmask_b32 v66, v104, v108, vcc
    v_cmp_eq_u32 vcc, 2, v5
    s_nop 1
    v_cndmask_b32 v66, v66, v112, vcc
    v_cmp_eq_u32 vcc, 3, v5
    s_nop 1
    v_cndmask_b32 v66, v66, v116, vcc

F_c2b:
    s_cmp_lg_u32 s3, 0
    s_cbranch_scc1 F_r1
    buffer_load_dword v11, v59, s[48:51], 0 offen sc0 sc1
F_r1:
    s_cmp_lg_u32 s3, 0
    s_cbranch_scc1 EV_87
    s_branch IW_w4
IW_r4:
EV_87:
    s_cmp_lg_u32 s3, 1
    s_cbranch_scc1 EV_88
    s_branch IW_w9
IW_r9:
EV_88:
    s_cmp_lg_u32 s3, 2
    s_cbranch_scc1 EV_89
    s_branch IW_w10
IW_r10:
EV_89:
    s_cmp_lg_u32 s3, 3
    s_cbranch_scc1 EV_90
    s_nop 0
EV_90:
    s_barrier
    v_and_b32 v52, 3, v0
    v_cmp_eq_u32 vcc, 1, v52
    s_nop 1
    v_cndmask_b32 v120, v120, v121, vcc
    v_cndmask_b32 v124, v124, v125, vcc
    v_cndmask_b32 v128, v128, v129, vcc
    v_cmp_eq_u32 vcc, 2, v52
    s_nop 1
    v_cndmask_b32 v120, v120, v122, vcc
    v_cndmask_b32 v124, v124, v126, vcc
    v_cndmask_b32 v128, v128, v130, vcc
    v_cmp_eq_u32 vcc, 3, v52
    s_nop 1
    v_cndmask_b32 v120, v120, v123, vcc
    v_cndmask_b32 v124, v124, v127, vcc
    v_cndmask_b32 v128, v128, v131, vcc
    v_add_f32_dpp v120, v120, v120 quad_perm:[1,0,3,2] row_mask:0xf bank_mask:0xf
    v_add_f32_dpp v124, v124, v124 quad_perm:[1,0,3,2] row_mask:0xf bank_mask:0xf
    v_add_f32_dpp v128, v128, v128 quad_perm:[1,0,3,2] row_mask:0xf bank_mask:0xf
    v_add_f32_dpp v120, v120, v120 quad_perm:[2,3,0,1] row_mask:0xf bank_mask:0xf
    v_add_f32_dpp v124, v124, v124 quad_perm:[2,3,0,1] row_mask:0xf bank_mask:0xf
    v_add_f32_dpp v128, v128, v128 quad_perm:[2,3,0,1] row_mask:0xf bank_mask:0xf
    v_readlane_b32 s44, v124, 8
    v_readlane_b32 s45, v124, 24
    v_readlane_b32 s46, v124, 40
    v_readlane_b32 s47, v124, 56
    v_mov_b32 v48, s44
    v_mov_b32 v52, s45
    s_nop 0
    v_writelane_b32 v48, s46, 1
    v_writelane_b32 v52, s47, 1
    v_readlane_b32 s44, v120, 0
    v_readlane_b32 s45, v120, 20
    v_readlane_b32 s46, v120, 40
    v_readlane_b32 s47, v120, 60
    v_mov_b32 v49, s44
    v_mov_b32 v53, s45
    s_nop 0
    v_writelane_b32 v49, s46, 1
    v_writelane_b32 v53, s47, 1
    v_readlane_b32 s44, v124, 0
    v_readlane_b32 s45, v124, 20
    v_readlane_b32 s46, v124, 32
    v_readlane_b32 s47, v124, 52
    v_mov_b32 v50, s44
    v_mov_b32 v54, s45
    s_nop 0
    v_writelane_b32 v50, s46, 1
    v_writelane_b32 v54, s47, 1
    v_readlane_b32 s44, v128, 8
    v_readlane_b32 s45, v128, 24
    v_readlane_b32 s46, v128, 8
    v_readlane_b32 s47, v128, 24
    v_mov_b32 v51, s44
    v_mov_b32 v55, s45
    s_nop 0
    v_writelane_b32 v51, s46, 1
    v_writelane_b32 v55, s47, 1
    v_add_f32 v48, v48, v52
    v_add_f32 v49, v49, v53
    v_add_f32 v50, v50, v54
    v_add_f32 v51, v51, v55
    v_mul_f32 v48, 0x3a800000, v48
    v_mul_f32 v49, 0x3a800000, v49
    v_fma_f32 v49, -v48, v48, v49
    v_max_f32 v49, 0, v49
    v_cvt_pk_bf16_f32 v52, v48, v49
    v_lshlrev_b32 v48, 16, v52
    v_and_b32 v49, 0xffff0000, v52
    v_add_f32 v49, 0x3727c5ac, v49
    v_cvt_pk_bf16_f32 v49, v49, v49
    v_lshlrev_b32 v49, 16, v49
    v_sqrt_f32 v49, v49
    s_nop 0
    v_cvt_pk_bf16_f32 v49, v49, v49
    v_lshlrev_b32 v49, 16, v49
    v_rcp_f32 v49, v49
    v_xor_b32 v48, 0x80000000, v48
    v_fma_f32 v50, v48, v51, v50
    v_mul_f32 v50, v50, v49
    v_cvt_pk_bf16_f32 v50, v50, v50
    v_and_b32 v50, 0xffff0000, v50
    v_ashrrev_i32 v51, 31, v50
    v_or_b32 v51, 0x80000000, v51
    v_xor_b32 v50, v50, v51
    v_and_b32 v50, 0xffff0000, v50
    s_sub_u32 s44, 2047, s77
    v_sub_u32 v51, s44, v9
    v_or_b32 v50, v50, v51
    s_lshl_b32 s44, s3, 1
    v_add_u32 v52, s44, v9
    v_lshlrev_b32 v53, 3, v52
    v_lshlrev_b32 v52, 2, v52
    v_add_u32 v53, 159744, v53
    v_add_u32 v52, 159808, v52
    s_mov_b64 exec, 3
    ds_write_b64 v53, v[48:49]
    ds_write_b32 v52, v50
    s_mov_b64 exec, -1
    s_waitcnt lgkmcnt(0)

    s_cmp_lg_u32 s3, 0
    s_cbranch_scc1 F_a0r
F_a0p:
    s_waitcnt vmcnt(0)
    v_cmp_eq_u32 vcc, 0, v11
    s_cbranch_vccz F_a0r
    s_sleep 4
    buffer_load_dword v11, v59, s[48:51], 0 offen sc0 sc1
    s_branch F_a0p
F_a0r:
    s_barrier
    s_cmp_eq_u32 s3, 0
    s_cbranch_scc1 F_ax0
    s_mul_i32 s44, s33, 768
    s_add_u32 s44, s44, 40960
    s_add_u32 s45, s3, 1
    s_lshr_b32 s45, s45, 1
    s_cmp_eq_u32 s3, 2
    s_cselect_b32 s45, 0, s45
    s_lshl_b32 s45, s45, 8
    s_add_u32 s44, s44, s45
    buffer_atomic_add_f32 v66, v3, s[40:43], s44 offen
    s_mul_i32 s44, s2, 1152
    s_mul_i32 s45, s3, 384
    s_add_u32 s44, s44, s45
    s_sub_u32 s44, s44, 384
    s_mov_b64 exec, 0xffffff
    buffer_store_dwordx4 v[12:15], v2, s[24:27], s44 offen sc0 sc1
    s_mov_b64 exec, -1
    s_branch F_s1
F_ax0:
    v_add_u32 v60, 159744, v3
    ds_read_b32 v60, v60
    s_lshl_b32 s44, s76, 7
    s_mov_b32 exec_hi, 0
    s_waitcnt lgkmcnt(0)
    buffer_store_dword v60, v3, s[40:43], s44 offen sc0 sc1
    s_mov_b64 exec, -1
F_s1:

    s_barrier
    v_mov_b32 v4, 159144
    v_mov_b32 v8, 1
    s_lshr_b32 s47, s32, 2
    s_lshl_b32 s47, s47, 11
    s_add_u32 s54, s47, 0x858180
    s_add_u32 s54, s72, s54
    s_addc_u32 s55, s73, 0
    s_waitcnt vmcnt(0)
    s_mov_b64 exec, 1
    ds_add_rtn_u32 v9, v4, v8
    s_waitcnt lgkmcnt(0)
    v_readfirstlane_b32 s44, v9
    s_mov_b64 exec, -1
    s_cmp_lg_u32 s44, 3
    s_cbranch_scc1 F_a0s
    s_mov_b32 s74, 1
    s_atomic_add s74, s[54:55], 0
    s_atomic_add s74, s[56:57], 0
    s_atomic_add s74, s[58:59], 0
F_a0s:

    s_barrier
    s_and_b32 s89, s2, 0xdd
    s_bfe_u32 s44, s2, 0x10005
    s_lshl_b32 s44, s44, 1
    s_or_b32 s89, s89, s44
    s_bfe_u32 s44, s2, 0x10001
    s_xor_b32 s44, s44, 1
    s_lshl_b32 s44, s44, 5
    s_or_b32 s89, s89, s44
    s_xor_b32 s89, s89, 0

    s_and_b32 s36, s89, 3
    s_bfe_u32 s37, s89, 0x10002
    s_lshr_b32 s38, s89, 3
    s_cmp_eq_u32 s37, 0
    s_cselect_b32 s16, s62, s64
    s_cselect_b32 s17, s63, s65
    s_cmp_lt_u32 s89, 224
    s_cselect_b32 s18, 7340032, 0
    v_mul_u32_u24 v6, 57344, v5
    v_lshl_add_u32 v6, v7, 4, v6
    s_lshl_b32 s44, s36, 2
    s_add_u32 s44, s44, s3
    s_waitcnt lgkmcnt(0)
    s_mul_i32 s54, s44, 458752
    s_lshl_b32 s45, s38, 8
    s_add_u32 s54, s54, s45
    s_lshl_b32 s55, s44, 7

    s_add_u32 s39, s35, 2
    s_and_b32 s39, s39, 7
    s_lshl_b32 s10, s34, 3
    s_add_u32 s10, s10, s30

    s_mul_i32 s10, s10, 112
    s_mul_i32 s79, s3, 28
    s_add_u32 s10, s10, s79
    s_lshl_b32 s78, s10, 11
    s_lshl_b32 s79, s39, 8
    s_add_u32 s78, s78, s79
    v_mul_u32_u24 v160, 14336, v5
    v_lshl_add_u32 v160, v7, 4, v160

    s_mov_b32 s80, s66
    s_mov_b32 s81, s67
    s_mov_b32 s82, 0x700000
    s_mov_b32 s83, 0x00020000
    s_mul_i32 s53, s2, 37
    s_and_b32 s53, s53, 255
    s_mul_i32 s53, s53, 4
    s_lshr_b32 s53, s53, 8
    s_branch F_swx
F_sw0:
    s_add_u32 s91, s54, 0
    buffer_load_dwordx4 v[72:75], v6, s[16:19], s91 offen nt
    s_add_u32 s91, s54, 7168
    buffer_load_dwordx4 v[76:79], v6, s[16:19], s91 offen nt
    s_add_u32 s91, s54, 14336
    buffer_load_dwordx4 v[80:83], v6, s[16:19], s91 offen nt
    s_add_u32 s91, s54, 21504
    buffer_load_dwordx4 v[84:87], v6, s[16:19], s91 offen nt
    s_add_u32 s91, s54, 28672
    buffer_load_dwordx4 v[88:91], v6, s[16:19], s91 offen nt
    s_add_u32 s91, s54, 35840
    buffer_load_dwordx4 v[92:95], v6, s[16:19], s91 offen nt
    s_add_u32 s91, s54, 43008
    buffer_load_dwordx4 v[96:99], v6, s[16:19], s91 offen nt
    s_add_u32 s91, s54, 50176
    buffer_load_dwordx4 v[100:103], v6, s[16:19], s91 offen nt
    s_setpc_b64 s[34:35]
F_swx:
    s_cmp_eq_u32 s3, 2
    s_cbranch_scc1 F_ax2
    s_cmp_eq_u32 s3, 1
    s_cbranch_scc1 F_ax1
    s_cmp_eq_u32 s3, 0
    s_cbranch_scc1 F_ax0b
    s_barrier
    s_cmp_lg_u32 s53, 0
    s_cbranch_scc1 SW_91
    s_call_b64 s[34:35], F_sw0
SW_91:
    s_branch IW_w5
IW_r5:
    s_barrier
    s_cmp_lg_u32 s53, 1
    s_cbranch_scc1 SW_92
    s_call_b64 s[34:35], F_sw0
SW_92:
    s_branch IW_w7
IW_r7:
    s_barrier
    s_cmp_lg_u32 s53, 2
    s_cbranch_scc1 SW_93
    s_call_b64 s[34:35], F_sw0
SW_93:
    s_nop 0
    s_barrier
    s_cmp_lg_u32 s53, 3
    s_cbranch_scc1 SW_94
    s_call_b64 s[34:35], F_sw0
SW_94:
    s_nop 0
    s_barrier
    s_nop 0
    s_barrier
    s_nop 0
    s_barrier
    s_add_u32 s91, s54, 229376
    buffer_load_dwordx4 v[104:107], v6, s[16:19], s91 offen nt
    s_add_u32 s91, s54, 236544
    buffer_load_dwordx4 v[108:111], v6, s[16:19], s91 offen nt
    s_add_u32 s91, s54, 243712
    buffer_load_dwordx4 v[112:115], v6, s[16:19], s91 offen nt
    s_add_u32 s91, s54, 250880
    buffer_load_dwordx4 v[116:119], v6, s[16:19], s91 offen nt
    s_nop 0
    s_load_dword s76, s[56:57], 0 glc
    s_barrier
    s_add_u32 s91, s54, 258048
    buffer_load_dwordx4 v[120:123], v6, s[16:19], s91 offen nt
    s_add_u32 s91, s54, 265216
    buffer_load_dwordx4 v[124:127], v6, s[16:19], s91 offen nt
    s_add_u32 s91, s54, 272384
    buffer_load_dwordx4 v[128:131], v6, s[16:19], s91 offen nt
    s_add_u32 s91, s54, 279552
    buffer_load_dwordx4 v[132:135], v6, s[16:19], s91 offen nt
    s_waitcnt lgkmcnt(0)
    s_cmp_lt_u32 s76, 1000
    s_cbranch_scc1 F_g3
    v_mov_b32 v4, 1
    s_mov_b64 exec, 1
    ds_write_b32 v10, v4 offset:48
    s_mov_b64 exec, -1
    s_mov_b32 s88, 0
F_g3:
    s_barrier
    s_branch F_aj
F_ax1:
    s_barrier
    s_cmp_lg_u32 s53, 0
    s_cbranch_scc1 SW_95
    s_call_b64 s[34:35], F_sw0
SW_95:
    s_branch IW_w6
IW_r6:
    s_barrier
    s_cmp_lg_u32 s53, 1
    s_cbranch_scc1 SW_96
    s_call_b64 s[34:35], F_sw0
SW_96:
    s_nop 0
    s_barrier
    s_cmp_lg_u32 s53, 2
    s_cbranch_scc1 SW_97
    s_call_b64 s[34:35], F_sw0
SW_97:
    s_nop 0
    s_mul_i32 s44, s33, 768
    s_add_u32 s44, s44, 40960
    s_barrier
    s_cmp_lg_u32 s53, 3
    s_cbranch_scc1 SW_98
    s_call_b64 s[34:35], F_sw0
SW_98:
    s_load_dword s76, s[58:59], 0 glc
    s_barrier
    s_waitcnt lgkmcnt(0)
    s_cmp_ge_u32 s76, 16
    s_cbranch_scc1 GC_99
SP_100:
    s_load_dword s76, s[58:59], 0 glc
    s_waitcnt lgkmcnt(0)
    s_cmp_ge_u32 s76, 16
    s_cbranch_scc1 SD_101
    s_sleep 3
    s_branch SP_100
SD_101:
GC_99:
    s_barrier
    s_sleep 4
    s_mov_b32 m0, 158208
    s_mov_b32 exec_hi, 0xffff
    buffer_load_dwordx4 v2, s[40:43], s44 offen sc0 sc1 lds
    s_mov_b64 exec, -1
    s_barrier
    s_add_u32 s91, s54, 229376
    buffer_load_dwordx4 v[104:107], v6, s[16:19], s91 offen nt
    s_add_u32 s91, s54, 236544
    buffer_load_dwordx4 v[108:111], v6, s[16:19], s91 offen nt
    s_add_u32 s91, s54, 243712
    buffer_load_dwordx4 v[112:115], v6, s[16:19], s91 offen nt
    s_add_u32 s91, s54, 250880
    buffer_load_dwordx4 v[116:119], v6, s[16:19], s91 offen nt
    s_barrier
    s_add_u32 s91, s54, 258048
    buffer_load_dwordx4 v[120:123], v6, s[16:19], s91 offen nt
    s_add_u32 s91, s54, 265216
    buffer_load_dwordx4 v[124:127], v6, s[16:19], s91 offen nt
    s_add_u32 s91, s54, 272384
    buffer_load_dwordx4 v[128:131], v6, s[16:19], s91 offen nt
    s_add_u32 s91, s54, 279552
    buffer_load_dwordx4 v[132:135], v6, s[16:19], s91 offen nt
    s_waitcnt vmcnt(8)
    v_mov_b32 v4, 1
    s_mov_b64 exec, 1
    ds_write_b32 v10, v4 offset:48
    s_mov_b64 exec, -1
    s_barrier
    s_branch F_aj
IW_w9:
    s_branch IW_r9
F_ax0b:
    s_barrier
    s_cmp_lg_u32 s53, 0
    s_cbranch_scc1 SW_102
    s_call_b64 s[34:35], F_sw0
SW_102:
    s_branch IW_w2
IW_r2:
    s_barrier
    s_cmp_lg_u32 s53, 1
    s_cbranch_scc1 SW_103
    s_call_b64 s[34:35], F_sw0
SW_103:
    s_nop 0
    s_barrier
    s_cmp_lg_u32 s53, 2
    s_cbranch_scc1 SW_104
    s_call_b64 s[34:35], F_sw0
SW_104:
    s_nop 0
    s_lshl_b32 s47, s28, 9
    s_add_u32 s58, s47, 0x858000
    s_add_u32 s58, s72, s58
    s_addc_u32 s59, s73, 0
    s_lshl_b32 s44, s32, 11
    s_lshl_b32 s45, s28, 11
    v_lshrrev_b32 v11, 2, v0
    v_and_b32 v9, 3, v0
    v_lshlrev_b32 v9, 4, v9
    v_lshl_add_u32 v11, v11, 7, v9

    s_barrier
    s_cmp_lg_u32 s53, 3
    s_cbranch_scc1 SW_105
    s_call_b64 s[34:35], F_sw0
SW_105:
    s_load_dword s76, s[56:57], 0 glc
    s_load_dword s77, s[58:59], 0 glc
    s_barrier
    s_waitcnt lgkmcnt(0)
    s_cmp_ge_u32 s76, 16
    s_cbranch_scc1 GC_106
SP_107:
    s_load_dword s76, s[56:57], 0 glc
    s_waitcnt lgkmcnt(0)
    s_cmp_ge_u32 s76, 16
    s_cbranch_scc1 SD_108
    s_sleep 3
    s_branch SP_107
SD_108:
GC_106:
    s_cmp_ge_u32 s77, 16
    s_cbranch_scc1 GC_109
SP_110:
    s_load_dword s77, s[58:59], 0 glc
    s_waitcnt lgkmcnt(0)
    s_cmp_ge_u32 s77, 16
    s_cbranch_scc1 SD_111
    s_sleep 3
    s_branch SP_110
SD_111:
GC_109:
    s_barrier
    s_sleep 4
    buffer_load_dwordx4 v[32:35], v11, s[40:43], s44 offen sc0 sc1
    buffer_load_dwordx4 v[36:39], v11, s[40:43], s45 offen sc0 sc1
    v_lshlrev_b32 v9, 3, v0
    v_add_u32 v9, 155648, v9
    s_mov_b32 s44, 0x3fb8aa3b

    s_barrier
    s_add_u32 s91, s54, 229376
    buffer_load_dwordx4 v[104:107], v6, s[16:19], s91 offen nt
    s_add_u32 s91, s54, 236544
    buffer_load_dwordx4 v[108:111], v6, s[16:19], s91 offen nt
    s_add_u32 s91, s54, 243712
    buffer_load_dwordx4 v[112:115], v6, s[16:19], s91 offen nt
    s_add_u32 s91, s54, 250880
    buffer_load_dwordx4 v[116:119], v6, s[16:19], s91 offen nt
    s_barrier
    s_add_u32 s91, s54, 258048
    buffer_load_dwordx4 v[120:123], v6, s[16:19], s91 offen nt
    s_add_u32 s91, s54, 265216
    buffer_load_dwordx4 v[124:127], v6, s[16:19], s91 offen nt
    s_add_u32 s91, s54, 272384
    buffer_load_dwordx4 v[128:131], v6, s[16:19], s91 offen nt
    s_add_u32 s91, s54, 279552
    buffer_load_dwordx4 v[132:135], v6, s[16:19], s91 offen nt
    s_waitcnt vmcnt(8)
    v_swap_b32 v33, v34
    v_swap_b32 v37, v38
    v_mul_f32 v40, s44, v34
    v_mul_f32 v41, s44, v35
    ds_write_b64 v9, v[32:33]
    ds_write_b64 v9, v[40:41] offset:1024
    ds_write_b64 v9, v[36:37] offset:1536
    ds_write_b64 v9, v[38:39] offset:2048

    v_mov_b32 v4, 1
    s_mov_b64 exec, 1
    ds_write_b32 v10, v4 offset:48
    s_mov_b64 exec, -1
    s_barrier
    s_branch F_aj
F_ax2:
    s_cmp_lg_u32 s2, 248
    s_cbranch_scc1 F_a2n
    s_waitcnt lgkmcnt(0)
    s_mov_b32 s74, 7
    v_lshrrev_b32 v11, 1, v0
    v_and_b32 v9, 1, v0
    v_lshlrev_b32 v9, 4, v9
    v_lshl_add_u32 v11, v11, 7, v9
    v_lshlrev_b32 v9, 9, v0
    v_mov_b32 v8, 1000
F_a2l:

    s_load_dword s60, s[40:41], 0x8180 glc
    s_load_dword s61, s[40:41], 0x8980 glc
    s_load_dword s62, s[40:41], 0x9180 glc
    s_load_dword s63, s[40:41], 0x9980 glc
    s_waitcnt lgkmcnt(0)
    s_add_u32 s60, s60, s61
    s_add_u32 s62, s62, s63
    s_add_u32 s60, s60, s62
    s_cmp_ge_u32 s60, 256
    s_cbranch_scc1 F_a2t

    s_cmp_ge_u32 s74, 17
    s_cbranch_scc1 DB_112
    s_barrier
    s_add_u32 s74, s74, 1
DB_112:
    s_branch F_a2l
F_a2t:
    s_movk_i32 s44, 0
    buffer_load_dwordx4 v[16:19], v11, s[40:43], s44 offen offset:64 sc0 sc1
    s_movk_i32 s44, 4096
    buffer_load_dwordx4 v[20:23], v11, s[40:43], s44 offen offset:64 sc0 sc1
    s_movk_i32 s44, 8192
    buffer_load_dwordx4 v[24:27], v11, s[40:43], s44 offen offset:64 sc0 sc1
    s_movk_i32 s44, 12288
    buffer_load_dwordx4 v[28:31], v11, s[40:43], s44 offen offset:64 sc0 sc1
    s_movk_i32 s44, 16384
    buffer_load_dwordx4 v[32:35], v11, s[40:43], s44 offen offset:64 sc0 sc1
    s_movk_i32 s44, 20480
    buffer_load_dwordx4 v[36:39], v11, s[40:43], s44 offen offset:64 sc0 sc1
    s_movk_i32 s44, 24576
    buffer_load_dwordx4 v[40:43], v11, s[40:43], s44 offen offset:64 sc0 sc1
    s_movk_i32 s44, 28672
    buffer_load_dwordx4 v[44:47], v11, s[40:43], s44 offen offset:64 sc0 sc1
    s_mov_b32 s44, 32768
    s_mov_b64 exec, 0xffff
    buffer_atomic_add v8, v9, s[40:43], s44 offen
    s_mov_b64 exec, -1

    s_cmp_ge_u32 s74, 17
    s_cbranch_scc1 DB_113
    s_barrier
    s_add_u32 s74, s74, 1
DB_113:
    s_waitcnt vmcnt(1)
    v_max3_u32 v48, v16, v17, v18
    v_med3_u32 v49, v16, v17, v18
    v_min3_u32 v50, v16, v17, v18
    v_med3_u32 v50, v49, v50, v19
    v_med3_u32 v49, v48, v49, v19
    v_max_u32 v48, v48, v19
    v_med3_u32 v50, v49, v50, v20
    v_med3_u32 v49, v48, v49, v20
    v_max_u32 v48, v48, v20
    v_med3_u32 v50, v49, v50, v21
    v_med3_u32 v49, v48, v49, v21
    v_max_u32 v48, v48, v21
    v_med3_u32 v50, v49, v50, v22
    v_med3_u32 v49, v48, v49, v22
    v_max_u32 v48, v48, v22
    v_med3_u32 v50, v49, v50, v23
    v_med3_u32 v49, v48, v49, v23
    v_max_u32 v48, v48, v23
    v_med3_u32 v50, v49, v50, v24
    v_med3_u32 v49, v48, v49, v24
    v_max_u32 v48, v48, v24
    v_med3_u32 v50, v49, v50, v25
    v_med3_u32 v49, v48, v49, v25
    v_max_u32 v48, v48, v25
    v_med3_u32 v50, v49, v50, v26
    v_med3_u32 v49, v48, v49, v26
    v_max_u32 v48, v48, v26
    v_med3_u32 v50, v49, v50, v27
    v_med3_u32 v49, v48, v49, v27
    v_max_u32 v48, v48, v27
    v_med3_u32 v50, v49, v50, v28
    v_med3_u32 v49, v48, v49, v28
    v_max_u32 v48, v48, v28
    v_med3_u32 v50, v49, v50, v29
    v_med3_u32 v49, v48, v49, v29
    v_max_u32 v48, v48, v29
    v_med3_u32 v50, v49, v50, v30
    v_med3_u32 v49, v48, v49, v30
    v_max_u32 v48, v48, v30
    v_med3_u32 v50, v49, v50, v31
    v_med3_u32 v49, v48, v49, v31
    v_max_u32 v48, v48, v31
    v_med3_u32 v50, v49, v50, v32
    v_med3_u32 v49, v48, v49, v32
    v_max_u32 v48, v48, v32
    v_med3_u32 v50, v49, v50, v33
    v_med3_u32 v49, v48, v49, v33
    v_max_u32 v48, v48, v33
    v_med3_u32 v50, v49, v50, v34
    v_med3_u32 v49, v48, v49, v34
    v_max_u32 v48, v48, v34
    v_med3_u32 v50, v49, v50, v35
    v_med3_u32 v49, v48, v49, v35
    v_max_u32 v48, v48, v35
    v_med3_u32 v50, v49, v50, v36
    v_med3_u32 v49, v48, v49, v36
    v_max_u32 v48, v48, v36
    v_med3_u32 v50, v49, v50, v37
    v_med3_u32 v49, v48, v49, v37
    v_max_u32 v48, v48, v37
    v_med3_u32 v50, v49, v50, v38
    v_med3_u32 v49, v48, v49, v38
    v_max_u32 v48, v48, v38
    v_med3_u32 v50, v49, v50, v39
    v_med3_u32 v49, v48, v49, v39
    v_max_u32 v48, v48, v39
    v_med3_u32 v50, v49, v50, v40
    v_med3_u32 v49, v48, v49, v40
    v_max_u32 v48, v48, v40
    v_med3_u32 v50, v49, v50, v41
    v_med3_u32 v49, v48, v49, v41
    v_max_u32 v48, v48, v41
    v_med3_u32 v50, v49, v50, v42
    v_med3_u32 v49, v48, v49, v42
    v_max_u32 v48, v48, v42
    v_med3_u32 v50, v49, v50, v43
    v_med3_u32 v49, v48, v49, v43
    v_max_u32 v48, v48, v43
    v_med3_u32 v50, v49, v50, v44
    v_med3_u32 v49, v48, v49, v44
    v_max_u32 v48, v48, v44
    v_med3_u32 v50, v49, v50, v45
    v_med3_u32 v49, v48, v49, v45
    v_max_u32 v48, v48, v45
    v_med3_u32 v50, v49, v50, v46
    v_med3_u32 v49, v48, v49, v46
    v_max_u32 v48, v48, v46
    v_med3_u32 v50, v49, v50, v47
    v_med3_u32 v49, v48, v49, v47
    v_max_u32 v48, v48, v47
    s_mov_b32 s53, 0
    v_max_u32 v4, v48, v49
    s_nop 1
    v_max_u32_dpp v4, v4, v4 row_shr:1 row_mask:0xf bank_mask:0xf bound_ctrl:0
    s_nop 1
    v_max_u32_dpp v4, v4, v4 row_shr:2 row_mask:0xf bank_mask:0xf bound_ctrl:0
    s_nop 1
    v_max_u32_dpp v4, v4, v4 row_shr:4 row_mask:0xf bank_mask:0xf bound_ctrl:0
    s_nop 1
    v_max_u32_dpp v4, v4, v4 row_shr:8 row_mask:0xf bank_mask:0xf bound_ctrl:0
    s_nop 1
    v_max_u32_dpp v4, v4, v4 row_bcast:15 row_mask:0xa bank_mask:0xf
    s_nop 1
    v_max_u32_dpp v4, v4, v4 row_bcast:31 row_mask:0xc bank_mask:0xf
    s_nop 0
    v_readlane_b32 s52, v4, 63
    s_nop 0
    s_add_u32 s53, s53, s52
    v_writelane_b32 v13, s53, 0
    v_subrev_u32 v48, s52, v48
    v_subrev_u32 v49, s52, v49
    v_max_u32 v4, v48, v49
    s_nop 1
    v_max_u32_dpp v4, v4, v4 row_shr:1 row_mask:0xf bank_mask:0xf bound_ctrl:0
    s_nop 1
    v_max_u32_dpp v4, v4, v4 row_shr:2 row_mask:0xf bank_mask:0xf bound_ctrl:0
    s_nop 1
    v_max_u32_dpp v4, v4, v4 row_shr:4 row_mask:0xf bank_mask:0xf bound_ctrl:0
    s_nop 1
    v_max_u32_dpp v4, v4, v4 row_shr:8 row_mask:0xf bank_mask:0xf bound_ctrl:0
    s_nop 1
    v_max_u32_dpp v4, v4, v4 row_bcast:15 row_mask:0xa bank_mask:0xf
    s_nop 1
    v_max_u32_dpp v4, v4, v4 row_bcast:31 row_mask:0xc bank_mask:0xf
    s_nop 0
    v_readlane_b32 s52, v4, 63
    s_nop 0
    s_add_u32 s53, s53, s52
    v_writelane_b32 v13, s53, 1
    v_subrev_u32 v48, s52, v48
    v_subrev_u32 v49, s52, v49
    v_max_u32 v4, v48, v49
    s_nop 1
    v_max_u32_dpp v4, v4, v4 row_shr:1 row_mask:0xf bank_mask:0xf bound_ctrl:0
    s_nop 1
    v_max_u32_dpp v4, v4, v4 row_shr:2 row_mask:0xf bank_mask:0xf bound_ctrl:0
    s_nop 1
    v_max_u32_dpp v4, v4, v4 row_shr:4 row_mask:0xf bank_mask:0xf bound_ctrl:0
    s_nop 1
    v_max_u32_dpp v4, v4, v4 row_shr:8 row_mask:0xf bank_mask:0xf bound_ctrl:0
    s_nop 1
    v_max_u32_dpp v4, v4, v4 row_bcast:15 row_mask:0xa bank_mask:0xf
    s_nop 1
    v_max_u32_dpp v4, v4, v4 row_bcast:31 row_mask:0xc bank_mask:0xf
    s_nop 0
    v_readlane_b32 s52, v4, 63
    s_nop 0
    s_add_u32 s53, s53, s52
    v_writelane_b32 v13, s53, 2
    v_subrev_u32 v48, s52, v48
    v_subrev_u32 v49, s52, v49
    v_max_u32 v4, v48, v49
    s_nop 1
    v_max_u32_dpp v4, v4, v4 row_shr:1 row_mask:0xf bank_mask:0xf bound_ctrl:0
    s_nop 1
    v_max_u32_dpp v4, v4, v4 row_shr:2 row_mask:0xf bank_mask:0xf bound_ctrl:0
    s_nop 1
    v_max_u32_dpp v4, v4, v4 row_shr:4 row_mask:0xf bank_mask:0xf bound_ctrl:0
    s_nop 1
    v_max_u32_dpp v4, v4, v4 row_shr:8 row_mask:0xf bank_mask:0xf bound_ctrl:0
    s_nop 1
    v_max_u32_dpp v4, v4, v4 row_bcast:15 row_mask:0xa bank_mask:0xf
    s_nop 1
    v_max_u32_dpp v4, v4, v4 row_bcast:31 row_mask:0xc bank_mask:0xf
    s_nop 0
    v_readlane_b32 s52, v4, 63
    s_nop 0
    s_add_u32 s53, s53, s52
    v_writelane_b32 v13, s53, 3
    v_subrev_u32 v48, s52, v48
    v_subrev_u32 v49, s52, v49
    v_max_u32 v4, v48, v49
    s_nop 1
    v_max_u32_dpp v4, v4, v4 row_shr:1 row_mask:0xf bank_mask:0xf bound_ctrl:0
    s_nop 1
    v_max_u32_dpp v4, v4, v4 row_shr:2 row_mask:0xf bank_mask:0xf bound_ctrl:0
    s_nop 1
    v_max_u32_dpp v4, v4, v4 row_shr:4 row_mask:0xf bank_mask:0xf bound_ctrl:0
    s_nop 1
    v_max_u32_dpp v4, v4, v4 row_shr:8 row_mask:0xf bank_mask:0xf bound_ctrl:0
    s_nop 1
    v_max_u32_dpp v4, v4, v4 row_bcast:15 row_mask:0xa bank_mask:0xf
    s_nop 1
    v_max_u32_dpp v4, v4, v4 row_bcast:31 row_mask:0xc bank_mask:0xf
    s_nop 0
    v_readlane_b32 s52, v4, 63
    s_nop 0
    s_add_u32 s53, s53, s52
    v_writelane_b32 v13, s53, 4
    v_subrev_u32 v48, s52, v48
    v_subrev_u32 v49, s52, v49
    v_max_u32 v4, v48, v49
    s_nop 1
    v_max_u32_dpp v4, v4, v4 row_shr:1 row_mask:0xf bank_mask:0xf bound_ctrl:0
    s_nop 1
    v_max_u32_dpp v4, v4, v4 row_shr:2 row_mask:0xf bank_mask:0xf bound_ctrl:0
    s_nop 1
    v_max_u32_dpp v4, v4, v4 row_shr:4 row_mask:0xf bank_mask:0xf bound_ctrl:0
    s_nop 1
    v_max_u32_dpp v4, v4, v4 row_shr:8 row_mask:0xf bank_mask:0xf bound_ctrl:0
    s_nop 1
    v_max_u32_dpp v4, v4, v4 row_bcast:15 row_mask:0xa bank_mask:0xf
    s_nop 1
    v_max_u32_dpp v4, v4, v4 row_bcast:31 row_mask:0xc bank_mask:0xf
    s_nop 0
    v_readlane_b32 s52, v4, 63
    s_nop 0
    s_add_u32 s53, s53, s52
    v_writelane_b32 v13, s53, 5
    v_subrev_u32 v48, s52, v48
    v_subrev_u32 v49, s52, v49
    v_max_u32 v4, v48, v49
    s_nop 1
    v_max_u32_dpp v4, v4, v4 row_shr:1 row_mask:0xf bank_mask:0xf bound_ctrl:0
    s_nop 1
    v_max_u32_dpp v4, v4, v4 row_shr:2 row_mask:0xf bank_mask:0xf bound_ctrl:0
    s_nop 1
    v_max_u32_dpp v4, v4, v4 row_shr:4 row_mask:0xf bank_mask:0xf bound_ctrl:0
    s_nop 1
    v_max_u32_dpp v4, v4, v4 row_shr:8 row_mask:0xf bank_mask:0xf bound_ctrl:0
    s_nop 1
    v_max_u32_dpp v4, v4, v4 row_bcast:15 row_mask:0xa bank_mask:0xf
    s_nop 1
    v_max_u32_dpp v4, v4, v4 row_bcast:31 row_mask:0xc bank_mask:0xf
    s_nop 0
    v_readlane_b32 s52, v4, 63
    s_nop 0
    s_add_u32 s53, s53, s52
    v_writelane_b32 v13, s53, 6
    v_subrev_u32 v48, s52, v48
    v_subrev_u32 v49, s52, v49
    v_max_u32 v4, v48, v49
    s_nop 1
    v_max_u32_dpp v4, v4, v4 row_shr:1 row_mask:0xf bank_mask:0xf bound_ctrl:0
    s_nop 1
    v_max_u32_dpp v4, v4, v4 row_shr:2 row_mask:0xf bank_mask:0xf bound_ctrl:0
    s_nop 1
    v_max_u32_dpp v4, v4, v4 row_shr:4 row_mask:0xf bank_mask:0xf bound_ctrl:0
    s_nop 1
    v_max_u32_dpp v4, v4, v4 row_shr:8 row_mask:0xf bank_mask:0xf bound_ctrl:0
    s_nop 1
    v_max_u32_dpp v4, v4, v4 row_bcast:15 row_mask:0xa bank_mask:0xf
    s_nop 1
    v_max_u32_dpp v4, v4, v4 row_bcast:31 row_mask:0xc bank_mask:0xf
    s_nop 0
    v_readlane_b32 s52, v4, 63
    s_nop 0
    s_add_u32 s53, s53, s52
    v_writelane_b32 v13, s53, 7
    v_cmp_lt_u32 vcc, s53, v50
    s_cbranch_vccz F_a2k
    s_mov_b32 s53, 0
    s_mov_b32 s52, 0
    s_mov_b32 s64, 0
F_a2f:
    v_subrev_u32 v16, s52, v16
    v_subrev_u32 v17, s52, v17
    v_subrev_u32 v18, s52, v18
    v_subrev_u32 v19, s52, v19
    v_subrev_u32 v20, s52, v20
    v_subrev_u32 v21, s52, v21
    v_subrev_u32 v22, s52, v22
    v_subrev_u32 v23, s52, v23
    v_subrev_u32 v24, s52, v24
    v_subrev_u32 v25, s52, v25
    v_subrev_u32 v26, s52, v26
    v_subrev_u32 v27, s52, v27
    v_subrev_u32 v28, s52, v28
    v_subrev_u32 v29, s52, v29
    v_subrev_u32 v30, s52, v30
    v_subrev_u32 v31, s52, v31
    v_subrev_u32 v32, s52, v32
    v_subrev_u32 v33, s52, v33
    v_subrev_u32 v34, s52, v34
    v_subrev_u32 v35, s52, v35
    v_subrev_u32 v36, s52, v36
    v_subrev_u32 v37, s52, v37
    v_subrev_u32 v38, s52, v38
    v_subrev_u32 v39, s52, v39
    v_subrev_u32 v40, s52, v40
    v_subrev_u32 v41, s52, v41
    v_subrev_u32 v42, s52, v42
    v_subrev_u32 v43, s52, v43
    v_subrev_u32 v44, s52, v44
    v_subrev_u32 v45, s52, v45
    v_subrev_u32 v46, s52, v46
    v_subrev_u32 v47, s52, v47
    v_max3_u32 v4, v16, v17, v18
    v_max3_u32 v12, v19, v20, v21
    v_max3_u32 v4, v4, v22, v23
    v_max3_u32 v12, v12, v24, v25
    v_max3_u32 v4, v4, v26, v27
    v_max3_u32 v12, v12, v28, v29
    v_max3_u32 v4, v4, v30, v31
    v_max3_u32 v12, v12, v32, v33
    v_max3_u32 v4, v4, v34, v35
    v_max3_u32 v12, v12, v36, v37
    v_max3_u32 v4, v4, v38, v39
    v_max3_u32 v12, v12, v40, v41
    v_max3_u32 v4, v4, v42, v43
    v_max3_u32 v12, v12, v44, v45
    v_max3_u32 v4, v4, v46, v47
    v_max_u32 v4, v4, v12
    s_nop 1
    v_max_u32_dpp v4, v4, v4 row_shr:1 row_mask:0xf bank_mask:0xf bound_ctrl:0
    s_nop 1
    v_max_u32_dpp v4, v4, v4 row_shr:2 row_mask:0xf bank_mask:0xf bound_ctrl:0
    s_nop 1
    v_max_u32_dpp v4, v4, v4 row_shr:4 row_mask:0xf bank_mask:0xf bound_ctrl:0
    s_nop 1
    v_max_u32_dpp v4, v4, v4 row_shr:8 row_mask:0xf bank_mask:0xf bound_ctrl:0
    s_nop 1
    v_max_u32_dpp v4, v4, v4 row_bcast:15 row_mask:0xa bank_mask:0xf
    s_nop 1
    v_max_u32_dpp v4, v4, v4 row_bcast:31 row_mask:0xc bank_mask:0xf
    s_nop 0
    v_readlane_b32 s52, v4, 63
    s_nop 0
    s_add_u32 s53, s53, s52
    s_mov_b32 m0, s64
    v_writelane_b32 v13, s53, m0
    s_cmp_ge_u32 s74, 17
    s_cbranch_scc1 DB_114
    s_barrier
    s_add_u32 s74, s74, 1
DB_114:
    s_add_u32 s64, s64, 1
    s_cmp_lt_u32 s64, 8
    s_cbranch_scc1 F_a2f
F_a2k:
    v_and_b32 v4, 7, v0
    v_lshlrev_b32 v4, 2, v4
    ds_bpermute_b32 v12, v4, v13
    v_lshrrev_b32 v9, 3, v0
    v_lshl_add_u32 v4, v9, 9, v4
    s_mov_b32 s44, 32896
    s_mov_b32 s45, 36992
    s_waitcnt lgkmcnt(0)
    v_or_b32 v12, 0x8000, v12
    buffer_store_dword v12, v4, s[40:43], s44 offen sc0 sc1
    buffer_store_dword v12, v4, s[40:43], s45 offen sc0 sc1

F_a2m:
    s_cmp_ge_u32 s74, 17
    s_cbranch_scc1 DB_115
    s_barrier
    s_add_u32 s74, s74, 1
DB_115:
    s_cmp_lt_u32 s74, 17
    s_cbranch_scc1 F_a2m
    s_add_u32 s91, s54, 0
    buffer_load_dwordx4 v[72:75], v6, s[16:19], s91 offen nt
    s_add_u32 s91, s54, 7168
    buffer_load_dwordx4 v[76:79], v6, s[16:19], s91 offen nt
    s_add_u32 s91, s54, 14336
    buffer_load_dwordx4 v[80:83], v6, s[16:19], s91 offen nt
    s_add_u32 s91, s54, 21504
    buffer_load_dwordx4 v[84:87], v6, s[16:19], s91 offen nt
    s_add_u32 s91, s54, 28672
    buffer_load_dwordx4 v[88:91], v6, s[16:19], s91 offen nt
    s_add_u32 s91, s54, 35840
    buffer_load_dwordx4 v[92:95], v6, s[16:19], s91 offen nt
    s_add_u32 s91, s54, 43008
    buffer_load_dwordx4 v[96:99], v6, s[16:19], s91 offen nt
    s_add_u32 s91, s54, 50176
    buffer_load_dwordx4 v[100:103], v6, s[16:19], s91 offen nt
    s_add_u32 s91, s54, 229376
    buffer_load_dwordx4 v[104:107], v6, s[16:19], s91 offen nt
    s_add_u32 s91, s54, 236544
    buffer_load_dwordx4 v[108:111], v6, s[16:19], s91 offen nt
    s_add_u32 s91, s54, 243712
    buffer_load_dwordx4 v[112:115], v6, s[16:19], s91 offen nt
    s_add_u32 s91, s54, 250880
    buffer_load_dwordx4 v[116:119], v6, s[16:19], s91 offen nt
    s_add_u32 s91, s54, 258048
    buffer_load_dwordx4 v[120:123], v6, s[16:19], s91 offen nt
    s_add_u32 s91, s54, 265216
    buffer_load_dwordx4 v[124:127], v6, s[16:19], s91 offen nt
    s_add_u32 s91, s54, 272384
    buffer_load_dwordx4 v[128:131], v6, s[16:19], s91 offen nt
    s_add_u32 s91, s54, 279552
    buffer_load_dwordx4 v[132:135], v6, s[16:19], s91 offen nt
    s_branch F_aj2
IW_w10:
    s_branch IW_r10
F_a2n:
    s_barrier
    s_cmp_lg_u32 s53, 0
    s_cbranch_scc1 SW_116
    s_call_b64 s[34:35], F_sw0
SW_116:
    s_branch IW_w11
IW_r11:
    s_barrier
    s_cmp_lg_u32 s53, 1
    s_cbranch_scc1 SW_117
    s_call_b64 s[34:35], F_sw0
SW_117:
    s_nop 0
    s_barrier
    s_cmp_lg_u32 s53, 2
    s_cbranch_scc1 SW_118
    s_call_b64 s[34:35], F_sw0
SW_118:
    s_nop 0
    s_barrier
    s_cmp_lg_u32 s53, 3
    s_cbranch_scc1 SW_119
    s_call_b64 s[34:35], F_sw0
SW_119:
    s_nop 0
    s_barrier
    s_nop 0
    s_barrier
    s_nop 0
    s_barrier
    s_add_u32 s91, s54, 229376
    buffer_load_dwordx4 v[104:107], v6, s[16:19], s91 offen nt
    s_add_u32 s91, s54, 236544
    buffer_load_dwordx4 v[108:111], v6, s[16:19], s91 offen nt
    s_add_u32 s91, s54, 243712
    buffer_load_dwordx4 v[112:115], v6, s[16:19], s91 offen nt
    s_add_u32 s91, s54, 250880
    buffer_load_dwordx4 v[116:119], v6, s[16:19], s91 offen nt
    s_nop 0
    s_load_dwordx8 s[60:67], s[56:57], 128 glc
    s_barrier
    s_add_u32 s91, s54, 258048
    buffer_load_dwordx4 v[120:123], v6, s[16:19], s91 offen nt
    s_add_u32 s91, s54, 265216
    buffer_load_dwordx4 v[124:127], v6, s[16:19], s91 offen nt
    s_add_u32 s91, s54, 272384
    buffer_load_dwordx4 v[128:131], v6, s[16:19], s91 offen nt
    s_add_u32 s91, s54, 279552
    buffer_load_dwordx4 v[132:135], v6, s[16:19], s91 offen nt
    s_waitcnt lgkmcnt(0)
    s_and_b64 s[44:45], s[60:61], s[62:63]
    s_and_b64 s[44:45], s[44:45], s[64:65]
    s_and_b64 s[44:45], s[44:45], s[66:67]
    s_and_b32 s44, s44, s45
    s_bitcmp1_b32 s44, 15
    s_cbranch_scc0 F_a2q
    s_andn2_b32 s60, s60, 0x8000
    v_writelane_b32 v12, s60, 0
    s_andn2_b32 s61, s61, 0x8000
    v_writelane_b32 v12, s61, 1
    s_andn2_b32 s62, s62, 0x8000
    v_writelane_b32 v12, s62, 2
    s_andn2_b32 s63, s63, 0x8000
    v_writelane_b32 v12, s63, 3
    s_andn2_b32 s64, s64, 0x8000
    v_writelane_b32 v12, s64, 4
    s_andn2_b32 s65, s65, 0x8000
    v_writelane_b32 v12, s65, 5
    s_andn2_b32 s66, s66, 0x8000
    v_writelane_b32 v12, s66, 6
    s_andn2_b32 s67, s67, 0x8000
    v_writelane_b32 v12, s67, 7
    v_add_u32 v4, 158976, v3
    s_mov_b64 exec, 0xff
    ds_write_b32 v4, v12
    s_mov_b64 exec, -1
    v_mov_b32 v4, 1
    s_mov_b64 exec, 1
    ds_write_b32 v10, v4 offset:48
    s_mov_b64 exec, -1
    s_waitcnt lgkmcnt(0)
    s_mov_b32 s88, 1
F_a2q:
    s_barrier
F_aj:
    s_mov_b32 s74, 0
F_aj2:
    v_and_b32 v13, 3, v0
    v_lshlrev_b32 v13, 2, v13
    v_add_u32 v13, 159040, v13

    s_cmp_lt_u32 s3, 2
    s_mov_b32 s75, 65536
    s_cselect_b32 s75, 32768, s75
    s_and_b32 s44, s3, 1
    s_lshl_b32 s44, s44, 12
    s_add_u32 s75, s75, s44
    s_add_u32 s12, s72, 0x900000
    s_addc_u32 s13, s73, 0
    s_mov_b32 s14, 0xe0000
    s_mov_b32 s15, 0x00020000
    s_mov_b32 s47, s10
    v_mov_b32 v4, 159096
    ds_read_b32 v9, v4
    s_waitcnt lgkmcnt(0)
    v_readfirstlane_b32 s79, v9
    s_nop 0
    s_cmp_eq_u32 s79, 0
    s_cbranch_scc1 F_xe
    v_and_b32 v4, 7, v0
    v_lshlrev_b32 v4, 2, v4
    v_add_u32 v4, 158976, v4
    ds_read_b32 v4, v4
    s_waitcnt lgkmcnt(0)
    v_and_b32 v4, 0x7ff, v4
    v_sub_u32 v4, 2047, v4
    v_and_b32 v11, 7, v4
    v_lshrrev_b32 v9, 3, v4
    v_lshlrev_b32 v9, 7, v9
    v_lshl_add_u32 v9, v11, 3, v9
    v_lshlrev_b32 v4, 11, v4
    v_lshl_add_u32 v4, v5, 4, v4
    buffer_load_dwordx4 v[64:67], v4, s[20:23], s55 offen
    buffer_load_dwordx4 v[68:71], v4, s[20:23], s55 offen offset:64
    buffer_load_dwordx2 v[14:15], v9, s[40:43], 0 offen sc0 sc1

F_xe:
    s_cmp_lg_u32 s74, 0
    s_cbranch_scc1 JB_120
    s_barrier
JB_120:
    s_cmp_lg_u32 s88, 3
    s_cbranch_scc1 F_g4
SP_121:
    s_load_dword s76, s[56:57], 0 glc
    s_waitcnt lgkmcnt(0)
    s_cmp_ge_u32 s76, 1000
    s_cbranch_scc1 SD_122
    s_sleep 3
    s_branch SP_121
SD_122:
    v_mov_b32 v4, 1
    s_mov_b64 exec, 1
    ds_write_b32 v10, v4 offset:48
    s_mov_b64 exec, -1
F_g4:
    s_setprio 1
    s_cmp_lg_u32 s79, 0
    s_cbranch_scc1 F_xd
    s_cmp_lg_u32 s88, 2
    s_cbranch_scc1 F_se
F_sc:
    s_load_dwordx8 s[60:67], s[56:57], 128 glc
    s_waitcnt lgkmcnt(0)
    s_and_b64 s[44:45], s[60:61], s[62:63]
    s_and_b64 s[44:45], s[44:45], s[64:65]
    s_and_b64 s[44:45], s[44:45], s[66:67]
    s_and_b32 s44, s44, s45
    s_bitcmp1_b32 s44, 15
    s_cbranch_scc1 F_sd
    s_sleep 4
    s_branch F_sc
F_sd:
    s_andn2_b32 s60, s60, 0x8000
    v_writelane_b32 v12, s60, 0
    s_andn2_b32 s61, s61, 0x8000
    v_writelane_b32 v12, s61, 1
    s_andn2_b32 s62, s62, 0x8000
    v_writelane_b32 v12, s62, 2
    s_andn2_b32 s63, s63, 0x8000
    v_writelane_b32 v12, s63, 3
    s_andn2_b32 s64, s64, 0x8000
    v_writelane_b32 v12, s64, 4
    s_andn2_b32 s65, s65, 0x8000
    v_writelane_b32 v12, s65, 5
    s_andn2_b32 s66, s66, 0x8000
    v_writelane_b32 v12, s66, 6
    s_andn2_b32 s67, s67, 0x8000
    v_writelane_b32 v12, s67, 7
    v_add_u32 v4, 158976, v3
    s_mov_b64 exec, 0xff
    ds_write_b32 v4, v12
    s_mov_b64 exec, -1
    v_mov_b32 v4, 1
    s_mov_b64 exec, 1
    ds_write_b32 v10, v4 offset:48
    s_mov_b64 exec, -1
F_se:
    v_mov_b32 v4, 159096
    ds_read_b32 v9, v4 offset:0
FW_123:
    s_waitcnt lgkmcnt(0)
    v_cmp_gt_u32 vcc, 1, v9
    s_cbranch_vccz FO_124
    s_sleep 1
    ds_read_b32 v9, v4 offset:0
    s_branch FW_123
FO_124:
    v_and_b32 v4, 7, v0
    v_lshlrev_b32 v4, 2, v4
    v_add_u32 v4, 158976, v4
    ds_read_b32 v4, v4
    s_waitcnt lgkmcnt(0)
    v_and_b32 v4, 0x7ff, v4
    v_sub_u32 v4, 2047, v4
    v_and_b32 v11, 7, v4
    v_lshrrev_b32 v9, 3, v4
    v_lshlrev_b32 v9, 7, v9
    v_lshl_add_u32 v9, v11, 3, v9
    v_lshlrev_b32 v4, 11, v4
    v_lshl_add_u32 v4, v5, 4, v4
    buffer_load_dwordx4 v[64:67], v4, s[20:23], s55 offen
    buffer_load_dwordx4 v[68:71], v4, s[20:23], s55 offen offset:64
    buffer_load_dwordx2 v[14:15], v9, s[40:43], 0 offen sc0 sc1

F_xd:
    s_mov_b32 s52, 0x05040100
    s_mov_b32 s53, 0x07060302
    s_setprio 1
    s_cmp_ge_u32 s89, 224
    s_cbranch_scc1 F_adown
    s_waitcnt vmcnt(0)
    v_lshlrev_b32 v34, 16, v64
    v_and_b32 v35, 0xffff0000, v64
    v_lshlrev_b32 v36, 16, v65
    v_and_b32 v37, 0xffff0000, v65
    v_lshlrev_b32 v38, 16, v66
    v_and_b32 v39, 0xffff0000, v66
    v_lshlrev_b32 v40, 16, v67
    v_and_b32 v41, 0xffff0000, v67
    v_lshlrev_b32 v42, 16, v68
    v_and_b32 v43, 0xffff0000, v68
    v_lshlrev_b32 v44, 16, v69
    v_and_b32 v45, 0xffff0000, v69
    v_lshlrev_b32 v46, 16, v70
    v_and_b32 v47, 0xffff0000, v70
    v_lshlrev_b32 v48, 16, v71
    v_and_b32 v49, 0xffff0000, v71
    v_add_f32 v34, v34, v14
    v_add_f32 v35, v35, v14
    v_add_f32 v36, v36, v14
    v_add_f32 v37, v37, v14
    v_add_f32 v38, v38, v14
    v_add_f32 v39, v39, v14
    v_add_f32 v40, v40, v14
    v_add_f32 v41, v41, v14
    v_add_f32 v42, v42, v14
    v_add_f32 v43, v43, v14
    v_add_f32 v44, v44, v14
    v_add_f32 v45, v45, v14
    v_add_f32 v46, v46, v14
    v_add_f32 v47, v47, v14
    v_add_f32 v48, v48, v14
    v_add_f32 v49, v49, v14
    v_cvt_pk_bf16_f32 v64, v34, v35
    v_cvt_pk_bf16_f32 v65, v36, v37
    v_cvt_pk_bf16_f32 v66, v38, v39
    v_cvt_pk_bf16_f32 v67, v40, v41
    v_cvt_pk_bf16_f32 v68, v42, v43
    v_cvt_pk_bf16_f32 v69, v44, v45
    v_cvt_pk_bf16_f32 v70, v46, v47
    v_cvt_pk_bf16_f32 v71, v48, v49
    v_lshlrev_b32 v34, 16, v64
    v_and_b32 v35, 0xffff0000, v64
    v_lshlrev_b32 v36, 16, v65
    v_and_b32 v37, 0xffff0000, v65
    v_lshlrev_b32 v38, 16, v66
    v_and_b32 v39, 0xffff0000, v66
    v_lshlrev_b32 v40, 16, v67
    v_and_b32 v41, 0xffff0000, v67
    v_lshlrev_b32 v42, 16, v68
    v_and_b32 v43, 0xffff0000, v68
    v_lshlrev_b32 v44, 16, v69
    v_and_b32 v45, 0xffff0000, v69
    v_lshlrev_b32 v46, 16, v70
    v_and_b32 v47, 0xffff0000, v70
    v_lshlrev_b32 v48, 16, v71
    v_and_b32 v49, 0xffff0000, v71
    v_mul_f32 v34, v34, v15
    v_mul_f32 v35, v35, v15
    v_mul_f32 v36, v36, v15
    v_mul_f32 v37, v37, v15
    v_mul_f32 v38, v38, v15
    v_mul_f32 v39, v39, v15
    v_mul_f32 v40, v40, v15
    v_mul_f32 v41, v41, v15
    v_mul_f32 v42, v42, v15
    v_mul_f32 v43, v43, v15
    v_mul_f32 v44, v44, v15
    v_mul_f32 v45, v45, v15
    v_mul_f32 v46, v46, v15
    v_mul_f32 v47, v47, v15
    v_mul_f32 v48, v48, v15
    v_mul_f32 v49, v49, v15
    v_cvt_pk_bf16_f32 v64, v34, v35
    v_cvt_pk_bf16_f32 v65, v36, v37
    v_cvt_pk_bf16_f32 v66, v38, v39
    v_cvt_pk_bf16_f32 v67, v40, v41
    v_cvt_pk_bf16_f32 v68, v42, v43
    v_cvt_pk_bf16_f32 v69, v44, v45
    v_cvt_pk_bf16_f32 v70, v46, v47
    v_cvt_pk_bf16_f32 v71, v48, v49
    s_waitcnt vmcnt(0)
    v_perm_b32 v136, v76, v72, s52
    v_perm_b32 v137, v84, v80, s52
    v_perm_b32 v138, v92, v88, s52
    v_perm_b32 v139, v100, v96, s52
    s_nop 1
    v_mfma_f32_16x16x32_bf16 v[32:35], v[64:67], v[136:139], 0
    v_perm_b32 v140, v76, v72, s53
    v_perm_b32 v141, v84, v80, s53
    v_perm_b32 v142, v92, v88, s53
    v_perm_b32 v143, v100, v96, s53
    s_nop 1
    v_mfma_f32_16x16x32_bf16 v[36:39], v[64:67], v[140:143], 0
    v_perm_b32 v136, v77, v73, s52
    v_perm_b32 v137, v85, v81, s52
    v_perm_b32 v138, v93, v89, s52
    v_perm_b32 v139, v101, v97, s52
    s_nop 1
    v_mfma_f32_16x16x32_bf16 v[40:43], v[64:67], v[136:139], 0
    v_perm_b32 v140, v77, v73, s53
    v_perm_b32 v141, v85, v81, s53
    v_perm_b32 v142, v93, v89, s53
    v_perm_b32 v143, v101, v97, s53
    s_nop 1
    v_mfma_f32_16x16x32_bf16 v[44:47], v[64:67], v[140:143], 0
    v_perm_b32 v136, v78, v74, s52
    v_perm_b32 v137, v86, v82, s52
    v_perm_b32 v138, v94, v90, s52
    v_perm_b32 v139, v102, v98, s52
    s_nop 1
    v_mfma_f32_16x16x32_bf16 v[48:51], v[64:67], v[136:139], 0
    v_perm_b32 v140, v78, v74, s53
    v_perm_b32 v141, v86, v82, s53
    v_perm_b32 v142, v94, v90, s53
    v_perm_b32 v143, v102, v98, s53
    s_nop 1
    v_mfma_f32_16x16x32_bf16 v[52:55], v[64:67], v[140:143], 0
    v_perm_b32 v136, v79, v75, s52
    v_perm_b32 v137, v87, v83, s52
    v_perm_b32 v138, v95, v91, s52
    v_perm_b32 v139, v103, v99, s52
    s_nop 1
    v_mfma_f32_16x16x32_bf16 v[56:59], v[64:67], v[136:139], 0
    v_perm_b32 v140, v79, v75, s53
    v_perm_b32 v141, v87, v83, s53
    v_perm_b32 v142, v95, v91, s53
    v_perm_b32 v143, v103, v99, s53
    s_nop 1
    v_mfma_f32_16x16x32_bf16 v[60:63], v[64:67], v[140:143], 0
    s_waitcnt vmcnt(0)
    v_perm_b32 v136, v108, v104, s52
    v_perm_b32 v137, v116, v112, s52
    v_perm_b32 v138, v124, v120, s52
    v_perm_b32 v139, v132, v128, s52
    s_nop 1
    v_mfma_f32_16x16x32_bf16 v[32:35], v[68:71], v[136:139], v[32:35]
    v_perm_b32 v140, v108, v104, s53
    v_perm_b32 v141, v116, v112, s53
    v_perm_b32 v142, v124, v120, s53
    v_perm_b32 v143, v132, v128, s53
    s_nop 1
    v_mfma_f32_16x16x32_bf16 v[36:39], v[68:71], v[140:143], v[36:39]
    v_perm_b32 v136, v109, v105, s52
    v_perm_b32 v137, v117, v113, s52
    v_perm_b32 v138, v125, v121, s52
    v_perm_b32 v139, v133, v129, s52
    s_nop 1
    v_mfma_f32_16x16x32_bf16 v[40:43], v[68:71], v[136:139], v[40:43]
    v_perm_b32 v140, v109, v105, s53
    v_perm_b32 v141, v117, v113, s53
    v_perm_b32 v142, v125, v121, s53
    v_perm_b32 v143, v133, v129, s53
    s_nop 1
    v_mfma_f32_16x16x32_bf16 v[44:47], v[68:71], v[140:143], v[44:47]
    v_perm_b32 v136, v110, v106, s52
    v_perm_b32 v137, v118, v114, s52
    v_perm_b32 v138, v126, v122, s52
    v_perm_b32 v139, v134, v130, s52
    s_nop 1
    v_mfma_f32_16x16x32_bf16 v[48:51], v[68:71], v[136:139], v[48:51]
    v_perm_b32 v140, v110, v106, s53
    v_perm_b32 v141, v118, v114, s53
    v_perm_b32 v142, v126, v122, s53
    v_perm_b32 v143, v134, v130, s53
    s_nop 1
    v_mfma_f32_16x16x32_bf16 v[52:55], v[68:71], v[140:143], v[52:55]
    v_perm_b32 v136, v111, v107, s52
    v_perm_b32 v137, v119, v115, s52
    v_perm_b32 v138, v127, v123, s52
    v_perm_b32 v139, v135, v131, s52
    s_nop 1
    v_mfma_f32_16x16x32_bf16 v[56:59], v[68:71], v[136:139], v[56:59]
    v_perm_b32 v140, v111, v107, s53
    v_perm_b32 v141, v119, v115, s53
    v_perm_b32 v142, v127, v123, s53
    v_perm_b32 v143, v135, v131, s53
    s_nop 1
    v_mfma_f32_16x16x32_bf16 v[60:63], v[68:71], v[140:143], v[60:63]
    s_setprio 3
    s_and_b32 s44, s3, 1
    s_lshl_b32 s44, s44, 12
    s_add_u32 s44, s44, 65536
    v_xor_b32 v4, v7, v5
    v_lshlrev_b32 v4, 4, v4
    v_lshl_add_u32 v4, v5, 8, v4
    v_add_u32 v72, s44, v4
    v_add_u32 v8, 8, v10

    v_xor_b32 v73, 32, v72
    v_xor_b32 v74, 64, v72
    v_xor_b32 v75, 96, v72
    v_xor_b32 v76, 128, v72
    v_xor_b32 v77, 160, v72
    v_xor_b32 v78, 192, v72
    v_xor_b32 v79, 224, v72
    ds_read_b32 v12, v13 offset:32
FW_125:
    s_waitcnt lgkmcnt(0)
    v_cmp_gt_u32 vcc, 2, v12
    s_cbranch_vccz FO_126
    s_sleep 1
    ds_read_b32 v12, v13 offset:32
    s_branch FW_125
FO_126:
    s_add_u32 s45, s78, 0
    buffer_load_dwordx4 v[16:19], v160, s[80:83], s45 offen nt
    s_add_u32 s45, s78, 2048
    buffer_load_dwordx4 v[20:23], v160, s[80:83], s45 offen nt
    s_add_u32 s45, s78, 4096
    buffer_load_dwordx4 v[24:27], v160, s[80:83], s45 offen nt
    s_add_u32 s45, s78, 6144
    buffer_load_dwordx4 v[28:31], v160, s[80:83], s45 offen nt
    s_add_u32 s45, s78, 8192
    buffer_load_dwordx4 v[144:147], v160, s[80:83], s45 offen nt
    s_add_u32 s45, s78, 10240
    buffer_load_dwordx4 v[148:151], v160, s[80:83], s45 offen nt
    s_add_u32 s45, s78, 12288
    buffer_load_dwordx4 v[152:155], v160, s[80:83], s45 offen nt
    s_cmp_lt_u32 s3, 2
    s_cbranch_scc1 F_t1
    ds_read_b32 v12, v13 offset:32
FW_127:
    s_waitcnt lgkmcnt(0)
    v_cmp_gt_u32 vcc, 2, v12
    s_cbranch_vccz FO_128
    s_sleep 1
    ds_read_b32 v12, v13 offset:32
    s_branch FW_127
FO_128:
    s_branch F_t2
F_t1:
    ds_read_b32 v12, v8 offset:64
FW_129:
    s_waitcnt lgkmcnt(0)
    v_cmp_gt_u32 vcc, 1, v12
    s_cbranch_vccz FO_130
    s_sleep 1
    ds_read_b32 v12, v8 offset:64
    s_branch FW_129
FO_130:
    ds_read_b128 v[80:83], v72 offset:0
    ds_read_b128 v[84:87], v73 offset:512
    ds_read_b128 v[88:91], v74 offset:1024
    ds_read_b128 v[92:95], v75 offset:1536
    ds_read_b128 v[96:99], v76 offset:2048
    ds_read_b128 v[100:103], v77 offset:2560
    ds_read_b128 v[104:107], v78 offset:3072
    ds_read_b128 v[108:111], v79 offset:3584
    s_waitcnt lgkmcnt(7)
    v_add_f32 v32, v32, v80
    v_add_f32 v33, v33, v81
    v_add_f32 v34, v34, v82
    v_add_f32 v35, v35, v83
    s_waitcnt lgkmcnt(6)
    v_add_f32 v36, v36, v84
    v_add_f32 v37, v37, v85
    v_add_f32 v38, v38, v86
    v_add_f32 v39, v39, v87
    s_waitcnt lgkmcnt(5)
    v_add_f32 v40, v40, v88
    v_add_f32 v41, v41, v89
    v_add_f32 v42, v42, v90
    v_add_f32 v43, v43, v91
    s_waitcnt lgkmcnt(4)
    v_add_f32 v44, v44, v92
    v_add_f32 v45, v45, v93
    v_add_f32 v46, v46, v94
    v_add_f32 v47, v47, v95
    s_waitcnt lgkmcnt(3)
    v_add_f32 v48, v48, v96
    v_add_f32 v49, v49, v97
    v_add_f32 v50, v50, v98
    v_add_f32 v51, v51, v99
    s_waitcnt lgkmcnt(2)
    v_add_f32 v52, v52, v100
    v_add_f32 v53, v53, v101
    v_add_f32 v54, v54, v102
    v_add_f32 v55, v55, v103
    s_waitcnt lgkmcnt(1)
    v_add_f32 v56, v56, v104
    v_add_f32 v57, v57, v105
    v_add_f32 v58, v58, v106
    v_add_f32 v59, v59, v107
    s_waitcnt lgkmcnt(0)
    v_add_f32 v60, v60, v108
    v_add_f32 v61, v61, v109
    v_add_f32 v62, v62, v110
    v_add_f32 v63, v63, v111
F_t2:
    s_mov_b32 exec_hi, 0
    ds_write_b128 v72, v[32:35] offset:0
    ds_write_b128 v73, v[36:39] offset:512
    ds_write_b128 v74, v[40:43] offset:1024
    ds_write_b128 v75, v[44:47] offset:1536
    ds_write_b128 v76, v[48:51] offset:2048
    ds_write_b128 v77, v[52:55] offset:2560
    ds_write_b128 v78, v[56:59] offset:3072
    ds_write_b128 v79, v[60:63] offset:3584
    s_mov_b64 exec, -1
    v_mov_b32 v4, 1
    s_mov_b64 exec, 1
    ds_write_b32 v10, v4 offset:64
    s_mov_b64 exec, -1
    s_lshl_b32 s44, s3, 2
    v_add_u32 v4, s44, v5
    v_xor_b32 v4, v4, v7
    v_lshlrev_b32 v4, 4, v4
    v_lshl_add_u32 v4, v7, 8, v4
    s_branch IW_s11
IW_w11:
    s_branch IW_r11
IW_s11:
    v_add_u32 v4, 65536, v4
    s_lshl_b32 s44, s3, 10
    s_lshl_b32 s77, s36, 1
    s_add_u32 s77, s77, s37
    s_mul_i32 s77, s77, 114688
    s_lshl_b32 s46, s38, 12
    s_add_u32 s77, s77, s46
    s_add_u32 s77, s77, s44
    s_lshl_b32 s46, s38, 9
    v_mov_b32 v9, 159148
    v_mov_b32 v11, 1

    s_add_u32 s56, s46, 0x829000
    s_add_u32 s56, s72, s56
    s_addc_u32 s57, s73, 0
    ds_read_b32 v12, v13 offset:64
FW_131:
    s_waitcnt lgkmcnt(0)
    v_cmp_gt_u32 vcc, 1, v12
    s_cbranch_vccz FO_132
    ds_read_b32 v12, v13 offset:64
    s_branch FW_131
FO_132:
    ds_read_b128 v[72:75], v4
    ds_read_b128 v[76:79], v4 offset:4096
    s_waitcnt lgkmcnt(0)
    v_add_f32 v72, v72, v76
    v_add_f32 v73, v73, v77
    v_add_f32 v74, v74, v78
    v_add_f32 v75, v75, v79
    buffer_store_dwordx4 v[72:75], v2, s[12:15], s77 offen sc0 sc1
    v_mov_b32 v4, 2
    s_mov_b64 exec, 1
    ds_write_b32 v10, v4 offset:64
    s_mov_b64 exec, -1
    s_waitcnt vmcnt(0)
    s_mov_b64 exec, 1
    ds_add_rtn_u32 v9, v9, v11
    s_waitcnt lgkmcnt(0)
    v_readfirstlane_b32 s44, v9
    s_mov_b64 exec, -1
    s_cmp_lg_u32 s44, 3
    s_cbranch_scc1 F_ad2

    s_mov_b32 s74, 1
    s_atomic_add s74, s[56:57], 0x0
    s_atomic_add s74, s[56:57], 0x80
    s_atomic_add s74, s[56:57], 0x100
    s_atomic_add s74, s[56:57], 0x180
    s_branch F_ad2
F_adown:
    s_add_u32 s45, s78, 0
    buffer_load_dwordx4 v[16:19], v160, s[80:83], s45 offen nt
    s_add_u32 s45, s78, 2048
    buffer_load_dwordx4 v[20:23], v160, s[80:83], s45 offen nt
    s_add_u32 s45, s78, 4096
    buffer_load_dwordx4 v[24:27], v160, s[80:83], s45 offen nt
    s_add_u32 s45, s78, 6144
    buffer_load_dwordx4 v[28:31], v160, s[80:83], s45 offen nt
    s_add_u32 s45, s78, 8192
    buffer_load_dwordx4 v[144:147], v160, s[80:83], s45 offen nt
    s_add_u32 s45, s78, 10240
    buffer_load_dwordx4 v[148:151], v160, s[80:83], s45 offen nt
    s_add_u32 s45, s78, 12288
    buffer_load_dwordx4 v[152:155], v160, s[80:83], s45 offen nt
    v_mov_b32 v4, 2
    s_mov_b64 exec, 1
    ds_write_b32 v10, v4 offset:64
    s_mov_b64 exec, -1
F_ad2:
    s_setprio 3
    v_min_u32 v4, 55, v0
    v_lshlrev_b32 v4, 4, v4
    s_lshl_b32 s38, s47, 5
    s_and_b32 s46, s39, 3
    s_lshr_b32 s44, s47, 7
    s_lshl_b32 s44, s44, 2
    s_add_u32 s44, s44, s46
    s_lshl_b32 s44, s44, 7
    s_add_u32 s45, s47, 111
    s_lshr_b32 s45, s45, 7
    s_lshl_b32 s45, s45, 2
    s_add_u32 s45, s45, s46
    s_lshl_b32 s45, s45, 7
    s_waitcnt lgkmcnt(0)

    s_add_u32 s56, s44, 0x829000
    s_add_u32 s56, s72, s56
    s_addc_u32 s57, s73, 0
    s_add_u32 s58, s45, 0x829000
    s_add_u32 s58, s72, s58
    s_addc_u32 s59, s73, 0
    v_mov_b32 v156, 0
    v_mov_b32 v157, 0
    v_mov_b32 v158, 0
    v_mov_b32 v159, 0
    s_mov_b32 s48, 0xbfb8aa3b
    ds_read_b32 v12, v13 offset:0
FW_133:
    s_waitcnt lgkmcnt(0)
    v_cmp_gt_u32 vcc, 4, v12
    s_cbranch_vccz FO_134
    s_sleep 1
    ds_read_b32 v12, v13 offset:0
    s_branch FW_133
FO_134:
    ds_read_b32 v12, v13 offset:64
FW_135:
    s_waitcnt lgkmcnt(0)
    v_cmp_gt_u32 vcc, 2, v12
    s_cbranch_vccz FO_136
    s_sleep 1
    ds_read_b32 v12, v13 offset:64
    s_branch FW_135
FO_136:
    ds_read_b32 v12, v13 offset:32
FW_137:
    s_waitcnt lgkmcnt(0)
    v_cmp_gt_u32 vcc, 2, v12
    s_cbranch_vccz FO_138
    s_sleep 1
    ds_read_b32 v12, v13 offset:32
    s_branch FW_137
FO_138:
    s_mov_b32 s44, s75
    v_lshlrev_b32 v9, 3, v0
    v_add_u32 v9, s44, v9
    ds_write_b64 v9, v[156:157]
    v_lshrrev_b32 v11, 1, v0
    v_mul_u32_u24 v9, 37, v11
    v_lshrrev_b32 v9, 8, v9
    v_add_u32 v11, v11, v9
    v_lshlrev_b32 v11, 1, v11
    v_and_b32 v9, 1, v0
    v_lshl_add_u32 v11, v9, 8, v11
    v_add_u32 v11, s44, v11
    v_and_b32 v9, 7, v0
    v_lshlrev_b32 v9, 6, v9
    v_lshl_add_u32 v9, v5, 4, v9
    v_add_u32 v9, s44, v9

    s_cmp_lg_u32 s3, 0
    s_cbranch_scc1 F_pp
SP_139:
    s_load_dword s76, s[56:57], 0 glc
    s_waitcnt lgkmcnt(0)
    s_cmp_ge_u32 s76, 8
    s_cbranch_scc1 SD_140
    s_sleep 2
    s_branch SP_139
SD_140:
SP_141:
    s_load_dword s76, s[58:59], 0 glc
    s_waitcnt lgkmcnt(0)
    s_cmp_ge_u32 s76, 8
    s_cbranch_scc1 SD_142
    s_sleep 2
    s_branch SP_141
SD_142:
    v_mov_b32 v12, 3
    s_mov_b64 exec, 1
    ds_write_b32 v10, v12 offset:64
    s_mov_b64 exec, -1
F_pp:
    v_mov_b32 v8, 159104
    ds_read_b32 v12, v8 offset:0
FW_143:
    s_waitcnt lgkmcnt(0)
    v_cmp_gt_u32 vcc, 3, v12
    s_cbranch_vccz FO_144
    s_sleep 1
    ds_read_b32 v12, v8 offset:0
    s_branch FW_143
FO_144:
    s_add_u32 s45, s38, 0
    buffer_load_dwordx4 v[32:35], v4, s[12:15], s45 offen sc0 sc1
    s_add_u32 s45, s38, 114688
    buffer_load_dwordx4 v[36:39], v4, s[12:15], s45 offen sc0 sc1
    s_add_u32 s45, s38, 229376
    buffer_load_dwordx4 v[40:43], v4, s[12:15], s45 offen sc0 sc1
    s_add_u32 s45, s38, 344064
    buffer_load_dwordx4 v[44:47], v4, s[12:15], s45 offen sc0 sc1
    s_add_u32 s45, s38, 458752
    buffer_load_dwordx4 v[48:51], v4, s[12:15], s45 offen sc0 sc1
    s_add_u32 s45, s38, 573440
    buffer_load_dwordx4 v[52:55], v4, s[12:15], s45 offen sc0 sc1
    s_add_u32 s45, s38, 688128
    buffer_load_dwordx4 v[56:59], v4, s[12:15], s45 offen sc0 sc1
    s_add_u32 s45, s38, 802816
    buffer_load_dwordx4 v[60:63], v4, s[12:15], s45 offen sc0 sc1
    s_waitcnt vmcnt(0)
    v_add_f32 v32, v32, v40
    v_add_f32 v48, v48, v56
    v_add_f32 v33, v33, v41
    v_add_f32 v49, v49, v57
    v_add_f32 v34, v34, v42
    v_add_f32 v50, v50, v58
    v_add_f32 v35, v35, v43
    v_add_f32 v51, v51, v59
    v_add_f32 v32, v32, v48
    v_add_f32 v33, v33, v49
    v_add_f32 v34, v34, v50
    v_add_f32 v35, v35, v51
    v_add_f32 v36, v36, v44
    v_add_f32 v52, v52, v60
    v_add_f32 v37, v37, v45
    v_add_f32 v53, v53, v61
    v_add_f32 v38, v38, v46
    v_add_f32 v54, v54, v62
    v_add_f32 v39, v39, v47
    v_add_f32 v55, v55, v63
    v_add_f32 v36, v36, v52
    v_add_f32 v37, v37, v53
    v_add_f32 v38, v38, v54
    v_add_f32 v39, v39, v55
    v_cvt_pk_bf16_f32 v40, v32, v36
    v_cvt_pk_bf16_f32 v41, v33, v37
    v_cvt_pk_bf16_f32 v42, v34, v38
    v_cvt_pk_bf16_f32 v43, v35, v39
    v_lshlrev_b32 v32, 16, v40
    v_and_b32 v36, 0xffff0000, v40
    v_lshlrev_b32 v33, 16, v41
    v_and_b32 v37, 0xffff0000, v41
    v_lshlrev_b32 v34, 16, v42
    v_and_b32 v38, 0xffff0000, v42
    v_lshlrev_b32 v35, 16, v43
    v_and_b32 v39, 0xffff0000, v43
    v_mul_f32 v40, s48, v32
    v_mul_f32 v41, s48, v33
    v_mul_f32 v42, s48, v34
    v_mul_f32 v43, s48, v35
    v_exp_f32 v40, v40
    v_exp_f32 v41, v41
    v_exp_f32 v42, v42
    v_exp_f32 v43, v43
    v_add_f32 v40, 1.0, v40
    v_add_f32 v41, 1.0, v41
    v_add_f32 v42, 1.0, v42
    v_add_f32 v43, 1.0, v43
    v_rcp_f32 v40, v40
    v_rcp_f32 v41, v41
    v_rcp_f32 v42, v42
    v_rcp_f32 v43, v43
    v_mul_f32 v32, v32, v40
    v_mul_f32 v33, v33, v41
    v_mul_f32 v34, v34, v42
    v_mul_f32 v35, v35, v43
    v_cvt_pk_bf16_f32 v32, v32, v32
    v_cvt_pk_bf16_f32 v33, v33, v33
    v_cvt_pk_bf16_f32 v34, v34, v34
    v_cvt_pk_bf16_f32 v35, v35, v35
    v_lshlrev_b32 v32, 16, v32
    v_lshlrev_b32 v33, 16, v33
    v_lshlrev_b32 v34, 16, v34
    v_lshlrev_b32 v35, 16, v35
    v_mul_f32 v32, v32, v36
    v_mul_f32 v33, v33, v37
    v_mul_f32 v34, v34, v38
    v_mul_f32 v35, v35, v39
    v_cvt_pk_bf16_f32 v32, v32, v32
    v_cvt_pk_bf16_f32 v33, v33, v33
    v_cvt_pk_bf16_f32 v34, v34, v34
    v_cvt_pk_bf16_f32 v35, v35, v35
    v_cmp_gt_u32 vcc, 56, v0
    s_nop 0
    s_and_saveexec_b64 s[44:45], vcc
    ds_write_b16 v11, v32 offset:0
    ds_write_b16 v11, v33 offset:64
    ds_write_b16 v11, v34 offset:128
    ds_write_b16 v11, v35 offset:192
    s_mov_b64 exec, s[44:45]
    ds_read_b128 v[64:67], v9
    s_waitcnt lgkmcnt(0)
    v_perm_b32 v136, v20, v16, s52
    v_perm_b32 v137, v28, v24, s52
    v_perm_b32 v138, v148, v144, s52
    v_perm_b32 v139, v156, v152, s52
    s_nop 1
    v_mfma_f32_16x16x32_bf16 v[104:107], v[64:67], v[136:139], 0
    v_perm_b32 v140, v20, v16, s53
    v_perm_b32 v141, v28, v24, s53
    v_perm_b32 v142, v148, v144, s53
    v_perm_b32 v143, v156, v152, s53
    s_nop 1
    v_mfma_f32_16x16x32_bf16 v[108:111], v[64:67], v[140:143], 0
    v_perm_b32 v136, v21, v17, s52
    v_perm_b32 v137, v29, v25, s52
    v_perm_b32 v138, v149, v145, s52
    v_perm_b32 v139, v157, v153, s52
    s_nop 1
    v_mfma_f32_16x16x32_bf16 v[112:115], v[64:67], v[136:139], 0
    v_perm_b32 v140, v21, v17, s53
    v_perm_b32 v141, v29, v25, s53
    v_perm_b32 v142, v149, v145, s53
    v_perm_b32 v143, v157, v153, s53
    s_nop 1
    v_mfma_f32_16x16x32_bf16 v[116:119], v[64:67], v[140:143], 0
    v_perm_b32 v136, v22, v18, s52
    v_perm_b32 v137, v30, v26, s52
    v_perm_b32 v138, v150, v146, s52
    v_perm_b32 v139, v158, v154, s52
    s_nop 1
    v_mfma_f32_16x16x32_bf16 v[120:123], v[64:67], v[136:139], 0
    v_perm_b32 v140, v22, v18, s53
    v_perm_b32 v141, v30, v26, s53
    v_perm_b32 v142, v150, v146, s53
    v_perm_b32 v143, v158, v154, s53
    s_nop 1
    v_mfma_f32_16x16x32_bf16 v[124:127], v[64:67], v[140:143], 0
    v_perm_b32 v136, v23, v19, s52
    v_perm_b32 v137, v31, v27, s52
    v_perm_b32 v138, v151, v147, s52
    v_perm_b32 v139, v159, v155, s52
    s_nop 1
    v_mfma_f32_16x16x32_bf16 v[128:131], v[64:67], v[136:139], 0
    v_perm_b32 v140, v23, v19, s53
    v_perm_b32 v141, v31, v27, s53
    v_perm_b32 v142, v151, v147, s53
    v_perm_b32 v143, v159, v155, s53
    s_nop 1
    v_mfma_f32_16x16x32_bf16 v[132:135], v[64:67], v[140:143], 0
    s_mov_b32 s44, s75
    v_and_b32 v4, 1, v5
    v_lshlrev_b32 v4, 11, v4
    v_lshl_add_u32 v4, v7, 5, v4
    v_lshrrev_b32 v8, 1, v5
    v_lshl_add_u32 v4, v8, 4, v4
    v_add_u32 v4, s44, v4
    v_cmp_gt_u32 vcc, 32, v0

    s_nop 1
    v_cndmask_b32 v72, v120, v104, vcc
    v_cndmask_b32 v73, v124, v108, vcc
    v_cndmask_b32 v74, v128, v112, vcc
    v_cndmask_b32 v75, v132, v116, vcc
    ds_write_b128 v4, v[72:75] offset:0
    v_cndmask_b32 v76, v121, v105, vcc
    v_cndmask_b32 v77, v125, v109, vcc
    v_cndmask_b32 v78, v129, v113, vcc
    v_cndmask_b32 v79, v133, v117, vcc
    ds_write_b128 v4, v[76:79] offset:512
    v_cndmask_b32 v80, v122, v106, vcc
    v_cndmask_b32 v81, v126, v110, vcc
    v_cndmask_b32 v82, v130, v114, vcc
    v_cndmask_b32 v83, v134, v118, vcc
    ds_write_b128 v4, v[80:83] offset:1024
    v_cndmask_b32 v84, v123, v107, vcc
    v_cndmask_b32 v85, v127, v111, vcc
    v_cndmask_b32 v86, v131, v115, vcc
    v_cndmask_b32 v87, v135, v119, vcc
    ds_write_b128 v4, v[84:87] offset:1536
    v_mov_b32 v4, 1
    s_mov_b64 exec, 1
    ds_write_b32 v10, v4 offset:80
    s_mov_b64 exec, -1
    ds_read_b32 v12, v13 offset:80
FW_145:
    s_waitcnt lgkmcnt(0)
    v_cmp_gt_u32 vcc, 1, v12
    s_cbranch_vccz FO_146
    s_sleep 1
    ds_read_b32 v12, v13 offset:80
    s_branch FW_145
FO_146:
    s_lshl_b32 s44, s3, 10
    s_add_u32 s44, s44, 32768
    v_add_u32 v4, s44, v3
    ds_read_b32 v32, v4 offset:0
    ds_read_b32 v33, v4 offset:256
    ds_read_b32 v34, v4 offset:512
    ds_read_b32 v35, v4 offset:768
    ds_read_b32 v36, v4 offset:4096
    ds_read_b32 v37, v4 offset:4352
    ds_read_b32 v38, v4 offset:4608
    ds_read_b32 v39, v4 offset:4864
    ds_read_b32 v40, v4 offset:32768
    ds_read_b32 v41, v4 offset:33024
    ds_read_b32 v42, v4 offset:33280
    ds_read_b32 v43, v4 offset:33536
    ds_read_b32 v44, v4 offset:36864
    ds_read_b32 v45, v4 offset:37120
    ds_read_b32 v46, v4 offset:37376
    s_waitcnt lgkmcnt(8)
    ds_read_b32 v47, v4 offset:37632
    s_lshl_b32 s44, s3, 13
    s_lshl_b32 s45, s39, 9
    s_add_u32 s44, s44, s45
    s_add_u32 s44, s44, 135168
    s_add_u32 s45, s44, 4096
    s_lshl_b32 s46, s39, 9
    s_waitcnt lgkmcnt(0)

    s_add_u32 s56, s46, 0x845000
    s_add_u32 s56, s72, s56
    s_addc_u32 s57, s73, 0
    v_add_f32 v32, v32, v36
    v_add_f32 v40, v40, v44
    v_add_f32 v33, v33, v37
    v_add_f32 v41, v41, v45
    v_add_f32 v34, v34, v38
    v_add_f32 v42, v42, v46
    v_add_f32 v35, v35, v39
    v_add_f32 v43, v43, v47
    v_add_f32 v32, v32, v40
    buffer_atomic_add_f32 v32, v3, s[24:27], s44 offen offset:0
    v_add_f32 v33, v33, v41
    buffer_atomic_add_f32 v33, v3, s[24:27], s44 offen offset:256
    v_add_f32 v34, v34, v42
    buffer_atomic_add_f32 v34, v3, s[24:27], s45 offen offset:0
    v_add_f32 v35, v35, v43
    buffer_atomic_add_f32 v35, v3, s[24:27], s45 offen offset:256
    v_mov_b32 v4, 159140
    v_mov_b32 v8, 1
    s_waitcnt vmcnt(0)
    s_mov_b64 exec, 1
    ds_add_rtn_u32 v9, v4, v8
    s_waitcnt lgkmcnt(0)
    v_readfirstlane_b32 s44, v9
    s_mov_b64 exec, -1
    s_cmp_lg_u32 s44, 3
    s_cbranch_scc1 F_ye
    s_mov_b32 s44, 1
    s_atomic_add s44, s[56:57], 0
    s_atomic_add s44, s[56:57], 0x80
    s_atomic_add s44, s[56:57], 0x100
    s_atomic_add s44, s[56:57], 0x180
F_ye:

    s_endpgm
F_codeend:
.section .rodata,"a"
.p2align 6
.amdhsa_kernel parallel_sum__linear_attn_block__moe_arch_mod__prompt_kernel
  .amdhsa_next_free_vgpr 168
  .amdhsa_next_free_sgpr 98
  .amdhsa_accum_offset 168
  .amdhsa_group_segment_fixed_size 0
  .amdhsa_kernarg_size 88
  .amdhsa_user_sgpr_count 2
  .amdhsa_user_sgpr_kernarg_segment_ptr 1
  .amdhsa_system_sgpr_workgroup_id_x 1
  .amdhsa_float_denorm_mode_32 3
  .amdhsa_float_denorm_mode_16_64 3
.end_amdhsa_kernel
```

```asm
; @launch grid=(256,1,1) block=(768,1,1) lds=163840
.amdgcn_target "amdgcn-amd-amdhsa--gfx950"
.text
.globl parallel_sum__linear_attn_block__moe_arch_mod__prompt_kernel
.p2align 12
.p2align 8
.type parallel_sum__linear_attn_block__moe_arch_mod__prompt_kernel,@function
parallel_sum__linear_attn_block__moe_arch_mod__prompt_kernel:
    s_load_dwordx4 s[4:7], s[0:1], 0
    s_load_dwordx2 s[8:9], s[0:1], 16
    s_load_dwordx8 s[60:67], s[0:1], 32
    s_load_dwordx4 s[68:71], s[0:1], 64
    s_load_dwordx2 s[72:73], s[0:1], 80
    s_cmp_ge_u32 s2, 256
    s_cbranch_scc1 F_end
    v_lshrrev_b32 v1, 6, v0
    v_and_b32 v0, 63, v0
    s_and_b32 s30, s2, 7
    v_readfirstlane_b32 s3, v1
    s_lshr_b32 s31, s2, 3
    s_and_b32 s36, s30, 1
    s_lshl_b32 s32, s36, 3
    s_and_b32 s35, s31, 7
    s_add_u32 s32, s32, s35
    s_lshr_b32 s37, s30, 1
    s_lshl_b32 s33, s37, 2
    s_lshr_b32 s34, s31, 3
    s_add_u32 s33, s33, s34
    s_add_u32 s10, s33, 0
    s_and_b32 s10, s10, 15
    s_add_u32 s11, s35, s34
    s_and_b32 s11, s11, 3
    s_and_b32 s28, s32, 11
    s_and_b32 s29, s37, 1
    s_lshl_b32 s29, s29, 2
    s_add_u32 s28, s28, s29
    s_lshr_b32 s29, s37, 1
    s_lshl_b32 s29, s29, 3
    s_and_b32 s38, s35, 4
    s_add_u32 s29, s29, s38
    s_add_u32 s38, s34, 1
    s_and_b32 s38, s38, 3
    s_add_u32 s29, s29, s38

    s_lshl_b32 s11, s34, 1
    s_add_u32 s11, s11, s35
    s_and_b32 s11, s11, 7
    s_mul_i32 s89, s36, 8
    s_mul_i32 s38, s37, 2
    s_add_u32 s89, s89, s38

    s_mov_b32 s94, 0x73156420
    s_mov_b32 s95, 0xfb9dea8c
    s_cmp_eq_u32 s11, 1
    s_cselect_b32 s94, 0x62047531, s94
    s_cselect_b32 s95, 0xea8cfb9d, s95
    s_cmp_eq_u32 s11, 2
    s_cselect_b32 s94, 0x53710642, s94
    s_cselect_b32 s95, 0xdbf9cae8, s95
    s_cmp_eq_u32 s11, 3
    s_cselect_b32 s94, 0x42601753, s94
    s_cselect_b32 s95, 0xcae8dbf9, s95
    s_cmp_eq_u32 s11, 4
    s_cselect_b32 s94, 0x58320164, s94
    s_cselect_b32 s95, 0xfdbec9a7, s95
    s_cmp_eq_u32 s11, 5
    s_cselect_b32 s94, 0x49231075, s94
    s_cselect_b32 s95, 0xecafd8b6, s95
    s_cmp_eq_u32 s11, 6
    s_cselect_b32 s94, 0xa5143206, s94
    s_cselect_b32 s95, 0xfd9ebc87, s95
    s_cmp_eq_u32 s11, 7
    s_cselect_b32 s94, 0xb4052317, s94
    s_cselect_b32 s95, 0xec8fad96, s95
    s_cmp_ge_u32 s3, 8
    s_cbranch_scc1 F_aux
    s_cmp_ge_u32 s3, 4
    s_cbranch_scc1 F_nl
    v_lshrrev_b32 v2, 3, v0
    v_and_b32 v3, 7, v0
    v_lshrrev_b32 v4, 1, v2
    v_xor_b32 v5, v3, v4
    v_xor_b32 v6, 4, v5
    v_lshlrev_b32 v5, 4, v5
    v_lshlrev_b32 v6, 4, v6
    v_lshlrev_b32 v7, 11, v2
    v_add_u32 v5, v5, v7
    v_add_u32 v6, v6, v7
    v_and_b32 v4, 1, v4
    v_lshlrev_b32 v4, 1, v4
    v_xor_b32 v8, v3, v4
    v_xor_b32 v9, 4, v8
    v_lshlrev_b32 v8, 4, v8
    v_lshlrev_b32 v9, 4, v9
    v_mul_u32_u24 v7, 6144, v2
    v_add_u32 v8, v8, v7
    v_add_u32 v9, v9, v7
    v_add_u32 v9, 49152, v9
    s_lshl_b32 s36, s32, 18
    s_lshl_b32 s37, s3, 16
    s_add_u32 s36, s36, s37
    s_lshl_b32 s38, s33, 7
    s_mul_i32 s37, s3, 98304
    s_add_u32 s38, s38, s37
    s_lshl_b32 s47, s10, 7
    s_add_u32 s47, s47, s37
    s_lshl_b32 s44, s3, 12
    s_lshl_b32 s45, s3, 11
    s_add_u32 s43, s45, 1024
    s_mov_b32 s14, 4194304
    s_mov_b32 s15, 0x20000
    s_mov_b32 s18, 6291456
    s_mov_b32 s19, 0x20000
    s_waitcnt lgkmcnt(0)
    s_mov_b32 s12, s4
    s_mov_b32 s13, s5
    s_mov_b32 s16, s6
    s_mov_b32 s17, s7

    s_setprio 3
    s_bfe_u32 s40, s94, 0x40000
    s_add_u32 s40, s89, s40
    s_and_b32 s40, s40, 15
    s_mul_i32 s41, s40, 393216
    s_lshl_b32 s40, s40, 7
    s_add_u32 s40, s40, s36
    s_add_u32 s42, s41, s47
    s_add_u32 s41, s41, s38
    s_add_u32 m0, s44, 0
    s_add_u32 s46, s40, 0
    buffer_load_dwordx4 v5, s[12:15], s46 offen lds
    s_add_u32 m0, s44, 1024
    s_add_u32 s46, s40, 16384
    buffer_load_dwordx4 v6, s[12:15], s46 offen lds
    s_add_u32 m0, s44, 2048
    s_add_u32 s46, s40, 32768
    buffer_load_dwordx4 v5, s[12:15], s46 offen lds
    s_add_u32 m0, s44, 3072
    s_add_u32 s46, s40, 49152
    buffer_load_dwordx4 v6, s[12:15], s46 offen lds
    s_add_u32 m0, s45, 65536
    s_add_u32 s46, s41, 2048
    buffer_load_dwordx4 v8, s[16:19], s46 offen lds
    s_add_u32 m0, s43, 65536
    s_add_u32 s46, s41, 2048
    buffer_load_dwordx4 v9, s[16:19], s46 offen lds
    s_add_u32 m0, s45, 73728
    s_add_u32 s46, s41, 4096
    buffer_load_dwordx4 v8, s[16:19], s46 offen lds
    s_add_u32 m0, s43, 73728
    s_add_u32 s46, s41, 4096
    buffer_load_dwordx4 v9, s[16:19], s46 offen lds
    s_add_u32 m0, s45, 147456
    s_nop 0
    buffer_load_dwordx4 v8, s[16:19], s42 offen lds
    s_add_u32 m0, s43, 147456
    s_nop 0
    buffer_load_dwordx4 v9, s[16:19], s42 offen lds
    s_bfe_u32 s40, s94, 0x40004
    s_add_u32 s40, s89, s40
    s_and_b32 s40, s40, 15
    s_mul_i32 s41, s40, 393216
    s_lshl_b32 s40, s40, 7
    s_add_u32 s40, s40, s36
    s_add_u32 s42, s41, s47
    s_add_u32 s41, s41, s38
    s_add_u32 m0, s44, 16384
    s_add_u32 s46, s40, 0
    buffer_load_dwordx4 v5, s[12:15], s46 offen lds
    s_add_u32 m0, s44, 17408
    s_add_u32 s46, s40, 16384
    buffer_load_dwordx4 v6, s[12:15], s46 offen lds
    s_add_u32 m0, s44, 18432
    s_add_u32 s46, s40, 32768
    buffer_load_dwordx4 v5, s[12:15], s46 offen lds
    s_add_u32 m0, s44, 19456
    s_add_u32 s46, s40, 49152
    buffer_load_dwordx4 v6, s[12:15], s46 offen lds
    s_add_u32 m0, s45, 81920
    s_add_u32 s46, s41, 2048
    buffer_load_dwordx4 v8, s[16:19], s46 offen lds
    s_add_u32 m0, s43, 81920
    s_add_u32 s46, s41, 2048
    buffer_load_dwordx4 v9, s[16:19], s46 offen lds
    v_and_b32 v1, 15, v0
    v_lshrrev_b32 v7, 4, v0
    v_lshrrev_b32 v3, 1, v1
    v_xor_b32 v3, v3, v7
    v_lshlrev_b32 v3, 4, v3
    v_lshlrev_b32 v1, 7, v1
    v_add3_u32 v2, v1, v3, s44
    v_xor_b32 v3, 64, v2
    v_add_u32 v14, 0x10000, v2
    v_add_u32 v15, 0x10000, v3
    v_bfe_u32 v1, v0, 2, 2
    v_lshl_add_u32 v4, v7, 3, v1
    v_lshrrev_b32 v1, 1, v1
    v_and_b32 v7, 1, v7
    v_lshl_add_u32 v1, v7, 1, v1
    v_lshlrev_b32 v1, 5, v1
    v_lshl_add_u32 v1, v4, 7, v1
    v_and_b32 v7, 3, v0
    v_lshl_add_u32 v1, v7, 3, v1
    v_add_u32 v10, 90112, v1
    v_xor_b32 v11, 32, v10
    v_xor_b32 v12, 64, v10
    v_xor_b32 v13, 96, v10
    v_lshlrev_b32 v1, 2, v7
    v_add_u32 v1, 159040, v1
    s_lshl_b32 s50, s3, 2
    s_add_u32 s50, s50, 159040
    v_mov_b32 v4, s50
    v_mov_b32 v164, 1

    s_waitcnt vmcnt(8)
    s_barrier
    s_add_u32 m0, s45, 90112
    s_add_u32 s46, s41, 4096
    buffer_load_dwordx4 v8, s[16:19], s46 offen lds
    ds_read_b128 v[48:51], v2 offset:0
    s_add_u32 m0, s43, 90112
    s_add_u32 s46, s41, 4096
    buffer_load_dwordx4 v9, s[16:19], s46 offen lds
    ds_read_b128 v[52:55], v2 offset:2048
    s_lshl_b32 s51, s32, 4
    s_add_u32 s51, s51, s33
    s_lshl_b32 s51, s51, 14
    s_add_u32 s51, s51, s45
    v_lshlrev_b32 v165, 4, v0
    s_mov_b32 s20, s60
    s_mov_b32 s21, s61
    s_mov_b32 s22, 0x800
    s_mov_b32 s23, 0x00020000
    s_add_u32 m0, s45, 98304
    s_add_u32 s46, s51, 0
    buffer_load_dwordx4 v165, s[12:15], s46 offen lds
    ds_read_b128 v[56:59], v3 offset:0
    s_add_u32 m0, s45, 99328
    s_add_u32 s46, s51, 1024
    buffer_load_dwordx4 v165, s[12:15], s46 offen lds
    ds_read_b128 v[60:63], v3 offset:2048
    s_and_b32 s46, s3, 1
    s_lshl_b32 s46, s46, 10
    s_add_u32 m0, s46, 161792
    s_nop 0
    buffer_load_dwordx4 v165, s[20:23], s46 offen lds
    s_add_u32 m0, s45, 106496
    s_add_u32 s46, s51, 8192
    buffer_load_dwordx4 v165, s[12:15], s46 offen lds
    s_add_u32 m0, s45, 107520
    s_add_u32 s46, s51, 9216
    buffer_load_dwordx4 v165, s[12:15], s46 offen lds
    s_bfe_u32 s40, s94, 0x40008
    s_add_u32 s40, s89, s40
    s_and_b32 s40, s40, 15
    s_mul_i32 s41, s40, 393216
    s_lshl_b32 s40, s40, 7
    s_add_u32 s40, s40, s36
    s_add_u32 s42, s41, s47
    s_add_u32 s41, s41, s38
    s_add_u32 m0, s44, 32768
    s_add_u32 s46, s40, 0
    buffer_load_dwordx4 v5, s[12:15], s46 offen lds
    s_add_u32 m0, s44, 33792
    s_add_u32 s46, s40, 16384
    buffer_load_dwordx4 v6, s[12:15], s46 offen lds
    s_add_u32 m0, s44, 34816
    s_add_u32 s46, s40, 32768
    buffer_load_dwordx4 v5, s[12:15], s46 offen lds
    s_add_u32 m0, s44, 35840
    s_add_u32 s46, s40, 49152
    buffer_load_dwordx4 v6, s[12:15], s46 offen lds
    s_waitcnt vmcnt(9) lgkmcnt(0)
    s_barrier
    s_add_u32 m0, s45, 114688
    s_add_u32 s46, s41, 2048
    buffer_load_dwordx4 v8, s[16:19], s46 offen lds
    ds_read_b64_tr_b16 v[64:65], v10 offset:57344
    ds_read_b64_tr_b16 v[66:67], v10 offset:57856
    s_add_u32 m0, s43, 114688
    s_add_u32 s46, s41, 2048
    buffer_load_dwordx4 v9, s[16:19], s46 offen lds
    ds_read_b128 v[68:71], v2 offset:16384
    s_add_u32 m0, s45, 122880
    s_add_u32 s46, s41, 4096
    buffer_load_dwordx4 v8, s[16:19], s46 offen lds
    ds_read_b64_tr_b16 v[72:73], v11 offset:57344
    ds_read_b64_tr_b16 v[74:75], v11 offset:57856
    s_add_u32 m0, s43, 122880
    s_add_u32 s46, s41, 4096
    buffer_load_dwordx4 v9, s[16:19], s46 offen lds
    ds_read_b128 v[76:79], v2 offset:18432
    s_bfe_u32 s40, s94, 0x40004
    s_add_u32 s40, s89, s40
    s_and_b32 s40, s40, 15
    s_mul_i32 s41, s40, 393216
    s_lshl_b32 s40, s40, 7
    s_add_u32 s40, s40, s36
    s_add_u32 s42, s41, s47
    s_add_u32 s41, s41, s38
    s_add_u32 m0, s45, 139264
    s_nop 0
    buffer_load_dwordx4 v8, s[16:19], s42 offen lds
    ds_read_b64_tr_b16 v[80:81], v12 offset:57344
    ds_read_b64_tr_b16 v[82:83], v12 offset:57856
    s_add_u32 m0, s43, 139264
    s_nop 0
    buffer_load_dwordx4 v9, s[16:19], s42 offen lds
    ds_read_b128 v[84:87], v3 offset:16384
    s_bfe_u32 s40, s94, 0x4000c
    s_add_u32 s40, s89, s40
    s_and_b32 s40, s40, 15
    s_mul_i32 s41, s40, 393216
    s_lshl_b32 s40, s40, 7
    s_add_u32 s40, s40, s36
    s_add_u32 s42, s41, s47
    s_add_u32 s41, s41, s38
    s_add_u32 m0, s44, 49152
    s_add_u32 s46, s40, 0
    buffer_load_dwordx4 v5, s[12:15], s46 offen lds
    ds_read_b64_tr_b16 v[88:89], v13 offset:57344
    ds_read_b64_tr_b16 v[90:91], v13 offset:57856
    s_add_u32 m0, s44, 50176
    s_add_u32 s46, s40, 16384
    buffer_load_dwordx4 v6, s[12:15], s46 offen lds
    ds_read_b128 v[92:95], v3 offset:18432
    s_add_u32 m0, s44, 51200
    s_add_u32 s46, s40, 32768
    buffer_load_dwordx4 v5, s[12:15], s46 offen lds
    s_add_u32 m0, s44, 52224
    s_add_u32 s46, s40, 49152
    buffer_load_dwordx4 v6, s[12:15], s46 offen lds
    s_add_u32 m0, s45, 131072
    s_add_u32 s46, s41, 2048
    buffer_load_dwordx4 v8, s[16:19], s46 offen lds
    s_waitcnt vmcnt(5) lgkmcnt(0)
    s_barrier
    s_add_u32 m0, s43, 131072
    s_add_u32 s46, s41, 2048
    buffer_load_dwordx4 v9, s[16:19], s46 offen lds
    v_mfma_f32_16x16x32_bf16 v[16:19], v[64:67], v[48:51], 0
    ds_read_b64_tr_b16 v[96:97], v10 offset:61440
    ds_read_b64_tr_b16 v[98:99], v10 offset:61952
    s_add_u32 m0, s45, 65536
    s_add_u32 s46, s41, 4096
    buffer_load_dwordx4 v8, s[16:19], s46 offen lds
    v_mfma_f32_16x16x32_bf16 v[32:35], v[64:67], v[52:55], 0
    ds_read_b128 v[100:103], v2 offset:32768
    s_add_u32 m0, s43, 65536
    s_add_u32 s46, s41, 4096
    buffer_load_dwordx4 v9, s[16:19], s46 offen lds
    v_mfma_f32_16x16x32_bf16 v[20:23], v[72:75], v[48:51], 0
    ds_read_b64_tr_b16 v[104:105], v11 offset:61440
    ds_read_b64_tr_b16 v[106:107], v11 offset:61952
    s_bfe_u32 s40, s94, 0x40008
    s_add_u32 s40, s89, s40
    s_and_b32 s40, s40, 15
    s_mul_i32 s41, s40, 393216
    s_lshl_b32 s40, s40, 7
    s_add_u32 s40, s40, s36
    s_add_u32 s42, s41, s47
    s_add_u32 s41, s41, s38
    s_add_u32 m0, s45, 90112
    s_nop 0
    buffer_load_dwordx4 v8, s[16:19], s42 offen lds
    v_mfma_f32_16x16x32_bf16 v[36:39], v[72:75], v[52:55], 0
    ds_read_b128 v[108:111], v2 offset:34816
    s_add_u32 m0, s43, 90112
    s_nop 0
    buffer_load_dwordx4 v9, s[16:19], s42 offen lds
    v_mfma_f32_16x16x32_bf16 v[24:27], v[80:83], v[48:51], 0
    ds_read_b64_tr_b16 v[112:113], v12 offset:61440
    ds_read_b64_tr_b16 v[114:115], v12 offset:61952
    s_bfe_u32 s40, s94, 0x40010
    s_add_u32 s40, s89, s40
    s_and_b32 s40, s40, 15
    s_mul_i32 s41, s40, 393216
    s_lshl_b32 s40, s40, 7
    s_add_u32 s40, s40, s36
    s_add_u32 s42, s41, s47
    s_add_u32 s41, s41, s38
    s_add_u32 m0, s44, 0
    s_add_u32 s46, s40, 0
    buffer_load_dwordx4 v5, s[12:15], s46 offen lds
    v_mfma_f32_16x16x32_bf16 v[40:43], v[80:83], v[52:55], 0
    ds_read_b128 v[116:119], v3 offset:32768
    s_add_u32 m0, s44, 1024
    s_add_u32 s46, s40, 16384
    buffer_load_dwordx4 v6, s[12:15], s46 offen lds
    v_mfma_f32_16x16x32_bf16 v[28:31], v[88:91], v[48:51], 0
    ds_read_b64_tr_b16 v[120:121], v13 offset:61440
    ds_read_b64_tr_b16 v[122:123], v13 offset:61952
    s_add_u32 m0, s44, 2048
    s_add_u32 s46, s40, 32768
    buffer_load_dwordx4 v5, s[12:15], s46 offen lds
    v_mfma_f32_16x16x32_bf16 v[44:47], v[88:91], v[52:55], 0
    ds_read_b128 v[124:127], v3 offset:34816
    s_add_u32 m0, s44, 3072
    s_add_u32 s46, s40, 49152
    buffer_load_dwordx4 v6, s[12:15], s46 offen lds
    ds_read_b64_tr_b16 v[128:129], v10 offset:49152
    ds_read_b64_tr_b16 v[130:131], v10 offset:49664
    s_add_u32 m0, s45, 73728
    s_add_u32 s46, s41, 2048
    buffer_load_dwordx4 v8, s[16:19], s46 offen lds
    ds_read_b64_tr_b16 v[132:133], v11 offset:49152
    s_waitcnt lgkmcnt(8)
    ds_read_b64_tr_b16 v[134:135], v11 offset:49664
    s_add_u32 m0, s43, 73728
    s_add_u32 s46, s41, 2048
    buffer_load_dwordx4 v9, s[16:19], s46 offen lds
    ds_read_b64_tr_b16 v[136:137], v12 offset:49152
    ds_read_b64_tr_b16 v[138:139], v12 offset:49664
    ds_read_b64_tr_b16 v[140:141], v13 offset:49152
    ds_read_b64_tr_b16 v[142:143], v13 offset:49664
    s_waitcnt vmcnt(6) lgkmcnt(0)
    s_barrier
    s_add_u32 m0, s45, 81920
    s_add_u32 s46, s41, 4096
    buffer_load_dwordx4 v8, s[16:19], s46 offen lds
    v_mfma_f32_16x16x32_bf16 v[16:19], v[96:99], v[56:59], v[16:19]
    ds_read_b64_tr_b16 v[144:145], v10 offset:53248
    ds_read_b64_tr_b16 v[146:147], v10 offset:53760
    s_add_u32 m0, s43, 81920
    s_add_u32 s46, s41, 4096
    buffer_load_dwordx4 v9, s[16:19], s46 offen lds
    v_mfma_f32_16x16x32_bf16 v[32:35], v[96:99], v[60:63], v[32:35]
    ds_read_b128 v[148:151], v2 offset:49152
    s_bfe_u32 s40, s94, 0x40014
    s_add_u32 s40, s89, s40
    s_and_b32 s40, s40, 15
    s_mul_i32 s41, s40, 393216
    s_lshl_b32 s40, s40, 7
    s_add_u32 s40, s40, s36
    s_add_u32 s42, s41, s47
    s_add_u32 s41, s41, s38
    s_add_u32 m0, s44, 16384
    s_add_u32 s46, s40, 0
    buffer_load_dwordx4 v5, s[12:15], s46 offen lds
    v_mfma_f32_16x16x32_bf16 v[20:23], v[104:107], v[56:59], v[20:23]
    ds_read_b64_tr_b16 v[152:153], v11 offset:53248
    ds_read_b64_tr_b16 v[154:155], v11 offset:53760
    s_add_u32 m0, s44, 17408
    s_add_u32 s46, s40, 16384
    buffer_load_dwordx4 v6, s[12:15], s46 offen lds
    v_mfma_f32_16x16x32_bf16 v[36:39], v[104:107], v[60:63], v[36:39]
    ds_read_b128 v[156:159], v2 offset:51200
    s_add_u32 m0, s44, 18432
    s_add_u32 s46, s40, 32768
    buffer_load_dwordx4 v5, s[12:15], s46 offen lds
    v_mfma_f32_16x16x32_bf16 v[24:27], v[112:115], v[56:59], v[24:27]
    ds_read_b64_tr_b16 v[160:161], v12 offset:53248
    ds_read_b64_tr_b16 v[162:163], v12 offset:53760
    s_add_u32 m0, s44, 19456
    s_add_u32 s46, s40, 49152
    buffer_load_dwordx4 v6, s[12:15], s46 offen lds
    v_mfma_f32_16x16x32_bf16 v[40:43], v[112:115], v[60:63], v[40:43]
    ds_read_b128 v[64:67], v3 offset:49152
    s_add_u32 m0, s45, 98304
    s_add_u32 s46, s41, 2048
    buffer_load_dwordx4 v8, s[16:19], s46 offen lds
    v_mfma_f32_16x16x32_bf16 v[28:31], v[120:123], v[56:59], v[28:31]
    ds_read_b64_tr_b16 v[72:73], v13 offset:53248
    ds_read_b64_tr_b16 v[74:75], v13 offset:53760
    s_add_u32 m0, s43, 98304
    s_add_u32 s46, s41, 2048
    buffer_load_dwordx4 v9, s[16:19], s46 offen lds
    v_mfma_f32_16x16x32_bf16 v[44:47], v[120:123], v[60:63], v[44:47]
    ds_read_b128 v[80:83], v3 offset:51200
    s_add_u32 m0, s45, 106496
    s_add_u32 s46, s41, 4096
    buffer_load_dwordx4 v8, s[16:19], s46 offen lds
    v_mfma_f32_16x16x32_bf16 v[16:19], v[128:131], v[68:71], v[16:19]
    ds_read_b64_tr_b16 v[48:49], v10 offset:0
    ds_read_b64_tr_b16 v[50:51], v10 offset:512
    s_add_u32 m0, s43, 106496
    s_add_u32 s46, s41, 4096
    buffer_load_dwordx4 v9, s[16:19], s46 offen lds
    v_mfma_f32_16x16x32_bf16 v[32:35], v[128:131], v[76:79], v[32:35]
    ds_read_b64_tr_b16 v[88:89], v11 offset:0
    s_waitcnt lgkmcnt(8)
    ds_read_b64_tr_b16 v[90:91], v11 offset:512
    s_bfe_u32 s40, s94, 0x4000c
    s_add_u32 s40, s89, s40
    s_and_b32 s40, s40, 15
    s_mul_i32 s41, s40, 393216
    s_lshl_b32 s40, s40, 7
    s_add_u32 s40, s40, s36
    s_add_u32 s42, s41, s47
    s_add_u32 s41, s41, s38
    s_add_u32 m0, s45, 147456
    s_nop 0
    buffer_load_dwordx4 v8, s[16:19], s42 offen lds
    v_mfma_f32_16x16x32_bf16 v[20:23], v[132:135], v[68:71], v[20:23]
    ds_read_b64_tr_b16 v[52:53], v12 offset:0
    ds_read_b64_tr_b16 v[54:55], v12 offset:512
    v_mfma_f32_16x16x32_bf16 v[36:39], v[132:135], v[76:79], v[36:39]
    ds_read_b64_tr_b16 v[96:97], v13 offset:0
    ds_read_b64_tr_b16 v[98:99], v13 offset:512
    v_mfma_f32_16x16x32_bf16 v[24:27], v[136:139], v[68:71], v[24:27]
    v_mfma_f32_16x16x32_bf16 v[40:43], v[136:139], v[76:79], v[40:43]
    v_mfma_f32_16x16x32_bf16 v[28:31], v[140:143], v[68:71], v[28:31]
    v_mfma_f32_16x16x32_bf16 v[44:47], v[140:143], v[76:79], v[44:47]
    s_waitcnt vmcnt(9) lgkmcnt(0)
    s_barrier
    s_add_u32 m0, s43, 147456
    s_nop 0
    buffer_load_dwordx4 v9, s[16:19], s42 offen lds
    v_mfma_f32_16x16x32_bf16 v[16:19], v[144:147], v[84:87], v[16:19]
    ds_read_b64_tr_b16 v[104:105], v10 offset:4096
    ds_read_b64_tr_b16 v[106:107], v10 offset:4608
    s_bfe_u32 s40, s94, 0x40018
    s_add_u32 s40, s89, s40
    s_and_b32 s40, s40, 15
    s_mul_i32 s41, s40, 393216
    s_lshl_b32 s40, s40, 7
    s_add_u32 s40, s40, s36
    s_add_u32 s42, s41, s47
    s_add_u32 s41, s41, s38
    s_add_u32 m0, s44, 32768
    s_add_u32 s46, s40, 0
    buffer_load_dwordx4 v5, s[12:15], s46 offen lds
    v_mfma_f32_16x16x32_bf16 v[32:35], v[144:147], v[92:95], v[32:35]
    ds_read_b128 v[112:115], v2 offset:0
    s_add_u32 m0, s44, 33792
    s_add_u32 s46, s40, 16384
    s_branch IW_s0
IW_w0:
    s_branch IW_r0
IW_s0:
    buffer_load_dwordx4 v6, s[12:15], s46 offen lds
    v_mfma_f32_16x16x32_bf16 v[20:23], v[152:155], v[84:87], v[20:23]
    ds_read_b64_tr_b16 v[56:57], v11 offset:4096
    ds_read_b64_tr_b16 v[58:59], v11 offset:4608
    s_add_u32 m0, s44, 34816
    s_add_u32 s46, s40, 32768
    buffer_load_dwordx4 v5, s[12:15], s46 offen lds
    v_mfma_f32_16x16x32_bf16 v[36:39], v[152:155], v[92:95], v[36:39]
    ds_read_b128 v[120:123], v2 offset:2048
    s_add_u32 m0, s44, 35840
    s_add_u32 s46, s40, 49152
    buffer_load_dwordx4 v6, s[12:15], s46 offen lds
    v_mfma_f32_16x16x32_bf16 v[24:27], v[160:163], v[84:87], v[24:27]
    ds_read_b64_tr_b16 v[60:61], v12 offset:4096
    ds_read_b64_tr_b16 v[62:63], v12 offset:4608
    s_add_u32 m0, s45, 114688
    s_add_u32 s46, s41, 2048
    buffer_load_dwordx4 v8, s[16:19], s46 offen lds
    v_mfma_f32_16x16x32_bf16 v[40:43], v[160:163], v[92:95], v[40:43]
    ds_read_b128 v[128:131], v3 offset:0
    s_add_u32 m0, s43, 114688
    s_add_u32 s46, s41, 2048
    buffer_load_dwordx4 v9, s[16:19], s46 offen lds
    v_mfma_f32_16x16x32_bf16 v[28:31], v[72:75], v[84:87], v[28:31]
    ds_read_b64_tr_b16 v[132:133], v13 offset:4096
    ds_read_b64_tr_b16 v[134:135], v13 offset:4608
    s_add_u32 m0, s45, 122880
    s_add_u32 s46, s41, 4096
    buffer_load_dwordx4 v8, s[16:19], s46 offen lds
    v_mfma_f32_16x16x32_bf16 v[44:47], v[72:75], v[92:95], v[44:47]
    ds_read_b128 v[136:139], v3 offset:2048
    s_add_u32 m0, s43, 122880
    s_add_u32 s46, s41, 4096
    buffer_load_dwordx4 v9, s[16:19], s46 offen lds
    v_mfma_f32_16x16x32_bf16 v[16:19], v[48:51], v[100:103], v[16:19]
    s_bfe_u32 s40, s94, 0x4001c
    s_add_u32 s40, s89, s40
    s_and_b32 s40, s40, 15
    s_mul_i32 s41, s40, 393216
    s_lshl_b32 s40, s40, 7
    s_add_u32 s40, s40, s36
    s_add_u32 s42, s41, s47
    s_add_u32 s41, s41, s38
    s_add_u32 m0, s44, 49152
    s_add_u32 s46, s40, 0
    buffer_load_dwordx4 v5, s[12:15], s46 offen lds
    v_mfma_f32_16x16x32_bf16 v[32:35], v[48:51], v[108:111], v[32:35]
    s_add_u32 m0, s44, 50176
    s_add_u32 s46, s40, 16384
    buffer_load_dwordx4 v6, s[12:15], s46 offen lds
    v_mfma_f32_16x16x32_bf16 v[20:23], v[88:91], v[100:103], v[20:23]
    v_mfma_f32_16x16x32_bf16 v[36:39], v[88:91], v[108:111], v[36:39]
    v_mfma_f32_16x16x32_bf16 v[24:27], v[52:55], v[100:103], v[24:27]
    v_mfma_f32_16x16x32_bf16 v[40:43], v[52:55], v[108:111], v[40:43]
    v_mfma_f32_16x16x32_bf16 v[28:31], v[96:99], v[100:103], v[28:31]
    v_mfma_f32_16x16x32_bf16 v[44:47], v[96:99], v[108:111], v[44:47]
    s_waitcnt vmcnt(10) lgkmcnt(0)
    s_barrier
    s_add_u32 m0, s44, 51200
    s_add_u32 s46, s40, 32768
    buffer_load_dwordx4 v5, s[12:15], s46 offen lds
    v_mfma_f32_16x16x32_bf16 v[16:19], v[104:107], v[116:119], v[16:19]
    ds_read_b64_tr_b16 v[68:69], v10 offset:57344
    ds_read_b64_tr_b16 v[70:71], v10 offset:57856
    s_add_u32 m0, s44, 52224
    s_add_u32 s46, s40, 49152
    buffer_load_dwordx4 v6, s[12:15], s46 offen lds
    v_mfma_f32_16x16x32_bf16 v[32:35], v[104:107], v[124:127], v[32:35]
    ds_read_b128 v[140:143], v2 offset:16384
    s_add_u32 m0, s45, 65536
    s_add_u32 s46, s41, 2048
    buffer_load_dwordx4 v8, s[16:19], s46 offen lds
    v_mfma_f32_16x16x32_bf16 v[20:23], v[56:59], v[116:119], v[20:23]
    ds_read_b64_tr_b16 v[76:77], v11 offset:57344
    ds_read_b64_tr_b16 v[78:79], v11 offset:57856
    s_add_u32 m0, s43, 65536
    s_add_u32 s46, s41, 2048
    buffer_load_dwordx4 v9, s[16:19], s46 offen lds
    v_mfma_f32_16x16x32_bf16 v[36:39], v[56:59], v[124:127], v[36:39]
    ds_read_b128 v[144:147], v2 offset:18432
    s_add_u32 m0, s45, 131072
    s_add_u32 s46, s41, 4096
    buffer_load_dwordx4 v8, s[16:19], s46 offen lds
    v_mfma_f32_16x16x32_bf16 v[24:27], v[60:63], v[116:119], v[24:27]
    ds_read_b64_tr_b16 v[152:153], v12 offset:57344
    ds_read_b64_tr_b16 v[154:155], v12 offset:57856
    s_add_u32 m0, s43, 131072
    s_add_u32 s46, s41, 4096
    buffer_load_dwordx4 v9, s[16:19], s46 offen lds
    v_mfma_f32_16x16x32_bf16 v[40:43], v[60:63], v[124:127], v[40:43]
    ds_read_b128 v[160:163], v3 offset:16384
    s_bfe_u32 s40, s94, 0x40010
    s_add_u32 s40, s89, s40
    s_and_b32 s40, s40, 15
    s_mul_i32 s41, s40, 393216
    s_lshl_b32 s40, s40, 7
    s_add_u32 s40, s40, s36
    s_add_u32 s42, s41, s47
    s_add_u32 s41, s41, s38
    s_add_u32 m0, s45, 139264
    s_nop 0
    buffer_load_dwordx4 v8, s[16:19], s42 offen lds
    v_mfma_f32_16x16x32_bf16 v[28:31], v[132:135], v[116:119], v[28:31]
    ds_read_b64_tr_b16 v[84:85], v13 offset:57344
    ds_read_b64_tr_b16 v[86:87], v13 offset:57856
    s_add_u32 m0, s43, 139264
    s_nop 0
    buffer_load_dwordx4 v9, s[16:19], s42 offen lds
    v_mfma_f32_16x16x32_bf16 v[44:47], v[132:135], v[124:127], v[44:47]
    ds_read_b128 v[72:75], v3 offset:18432
    s_bfe_u32 s40, s95, 0x40000
    s_add_u32 s40, s89, s40
    s_and_b32 s40, s40, 15
    s_mul_i32 s41, s40, 393216
    s_lshl_b32 s40, s40, 7
    s_add_u32 s40, s40, s36
    s_add_u32 s42, s41, s47
    s_add_u32 s41, s41, s38
    s_add_u32 m0, s44, 0
    s_add_u32 s46, s40, 0
    buffer_load_dwordx4 v5, s[12:15], s46 offen lds
    s_add_u32 m0, s44, 1024
    s_add_u32 s46, s40, 16384
    buffer_load_dwordx4 v6, s[12:15], s46 offen lds
    s_add_u32 m0, s44, 2048
    s_add_u32 s46, s40, 32768
    buffer_load_dwordx4 v5, s[12:15], s46 offen lds
    s_waitcnt vmcnt(13) lgkmcnt(0)
    s_barrier
    s_add_u32 m0, s44, 3072
    s_add_u32 s46, s40, 49152
    buffer_load_dwordx4 v6, s[12:15], s46 offen lds
    v_mfma_f32_16x16x32_bf16 v[16:19], v[68:71], v[148:151], v[16:19]
    ds_read_b64_tr_b16 v[92:93], v10 offset:61440
    ds_read_b64_tr_b16 v[94:95], v10 offset:61952
    s_add_u32 m0, s45, 73728
    s_add_u32 s46, s41, 2048
    buffer_load_dwordx4 v8, s[16:19], s46 offen lds
    v_mfma_f32_16x16x32_bf16 v[32:35], v[68:71], v[156:159], v[32:35]
    ds_read_b128 v[48:51], v2 offset:32768
    s_add_u32 m0, s43, 73728
    s_add_u32 s46, s41, 2048
    buffer_load_dwordx4 v9, s[16:19], s46 offen lds
    v_mfma_f32_16x16x32_bf16 v[20:23], v[76:79], v[148:151], v[20:23]
    ds_read_b64_tr_b16 v[88:89], v11 offset:61440
    ds_read_b64_tr_b16 v[90:91], v11 offset:61952
    s_add_u32 m0, s45, 81920
    s_add_u32 s46, s41, 4096
    buffer_load_dwordx4 v8, s[16:19], s46 offen lds
    v_mfma_f32_16x16x32_bf16 v[36:39], v[76:79], v[156:159], v[36:39]
    ds_read_b128 v[52:55], v2 offset:34816
    s_add_u32 m0, s43, 81920
    s_add_u32 s46, s41, 4096
    buffer_load_dwordx4 v9, s[16:19], s46 offen lds
    v_mfma_f32_16x16x32_bf16 v[24:27], v[152:155], v[148:151], v[24:27]
    ds_read_b64_tr_b16 v[100:101], v12 offset:61440
    ds_read_b64_tr_b16 v[102:103], v12 offset:61952
    s_bfe_u32 s40, s95, 0x40004
    s_add_u32 s40, s89, s40
    s_and_b32 s40, s40, 15
    s_mul_i32 s41, s40, 393216
    s_lshl_b32 s40, s40, 7
    s_add_u32 s40, s40, s36
    s_add_u32 s42, s41, s47
    s_add_u32 s41, s41, s38
    s_add_u32 m0, s44, 16384
    s_add_u32 s46, s40, 0
    buffer_load_dwordx4 v5, s[12:15], s46 offen lds
    v_mfma_f32_16x16x32_bf16 v[40:43], v[152:155], v[156:159], v[40:43]
    ds_read_b128 v[96:99], v3 offset:32768
    s_add_u32 m0, s44, 17408
    s_add_u32 s46, s40, 16384
    buffer_load_dwordx4 v6, s[12:15], s46 offen lds
    v_mfma_f32_16x16x32_bf16 v[28:31], v[84:87], v[148:151], v[28:31]
    ds_read_b64_tr_b16 v[108:109], v13 offset:61440
    ds_read_b64_tr_b16 v[110:111], v13 offset:61952
    s_add_u32 m0, s44, 18432
    s_add_u32 s46, s40, 32768
    buffer_load_dwordx4 v5, s[12:15], s46 offen lds
    v_mfma_f32_16x16x32_bf16 v[44:47], v[84:87], v[156:159], v[44:47]
    ds_read_b128 v[104:107], v3 offset:34816
    s_add_u32 m0, s44, 19456
    s_add_u32 s46, s40, 49152
    buffer_load_dwordx4 v6, s[12:15], s46 offen lds
    s_add_u32 m0, s45, 90112
    s_add_u32 s46, s41, 2048
    buffer_load_dwordx4 v8, s[16:19], s46 offen lds
    s_add_u32 m0, s43, 90112
    s_add_u32 s46, s41, 2048
    buffer_load_dwordx4 v9, s[16:19], s46 offen lds
    s_waitcnt vmcnt(14) lgkmcnt(0)
    s_barrier
    s_add_u32 m0, s45, 98304
    s_add_u32 s46, s41, 4096
    buffer_load_dwordx4 v8, s[16:19], s46 offen lds
    v_mfma_f32_16x16x32_bf16 v[16:19], v[92:95], v[64:67], v[16:19]
    ds_read_b64_tr_b16 v[56:57], v10 offset:49152
    ds_read_b64_tr_b16 v[58:59], v10 offset:49664
    s_add_u32 m0, s43, 98304
    s_add_u32 s46, s41, 4096
    buffer_load_dwordx4 v9, s[16:19], s46 offen lds
    v_mfma_f32_16x16x32_bf16 v[32:35], v[92:95], v[80:83], v[32:35]
    ds_read_b128 v[60:63], v2 offset:49152
    s_bfe_u32 s40, s94, 0x40014
    s_add_u32 s40, s89, s40
    s_and_b32 s40, s40, 15
    s_mul_i32 s41, s40, 393216
    s_lshl_b32 s40, s40, 7
    s_add_u32 s40, s40, s36
    s_add_u32 s42, s41, s47
    s_add_u32 s41, s41, s38
    s_add_u32 m0, s45, 106496
    s_nop 0
    buffer_load_dwordx4 v8, s[16:19], s42 offen lds
    v_mfma_f32_16x16x32_bf16 v[20:23], v[88:91], v[64:67], v[20:23]
    ds_read_b64_tr_b16 v[116:117], v11 offset:49152
    ds_read_b64_tr_b16 v[118:119], v11 offset:49664
    s_add_u32 m0, s43, 106496
    s_nop 0
    buffer_load_dwordx4 v9, s[16:19], s42 offen lds
    v_mfma_f32_16x16x32_bf16 v[36:39], v[88:91], v[80:83], v[36:39]
    ds_read_b128 v[132:135], v2 offset:51200
    s_bfe_u32 s40, s95, 0x40008
    s_add_u32 s40, s89, s40
    s_and_b32 s40, s40, 15
    s_mul_i32 s41, s40, 393216
    s_lshl_b32 s40, s40, 7
    s_add_u32 s40, s40, s36
    s_add_u32 s42, s41, s47
    s_add_u32 s41, s41, s38
    s_add_u32 m0, s44, 32768
    s_add_u32 s46, s40, 0
    buffer_load_dwordx4 v5, s[12:15], s46 offen lds
    v_mfma_f32_16x16x32_bf16 v[24:27], v[100:103], v[64:67], v[24:27]
    ds_read_b64_tr_b16 v[124:125], v12 offset:49152
    ds_read_b64_tr_b16 v[126:127], v12 offset:49664
    s_add_u32 m0, s44, 33792
    s_add_u32 s46, s40, 16384
    buffer_load_dwordx4 v6, s[12:15], s46 offen lds
    v_mfma_f32_16x16x32_bf16 v[40:43], v[100:103], v[80:83], v[40:43]
    ds_read_b128 v[68:71], v3 offset:49152
    s_add_u32 m0, s44, 34816
    s_add_u32 s46, s40, 32768
    buffer_load_dwordx4 v5, s[12:15], s46 offen lds
    v_mfma_f32_16x16x32_bf16 v[28:31], v[108:111], v[64:67], v[28:31]
    ds_read_b64_tr_b16 v[76:77], v13 offset:49152
    ds_read_b64_tr_b16 v[78:79], v13 offset:49664
    s_add_u32 m0, s44, 35840
    s_add_u32 s46, s40, 49152
    buffer_load_dwordx4 v6, s[12:15], s46 offen lds
    v_mfma_f32_16x16x32_bf16 v[44:47], v[108:111], v[80:83], v[44:47]
    ds_read_b128 v[152:155], v3 offset:51200
    s_add_u32 m0, s45, 114688
    s_add_u32 s46, s41, 2048
    buffer_load_dwordx4 v8, s[16:19], s46 offen lds
    s_add_u32 m0, s43, 114688
    s_add_u32 s46, s41, 2048
    buffer_load_dwordx4 v9, s[16:19], s46 offen lds
    s_add_u32 m0, s45, 122880
    s_add_u32 s46, s41, 4096
    buffer_load_dwordx4 v8, s[16:19], s46 offen lds
    s_waitcnt vmcnt(17) lgkmcnt(0)
    s_barrier
    s_add_u32 m0, s43, 122880
    s_add_u32 s46, s41, 4096
    buffer_load_dwordx4 v9, s[16:19], s46 offen lds
    v_mfma_f32_16x16x32_bf16 v[16:19], v[56:59], v[112:115], v[16:19]
    ds_read_b64_tr_b16 v[148:149], v10 offset:53248
    ds_read_b64_tr_b16 v[150:151], v10 offset:53760
    s_bfe_u32 s40, s95, 0x4000c
    s_add_u32 s40, s89, s40
    s_and_b32 s40, s40, 15
    s_mul_i32 s41, s40, 393216
    s_lshl_b32 s40, s40, 7
    s_add_u32 s40, s40, s36
    s_add_u32 s42, s41, s47
    s_add_u32 s41, s41, s38
    s_add_u32 m0, s44, 49152
    s_add_u32 s46, s40, 0
    buffer_load_dwordx4 v5, s[12:15], s46 offen lds
    v_mfma_f32_16x16x32_bf16 v[32:35], v[56:59], v[120:123], v[32:35]
    ds_read_b128 v[84:87], v2 offset:0
    s_add_u32 m0, s44, 50176
    s_add_u32 s46, s40, 16384
    buffer_load_dwordx4 v6, s[12:15], s46 offen lds
    v_mfma_f32_16x16x32_bf16 v[20:23], v[116:119], v[112:115], v[20:23]
    ds_read_b64_tr_b16 v[156:157], v11 offset:53248
    ds_read_b64_tr_b16 v[158:159], v11 offset:53760
    s_add_u32 m0, s44, 51200
    s_add_u32 s46, s40, 32768
    buffer_load_dwordx4 v5, s[12:15], s46 offen lds
    v_mfma_f32_16x16x32_bf16 v[36:39], v[116:119], v[120:123], v[36:39]
    ds_read_b128 v[92:95], v2 offset:2048
    s_add_u32 m0, s44, 52224
    s_add_u32 s46, s40, 49152
    buffer_load_dwordx4 v6, s[12:15], s46 offen lds
    v_mfma_f32_16x16x32_bf16 v[24:27], v[124:127], v[112:115], v[24:27]
    ds_read_b64_tr_b16 v[88:89], v12 offset:53248
    ds_read_b64_tr_b16 v[90:91], v12 offset:53760
    s_add_u32 m0, s45, 65536
    s_add_u32 s46, s41, 2048
    buffer_load_dwordx4 v8, s[16:19], s46 offen lds
    v_mfma_f32_16x16x32_bf16 v[40:43], v[124:127], v[120:123], v[40:43]
    ds_read_b128 v[100:103], v3 offset:0
    s_add_u32 m0, s43, 65536
    s_add_u32 s46, s41, 2048
    buffer_load_dwordx4 v9, s[16:19], s46 offen lds
    v_mfma_f32_16x16x32_bf16 v[28:31], v[76:79], v[112:115], v[28:31]
    ds_read_b64_tr_b16 v[64:65], v13 offset:53248
    ds_read_b64_tr_b16 v[66:67], v13 offset:53760
    s_add_u32 m0, s45, 131072
    s_add_u32 s46, s41, 4096
    buffer_load_dwordx4 v8, s[16:19], s46 offen lds
    v_mfma_f32_16x16x32_bf16 v[44:47], v[76:79], v[120:123], v[44:47]
    ds_read_b128 v[108:111], v3 offset:2048
    s_add_u32 m0, s43, 131072
    s_add_u32 s46, s41, 4096
    buffer_load_dwordx4 v9, s[16:19], s46 offen lds
    s_waitcnt vmcnt(16) lgkmcnt(0)
    s_barrier
    s_bfe_u32 s40, s95, 0x40010
    s_add_u32 s40, s89, s40
    s_and_b32 s40, s40, 15
    s_mul_i32 s41, s40, 393216
    s_lshl_b32 s40, s40, 7
    s_add_u32 s40, s40, s36
    s_add_u32 s42, s41, s47
    s_add_u32 s41, s41, s38
    s_add_u32 m0, s44, 0
    s_add_u32 s46, s40, 0
    buffer_load_dwordx4 v5, s[12:15], s46 offen lds
    v_mfma_f32_16x16x32_bf16 v[16:19], v[148:151], v[128:131], v[16:19]
    ds_read_b64_tr_b16 v[80:81], v10 offset:16384
    ds_read_b64_tr_b16 v[82:83], v10 offset:16896
    s_add_u32 m0, s44, 1024
    s_add_u32 s46, s40, 16384
    buffer_load_dwordx4 v6, s[12:15], s46 offen lds
    v_mfma_f32_16x16x32_bf16 v[32:35], v[148:151], v[136:139], v[32:35]
    ds_read_b128 v[56:59], v2 offset:16384
    s_add_u32 m0, s44, 2048
    s_add_u32 s46, s40, 32768
    buffer_load_dwordx4 v5, s[12:15], s46 offen lds
    v_mfma_f32_16x16x32_bf16 v[20:23], v[156:159], v[128:131], v[20:23]
    ds_read_b64_tr_b16 v[116:117], v11 offset:16384
    ds_read_b64_tr_b16 v[118:119], v11 offset:16896
    s_add_u32 m0, s44, 3072
    s_add_u32 s46, s40, 49152
    buffer_load_dwordx4 v6, s[12:15], s46 offen lds
    v_mfma_f32_16x16x32_bf16 v[36:39], v[156:159], v[136:139], v[36:39]
    ds_read_b128 v[124:127], v2 offset:18432
    s_add_u32 m0, s45, 73728
    s_add_u32 s46, s41, 2048
    buffer_load_dwordx4 v8, s[16:19], s46 offen lds
    v_mfma_f32_16x16x32_bf16 v[24:27], v[88:91], v[128:131], v[24:27]
    ds_read_b64_tr_b16 v[112:113], v12 offset:16384
    ds_read_b64_tr_b16 v[114:115], v12 offset:16896
    s_add_u32 m0, s43, 73728
    s_add_u32 s46, s41, 2048
    buffer_load_dwordx4 v9, s[16:19], s46 offen lds
    v_mfma_f32_16x16x32_bf16 v[40:43], v[88:91], v[136:139], v[40:43]
    ds_read_b128 v[76:79], v3 offset:16384
    s_add_u32 m0, s45, 81920
    s_add_u32 s46, s41, 4096
    buffer_load_dwordx4 v8, s[16:19], s46 offen lds
    v_mfma_f32_16x16x32_bf16 v[28:31], v[64:67], v[128:131], v[28:31]
    ds_read_b64_tr_b16 v[120:121], v13 offset:16384
    ds_read_b64_tr_b16 v[122:123], v13 offset:16896
    s_add_u32 m0, s43, 81920
    s_add_u32 s46, s41, 4096
    buffer_load_dwordx4 v9, s[16:19], s46 offen lds
    v_mfma_f32_16x16x32_bf16 v[44:47], v[64:67], v[136:139], v[44:47]
    ds_read_b128 v[148:151], v3 offset:18432
    s_waitcnt vmcnt(16) lgkmcnt(0)
    s_barrier
    s_bfe_u32 s40, s95, 0x40014
    s_add_u32 s40, s89, s40
    s_and_b32 s40, s40, 15
    s_mul_i32 s41, s40, 393216
    s_lshl_b32 s40, s40, 7
    s_add_u32 s40, s40, s36
    s_add_u32 s42, s41, s47
    s_add_u32 s41, s41, s38
    s_add_u32 m0, s44, 16384
    s_add_u32 s46, s40, 0
    buffer_load_dwordx4 v5, s[12:15], s46 offen lds
    v_mfma_f32_16x16x32_bf16 v[16:19], v[80:83], v[140:143], v[16:19]
    ds_read_b64_tr_b16 v[156:157], v10 offset:20480
    ds_read_b64_tr_b16 v[158:159], v10 offset:20992
    s_add_u32 m0, s44, 17408
    s_add_u32 s46, s40, 16384
    buffer_load_dwordx4 v6, s[12:15], s46 offen lds
    v_mfma_f32_16x16x32_bf16 v[32:35], v[80:83], v[144:147], v[32:35]
    ds_read_b128 v[88:91], v2 offset:32768
    s_add_u32 m0, s44, 18432
    s_add_u32 s46, s40, 32768
    buffer_load_dwordx4 v5, s[12:15], s46 offen lds
    v_mfma_f32_16x16x32_bf16 v[20:23], v[116:119], v[140:143], v[20:23]
    ds_read_b64_tr_b16 v[128:129], v11 offset:20480
    ds_read_b64_tr_b16 v[130:131], v11 offset:20992
    s_add_u32 m0, s44, 19456
    s_add_u32 s46, s40, 49152
    buffer_load_dwordx4 v6, s[12:15], s46 offen lds
    v_mfma_f32_16x16x32_bf16 v[36:39], v[116:119], v[144:147], v[36:39]
    ds_read_b128 v[64:67], v2 offset:34816
    s_add_u32 m0, s45, 90112
    s_add_u32 s46, s41, 2048
    buffer_load_dwordx4 v8, s[16:19], s46 offen lds
    v_mfma_f32_16x16x32_bf16 v[24:27], v[112:115], v[140:143], v[24:27]
    ds_read_b64_tr_b16 v[136:137], v12 offset:20480
    ds_read_b64_tr_b16 v[138:139], v12 offset:20992
    s_add_u32 m0, s43, 90112
    s_add_u32 s46, s41, 2048
    buffer_load_dwordx4 v9, s[16:19], s46 offen lds
    v_mfma_f32_16x16x32_bf16 v[40:43], v[112:115], v[144:147], v[40:43]
    ds_read_b128 v[80:83], v3 offset:32768
    s_add_u32 m0, s45, 98304
    s_add_u32 s46, s41, 4096
    buffer_load_dwordx4 v8, s[16:19], s46 offen lds
    v_mfma_f32_16x16x32_bf16 v[28:31], v[120:123], v[140:143], v[28:31]
    ds_read_b64_tr_b16 v[116:117], v13 offset:20480
    ds_read_b64_tr_b16 v[118:119], v13 offset:20992
    s_add_u32 m0, s43, 98304
    s_add_u32 s46, s41, 4096
    buffer_load_dwordx4 v9, s[16:19], s46 offen lds
    v_mfma_f32_16x16x32_bf16 v[44:47], v[120:123], v[144:147], v[44:47]
    ds_read_b128 v[112:115], v3 offset:34816
    s_waitcnt vmcnt(16) lgkmcnt(0)
    s_barrier
    s_bfe_u32 s40, s95, 0x40018
    s_add_u32 s40, s89, s40
    s_and_b32 s40, s40, 15
    s_mul_i32 s41, s40, 393216
    s_lshl_b32 s40, s40, 7
    s_add_u32 s40, s40, s36
    s_add_u32 s42, s41, s47
    s_add_u32 s41, s41, s38
    s_add_u32 m0, s44, 32768
    s_add_u32 s46, s40, 0
    buffer_load_dwordx4 v5, s[12:15], s46 offen lds
    v_mfma_f32_16x16x32_bf16 v[16:19], v[156:159], v[160:163], v[16:19]
    ds_read_b128 v[140:143], v2 offset:49152
    s_add_u32 m0, s44, 33792
    s_add_u32 s46, s40, 16384
    buffer_load_dwordx4 v6, s[12:15], s46 offen lds
    v_mfma_f32_16x16x32_bf16 v[32:35], v[156:159], v[72:75], v[32:35]
    ds_read_b128 v[120:123], v2 offset:51200
    s_add_u32 m0, s44, 34816
    s_add_u32 s46, s40, 32768
    buffer_load_dwordx4 v5, s[12:15], s46 offen lds
    v_mfma_f32_16x16x32_bf16 v[20:23], v[128:131], v[160:163], v[20:23]
    ds_read_b128 v[144:147], v3 offset:49152
    s_add_u32 m0, s44, 35840
    s_add_u32 s46, s40, 49152
    buffer_load_dwordx4 v6, s[12:15], s46 offen lds
    v_mfma_f32_16x16x32_bf16 v[36:39], v[128:131], v[72:75], v[36:39]
    ds_read_b128 v[156:159], v3 offset:51200
    s_add_u32 m0, s45, 106496
    s_add_u32 s46, s41, 2048
    buffer_load_dwordx4 v8, s[16:19], s46 offen lds
    v_mfma_f32_16x16x32_bf16 v[24:27], v[136:139], v[160:163], v[24:27]
    s_add_u32 m0, s43, 106496
    s_add_u32 s46, s41, 2048
    buffer_load_dwordx4 v9, s[16:19], s46 offen lds
    v_mfma_f32_16x16x32_bf16 v[40:43], v[136:139], v[72:75], v[40:43]
    s_add_u32 m0, s45, 114688
    s_add_u32 s46, s41, 4096
    buffer_load_dwordx4 v8, s[16:19], s46 offen lds
    v_mfma_f32_16x16x32_bf16 v[28:31], v[116:119], v[160:163], v[28:31]
    s_add_u32 m0, s43, 114688
    s_add_u32 s46, s41, 4096
    buffer_load_dwordx4 v9, s[16:19], s46 offen lds
    v_mfma_f32_16x16x32_bf16 v[44:47], v[116:119], v[72:75], v[44:47]
    s_waitcnt vmcnt(16) lgkmcnt(0)
    s_barrier
    s_bfe_u32 s40, s95, 0x4001c
    s_add_u32 s40, s89, s40
    s_and_b32 s40, s40, 15
    s_mul_i32 s41, s40, 393216
    s_lshl_b32 s40, s40, 7
    s_add_u32 s40, s40, s36
    s_add_u32 s42, s41, s47
    s_add_u32 s41, s41, s38
    s_add_u32 m0, s44, 49152
    s_add_u32 s46, s40, 0
    buffer_load_dwordx4 v5, s[12:15], s46 offen lds
    s_add_u32 m0, s44, 50176
    s_add_u32 s46, s40, 16384
    buffer_load_dwordx4 v6, s[12:15], s46 offen lds
    s_add_u32 m0, s44, 51200
    s_add_u32 s46, s40, 32768
    buffer_load_dwordx4 v5, s[12:15], s46 offen lds
    s_add_u32 m0, s44, 52224
    s_add_u32 s46, s40, 49152
    buffer_load_dwordx4 v6, s[12:15], s46 offen lds
    s_add_u32 m0, s45, 65536
    s_add_u32 s46, s41, 2048
    buffer_load_dwordx4 v8, s[16:19], s46 offen lds
    s_add_u32 m0, s43, 65536
    s_add_u32 s46, s41, 2048
    buffer_load_dwordx4 v9, s[16:19], s46 offen lds
    s_add_u32 m0, s45, 122880
    s_add_u32 s46, s41, 4096
    buffer_load_dwordx4 v8, s[16:19], s46 offen lds
    s_add_u32 m0, s43, 122880
    s_add_u32 s46, s41, 4096
    buffer_load_dwordx4 v9, s[16:19], s46 offen lds
    s_waitcnt vmcnt(16)
    s_barrier
    s_bfe_u32 s40, s94, 0x40018
    s_add_u32 s40, s89, s40
    s_and_b32 s40, s40, 15
    s_mul_i32 s41, s40, 393216
    s_lshl_b32 s40, s40, 7
    s_add_u32 s40, s40, s36
    s_add_u32 s42, s41, s47
    s_add_u32 s41, s41, s38
    s_add_u32 m0, s45, 147456
    s_nop 0
    buffer_load_dwordx4 v8, s[16:19], s42 offen lds
    s_add_u32 m0, s43, 147456
    s_nop 0
    buffer_load_dwordx4 v9, s[16:19], s42 offen lds
    s_waitcnt vmcnt(10)
    s_barrier
    s_bfe_u32 s40, s95, 0x40010
    s_add_u32 s40, s89, s40
    s_and_b32 s40, s40, 15
    s_mul_i32 s41, s40, 393216
    s_lshl_b32 s40, s40, 7
    s_add_u32 s40, s40, s36
    s_add_u32 s42, s41, s47
    s_add_u32 s41, s41, s38
    s_add_u32 m0, s45, 139264
    s_nop 0
    buffer_load_dwordx4 v8, s[16:19], s42 offen lds
    s_add_u32 m0, s43, 139264
    s_nop 0
    buffer_load_dwordx4 v9, s[16:19], s42 offen lds
    s_waitcnt vmcnt(4)
    s_barrier
    s_bfe_u32 s40, s95, 0x40014
    s_add_u32 s40, s89, s40
    s_and_b32 s40, s40, 15
    s_mul_i32 s41, s40, 393216
    s_lshl_b32 s40, s40, 7
    s_add_u32 s40, s40, s36
    s_add_u32 s42, s41, s47
    s_add_u32 s41, s41, s38
    s_add_u32 m0, s45, 131072
    s_nop 0
    buffer_load_dwordx4 v8, s[16:19], s42 offen lds
    s_add_u32 m0, s43, 131072
    s_nop 0
    buffer_load_dwordx4 v9, s[16:19], s42 offen lds
    s_waitcnt vmcnt(6)
    s_barrier
    s_bfe_u32 s40, s95, 0x40018
    s_add_u32 s40, s89, s40
    s_and_b32 s40, s40, 15
    s_mul_i32 s41, s40, 393216
    s_lshl_b32 s40, s40, 7
    s_add_u32 s40, s40, s36
    s_add_u32 s42, s41, s47
    s_add_u32 s41, s41, s38
    s_add_u32 m0, s45, 81920
    s_nop 0
    buffer_load_dwordx4 v8, s[16:19], s42 offen lds
    s_add_u32 m0, s43, 81920
    s_nop 0
    buffer_load_dwordx4 v9, s[16:19], s42 offen lds
    s_bfe_u32 s40, s95, 0x4001c
    s_add_u32 s40, s89, s40
    s_and_b32 s40, s40, 15
    s_mul_i32 s41, s40, 393216
    s_lshl_b32 s40, s40, 7
    s_add_u32 s40, s40, s36
    s_add_u32 s42, s41, s47
    s_add_u32 s41, s41, s38
    s_add_u32 m0, s45, 73728
    s_nop 0
    buffer_load_dwordx4 v8, s[16:19], s42 offen lds
    s_add_u32 m0, s43, 73728
    s_nop 0
    s_branch IW_s1
IW_w1:
    s_branch IW_r1
IW_s1:
    buffer_load_dwordx4 v9, s[16:19], s42 offen lds
    s_bfe_u32 s40, s94, 0x4001c
    s_add_u32 s40, s89, s40
    s_and_b32 s40, s40, 15
    s_mul_i32 s41, s40, 393216
    s_lshl_b32 s40, s40, 7
    s_add_u32 s40, s40, s36
    s_add_u32 s42, s41, s47
    s_add_u32 s41, s41, s38
    s_add_u32 m0, s45, 98304
    s_nop 0
    buffer_load_dwordx4 v8, s[16:19], s42 offen lds
    s_add_u32 m0, s43, 98304
    s_nop 0
    buffer_load_dwordx4 v9, s[16:19], s42 offen lds
    s_bfe_u32 s40, s95, 0x40000
    s_add_u32 s40, s89, s40
    s_and_b32 s40, s40, 15
    s_mul_i32 s41, s40, 393216
    s_lshl_b32 s40, s40, 7
    s_add_u32 s40, s40, s36
    s_add_u32 s42, s41, s47
    s_add_u32 s41, s41, s38
    s_add_u32 m0, s45, 90112
    s_nop 0
    buffer_load_dwordx4 v8, s[16:19], s42 offen lds
    s_add_u32 m0, s43, 90112
    s_nop 0
    buffer_load_dwordx4 v9, s[16:19], s42 offen lds
    s_bfe_u32 s40, s95, 0x40004
    s_add_u32 s40, s89, s40
    s_and_b32 s40, s40, 15
    s_mul_i32 s41, s40, 393216
    s_lshl_b32 s40, s40, 7
    s_add_u32 s40, s40, s36
    s_add_u32 s42, s41, s47
    s_add_u32 s41, s41, s38
    s_add_u32 m0, s45, 114688
    s_nop 0
    buffer_load_dwordx4 v8, s[16:19], s42 offen lds
    s_add_u32 m0, s43, 114688
    s_nop 0
    buffer_load_dwordx4 v9, s[16:19], s42 offen lds
    s_bfe_u32 s40, s95, 0x40008
    s_add_u32 s40, s89, s40
    s_and_b32 s40, s40, 15
    s_mul_i32 s41, s40, 393216
    s_lshl_b32 s40, s40, 7
    s_add_u32 s40, s40, s36
    s_add_u32 s42, s41, s47
    s_add_u32 s41, s41, s38
    s_add_u32 m0, s45, 106496
    s_nop 0
    buffer_load_dwordx4 v8, s[16:19], s42 offen lds
    s_add_u32 m0, s43, 106496
    s_nop 0
    buffer_load_dwordx4 v9, s[16:19], s42 offen lds
    s_bfe_u32 s40, s95, 0x4000c
    s_add_u32 s40, s89, s40
    s_and_b32 s40, s40, 15
    s_mul_i32 s41, s40, 393216
    s_lshl_b32 s40, s40, 7
    s_add_u32 s40, s40, s36
    s_add_u32 s42, s41, s47
    s_add_u32 s41, s41, s38
    s_add_u32 m0, s45, 122880
    s_nop 0
    buffer_load_dwordx4 v8, s[16:19], s42 offen lds
    s_add_u32 m0, s43, 122880
    s_nop 0
    buffer_load_dwordx4 v9, s[16:19], s42 offen lds
    s_setprio 1
    v_subrev_u32 v5, 24576, v10
    v_subrev_u32 v6, 24576, v11
    v_subrev_u32 v8, 24576, v12
    v_subrev_u32 v9, 24576, v13
    s_add_u32 s16, s72, 0x400000
    s_addc_u32 s17, s73, 0
    s_mov_b32 s18, 0x400000
    s_mov_b32 s19, 0x00020000
    s_add_u32 s24, s72, 0x800000
    s_addc_u32 s25, s73, 0
    s_mov_b32 s26, 0x48000
    s_mov_b32 s27, 0x00020000
    s_mov_b32 s40, 0x21317218
    s_mov_b32 s41, s40
    s_mov_b32 s74, 0x358637bd
    s_mov_b32 s75, s74
    s_mov_b32 s76, 0x5d800000
    s_mov_b32 s77, s76
    v_and_b32 v14, 15, v0
    v_lshlrev_b32 v14, 2, v14
    s_lshl_b32 s42, s3, 7
    s_add_u32 s42, s42, 155648
    v_add_u32 v14, s42, v14
    v_and_b32 v15, 0x30, v0
    v_add_u32 v15, 158208, v15
    v_and_b32 v165, 0xfffffff7, v1
    s_lshl_b32 s79, s32, 18
    s_lshl_b32 s80, s3, 16
    s_add_u32 s79, s79, s80
    s_lshl_b32 s80, s10, 11
    s_add_u32 s79, s79, s80
    s_add_u32 s80, s79, 0x8000
    s_lshl_b32 s45, s32, 2
    s_add_u32 s45, s45, s3
    s_lshl_b32 s45, s45, 10
    s_mov_b32 s46, 0x3fb8aa3b

    s_add_u32 s54, s45, 0x835000
    s_add_u32 s54, s72, s54
    s_addc_u32 s55, s73, 0
    ds_read_b32 v7, v165 offset:48
FW_1:
    s_waitcnt lgkmcnt(0)
    v_cmp_gt_u32 vcc, 1, v7
    s_cbranch_vccz FO_2
    s_sleep 1
    ds_read_b32 v7, v165 offset:48
    s_branch FW_1
FO_2:
    ds_read2_b32 v[72:73], v14 offset0:0 offset1:0
    ds_read2_b32 v[74:75], v14 offset0:16 offset1:16
    ds_read_b128 v[128:131], v15 offset:0
    ds_read_b128 v[136:139], v15 offset:64
    ds_read_b128 v[160:163], v15 offset:128
    ds_read_b128 v[116:119], v15 offset:192
    v_add_u32 v14, 1024, v14
    s_waitcnt lgkmcnt(3)
    v_pk_fma_f32 v[16:17], v[128:129], v[72:73], v[16:17]
    v_pk_fma_f32 v[18:19], v[130:131], v[72:73], v[18:19]
    v_pk_fma_f32 v[32:33], v[128:129], v[74:75], v[32:33]
    v_pk_fma_f32 v[34:35], v[130:131], v[74:75], v[34:35]
    s_waitcnt lgkmcnt(2)
    v_pk_fma_f32 v[20:21], v[136:137], v[72:73], v[20:21]
    v_pk_fma_f32 v[22:23], v[138:139], v[72:73], v[22:23]
    v_pk_fma_f32 v[36:37], v[136:137], v[74:75], v[36:37]
    v_pk_fma_f32 v[38:39], v[138:139], v[74:75], v[38:39]
    s_waitcnt lgkmcnt(1)
    v_pk_fma_f32 v[24:25], v[160:161], v[72:73], v[24:25]
    v_pk_fma_f32 v[26:27], v[162:163], v[72:73], v[26:27]
    v_pk_fma_f32 v[40:41], v[160:161], v[74:75], v[40:41]
    v_pk_fma_f32 v[42:43], v[162:163], v[74:75], v[42:43]
    s_waitcnt lgkmcnt(0)
    v_pk_fma_f32 v[28:29], v[116:117], v[72:73], v[28:29]
    v_pk_fma_f32 v[30:31], v[118:119], v[72:73], v[30:31]
    v_pk_fma_f32 v[44:45], v[116:117], v[74:75], v[44:45]
    v_pk_fma_f32 v[46:47], v[118:119], v[74:75], v[46:47]
    s_waitcnt vmcnt(8)
    s_mov_b64 exec, 1
    ds_add_u32 v4, v164 offset:112
    s_mov_b64 exec, -1
    ds_read_b32 v7, v1 offset:32
FW_3:
    s_waitcnt lgkmcnt(0)
    v_cmp_gt_u32 vcc, 1, v7
    s_cbranch_vccz FO_4
    s_sleep 2
    ds_read_b32 v7, v1 offset:32
    s_branch FW_3
FO_4:
    ds_read_b32 v7, v1 offset:112
FW_5:
    s_waitcnt lgkmcnt(0)
    v_cmp_gt_u32 vcc, 1, v7
    s_cbranch_vccz FO_6
    ds_read_b32 v7, v1 offset:112
    s_branch FW_5
FO_6:
    ds_read_b64_tr_b16 v[128:129], v10 offset:57344
    ds_read_b64_tr_b16 v[130:131], v10 offset:57856
    ds_read_b64_tr_b16 v[136:137], v11 offset:57344
    ds_read_b64_tr_b16 v[138:139], v11 offset:57856
    ds_read_b64_tr_b16 v[160:161], v12 offset:57344
    ds_read_b64_tr_b16 v[162:163], v12 offset:57856
    ds_read_b64_tr_b16 v[116:117], v13 offset:57344
    ds_read_b64_tr_b16 v[118:119], v13 offset:57856
    ds_read_b64_tr_b16 v[72:73], v10 offset:61440
    ds_read_b64_tr_b16 v[74:75], v10 offset:61952
    s_waitcnt lgkmcnt(8)
    v_mfma_f32_16x16x32_bf16 v[16:19], v[128:131], v[48:51], v[16:19]
    v_mfma_f32_16x16x32_bf16 v[32:35], v[128:131], v[52:55], v[32:35]
    ds_read_b64_tr_b16 v[128:129], v11 offset:61440
    ds_read_b64_tr_b16 v[130:131], v11 offset:61952
    s_waitcnt lgkmcnt(8)
    v_mfma_f32_16x16x32_bf16 v[20:23], v[136:139], v[48:51], v[20:23]
    v_mfma_f32_16x16x32_bf16 v[36:39], v[136:139], v[52:55], v[36:39]
    ds_read_b64_tr_b16 v[136:137], v12 offset:61440
    ds_read_b64_tr_b16 v[138:139], v12 offset:61952
    s_waitcnt lgkmcnt(8)
    v_mfma_f32_16x16x32_bf16 v[24:27], v[160:163], v[48:51], v[24:27]
    v_mfma_f32_16x16x32_bf16 v[40:43], v[160:163], v[52:55], v[40:43]
    ds_read_b64_tr_b16 v[160:161], v13 offset:61440
    ds_read_b64_tr_b16 v[162:163], v13 offset:61952
    s_waitcnt lgkmcnt(8)
    v_mfma_f32_16x16x32_bf16 v[28:31], v[116:119], v[48:51], v[28:31]
    ds_read_b128 v[48:51], v2 offset:0
    v_mfma_f32_16x16x32_bf16 v[44:47], v[116:119], v[52:55], v[44:47]
    ds_read_b64_tr_b16 v[116:117], v10 offset:49152
    ds_read_b64_tr_b16 v[118:119], v10 offset:49664
    s_waitcnt lgkmcnt(9)
    v_mfma_f32_16x16x32_bf16 v[16:19], v[72:75], v[96:99], v[16:19]
    ds_read_b128 v[52:55], v2 offset:2048
    v_mfma_f32_16x16x32_bf16 v[32:35], v[72:75], v[104:107], v[32:35]
    ds_read_b64_tr_b16 v[72:73], v11 offset:49152
    ds_read_b64_tr_b16 v[74:75], v11 offset:49664
    s_waitcnt lgkmcnt(10)
    v_mfma_f32_16x16x32_bf16 v[20:23], v[128:131], v[96:99], v[20:23]
    v_mfma_f32_16x16x32_bf16 v[36:39], v[128:131], v[104:107], v[36:39]
    ds_read_b64_tr_b16 v[128:129], v12 offset:49152
    ds_read_b64_tr_b16 v[130:131], v12 offset:49664
    s_waitcnt lgkmcnt(10)
    v_mfma_f32_16x16x32_bf16 v[24:27], v[136:139], v[96:99], v[24:27]
    v_mfma_f32_16x16x32_bf16 v[40:43], v[136:139], v[104:107], v[40:43]
    ds_read_b64_tr_b16 v[136:137], v13 offset:49152
    ds_read_b64_tr_b16 v[138:139], v13 offset:49664
    s_waitcnt lgkmcnt(10)
    v_mfma_f32_16x16x32_bf16 v[28:31], v[160:163], v[96:99], v[28:31]
    ds_read_b128 v[96:99], v3 offset:0
    v_mfma_f32_16x16x32_bf16 v[44:47], v[160:163], v[104:107], v[44:47]
    ds_read_b64_tr_b16 v[160:161], v10 offset:53248
    ds_read_b64_tr_b16 v[162:163], v10 offset:53760
    s_waitcnt lgkmcnt(10)
    v_mfma_f32_16x16x32_bf16 v[16:19], v[116:119], v[48:51], v[16:19]
    ds_read_b128 v[104:107], v3 offset:2048
    s_waitcnt lgkmcnt(10)
    v_mfma_f32_16x16x32_bf16 v[32:35], v[116:119], v[52:55], v[32:35]
    ds_read_b64_tr_b16 v[116:117], v11 offset:53248
    ds_read_b64_tr_b16 v[118:119], v11 offset:53760
    s_waitcnt lgkmcnt(10)
    v_mfma_f32_16x16x32_bf16 v[20:23], v[72:75], v[48:51], v[20:23]
    v_mfma_f32_16x16x32_bf16 v[36:39], v[72:75], v[52:55], v[36:39]
    ds_read_b64_tr_b16 v[72:73], v12 offset:53248
    ds_read_b64_tr_b16 v[74:75], v12 offset:53760
    s_waitcnt lgkmcnt(10)
    v_mfma_f32_16x16x32_bf16 v[24:27], v[128:131], v[48:51], v[24:27]
    v_mfma_f32_16x16x32_bf16 v[40:43], v[128:131], v[52:55], v[40:43]
    ds_read_b64_tr_b16 v[128:129], v13 offset:53248
    ds_read_b64_tr_b16 v[130:131], v13 offset:53760
    s_waitcnt lgkmcnt(10)
    v_mfma_f32_16x16x32_bf16 v[28:31], v[136:139], v[48:51], v[28:31]
    ds_read_b128 v[48:51], v2 offset:16384
    v_mfma_f32_16x16x32_bf16 v[44:47], v[136:139], v[52:55], v[44:47]
    ds_read_b64_tr_b16 v[136:137], v10 offset:40960
    ds_read_b64_tr_b16 v[138:139], v10 offset:41472
    s_waitcnt lgkmcnt(10)
    v_mfma_f32_16x16x32_bf16 v[16:19], v[160:163], v[96:99], v[16:19]
    ds_read_b128 v[52:55], v2 offset:18432
    s_waitcnt lgkmcnt(10)
    v_mfma_f32_16x16x32_bf16 v[32:35], v[160:163], v[104:107], v[32:35]
    ds_read_b64_tr_b16 v[160:161], v11 offset:40960
    ds_read_b64_tr_b16 v[162:163], v11 offset:41472
    s_waitcnt lgkmcnt(10)
    v_mfma_f32_16x16x32_bf16 v[20:23], v[116:119], v[96:99], v[20:23]
    v_mfma_f32_16x16x32_bf16 v[36:39], v[116:119], v[104:107], v[36:39]
    ds_read_b64_tr_b16 v[116:117], v12 offset:40960
    ds_read_b64_tr_b16 v[118:119], v12 offset:41472
    s_waitcnt lgkmcnt(10)
    v_mfma_f32_16x16x32_bf16 v[24:27], v[72:75], v[96:99], v[24:27]
    v_mfma_f32_16x16x32_bf16 v[40:43], v[72:75], v[104:107], v[40:43]
    ds_read_b64_tr_b16 v[72:73], v13 offset:40960
    ds_read_b64_tr_b16 v[74:75], v13 offset:41472
    s_waitcnt lgkmcnt(10)
    v_mfma_f32_16x16x32_bf16 v[28:31], v[128:131], v[96:99], v[28:31]
    ds_read_b128 v[96:99], v3 offset:16384
    v_mfma_f32_16x16x32_bf16 v[44:47], v[128:131], v[104:107], v[44:47]
    ds_read_b64_tr_b16 v[128:129], v10 offset:45056
    ds_read_b64_tr_b16 v[130:131], v10 offset:45568
    s_waitcnt lgkmcnt(10)
    v_mfma_f32_16x16x32_bf16 v[16:19], v[136:139], v[48:51], v[16:19]
    ds_read_b128 v[104:107], v3 offset:18432
    s_waitcnt lgkmcnt(10)
    v_mfma_f32_16x16x32_bf16 v[32:35], v[136:139], v[52:55], v[32:35]
    ds_read_b64_tr_b16 v[136:137], v11 offset:45056
    ds_read_b64_tr_b16 v[138:139], v11 offset:45568
    s_waitcnt lgkmcnt(10)
    v_mfma_f32_16x16x32_bf16 v[20:23], v[160:163], v[48:51], v[20:23]
    v_mfma_f32_16x16x32_bf16 v[36:39], v[160:163], v[52:55], v[36:39]
    ds_read_b64_tr_b16 v[160:161], v12 offset:45056
    ds_read_b64_tr_b16 v[162:163], v12 offset:45568
    s_waitcnt lgkmcnt(10)
    v_mfma_f32_16x16x32_bf16 v[24:27], v[116:119], v[48:51], v[24:27]
    v_mfma_f32_16x16x32_bf16 v[40:43], v[116:119], v[52:55], v[40:43]
    ds_read_b64_tr_b16 v[116:117], v13 offset:45056
    ds_read_b64_tr_b16 v[118:119], v13 offset:45568
    s_waitcnt lgkmcnt(10)
    v_mfma_f32_16x16x32_bf16 v[28:31], v[72:75], v[48:51], v[28:31]
    ds_read_b128 v[48:51], v2 offset:32768
    v_mfma_f32_16x16x32_bf16 v[44:47], v[72:75], v[52:55], v[44:47]
    ds_read_b64_tr_b16 v[72:73], v5 offset:16384
    ds_read_b64_tr_b16 v[74:75], v5 offset:16896
    s_waitcnt lgkmcnt(10)
    v_mfma_f32_16x16x32_bf16 v[16:19], v[128:131], v[96:99], v[16:19]
    ds_read_b128 v[52:55], v2 offset:34816
    s_waitcnt lgkmcnt(10)
    v_mfma_f32_16x16x32_bf16 v[32:35], v[128:131], v[104:107], v[32:35]
    ds_read_b64_tr_b16 v[128:129], v6 offset:16384
    ds_read_b64_tr_b16 v[130:131], v6 offset:16896
    s_waitcnt lgkmcnt(10)
    v_mfma_f32_16x16x32_bf16 v[20:23], v[136:139], v[96:99], v[20:23]
    v_mfma_f32_16x16x32_bf16 v[36:39], v[136:139], v[104:107], v[36:39]
    ds_read_b64_tr_b16 v[136:137], v8 offset:16384
    ds_read_b64_tr_b16 v[138:139], v8 offset:16896
    s_waitcnt lgkmcnt(10)
    v_mfma_f32_16x16x32_bf16 v[24:27], v[160:163], v[96:99], v[24:27]
    v_mfma_f32_16x16x32_bf16 v[40:43], v[160:163], v[104:107], v[40:43]
    ds_read_b64_tr_b16 v[160:161], v9 offset:16384
    ds_read_b64_tr_b16 v[162:163], v9 offset:16896
    s_waitcnt lgkmcnt(10)
    v_mfma_f32_16x16x32_bf16 v[28:31], v[116:119], v[96:99], v[28:31]
    ds_read_b128 v[96:99], v3 offset:32768
    v_mfma_f32_16x16x32_bf16 v[44:47], v[116:119], v[104:107], v[44:47]
    ds_read_b64_tr_b16 v[116:117], v5 offset:20480
    ds_read_b64_tr_b16 v[118:119], v5 offset:20992
    s_waitcnt lgkmcnt(10)
    v_mfma_f32_16x16x32_bf16 v[16:19], v[72:75], v[48:51], v[16:19]
    ds_read_b128 v[104:107], v3 offset:34816
    s_waitcnt lgkmcnt(10)
    v_mfma_f32_16x16x32_bf16 v[32:35], v[72:75], v[52:55], v[32:35]
    ds_read_b64_tr_b16 v[72:73], v6 offset:20480
    ds_read_b64_tr_b16 v[74:75], v6 offset:20992
    s_waitcnt lgkmcnt(10)
    v_mfma_f32_16x16x32_bf16 v[20:23], v[128:131], v[48:51], v[20:23]
    v_mfma_f32_16x16x32_bf16 v[36:39], v[128:131], v[52:55], v[36:39]
    ds_read_b64_tr_b16 v[128:129], v8 offset:20480
    ds_read_b64_tr_b16 v[130:131], v8 offset:20992
    s_waitcnt lgkmcnt(10)
    v_mfma_f32_16x16x32_bf16 v[24:27], v[136:139], v[48:51], v[24:27]
    v_mfma_f32_16x16x32_bf16 v[40:43], v[136:139], v[52:55], v[40:43]
    ds_read_b64_tr_b16 v[136:137], v9 offset:20480
    ds_read_b64_tr_b16 v[138:139], v9 offset:20992
    s_waitcnt lgkmcnt(10)
    v_mfma_f32_16x16x32_bf16 v[28:31], v[160:163], v[48:51], v[28:31]
    s_waitcnt vmcnt(0)
    s_mov_b64 exec, 1
    ds_add_u32 v4, v164 offset:112
    s_mov_b64 exec, -1
    ds_read_b128 v[48:51], v2 offset:49152
    v_mfma_f32_16x16x32_bf16 v[44:47], v[160:163], v[52:55], v[44:47]
    ds_read_b64_tr_b16 v[160:161], v5 offset:8192
    ds_read_b64_tr_b16 v[162:163], v5 offset:8704
    s_waitcnt lgkmcnt(11)
    v_mfma_f32_16x16x32_bf16 v[16:19], v[116:119], v[96:99], v[16:19]
    ds_read_b128 v[52:55], v2 offset:51200
    s_waitcnt lgkmcnt(11)
    v_mfma_f32_16x16x32_bf16 v[32:35], v[116:119], v[104:107], v[32:35]
    ds_read_b64_tr_b16 v[116:117], v6 offset:8192
    ds_read_b64_tr_b16 v[118:119], v6 offset:8704
    s_waitcnt lgkmcnt(11)
    v_mfma_f32_16x16x32_bf16 v[20:23], v[72:75], v[96:99], v[20:23]
    v_mfma_f32_16x16x32_bf16 v[36:39], v[72:75], v[104:107], v[36:39]
    ds_read_b64_tr_b16 v[72:73], v8 offset:8192
    ds_read_b64_tr_b16 v[74:75], v8 offset:8704
    s_waitcnt lgkmcnt(9)
    v_mov_b32 v165, 4
    s_mov_b64 exec, 1
    ds_write_b32 v4, v165 offset:0
    s_mov_b64 exec, -1
    v_mfma_f32_16x16x32_bf16 v[24:27], v[128:131], v[96:99], v[24:27]
    v_mfma_f32_16x16x32_bf16 v[40:43], v[128:131], v[104:107], v[40:43]
    ds_read_b64_tr_b16 v[128:129], v9 offset:8192
    ds_read_b64_tr_b16 v[130:131], v9 offset:8704
    v_mfma_f32_16x16x32_bf16 v[28:31], v[136:139], v[96:99], v[28:31]
    ds_read_b128 v[96:99], v3 offset:49152
    v_mfma_f32_16x16x32_bf16 v[44:47], v[136:139], v[104:107], v[44:47]
    ds_read_b64_tr_b16 v[136:137], v5 offset:12288
    ds_read_b64_tr_b16 v[138:139], v5 offset:12800
    s_waitcnt lgkmcnt(11)
    v_mfma_f32_16x16x32_bf16 v[16:19], v[160:163], v[48:51], v[16:19]
    ds_read_b128 v[104:107], v3 offset:51200
    s_waitcnt lgkmcnt(11)
    v_mfma_f32_16x16x32_bf16 v[32:35], v[160:163], v[52:55], v[32:35]
    ds_read_b64_tr_b16 v[160:161], v6 offset:12288
    ds_read_b64_tr_b16 v[162:163], v6 offset:12800
    s_waitcnt lgkmcnt(11)
    v_mfma_f32_16x16x32_bf16 v[20:23], v[116:119], v[48:51], v[20:23]
    v_mfma_f32_16x16x32_bf16 v[36:39], v[116:119], v[52:55], v[36:39]
    ds_read_b64_tr_b16 v[116:117], v8 offset:12288
    ds_read_b64_tr_b16 v[118:119], v8 offset:12800
    s_waitcnt lgkmcnt(11)
    v_mfma_f32_16x16x32_bf16 v[24:27], v[72:75], v[48:51], v[24:27]
    v_mfma_f32_16x16x32_bf16 v[40:43], v[72:75], v[52:55], v[40:43]
    ds_read_b64_tr_b16 v[72:73], v9 offset:12288
    ds_read_b64_tr_b16 v[74:75], v9 offset:12800
    s_waitcnt lgkmcnt(10)
    v_mfma_f32_16x16x32_bf16 v[28:31], v[128:131], v[48:51], v[28:31]
    ds_read_b64_tr_b16 v[48:49], v10 offset:8192
    v_mfma_f32_16x16x32_bf16 v[44:47], v[128:131], v[52:55], v[44:47]
    ds_read_b64_tr_b16 v[50:51], v10 offset:8704
    ds_read_b64_tr_b16 v[128:129], v11 offset:8192
    s_waitcnt lgkmcnt(10)
    v_mfma_f32_16x16x32_bf16 v[16:19], v[136:139], v[96:99], v[16:19]
    ds_read_b64_tr_b16 v[130:131], v11 offset:8704
    s_waitcnt lgkmcnt(10)
    v_mfma_f32_16x16x32_bf16 v[32:35], v[136:139], v[104:107], v[32:35]
    ds_read_b64_tr_b16 v[52:53], v12 offset:8192
    ds_read_b64_tr_b16 v[54:55], v12 offset:8704
    s_waitcnt lgkmcnt(10)
    v_mfma_f32_16x16x32_bf16 v[20:23], v[160:163], v[96:99], v[20:23]
    ds_read_b64_tr_b16 v[136:137], v13 offset:8192
    v_mfma_f32_16x16x32_bf16 v[36:39], v[160:163], v[104:107], v[36:39]
    ds_read_b64_tr_b16 v[138:139], v13 offset:8704
    ds_read_b64_tr_b16 v[160:161], v10 offset:12288
    s_waitcnt lgkmcnt(11)
    v_mfma_f32_16x16x32_bf16 v[24:27], v[116:119], v[96:99], v[24:27]
    ds_read_b64_tr_b16 v[162:163], v10 offset:12800
    v_mfma_f32_16x16x32_bf16 v[40:43], v[116:119], v[104:107], v[40:43]
    ds_read_b64_tr_b16 v[116:117], v11 offset:12288
    ds_read_b64_tr_b16 v[118:119], v11 offset:12800
    s_waitcnt lgkmcnt(12)
    v_mfma_f32_16x16x32_bf16 v[28:31], v[72:75], v[96:99], v[28:31]
    ds_read_b64_tr_b16 v[96:97], v12 offset:12288
    v_mfma_f32_16x16x32_bf16 v[44:47], v[72:75], v[104:107], v[44:47]
    ds_read_b64_tr_b16 v[98:99], v12 offset:12800
    ds_read_b64_tr_b16 v[72:73], v13 offset:12288
    s_waitcnt lgkmcnt(13)
    v_mfma_f32_16x16x32_bf16 v[16:19], v[48:51], v[60:63], v[16:19]
    ds_read_b64_tr_b16 v[74:75], v13 offset:12800
    v_mfma_f32_16x16x32_bf16 v[32:35], v[48:51], v[132:135], v[32:35]
    ds_read_b32 v7, v1 offset:112
FW_7:
    s_waitcnt lgkmcnt(0)
    v_cmp_gt_u32 vcc, 2, v7
    s_cbranch_vccz FO_8
    ds_read_b32 v7, v1 offset:112
    s_branch FW_7
FO_8:
    ds_read_b64_tr_b16 v[104:105], v10 offset:0
    ds_read_b64_tr_b16 v[106:107], v10 offset:512
    v_mfma_f32_16x16x32_bf16 v[20:23], v[128:131], v[60:63], v[20:23]
    ds_read_b64_tr_b16 v[48:49], v11 offset:0
    v_mfma_f32_16x16x32_bf16 v[36:39], v[128:131], v[132:135], v[36:39]
    ds_read_b64_tr_b16 v[50:51], v11 offset:512
    ds_read_b64_tr_b16 v[128:129], v12 offset:0
    v_mfma_f32_16x16x32_bf16 v[24:27], v[52:55], v[60:63], v[24:27]
    ds_read_b64_tr_b16 v[130:131], v12 offset:512
    v_mfma_f32_16x16x32_bf16 v[40:43], v[52:55], v[132:135], v[40:43]
    ds_read_b64_tr_b16 v[52:53], v13 offset:0
    ds_read_b64_tr_b16 v[54:55], v13 offset:512
    v_mfma_f32_16x16x32_bf16 v[28:31], v[136:139], v[60:63], v[28:31]
    v_mfma_f32_16x16x32_bf16 v[44:47], v[136:139], v[132:135], v[44:47]
    v_mfma_f32_16x16x32_bf16 v[16:19], v[160:163], v[68:71], v[16:19]
    ds_read_b64_tr_b16 v[60:61], v10 offset:4096
    v_mfma_f32_16x16x32_bf16 v[32:35], v[160:163], v[152:155], v[32:35]
    ds_read_b64_tr_b16 v[62:63], v10 offset:4608
    ds_read_b64_tr_b16 v[136:137], v11 offset:4096
    v_mfma_f32_16x16x32_bf16 v[20:23], v[116:119], v[68:71], v[20:23]
    ds_read_b64_tr_b16 v[138:139], v11 offset:4608
    v_mfma_f32_16x16x32_bf16 v[36:39], v[116:119], v[152:155], v[36:39]
    ds_read_b64_tr_b16 v[132:133], v12 offset:4096
    ds_read_b64_tr_b16 v[134:135], v12 offset:4608
    v_mfma_f32_16x16x32_bf16 v[24:27], v[96:99], v[68:71], v[24:27]
    ds_read_b64_tr_b16 v[160:161], v13 offset:4096
    v_mfma_f32_16x16x32_bf16 v[40:43], v[96:99], v[152:155], v[40:43]
    s_waitcnt lgkmcnt(8)
    ds_read_b64_tr_b16 v[162:163], v13 offset:4608
    v_mfma_f32_16x16x32_bf16 v[28:31], v[72:75], v[68:71], v[28:31]
    v_mfma_f32_16x16x32_bf16 v[44:47], v[72:75], v[152:155], v[44:47]
    s_waitcnt lgkmcnt(14)
    v_mfma_f32_16x16x32_bf16 v[16:19], v[104:107], v[84:87], v[16:19]
    ds_read_b64_tr_b16 v[116:117], v10 offset:24576
    v_mfma_f32_16x16x32_bf16 v[32:35], v[104:107], v[92:95], v[32:35]
    ds_read_b64_tr_b16 v[118:119], v10 offset:25088
    ds_read_b64_tr_b16 v[96:97], v11 offset:24576
    s_waitcnt lgkmcnt(15)
    v_mfma_f32_16x16x32_bf16 v[20:23], v[48:51], v[84:87], v[20:23]
    ds_read_b64_tr_b16 v[98:99], v11 offset:25088
    v_mfma_f32_16x16x32_bf16 v[36:39], v[48:51], v[92:95], v[36:39]
    ds_read_b64_tr_b16 v[68:69], v12 offset:24576
    ds_read_b64_tr_b16 v[70:71], v12 offset:25088
    s_waitcnt lgkmcnt(15)
    v_mfma_f32_16x16x32_bf16 v[24:27], v[128:131], v[84:87], v[24:27]
    s_waitcnt lgkmcnt(8)
    ds_read_b64_tr_b16 v[72:73], v13 offset:24576
    v_mfma_f32_16x16x32_bf16 v[40:43], v[128:131], v[92:95], v[40:43]
    ds_read_b64_tr_b16 v[74:75], v13 offset:25088
    s_waitcnt lgkmcnt(15)
    v_mfma_f32_16x16x32_bf16 v[28:31], v[52:55], v[84:87], v[28:31]
    v_mfma_f32_16x16x32_bf16 v[44:47], v[52:55], v[92:95], v[44:47]
    s_waitcnt lgkmcnt(14)
    v_mfma_f32_16x16x32_bf16 v[16:19], v[60:63], v[100:103], v[16:19]
    ds_read_b64_tr_b16 v[152:153], v10 offset:28672
    v_mfma_f32_16x16x32_bf16 v[32:35], v[60:63], v[108:111], v[32:35]
    ds_read_b64_tr_b16 v[154:155], v10 offset:29184
    ds_read_b64_tr_b16 v[104:105], v11 offset:28672
    s_waitcnt lgkmcnt(15)
    v_mfma_f32_16x16x32_bf16 v[20:23], v[136:139], v[100:103], v[20:23]
    ds_read_b64_tr_b16 v[106:107], v11 offset:29184
    v_mfma_f32_16x16x32_bf16 v[36:39], v[136:139], v[108:111], v[36:39]
    ds_read_b64_tr_b16 v[48:49], v12 offset:28672
    s_waitcnt lgkmcnt(8)
    ds_read_b64_tr_b16 v[50:51], v12 offset:29184
    s_waitcnt lgkmcnt(15)
    v_mfma_f32_16x16x32_bf16 v[24:27], v[132:135], v[100:103], v[24:27]
    ds_read_b64_tr_b16 v[128:129], v13 offset:28672
    v_mfma_f32_16x16x32_bf16 v[40:43], v[132:135], v[108:111], v[40:43]
    ds_read_b64_tr_b16 v[130:131], v13 offset:29184
    s_waitcnt lgkmcnt(15)
    v_mfma_f32_16x16x32_bf16 v[28:31], v[160:163], v[100:103], v[28:31]
    v_mfma_f32_16x16x32_bf16 v[44:47], v[160:163], v[108:111], v[44:47]
    s_waitcnt lgkmcnt(14)
    v_mfma_f32_16x16x32_bf16 v[16:19], v[116:119], v[56:59], v[16:19]
    ds_read_b64_tr_b16 v[84:85], v10 offset:16384
    v_mfma_f32_16x16x32_bf16 v[32:35], v[116:119], v[124:127], v[32:35]
    ds_read_b64_tr_b16 v[86:87], v10 offset:16896
    ds_read_b64_tr_b16 v[52:53], v11 offset:16384
    s_waitcnt lgkmcnt(15)
    v_mfma_f32_16x16x32_bf16 v[20:23], v[96:99], v[56:59], v[20:23]
    ds_read_b64_tr_b16 v[54:55], v11 offset:16896
    v_mfma_f32_16x16x32_bf16 v[36:39], v[96:99], v[124:127], v[36:39]
    s_waitcnt lgkmcnt(8)
    ds_read_b64_tr_b16 v[92:93], v12 offset:16384
    ds_read_b64_tr_b16 v[94:95], v12 offset:16896
    s_waitcnt lgkmcnt(15)
    v_mfma_f32_16x16x32_bf16 v[24:27], v[68:71], v[56:59], v[24:27]
    ds_read_b64_tr_b16 v[60:61], v13 offset:16384
    v_mfma_f32_16x16x32_bf16 v[40:43], v[68:71], v[124:127], v[40:43]
    ds_read_b64_tr_b16 v[62:63], v13 offset:16896
    s_waitcnt lgkmcnt(15)
    v_mfma_f32_16x16x32_bf16 v[28:31], v[72:75], v[56:59], v[28:31]
    v_mfma_f32_16x16x32_bf16 v[44:47], v[72:75], v[124:127], v[44:47]
    s_waitcnt lgkmcnt(14)
    v_mfma_f32_16x16x32_bf16 v[16:19], v[152:155], v[76:79], v[16:19]
    ds_read_b64_tr_b16 v[136:137], v10 offset:20480
    v_mfma_f32_16x16x32_bf16 v[32:35], v[152:155], v[148:151], v[32:35]
    ds_read_b64_tr_b16 v[138:139], v10 offset:20992
    ds_read_b64_tr_b16 v[132:133], v11 offset:20480
    s_waitcnt lgkmcnt(15)
    v_mfma_f32_16x16x32_bf16 v[20:23], v[104:107], v[76:79], v[20:23]
    s_waitcnt lgkmcnt(8)
    ds_read_b64_tr_b16 v[134:135], v11 offset:20992
    v_mfma_f32_16x16x32_bf16 v[36:39], v[104:107], v[148:151], v[36:39]
    ds_read_b64_tr_b16 v[100:101], v12 offset:20480
    ds_read_b64_tr_b16 v[102:103], v12 offset:20992
    s_waitcnt lgkmcnt(15)
    v_mfma_f32_16x16x32_bf16 v[24:27], v[48:51], v[76:79], v[24:27]
    ds_read_b64_tr_b16 v[160:161], v13 offset:20480
    v_mfma_f32_16x16x32_bf16 v[40:43], v[48:51], v[148:151], v[40:43]
    ds_read_b64_tr_b16 v[162:163], v13 offset:20992
    s_waitcnt lgkmcnt(15)
    v_mfma_f32_16x16x32_bf16 v[28:31], v[128:131], v[76:79], v[28:31]
    v_mfma_f32_16x16x32_bf16 v[44:47], v[128:131], v[148:151], v[44:47]
    s_waitcnt lgkmcnt(14)
    v_mfma_f32_16x16x32_bf16 v[16:19], v[84:87], v[88:91], v[16:19]
    ds_read_b64_tr_b16 v[108:109], v10 offset:32768
    v_mfma_f32_16x16x32_bf16 v[32:35], v[84:87], v[64:67], v[32:35]
    ds_read_b64_tr_b16 v[110:111], v10 offset:33280
    s_waitcnt lgkmcnt(8)
    ds_read_b64_tr_b16 v[116:117], v11 offset:32768
    s_waitcnt lgkmcnt(15)
    v_mfma_f32_16x16x32_bf16 v[20:23], v[52:55], v[88:91], v[20:23]
    ds_read_b64_tr_b16 v[118:119], v11 offset:33280
    v_mfma_f32_16x16x32_bf16 v[36:39], v[52:55], v[64:67], v[36:39]
    ds_read_b64_tr_b16 v[96:97], v12 offset:32768
    ds_read_b64_tr_b16 v[98:99], v12 offset:33280
    s_waitcnt lgkmcnt(15)
    v_mfma_f32_16x16x32_bf16 v[24:27], v[92:95], v[88:91], v[24:27]
    ds_read_b64_tr_b16 v[68:69], v13 offset:32768
    v_mfma_f32_16x16x32_bf16 v[40:43], v[92:95], v[64:67], v[40:43]
    ds_read_b64_tr_b16 v[70:71], v13 offset:33280
    s_waitcnt lgkmcnt(15)
    v_mfma_f32_16x16x32_bf16 v[28:31], v[60:63], v[88:91], v[28:31]
    v_mfma_f32_16x16x32_bf16 v[44:47], v[60:63], v[64:67], v[44:47]
    s_waitcnt lgkmcnt(14)
    v_mfma_f32_16x16x32_bf16 v[16:19], v[136:139], v[80:83], v[16:19]
    ds_read_b64_tr_b16 v[56:57], v10 offset:36864
    v_mfma_f32_16x16x32_bf16 v[32:35], v[136:139], v[112:115], v[32:35]
    s_waitcnt lgkmcnt(8)
    ds_read_b64_tr_b16 v[58:59], v10 offset:37376
    ds_read_b64_tr_b16 v[72:73], v11 offset:36864
    s_waitcnt lgkmcnt(15)
    v_mfma_f32_16x16x32_bf16 v[20:23], v[132:135], v[80:83], v[20:23]
    ds_read_b64_tr_b16 v[74:75], v11 offset:37376
    v_mfma_f32_16x16x32_bf16 v[36:39], v[132:135], v[112:115], v[36:39]
    ds_read_b64_tr_b16 v[124:125], v12 offset:36864
    ds_read_b64_tr_b16 v[126:127], v12 offset:37376
    s_waitcnt lgkmcnt(15)
    v_mfma_f32_16x16x32_bf16 v[24:27], v[100:103], v[80:83], v[24:27]
    ds_read_b64_tr_b16 v[152:153], v13 offset:36864
    v_mfma_f32_16x16x32_bf16 v[40:43], v[100:103], v[112:115], v[40:43]
    ds_read_b64_tr_b16 v[154:155], v13 offset:37376
    s_waitcnt lgkmcnt(15)
    v_mfma_f32_16x16x32_bf16 v[28:31], v[160:163], v[80:83], v[28:31]
    v_mfma_f32_16x16x32_bf16 v[44:47], v[160:163], v[112:115], v[44:47]
    s_waitcnt lgkmcnt(14)
    v_mfma_f32_16x16x32_bf16 v[16:19], v[108:111], v[140:143], v[16:19]
    ds_read2_b32 v[112:113], v14 offset0:0 offset1:0
    s_waitcnt lgkmcnt(8)
    ds_read2_b32 v[114:115], v14 offset0:16 offset1:16
    v_mfma_f32_16x16x32_bf16 v[32:35], v[108:111], v[120:123], v[32:35]
    s_waitcnt lgkmcnt(14)
    v_mfma_f32_16x16x32_bf16 v[20:23], v[116:119], v[140:143], v[20:23]
    s_waitcnt lgkmcnt(2)
    v_mov_b32 v165, 10
    s_mov_b64 exec, 1
    ds_write_b32 v4, v165 offset:0
    s_mov_b64 exec, -1
    v_mfma_f32_16x16x32_bf16 v[36:39], v[116:119], v[120:123], v[36:39]
    v_mfma_f32_16x16x32_bf16 v[24:27], v[96:99], v[140:143], v[24:27]
    v_mfma_f32_16x16x32_bf16 v[40:43], v[96:99], v[120:123], v[40:43]
    v_mfma_f32_16x16x32_bf16 v[28:31], v[68:71], v[140:143], v[28:31]
    v_mfma_f32_16x16x32_bf16 v[44:47], v[68:71], v[120:123], v[44:47]
    v_mfma_f32_16x16x32_bf16 v[16:19], v[56:59], v[144:147], v[16:19]
    v_mfma_f32_16x16x32_bf16 v[32:35], v[56:59], v[156:159], v[32:35]
    v_mfma_f32_16x16x32_bf16 v[20:23], v[72:75], v[144:147], v[20:23]
    v_mfma_f32_16x16x32_bf16 v[36:39], v[72:75], v[156:159], v[36:39]
    v_mfma_f32_16x16x32_bf16 v[24:27], v[124:127], v[144:147], v[24:27]
    v_mfma_f32_16x16x32_bf16 v[40:43], v[124:127], v[156:159], v[40:43]
    v_mfma_f32_16x16x32_bf16 v[28:31], v[152:155], v[144:147], v[28:31]
    v_mfma_f32_16x16x32_bf16 v[44:47], v[152:155], v[156:159], v[44:47]
    s_branch IW_s2
IW_w2:
    s_branch IW_r2
IW_s2:
    s_setprio 3
    v_lshlrev_b32 v6, 4, v0
    v_lshlrev_b32 v8, 2, v0
    v_add_u32 v8, 40960, v8
    v_mov_b32 v11, 0x35c1a2a0

    s_waitcnt lgkmcnt(2)
    v_pk_mul_f32 v[16:17], v[16:17], v[112:113]
    v_pk_mul_f32 v[18:19], v[18:19], v[112:113]
    v_pk_mul_f32 v[20:21], v[20:21], v[112:113]
    v_pk_mul_f32 v[22:23], v[22:23], v[112:113]
    v_pk_mul_f32 v[24:25], v[24:25], v[112:113]
    v_pk_mul_f32 v[26:27], v[26:27], v[112:113]
    v_pk_mul_f32 v[28:29], v[28:29], v[112:113]
    v_pk_mul_f32 v[30:31], v[30:31], v[112:113]
    s_waitcnt lgkmcnt(1)
    v_pk_mul_f32 v[32:33], v[32:33], v[114:115]
    v_pk_mul_f32 v[34:35], v[34:35], v[114:115]
    v_pk_mul_f32 v[36:37], v[36:37], v[114:115]
    v_pk_mul_f32 v[38:39], v[38:39], v[114:115]
    v_pk_mul_f32 v[40:41], v[40:41], v[114:115]
    v_pk_mul_f32 v[42:43], v[42:43], v[114:115]
    v_pk_mul_f32 v[44:45], v[44:45], v[114:115]
    v_pk_mul_f32 v[46:47], v[46:47], v[114:115]
    v_exp_f32 v80, v16 clamp
    v_exp_f32 v81, v17 clamp
    v_exp_f32 v82, v18 clamp
    v_exp_f32 v83, v19 clamp
    v_exp_f32 v84, v20 clamp
    v_exp_f32 v85, v21 clamp
    v_exp_f32 v86, v22 clamp
    v_exp_f32 v87, v23 clamp
    v_exp_f32 v88, v24 clamp
    v_exp_f32 v89, v25 clamp
    v_exp_f32 v90, v26 clamp
    v_exp_f32 v91, v27 clamp
    v_exp_f32 v92, v28 clamp
    v_exp_f32 v93, v29 clamp
    v_exp_f32 v94, v30 clamp
    v_exp_f32 v95, v31 clamp
    v_exp_f32 v96, v32 clamp
    v_exp_f32 v97, v33 clamp
    v_exp_f32 v98, v34 clamp
    v_exp_f32 v99, v35 clamp
    v_exp_f32 v100, v36 clamp
    v_exp_f32 v101, v37 clamp
    v_exp_f32 v102, v38 clamp
    v_exp_f32 v103, v39 clamp
    v_exp_f32 v104, v40 clamp
    v_exp_f32 v105, v41 clamp
    v_exp_f32 v106, v42 clamp
    v_exp_f32 v107, v43 clamp
    v_exp_f32 v108, v44 clamp
    v_exp_f32 v109, v45 clamp
    v_exp_f32 v110, v46 clamp
    v_exp_f32 v111, v47 clamp
    v_pk_mul_f32 v[16:17], v[16:17], s[40:41] clamp
    v_pk_mul_f32 v[18:19], v[18:19], s[40:41] clamp
    v_pk_mul_f32 v[20:21], v[20:21], s[40:41] clamp
    v_pk_mul_f32 v[22:23], v[22:23], s[40:41] clamp
    v_pk_mul_f32 v[24:25], v[24:25], s[40:41] clamp
    v_pk_mul_f32 v[26:27], v[26:27], s[40:41] clamp
    v_pk_mul_f32 v[28:29], v[28:29], s[40:41] clamp
    v_pk_mul_f32 v[30:31], v[30:31], s[40:41] clamp
    v_pk_mul_f32 v[32:33], v[32:33], s[40:41] clamp
    v_pk_mul_f32 v[34:35], v[34:35], s[40:41] clamp
    v_pk_mul_f32 v[36:37], v[36:37], s[40:41] clamp
    v_pk_mul_f32 v[38:39], v[38:39], s[40:41] clamp
    v_pk_mul_f32 v[40:41], v[40:41], s[40:41] clamp
    v_pk_mul_f32 v[42:43], v[42:43], s[40:41] clamp
    v_pk_mul_f32 v[44:45], v[44:45], s[40:41] clamp
    v_pk_mul_f32 v[46:47], v[46:47], s[40:41] clamp
    v_pk_add_f32 v[80:81], v[80:81], s[74:75]
    v_pk_add_f32 v[82:83], v[82:83], s[74:75]
    v_pk_add_f32 v[84:85], v[84:85], s[74:75]
    v_pk_add_f32 v[86:87], v[86:87], s[74:75]
    v_pk_add_f32 v[88:89], v[88:89], s[74:75]
    v_pk_add_f32 v[90:91], v[90:91], s[74:75]
    v_pk_add_f32 v[92:93], v[92:93], s[74:75]
    v_pk_add_f32 v[94:95], v[94:95], s[74:75]
    v_pk_add_f32 v[96:97], v[96:97], s[74:75]
    v_pk_add_f32 v[98:99], v[98:99], s[74:75]
    v_pk_add_f32 v[100:101], v[100:101], s[74:75]
    v_pk_add_f32 v[102:103], v[102:103], s[74:75]
    v_pk_add_f32 v[104:105], v[104:105], s[74:75]
    v_pk_add_f32 v[106:107], v[106:107], s[74:75]
    v_pk_add_f32 v[108:109], v[108:109], s[74:75]
    v_pk_add_f32 v[110:111], v[110:111], s[74:75]
    v_pk_fma_f32 v[16:17], v[16:17], s[76:77], v[80:81]
    v_pk_fma_f32 v[18:19], v[18:19], s[76:77], v[82:83]
    v_pk_fma_f32 v[20:21], v[20:21], s[76:77], v[84:85]
    v_pk_fma_f32 v[22:23], v[22:23], s[76:77], v[86:87]
    v_pk_fma_f32 v[24:25], v[24:25], s[76:77], v[88:89]
    v_pk_fma_f32 v[26:27], v[26:27], s[76:77], v[90:91]
    v_pk_fma_f32 v[28:29], v[28:29], s[76:77], v[92:93]
    v_pk_fma_f32 v[30:31], v[30:31], s[76:77], v[94:95]
    v_pk_fma_f32 v[32:33], v[32:33], s[76:77], v[96:97]
    v_pk_fma_f32 v[34:35], v[34:35], s[76:77], v[98:99]
    v_pk_fma_f32 v[36:37], v[36:37], s[76:77], v[100:101]
    v_pk_fma_f32 v[38:39], v[38:39], s[76:77], v[102:103]
    v_pk_fma_f32 v[40:41], v[40:41], s[76:77], v[104:105]
    v_pk_fma_f32 v[42:43], v[42:43], s[76:77], v[106:107]
    v_pk_fma_f32 v[44:45], v[44:45], s[76:77], v[108:109]
    v_pk_fma_f32 v[46:47], v[46:47], s[76:77], v[110:111]
    v_cvt_pk_bf16_f32 v112, v16, v17
    v_cvt_pk_bf16_f32 v113, v18, v19
    v_cvt_pk_bf16_f32 v114, v20, v21
    v_cvt_pk_bf16_f32 v115, v22, v23
    v_cvt_pk_bf16_f32 v116, v24, v25
    v_cvt_pk_bf16_f32 v117, v26, v27
    v_cvt_pk_bf16_f32 v118, v28, v29
    v_cvt_pk_bf16_f32 v119, v30, v31
    v_cvt_pk_bf16_f32 v120, v32, v33
    v_cvt_pk_bf16_f32 v121, v34, v35
    v_cvt_pk_bf16_f32 v122, v36, v37
    v_cvt_pk_bf16_f32 v123, v38, v39
    v_cvt_pk_bf16_f32 v124, v40, v41
    v_cvt_pk_bf16_f32 v125, v42, v43
    v_cvt_pk_bf16_f32 v126, v44, v45
    v_cvt_pk_bf16_f32 v127, v46, v47
    s_waitcnt lgkmcnt(0)
    v_and_b32 v9, 0xfffffff7, v1
    v_and_b32 v5, 0x30, v0
    v_add_u32 v5, 159232, v5
    ds_read_b32 v7, v9 offset:128
FW_9:
    s_waitcnt lgkmcnt(0)
    v_cmp_gt_u32 vcc, 1, v7
    s_cbranch_vccz FO_10
    s_sleep 1
    ds_read_b32 v7, v9 offset:128
    s_branch FW_9
FO_10:
    ds_read_b32 v7, v9 offset:128
FW_11:
    s_waitcnt lgkmcnt(0)
    v_cmp_gt_u32 vcc, 2, v7
    s_cbranch_vccz FO_12
    ds_read_b32 v7, v9 offset:128
    s_branch FW_11
FO_12:
    ds_read_b128 v[32:35], v5 offset:0
    ds_read_b128 v[36:39], v5 offset:64
    ds_read2st64_b32 v[16:17], v8 offset0:0 offset1:1
    ds_read2st64_b32 v[18:19], v8 offset0:2 offset1:3
    ds_read2st64_b32 v[20:21], v8 offset0:4 offset1:5
    ds_read2st64_b32 v[22:23], v8 offset0:6 offset1:7
    ds_read2st64_b32 v[24:25], v8 offset0:16 offset1:17
    ds_read2st64_b32 v[26:27], v8 offset0:18 offset1:19
    ds_read2st64_b32 v[28:29], v8 offset0:20 offset1:21
    ds_read2st64_b32 v[30:31], v8 offset0:22 offset1:23
    s_waitcnt lgkmcnt(5)
    ds_read_b128 v[56:59], v5 offset:128
    ds_read_b128 v[60:63], v5 offset:192
    ds_read2st64_b32 v[40:41], v8 offset0:8 offset1:9
    ds_read2st64_b32 v[42:43], v8 offset0:10 offset1:11
    ds_read2st64_b32 v[44:45], v8 offset0:12 offset1:13
    ds_read2st64_b32 v[46:47], v8 offset0:14 offset1:15
    ds_read2st64_b32 v[48:49], v8 offset0:24 offset1:25
    ds_read2st64_b32 v[50:51], v8 offset0:26 offset1:27
    ds_read2st64_b32 v[52:53], v8 offset0:28 offset1:29
    ds_read2st64_b32 v[54:55], v8 offset0:30 offset1:31
    s_waitcnt lgkmcnt(10)
    v_cvt_pk_bf16_f32 v136, v32, v33
    v_cvt_pk_bf16_f32 v137, v34, v35
    v_cvt_pk_bf16_f32 v138, v36, v37
    v_cvt_pk_bf16_f32 v139, v38, v39
    s_nop 1
    v_mfma_f32_16x16x32_bf16 v[72:75], v[136:139], v[112:115], 0
    v_mfma_f32_16x16x32_bf16 v[84:87], v[136:139], v[120:123], 0
    v_cvt_pk_bf16_f32 v128, v16, v17
    v_cvt_pk_bf16_f32 v129, v18, v19
    v_cvt_pk_bf16_f32 v130, v20, v21
    v_cvt_pk_bf16_f32 v131, v22, v23
    s_nop 1
    v_mfma_f32_16x16x32_bf16 v[64:67], v[128:131], v[112:115], 0
    v_mfma_f32_16x16x32_bf16 v[76:79], v[128:131], v[120:123], 0
    v_cvt_pk_bf16_f32 v132, v24, v25
    v_cvt_pk_bf16_f32 v133, v26, v27
    v_cvt_pk_bf16_f32 v134, v28, v29
    v_cvt_pk_bf16_f32 v135, v30, v31
    s_nop 1
    v_mfma_f32_16x16x32_bf16 v[68:71], v[132:135], v[112:115], 0
    v_mfma_f32_16x16x32_bf16 v[80:83], v[132:135], v[120:123], 0
    s_waitcnt lgkmcnt(0)
    v_cvt_pk_bf16_f32 v148, v56, v57
    v_cvt_pk_bf16_f32 v149, v58, v59
    v_cvt_pk_bf16_f32 v150, v60, v61
    v_cvt_pk_bf16_f32 v151, v62, v63
    v_fma_f32 v72, v72, s46, v11
    v_rcp_f32 v72, v72
    v_fma_f32 v84, v84, s46, v11
    v_rcp_f32 v84, v84
    v_mfma_f32_16x16x32_bf16 v[96:99], v[148:151], v[116:119], 0
    v_mfma_f32_16x16x32_bf16 v[108:111], v[148:151], v[124:127], 0
    v_cvt_pk_bf16_f32 v140, v40, v41
    v_cvt_pk_bf16_f32 v141, v42, v43
    v_cvt_pk_bf16_f32 v142, v44, v45
    v_cvt_pk_bf16_f32 v143, v46, v47
    s_nop 1
    v_mfma_f32_16x16x32_bf16 v[88:91], v[140:143], v[116:119], 0
    v_mfma_f32_16x16x32_bf16 v[100:103], v[140:143], v[124:127], 0
    v_mul_f32 v64, v64, v72
    v_mul_f32 v65, v65, v72
    v_mul_f32 v66, v66, v72
    v_mul_f32 v67, v67, v72
    v_mul_f32 v68, v68, v72
    v_mul_f32 v69, v69, v72
    v_mul_f32 v70, v70, v72
    v_mul_f32 v71, v71, v72
    v_cvt_pk_bf16_f32 v16, v64, v65
    v_cvt_pk_bf16_f32 v17, v66, v67
    v_cvt_pk_bf16_f32 v18, v68, v69
    v_cvt_pk_bf16_f32 v19, v70, v71
    buffer_store_dwordx4 v[16:19], v6, s[16:19], s79 offen offset:0 sc0 sc1
    v_cvt_pk_bf16_f32 v144, v48, v49
    v_cvt_pk_bf16_f32 v145, v50, v51
    v_cvt_pk_bf16_f32 v146, v52, v53
    v_cvt_pk_bf16_f32 v147, v54, v55
    s_nop 1
    v_mfma_f32_16x16x32_bf16 v[92:95], v[144:147], v[116:119], 0
    v_mfma_f32_16x16x32_bf16 v[104:107], v[144:147], v[124:127], 0
    v_mul_f32 v76, v76, v84
    v_mul_f32 v77, v77, v84
    v_mul_f32 v78, v78, v84
    v_mul_f32 v79, v79, v84
    v_mul_f32 v80, v80, v84
    v_mul_f32 v81, v81, v84
    v_mul_f32 v82, v82, v84
    v_mul_f32 v83, v83, v84
    v_cvt_pk_bf16_f32 v20, v76, v77
    v_cvt_pk_bf16_f32 v21, v78, v79
    v_cvt_pk_bf16_f32 v22, v80, v81
    v_cvt_pk_bf16_f32 v23, v82, v83
    buffer_store_dwordx4 v[20:23], v6, s[16:19], s80 offen offset:0 sc0 sc1
    v_fma_f32 v96, v96, s46, v11
    v_rcp_f32 v96, v96
    v_fma_f32 v108, v108, s46, v11
    v_rcp_f32 v108, v108
    v_mul_f32 v88, v88, v96
    v_mul_f32 v89, v89, v96
    v_mul_f32 v90, v90, v96
    v_mul_f32 v91, v91, v96
    v_mul_f32 v92, v92, v96
    v_mul_f32 v93, v93, v96
    v_mul_f32 v94, v94, v96
    v_mul_f32 v95, v95, v96
    v_cvt_pk_bf16_f32 v24, v88, v89
    v_cvt_pk_bf16_f32 v25, v90, v91
    v_cvt_pk_bf16_f32 v26, v92, v93
    v_cvt_pk_bf16_f32 v27, v94, v95
    buffer_store_dwordx4 v[24:27], v6, s[16:19], s79 offen offset:1024 sc0 sc1
    v_mul_f32 v100, v100, v108
    v_mul_f32 v101, v101, v108
    v_mul_f32 v102, v102, v108
    v_mul_f32 v103, v103, v108
    v_mul_f32 v104, v104, v108
    v_mul_f32 v105, v105, v108
    v_mul_f32 v106, v106, v108
    v_mul_f32 v107, v107, v108
    v_cvt_pk_bf16_f32 v28, v100, v101
    v_cvt_pk_bf16_f32 v29, v102, v103
    v_cvt_pk_bf16_f32 v30, v104, v105
    v_cvt_pk_bf16_f32 v31, v106, v107
    buffer_store_dwordx4 v[28:31], v6, s[16:19], s80 offen offset:1024 sc0 sc1
    s_mov_b64 exec, 1
    ds_write_b32 v4, v164 offset:144
    s_waitcnt vmcnt(0)
    s_mov_b32 s45, 1
    s_atomic_add s45, s[54:55], 0x0
    s_atomic_add s45, s[54:55], 0x80
    s_atomic_add s45, s[54:55], 0x100
    s_atomic_add s45, s[54:55], 0x180
    ds_add_u32 v4, v164 offset:144
    s_mov_b64 exec, -1
    s_cmp_lg_u32 s3, 0
    s_cbranch_scc1 F_end
    s_setprio 3
    s_lshr_b32 s50, s29, 1
    s_lshl_b32 s50, s50, 2
    s_and_b32 s51, s28, 3
    s_add_u32 s50, s50, s51
    s_lshl_b32 s50, s50, 7
    s_add_u32 s56, s50, 0x845000
    s_add_u32 s56, s72, s56
    s_addc_u32 s57, s73, 0
    v_mov_b32 v2, 159096
    ds_read_b32 v7, v2 offset:0
FW_13:
    s_waitcnt lgkmcnt(0)
    v_cmp_gt_u32 vcc, 1, v7
    s_cbranch_vccz FO_14
    s_sleep 2
    ds_read_b32 v7, v2 offset:0
    s_branch FW_13
FO_14:
    v_and_b32 v2, 7, v0
    v_lshlrev_b32 v2, 2, v2
    v_add_u32 v2, 158976, v2
    ds_read_b32 v2, v2
    s_sub_u32 s51, 15, s28
    s_waitcnt lgkmcnt(0)
    v_bfe_u32 v2, v2, 7, 4
    v_cmp_eq_u32 vcc, s51, v2
    s_cbranch_vccz F_ny

    v_lshrrev_b32 v2, 4, v0
    v_and_b32 v6, 15, v0
    v_lshlrev_b32 v6, 4, v6
    v_lshl_add_u32 v2, v2, 12, v6
    s_lshl_b32 s50, s29, 8
    s_add_u32 s50, s50, 135168

SP_15:
    s_load_dword s58, s[56:57], 0 glc
    s_waitcnt lgkmcnt(0)
    s_cmp_ge_u32 s58, 32
    s_cbranch_scc1 SD_16
    s_sleep 2
    s_branch SP_15
SD_16:
    s_mov_b32 m0, 159744
    s_nop 0
    buffer_load_dwordx4 v2, s[24:27], s50 offen sc0 sc1 lds
    s_add_u32 s50, s50, 16384
    s_add_u32 m0, m0, 1024
    s_nop 0
    buffer_load_dwordx4 v2, s[24:27], s50 offen sc0 sc1 lds
    s_waitcnt vmcnt(0)
    v_mov_b32 v7, 1
    s_mov_b64 exec, 1
    ds_write_b32 v4, v7 offset:96
    s_mov_b64 exec, -1
F_ny:
F_end:
    s_endpgm
F_nl:
    s_sub_u32 s3, s3, 4
    s_setprio 2
    s_lshr_b32 s36, s3, 1
    s_and_b32 s37, s3, 1
    v_and_b32 v1, 15, v0
    v_lshrrev_b32 v2, 4, v0
    v_lshrrev_b32 v3, 1, v1
    v_xor_b32 v3, v3, v2
    v_lshlrev_b32 v3, 4, v3
    v_lshlrev_b32 v1, 7, v1
    s_lshl_b32 s38, s36, 13
    v_add3_u32 v4, v1, v3, s38
    v_xor_b32 v5, 64, v4
    v_add_u32 v6, 0x10000, v4
    v_add_u32 v7, 0x10000, v5
    v_bfe_u32 v1, v0, 2, 2
    v_lshl_add_u32 v3, v2, 3, v1
    v_lshrrev_b32 v1, 1, v1
    v_and_b32 v2, 1, v2
    v_lshl_add_u32 v1, v2, 1, v1
    s_lshl_b32 s38, s37, 1
    s_add_u32 s38, s38, s36
    v_xor_b32 v1, s38, v1
    v_lshlrev_b32 v1, 5, v1
    v_lshl_add_u32 v1, v3, 7, v1
    v_and_b32 v2, 3, v0
    v_lshl_add_u32 v1, v2, 3, v1
    v_add_u32 v8, 0x10000, v1
    v_xor_b32 v9, 32, v8
    v_add_u32 v10, 0x8000, v8
    v_add_u32 v11, 0x8000, v9
    s_mov_b32 s40, 0x21317218
    s_mov_b32 s41, s40
    s_mov_b32 s74, 0x358637bd
    s_mov_b32 s75, s74
    s_mov_b32 s76, 0x5d800000
    s_mov_b32 s77, s76
    v_and_b32 v164, 0x30, v0
    s_lshl_b32 s42, s36, 8
    s_add_u32 s42, s42, 155648
    v_add_u32 v164, s42, v164
    v_and_b32 v165, 15, v0
    v_lshlrev_b32 v165, 2, v165
    s_lshl_b32 s42, s38, 6
    s_add_u32 s42, s42, 158208
    v_add_u32 v165, s42, v165
    s_lshl_b32 s42, s3, 2
    s_add_u32 s42, s42, 159040
    v_mov_b32 v3, s42
    v_lshlrev_b32 v1, 2, v2
    v_add_u32 v1, 159040, v1
    v_xor_b32 v2, 64, v165
    s_lshl_b32 s44, s33, 1
    s_add_u32 s44, s44, s37
    s_mul_i32 s45, s44, 4224
    s_mul_i32 s46, s36, 3072
    s_add_u32 s46, s46, s45
    s_lshl_b32 s47, s36, 10
    s_add_u32 s47, s47, 1024
    s_add_u32 s47, s47, s45
    s_lshl_b32 s48, s36, 6
    s_add_u32 s48, s48, 4096
    s_add_u32 s48, s48, s45
    s_lshl_b32 s49, s44, 10
    s_lshl_b32 s52, s3, 11
    s_add_u32 s52, s52, 65536
    s_lshl_b32 s53, s3, 7
    s_lshl_b32 s43, s36, 6
    s_add_u32 s53, s53, s43
    s_add_u32 s53, s53, 159232
    s_mov_b32 s50, 159068
    s_waitcnt lgkmcnt(0)
    s_lshl_b32 s64, s28, 7
    s_lshl_b32 s65, s3, 5
    s_add_u32 s64, s64, s65
    s_lshl_b32 s42, s64, 11
    s_lshl_b32 s65, s29, 7
    s_add_u32 s42, s42, s65
    s_add_u32 s43, s42, 0x8000
    s_lshl_b32 s66, s44, 1
    s_add_u32 s66, s66, s36
    s_lshl_b32 s66, s66, 4
    s_add_u32 s66, s66, s32
    s_lshl_b32 s66, s66, 10

    s_mov_b32 s12, s4
    s_mov_b32 s13, s5
    s_mov_b32 s14, 0x400000
    s_mov_b32 s15, 0x00020000
    s_mov_b32 s16, s6
    s_mov_b32 s17, s7
    s_mov_b32 s18, 0x600000
    s_mov_b32 s19, 0x00020000
    s_mov_b32 s20, s8
    s_mov_b32 s21, s9
    s_mov_b32 s22, 0x200000
    s_mov_b32 s23, 0x00020000
    s_add_u32 s24, s72, 0x800000
    s_addc_u32 s25, s73, 0
    s_mov_b32 s26, 0x48000
    s_mov_b32 s27, 0x00020000
    s_add_u32 s84, s72, 0xa00000
    s_addc_u32 s85, s73, 0
    s_mov_b32 s86, 0x100000
    s_mov_b32 s87, 0x00020000
    s_barrier
    ds_read_b128 v[12:15], v4 offset:0
    ds_read_b64_tr_b16 v[44:45], v8 offset:0
    ds_read_b64_tr_b16 v[46:47], v8 offset:512
    ds_read_b128 v[16:19], v4 offset:2048
    ds_read_b128 v[20:23], v4 offset:4096
    ds_read_b128 v[24:27], v4 offset:6144
    ds_read_b64_tr_b16 v[48:49], v9 offset:0
    ds_read_b64_tr_b16 v[50:51], v9 offset:512
    ds_read_b64_tr_b16 v[52:53], v8 offset:8192
    ds_read_b64_tr_b16 v[54:55], v8 offset:8704
    ds_read_b64_tr_b16 v[56:57], v9 offset:8192
    ds_read_b64_tr_b16 v[58:59], v9 offset:8704
    s_waitcnt lgkmcnt(9)
    v_mfma_f32_16x16x32_bf16 v[100:103], v[12:15], v[44:47], 0
    ds_read_b128 v[28:31], v5 offset:0
    s_waitcnt lgkmcnt(9)
    v_mfma_f32_16x16x32_bf16 v[104:107], v[16:19], v[44:47], 0
    ds_read_b64_tr_b16 v[60:61], v8 offset:4096
    s_waitcnt lgkmcnt(9)
    v_mfma_f32_16x16x32_bf16 v[108:111], v[20:23], v[44:47], 0
    ds_read_b64_tr_b16 v[62:63], v8 offset:4608
    s_waitcnt lgkmcnt(9)
    v_mfma_f32_16x16x32_bf16 v[112:115], v[24:27], v[44:47], 0
    ds_read_b128 v[32:35], v5 offset:2048
    s_waitcnt lgkmcnt(8)
    v_mfma_f32_16x16x32_bf16 v[116:119], v[12:15], v[48:51], 0
    ds_read_b128 v[36:39], v5 offset:4096
    v_mfma_f32_16x16x32_bf16 v[120:123], v[16:19], v[48:51], 0
    ds_read_b128 v[40:43], v5 offset:6144
    v_mfma_f32_16x16x32_bf16 v[124:127], v[20:23], v[48:51], 0
    ds_read_b64_tr_b16 v[64:65], v9 offset:4096
    v_mfma_f32_16x16x32_bf16 v[128:131], v[24:27], v[48:51], 0
    ds_read_b64_tr_b16 v[66:67], v9 offset:4608
    s_waitcnt lgkmcnt(10)
    v_mfma_f32_16x16x32_bf16 v[132:135], v[12:15], v[52:55], 0
    ds_read_b64_tr_b16 v[44:45], v8 offset:12288
    v_mfma_f32_16x16x32_bf16 v[136:139], v[16:19], v[52:55], 0
    ds_read_b64_tr_b16 v[46:47], v8 offset:12800
    v_mfma_f32_16x16x32_bf16 v[140:143], v[20:23], v[52:55], 0
    ds_read_b64_tr_b16 v[48:49], v9 offset:12288
    v_mfma_f32_16x16x32_bf16 v[144:147], v[24:27], v[52:55], 0
    ds_read_b64_tr_b16 v[50:51], v9 offset:12800
    s_waitcnt lgkmcnt(12)
    v_mfma_f32_16x16x32_bf16 v[148:151], v[12:15], v[56:59], 0
    v_mfma_f32_16x16x32_bf16 v[152:155], v[16:19], v[56:59], 0
    v_mfma_f32_16x16x32_bf16 v[156:159], v[20:23], v[56:59], 0
    v_mfma_f32_16x16x32_bf16 v[160:163], v[24:27], v[56:59], 0
    s_waitcnt lgkmcnt(9)
    v_mfma_f32_16x16x32_bf16 v[100:103], v[28:31], v[60:63], v[100:103]
    s_waitcnt lgkmcnt(8)
    v_mfma_f32_16x16x32_bf16 v[104:107], v[32:35], v[60:63], v[104:107]
    s_waitcnt lgkmcnt(0)
    s_barrier
    v_mfma_f32_16x16x32_bf16 v[108:111], v[36:39], v[60:63], v[108:111]
    ds_read_b128 v[12:15], v4 offset:16384
    v_mfma_f32_16x16x32_bf16 v[112:115], v[40:43], v[60:63], v[112:115]
    ds_read_b64_tr_b16 v[52:53], v8 offset:16384
    v_mfma_f32_16x16x32_bf16 v[116:119], v[28:31], v[64:67], v[116:119]
    ds_read_b64_tr_b16 v[54:55], v8 offset:16896
    v_mfma_f32_16x16x32_bf16 v[120:123], v[32:35], v[64:67], v[120:123]
    ds_read_b128 v[16:19], v4 offset:18432
    v_mfma_f32_16x16x32_bf16 v[124:127], v[36:39], v[64:67], v[124:127]
    ds_read_b128 v[20:23], v4 offset:20480
    v_mfma_f32_16x16x32_bf16 v[128:131], v[40:43], v[64:67], v[128:131]
    ds_read_b128 v[24:27], v4 offset:22528
    v_mfma_f32_16x16x32_bf16 v[132:135], v[28:31], v[44:47], v[132:135]
    ds_read_b64_tr_b16 v[56:57], v9 offset:16384
    v_mfma_f32_16x16x32_bf16 v[136:139], v[32:35], v[44:47], v[136:139]
    ds_read_b64_tr_b16 v[58:59], v9 offset:16896
    v_mfma_f32_16x16x32_bf16 v[140:143], v[36:39], v[44:47], v[140:143]
    ds_read_b64_tr_b16 v[60:61], v8 offset:24576
    v_mfma_f32_16x16x32_bf16 v[144:147], v[40:43], v[44:47], v[144:147]
    ds_read_b64_tr_b16 v[62:63], v8 offset:25088
    v_mfma_f32_16x16x32_bf16 v[148:151], v[28:31], v[48:51], v[148:151]
    ds_read_b64_tr_b16 v[64:65], v9 offset:24576
    v_mfma_f32_16x16x32_bf16 v[152:155], v[32:35], v[48:51], v[152:155]
    ds_read_b64_tr_b16 v[66:67], v9 offset:25088
    v_mfma_f32_16x16x32_bf16 v[156:159], v[36:39], v[48:51], v[156:159]
    v_mfma_f32_16x16x32_bf16 v[160:163], v[40:43], v[48:51], v[160:163]
    s_waitcnt lgkmcnt(9)
    v_mfma_f32_16x16x32_bf16 v[100:103], v[12:15], v[52:55], v[100:103]
    ds_read_b128 v[28:31], v5 offset:16384
    s_waitcnt lgkmcnt(9)
    v_mfma_f32_16x16x32_bf16 v[104:107], v[16:19], v[52:55], v[104:107]
    ds_read_b64_tr_b16 v[44:45], v8 offset:20480
    s_waitcnt lgkmcnt(9)
    v_mfma_f32_16x16x32_bf16 v[108:111], v[20:23], v[52:55], v[108:111]
    ds_read_b64_tr_b16 v[46:47], v8 offset:20992
    s_waitcnt lgkmcnt(9)
    v_mfma_f32_16x16x32_bf16 v[112:115], v[24:27], v[52:55], v[112:115]
    ds_read_b128 v[32:35], v5 offset:18432
    s_waitcnt lgkmcnt(8)
    v_mfma_f32_16x16x32_bf16 v[116:119], v[12:15], v[56:59], v[116:119]
    ds_read_b128 v[36:39], v5 offset:20480
    v_mfma_f32_16x16x32_bf16 v[120:123], v[16:19], v[56:59], v[120:123]
    ds_read_b128 v[40:43], v5 offset:22528
    v_mfma_f32_16x16x32_bf16 v[124:127], v[20:23], v[56:59], v[124:127]
    ds_read_b64_tr_b16 v[48:49], v9 offset:20480
    v_mfma_f32_16x16x32_bf16 v[128:131], v[24:27], v[56:59], v[128:131]
    ds_read_b64_tr_b16 v[50:51], v9 offset:20992
    s_waitcnt lgkmcnt(10)
    v_mfma_f32_16x16x32_bf16 v[132:135], v[12:15], v[60:63], v[132:135]
    ds_read_b64_tr_b16 v[52:53], v8 offset:28672
    v_mfma_f32_16x16x32_bf16 v[136:139], v[16:19], v[60:63], v[136:139]
    ds_read_b64_tr_b16 v[54:55], v8 offset:29184
    v_mfma_f32_16x16x32_bf16 v[140:143], v[20:23], v[60:63], v[140:143]
    ds_read_b64_tr_b16 v[56:57], v9 offset:28672
    v_mfma_f32_16x16x32_bf16 v[144:147], v[24:27], v[60:63], v[144:147]
    ds_read_b64_tr_b16 v[58:59], v9 offset:29184
    s_waitcnt lgkmcnt(12)
    v_mfma_f32_16x16x32_bf16 v[148:151], v[12:15], v[64:67], v[148:151]
    v_mfma_f32_16x16x32_bf16 v[152:155], v[16:19], v[64:67], v[152:155]
    v_mfma_f32_16x16x32_bf16 v[156:159], v[20:23], v[64:67], v[156:159]
    v_mfma_f32_16x16x32_bf16 v[160:163], v[24:27], v[64:67], v[160:163]
    s_waitcnt lgkmcnt(9)
    v_mfma_f32_16x16x32_bf16 v[100:103], v[28:31], v[44:47], v[100:103]
    s_waitcnt lgkmcnt(8)
    v_mfma_f32_16x16x32_bf16 v[104:107], v[32:35], v[44:47], v[104:107]
    s_waitcnt lgkmcnt(0)
    s_barrier
    v_mfma_f32_16x16x32_bf16 v[108:111], v[36:39], v[44:47], v[108:111]
    ds_read_b128 v[12:15], v4 offset:32768
    v_mfma_f32_16x16x32_bf16 v[112:115], v[40:43], v[44:47], v[112:115]
    ds_read_b64_tr_b16 v[60:61], v10 offset:16384
    v_mfma_f32_16x16x32_bf16 v[116:119], v[28:31], v[48:51], v[116:119]
    ds_read_b64_tr_b16 v[62:63], v10 offset:16896
    v_mfma_f32_16x16x32_bf16 v[120:123], v[32:35], v[48:51], v[120:123]
    ds_read_b128 v[16:19], v4 offset:34816
    v_mfma_f32_16x16x32_bf16 v[124:127], v[36:39], v[48:51], v[124:127]
    ds_read_b128 v[20:23], v4 offset:36864
    v_mfma_f32_16x16x32_bf16 v[128:131], v[40:43], v[48:51], v[128:131]
    ds_read_b128 v[24:27], v4 offset:38912
    v_mfma_f32_16x16x32_bf16 v[132:135], v[28:31], v[52:55], v[132:135]
    ds_read_b64_tr_b16 v[64:65], v11 offset:16384
    v_mfma_f32_16x16x32_bf16 v[136:139], v[32:35], v[52:55], v[136:139]
    ds_read_b64_tr_b16 v[66:67], v11 offset:16896
    v_mfma_f32_16x16x32_bf16 v[140:143], v[36:39], v[52:55], v[140:143]
    ds_read_b64_tr_b16 v[44:45], v10 offset:24576
    v_mfma_f32_16x16x32_bf16 v[144:147], v[40:43], v[52:55], v[144:147]
    ds_read_b64_tr_b16 v[46:47], v10 offset:25088
    v_mfma_f32_16x16x32_bf16 v[148:151], v[28:31], v[56:59], v[148:151]
    ds_read_b64_tr_b16 v[48:49], v11 offset:24576
    v_mfma_f32_16x16x32_bf16 v[152:155], v[32:35], v[56:59], v[152:155]
    ds_read_b64_tr_b16 v[50:51], v11 offset:25088
    v_mfma_f32_16x16x32_bf16 v[156:159], v[36:39], v[56:59], v[156:159]
    v_mfma_f32_16x16x32_bf16 v[160:163], v[40:43], v[56:59], v[160:163]
    s_waitcnt lgkmcnt(9)
    v_mfma_f32_16x16x32_bf16 v[100:103], v[12:15], v[60:63], v[100:103]
    ds_read_b128 v[28:31], v5 offset:32768
    s_waitcnt lgkmcnt(9)
    v_mfma_f32_16x16x32_bf16 v[104:107], v[16:19], v[60:63], v[104:107]
    ds_read_b64_tr_b16 v[52:53], v10 offset:20480
    s_waitcnt lgkmcnt(9)
    v_mfma_f32_16x16x32_bf16 v[108:111], v[20:23], v[60:63], v[108:111]
    ds_read_b64_tr_b16 v[54:55], v10 offset:20992
    s_waitcnt lgkmcnt(9)
    v_mfma_f32_16x16x32_bf16 v[112:115], v[24:27], v[60:63], v[112:115]
    ds_read_b128 v[32:35], v5 offset:34816
    s_waitcnt lgkmcnt(8)
    v_mfma_f32_16x16x32_bf16 v[116:119], v[12:15], v[64:67], v[116:119]
    ds_read_b128 v[36:39], v5 offset:36864
    v_mfma_f32_16x16x32_bf16 v[120:123], v[16:19], v[64:67], v[120:123]
    ds_read_b128 v[40:43], v5 offset:38912
    v_mfma_f32_16x16x32_bf16 v[124:127], v[20:23], v[64:67], v[124:127]
    ds_read_b64_tr_b16 v[56:57], v11 offset:20480
    v_mfma_f32_16x16x32_bf16 v[128:131], v[24:27], v[64:67], v[128:131]
    ds_read_b64_tr_b16 v[58:59], v11 offset:20992
    s_waitcnt lgkmcnt(10)
    v_mfma_f32_16x16x32_bf16 v[132:135], v[12:15], v[44:47], v[132:135]
    ds_read_b64_tr_b16 v[60:61], v10 offset:28672
    v_mfma_f32_16x16x32_bf16 v[136:139], v[16:19], v[44:47], v[136:139]
    ds_read_b64_tr_b16 v[62:63], v10 offset:29184
    v_mfma_f32_16x16x32_bf16 v[140:143], v[20:23], v[44:47], v[140:143]
    ds_read_b64_tr_b16 v[64:65], v11 offset:28672
    v_mfma_f32_16x16x32_bf16 v[144:147], v[24:27], v[44:47], v[144:147]
    ds_read_b64_tr_b16 v[66:67], v11 offset:29184
    s_waitcnt lgkmcnt(12)
    v_mfma_f32_16x16x32_bf16 v[148:151], v[12:15], v[48:51], v[148:151]
    v_mfma_f32_16x16x32_bf16 v[152:155], v[16:19], v[48:51], v[152:155]
    v_mfma_f32_16x16x32_bf16 v[156:159], v[20:23], v[48:51], v[156:159]
    v_mfma_f32_16x16x32_bf16 v[160:163], v[24:27], v[48:51], v[160:163]
    s_waitcnt lgkmcnt(9)
    s_branch IW_s3
IW_w3:
    s_branch IW_r3
IW_s3:
    v_mfma_f32_16x16x32_bf16 v[100:103], v[28:31], v[52:55], v[100:103]
    s_waitcnt lgkmcnt(8)
    v_mfma_f32_16x16x32_bf16 v[104:107], v[32:35], v[52:55], v[104:107]
    s_waitcnt lgkmcnt(0)
    s_barrier
    v_mfma_f32_16x16x32_bf16 v[108:111], v[36:39], v[52:55], v[108:111]
    ds_read_b128 v[12:15], v4 offset:49152
    v_mfma_f32_16x16x32_bf16 v[112:115], v[40:43], v[52:55], v[112:115]
    ds_read_b64_tr_b16 v[44:45], v10 offset:32768
    v_mfma_f32_16x16x32_bf16 v[116:119], v[28:31], v[56:59], v[116:119]
    ds_read_b64_tr_b16 v[46:47], v10 offset:33280
    v_mfma_f32_16x16x32_bf16 v[120:123], v[32:35], v[56:59], v[120:123]
    ds_read_b128 v[16:19], v4 offset:51200
    v_mfma_f32_16x16x32_bf16 v[124:127], v[36:39], v[56:59], v[124:127]
    ds_read_b128 v[20:23], v4 offset:53248
    v_mfma_f32_16x16x32_bf16 v[128:131], v[40:43], v[56:59], v[128:131]
    ds_read_b128 v[24:27], v4 offset:55296
    v_mfma_f32_16x16x32_bf16 v[132:135], v[28:31], v[60:63], v[132:135]
    ds_read_b64_tr_b16 v[48:49], v11 offset:32768
    v_mfma_f32_16x16x32_bf16 v[136:139], v[32:35], v[60:63], v[136:139]
    ds_read_b64_tr_b16 v[50:51], v11 offset:33280
    v_mfma_f32_16x16x32_bf16 v[140:143], v[36:39], v[60:63], v[140:143]
    ds_read_b64_tr_b16 v[52:53], v8 offset:0
    v_mfma_f32_16x16x32_bf16 v[144:147], v[40:43], v[60:63], v[144:147]
    ds_read_b64_tr_b16 v[54:55], v8 offset:512
    v_mfma_f32_16x16x32_bf16 v[148:151], v[28:31], v[64:67], v[148:151]
    ds_read_b64_tr_b16 v[56:57], v9 offset:0
    v_mfma_f32_16x16x32_bf16 v[152:155], v[32:35], v[64:67], v[152:155]
    ds_read_b64_tr_b16 v[58:59], v9 offset:512
    v_mfma_f32_16x16x32_bf16 v[156:159], v[36:39], v[64:67], v[156:159]
    v_mfma_f32_16x16x32_bf16 v[160:163], v[40:43], v[64:67], v[160:163]
    s_waitcnt lgkmcnt(9)
    v_mfma_f32_16x16x32_bf16 v[100:103], v[12:15], v[44:47], v[100:103]
    ds_read_b128 v[28:31], v5 offset:49152
    s_waitcnt lgkmcnt(9)
    v_mfma_f32_16x16x32_bf16 v[104:107], v[16:19], v[44:47], v[104:107]
    ds_read_b64_tr_b16 v[60:61], v10 offset:36864
    s_waitcnt lgkmcnt(9)
    v_mfma_f32_16x16x32_bf16 v[108:111], v[20:23], v[44:47], v[108:111]
    ds_read_b64_tr_b16 v[62:63], v10 offset:37376
    s_waitcnt lgkmcnt(9)
    v_mfma_f32_16x16x32_bf16 v[112:115], v[24:27], v[44:47], v[112:115]
    ds_read_b128 v[32:35], v5 offset:51200
    s_waitcnt lgkmcnt(8)
    v_mfma_f32_16x16x32_bf16 v[116:119], v[12:15], v[48:51], v[116:119]
    ds_read_b128 v[36:39], v5 offset:53248
    v_mfma_f32_16x16x32_bf16 v[120:123], v[16:19], v[48:51], v[120:123]
    ds_read_b128 v[40:43], v5 offset:55296
    v_mfma_f32_16x16x32_bf16 v[124:127], v[20:23], v[48:51], v[124:127]
    ds_read_b64_tr_b16 v[64:65], v11 offset:36864
    v_mfma_f32_16x16x32_bf16 v[128:131], v[24:27], v[48:51], v[128:131]
    ds_read_b64_tr_b16 v[66:67], v11 offset:37376
    s_waitcnt lgkmcnt(10)
    v_mfma_f32_16x16x32_bf16 v[132:135], v[12:15], v[52:55], v[132:135]
    ds_read_b64_tr_b16 v[44:45], v8 offset:4096
    v_mfma_f32_16x16x32_bf16 v[136:139], v[16:19], v[52:55], v[136:139]
    ds_read_b64_tr_b16 v[46:47], v8 offset:4608
    v_mfma_f32_16x16x32_bf16 v[140:143], v[20:23], v[52:55], v[140:143]
    ds_read_b64_tr_b16 v[48:49], v9 offset:4096
    v_mfma_f32_16x16x32_bf16 v[144:147], v[24:27], v[52:55], v[144:147]
    ds_read_b64_tr_b16 v[50:51], v9 offset:4608
    s_waitcnt lgkmcnt(12)
    v_mfma_f32_16x16x32_bf16 v[148:151], v[12:15], v[56:59], v[148:151]
    v_mfma_f32_16x16x32_bf16 v[152:155], v[16:19], v[56:59], v[152:155]
    v_mfma_f32_16x16x32_bf16 v[156:159], v[20:23], v[56:59], v[156:159]
    v_mfma_f32_16x16x32_bf16 v[160:163], v[24:27], v[56:59], v[160:163]
    s_waitcnt lgkmcnt(9)
    v_mfma_f32_16x16x32_bf16 v[100:103], v[28:31], v[60:63], v[100:103]
    s_waitcnt lgkmcnt(8)
    v_mfma_f32_16x16x32_bf16 v[104:107], v[32:35], v[60:63], v[104:107]
    s_waitcnt lgkmcnt(0)
    s_barrier
    v_mfma_f32_16x16x32_bf16 v[108:111], v[36:39], v[60:63], v[108:111]
    ds_read_b128 v[12:15], v4 offset:0
    v_mfma_f32_16x16x32_bf16 v[112:115], v[40:43], v[60:63], v[112:115]
    ds_read_b64_tr_b16 v[52:53], v8 offset:8192
    v_mfma_f32_16x16x32_bf16 v[116:119], v[28:31], v[64:67], v[116:119]
    ds_read_b64_tr_b16 v[54:55], v8 offset:8704
    v_mfma_f32_16x16x32_bf16 v[120:123], v[32:35], v[64:67], v[120:123]
    ds_read_b128 v[16:19], v4 offset:2048
    v_mfma_f32_16x16x32_bf16 v[124:127], v[36:39], v[64:67], v[124:127]
    ds_read_b128 v[20:23], v4 offset:4096
    v_mfma_f32_16x16x32_bf16 v[128:131], v[40:43], v[64:67], v[128:131]
    ds_read_b128 v[24:27], v4 offset:6144
    v_mfma_f32_16x16x32_bf16 v[132:135], v[28:31], v[44:47], v[132:135]
    ds_read_b64_tr_b16 v[56:57], v9 offset:8192
    v_mfma_f32_16x16x32_bf16 v[136:139], v[32:35], v[44:47], v[136:139]
    ds_read_b64_tr_b16 v[58:59], v9 offset:8704
    v_mfma_f32_16x16x32_bf16 v[140:143], v[36:39], v[44:47], v[140:143]
    ds_read_b64_tr_b16 v[60:61], v8 offset:16384
    v_mfma_f32_16x16x32_bf16 v[144:147], v[40:43], v[44:47], v[144:147]
    ds_read_b64_tr_b16 v[62:63], v8 offset:16896
    v_mfma_f32_16x16x32_bf16 v[148:151], v[28:31], v[48:51], v[148:151]
    ds_read_b64_tr_b16 v[64:65], v9 offset:16384
    v_mfma_f32_16x16x32_bf16 v[152:155], v[32:35], v[48:51], v[152:155]
    ds_read_b64_tr_b16 v[66:67], v9 offset:16896
    v_mfma_f32_16x16x32_bf16 v[156:159], v[36:39], v[48:51], v[156:159]
    v_mfma_f32_16x16x32_bf16 v[160:163], v[40:43], v[48:51], v[160:163]
    s_waitcnt lgkmcnt(9)
    v_mfma_f32_16x16x32_bf16 v[100:103], v[12:15], v[52:55], v[100:103]
    ds_read_b128 v[28:31], v5 offset:0
    s_waitcnt lgkmcnt(9)
    v_mfma_f32_16x16x32_bf16 v[104:107], v[16:19], v[52:55], v[104:107]
    ds_read_b64_tr_b16 v[44:45], v8 offset:12288
    s_waitcnt lgkmcnt(9)
    v_mfma_f32_16x16x32_bf16 v[108:111], v[20:23], v[52:55], v[108:111]
    ds_read_b64_tr_b16 v[46:47], v8 offset:12800
    s_waitcnt lgkmcnt(9)
    v_mfma_f32_16x16x32_bf16 v[112:115], v[24:27], v[52:55], v[112:115]
    ds_read_b128 v[32:35], v5 offset:2048
    s_waitcnt lgkmcnt(8)
    v_mfma_f32_16x16x32_bf16 v[116:119], v[12:15], v[56:59], v[116:119]
    ds_read_b128 v[36:39], v5 offset:4096
    v_mfma_f32_16x16x32_bf16 v[120:123], v[16:19], v[56:59], v[120:123]
    ds_read_b128 v[40:43], v5 offset:6144
    v_mfma_f32_16x16x32_bf16 v[124:127], v[20:23], v[56:59], v[124:127]
    ds_read_b64_tr_b16 v[48:49], v9 offset:12288
    v_mfma_f32_16x16x32_bf16 v[128:131], v[24:27], v[56:59], v[128:131]
    ds_read_b64_tr_b16 v[50:51], v9 offset:12800
    s_waitcnt lgkmcnt(10)
    v_mfma_f32_16x16x32_bf16 v[132:135], v[12:15], v[60:63], v[132:135]
    ds_read_b64_tr_b16 v[52:53], v8 offset:20480
    v_mfma_f32_16x16x32_bf16 v[136:139], v[16:19], v[60:63], v[136:139]
    ds_read_b64_tr_b16 v[54:55], v8 offset:20992
    v_mfma_f32_16x16x32_bf16 v[140:143], v[20:23], v[60:63], v[140:143]
    ds_read_b64_tr_b16 v[56:57], v9 offset:20480
    v_mfma_f32_16x16x32_bf16 v[144:147], v[24:27], v[60:63], v[144:147]
    ds_read_b64_tr_b16 v[58:59], v9 offset:20992
    s_waitcnt lgkmcnt(12)
    v_mfma_f32_16x16x32_bf16 v[148:151], v[12:15], v[64:67], v[148:151]
    v_mfma_f32_16x16x32_bf16 v[152:155], v[16:19], v[64:67], v[152:155]
    v_mfma_f32_16x16x32_bf16 v[156:159], v[20:23], v[64:67], v[156:159]
    v_mfma_f32_16x16x32_bf16 v[160:163], v[24:27], v[64:67], v[160:163]
    s_waitcnt lgkmcnt(9)
    v_mfma_f32_16x16x32_bf16 v[100:103], v[28:31], v[44:47], v[100:103]
    s_waitcnt lgkmcnt(8)
    v_mfma_f32_16x16x32_bf16 v[104:107], v[32:35], v[44:47], v[104:107]
    s_waitcnt lgkmcnt(0)
    s_barrier
    v_mfma_f32_16x16x32_bf16 v[108:111], v[36:39], v[44:47], v[108:111]
    ds_read_b128 v[12:15], v4 offset:16384
    v_mfma_f32_16x16x32_bf16 v[112:115], v[40:43], v[44:47], v[112:115]
    ds_read_b64_tr_b16 v[60:61], v10 offset:0
    v_mfma_f32_16x16x32_bf16 v[116:119], v[28:31], v[48:51], v[116:119]
    ds_read_b64_tr_b16 v[62:63], v10 offset:512
    v_mfma_f32_16x16x32_bf16 v[120:123], v[32:35], v[48:51], v[120:123]
    ds_read_b128 v[16:19], v4 offset:18432
    v_mfma_f32_16x16x32_bf16 v[124:127], v[36:39], v[48:51], v[124:127]
    ds_read_b128 v[20:23], v4 offset:20480
    v_mfma_f32_16x16x32_bf16 v[128:131], v[40:43], v[48:51], v[128:131]
    ds_read_b128 v[24:27], v4 offset:22528
    v_mfma_f32_16x16x32_bf16 v[132:135], v[28:31], v[52:55], v[132:135]
    ds_read_b64_tr_b16 v[64:65], v11 offset:0
    v_mfma_f32_16x16x32_bf16 v[136:139], v[32:35], v[52:55], v[136:139]
    ds_read_b64_tr_b16 v[66:67], v11 offset:512
    v_mfma_f32_16x16x32_bf16 v[140:143], v[36:39], v[52:55], v[140:143]
    ds_read_b64_tr_b16 v[44:45], v10 offset:8192
    v_mfma_f32_16x16x32_bf16 v[144:147], v[40:43], v[52:55], v[144:147]
    ds_read_b64_tr_b16 v[46:47], v10 offset:8704
    v_mfma_f32_16x16x32_bf16 v[148:151], v[28:31], v[56:59], v[148:151]
    ds_read_b64_tr_b16 v[48:49], v11 offset:8192
    v_mfma_f32_16x16x32_bf16 v[152:155], v[32:35], v[56:59], v[152:155]
    ds_read_b64_tr_b16 v[50:51], v11 offset:8704
    v_mfma_f32_16x16x32_bf16 v[156:159], v[36:39], v[56:59], v[156:159]
    v_mfma_f32_16x16x32_bf16 v[160:163], v[40:43], v[56:59], v[160:163]
    s_waitcnt lgkmcnt(9)
    v_mfma_f32_16x16x32_bf16 v[100:103], v[12:15], v[60:63], v[100:103]
    ds_read_b128 v[28:31], v5 offset:16384
    s_waitcnt lgkmcnt(9)
    v_mfma_f32_16x16x32_bf16 v[104:107], v[16:19], v[60:63], v[104:107]
    ds_read_b64_tr_b16 v[52:53], v10 offset:4096
    s_waitcnt lgkmcnt(9)
    v_mfma_f32_16x16x32_bf16 v[108:111], v[20:23], v[60:63], v[108:111]
    ds_read_b64_tr_b16 v[54:55], v10 offset:4608
    s_waitcnt lgkmcnt(9)
    v_mfma_f32_16x16x32_bf16 v[112:115], v[24:27], v[60:63], v[112:115]
    ds_read_b128 v[32:35], v5 offset:18432
    s_waitcnt lgkmcnt(8)
    v_mfma_f32_16x16x32_bf16 v[116:119], v[12:15], v[64:67], v[116:119]
    ds_read_b128 v[36:39], v5 offset:20480
    v_mfma_f32_16x16x32_bf16 v[120:123], v[16:19], v[64:67], v[120:123]
    ds_read_b128 v[40:43], v5 offset:22528
    v_mfma_f32_16x16x32_bf16 v[124:127], v[20:23], v[64:67], v[124:127]
    ds_read_b64_tr_b16 v[56:57], v11 offset:4096
    v_mfma_f32_16x16x32_bf16 v[128:131], v[24:27], v[64:67], v[128:131]
    ds_read_b64_tr_b16 v[58:59], v11 offset:4608
    s_waitcnt lgkmcnt(10)
    v_mfma_f32_16x16x32_bf16 v[132:135], v[12:15], v[44:47], v[132:135]
    ds_read_b64_tr_b16 v[60:61], v10 offset:12288
    v_mfma_f32_16x16x32_bf16 v[136:139], v[16:19], v[44:47], v[136:139]
    ds_read_b64_tr_b16 v[62:63], v10 offset:12800
    v_mfma_f32_16x16x32_bf16 v[140:143], v[20:23], v[44:47], v[140:143]
    ds_read_b64_tr_b16 v[64:65], v11 offset:12288
    v_mfma_f32_16x16x32_bf16 v[144:147], v[24:27], v[44:47], v[144:147]
    ds_read_b64_tr_b16 v[66:67], v11 offset:12800
    s_waitcnt lgkmcnt(12)
    v_mfma_f32_16x16x32_bf16 v[148:151], v[12:15], v[48:51], v[148:151]
    v_mfma_f32_16x16x32_bf16 v[152:155], v[16:19], v[48:51], v[152:155]
    v_mfma_f32_16x16x32_bf16 v[156:159], v[20:23], v[48:51], v[156:159]
    v_mfma_f32_16x16x32_bf16 v[160:163], v[24:27], v[48:51], v[160:163]
    s_waitcnt lgkmcnt(9)
    v_mfma_f32_16x16x32_bf16 v[100:103], v[28:31], v[52:55], v[100:103]
    s_waitcnt lgkmcnt(8)
    v_mfma_f32_16x16x32_bf16 v[104:107], v[32:35], v[52:55], v[104:107]
    s_waitcnt lgkmcnt(0)
    s_barrier
    v_mfma_f32_16x16x32_bf16 v[108:111], v[36:39], v[52:55], v[108:111]
    ds_read_b128 v[12:15], v4 offset:32768
    v_mfma_f32_16x16x32_bf16 v[112:115], v[40:43], v[52:55], v[112:115]
    ds_read_b64_tr_b16 v[44:45], v10 offset:16384
    v_mfma_f32_16x16x32_bf16 v[116:119], v[28:31], v[56:59], v[116:119]
    ds_read_b64_tr_b16 v[46:47], v10 offset:16896
    v_mfma_f32_16x16x32_bf16 v[120:123], v[32:35], v[56:59], v[120:123]
    ds_read_b128 v[16:19], v4 offset:34816
    v_mfma_f32_16x16x32_bf16 v[124:127], v[36:39], v[56:59], v[124:127]
    ds_read_b128 v[20:23], v4 offset:36864
    v_mfma_f32_16x16x32_bf16 v[128:131], v[40:43], v[56:59], v[128:131]
    ds_read_b128 v[24:27], v4 offset:38912
    v_mfma_f32_16x16x32_bf16 v[132:135], v[28:31], v[60:63], v[132:135]
    ds_read_b64_tr_b16 v[48:49], v11 offset:16384
    v_mfma_f32_16x16x32_bf16 v[136:139], v[32:35], v[60:63], v[136:139]
    ds_read_b64_tr_b16 v[50:51], v11 offset:16896
    v_mfma_f32_16x16x32_bf16 v[140:143], v[36:39], v[60:63], v[140:143]
    ds_read_b64_tr_b16 v[52:53], v10 offset:24576
    v_mfma_f32_16x16x32_bf16 v[144:147], v[40:43], v[60:63], v[144:147]
    ds_read_b64_tr_b16 v[54:55], v10 offset:25088
    v_mfma_f32_16x16x32_bf16 v[148:151], v[28:31], v[64:67], v[148:151]
    ds_read_b64_tr_b16 v[56:57], v11 offset:24576
    v_mfma_f32_16x16x32_bf16 v[152:155], v[32:35], v[64:67], v[152:155]
    ds_read_b64_tr_b16 v[58:59], v11 offset:25088
    v_mfma_f32_16x16x32_bf16 v[156:159], v[36:39], v[64:67], v[156:159]
    v_mfma_f32_16x16x32_bf16 v[160:163], v[40:43], v[64:67], v[160:163]
    s_waitcnt lgkmcnt(9)
    v_mfma_f32_16x16x32_bf16 v[100:103], v[12:15], v[44:47], v[100:103]
    ds_read_b128 v[28:31], v5 offset:32768
    s_waitcnt lgkmcnt(9)
    v_mfma_f32_16x16x32_bf16 v[104:107], v[16:19], v[44:47], v[104:107]
    ds_read_b64_tr_b16 v[60:61], v10 offset:20480
    s_waitcnt lgkmcnt(9)
    v_mfma_f32_16x16x32_bf16 v[108:111], v[20:23], v[44:47], v[108:111]
    ds_read_b64_tr_b16 v[62:63], v10 offset:20992
    s_waitcnt lgkmcnt(9)
    v_mfma_f32_16x16x32_bf16 v[112:115], v[24:27], v[44:47], v[112:115]
    ds_read_b128 v[32:35], v5 offset:34816
    s_waitcnt lgkmcnt(8)
    v_mfma_f32_16x16x32_bf16 v[116:119], v[12:15], v[48:51], v[116:119]
    ds_read_b128 v[36:39], v5 offset:36864
    v_mfma_f32_16x16x32_bf16 v[120:123], v[16:19], v[48:51], v[120:123]
    ds_read_b128 v[40:43], v5 offset:38912
    v_mfma_f32_16x16x32_bf16 v[124:127], v[20:23], v[48:51], v[124:127]
    ds_read_b64_tr_b16 v[64:65], v11 offset:20480
    v_mfma_f32_16x16x32_bf16 v[128:131], v[24:27], v[48:51], v[128:131]
    ds_read_b64_tr_b16 v[66:67], v11 offset:20992
    s_waitcnt lgkmcnt(10)
    v_mfma_f32_16x16x32_bf16 v[132:135], v[12:15], v[52:55], v[132:135]
    ds_read_b64_tr_b16 v[44:45], v10 offset:28672
    v_mfma_f32_16x16x32_bf16 v[136:139], v[16:19], v[52:55], v[136:139]
    ds_read_b64_tr_b16 v[46:47], v10 offset:29184
    v_mfma_f32_16x16x32_bf16 v[140:143], v[20:23], v[52:55], v[140:143]
    ds_read_b64_tr_b16 v[48:49], v11 offset:28672
    v_mfma_f32_16x16x32_bf16 v[144:147], v[24:27], v[52:55], v[144:147]
    ds_read_b64_tr_b16 v[50:51], v11 offset:29184
    s_waitcnt lgkmcnt(12)
    v_mfma_f32_16x16x32_bf16 v[148:151], v[12:15], v[56:59], v[148:151]
    v_mfma_f32_16x16x32_bf16 v[152:155], v[16:19], v[56:59], v[152:155]
    v_mfma_f32_16x16x32_bf16 v[156:159], v[20:23], v[56:59], v[156:159]
    v_mfma_f32_16x16x32_bf16 v[160:163], v[24:27], v[56:59], v[160:163]
    s_waitcnt lgkmcnt(9)
    v_mfma_f32_16x16x32_bf16 v[100:103], v[28:31], v[60:63], v[100:103]
    s_waitcnt lgkmcnt(8)
    v_mfma_f32_16x16x32_bf16 v[104:107], v[32:35], v[60:63], v[104:107]
    s_waitcnt lgkmcnt(0)
    s_barrier
    v_mfma_f32_16x16x32_bf16 v[108:111], v[36:39], v[60:63], v[108:111]
    ds_read_b128 v[12:15], v4 offset:49152
    v_mfma_f32_16x16x32_bf16 v[112:115], v[40:43], v[60:63], v[112:115]
    ds_read_b64_tr_b16 v[52:53], v8 offset:0
    v_mfma_f32_16x16x32_bf16 v[116:119], v[28:31], v[64:67], v[116:119]
    ds_read_b64_tr_b16 v[54:55], v8 offset:512
    v_mfma_f32_16x16x32_bf16 v[120:123], v[32:35], v[64:67], v[120:123]
    ds_read_b128 v[16:19], v4 offset:51200
    v_mfma_f32_16x16x32_bf16 v[124:127], v[36:39], v[64:67], v[124:127]
    ds_read_b128 v[20:23], v4 offset:53248
    v_mfma_f32_16x16x32_bf16 v[128:131], v[40:43], v[64:67], v[128:131]
    ds_read_b128 v[24:27], v4 offset:55296
    v_mfma_f32_16x16x32_bf16 v[132:135], v[28:31], v[44:47], v[132:135]
    ds_read_b64_tr_b16 v[56:57], v9 offset:0
    v_mfma_f32_16x16x32_bf16 v[136:139], v[32:35], v[44:47], v[136:139]
    ds_read_b64_tr_b16 v[58:59], v9 offset:512
    v_mfma_f32_16x16x32_bf16 v[140:143], v[36:39], v[44:47], v[140:143]
    ds_read_b64_tr_b16 v[60:61], v10 offset:32768
    v_mfma_f32_16x16x32_bf16 v[144:147], v[40:43], v[44:47], v[144:147]
    ds_read_b64_tr_b16 v[62:63], v10 offset:33280
    v_mfma_f32_16x16x32_bf16 v[148:151], v[28:31], v[48:51], v[148:151]
    ds_read_b64_tr_b16 v[64:65], v11 offset:32768
    v_mfma_f32_16x16x32_bf16 v[152:155], v[32:35], v[48:51], v[152:155]
    ds_read_b64_tr_b16 v[66:67], v11 offset:33280
    v_mfma_f32_16x16x32_bf16 v[156:159], v[36:39], v[48:51], v[156:159]
    v_mfma_f32_16x16x32_bf16 v[160:163], v[40:43], v[48:51], v[160:163]
    s_waitcnt lgkmcnt(9)
    v_mfma_f32_16x16x32_bf16 v[100:103], v[12:15], v[52:55], v[100:103]
    ds_read_b128 v[28:31], v5 offset:49152
    s_waitcnt lgkmcnt(9)
    v_mfma_f32_16x16x32_bf16 v[104:107], v[16:19], v[52:55], v[104:107]
    ds_read_b64_tr_b16 v[44:45], v8 offset:4096
    s_waitcnt lgkmcnt(9)
    v_mfma_f32_16x16x32_bf16 v[108:111], v[20:23], v[52:55], v[108:111]
    ds_read_b64_tr_b16 v[46:47], v8 offset:4608
    s_waitcnt lgkmcnt(9)
    v_mfma_f32_16x16x32_bf16 v[112:115], v[24:27], v[52:55], v[112:115]
    ds_read_b128 v[32:35], v5 offset:51200
    s_waitcnt lgkmcnt(8)
    v_mfma_f32_16x16x32_bf16 v[116:119], v[12:15], v[56:59], v[116:119]
    ds_read_b128 v[36:39], v5 offset:53248
    v_mfma_f32_16x16x32_bf16 v[120:123], v[16:19], v[56:59], v[120:123]
    ds_read_b128 v[40:43], v5 offset:55296
    v_mfma_f32_16x16x32_bf16 v[124:127], v[20:23], v[56:59], v[124:127]
    ds_read_b64_tr_b16 v[48:49], v9 offset:4096
    v_mfma_f32_16x16x32_bf16 v[128:131], v[24:27], v[56:59], v[128:131]
    ds_read_b64_tr_b16 v[50:51], v9 offset:4608
    s_waitcnt lgkmcnt(10)
    v_mfma_f32_16x16x32_bf16 v[132:135], v[12:15], v[60:63], v[132:135]
    ds_read_b64_tr_b16 v[52:53], v10 offset:36864
    v_mfma_f32_16x16x32_bf16 v[136:139], v[16:19], v[60:63], v[136:139]
    ds_read_b64_tr_b16 v[54:55], v10 offset:37376
    v_mfma_f32_16x16x32_bf16 v[140:143], v[20:23], v[60:63], v[140:143]
    ds_read_b64_tr_b16 v[56:57], v11 offset:36864
    v_mfma_f32_16x16x32_bf16 v[144:147], v[24:27], v[60:63], v[144:147]
    ds_read_b64_tr_b16 v[58:59], v11 offset:37376
    s_waitcnt lgkmcnt(12)
    v_mfma_f32_16x16x32_bf16 v[148:151], v[12:15], v[64:67], v[148:151]
    v_mfma_f32_16x16x32_bf16 v[152:155], v[16:19], v[64:67], v[152:155]
    v_mfma_f32_16x16x32_bf16 v[156:159], v[20:23], v[64:67], v[156:159]
    v_mfma_f32_16x16x32_bf16 v[160:163], v[24:27], v[64:67], v[160:163]
    s_waitcnt lgkmcnt(9)
    v_mfma_f32_16x16x32_bf16 v[100:103], v[28:31], v[44:47], v[100:103]
    s_waitcnt lgkmcnt(8)
    v_mfma_f32_16x16x32_bf16 v[104:107], v[32:35], v[44:47], v[104:107]
    s_waitcnt lgkmcnt(0)
    s_barrier
    v_mfma_f32_16x16x32_bf16 v[108:111], v[36:39], v[44:47], v[108:111]
    ds_read_b128 v[12:15], v4 offset:0
    v_mfma_f32_16x16x32_bf16 v[112:115], v[40:43], v[44:47], v[112:115]
    ds_read_b64_tr_b16 v[60:61], v8 offset:8192
    v_mfma_f32_16x16x32_bf16 v[116:119], v[28:31], v[48:51], v[116:119]
    ds_read_b64_tr_b16 v[62:63], v8 offset:8704
    v_mfma_f32_16x16x32_bf16 v[120:123], v[32:35], v[48:51], v[120:123]
    ds_read_b128 v[16:19], v4 offset:2048
    v_mfma_f32_16x16x32_bf16 v[124:127], v[36:39], v[48:51], v[124:127]
    ds_read_b128 v[20:23], v4 offset:4096
    v_mfma_f32_16x16x32_bf16 v[128:131], v[40:43], v[48:51], v[128:131]
    ds_read_b128 v[24:27], v4 offset:6144
    v_mfma_f32_16x16x32_bf16 v[132:135], v[28:31], v[52:55], v[132:135]
    ds_read_b64_tr_b16 v[64:65], v9 offset:8192
    v_mfma_f32_16x16x32_bf16 v[136:139], v[32:35], v[52:55], v[136:139]
    ds_read_b64_tr_b16 v[66:67], v9 offset:8704
    v_mfma_f32_16x16x32_bf16 v[140:143], v[36:39], v[52:55], v[140:143]
    ds_read_b64_tr_b16 v[44:45], v8 offset:16384
    v_mfma_f32_16x16x32_bf16 v[144:147], v[40:43], v[52:55], v[144:147]
    ds_read_b64_tr_b16 v[46:47], v8 offset:16896
    v_mfma_f32_16x16x32_bf16 v[148:151], v[28:31], v[56:59], v[148:151]
    ds_read_b64_tr_b16 v[48:49], v9 offset:16384
    v_mfma_f32_16x16x32_bf16 v[152:155], v[32:35], v[56:59], v[152:155]
    ds_read_b64_tr_b16 v[50:51], v9 offset:16896
    v_mfma_f32_16x16x32_bf16 v[156:159], v[36:39], v[56:59], v[156:159]
    v_mfma_f32_16x16x32_bf16 v[160:163], v[40:43], v[56:59], v[160:163]
    s_waitcnt lgkmcnt(9)
    v_mfma_f32_16x16x32_bf16 v[100:103], v[12:15], v[60:63], v[100:103]
    ds_read_b128 v[28:31], v5 offset:0
    s_waitcnt lgkmcnt(9)
    v_mfma_f32_16x16x32_bf16 v[104:107], v[16:19], v[60:63], v[104:107]
    ds_read_b64_tr_b16 v[52:53], v8 offset:12288
    s_waitcnt lgkmcnt(9)
    v_mfma_f32_16x16x32_bf16 v[108:111], v[20:23], v[60:63], v[108:111]
    ds_read_b64_tr_b16 v[54:55], v8 offset:12800
    s_waitcnt lgkmcnt(9)
    v_mfma_f32_16x16x32_bf16 v[112:115], v[24:27], v[60:63], v[112:115]
    ds_read_b128 v[32:35], v5 offset:2048
    s_waitcnt lgkmcnt(8)
    v_mfma_f32_16x16x32_bf16 v[116:119], v[12:15], v[64:67], v[116:119]
    ds_read_b128 v[36:39], v5 offset:4096
    v_mfma_f32_16x16x32_bf16 v[120:123], v[16:19], v[64:67], v[120:123]
    ds_read_b128 v[40:43], v5 offset:6144
    v_mfma_f32_16x16x32_bf16 v[124:127], v[20:23], v[64:67], v[124:127]
    ds_read_b64_tr_b16 v[56:57], v9 offset:12288
    v_mfma_f32_16x16x32_bf16 v[128:131], v[24:27], v[64:67], v[128:131]
    ds_read_b64_tr_b16 v[58:59], v9 offset:12800
    s_waitcnt lgkmcnt(10)
    v_mfma_f32_16x16x32_bf16 v[132:135], v[12:15], v[44:47], v[132:135]
    ds_read_b64_tr_b16 v[60:61], v8 offset:20480
    v_mfma_f32_16x16x32_bf16 v[136:139], v[16:19], v[44:47], v[136:139]
    ds_read_b64_tr_b16 v[62:63], v8 offset:20992
    v_mfma_f32_16x16x32_bf16 v[140:143], v[20:23], v[44:47], v[140:143]
    ds_read_b64_tr_b16 v[64:65], v9 offset:20480
    v_mfma_f32_16x16x32_bf16 v[144:147], v[24:27], v[44:47], v[144:147]
    ds_read_b64_tr_b16 v[66:67], v9 offset:20992
    s_waitcnt lgkmcnt(12)
    v_mfma_f32_16x16x32_bf16 v[148:151], v[12:15], v[48:51], v[148:151]
    v_mfma_f32_16x16x32_bf16 v[152:155], v[16:19], v[48:51], v[152:155]
    v_mfma_f32_16x16x32_bf16 v[156:159], v[20:23], v[48:51], v[156:159]
    v_mfma_f32_16x16x32_bf16 v[160:163], v[24:27], v[48:51], v[160:163]
    s_waitcnt lgkmcnt(9)
    v_mfma_f32_16x16x32_bf16 v[100:103], v[28:31], v[52:55], v[100:103]
    s_waitcnt lgkmcnt(8)
    v_mfma_f32_16x16x32_bf16 v[104:107], v[32:35], v[52:55], v[104:107]
    s_waitcnt lgkmcnt(0)
    s_barrier
    v_mfma_f32_16x16x32_bf16 v[108:111], v[36:39], v[52:55], v[108:111]
    ds_read_b128 v[12:15], v4 offset:16384
    v_mfma_f32_16x16x32_bf16 v[112:115], v[40:43], v[52:55], v[112:115]
    ds_read_b64_tr_b16 v[44:45], v8 offset:24576
    v_mfma_f32_16x16x32_bf16 v[116:119], v[28:31], v[56:59], v[116:119]
    ds_read_b64_tr_b16 v[46:47], v8 offset:25088
    v_mfma_f32_16x16x32_bf16 v[120:123], v[32:35], v[56:59], v[120:123]
    ds_read_b128 v[16:19], v4 offset:18432
    v_mfma_f32_16x16x32_bf16 v[124:127], v[36:39], v[56:59], v[124:127]
    ds_read_b128 v[20:23], v4 offset:20480
    v_mfma_f32_16x16x32_bf16 v[128:131], v[40:43], v[56:59], v[128:131]
    ds_read_b128 v[24:27], v4 offset:22528
    v_mfma_f32_16x16x32_bf16 v[132:135], v[28:31], v[60:63], v[132:135]
    ds_read_b64_tr_b16 v[48:49], v9 offset:24576
    v_mfma_f32_16x16x32_bf16 v[136:139], v[32:35], v[60:63], v[136:139]
    ds_read_b64_tr_b16 v[50:51], v9 offset:25088
    v_mfma_f32_16x16x32_bf16 v[140:143], v[36:39], v[60:63], v[140:143]
    ds_read_b64_tr_b16 v[52:53], v10 offset:0
    v_mfma_f32_16x16x32_bf16 v[144:147], v[40:43], v[60:63], v[144:147]
    ds_read_b64_tr_b16 v[54:55], v10 offset:512
    v_mfma_f32_16x16x32_bf16 v[148:151], v[28:31], v[64:67], v[148:151]
    ds_read_b64_tr_b16 v[56:57], v11 offset:0
    v_mfma_f32_16x16x32_bf16 v[152:155], v[32:35], v[64:67], v[152:155]
    ds_read_b64_tr_b16 v[58:59], v11 offset:512
    v_mfma_f32_16x16x32_bf16 v[156:159], v[36:39], v[64:67], v[156:159]
    v_mfma_f32_16x16x32_bf16 v[160:163], v[40:43], v[64:67], v[160:163]
    s_waitcnt lgkmcnt(9)
    v_mfma_f32_16x16x32_bf16 v[100:103], v[12:15], v[44:47], v[100:103]
    ds_read_b128 v[28:31], v5 offset:16384
    s_waitcnt lgkmcnt(9)
    v_mfma_f32_16x16x32_bf16 v[104:107], v[16:19], v[44:47], v[104:107]
    ds_read_b64_tr_b16 v[60:61], v8 offset:28672
    s_waitcnt lgkmcnt(9)
    v_mfma_f32_16x16x32_bf16 v[108:111], v[20:23], v[44:47], v[108:111]
    ds_read_b64_tr_b16 v[62:63], v8 offset:29184
    s_waitcnt lgkmcnt(9)
    v_mfma_f32_16x16x32_bf16 v[112:115], v[24:27], v[44:47], v[112:115]
    ds_read_b128 v[32:35], v5 offset:18432
    s_waitcnt lgkmcnt(8)
    v_mfma_f32_16x16x32_bf16 v[116:119], v[12:15], v[48:51], v[116:119]
    ds_read_b128 v[36:39], v5 offset:20480
    v_mfma_f32_16x16x32_bf16 v[120:123], v[16:19], v[48:51], v[120:123]
    ds_read_b128 v[40:43], v5 offset:22528
    v_mfma_f32_16x16x32_bf16 v[124:127], v[20:23], v[48:51], v[124:127]
    ds_read_b64_tr_b16 v[64:65], v9 offset:28672
    v_mfma_f32_16x16x32_bf16 v[128:131], v[24:27], v[48:51], v[128:131]
    ds_read_b64_tr_b16 v[66:67], v9 offset:29184
    s_waitcnt lgkmcnt(10)
    v_mfma_f32_16x16x32_bf16 v[132:135], v[12:15], v[52:55], v[132:135]
    ds_read_b64_tr_b16 v[44:45], v10 offset:4096
    v_mfma_f32_16x16x32_bf16 v[136:139], v[16:19], v[52:55], v[136:139]
    ds_read_b64_tr_b16 v[46:47], v10 offset:4608
    v_mfma_f32_16x16x32_bf16 v[140:143], v[20:23], v[52:55], v[140:143]
    ds_read_b64_tr_b16 v[48:49], v11 offset:4096
    v_mfma_f32_16x16x32_bf16 v[144:147], v[24:27], v[52:55], v[144:147]
    ds_read_b64_tr_b16 v[50:51], v11 offset:4608
    s_waitcnt lgkmcnt(12)
    v_mfma_f32_16x16x32_bf16 v[148:151], v[12:15], v[56:59], v[148:151]
    v_mfma_f32_16x16x32_bf16 v[152:155], v[16:19], v[56:59], v[152:155]
    v_mfma_f32_16x16x32_bf16 v[156:159], v[20:23], v[56:59], v[156:159]
    v_mfma_f32_16x16x32_bf16 v[160:163], v[24:27], v[56:59], v[160:163]
    s_waitcnt lgkmcnt(9)
    v_mfma_f32_16x16x32_bf16 v[100:103], v[28:31], v[60:63], v[100:103]
    s_waitcnt lgkmcnt(8)
    v_mfma_f32_16x16x32_bf16 v[104:107], v[32:35], v[60:63], v[104:107]
    s_waitcnt lgkmcnt(0)
    s_barrier
    v_mfma_f32_16x16x32_bf16 v[108:111], v[36:39], v[60:63], v[108:111]
    ds_read_b128 v[12:15], v4 offset:32768
    v_mfma_f32_16x16x32_bf16 v[112:115], v[40:43], v[60:63], v[112:115]
    ds_read_b64_tr_b16 v[52:53], v10 offset:16384
    v_mfma_f32_16x16x32_bf16 v[116:119], v[28:31], v[64:67], v[116:119]
    ds_read_b64_tr_b16 v[54:55], v10 offset:16896
    v_mfma_f32_16x16x32_bf16 v[120:123], v[32:35], v[64:67], v[120:123]
    ds_read_b128 v[16:19], v4 offset:34816
    v_mfma_f32_16x16x32_bf16 v[124:127], v[36:39], v[64:67], v[124:127]
    ds_read_b128 v[20:23], v4 offset:36864
    v_mfma_f32_16x16x32_bf16 v[128:131], v[40:43], v[64:67], v[128:131]
    ds_read_b128 v[24:27], v4 offset:38912
    v_mfma_f32_16x16x32_bf16 v[132:135], v[28:31], v[44:47], v[132:135]
    ds_read_b64_tr_b16 v[56:57], v11 offset:16384
    v_mfma_f32_16x16x32_bf16 v[136:139], v[32:35], v[44:47], v[136:139]
    ds_read_b64_tr_b16 v[58:59], v11 offset:16896
    v_mfma_f32_16x16x32_bf16 v[140:143], v[36:39], v[44:47], v[140:143]
    ds_read_b64_tr_b16 v[60:61], v10 offset:24576
    v_mfma_f32_16x16x32_bf16 v[144:147], v[40:43], v[44:47], v[144:147]
    ds_read_b64_tr_b16 v[62:63], v10 offset:25088
    v_mfma_f32_16x16x32_bf16 v[148:151], v[28:31], v[48:51], v[148:151]
    ds_read_b64_tr_b16 v[64:65], v11 offset:24576
    v_mfma_f32_16x16x32_bf16 v[152:155], v[32:35], v[48:51], v[152:155]
    ds_read_b64_tr_b16 v[66:67], v11 offset:25088
    v_mfma_f32_16x16x32_bf16 v[156:159], v[36:39], v[48:51], v[156:159]
    v_mfma_f32_16x16x32_bf16 v[160:163], v[40:43], v[48:51], v[160:163]
    s_waitcnt lgkmcnt(9)
    v_mfma_f32_16x16x32_bf16 v[100:103], v[12:15], v[52:55], v[100:103]
    ds_read_b128 v[28:31], v5 offset:32768
    s_waitcnt lgkmcnt(9)
    v_mfma_f32_16x16x32_bf16 v[104:107], v[16:19], v[52:55], v[104:107]
    ds_read_b64_tr_b16 v[44:45], v10 offset:20480
    s_waitcnt lgkmcnt(9)
    v_mfma_f32_16x16x32_bf16 v[108:111], v[20:23], v[52:55], v[108:111]
    ds_read_b64_tr_b16 v[46:47], v10 offset:20992
    s_waitcnt lgkmcnt(9)
    v_mfma_f32_16x16x32_bf16 v[112:115], v[24:27], v[52:55], v[112:115]
    ds_read_b128 v[32:35], v5 offset:34816
    s_waitcnt lgkmcnt(8)
    v_mfma_f32_16x16x32_bf16 v[116:119], v[12:15], v[56:59], v[116:119]
    ds_read_b128 v[36:39], v5 offset:36864
    v_mfma_f32_16x16x32_bf16 v[120:123], v[16:19], v[56:59], v[120:123]
    ds_read_b128 v[40:43], v5 offset:38912
    v_mfma_f32_16x16x32_bf16 v[124:127], v[20:23], v[56:59], v[124:127]
    ds_read_b64_tr_b16 v[48:49], v11 offset:20480
    v_mfma_f32_16x16x32_bf16 v[128:131], v[24:27], v[56:59], v[128:131]
    ds_read_b64_tr_b16 v[50:51], v11 offset:20992
    s_waitcnt lgkmcnt(10)
    v_mfma_f32_16x16x32_bf16 v[132:135], v[12:15], v[60:63], v[132:135]
    ds_read_b64_tr_b16 v[52:53], v10 offset:28672
    v_mfma_f32_16x16x32_bf16 v[136:139], v[16:19], v[60:63], v[136:139]
    ds_read_b64_tr_b16 v[54:55], v10 offset:29184
    v_mfma_f32_16x16x32_bf16 v[140:143], v[20:23], v[60:63], v[140:143]
    ds_read_b64_tr_b16 v[56:57], v11 offset:28672
    v_mfma_f32_16x16x32_bf16 v[144:147], v[24:27], v[60:63], v[144:147]
    ds_read_b64_tr_b16 v[58:59], v11 offset:29184
    s_waitcnt lgkmcnt(12)
    v_mfma_f32_16x16x32_bf16 v[148:151], v[12:15], v[64:67], v[148:151]
    v_mfma_f32_16x16x32_bf16 v[152:155], v[16:19], v[64:67], v[152:155]
    v_mfma_f32_16x16x32_bf16 v[156:159], v[20:23], v[64:67], v[156:159]
    v_mfma_f32_16x16x32_bf16 v[160:163], v[24:27], v[64:67], v[160:163]
    s_waitcnt lgkmcnt(9)
    v_mfma_f32_16x16x32_bf16 v[100:103], v[28:31], v[44:47], v[100:103]
    s_waitcnt lgkmcnt(8)
    v_mfma_f32_16x16x32_bf16 v[104:107], v[32:35], v[44:47], v[104:107]
    s_waitcnt lgkmcnt(0)
    s_barrier
    v_mfma_f32_16x16x32_bf16 v[108:111], v[36:39], v[44:47], v[108:111]
    ds_read_b128 v[12:15], v4 offset:49152
    v_mfma_f32_16x16x32_bf16 v[112:115], v[40:43], v[44:47], v[112:115]
    ds_read_b64_tr_b16 v[60:61], v8 offset:0
    v_mfma_f32_16x16x32_bf16 v[116:119], v[28:31], v[48:51], v[116:119]
    ds_read_b64_tr_b16 v[62:63], v8 offset:512
    v_mfma_f32_16x16x32_bf16 v[120:123], v[32:35], v[48:51], v[120:123]
    ds_read_b128 v[16:19], v4 offset:51200
    v_mfma_f32_16x16x32_bf16 v[124:127], v[36:39], v[48:51], v[124:127]
    ds_read_b128 v[20:23], v4 offset:53248
    v_mfma_f32_16x16x32_bf16 v[128:131], v[40:43], v[48:51], v[128:131]
    ds_read_b128 v[24:27], v4 offset:55296
    v_mfma_f32_16x16x32_bf16 v[132:135], v[28:31], v[52:55], v[132:135]
    ds_read_b64_tr_b16 v[64:65], v9 offset:0
    v_mfma_f32_16x16x32_bf16 v[136:139], v[32:35], v[52:55], v[136:139]
    ds_read_b64_tr_b16 v[66:67], v9 offset:512
    s_branch IW_s4
IW_w4:
    s_branch IW_r4
IW_s4:
    v_mfma_f32_16x16x32_bf16 v[140:143], v[36:39], v[52:55], v[140:143]
    ds_read_b64_tr_b16 v[44:45], v10 offset:32768
    v_mfma_f32_16x16x32_bf16 v[144:147], v[40:43], v[52:55], v[144:147]
    ds_read_b64_tr_b16 v[46:47], v10 offset:33280
    v_mfma_f32_16x16x32_bf16 v[148:151], v[28:31], v[56:59], v[148:151]
    ds_read_b64_tr_b16 v[48:49], v11 offset:32768
    v_mfma_f32_16x16x32_bf16 v[152:155], v[32:35], v[56:59], v[152:155]
    ds_read_b64_tr_b16 v[50:51], v11 offset:33280
    v_mfma_f32_16x16x32_bf16 v[156:159], v[36:39], v[56:59], v[156:159]
    v_mfma_f32_16x16x32_bf16 v[160:163], v[40:43], v[56:59], v[160:163]
    s_waitcnt lgkmcnt(9)
    v_mfma_f32_16x16x32_bf16 v[100:103], v[12:15], v[60:63], v[100:103]
    ds_read_b128 v[28:31], v5 offset:49152
    s_waitcnt lgkmcnt(9)
    v_mfma_f32_16x16x32_bf16 v[104:107], v[16:19], v[60:63], v[104:107]
    ds_read_b64_tr_b16 v[52:53], v8 offset:4096
    s_waitcnt lgkmcnt(9)
    v_mfma_f32_16x16x32_bf16 v[108:111], v[20:23], v[60:63], v[108:111]
    ds_read_b64_tr_b16 v[54:55], v8 offset:4608
    s_waitcnt lgkmcnt(9)
    v_mfma_f32_16x16x32_bf16 v[112:115], v[24:27], v[60:63], v[112:115]
    ds_read_b128 v[32:35], v5 offset:51200
    s_waitcnt lgkmcnt(8)
    v_mfma_f32_16x16x32_bf16 v[116:119], v[12:15], v[64:67], v[116:119]
    ds_read_b128 v[36:39], v5 offset:53248
    v_mfma_f32_16x16x32_bf16 v[120:123], v[16:19], v[64:67], v[120:123]
    ds_read_b128 v[40:43], v5 offset:55296
    v_mfma_f32_16x16x32_bf16 v[124:127], v[20:23], v[64:67], v[124:127]
    ds_read_b64_tr_b16 v[56:57], v9 offset:4096
    v_mfma_f32_16x16x32_bf16 v[128:131], v[24:27], v[64:67], v[128:131]
    ds_read_b64_tr_b16 v[58:59], v9 offset:4608
    s_waitcnt lgkmcnt(10)
    v_mfma_f32_16x16x32_bf16 v[132:135], v[12:15], v[44:47], v[132:135]
    ds_read_b64_tr_b16 v[60:61], v10 offset:36864
    v_mfma_f32_16x16x32_bf16 v[136:139], v[16:19], v[44:47], v[136:139]
    ds_read_b64_tr_b16 v[62:63], v10 offset:37376
    v_mfma_f32_16x16x32_bf16 v[140:143], v[20:23], v[44:47], v[140:143]
    ds_read_b64_tr_b16 v[64:65], v11 offset:36864
    v_mfma_f32_16x16x32_bf16 v[144:147], v[24:27], v[44:47], v[144:147]
    ds_read_b64_tr_b16 v[66:67], v11 offset:37376
    s_waitcnt lgkmcnt(12)
    v_mfma_f32_16x16x32_bf16 v[148:151], v[12:15], v[48:51], v[148:151]
    v_mfma_f32_16x16x32_bf16 v[152:155], v[16:19], v[48:51], v[152:155]
    v_mfma_f32_16x16x32_bf16 v[156:159], v[20:23], v[48:51], v[156:159]
    v_mfma_f32_16x16x32_bf16 v[160:163], v[24:27], v[48:51], v[160:163]
    s_waitcnt lgkmcnt(9)
    v_mfma_f32_16x16x32_bf16 v[100:103], v[28:31], v[52:55], v[100:103]
    s_waitcnt lgkmcnt(8)
    v_mfma_f32_16x16x32_bf16 v[104:107], v[32:35], v[52:55], v[104:107]
    s_waitcnt lgkmcnt(0)
    s_barrier
    v_mfma_f32_16x16x32_bf16 v[108:111], v[36:39], v[52:55], v[108:111]
    ds_read_b128 v[12:15], v4 offset:0
    v_mfma_f32_16x16x32_bf16 v[112:115], v[40:43], v[52:55], v[112:115]
    ds_read_b64_tr_b16 v[44:45], v8 offset:8192
    v_mfma_f32_16x16x32_bf16 v[116:119], v[28:31], v[56:59], v[116:119]
    ds_read_b64_tr_b16 v[46:47], v8 offset:8704
    v_mfma_f32_16x16x32_bf16 v[120:123], v[32:35], v[56:59], v[120:123]
    ds_read_b128 v[16:19], v4 offset:2048
    v_mfma_f32_16x16x32_bf16 v[124:127], v[36:39], v[56:59], v[124:127]
    ds_read_b128 v[20:23], v4 offset:4096
    v_mfma_f32_16x16x32_bf16 v[128:131], v[40:43], v[56:59], v[128:131]
    ds_read_b128 v[24:27], v4 offset:6144
    v_mfma_f32_16x16x32_bf16 v[132:135], v[28:31], v[60:63], v[132:135]
    ds_read_b64_tr_b16 v[48:49], v9 offset:8192
    v_mfma_f32_16x16x32_bf16 v[136:139], v[32:35], v[60:63], v[136:139]
    ds_read_b64_tr_b16 v[50:51], v9 offset:8704
    v_mfma_f32_16x16x32_bf16 v[140:143], v[36:39], v[60:63], v[140:143]
    ds_read_b64_tr_b16 v[52:53], v8 offset:16384
    v_mfma_f32_16x16x32_bf16 v[144:147], v[40:43], v[60:63], v[144:147]
    ds_read_b64_tr_b16 v[54:55], v8 offset:16896
    v_mfma_f32_16x16x32_bf16 v[148:151], v[28:31], v[64:67], v[148:151]
    ds_read_b64_tr_b16 v[56:57], v9 offset:16384
    v_mfma_f32_16x16x32_bf16 v[152:155], v[32:35], v[64:67], v[152:155]
    ds_read_b64_tr_b16 v[58:59], v9 offset:16896
    v_mfma_f32_16x16x32_bf16 v[156:159], v[36:39], v[64:67], v[156:159]
    v_mfma_f32_16x16x32_bf16 v[160:163], v[40:43], v[64:67], v[160:163]
    s_waitcnt lgkmcnt(9)
    v_mfma_f32_16x16x32_bf16 v[100:103], v[12:15], v[44:47], v[100:103]
    ds_read_b128 v[28:31], v5 offset:0
    s_waitcnt lgkmcnt(9)
    v_mfma_f32_16x16x32_bf16 v[104:107], v[16:19], v[44:47], v[104:107]
    ds_read_b64_tr_b16 v[60:61], v8 offset:12288
    s_waitcnt lgkmcnt(9)
    v_mfma_f32_16x16x32_bf16 v[108:111], v[20:23], v[44:47], v[108:111]
    ds_read_b64_tr_b16 v[62:63], v8 offset:12800
    s_waitcnt lgkmcnt(9)
    v_mfma_f32_16x16x32_bf16 v[112:115], v[24:27], v[44:47], v[112:115]
    ds_read_b128 v[32:35], v5 offset:2048
    s_waitcnt lgkmcnt(8)
    v_mfma_f32_16x16x32_bf16 v[116:119], v[12:15], v[48:51], v[116:119]
    ds_read_b128 v[36:39], v5 offset:4096
    v_mfma_f32_16x16x32_bf16 v[120:123], v[16:19], v[48:51], v[120:123]
    ds_read_b128 v[40:43], v5 offset:6144
    v_mfma_f32_16x16x32_bf16 v[124:127], v[20:23], v[48:51], v[124:127]
    ds_read_b64_tr_b16 v[64:65], v9 offset:12288
    v_mfma_f32_16x16x32_bf16 v[128:131], v[24:27], v[48:51], v[128:131]
    ds_read_b64_tr_b16 v[66:67], v9 offset:12800
    s_waitcnt lgkmcnt(10)
    v_mfma_f32_16x16x32_bf16 v[132:135], v[12:15], v[52:55], v[132:135]
    ds_read_b64_tr_b16 v[44:45], v8 offset:20480
    v_mfma_f32_16x16x32_bf16 v[136:139], v[16:19], v[52:55], v[136:139]
    ds_read_b64_tr_b16 v[46:47], v8 offset:20992
    v_mfma_f32_16x16x32_bf16 v[140:143], v[20:23], v[52:55], v[140:143]
    ds_read_b64_tr_b16 v[48:49], v9 offset:20480
    v_mfma_f32_16x16x32_bf16 v[144:147], v[24:27], v[52:55], v[144:147]
    ds_read_b64_tr_b16 v[50:51], v9 offset:20992
    s_waitcnt lgkmcnt(12)
    v_mfma_f32_16x16x32_bf16 v[148:151], v[12:15], v[56:59], v[148:151]
    v_mfma_f32_16x16x32_bf16 v[152:155], v[16:19], v[56:59], v[152:155]
    v_mfma_f32_16x16x32_bf16 v[156:159], v[20:23], v[56:59], v[156:159]
    v_mfma_f32_16x16x32_bf16 v[160:163], v[24:27], v[56:59], v[160:163]
    s_waitcnt lgkmcnt(9)
    v_mfma_f32_16x16x32_bf16 v[100:103], v[28:31], v[60:63], v[100:103]
    s_waitcnt lgkmcnt(8)
    v_mfma_f32_16x16x32_bf16 v[104:107], v[32:35], v[60:63], v[104:107]
    s_waitcnt lgkmcnt(0)
    s_barrier
    v_mfma_f32_16x16x32_bf16 v[108:111], v[36:39], v[60:63], v[108:111]
    ds_read_b128 v[12:15], v4 offset:16384
    v_mfma_f32_16x16x32_bf16 v[112:115], v[40:43], v[60:63], v[112:115]
    ds_read_b64_tr_b16 v[52:53], v8 offset:24576
    v_mfma_f32_16x16x32_bf16 v[116:119], v[28:31], v[64:67], v[116:119]
    ds_read_b64_tr_b16 v[54:55], v8 offset:25088
    v_mfma_f32_16x16x32_bf16 v[120:123], v[32:35], v[64:67], v[120:123]
    ds_read_b128 v[16:19], v4 offset:18432
    v_mfma_f32_16x16x32_bf16 v[124:127], v[36:39], v[64:67], v[124:127]
    ds_read_b128 v[20:23], v4 offset:20480
    v_mfma_f32_16x16x32_bf16 v[128:131], v[40:43], v[64:67], v[128:131]
    ds_read_b128 v[24:27], v4 offset:22528
    v_mfma_f32_16x16x32_bf16 v[132:135], v[28:31], v[44:47], v[132:135]
    ds_read_b64_tr_b16 v[56:57], v9 offset:24576
    v_mfma_f32_16x16x32_bf16 v[136:139], v[32:35], v[44:47], v[136:139]
    ds_read_b64_tr_b16 v[58:59], v9 offset:25088
    v_mfma_f32_16x16x32_bf16 v[140:143], v[36:39], v[44:47], v[140:143]
    ds_read_b64_tr_b16 v[60:61], v10 offset:0
    v_mfma_f32_16x16x32_bf16 v[144:147], v[40:43], v[44:47], v[144:147]
    ds_read_b64_tr_b16 v[62:63], v10 offset:512
    v_mfma_f32_16x16x32_bf16 v[148:151], v[28:31], v[48:51], v[148:151]
    ds_read_b64_tr_b16 v[64:65], v11 offset:0
    v_mfma_f32_16x16x32_bf16 v[152:155], v[32:35], v[48:51], v[152:155]
    ds_read_b64_tr_b16 v[66:67], v11 offset:512
    v_mfma_f32_16x16x32_bf16 v[156:159], v[36:39], v[48:51], v[156:159]
    v_mfma_f32_16x16x32_bf16 v[160:163], v[40:43], v[48:51], v[160:163]
    s_waitcnt lgkmcnt(9)
    v_mfma_f32_16x16x32_bf16 v[100:103], v[12:15], v[52:55], v[100:103]
    ds_read_b128 v[28:31], v5 offset:16384
    s_waitcnt lgkmcnt(9)
    v_mfma_f32_16x16x32_bf16 v[104:107], v[16:19], v[52:55], v[104:107]
    ds_read_b64_tr_b16 v[44:45], v8 offset:28672
    s_waitcnt lgkmcnt(9)
    v_mfma_f32_16x16x32_bf16 v[108:111], v[20:23], v[52:55], v[108:111]
    ds_read_b64_tr_b16 v[46:47], v8 offset:29184
    s_waitcnt lgkmcnt(9)
    v_mfma_f32_16x16x32_bf16 v[112:115], v[24:27], v[52:55], v[112:115]
    ds_read_b128 v[32:35], v5 offset:18432
    s_waitcnt lgkmcnt(8)
    v_mfma_f32_16x16x32_bf16 v[116:119], v[12:15], v[56:59], v[116:119]
    ds_read_b128 v[36:39], v5 offset:20480
    v_mfma_f32_16x16x32_bf16 v[120:123], v[16:19], v[56:59], v[120:123]
    ds_read_b128 v[40:43], v5 offset:22528
    v_mfma_f32_16x16x32_bf16 v[124:127], v[20:23], v[56:59], v[124:127]
    ds_read_b64_tr_b16 v[48:49], v9 offset:28672
    v_mfma_f32_16x16x32_bf16 v[128:131], v[24:27], v[56:59], v[128:131]
    ds_read_b64_tr_b16 v[50:51], v9 offset:29184
    s_waitcnt lgkmcnt(10)
    v_mfma_f32_16x16x32_bf16 v[132:135], v[12:15], v[60:63], v[132:135]
    ds_read_b64_tr_b16 v[52:53], v10 offset:4096
    v_mfma_f32_16x16x32_bf16 v[136:139], v[16:19], v[60:63], v[136:139]
    ds_read_b64_tr_b16 v[54:55], v10 offset:4608
    v_mfma_f32_16x16x32_bf16 v[140:143], v[20:23], v[60:63], v[140:143]
    ds_read_b64_tr_b16 v[56:57], v11 offset:4096
    v_mfma_f32_16x16x32_bf16 v[144:147], v[24:27], v[60:63], v[144:147]
    ds_read_b64_tr_b16 v[58:59], v11 offset:4608
    s_waitcnt lgkmcnt(12)
    v_mfma_f32_16x16x32_bf16 v[148:151], v[12:15], v[64:67], v[148:151]
    v_mfma_f32_16x16x32_bf16 v[152:155], v[16:19], v[64:67], v[152:155]
    v_mfma_f32_16x16x32_bf16 v[156:159], v[20:23], v[64:67], v[156:159]
    v_mfma_f32_16x16x32_bf16 v[160:163], v[24:27], v[64:67], v[160:163]
    s_waitcnt lgkmcnt(9)
    v_mfma_f32_16x16x32_bf16 v[100:103], v[28:31], v[44:47], v[100:103]
    s_waitcnt lgkmcnt(8)
    v_mfma_f32_16x16x32_bf16 v[104:107], v[32:35], v[44:47], v[104:107]
    s_waitcnt lgkmcnt(0)
    s_barrier
    v_mfma_f32_16x16x32_bf16 v[108:111], v[36:39], v[44:47], v[108:111]
    ds_read_b128 v[12:15], v4 offset:32768
    v_mfma_f32_16x16x32_bf16 v[112:115], v[40:43], v[44:47], v[112:115]
    ds_read_b64_tr_b16 v[60:61], v10 offset:8192
    v_mfma_f32_16x16x32_bf16 v[116:119], v[28:31], v[48:51], v[116:119]
    ds_read_b64_tr_b16 v[62:63], v10 offset:8704
    v_mfma_f32_16x16x32_bf16 v[120:123], v[32:35], v[48:51], v[120:123]
    ds_read_b128 v[16:19], v4 offset:34816
    v_mfma_f32_16x16x32_bf16 v[124:127], v[36:39], v[48:51], v[124:127]
    ds_read_b128 v[20:23], v4 offset:36864
    v_mfma_f32_16x16x32_bf16 v[128:131], v[40:43], v[48:51], v[128:131]
    ds_read_b128 v[24:27], v4 offset:38912
    v_mfma_f32_16x16x32_bf16 v[132:135], v[28:31], v[52:55], v[132:135]
    ds_read_b64_tr_b16 v[64:65], v11 offset:8192
    v_mfma_f32_16x16x32_bf16 v[136:139], v[32:35], v[52:55], v[136:139]
    ds_read_b64_tr_b16 v[66:67], v11 offset:8704
    v_mfma_f32_16x16x32_bf16 v[140:143], v[36:39], v[52:55], v[140:143]
    ds_read_b64_tr_b16 v[44:45], v10 offset:16384
    v_mfma_f32_16x16x32_bf16 v[144:147], v[40:43], v[52:55], v[144:147]
    ds_read_b64_tr_b16 v[46:47], v10 offset:16896
    v_mfma_f32_16x16x32_bf16 v[148:151], v[28:31], v[56:59], v[148:151]
    ds_read_b64_tr_b16 v[48:49], v11 offset:16384
    v_mfma_f32_16x16x32_bf16 v[152:155], v[32:35], v[56:59], v[152:155]
    ds_read_b64_tr_b16 v[50:51], v11 offset:16896
    v_mfma_f32_16x16x32_bf16 v[156:159], v[36:39], v[56:59], v[156:159]
    v_mfma_f32_16x16x32_bf16 v[160:163], v[40:43], v[56:59], v[160:163]
    s_waitcnt lgkmcnt(9)
    v_mfma_f32_16x16x32_bf16 v[100:103], v[12:15], v[60:63], v[100:103]
    ds_read_b128 v[28:31], v5 offset:32768
    s_waitcnt lgkmcnt(9)
    v_mfma_f32_16x16x32_bf16 v[104:107], v[16:19], v[60:63], v[104:107]
    ds_read_b64_tr_b16 v[52:53], v10 offset:12288
    s_waitcnt lgkmcnt(9)
    v_mfma_f32_16x16x32_bf16 v[108:111], v[20:23], v[60:63], v[108:111]
    ds_read_b64_tr_b16 v[54:55], v10 offset:12800
    s_waitcnt lgkmcnt(9)
    v_mfma_f32_16x16x32_bf16 v[112:115], v[24:27], v[60:63], v[112:115]
    ds_read_b128 v[32:35], v5 offset:34816
    s_waitcnt lgkmcnt(8)
    v_mfma_f32_16x16x32_bf16 v[116:119], v[12:15], v[64:67], v[116:119]
    ds_read_b128 v[36:39], v5 offset:36864
    v_mfma_f32_16x16x32_bf16 v[120:123], v[16:19], v[64:67], v[120:123]
    ds_read_b128 v[40:43], v5 offset:38912
    v_mfma_f32_16x16x32_bf16 v[124:127], v[20:23], v[64:67], v[124:127]
    ds_read_b64_tr_b16 v[56:57], v11 offset:12288
    v_mfma_f32_16x16x32_bf16 v[128:131], v[24:27], v[64:67], v[128:131]
    ds_read_b64_tr_b16 v[58:59], v11 offset:12800
    s_waitcnt lgkmcnt(10)
    v_mfma_f32_16x16x32_bf16 v[132:135], v[12:15], v[44:47], v[132:135]
    ds_read_b64_tr_b16 v[60:61], v10 offset:20480
    v_mfma_f32_16x16x32_bf16 v[136:139], v[16:19], v[44:47], v[136:139]
    ds_read_b64_tr_b16 v[62:63], v10 offset:20992
    v_mfma_f32_16x16x32_bf16 v[140:143], v[20:23], v[44:47], v[140:143]
    ds_read_b64_tr_b16 v[64:65], v11 offset:20480
    v_mfma_f32_16x16x32_bf16 v[144:147], v[24:27], v[44:47], v[144:147]
    ds_read_b64_tr_b16 v[66:67], v11 offset:20992
    s_waitcnt lgkmcnt(12)
    v_mfma_f32_16x16x32_bf16 v[148:151], v[12:15], v[48:51], v[148:151]
    v_mfma_f32_16x16x32_bf16 v[152:155], v[16:19], v[48:51], v[152:155]
    v_mfma_f32_16x16x32_bf16 v[156:159], v[20:23], v[48:51], v[156:159]
    v_mfma_f32_16x16x32_bf16 v[160:163], v[24:27], v[48:51], v[160:163]
    s_waitcnt lgkmcnt(9)
    v_mfma_f32_16x16x32_bf16 v[100:103], v[28:31], v[52:55], v[100:103]
    s_waitcnt lgkmcnt(8)
    v_mfma_f32_16x16x32_bf16 v[104:107], v[32:35], v[52:55], v[104:107]
    s_waitcnt lgkmcnt(0)
    s_barrier
    v_mfma_f32_16x16x32_bf16 v[108:111], v[36:39], v[52:55], v[108:111]
    ds_read_b128 v[12:15], v4 offset:49152
    v_mfma_f32_16x16x32_bf16 v[112:115], v[40:43], v[52:55], v[112:115]
    ds_read_b64_tr_b16 v[44:45], v8 offset:0
    v_mfma_f32_16x16x32_bf16 v[116:119], v[28:31], v[56:59], v[116:119]
    ds_read_b64_tr_b16 v[46:47], v8 offset:512
    v_mfma_f32_16x16x32_bf16 v[120:123], v[32:35], v[56:59], v[120:123]
    ds_read_b128 v[16:19], v4 offset:51200
    v_mfma_f32_16x16x32_bf16 v[124:127], v[36:39], v[56:59], v[124:127]
    ds_read_b128 v[20:23], v4 offset:53248
    v_mfma_f32_16x16x32_bf16 v[128:131], v[40:43], v[56:59], v[128:131]
    ds_read_b128 v[24:27], v4 offset:55296
    v_mfma_f32_16x16x32_bf16 v[132:135], v[28:31], v[60:63], v[132:135]
    ds_read_b64_tr_b16 v[48:49], v9 offset:0
    v_mfma_f32_16x16x32_bf16 v[136:139], v[32:35], v[60:63], v[136:139]
    ds_read_b64_tr_b16 v[50:51], v9 offset:512
    v_mfma_f32_16x16x32_bf16 v[140:143], v[36:39], v[60:63], v[140:143]
    ds_read_b64_tr_b16 v[52:53], v10 offset:24576
    v_mfma_f32_16x16x32_bf16 v[144:147], v[40:43], v[60:63], v[144:147]
    ds_read_b64_tr_b16 v[54:55], v10 offset:25088
    v_mfma_f32_16x16x32_bf16 v[148:151], v[28:31], v[64:67], v[148:151]
    ds_read_b64_tr_b16 v[56:57], v11 offset:24576
    v_mfma_f32_16x16x32_bf16 v[152:155], v[32:35], v[64:67], v[152:155]
    ds_read_b64_tr_b16 v[58:59], v11 offset:25088
    v_mfma_f32_16x16x32_bf16 v[156:159], v[36:39], v[64:67], v[156:159]
    v_mfma_f32_16x16x32_bf16 v[160:163], v[40:43], v[64:67], v[160:163]
    ds_read_b32 v68, v1 offset:48
    s_waitcnt lgkmcnt(10)
    v_mfma_f32_16x16x32_bf16 v[100:103], v[12:15], v[44:47], v[100:103]
    ds_read_b128 v[28:31], v5 offset:49152
    s_waitcnt lgkmcnt(10)
    v_mfma_f32_16x16x32_bf16 v[104:107], v[16:19], v[44:47], v[104:107]
    ds_read_b64_tr_b16 v[60:61], v8 offset:4096
    s_waitcnt lgkmcnt(10)
    v_mfma_f32_16x16x32_bf16 v[108:111], v[20:23], v[44:47], v[108:111]
    ds_read_b64_tr_b16 v[62:63], v8 offset:4608
    s_waitcnt lgkmcnt(10)
    v_mfma_f32_16x16x32_bf16 v[112:115], v[24:27], v[44:47], v[112:115]
    ds_read_b128 v[32:35], v5 offset:51200
    s_waitcnt lgkmcnt(9)
    v_mfma_f32_16x16x32_bf16 v[116:119], v[12:15], v[48:51], v[116:119]
    ds_read_b128 v[36:39], v5 offset:53248
    v_mfma_f32_16x16x32_bf16 v[120:123], v[16:19], v[48:51], v[120:123]
    ds_read_b128 v[40:43], v5 offset:55296
    v_mfma_f32_16x16x32_bf16 v[124:127], v[20:23], v[48:51], v[124:127]
    ds_read_b64_tr_b16 v[64:65], v9 offset:4096
    v_mfma_f32_16x16x32_bf16 v[128:131], v[24:27], v[48:51], v[128:131]
    ds_read_b64_tr_b16 v[66:67], v9 offset:4608
    s_waitcnt lgkmcnt(11)
    v_mfma_f32_16x16x32_bf16 v[132:135], v[12:15], v[52:55], v[132:135]
    ds_read_b64_tr_b16 v[44:45], v10 offset:28672
    v_mfma_f32_16x16x32_bf16 v[136:139], v[16:19], v[52:55], v[136:139]
    ds_read_b64_tr_b16 v[46:47], v10 offset:29184
    v_mfma_f32_16x16x32_bf16 v[140:143], v[20:23], v[52:55], v[140:143]
    ds_read_b64_tr_b16 v[48:49], v11 offset:28672
    v_mfma_f32_16x16x32_bf16 v[144:147], v[24:27], v[52:55], v[144:147]
    ds_read_b64_tr_b16 v[50:51], v11 offset:29184
    s_waitcnt lgkmcnt(13)
    v_mfma_f32_16x16x32_bf16 v[148:151], v[12:15], v[56:59], v[148:151]
    v_mfma_f32_16x16x32_bf16 v[152:155], v[16:19], v[56:59], v[152:155]
    v_mfma_f32_16x16x32_bf16 v[156:159], v[20:23], v[56:59], v[156:159]
    v_mfma_f32_16x16x32_bf16 v[160:163], v[24:27], v[56:59], v[160:163]
    s_waitcnt lgkmcnt(9)
    v_mfma_f32_16x16x32_bf16 v[100:103], v[28:31], v[60:63], v[100:103]
    v_lshlrev_b32 v18, 4, v0
    v_add_u32 v12, s52, v18
    s_waitcnt lgkmcnt(8)
    v_mfma_f32_16x16x32_bf16 v[104:107], v[32:35], v[60:63], v[104:107]
    v_xor_b32 v13, 4096, v12
    v_and_b32 v14, 0x30, v0
    s_waitcnt lgkmcnt(0)
    s_barrier
    v_cmp_gt_u32 vcc, 1, v68
    s_nop 0
    s_and_b32 vcc_lo, vcc_lo, 3
    s_cbranch_scc0 SCK_17
    v_and_b32 v69, 1, v0
    v_lshlrev_b32 v69, 2, v69
    v_add_u32 v69, 159088, v69
    ds_read_b32 v68, v69 offset:0
FW_18:
    s_waitcnt lgkmcnt(0)
    v_cmp_gt_u32 vcc, 1, v68
    s_cbranch_vccz FO_19
    ds_read_b32 v68, v69 offset:0
    s_branch FW_18
FO_19:
SCK_17:
    v_mfma_f32_16x16x32_bf16 v[108:111], v[36:39], v[60:63], v[108:111]
    ds_read_b128 v[68:71], v164 offset:0
    v_add_u32 v14, s53, v14
    v_mfma_f32_16x16x32_bf16 v[112:115], v[40:43], v[60:63], v[112:115]
    ds_read2_b32 v[52:53], v165 offset0:64 offset1:64
    v_xor_b32 v15, 64, v14
    v_mfma_f32_16x16x32_bf16 v[116:119], v[28:31], v[64:67], v[116:119]
    ds_read2_b32 v[54:55], v2 offset0:64 offset1:64
    v_lshlrev_b32 v19, 2, v0
    v_mfma_f32_16x16x32_bf16 v[120:123], v[32:35], v[64:67], v[120:123]
    ds_read2_b32 v[56:57], v165 offset0:128 offset1:128
    v_add_u32 v16, s53, v19
    v_mfma_f32_16x16x32_bf16 v[124:127], v[36:39], v[64:67], v[124:127]
    ds_read2_b32 v[58:59], v2 offset0:128 offset1:128
    v_xor_b32 v17, 256, v16
    v_mfma_f32_16x16x32_bf16 v[128:131], v[40:43], v[64:67], v[128:131]
    ds_read_b128 v[72:75], v164 offset:1024
    v_xor_b32 v18, 8, v3
    v_mfma_f32_16x16x32_bf16 v[132:135], v[28:31], v[44:47], v[132:135]
    ds_read_b128 v[76:79], v164 offset:64
    v_writelane_b32 v18, s50, 1
    v_mfma_f32_16x16x32_bf16 v[136:139], v[32:35], v[44:47], v[136:139]
    ds_read_b128 v[80:83], v164 offset:1088
    v_mov_b32 v20, 0x3f803f80
    v_mfma_f32_16x16x32_bf16 v[140:143], v[36:39], v[44:47], v[140:143]
    ds_read_b128 v[84:87], v164 offset:128
    v_mov_b32 v21, 0x3f803f80
    v_mfma_f32_16x16x32_bf16 v[144:147], v[40:43], v[44:47], v[144:147]
    ds_read_b128 v[88:91], v164 offset:1152
    v_mov_b32 v22, 0x3f803f80
    v_mfma_f32_16x16x32_bf16 v[148:151], v[28:31], v[48:51], v[148:151]
    ds_read_b128 v[92:95], v164 offset:192
    v_mov_b32 v23, 0x3f803f80
    v_mfma_f32_16x16x32_bf16 v[152:155], v[32:35], v[48:51], v[152:155]
    ds_read_b128 v[96:99], v164 offset:1216
    v_mov_b32 v24, 1
    v_and_b32 v4, 15, v0
    v_mfma_f32_16x16x32_bf16 v[156:159], v[36:39], v[48:51], v[156:159]
    v_bfe_u32 v5, v0, 4, 1
    v_lshlrev_b32 v5, 5, v5
    v_mfma_f32_16x16x32_bf16 v[160:163], v[40:43], v[48:51], v[160:163]
    v_lshrrev_b32 v6, 5, v0
    v_lshl_add_u32 v5, v6, 4, v5
    v_lshl_add_u32 v7, v4, 11, v5
    v_lshlrev_b32 v6, 4, v0
    s_waitcnt lgkmcnt(10)
    v_pk_fma_f32 v[100:101], v[68:69], v[52:53], v[100:101]
    v_pk_fma_f32 v[102:103], v[70:71], v[52:53], v[102:103]
    s_waitcnt lgkmcnt(9)
    v_pk_fma_f32 v[116:117], v[68:69], v[54:55], v[116:117]
    v_pk_fma_f32 v[118:119], v[70:71], v[54:55], v[118:119]
    s_waitcnt lgkmcnt(8)
    v_pk_fma_f32 v[132:133], v[68:69], v[56:57], v[132:133]
    v_pk_fma_f32 v[134:135], v[70:71], v[56:57], v[134:135]
    s_waitcnt lgkmcnt(7)
    v_pk_fma_f32 v[148:149], v[68:69], v[58:59], v[148:149]
    v_pk_fma_f32 v[150:151], v[70:71], v[58:59], v[150:151]
    s_waitcnt lgkmcnt(6)
    v_pk_mul_f32 v[100:101], v[100:101], v[72:73]
    v_pk_mul_f32 v[102:103], v[102:103], v[74:75]
    v_pk_mul_f32 v[116:117], v[116:117], v[72:73]
    v_pk_mul_f32 v[118:119], v[118:119], v[74:75]
    v_pk_mul_f32 v[132:133], v[132:133], v[72:73]
    v_pk_mul_f32 v[134:135], v[134:135], v[74:75]
    v_pk_mul_f32 v[148:149], v[148:149], v[72:73]
    v_pk_mul_f32 v[150:151], v[150:151], v[74:75]
    v_exp_f32 v28, v100 clamp
    v_exp_f32 v29, v101 clamp
    v_exp_f32 v30, v102 clamp
    v_exp_f32 v31, v103 clamp
    v_exp_f32 v32, v116 clamp
    v_exp_f32 v33, v117 clamp
    v_exp_f32 v34, v118 clamp
    v_exp_f32 v35, v119 clamp
    v_cvt_pk_bf16_f32 v132, v132, v133
    v_cvt_pk_bf16_f32 v133, v134, v135
    v_cvt_pk_bf16_f32 v148, v148, v149
    v_cvt_pk_bf16_f32 v149, v150, v151
    v_pk_mul_f32 v[100:101], v[100:101], s[40:41] clamp
    v_pk_mul_f32 v[102:103], v[102:103], s[40:41] clamp
    v_pk_mul_f32 v[116:117], v[116:117], s[40:41] clamp
    v_pk_mul_f32 v[118:119], v[118:119], s[40:41] clamp
    v_pk_add_f32 v[28:29], v[28:29], s[74:75]
    v_pk_add_f32 v[30:31], v[30:31], s[74:75]
    v_pk_add_f32 v[32:33], v[32:33], s[74:75]
    v_pk_add_f32 v[34:35], v[34:35], s[74:75]
    v_pk_fma_f32 v[100:101], v[100:101], s[76:77], v[28:29]
    v_pk_fma_f32 v[102:103], v[102:103], s[76:77], v[30:31]
    v_pk_fma_f32 v[116:117], v[116:117], s[76:77], v[32:33]
    v_pk_fma_f32 v[118:119], v[118:119], s[76:77], v[34:35]
    v_cvt_pk_bf16_f32 v100, v100, v101
    v_cvt_pk_bf16_f32 v101, v102, v103
    v_cvt_pk_bf16_f32 v116, v116, v117
    v_cvt_pk_bf16_f32 v117, v118, v119
    s_waitcnt lgkmcnt(5)
    v_pk_fma_f32 v[104:105], v[76:77], v[52:53], v[104:105]
    v_pk_fma_f32 v[106:107], v[78:79], v[52:53], v[106:107]
    v_pk_fma_f32 v[120:121], v[76:77], v[54:55], v[120:121]
    v_pk_fma_f32 v[122:123], v[78:79], v[54:55], v[122:123]
    v_pk_fma_f32 v[136:137], v[76:77], v[56:57], v[136:137]
    v_pk_fma_f32 v[138:139], v[78:79], v[56:57], v[138:139]
    v_pk_fma_f32 v[152:153], v[76:77], v[58:59], v[152:153]
    v_pk_fma_f32 v[154:155], v[78:79], v[58:59], v[154:155]
    s_waitcnt lgkmcnt(4)
    v_pk_mul_f32 v[104:105], v[104:105], v[80:81]
    v_pk_mul_f32 v[106:107], v[106:107], v[82:83]
    v_pk_mul_f32 v[120:121], v[120:121], v[80:81]
    v_pk_mul_f32 v[122:123], v[122:123], v[82:83]
    v_pk_mul_f32 v[136:137], v[136:137], v[80:81]
    v_pk_mul_f32 v[138:139], v[138:139], v[82:83]
    v_pk_mul_f32 v[152:153], v[152:153], v[80:81]
    v_pk_mul_f32 v[154:155], v[154:155], v[82:83]
    v_exp_f32 v36, v104 clamp
    v_exp_f32 v37, v105 clamp
    v_exp_f32 v38, v106 clamp
    v_exp_f32 v39, v107 clamp
    v_exp_f32 v40, v120 clamp
    v_exp_f32 v41, v121 clamp
    v_exp_f32 v42, v122 clamp
    v_exp_f32 v43, v123 clamp
    v_cvt_pk_bf16_f32 v134, v136, v137
    v_cvt_pk_bf16_f32 v135, v138, v139
    v_cvt_pk_bf16_f32 v150, v152, v153
    v_cvt_pk_bf16_f32 v151, v154, v155
    v_pk_mul_f32 v[104:105], v[104:105], s[40:41] clamp
    v_pk_mul_f32 v[106:107], v[106:107], s[40:41] clamp
    v_pk_mul_f32 v[120:121], v[120:121], s[40:41] clamp
    v_pk_mul_f32 v[122:123], v[122:123], s[40:41] clamp
    v_pk_add_f32 v[36:37], v[36:37], s[74:75]
    v_pk_add_f32 v[38:39], v[38:39], s[74:75]
    v_pk_add_f32 v[40:41], v[40:41], s[74:75]
    v_pk_add_f32 v[42:43], v[42:43], s[74:75]
    v_pk_fma_f32 v[104:105], v[104:105], s[76:77], v[36:37]
    v_pk_fma_f32 v[106:107], v[106:107], s[76:77], v[38:39]
    v_pk_fma_f32 v[120:121], v[120:121], s[76:77], v[40:41]
    v_pk_fma_f32 v[122:123], v[122:123], s[76:77], v[42:43]
    v_cvt_pk_bf16_f32 v102, v104, v105
    v_cvt_pk_bf16_f32 v103, v106, v107
    v_cvt_pk_bf16_f32 v118, v120, v121
    v_cvt_pk_bf16_f32 v119, v122, v123
    s_waitcnt lgkmcnt(3)
    v_pk_fma_f32 v[108:109], v[84:85], v[52:53], v[108:109]
    v_pk_fma_f32 v[110:111], v[86:87], v[52:53], v[110:111]
    v_pk_fma_f32 v[124:125], v[84:85], v[54:55], v[124:125]
    v_pk_fma_f32 v[126:127], v[86:87], v[54:55], v[126:127]
    v_pk_fma_f32 v[140:141], v[84:85], v[56:57], v[140:141]
    v_pk_fma_f32 v[142:143], v[86:87], v[56:57], v[142:143]
    v_pk_fma_f32 v[156:157], v[84:85], v[58:59], v[156:157]
    v_pk_fma_f32 v[158:159], v[86:87], v[58:59], v[158:159]
    s_waitcnt lgkmcnt(2)
    v_pk_mul_f32 v[108:109], v[108:109], v[88:89]
    v_pk_mul_f32 v[110:111], v[110:111], v[90:91]
    v_pk_mul_f32 v[124:125], v[124:125], v[88:89]
    v_pk_mul_f32 v[126:127], v[126:127], v[90:91]
    v_pk_mul_f32 v[140:141], v[140:141], v[88:89]
    v_pk_mul_f32 v[142:143], v[142:143], v[90:91]
    v_pk_mul_f32 v[156:157], v[156:157], v[88:89]
    v_pk_mul_f32 v[158:159], v[158:159], v[90:91]
    v_mfma_f32_16x16x32_bf16 v[60:63], v[100:103], v[148:151], 0
    v_exp_f32 v28, v108 clamp
    v_exp_f32 v29, v109 clamp
    v_mfma_f32_16x16x32_bf16 v[64:67], v[116:119], v[148:151], 0
    v_exp_f32 v30, v110 clamp
    v_exp_f32 v31, v111 clamp
    v_mfma_f32_16x16x32_bf16 v[68:71], v[100:103], v[20:23], 0
    v_exp_f32 v32, v124 clamp
    v_exp_f32 v33, v125 clamp
    v_exp_f32 v34, v126 clamp
    v_exp_f32 v35, v127 clamp
    v_cvt_pk_bf16_f32 v136, v140, v141
    v_cvt_pk_bf16_f32 v137, v142, v143
    v_cvt_pk_bf16_f32 v152, v156, v157
    v_cvt_pk_bf16_f32 v153, v158, v159
    v_pk_mul_f32 v[108:109], v[108:109], s[40:41] clamp
    v_pk_mul_f32 v[110:111], v[110:111], s[40:41] clamp
    v_pk_mul_f32 v[124:125], v[124:125], s[40:41] clamp
    v_pk_mul_f32 v[126:127], v[126:127], s[40:41] clamp
    v_pk_add_f32 v[28:29], v[28:29], s[74:75]
    v_pk_add_f32 v[30:31], v[30:31], s[74:75]
    v_pk_add_f32 v[32:33], v[32:33], s[74:75]
    v_pk_add_f32 v[34:35], v[34:35], s[74:75]
    v_pk_fma_f32 v[108:109], v[108:109], s[76:77], v[28:29]
    v_pk_fma_f32 v[110:111], v[110:111], s[76:77], v[30:31]
    v_pk_fma_f32 v[124:125], v[124:125], s[76:77], v[32:33]
    v_pk_fma_f32 v[126:127], v[126:127], s[76:77], v[34:35]
    v_cvt_pk_bf16_f32 v104, v108, v109
    v_cvt_pk_bf16_f32 v105, v110, v111
    v_cvt_pk_bf16_f32 v120, v124, v125
    v_cvt_pk_bf16_f32 v121, v126, v127
    s_waitcnt lgkmcnt(1)
    v_pk_fma_f32 v[112:113], v[92:93], v[52:53], v[112:113]
    v_pk_fma_f32 v[114:115], v[94:95], v[52:53], v[114:115]
    v_pk_fma_f32 v[128:129], v[92:93], v[54:55], v[128:129]
    v_pk_fma_f32 v[130:131], v[94:95], v[54:55], v[130:131]
    v_pk_fma_f32 v[144:145], v[92:93], v[56:57], v[144:145]
    v_pk_fma_f32 v[146:147], v[94:95], v[56:57], v[146:147]
    v_pk_fma_f32 v[160:161], v[92:93], v[58:59], v[160:161]
    v_pk_fma_f32 v[162:163], v[94:95], v[58:59], v[162:163]
    s_waitcnt lgkmcnt(0)
    v_pk_mul_f32 v[112:113], v[112:113], v[96:97]
    v_pk_mul_f32 v[114:115], v[114:115], v[98:99]
    v_pk_mul_f32 v[128:129], v[128:129], v[96:97]
    v_pk_mul_f32 v[130:131], v[130:131], v[98:99]
    v_pk_mul_f32 v[144:145], v[144:145], v[96:97]
    v_pk_mul_f32 v[146:147], v[146:147], v[98:99]
    v_pk_mul_f32 v[160:161], v[160:161], v[96:97]
    v_pk_mul_f32 v[162:163], v[162:163], v[98:99]
    v_mfma_f32_16x16x32_bf16 v[72:75], v[116:119], v[20:23], 0
    v_exp_f32 v36, v112 clamp
    v_exp_f32 v37, v113 clamp
    v_mfma_f32_16x16x32_bf16 v[44:47], v[100:103], v[132:135], 0
    v_exp_f32 v38, v114 clamp
    v_exp_f32 v39, v115 clamp
    v_mfma_f32_16x16x32_bf16 v[48:51], v[116:119], v[132:135], 0
    v_exp_f32 v40, v128 clamp
    v_exp_f32 v41, v129 clamp
    v_exp_f32 v42, v130 clamp
    v_exp_f32 v43, v131 clamp
    s_branch IW_s5
IW_w5:
    s_branch IW_r5
IW_s5:
    v_cvt_pk_bf16_f32 v138, v144, v145
    v_cvt_pk_bf16_f32 v139, v146, v147
    v_cvt_pk_bf16_f32 v154, v160, v161
    v_cvt_pk_bf16_f32 v155, v162, v163
    v_pk_mul_f32 v[112:113], v[112:113], s[40:41] clamp
    v_pk_mul_f32 v[114:115], v[114:115], s[40:41] clamp
    v_pk_mul_f32 v[128:129], v[128:129], s[40:41] clamp
    v_pk_mul_f32 v[130:131], v[130:131], s[40:41] clamp
    v_pk_add_f32 v[36:37], v[36:37], s[74:75]
    v_pk_add_f32 v[38:39], v[38:39], s[74:75]
    v_pk_add_f32 v[40:41], v[40:41], s[74:75]
    v_pk_add_f32 v[42:43], v[42:43], s[74:75]
    v_pk_fma_f32 v[112:113], v[112:113], s[76:77], v[36:37]
    v_pk_fma_f32 v[114:115], v[114:115], s[76:77], v[38:39]
    v_pk_fma_f32 v[128:129], v[128:129], s[76:77], v[40:41]
    v_pk_fma_f32 v[130:131], v[130:131], s[76:77], v[42:43]
    v_cvt_pk_bf16_f32 v106, v112, v113
    v_cvt_pk_bf16_f32 v107, v114, v115
    v_cvt_pk_bf16_f32 v122, v128, v129
    v_cvt_pk_bf16_f32 v123, v130, v131
    v_mfma_f32_16x16x32_bf16 v[60:63], v[104:107], v[152:155], v[60:63]
    s_nop 0
    v_mfma_f32_16x16x32_bf16 v[64:67], v[120:123], v[152:155], v[64:67]
    v_mfma_f32_16x16x32_bf16 v[68:71], v[104:107], v[20:23], v[68:71]
    v_mfma_f32_16x16x32_bf16 v[72:75], v[120:123], v[20:23], v[72:75]
    v_mfma_f32_16x16x32_bf16 v[44:47], v[104:107], v[136:139], v[44:47]
    v_mfma_f32_16x16x32_bf16 v[48:51], v[120:123], v[136:139], v[48:51]
    buffer_load_dwordx4 v[140:143], v7, s[12:15], s42 offen offset:0
    buffer_load_dwordx4 v[144:147], v7, s[12:15], s42 offen offset:64
    buffer_load_dwordx4 v[156:159], v7, s[12:15], s43 offen offset:0
    buffer_load_dwordx4 v[160:163], v7, s[12:15], s43 offen offset:64
    ds_write_b128 v12, v[60:63] offset:0
    ds_write_b128 v12, v[64:67] offset:1024
    s_mov_b32 exec_lo, 0x10001
    s_mov_b32 exec_hi, 0x10001
    ds_write_b128 v14, v[68:71]
    ds_write_b128 v15, v[72:75]
    s_mov_b64 exec, 1
    ds_write_b32 v3, v24 offset:32
    s_mov_b64 exec, -1
F_xw:
    ds_read_b32 v25, v18 offset:32
    ds_read_b128 v[28:31], v13 offset:1024
    ds_read_b128 v[32:35], v13
    ds_read_b32 v26, v16
    ds_read_b32 v27, v17
    s_waitcnt lgkmcnt(4)
    v_cmp_eq_u32 vcc, 0, v25
    s_cbranch_vccz F_xx
    s_waitcnt lgkmcnt(0)
    s_branch F_xw
F_xx:
    s_waitcnt lgkmcnt(3)
    v_add_f32 v44, v44, v28
    v_add_f32 v45, v45, v29
    v_add_f32 v46, v46, v30
    v_add_f32 v47, v47, v31
    buffer_atomic_add_f32 v44, v19, s[24:27], s46 offen offset:0
    buffer_atomic_add_f32 v45, v19, s[24:27], s46 offen offset:256
    buffer_atomic_add_f32 v46, v19, s[24:27], s46 offen offset:512
    buffer_atomic_add_f32 v47, v19, s[24:27], s46 offen offset:768
    s_waitcnt lgkmcnt(2)
    v_add_f32 v48, v48, v32
    v_add_f32 v49, v49, v33
    v_add_f32 v50, v50, v34
    v_add_f32 v51, v51, v35
    buffer_atomic_add_f32 v48, v19, s[24:27], s47 offen offset:0
    buffer_atomic_add_f32 v49, v19, s[24:27], s47 offen offset:256
    buffer_atomic_add_f32 v50, v19, s[24:27], s47 offen offset:512
    buffer_atomic_add_f32 v51, v19, s[24:27], s47 offen offset:768
    s_waitcnt lgkmcnt(0)
    v_add_f32 v26, v26, v27
    s_mov_b64 exec, 0xffff
    buffer_atomic_add_f32 v26, v19, s[24:27], s48 offen
    s_mov_b64 exec, 1
    ds_add_u32 v3, v24 offset:32
    s_mov_b64 exec, -1
    s_setprio 2
    v_mov_b32 v2, v7
    s_lshl_b32 s47, s3, 7
    s_add_u32 s47, s47, 157184
    v_lshlrev_b32 v5, 2, v4
    v_add_u32 v5, s47, v5
    ds_read2_b32 v[76:77], v5 offset0:0 offset1:128
    ds_read2_b32 v[78:79], v5 offset0:16 offset1:144
    v_lshrrev_b32 v4, 3, v0
    v_and_b32 v5, 7, v0
    v_lshrrev_b32 v6, 1, v4
    v_lshlrev_b32 v7, 1, v6
    v_xor_b32 v7, v5, v7
    v_lshlrev_b32 v7, 4, v7
    v_lshl_add_u32 v40, v4, 11, v7
    v_and_b32 v6, 1, v6
    v_lshlrev_b32 v6, 1, v6
    v_xor_b32 v41, v5, v6
    v_xor_b32 v42, 4, v41
    v_lshlrev_b32 v41, 4, v41
    v_lshlrev_b32 v42, 4, v42
    v_mul_u32_u24 v7, 6144, v4
    v_add_u32 v41, v41, v7
    v_add_u32 v42, v42, v7
    v_add_u32 v42, 49152, v42
    s_mul_i32 s56, s3, 98304
    s_lshl_b32 s47, s10, 7
    s_add_u32 s56, s56, s47
    s_lshl_b32 s57, s29, 7
    s_lshl_b32 s47, s3, 15
    s_add_u32 s57, s57, s47
    s_and_b32 s81, s28, 3
    s_mul_i32 s81, s81, 4
    s_lshr_b32 s47, s28, 2
    s_mul_i32 s47, s47, 1
    s_add_u32 s81, s81, s47
    s_lshl_b32 s78, s3, 11
    s_lshl_b32 s44, s10, 1
    s_add_u32 s44, s44, s37
    s_mul_i32 s45, s44, 4224
    s_mov_b32 s52, s45
    s_add_u32 s53, s45, 4096
    s_lshl_b32 s51, s44, 3
    s_and_b32 s47, s32, 3
    s_add_u32 s51, s51, s47
    s_lshl_b32 s51, s51, 7
    v_xor_b32 v18, 8, v3
    v_mov_b32 v25, 0

    s_add_u32 s54, s51, 0x82d000
    s_add_u32 s54, s72, s54
    s_addc_u32 s55, s73, 0
    s_add_u32 s82, s49, 0x82d000
    s_add_u32 s82, s72, s82
    s_addc_u32 s83, s73, 0
    s_lshl_b32 s57, s29, 7
    s_and_b32 s47, s3, 1
    s_lshl_b32 s79, s47, 12
    s_lshl_b32 s47, s47, 16
    s_add_u32 s57, s57, s47

    s_setprio 2
    s_waitcnt lgkmcnt(0)
    v_mul_f32 v76, v76, v77
    v_add_f32 v77, 1.0, v77
    v_mul_f32 v78, v78, v79
    v_add_f32 v79, 1.0, v79
    s_waitcnt vmcnt(9)
    v_lshlrev_b32 v100, 16, v140
    v_and_b32 v101, 0xffff0000, v140
    v_lshlrev_b32 v102, 16, v141
    v_and_b32 v103, 0xffff0000, v141
    v_lshlrev_b32 v104, 16, v142
    v_and_b32 v105, 0xffff0000, v142
    v_lshlrev_b32 v106, 16, v143
    v_and_b32 v107, 0xffff0000, v143
    v_fma_f32 v100, v100, v77, v76
    v_fma_f32 v101, v101, v77, v76
    v_fma_f32 v102, v102, v77, v76
    v_fma_f32 v103, v103, v77, v76
    v_fma_f32 v104, v104, v77, v76
    v_fma_f32 v105, v105, v77, v76
    v_fma_f32 v106, v106, v77, v76
    v_fma_f32 v107, v107, v77, v76
    v_lshlrev_b32 v108, 16, v144
    v_and_b32 v109, 0xffff0000, v144
    v_lshlrev_b32 v110, 16, v145
    v_and_b32 v111, 0xffff0000, v145
    v_lshlrev_b32 v112, 16, v146
    v_and_b32 v113, 0xffff0000, v146
    v_lshlrev_b32 v114, 16, v147
    v_and_b32 v115, 0xffff0000, v147
    v_fma_f32 v108, v108, v77, v76
    v_fma_f32 v109, v109, v77, v76
    v_fma_f32 v110, v110, v77, v76
    v_fma_f32 v111, v111, v77, v76
    v_fma_f32 v112, v112, v77, v76
    v_fma_f32 v113, v113, v77, v76
    v_fma_f32 v114, v114, v77, v76
    v_fma_f32 v115, v115, v77, v76
    v_lshlrev_b32 v116, 16, v156
    v_and_b32 v117, 0xffff0000, v156
    v_lshlrev_b32 v118, 16, v157
    v_and_b32 v119, 0xffff0000, v157
    v_lshlrev_b32 v120, 16, v158
    v_and_b32 v121, 0xffff0000, v158
    v_lshlrev_b32 v122, 16, v159
    v_and_b32 v123, 0xffff0000, v159
    v_fma_f32 v116, v116, v79, v78
    v_fma_f32 v117, v117, v79, v78
    v_fma_f32 v118, v118, v79, v78
    v_fma_f32 v119, v119, v79, v78
    v_fma_f32 v120, v120, v79, v78
    v_fma_f32 v121, v121, v79, v78
    v_fma_f32 v122, v122, v79, v78
    v_fma_f32 v123, v123, v79, v78
    v_lshlrev_b32 v124, 16, v160
    v_and_b32 v125, 0xffff0000, v160
    v_lshlrev_b32 v126, 16, v161
    v_and_b32 v127, 0xffff0000, v161
    v_lshlrev_b32 v128, 16, v162
    v_and_b32 v129, 0xffff0000, v162
    v_lshlrev_b32 v130, 16, v163
    v_and_b32 v131, 0xffff0000, v163
    v_fma_f32 v124, v124, v79, v78
    v_fma_f32 v125, v125, v79, v78
    v_fma_f32 v126, v126, v79, v78
    v_fma_f32 v127, v127, v79, v78
    v_fma_f32 v128, v128, v79, v78
    v_fma_f32 v129, v129, v79, v78
    v_fma_f32 v130, v130, v79, v78
    v_fma_f32 v131, v131, v79, v78
    v_permlane16_swap_b32 v100, v104
    v_permlane16_swap_b32 v101, v105
    v_permlane16_swap_b32 v102, v106
    v_permlane16_swap_b32 v103, v107
    v_permlane16_swap_b32 v108, v112
    v_permlane16_swap_b32 v109, v113
    v_permlane16_swap_b32 v110, v114
    v_permlane16_swap_b32 v111, v115
    v_permlane16_swap_b32 v116, v120
    v_permlane16_swap_b32 v117, v121
    v_permlane16_swap_b32 v118, v122
    v_permlane16_swap_b32 v119, v123
    v_permlane16_swap_b32 v124, v128
    v_permlane16_swap_b32 v125, v129
    v_permlane16_swap_b32 v126, v130
    v_permlane16_swap_b32 v127, v131
    s_setprio 2
    s_cmp_lt_u32 s3, 2
    s_cbranch_scc1 F_w0
    v_cmp_gt_u32 vcc, 1, v25
    s_cbranch_vccz CW_20
    ds_read_b32 v25, v1 offset:0
FW_21:
    s_waitcnt lgkmcnt(0)
    v_cmp_gt_u32 vcc, 1, v25
    s_cbranch_vccz FO_22
    s_sleep 2
    ds_read_b32 v25, v1 offset:0
    s_branch FW_21
FO_22:
CW_20:
    s_add_u32 s47, s81, 0
    s_and_b32 s47, s47, 15
    s_lshl_b32 s47, s47, 17
    s_add_u32 m0, s79, 147456
    s_add_u32 s47, s47, s57
    buffer_load_dwordx4 v40, s[20:23], s47 offen lds
    s_add_u32 m0, m0, 1024
    s_add_u32 s47, s47, 16384
    buffer_load_dwordx4 v40, s[20:23], s47 offen lds
    s_add_u32 m0, m0, 1024
    s_add_u32 s47, s47, 16384
    buffer_load_dwordx4 v40, s[20:23], s47 offen lds
    s_add_u32 m0, m0, 1024
    s_add_u32 s47, s47, 16384
    buffer_load_dwordx4 v40, s[20:23], s47 offen lds
    v_cmp_gt_u32 vcc, 2, v25
    s_cbranch_vccz CW_23
    ds_read_b32 v25, v1 offset:0
FW_24:
    s_waitcnt lgkmcnt(0)
    v_cmp_gt_u32 vcc, 2, v25
    s_cbranch_vccz FO_25
    s_sleep 2
    ds_read_b32 v25, v1 offset:0
    s_branch FW_24
FO_25:
CW_23:
    s_add_u32 s47, s81, 1
    s_and_b32 s47, s47, 15
    s_lshl_b32 s47, s47, 17
    s_add_u32 m0, s79, 0
    s_add_u32 s47, s47, s57
    buffer_load_dwordx4 v40, s[20:23], s47 offen lds
    s_add_u32 m0, m0, 1024
    s_add_u32 s47, s47, 16384
    buffer_load_dwordx4 v40, s[20:23], s47 offen lds
    s_add_u32 m0, m0, 1024
    s_add_u32 s47, s47, 16384
    buffer_load_dwordx4 v40, s[20:23], s47 offen lds
    s_add_u32 m0, m0, 1024
    s_add_u32 s47, s47, 16384
    buffer_load_dwordx4 v40, s[20:23], s47 offen lds
    s_waitcnt vmcnt(8)
    s_branch F_w1
F_w0:
    s_waitcnt vmcnt(0)
F_w1:
    s_mov_b32 s49, 1
    s_atomic_add s49, s[82:83], 0x0
    s_atomic_add s49, s[82:83], 0x80
    s_atomic_add s49, s[82:83], 0x100
    s_atomic_add s49, s[82:83], 0x180
    v_mov_b32 v26, 3
    s_mov_b64 exec, 1
    ds_write_b32 v3, v26 offset:32
    s_mov_b64 exec, -1
    s_cmp_ge_u32 s3, 2
    s_cbranch_scc1 F_wo
    ds_read_b32 v26, v18 offset:32
FW_26:
    s_waitcnt lgkmcnt(0)
    v_cmp_gt_u32 vcc, 2, v26
    s_cbranch_vccz FO_27
    ds_read_b32 v26, v18 offset:32
    s_branch FW_26
FO_27:
    v_cmp_gt_u32 vcc, 4, v25
    s_cbranch_vccz CW_28
    ds_read_b32 v25, v1 offset:0
FW_29:
    s_waitcnt lgkmcnt(0)
    v_cmp_gt_u32 vcc, 4, v25
    s_cbranch_vccz FO_30
    s_sleep 2
    ds_read_b32 v25, v1 offset:0
    s_branch FW_29
FO_30:
CW_28:
    v_lshlrev_b32 v9, 4, v0
    s_lshl_b32 s50, s3, 7
    s_add_u32 s50, s50, 159232
    s_add_u32 m0, s78, 40960
SP_31:
    s_load_dword s58, s[54:55], 0 glc
    s_waitcnt lgkmcnt(0)
    s_cmp_ge_u32 s58, 32
    s_cbranch_scc1 SD_32
    s_sleep 1
    s_branch SP_31
SD_32:
    buffer_load_dwordx4 v9, s[24:27], s52 offen offset:0 sc1 lds
    buffer_load_dwordx4 v9, s[24:27], s52 offen offset:1024 sc1 lds
    s_add_u32 m0, m0, 2048
    s_nop 0
    buffer_load_dwordx4 v9, s[24:27], s52 offen offset:2048 sc1 lds
    buffer_load_dwordx4 v9, s[24:27], s52 offen offset:3072 sc1 lds
    s_mov_b32 m0, s50
    s_mov_b32 exec_hi, 0
    buffer_load_dword v19, s[24:27], s53 offen sc1 lds
    s_mov_b64 exec, 1
    s_lshl_b32 s50, s3, 2
    s_add_u32 m0, s50, 159168
    s_add_u32 s51, s51, 184320
    buffer_load_dword v19, s[24:27], s51 offen sc1 lds
    s_waitcnt vmcnt(0)
    s_mov_b64 exec, 1
    v_mov_b32 v26, 32
    ds_write_b32 v3, v26 offset:128
    s_mov_b64 exec, -1
    s_branch F_wj
F_wo:
    v_cmp_gt_u32 vcc, 2, v25
    s_cbranch_vccz CW_33
    ds_read_b32 v25, v1 offset:0
FW_34:
    s_waitcnt lgkmcnt(0)
    v_cmp_gt_u32 vcc, 2, v25
    s_cbranch_vccz FO_35
    s_sleep 2
    ds_read_b32 v25, v1 offset:0
    s_branch FW_34
FO_35:
CW_33:
    s_add_u32 s47, s81, 2
    s_and_b32 s47, s47, 15
    s_lshl_b32 s47, s47, 17
    s_add_u32 m0, s79, 8192
    s_add_u32 s47, s47, s57
    buffer_load_dwordx4 v40, s[20:23], s47 offen lds
    s_add_u32 m0, m0, 1024
    s_add_u32 s47, s47, 16384
    buffer_load_dwordx4 v40, s[20:23], s47 offen lds
    s_add_u32 m0, m0, 1024
    s_add_u32 s47, s47, 16384
    buffer_load_dwordx4 v40, s[20:23], s47 offen lds
    s_add_u32 m0, m0, 1024
    s_add_u32 s47, s47, 16384
    buffer_load_dwordx4 v40, s[20:23], s47 offen lds
    v_cmp_gt_u32 vcc, 2, v25
    s_cbranch_vccz CW_36
    ds_read_b32 v25, v1 offset:0
FW_37:
    s_waitcnt lgkmcnt(0)
    v_cmp_gt_u32 vcc, 2, v25
    s_cbranch_vccz FO_38
    s_sleep 2
    ds_read_b32 v25, v1 offset:0
    s_branch FW_37
FO_38:
CW_36:
    s_waitcnt vmcnt(8)
    s_add_u32 s47, s81, 3
    s_and_b32 s47, s47, 15
    s_lshl_b32 s47, s47, 17
    s_add_u32 m0, s79, 139264
    s_add_u32 s47, s47, s57
    buffer_load_dwordx4 v40, s[20:23], s47 offen lds
    s_add_u32 m0, m0, 1024
    s_add_u32 s47, s47, 16384
    buffer_load_dwordx4 v40, s[20:23], s47 offen lds
    s_add_u32 m0, m0, 1024
    s_add_u32 s47, s47, 16384
    buffer_load_dwordx4 v40, s[20:23], s47 offen lds
    s_add_u32 m0, m0, 1024
    s_add_u32 s47, s47, 16384
    buffer_load_dwordx4 v40, s[20:23], s47 offen lds
    v_cmp_gt_u32 vcc, 3, v25
    s_cbranch_vccz CW_39
    ds_read_b32 v25, v1 offset:0
FW_40:
    s_waitcnt lgkmcnt(0)
    v_cmp_gt_u32 vcc, 3, v25
    s_cbranch_vccz FO_41
    s_sleep 2
    ds_read_b32 v25, v1 offset:0
    s_branch FW_40
FO_41:
CW_39:
    s_waitcnt vmcnt(8)
    s_add_u32 s47, s81, 4
    s_and_b32 s47, s47, 15
    s_lshl_b32 s47, s47, 17
    s_add_u32 m0, s79, 16384
    s_add_u32 s47, s47, s57
    buffer_load_dwordx4 v40, s[20:23], s47 offen lds
    s_add_u32 m0, m0, 1024
    s_add_u32 s47, s47, 16384
    buffer_load_dwordx4 v40, s[20:23], s47 offen lds
    s_add_u32 m0, m0, 1024
    s_add_u32 s47, s47, 16384
    buffer_load_dwordx4 v40, s[20:23], s47 offen lds
    s_add_u32 m0, m0, 1024
    s_add_u32 s47, s47, 16384
    buffer_load_dwordx4 v40, s[20:23], s47 offen lds
    v_cmp_gt_u32 vcc, 3, v25
    s_cbranch_vccz CW_42
    ds_read_b32 v25, v1 offset:0
FW_43:
    s_waitcnt lgkmcnt(0)
    v_cmp_gt_u32 vcc, 3, v25
    s_cbranch_vccz FO_44
    s_sleep 2
    ds_read_b32 v25, v1 offset:0
    s_branch FW_43
FO_44:
CW_42:
    s_waitcnt vmcnt(8)
    s_add_u32 s47, s81, 5
    s_and_b32 s47, s47, 15
    s_lshl_b32 s47, s47, 17
    s_add_u32 m0, s79, 24576
    s_add_u32 s47, s47, s57
    buffer_load_dwordx4 v40, s[20:23], s47 offen lds
    s_add_u32 m0, m0, 1024
    s_add_u32 s47, s47, 16384
    buffer_load_dwordx4 v40, s[20:23], s47 offen lds
    s_add_u32 m0, m0, 1024
    s_add_u32 s47, s47, 16384
    buffer_load_dwordx4 v40, s[20:23], s47 offen lds
    s_add_u32 m0, m0, 1024
    s_add_u32 s47, s47, 16384
    buffer_load_dwordx4 v40, s[20:23], s47 offen lds
    v_cmp_gt_u32 vcc, 3, v25
    s_cbranch_vccz CW_45
    ds_read_b32 v25, v1 offset:0
FW_46:
    s_waitcnt lgkmcnt(0)
    v_cmp_gt_u32 vcc, 3, v25
    s_cbranch_vccz FO_47
    s_sleep 2
    ds_read_b32 v25, v1 offset:0
    s_branch FW_46
FO_47:
CW_45:
    s_waitcnt vmcnt(8)
    s_add_u32 s47, s81, 6
    s_and_b32 s47, s47, 15
    s_lshl_b32 s47, s47, 17
    s_add_u32 m0, s79, 131072
    s_add_u32 s47, s47, s57
    buffer_load_dwordx4 v40, s[20:23], s47 offen lds
    s_add_u32 m0, m0, 1024
    s_add_u32 s47, s47, 16384
    buffer_load_dwordx4 v40, s[20:23], s47 offen lds
    s_add_u32 m0, m0, 1024
    s_add_u32 s47, s47, 16384
    buffer_load_dwordx4 v40, s[20:23], s47 offen lds
    s_add_u32 m0, m0, 1024
    s_add_u32 s47, s47, 16384
    buffer_load_dwordx4 v40, s[20:23], s47 offen lds
    v_cmp_gt_u32 vcc, 4, v25
    s_cbranch_vccz CW_48
    ds_read_b32 v25, v1 offset:0
FW_49:
    s_waitcnt lgkmcnt(0)
    v_cmp_gt_u32 vcc, 4, v25
    s_cbranch_vccz FO_50
    s_sleep 2
    ds_read_b32 v25, v1 offset:0
    s_branch FW_49
FO_50:
CW_48:
    s_waitcnt vmcnt(8)
    s_add_u32 s47, s81, 7
    s_and_b32 s47, s47, 15
    s_lshl_b32 s47, s47, 17
    s_add_u32 m0, s79, 81920
    s_add_u32 s47, s47, s57
    buffer_load_dwordx4 v40, s[20:23], s47 offen lds
    s_add_u32 m0, m0, 1024
    s_add_u32 s47, s47, 16384
    buffer_load_dwordx4 v40, s[20:23], s47 offen lds
    s_add_u32 m0, m0, 1024
    s_add_u32 s47, s47, 16384
    buffer_load_dwordx4 v40, s[20:23], s47 offen lds
    s_add_u32 m0, m0, 1024
    s_add_u32 s47, s47, 16384
    buffer_load_dwordx4 v40, s[20:23], s47 offen lds
    v_cmp_gt_u32 vcc, 5, v25
    s_cbranch_vccz CW_51
    ds_read_b32 v25, v1 offset:0
FW_52:
    s_waitcnt lgkmcnt(0)
    v_cmp_gt_u32 vcc, 5, v25
    s_cbranch_vccz FO_53
    s_sleep 2
    ds_read_b32 v25, v1 offset:0
    s_branch FW_52
FO_53:
CW_51:
    s_waitcnt vmcnt(8)
    s_add_u32 s47, s81, 8
    s_and_b32 s47, s47, 15
    s_lshl_b32 s47, s47, 17
    s_add_u32 m0, s79, 49152
    s_add_u32 s47, s47, s57
    buffer_load_dwordx4 v40, s[20:23], s47 offen lds
    s_add_u32 m0, m0, 1024
    s_add_u32 s47, s47, 16384
    buffer_load_dwordx4 v40, s[20:23], s47 offen lds
    s_add_u32 m0, m0, 1024
    s_add_u32 s47, s47, 16384
    buffer_load_dwordx4 v40, s[20:23], s47 offen lds
    s_add_u32 m0, m0, 1024
    s_add_u32 s47, s47, 16384
    buffer_load_dwordx4 v40, s[20:23], s47 offen lds
    v_cmp_gt_u32 vcc, 5, v25
    s_cbranch_vccz CW_54
    ds_read_b32 v25, v1 offset:0
FW_55:
    s_waitcnt lgkmcnt(0)
    v_cmp_gt_u32 vcc, 5, v25
    s_cbranch_vccz FO_56
    s_sleep 2
    ds_read_b32 v25, v1 offset:0
    s_branch FW_55
FO_56:
CW_54:
    s_waitcnt vmcnt(8)
    s_add_u32 s47, s81, 9
    s_and_b32 s47, s47, 15
    s_lshl_b32 s47, s47, 17
    s_add_u32 m0, s79, 57344
    s_add_u32 s47, s47, s57
    buffer_load_dwordx4 v40, s[20:23], s47 offen lds
    s_add_u32 m0, m0, 1024
    s_add_u32 s47, s47, 16384
    buffer_load_dwordx4 v40, s[20:23], s47 offen lds
    s_add_u32 m0, m0, 1024
    s_add_u32 s47, s47, 16384
    buffer_load_dwordx4 v40, s[20:23], s47 offen lds
    s_add_u32 m0, m0, 1024
    s_add_u32 s47, s47, 16384
    buffer_load_dwordx4 v40, s[20:23], s47 offen lds
    v_cmp_gt_u32 vcc, 5, v25
    s_cbranch_vccz CW_57
    ds_read_b32 v25, v1 offset:0
FW_58:
    s_waitcnt lgkmcnt(0)
    v_cmp_gt_u32 vcc, 5, v25
    s_cbranch_vccz FO_59
    s_sleep 2
    ds_read_b32 v25, v1 offset:0
    s_branch FW_58
FO_59:
CW_57:
    s_waitcnt vmcnt(8)
    s_add_u32 s47, s81, 10
    s_and_b32 s47, s47, 15
    s_lshl_b32 s47, s47, 17
    s_add_u32 m0, s79, 73728
    s_add_u32 s47, s47, s57
    buffer_load_dwordx4 v40, s[20:23], s47 offen lds
    s_add_u32 m0, m0, 1024
    s_add_u32 s47, s47, 16384
    buffer_load_dwordx4 v40, s[20:23], s47 offen lds
    s_add_u32 m0, m0, 1024
    s_add_u32 s47, s47, 16384
    buffer_load_dwordx4 v40, s[20:23], s47 offen lds
    s_add_u32 m0, m0, 1024
    s_add_u32 s47, s47, 16384
    buffer_load_dwordx4 v40, s[20:23], s47 offen lds
    v_cmp_gt_u32 vcc, 6, v25
    s_cbranch_vccz CW_60
    ds_read_b32 v25, v1 offset:0
FW_61:
    s_waitcnt lgkmcnt(0)
    v_cmp_gt_u32 vcc, 6, v25
    s_cbranch_vccz FO_62
    s_sleep 2
    ds_read_b32 v25, v1 offset:0
    s_branch FW_61
FO_62:
CW_60:
    s_waitcnt vmcnt(8)
    s_add_u32 s47, s81, 11
    s_and_b32 s47, s47, 15
    s_lshl_b32 s47, s47, 17
    s_add_u32 m0, s79, 98304
    s_add_u32 s47, s47, s57
    buffer_load_dwordx4 v40, s[20:23], s47 offen lds
    s_add_u32 m0, m0, 1024
    s_add_u32 s47, s47, 16384
    buffer_load_dwordx4 v40, s[20:23], s47 offen lds
    s_add_u32 m0, m0, 1024
    s_add_u32 s47, s47, 16384
    buffer_load_dwordx4 v40, s[20:23], s47 offen lds
    s_add_u32 m0, m0, 1024
    s_add_u32 s47, s47, 16384
    buffer_load_dwordx4 v40, s[20:23], s47 offen lds
    v_cmp_gt_u32 vcc, 7, v25
    s_cbranch_vccz CW_63
    ds_read_b32 v25, v1 offset:0
FW_64:
    s_waitcnt lgkmcnt(0)
    v_cmp_gt_u32 vcc, 7, v25
    s_cbranch_vccz FO_65
    s_sleep 2
    ds_read_b32 v25, v1 offset:0
    s_branch FW_64
FO_65:
CW_63:
    s_waitcnt vmcnt(8)
    s_add_u32 s47, s81, 12
    s_and_b32 s47, s47, 15
    s_lshl_b32 s47, s47, 17
    s_add_u32 m0, s79, 90112
    s_add_u32 s47, s47, s57
    buffer_load_dwordx4 v40, s[20:23], s47 offen lds
    s_add_u32 m0, m0, 1024
    s_add_u32 s47, s47, 16384
    buffer_load_dwordx4 v40, s[20:23], s47 offen lds
    s_add_u32 m0, m0, 1024
    s_add_u32 s47, s47, 16384
    buffer_load_dwordx4 v40, s[20:23], s47 offen lds
    s_add_u32 m0, m0, 1024
    s_add_u32 s47, s47, 16384
    buffer_load_dwordx4 v40, s[20:23], s47 offen lds
    v_cmp_gt_u32 vcc, 8, v25
    s_cbranch_vccz CW_66
    ds_read_b32 v25, v1 offset:0
FW_67:
    s_waitcnt lgkmcnt(0)
    v_cmp_gt_u32 vcc, 8, v25
    s_cbranch_vccz FO_68
    s_sleep 2
    ds_read_b32 v25, v1 offset:0
    s_branch FW_67
FO_68:
CW_66:
    s_waitcnt vmcnt(8)
    s_add_u32 s47, s81, 13
    s_and_b32 s47, s47, 15
    s_lshl_b32 s47, s47, 17
    s_add_u32 m0, s79, 114688
    s_add_u32 s47, s47, s57
    buffer_load_dwordx4 v40, s[20:23], s47 offen lds
    s_add_u32 m0, m0, 1024
    s_add_u32 s47, s47, 16384
    buffer_load_dwordx4 v40, s[20:23], s47 offen lds
    s_add_u32 m0, m0, 1024
    s_add_u32 s47, s47, 16384
    buffer_load_dwordx4 v40, s[20:23], s47 offen lds
    s_add_u32 m0, m0, 1024
    s_add_u32 s47, s47, 16384
    buffer_load_dwordx4 v40, s[20:23], s47 offen lds
    v_cmp_gt_u32 vcc, 9, v25
    s_cbranch_vccz CW_69
    ds_read_b32 v25, v1 offset:0
FW_70:
    s_waitcnt lgkmcnt(0)
    v_cmp_gt_u32 vcc, 9, v25
    s_cbranch_vccz FO_71
    s_sleep 2
    ds_read_b32 v25, v1 offset:0
    s_branch FW_70
FO_71:
CW_69:
    s_waitcnt vmcnt(8)
    s_add_u32 s47, s81, 14
    s_and_b32 s47, s47, 15
    s_lshl_b32 s47, s47, 17
    s_add_u32 m0, s79, 106496
    s_add_u32 s47, s47, s57
    buffer_load_dwordx4 v40, s[20:23], s47 offen lds
    s_add_u32 m0, m0, 1024
    s_add_u32 s47, s47, 16384
    buffer_load_dwordx4 v40, s[20:23], s47 offen lds
    s_add_u32 m0, m0, 1024
    s_add_u32 s47, s47, 16384
    buffer_load_dwordx4 v40, s[20:23], s47 offen lds
    s_add_u32 m0, m0, 1024
    s_add_u32 s47, s47, 16384
    buffer_load_dwordx4 v40, s[20:23], s47 offen lds
    v_cmp_gt_u32 vcc, 10, v25
    s_cbranch_vccz CW_72
    ds_read_b32 v25, v1 offset:0
FW_73:
    s_waitcnt lgkmcnt(0)
    v_cmp_gt_u32 vcc, 10, v25
    s_cbranch_vccz FO_74
    s_sleep 2
    ds_read_b32 v25, v1 offset:0
    s_branch FW_73
FO_74:
CW_72:
    s_waitcnt vmcnt(8)
    s_add_u32 s47, s81, 15
    s_and_b32 s47, s47, 15
    s_lshl_b32 s47, s47, 17
    s_add_u32 m0, s79, 122880
    s_add_u32 s47, s47, s57
    buffer_load_dwordx4 v40, s[20:23], s47 offen lds
    s_add_u32 m0, m0, 1024
    s_add_u32 s47, s47, 16384
    buffer_load_dwordx4 v40, s[20:23], s47 offen lds
    s_add_u32 m0, m0, 1024
    s_add_u32 s47, s47, 16384
    buffer_load_dwordx4 v40, s[20:23], s47 offen lds
    s_add_u32 m0, m0, 1024
    s_add_u32 s47, s47, 16384
    buffer_load_dwordx4 v40, s[20:23], s47 offen lds
F_wj:
    v_mov_b32 v5, 159096
    s_branch IW_s6
IW_w6:
    s_branch IW_r6
IW_s6:
    ds_read_b32 v6, v5 offset:0
FW_75:
    s_waitcnt lgkmcnt(0)
    v_cmp_gt_u32 vcc, 1, v6
    s_cbranch_vccz FO_76
    s_sleep 1
    ds_read_b32 v6, v5 offset:0
    s_branch FW_75
FO_76:
    v_and_b32 v5, 7, v0
    v_lshlrev_b32 v5, 2, v5
    v_add_u32 v5, 158976, v5
    ds_read_b32 v5, v5
    s_lshr_b32 s47, s64, 5
    s_sub_u32 s47, 63, s47
    s_mov_b64 s[60:61], 0
    s_waitcnt lgkmcnt(0)
    v_bfe_u32 v5, v5, 5, 6
    v_cmp_eq_u32 vcc, s47, v5
    s_cbranch_vccz F_ns

    v_mov_b32 v5, 158976
    ds_read_b128 v[44:47], v5
    ds_read_b128 v[48:51], v5 offset:16
    v_and_b32 v6, 15, v0
    v_add_u32 v6, s64, v6
    v_sub_u32 v6, 2047, v6
    v_subrev_u32 v7, 16, v6
    v_mov_b32 v164, 0
    v_mov_b32 v165, 0
    s_waitcnt lgkmcnt(0)
    v_and_b32 v5, 0x7ff, v44
    v_or_b32 v44, 0x4000, v44
    v_cmp_eq_u32 vcc, v5, v6
    v_cmp_eq_u32 s[62:63], v5, v7
    s_nop 0
    v_cndmask_b32 v164, v164, v44, vcc
    v_cndmask_b32 v165, v165, v44, s[62:63]
    v_and_b32 v5, 0x7ff, v45
    v_or_b32 v45, 0x4800, v45
    v_cmp_eq_u32 vcc, v5, v6
    v_cmp_eq_u32 s[62:63], v5, v7
    s_nop 0
    v_cndmask_b32 v164, v164, v45, vcc
    v_cndmask_b32 v165, v165, v45, s[62:63]
    v_and_b32 v5, 0x7ff, v46
    v_or_b32 v46, 0x5000, v46
    v_cmp_eq_u32 vcc, v5, v6
    v_cmp_eq_u32 s[62:63], v5, v7
    s_nop 0
    v_cndmask_b32 v164, v164, v46, vcc
    v_cndmask_b32 v165, v165, v46, s[62:63]
    v_and_b32 v5, 0x7ff, v47
    v_or_b32 v47, 0x5800, v47
    v_cmp_eq_u32 vcc, v5, v6
    v_cmp_eq_u32 s[62:63], v5, v7
    s_nop 0
    v_cndmask_b32 v164, v164, v47, vcc
    v_cndmask_b32 v165, v165, v47, s[62:63]
    v_and_b32 v5, 0x7ff, v48
    v_or_b32 v48, 0x6000, v48
    v_cmp_eq_u32 vcc, v5, v6
    v_cmp_eq_u32 s[62:63], v5, v7
    s_nop 0
    v_cndmask_b32 v164, v164, v48, vcc
    v_cndmask_b32 v165, v165, v48, s[62:63]
    v_and_b32 v5, 0x7ff, v49
    v_or_b32 v49, 0x6800, v49
    v_cmp_eq_u32 vcc, v5, v6
    v_cmp_eq_u32 s[62:63], v5, v7
    s_nop 0
    v_cndmask_b32 v164, v164, v49, vcc
    v_cndmask_b32 v165, v165, v49, s[62:63]
    v_and_b32 v5, 0x7ff, v50
    v_or_b32 v50, 0x7000, v50
    v_cmp_eq_u32 vcc, v5, v6
    v_cmp_eq_u32 s[62:63], v5, v7
    s_nop 0
    v_cndmask_b32 v164, v164, v50, vcc
    v_cndmask_b32 v165, v165, v50, s[62:63]
    v_and_b32 v5, 0x7ff, v51
    v_or_b32 v51, 0x7800, v51
    v_cmp_eq_u32 vcc, v5, v6
    v_cmp_eq_u32 s[62:63], v5, v7
    s_nop 0
    v_cndmask_b32 v164, v164, v51, vcc
    v_cndmask_b32 v165, v165, v51, s[62:63]
    s_mov_b64 s[60:61], 1
F_ns:
    s_lshl_b32 s51, s28, 2
    s_add_u32 s51, s51, s3
    s_lshl_b32 s51, s51, 3
    s_and_b32 s47, s29, 3
    s_add_u32 s51, s51, s47
    s_lshl_b32 s51, s51, 7

    s_add_u32 s54, s51, 0x835000
    s_add_u32 s54, s72, s54
    s_addc_u32 s55, s73, 0
    v_lshlrev_b32 v98, 4, v0
    v_lshrrev_b32 v16, 4, v0
    v_bfe_u32 v17, v0, 2, 2
    v_lshl_add_u32 v17, v16, 2, v17
    v_bfe_u32 v16, v17, 1, 2
    v_lshlrev_b32 v16, 5, v16
    v_lshl_add_u32 v16, v17, 7, v16
    v_and_b32 v17, 3, v0
    v_lshl_add_u32 v4, v17, 3, v16
    v_xor_b32 v5, 32, v4
    v_xor_b32 v6, 64, v4
    v_xor_b32 v7, 96, v4
    s_lshl_b32 s79, s28, 18
    s_lshl_b32 s80, s3, 16
    s_add_u32 s79, s79, s80
    s_lshl_b32 s81, s81, 11
    v_mov_b32 v99, 1

    v_add_u32 v8, 57344, v4
    v_add_u32 v9, 57344, v5
    v_add_u32 v10, 57344, v6
    v_add_u32 v11, 57344, v7
    v_add_u32 v12, 114688, v4
    v_add_u32 v13, 114688, v5
    v_add_u32 v14, 114688, v6
    v_add_u32 v15, 114688, v7
    s_add_u32 s16, s72, 0x400000
    s_addc_u32 s17, s73, 0
    s_mov_b32 s18, 0x400000
    s_mov_b32 s19, 0x00020000
    s_mov_b32 s12, s68
    s_mov_b32 s13, s69
    s_mov_b32 s14, 0x400000
    s_mov_b32 s15, 0x00020000
    s_add_u32 s80, s81, 0
    s_and_b32 s80, s80, 0x7fff
    s_add_u32 s4, s80, s79
    s_add_u32 s80, s81, 2048
    s_and_b32 s80, s80, 0x7fff
    s_add_u32 s5, s80, s79
    s_add_u32 s80, s81, 4096
    s_and_b32 s80, s80, 0x7fff
    s_add_u32 s6, s80, s79
    s_add_u32 s80, s81, 6144
    s_and_b32 s80, s80, 0x7fff
    s_add_u32 s7, s80, s79
    s_add_u32 s80, s81, 8192
    s_and_b32 s80, s80, 0x7fff
    s_add_u32 s8, s80, s79
    s_add_u32 s80, s81, 10240
    s_and_b32 s80, s80, 0x7fff
    s_add_u32 s9, s80, s79
    s_add_u32 s80, s81, 12288
    s_and_b32 s80, s80, 0x7fff
    s_add_u32 s10, s80, s79
    s_add_u32 s80, s81, 14336
    s_and_b32 s80, s80, 0x7fff
    s_add_u32 s11, s80, s79
    s_add_u32 s80, s81, 16384
    s_and_b32 s80, s80, 0x7fff
    s_add_u32 s30, s80, s79
    s_add_u32 s80, s81, 18432
    s_and_b32 s80, s80, 0x7fff
    s_add_u32 s31, s80, s79
    s_add_u32 s80, s81, 20480
    s_and_b32 s80, s80, 0x7fff
    s_add_u32 s32, s80, s79
    s_add_u32 s80, s81, 22528
    s_and_b32 s80, s80, 0x7fff
    s_add_u32 s33, s80, s79
    s_add_u32 s80, s81, 24576
    s_and_b32 s80, s80, 0x7fff
    s_add_u32 s34, s80, s79
    s_add_u32 s80, s81, 26624
    s_and_b32 s80, s80, 0x7fff
    s_add_u32 s35, s80, s79
    s_add_u32 s80, s81, 28672
    s_and_b32 s80, s80, 0x7fff
    s_add_u32 s36, s80, s79
    s_add_u32 s80, s81, 30720
    s_and_b32 s80, s80, 0x7fff
    s_add_u32 s37, s80, s79
    v_add_u32 v97, 0x8000, v98
    s_setprio 2
    s_mov_b32 s50, 0
F_op:
    s_load_dword s47, s[54:55], 0 glc
    s_getreg_b32 s51, hwreg(HW_REG_IB_STS)
    s_and_b32 s51, s51, 0xc0000f
    s_or_b32 s51, s51, s50
    s_cbranch_scc1 F_oq
    s_mov_b64 exec, 1
    ds_write_b32 v3, v99 offset:160
    s_mov_b64 exec, -1
    s_mov_b32 s50, 1
F_oq:
    s_waitcnt lgkmcnt(0)
    s_cmp_lt_u32 s47, 16
    s_cbranch_scc1 F_op
    buffer_load_dwordx4 v[48:51], v98, s[16:19], s4 offen offset:0 sc1
    buffer_load_dwordx4 v[52:55], v97, s[16:19], s4 offen offset:0 sc1
    buffer_load_dwordx4 v[56:59], v98, s[16:19], s4 offen offset:1024 sc1
    buffer_load_dwordx4 v[60:63], v97, s[16:19], s4 offen offset:1024 sc1
    buffer_load_dwordx4 v[64:67], v98, s[16:19], s5 offen offset:0 sc1
    buffer_load_dwordx4 v[68:71], v97, s[16:19], s5 offen offset:0 sc1
    buffer_load_dwordx4 v[72:75], v98, s[16:19], s5 offen offset:1024 sc1
    buffer_load_dwordx4 v[76:79], v97, s[16:19], s5 offen offset:1024 sc1
    buffer_load_dwordx4 v[80:83], v98, s[16:19], s6 offen offset:0 sc1
    buffer_load_dwordx4 v[84:87], v97, s[16:19], s6 offen offset:0 sc1
    buffer_load_dwordx4 v[88:91], v98, s[16:19], s6 offen offset:1024 sc1
    buffer_load_dwordx4 v[92:95], v97, s[16:19], s6 offen offset:1024 sc1
    s_cmp_lg_u32 s50, 0
    s_cbranch_scc1 F_or
    s_waitcnt vmcnt(12)
    s_mov_b64 exec, 1
    ds_write_b32 v3, v99 offset:160
    s_mov_b64 exec, -1
F_or:
    v_or_b32 v17, 8, v1
    ds_read_b32 v16, v17 offset:160
FW_77:
    s_waitcnt lgkmcnt(0)
    v_cmp_gt_u32 vcc, 1, v16
    s_cbranch_vccz FO_78
    ds_read_b32 v16, v17 offset:160
    s_branch FW_77
FO_78:
    v_and_b32 v1, 0x3fff, v2
    v_bfe_u32 v99, v0, 3, 1
    v_lshl_add_u32 v1, v99, 6, v1
    ds_read_b64_tr_b16 v[16:17], v12 offset:32768
    ds_read_b64_tr_b16 v[18:19], v12 offset:34816
    ds_read_b64_tr_b16 v[20:21], v13 offset:32768
    ds_read_b64_tr_b16 v[22:23], v13 offset:34816
    ds_read_b64_tr_b16 v[24:25], v14 offset:32768
    ds_read_b64_tr_b16 v[26:27], v14 offset:34816
    ds_read_b64_tr_b16 v[28:29], v15 offset:32768
    ds_read_b64_tr_b16 v[30:31], v15 offset:34816
    s_waitcnt vmcnt(10) lgkmcnt(0)
    v_mfma_f32_16x16x32_bf16 v[100:103], v[16:19], v[48:51], v[100:103]
    ds_read_b64_tr_b16 v[32:33], v12 offset:36864
    ds_read_b64_tr_b16 v[34:35], v12 offset:38912
    v_mfma_f32_16x16x32_bf16 v[116:119], v[16:19], v[52:55], v[116:119]
    ds_read_b64_tr_b16 v[36:37], v13 offset:36864
    ds_read_b64_tr_b16 v[38:39], v13 offset:38912
    v_mfma_f32_16x16x32_bf16 v[104:107], v[20:23], v[48:51], v[104:107]
    ds_read_b64_tr_b16 v[40:41], v14 offset:36864
    ds_read_b64_tr_b16 v[42:43], v14 offset:38912
    v_mfma_f32_16x16x32_bf16 v[120:123], v[20:23], v[52:55], v[120:123]
    ds_read_b64_tr_b16 v[44:45], v15 offset:36864
    ds_read_b64_tr_b16 v[46:47], v15 offset:38912
    v_mfma_f32_16x16x32_bf16 v[108:111], v[24:27], v[48:51], v[108:111]
    buffer_load_dwordx4 v[132:135], v98, s[16:19], s7 offen offset:0 sc1
    v_mfma_f32_16x16x32_bf16 v[124:127], v[24:27], v[52:55], v[124:127]
    v_mfma_f32_16x16x32_bf16 v[112:115], v[28:31], v[48:51], v[112:115]
    buffer_load_dwordx4 v[136:139], v97, s[16:19], s7 offen offset:0 sc1
    v_mfma_f32_16x16x32_bf16 v[128:131], v[28:31], v[52:55], v[128:131]
    s_waitcnt vmcnt(10) lgkmcnt(0)
    v_mfma_f32_16x16x32_bf16 v[100:103], v[32:35], v[56:59], v[100:103]
    ds_read_b64_tr_b16 v[16:17], v4 offset:0
    ds_read_b64_tr_b16 v[18:19], v4 offset:2048
    v_mfma_f32_16x16x32_bf16 v[116:119], v[32:35], v[60:63], v[116:119]
    ds_read_b64_tr_b16 v[20:21], v5 offset:0
    ds_read_b64_tr_b16 v[22:23], v5 offset:2048
    v_mfma_f32_16x16x32_bf16 v[104:107], v[36:39], v[56:59], v[104:107]
    ds_read_b64_tr_b16 v[24:25], v6 offset:0
    ds_read_b64_tr_b16 v[26:27], v6 offset:2048
    v_mfma_f32_16x16x32_bf16 v[120:123], v[36:39], v[60:63], v[120:123]
    ds_read_b64_tr_b16 v[28:29], v7 offset:0
    ds_read_b64_tr_b16 v[30:31], v7 offset:2048
    v_mfma_f32_16x16x32_bf16 v[108:111], v[40:43], v[56:59], v[108:111]
    buffer_load_dwordx4 v[48:51], v98, s[16:19], s7 offen offset:1024 sc1
    v_mfma_f32_16x16x32_bf16 v[124:127], v[40:43], v[60:63], v[124:127]
    v_mfma_f32_16x16x32_bf16 v[112:115], v[44:47], v[56:59], v[112:115]
    buffer_load_dwordx4 v[52:55], v97, s[16:19], s7 offen offset:1024 sc1
    v_mfma_f32_16x16x32_bf16 v[128:131], v[44:47], v[60:63], v[128:131]
    s_waitcnt vmcnt(10) lgkmcnt(0)
    v_mfma_f32_16x16x32_bf16 v[100:103], v[16:19], v[64:67], v[100:103]
    ds_read_b64_tr_b16 v[32:33], v4 offset:4096
    ds_read_b64_tr_b16 v[34:35], v4 offset:6144
    v_mfma_f32_16x16x32_bf16 v[116:119], v[16:19], v[68:71], v[116:119]
    ds_read_b64_tr_b16 v[36:37], v5 offset:4096
    ds_read_b64_tr_b16 v[38:39], v5 offset:6144
    v_mfma_f32_16x16x32_bf16 v[104:107], v[20:23], v[64:67], v[104:107]
    ds_read_b64_tr_b16 v[40:41], v6 offset:4096
    ds_read_b64_tr_b16 v[42:43], v6 offset:6144
    v_mfma_f32_16x16x32_bf16 v[120:123], v[20:23], v[68:71], v[120:123]
    ds_read_b64_tr_b16 v[44:45], v7 offset:4096
    ds_read_b64_tr_b16 v[46:47], v7 offset:6144
    v_mfma_f32_16x16x32_bf16 v[108:111], v[24:27], v[64:67], v[108:111]
    buffer_load_dwordx4 v[56:59], v98, s[16:19], s8 offen offset:0 sc1
    v_mfma_f32_16x16x32_bf16 v[124:127], v[24:27], v[68:71], v[124:127]
    v_mfma_f32_16x16x32_bf16 v[112:115], v[28:31], v[64:67], v[112:115]
    buffer_load_dwordx4 v[60:63], v97, s[16:19], s8 offen offset:0 sc1
    v_mfma_f32_16x16x32_bf16 v[128:131], v[28:31], v[68:71], v[128:131]
    s_waitcnt vmcnt(10) lgkmcnt(0)
    v_mfma_f32_16x16x32_bf16 v[100:103], v[32:35], v[72:75], v[100:103]
    ds_read_b64_tr_b16 v[16:17], v4 offset:8192
    ds_read_b64_tr_b16 v[18:19], v4 offset:10240
    v_mfma_f32_16x16x32_bf16 v[116:119], v[32:35], v[76:79], v[116:119]
    ds_read_b64_tr_b16 v[20:21], v5 offset:8192
    ds_read_b64_tr_b16 v[22:23], v5 offset:10240
    v_mfma_f32_16x16x32_bf16 v[104:107], v[36:39], v[72:75], v[104:107]
    ds_read_b64_tr_b16 v[24:25], v6 offset:8192
    ds_read_b64_tr_b16 v[26:27], v6 offset:10240
    v_mfma_f32_16x16x32_bf16 v[120:123], v[36:39], v[76:79], v[120:123]
    ds_read_b64_tr_b16 v[28:29], v7 offset:8192
    ds_read_b64_tr_b16 v[30:31], v7 offset:10240
    v_mfma_f32_16x16x32_bf16 v[108:111], v[40:43], v[72:75], v[108:111]
    buffer_load_dwordx4 v[64:67], v98, s[16:19], s8 offen offset:1024 sc1
    v_mfma_f32_16x16x32_bf16 v[124:127], v[40:43], v[76:79], v[124:127]
    v_mfma_f32_16x16x32_bf16 v[112:115], v[44:47], v[72:75], v[112:115]
    buffer_load_dwordx4 v[68:71], v97, s[16:19], s8 offen offset:1024 sc1
    v_mfma_f32_16x16x32_bf16 v[128:131], v[44:47], v[76:79], v[128:131]
    s_waitcnt vmcnt(10) lgkmcnt(0)
    v_mfma_f32_16x16x32_bf16 v[100:103], v[16:19], v[80:83], v[100:103]
    ds_read_b64_tr_b16 v[32:33], v4 offset:12288
    ds_read_b64_tr_b16 v[34:35], v4 offset:14336
    v_mfma_f32_16x16x32_bf16 v[116:119], v[16:19], v[84:87], v[116:119]
    ds_read_b64_tr_b16 v[36:37], v5 offset:12288
    ds_read_b64_tr_b16 v[38:39], v5 offset:14336
    v_mfma_f32_16x16x32_bf16 v[104:107], v[20:23], v[80:83], v[104:107]
    ds_read_b64_tr_b16 v[40:41], v6 offset:12288
    ds_read_b64_tr_b16 v[42:43], v6 offset:14336
    v_mfma_f32_16x16x32_bf16 v[120:123], v[20:23], v[84:87], v[120:123]
    ds_read_b64_tr_b16 v[44:45], v7 offset:12288
    ds_read_b64_tr_b16 v[46:47], v7 offset:14336
    v_mfma_f32_16x16x32_bf16 v[108:111], v[24:27], v[80:83], v[108:111]
    buffer_load_dwordx4 v[72:75], v98, s[16:19], s9 offen offset:0 sc1
    v_mfma_f32_16x16x32_bf16 v[124:127], v[24:27], v[84:87], v[124:127]
    v_mfma_f32_16x16x32_bf16 v[112:115], v[28:31], v[80:83], v[112:115]
    buffer_load_dwordx4 v[76:79], v97, s[16:19], s9 offen offset:0 sc1
    v_mfma_f32_16x16x32_bf16 v[128:131], v[28:31], v[84:87], v[128:131]
    s_waitcnt vmcnt(10) lgkmcnt(0)
    v_mfma_f32_16x16x32_bf16 v[100:103], v[32:35], v[88:91], v[100:103]
    ds_read_b64_tr_b16 v[16:17], v12 offset:24576
    ds_read_b64_tr_b16 v[18:19], v12 offset:26624
    v_mfma_f32_16x16x32_bf16 v[116:119], v[32:35], v[92:95], v[116:119]
    ds_read_b64_tr_b16 v[20:21], v13 offset:24576
    ds_read_b64_tr_b16 v[22:23], v13 offset:26624
    v_mfma_f32_16x16x32_bf16 v[104:107], v[36:39], v[88:91], v[104:107]
    ds_read_b64_tr_b16 v[24:25], v14 offset:24576
    ds_read_b64_tr_b16 v[26:27], v14 offset:26624
    v_mfma_f32_16x16x32_bf16 v[120:123], v[36:39], v[92:95], v[120:123]
    ds_read_b64_tr_b16 v[28:29], v15 offset:24576
    ds_read_b64_tr_b16 v[30:31], v15 offset:26624
    v_mfma_f32_16x16x32_bf16 v[108:111], v[40:43], v[88:91], v[108:111]
    buffer_load_dwordx4 v[80:83], v98, s[16:19], s9 offen offset:1024 sc1
    v_mfma_f32_16x16x32_bf16 v[124:127], v[40:43], v[92:95], v[124:127]
    v_mfma_f32_16x16x32_bf16 v[112:115], v[44:47], v[88:91], v[112:115]
    buffer_load_dwordx4 v[84:87], v97, s[16:19], s9 offen offset:1024 sc1
    v_mfma_f32_16x16x32_bf16 v[128:131], v[44:47], v[92:95], v[128:131]
    s_waitcnt vmcnt(10) lgkmcnt(0)
    v_mfma_f32_16x16x32_bf16 v[100:103], v[16:19], v[132:135], v[100:103]
    ds_read_b64_tr_b16 v[32:33], v12 offset:28672
    ds_read_b64_tr_b16 v[34:35], v12 offset:30720
    v_mfma_f32_16x16x32_bf16 v[116:119], v[16:19], v[136:139], v[116:119]
    ds_read_b64_tr_b16 v[36:37], v13 offset:28672
    ds_read_b64_tr_b16 v[38:39], v13 offset:30720
    v_mfma_f32_16x16x32_bf16 v[104:107], v[20:23], v[132:135], v[104:107]
    ds_read_b64_tr_b16 v[40:41], v14 offset:28672
    ds_read_b64_tr_b16 v[42:43], v14 offset:30720
    v_mfma_f32_16x16x32_bf16 v[120:123], v[20:23], v[136:139], v[120:123]
    ds_read_b64_tr_b16 v[44:45], v15 offset:28672
    ds_read_b64_tr_b16 v[46:47], v15 offset:30720
    v_mfma_f32_16x16x32_bf16 v[108:111], v[24:27], v[132:135], v[108:111]
    buffer_load_dwordx4 v[88:91], v98, s[16:19], s10 offen offset:0 sc1
    v_mfma_f32_16x16x32_bf16 v[124:127], v[24:27], v[136:139], v[124:127]
    v_mfma_f32_16x16x32_bf16 v[112:115], v[28:31], v[132:135], v[112:115]
    buffer_load_dwordx4 v[92:95], v97, s[16:19], s10 offen offset:0 sc1
    v_mfma_f32_16x16x32_bf16 v[128:131], v[28:31], v[136:139], v[128:131]
    s_waitcnt vmcnt(10) lgkmcnt(0)
    v_mfma_f32_16x16x32_bf16 v[100:103], v[32:35], v[48:51], v[100:103]
    ds_read_b64_tr_b16 v[16:17], v4 offset:16384
    ds_read_b64_tr_b16 v[18:19], v4 offset:18432
    v_mfma_f32_16x16x32_bf16 v[116:119], v[32:35], v[52:55], v[116:119]
    ds_read_b64_tr_b16 v[20:21], v5 offset:16384
    ds_read_b64_tr_b16 v[22:23], v5 offset:18432
    v_mfma_f32_16x16x32_bf16 v[104:107], v[36:39], v[48:51], v[104:107]
    ds_read_b64_tr_b16 v[24:25], v6 offset:16384
    ds_read_b64_tr_b16 v[26:27], v6 offset:18432
    v_mfma_f32_16x16x32_bf16 v[120:123], v[36:39], v[52:55], v[120:123]
    ds_read_b64_tr_b16 v[28:29], v7 offset:16384
    ds_read_b64_tr_b16 v[30:31], v7 offset:18432
    v_mfma_f32_16x16x32_bf16 v[108:111], v[40:43], v[48:51], v[108:111]
    buffer_load_dwordx4 v[132:135], v98, s[16:19], s10 offen offset:1024 sc1
    v_mfma_f32_16x16x32_bf16 v[124:127], v[40:43], v[52:55], v[124:127]
    v_mfma_f32_16x16x32_bf16 v[112:115], v[44:47], v[48:51], v[112:115]
    buffer_load_dwordx4 v[136:139], v97, s[16:19], s10 offen offset:1024 sc1
    v_mfma_f32_16x16x32_bf16 v[128:131], v[44:47], v[52:55], v[128:131]
    s_waitcnt vmcnt(10) lgkmcnt(0)
    v_mfma_f32_16x16x32_bf16 v[100:103], v[16:19], v[56:59], v[100:103]
    ds_read_b64_tr_b16 v[32:33], v4 offset:20480
    ds_read_b64_tr_b16 v[34:35], v4 offset:22528
    v_mfma_f32_16x16x32_bf16 v[116:119], v[16:19], v[60:63], v[116:119]
    ds_read_b64_tr_b16 v[36:37], v5 offset:20480
    ds_read_b64_tr_b16 v[38:39], v5 offset:22528
    v_mfma_f32_16x16x32_bf16 v[104:107], v[20:23], v[56:59], v[104:107]
    ds_read_b64_tr_b16 v[40:41], v6 offset:20480
    ds_read_b64_tr_b16 v[42:43], v6 offset:22528
    v_mfma_f32_16x16x32_bf16 v[120:123], v[20:23], v[60:63], v[120:123]
    ds_read_b64_tr_b16 v[44:45], v7 offset:20480
    ds_read_b64_tr_b16 v[46:47], v7 offset:22528
    v_mfma_f32_16x16x32_bf16 v[108:111], v[24:27], v[56:59], v[108:111]
    buffer_load_dwordx4 v[48:51], v98, s[16:19], s11 offen offset:0 sc1
    v_mfma_f32_16x16x32_bf16 v[124:127], v[24:27], v[60:63], v[124:127]
    v_mfma_f32_16x16x32_bf16 v[112:115], v[28:31], v[56:59], v[112:115]
    buffer_load_dwordx4 v[52:55], v97, s[16:19], s11 offen offset:0 sc1
    v_mfma_f32_16x16x32_bf16 v[128:131], v[28:31], v[60:63], v[128:131]
    s_waitcnt vmcnt(10) lgkmcnt(0)
    v_mfma_f32_16x16x32_bf16 v[100:103], v[32:35], v[64:67], v[100:103]
    ds_read_b64_tr_b16 v[16:17], v4 offset:24576
    ds_read_b64_tr_b16 v[18:19], v4 offset:26624
    v_mfma_f32_16x16x32_bf16 v[116:119], v[32:35], v[68:71], v[116:119]
    ds_read_b64_tr_b16 v[20:21], v5 offset:24576
    ds_read_b64_tr_b16 v[22:23], v5 offset:26624
    v_mfma_f32_16x16x32_bf16 v[104:107], v[36:39], v[64:67], v[104:107]
    ds_read_b64_tr_b16 v[24:25], v6 offset:24576
    ds_read_b64_tr_b16 v[26:27], v6 offset:26624
    v_mfma_f32_16x16x32_bf16 v[120:123], v[36:39], v[68:71], v[120:123]
    ds_read_b64_tr_b16 v[28:29], v7 offset:24576
    ds_read_b64_tr_b16 v[30:31], v7 offset:26624
    v_mfma_f32_16x16x32_bf16 v[108:111], v[40:43], v[64:67], v[108:111]
    buffer_load_dwordx4 v[56:59], v98, s[16:19], s11 offen offset:1024 sc1
    v_mfma_f32_16x16x32_bf16 v[124:127], v[40:43], v[68:71], v[124:127]
    v_mfma_f32_16x16x32_bf16 v[112:115], v[44:47], v[64:67], v[112:115]
    buffer_load_dwordx4 v[60:63], v97, s[16:19], s11 offen offset:1024 sc1
    v_mfma_f32_16x16x32_bf16 v[128:131], v[44:47], v[68:71], v[128:131]
    s_waitcnt vmcnt(10) lgkmcnt(0)
    v_mfma_f32_16x16x32_bf16 v[100:103], v[16:19], v[72:75], v[100:103]
    ds_read_b64_tr_b16 v[32:33], v4 offset:28672
    ds_read_b64_tr_b16 v[34:35], v4 offset:30720
    v_mfma_f32_16x16x32_bf16 v[116:119], v[16:19], v[76:79], v[116:119]
    ds_read_b64_tr_b16 v[36:37], v5 offset:28672
    ds_read_b64_tr_b16 v[38:39], v5 offset:30720
    v_mfma_f32_16x16x32_bf16 v[104:107], v[20:23], v[72:75], v[104:107]
    ds_read_b64_tr_b16 v[40:41], v6 offset:28672
    ds_read_b64_tr_b16 v[42:43], v6 offset:30720
    v_mfma_f32_16x16x32_bf16 v[120:123], v[20:23], v[76:79], v[120:123]
    ds_read_b64_tr_b16 v[44:45], v7 offset:28672
    ds_read_b64_tr_b16 v[46:47], v7 offset:30720
    v_mfma_f32_16x16x32_bf16 v[108:111], v[24:27], v[72:75], v[108:111]
    buffer_load_dwordx4 v[64:67], v98, s[16:19], s30 offen offset:0 sc1
    v_mfma_f32_16x16x32_bf16 v[124:127], v[24:27], v[76:79], v[124:127]
    v_mfma_f32_16x16x32_bf16 v[112:115], v[28:31], v[72:75], v[112:115]
    buffer_load_dwordx4 v[68:71], v97, s[16:19], s30 offen offset:0 sc1
    v_mfma_f32_16x16x32_bf16 v[128:131], v[28:31], v[76:79], v[128:131]
    s_waitcnt vmcnt(10) lgkmcnt(0)
    v_mfma_f32_16x16x32_bf16 v[100:103], v[32:35], v[80:83], v[100:103]
    ds_read_b64_tr_b16 v[16:17], v12 offset:16384
    ds_read_b64_tr_b16 v[18:19], v12 offset:18432
    v_mfma_f32_16x16x32_bf16 v[116:119], v[32:35], v[84:87], v[116:119]
    ds_read_b64_tr_b16 v[20:21], v13 offset:16384
    ds_read_b64_tr_b16 v[22:23], v13 offset:18432
    v_mfma_f32_16x16x32_bf16 v[104:107], v[36:39], v[80:83], v[104:107]
    ds_read_b64_tr_b16 v[24:25], v14 offset:16384
    ds_read_b64_tr_b16 v[26:27], v14 offset:18432
    v_mfma_f32_16x16x32_bf16 v[120:123], v[36:39], v[84:87], v[120:123]
    ds_read_b64_tr_b16 v[28:29], v15 offset:16384
    ds_read_b64_tr_b16 v[30:31], v15 offset:18432
    v_mfma_f32_16x16x32_bf16 v[108:111], v[40:43], v[80:83], v[108:111]
    buffer_load_dwordx4 v[72:75], v98, s[16:19], s30 offen offset:1024 sc1
    v_mfma_f32_16x16x32_bf16 v[124:127], v[40:43], v[84:87], v[124:127]
    v_mfma_f32_16x16x32_bf16 v[112:115], v[44:47], v[80:83], v[112:115]
    buffer_load_dwordx4 v[76:79], v97, s[16:19], s30 offen offset:1024 sc1
    v_mfma_f32_16x16x32_bf16 v[128:131], v[44:47], v[84:87], v[128:131]
    s_waitcnt vmcnt(10) lgkmcnt(0)
    v_mfma_f32_16x16x32_bf16 v[100:103], v[16:19], v[88:91], v[100:103]
    ds_read_b64_tr_b16 v[32:33], v12 offset:20480
    ds_read_b64_tr_b16 v[34:35], v12 offset:22528
    v_mfma_f32_16x16x32_bf16 v[116:119], v[16:19], v[92:95], v[116:119]
    ds_read_b64_tr_b16 v[36:37], v13 offset:20480
    ds_read_b64_tr_b16 v[38:39], v13 offset:22528
    v_mfma_f32_16x16x32_bf16 v[104:107], v[20:23], v[88:91], v[104:107]
    ds_read_b64_tr_b16 v[40:41], v14 offset:20480
    ds_read_b64_tr_b16 v[42:43], v14 offset:22528
    v_mfma_f32_16x16x32_bf16 v[120:123], v[20:23], v[92:95], v[120:123]
    ds_read_b64_tr_b16 v[44:45], v15 offset:20480
    ds_read_b64_tr_b16 v[46:47], v15 offset:22528
    v_mfma_f32_16x16x32_bf16 v[108:111], v[24:27], v[88:91], v[108:111]
    buffer_load_dwordx4 v[80:83], v98, s[16:19], s31 offen offset:0 sc1
    v_mfma_f32_16x16x32_bf16 v[124:127], v[24:27], v[92:95], v[124:127]
    v_mfma_f32_16x16x32_bf16 v[112:115], v[28:31], v[88:91], v[112:115]
    buffer_load_dwordx4 v[84:87], v97, s[16:19], s31 offen offset:0 sc1
    v_mfma_f32_16x16x32_bf16 v[128:131], v[28:31], v[92:95], v[128:131]
    s_waitcnt vmcnt(10) lgkmcnt(0)
    v_mfma_f32_16x16x32_bf16 v[100:103], v[32:35], v[132:135], v[100:103]
    ds_read_b64_tr_b16 v[16:17], v8 offset:24576
    ds_read_b64_tr_b16 v[18:19], v8 offset:26624
    v_mfma_f32_16x16x32_bf16 v[116:119], v[32:35], v[136:139], v[116:119]
    ds_read_b64_tr_b16 v[20:21], v9 offset:24576
    ds_read_b64_tr_b16 v[22:23], v9 offset:26624
    v_mfma_f32_16x16x32_bf16 v[104:107], v[36:39], v[132:135], v[104:107]
    ds_read_b64_tr_b16 v[24:25], v10 offset:24576
    ds_read_b64_tr_b16 v[26:27], v10 offset:26624
    v_mfma_f32_16x16x32_bf16 v[120:123], v[36:39], v[136:139], v[120:123]
    ds_read_b64_tr_b16 v[28:29], v11 offset:24576
    ds_read_b64_tr_b16 v[30:31], v11 offset:26624
    v_mfma_f32_16x16x32_bf16 v[108:111], v[40:43], v[132:135], v[108:111]
    buffer_load_dwordx4 v[88:91], v98, s[16:19], s31 offen offset:1024 sc1
    v_mfma_f32_16x16x32_bf16 v[124:127], v[40:43], v[136:139], v[124:127]
    v_mfma_f32_16x16x32_bf16 v[112:115], v[44:47], v[132:135], v[112:115]
    buffer_load_dwordx4 v[92:95], v97, s[16:19], s31 offen offset:1024 sc1
    v_mfma_f32_16x16x32_bf16 v[128:131], v[44:47], v[136:139], v[128:131]
    s_waitcnt vmcnt(10) lgkmcnt(0)
    v_mfma_f32_16x16x32_bf16 v[100:103], v[16:19], v[48:51], v[100:103]
    ds_read_b64_tr_b16 v[32:33], v8 offset:28672
    ds_read_b64_tr_b16 v[34:35], v8 offset:30720
    v_mfma_f32_16x16x32_bf16 v[116:119], v[16:19], v[52:55], v[116:119]
    ds_read_b64_tr_b16 v[36:37], v9 offset:28672
    ds_read_b64_tr_b16 v[38:39], v9 offset:30720
    v_mfma_f32_16x16x32_bf16 v[104:107], v[20:23], v[48:51], v[104:107]
    ds_read_b64_tr_b16 v[40:41], v10 offset:28672
    ds_read_b64_tr_b16 v[42:43], v10 offset:30720
    v_mfma_f32_16x16x32_bf16 v[120:123], v[20:23], v[52:55], v[120:123]
    ds_read_b64_tr_b16 v[44:45], v11 offset:28672
    ds_read_b64_tr_b16 v[46:47], v11 offset:30720
    v_mfma_f32_16x16x32_bf16 v[108:111], v[24:27], v[48:51], v[108:111]
    buffer_load_dwordx4 v[132:135], v98, s[16:19], s32 offen offset:0 sc1
    v_mfma_f32_16x16x32_bf16 v[124:127], v[24:27], v[52:55], v[124:127]
    v_mfma_f32_16x16x32_bf16 v[112:115], v[28:31], v[48:51], v[112:115]
    buffer_load_dwordx4 v[136:139], v97, s[16:19], s32 offen offset:0 sc1
    v_mfma_f32_16x16x32_bf16 v[128:131], v[28:31], v[52:55], v[128:131]
    s_waitcnt vmcnt(10) lgkmcnt(0)
    v_mfma_f32_16x16x32_bf16 v[100:103], v[32:35], v[56:59], v[100:103]
    ds_read_b64_tr_b16 v[16:17], v4 offset:49152
    ds_read_b64_tr_b16 v[18:19], v4 offset:51200
    v_mfma_f32_16x16x32_bf16 v[116:119], v[32:35], v[60:63], v[116:119]
    ds_read_b64_tr_b16 v[20:21], v5 offset:49152
    ds_read_b64_tr_b16 v[22:23], v5 offset:51200
    v_mfma_f32_16x16x32_bf16 v[104:107], v[36:39], v[56:59], v[104:107]
    ds_read_b64_tr_b16 v[24:25], v6 offset:49152
    ds_read_b64_tr_b16 v[26:27], v6 offset:51200
    v_mfma_f32_16x16x32_bf16 v[120:123], v[36:39], v[60:63], v[120:123]
    ds_read_b64_tr_b16 v[28:29], v7 offset:49152
    ds_read_b64_tr_b16 v[30:31], v7 offset:51200
    v_mfma_f32_16x16x32_bf16 v[108:111], v[40:43], v[56:59], v[108:111]
    buffer_load_dwordx4 v[48:51], v98, s[16:19], s32 offen offset:1024 sc1
    v_mfma_f32_16x16x32_bf16 v[124:127], v[40:43], v[60:63], v[124:127]
    v_mfma_f32_16x16x32_bf16 v[112:115], v[44:47], v[56:59], v[112:115]
    buffer_load_dwordx4 v[52:55], v97, s[16:19], s32 offen offset:1024 sc1
    v_mfma_f32_16x16x32_bf16 v[128:131], v[44:47], v[60:63], v[128:131]
    s_waitcnt vmcnt(10) lgkmcnt(0)
    v_mfma_f32_16x16x32_bf16 v[100:103], v[16:19], v[64:67], v[100:103]
    ds_read_b64_tr_b16 v[32:33], v4 offset:53248
    ds_read_b64_tr_b16 v[34:35], v4 offset:55296
    v_mfma_f32_16x16x32_bf16 v[116:119], v[16:19], v[68:71], v[116:119]
    ds_read_b64_tr_b16 v[36:37], v5 offset:53248
    ds_read_b64_tr_b16 v[38:39], v5 offset:55296
    v_mfma_f32_16x16x32_bf16 v[104:107], v[20:23], v[64:67], v[104:107]
    ds_read_b64_tr_b16 v[40:41], v6 offset:53248
    ds_read_b64_tr_b16 v[42:43], v6 offset:55296
    v_mfma_f32_16x16x32_bf16 v[120:123], v[20:23], v[68:71], v[120:123]
    ds_read_b64_tr_b16 v[44:45], v7 offset:53248
    ds_read_b64_tr_b16 v[46:47], v7 offset:55296
    v_mfma_f32_16x16x32_bf16 v[108:111], v[24:27], v[64:67], v[108:111]
    buffer_load_dwordx4 v[56:59], v98, s[16:19], s33 offen offset:0 sc1
    v_mfma_f32_16x16x32_bf16 v[124:127], v[24:27], v[68:71], v[124:127]
    v_mfma_f32_16x16x32_bf16 v[112:115], v[28:31], v[64:67], v[112:115]
    buffer_load_dwordx4 v[60:63], v97, s[16:19], s33 offen offset:0 sc1
    v_mfma_f32_16x16x32_bf16 v[128:131], v[28:31], v[68:71], v[128:131]
    s_waitcnt vmcnt(10) lgkmcnt(0)
    v_mfma_f32_16x16x32_bf16 v[100:103], v[32:35], v[72:75], v[100:103]
    ds_read_b64_tr_b16 v[16:17], v8 offset:0
    ds_read_b64_tr_b16 v[18:19], v8 offset:2048
    v_mfma_f32_16x16x32_bf16 v[116:119], v[32:35], v[76:79], v[116:119]
    ds_read_b64_tr_b16 v[20:21], v9 offset:0
    ds_read_b64_tr_b16 v[22:23], v9 offset:2048
    v_mfma_f32_16x16x32_bf16 v[104:107], v[36:39], v[72:75], v[104:107]
    ds_read_b64_tr_b16 v[24:25], v10 offset:0
    ds_read_b64_tr_b16 v[26:27], v10 offset:2048
    v_mfma_f32_16x16x32_bf16 v[120:123], v[36:39], v[76:79], v[120:123]
    ds_read_b64_tr_b16 v[28:29], v11 offset:0
    ds_read_b64_tr_b16 v[30:31], v11 offset:2048
    v_mfma_f32_16x16x32_bf16 v[108:111], v[40:43], v[72:75], v[108:111]
    buffer_load_dwordx4 v[64:67], v98, s[16:19], s33 offen offset:1024 sc1
    v_mfma_f32_16x16x32_bf16 v[124:127], v[40:43], v[76:79], v[124:127]
    v_mfma_f32_16x16x32_bf16 v[112:115], v[44:47], v[72:75], v[112:115]
    buffer_load_dwordx4 v[68:71], v97, s[16:19], s33 offen offset:1024 sc1
    v_mfma_f32_16x16x32_bf16 v[128:131], v[44:47], v[76:79], v[128:131]
    s_waitcnt vmcnt(10) lgkmcnt(0)
    v_mfma_f32_16x16x32_bf16 v[100:103], v[16:19], v[80:83], v[100:103]
    ds_read_b64_tr_b16 v[32:33], v8 offset:4096
    ds_read_b64_tr_b16 v[34:35], v8 offset:6144
    s_branch IW_s7
IW_w7:
    s_branch IW_r7
IW_s7:
    v_mfma_f32_16x16x32_bf16 v[116:119], v[16:19], v[84:87], v[116:119]
    ds_read_b64_tr_b16 v[36:37], v9 offset:4096
    ds_read_b64_tr_b16 v[38:39], v9 offset:6144
    v_mfma_f32_16x16x32_bf16 v[104:107], v[20:23], v[80:83], v[104:107]
    ds_read_b64_tr_b16 v[40:41], v10 offset:4096
    ds_read_b64_tr_b16 v[42:43], v10 offset:6144
    v_mfma_f32_16x16x32_bf16 v[120:123], v[20:23], v[84:87], v[120:123]
    ds_read_b64_tr_b16 v[44:45], v11 offset:4096
    ds_read_b64_tr_b16 v[46:47], v11 offset:6144
    v_mfma_f32_16x16x32_bf16 v[108:111], v[24:27], v[80:83], v[108:111]
    buffer_load_dwordx4 v[72:75], v98, s[16:19], s34 offen offset:0 sc1
    v_mfma_f32_16x16x32_bf16 v[124:127], v[24:27], v[84:87], v[124:127]
    v_mfma_f32_16x16x32_bf16 v[112:115], v[28:31], v[80:83], v[112:115]
    buffer_load_dwordx4 v[76:79], v97, s[16:19], s34 offen offset:0 sc1
    v_mfma_f32_16x16x32_bf16 v[128:131], v[28:31], v[84:87], v[128:131]
    s_waitcnt vmcnt(10) lgkmcnt(0)
    v_mfma_f32_16x16x32_bf16 v[100:103], v[32:35], v[88:91], v[100:103]
    ds_read_b64_tr_b16 v[16:17], v8 offset:16384
    ds_read_b64_tr_b16 v[18:19], v8 offset:18432
    v_mfma_f32_16x16x32_bf16 v[116:119], v[32:35], v[92:95], v[116:119]
    ds_read_b64_tr_b16 v[20:21], v9 offset:16384
    ds_read_b64_tr_b16 v[22:23], v9 offset:18432
    v_mfma_f32_16x16x32_bf16 v[104:107], v[36:39], v[88:91], v[104:107]
    ds_read_b64_tr_b16 v[24:25], v10 offset:16384
    ds_read_b64_tr_b16 v[26:27], v10 offset:18432
    v_mfma_f32_16x16x32_bf16 v[120:123], v[36:39], v[92:95], v[120:123]
    ds_read_b64_tr_b16 v[28:29], v11 offset:16384
    ds_read_b64_tr_b16 v[30:31], v11 offset:18432
    v_mfma_f32_16x16x32_bf16 v[108:111], v[40:43], v[88:91], v[108:111]
    buffer_load_dwordx4 v[80:83], v98, s[16:19], s34 offen offset:1024 sc1
    v_mfma_f32_16x16x32_bf16 v[124:127], v[40:43], v[92:95], v[124:127]
    v_mfma_f32_16x16x32_bf16 v[112:115], v[44:47], v[88:91], v[112:115]
    buffer_load_dwordx4 v[84:87], v97, s[16:19], s34 offen offset:1024 sc1
    v_mfma_f32_16x16x32_bf16 v[128:131], v[44:47], v[92:95], v[128:131]
    s_waitcnt vmcnt(10) lgkmcnt(0)
    v_mfma_f32_16x16x32_bf16 v[100:103], v[16:19], v[132:135], v[100:103]
    ds_read_b64_tr_b16 v[32:33], v8 offset:20480
    ds_read_b64_tr_b16 v[34:35], v8 offset:22528
    v_mfma_f32_16x16x32_bf16 v[116:119], v[16:19], v[136:139], v[116:119]
    ds_read_b64_tr_b16 v[36:37], v9 offset:20480
    ds_read_b64_tr_b16 v[38:39], v9 offset:22528
    v_mfma_f32_16x16x32_bf16 v[104:107], v[20:23], v[132:135], v[104:107]
    ds_read_b64_tr_b16 v[40:41], v10 offset:20480
    ds_read_b64_tr_b16 v[42:43], v10 offset:22528
    v_mfma_f32_16x16x32_bf16 v[120:123], v[20:23], v[136:139], v[120:123]
    ds_read_b64_tr_b16 v[44:45], v11 offset:20480
    ds_read_b64_tr_b16 v[46:47], v11 offset:22528
    v_mfma_f32_16x16x32_bf16 v[108:111], v[24:27], v[132:135], v[108:111]
    buffer_load_dwordx4 v[88:91], v98, s[16:19], s35 offen offset:0 sc1
    v_mfma_f32_16x16x32_bf16 v[124:127], v[24:27], v[136:139], v[124:127]
    v_mfma_f32_16x16x32_bf16 v[112:115], v[28:31], v[132:135], v[112:115]
    buffer_load_dwordx4 v[92:95], v97, s[16:19], s35 offen offset:0 sc1
    v_mfma_f32_16x16x32_bf16 v[128:131], v[28:31], v[136:139], v[128:131]
    s_waitcnt vmcnt(10) lgkmcnt(0)
    v_mfma_f32_16x16x32_bf16 v[100:103], v[32:35], v[48:51], v[100:103]
    ds_read_b64_tr_b16 v[16:17], v8 offset:40960
    ds_read_b64_tr_b16 v[18:19], v8 offset:43008
    v_mfma_f32_16x16x32_bf16 v[116:119], v[32:35], v[52:55], v[116:119]
    ds_read_b64_tr_b16 v[20:21], v9 offset:40960
    ds_read_b64_tr_b16 v[22:23], v9 offset:43008
    v_mfma_f32_16x16x32_bf16 v[104:107], v[36:39], v[48:51], v[104:107]
    ds_read_b64_tr_b16 v[24:25], v10 offset:40960
    ds_read_b64_tr_b16 v[26:27], v10 offset:43008
    v_mfma_f32_16x16x32_bf16 v[120:123], v[36:39], v[52:55], v[120:123]
    ds_read_b64_tr_b16 v[28:29], v11 offset:40960
    ds_read_b64_tr_b16 v[30:31], v11 offset:43008
    v_mfma_f32_16x16x32_bf16 v[108:111], v[40:43], v[48:51], v[108:111]
    buffer_load_dwordx4 v[132:135], v98, s[16:19], s35 offen offset:1024 sc1
    v_mfma_f32_16x16x32_bf16 v[124:127], v[40:43], v[52:55], v[124:127]
    v_mfma_f32_16x16x32_bf16 v[112:115], v[44:47], v[48:51], v[112:115]
    buffer_load_dwordx4 v[136:139], v97, s[16:19], s35 offen offset:1024 sc1
    v_mfma_f32_16x16x32_bf16 v[128:131], v[44:47], v[52:55], v[128:131]
    s_waitcnt vmcnt(10) lgkmcnt(0)
    v_mfma_f32_16x16x32_bf16 v[100:103], v[16:19], v[56:59], v[100:103]
    ds_read_b64_tr_b16 v[32:33], v8 offset:45056
    ds_read_b64_tr_b16 v[34:35], v8 offset:47104
    v_mfma_f32_16x16x32_bf16 v[116:119], v[16:19], v[60:63], v[116:119]
    ds_read_b64_tr_b16 v[36:37], v9 offset:45056
    ds_read_b64_tr_b16 v[38:39], v9 offset:47104
    v_mfma_f32_16x16x32_bf16 v[104:107], v[20:23], v[56:59], v[104:107]
    ds_read_b64_tr_b16 v[40:41], v10 offset:45056
    ds_read_b64_tr_b16 v[42:43], v10 offset:47104
    v_mfma_f32_16x16x32_bf16 v[120:123], v[20:23], v[60:63], v[120:123]
    ds_read_b64_tr_b16 v[44:45], v11 offset:45056
    ds_read_b64_tr_b16 v[46:47], v11 offset:47104
    v_mfma_f32_16x16x32_bf16 v[108:111], v[24:27], v[56:59], v[108:111]
    buffer_load_dwordx4 v[48:51], v98, s[16:19], s36 offen offset:0 sc1
    v_mfma_f32_16x16x32_bf16 v[124:127], v[24:27], v[60:63], v[124:127]
    v_mfma_f32_16x16x32_bf16 v[112:115], v[28:31], v[56:59], v[112:115]
    buffer_load_dwordx4 v[52:55], v97, s[16:19], s36 offen offset:0 sc1
    v_mfma_f32_16x16x32_bf16 v[128:131], v[28:31], v[60:63], v[128:131]
    s_waitcnt vmcnt(10) lgkmcnt(0)
    v_mfma_f32_16x16x32_bf16 v[100:103], v[32:35], v[64:67], v[100:103]
    ds_read_b64_tr_b16 v[16:17], v8 offset:32768
    ds_read_b64_tr_b16 v[18:19], v8 offset:34816
    v_mfma_f32_16x16x32_bf16 v[116:119], v[32:35], v[68:71], v[116:119]
    ds_read_b64_tr_b16 v[20:21], v9 offset:32768
    ds_read_b64_tr_b16 v[22:23], v9 offset:34816
    v_mfma_f32_16x16x32_bf16 v[104:107], v[36:39], v[64:67], v[104:107]
    ds_read_b64_tr_b16 v[24:25], v10 offset:32768
    ds_read_b64_tr_b16 v[26:27], v10 offset:34816
    v_mfma_f32_16x16x32_bf16 v[120:123], v[36:39], v[68:71], v[120:123]
    ds_read_b64_tr_b16 v[28:29], v11 offset:32768
    ds_read_b64_tr_b16 v[30:31], v11 offset:34816
    v_mfma_f32_16x16x32_bf16 v[108:111], v[40:43], v[64:67], v[108:111]
    buffer_load_dwordx4 v[56:59], v98, s[16:19], s36 offen offset:1024 sc1
    v_mfma_f32_16x16x32_bf16 v[124:127], v[40:43], v[68:71], v[124:127]
    v_mfma_f32_16x16x32_bf16 v[112:115], v[44:47], v[64:67], v[112:115]
    buffer_load_dwordx4 v[60:63], v97, s[16:19], s36 offen offset:1024 sc1
    v_mfma_f32_16x16x32_bf16 v[128:131], v[44:47], v[68:71], v[128:131]
    s_waitcnt vmcnt(10) lgkmcnt(0)
    v_mfma_f32_16x16x32_bf16 v[100:103], v[16:19], v[72:75], v[100:103]
    ds_read_b64_tr_b16 v[32:33], v8 offset:36864
    ds_read_b64_tr_b16 v[34:35], v8 offset:38912
    v_mfma_f32_16x16x32_bf16 v[116:119], v[16:19], v[76:79], v[116:119]
    ds_read_b64_tr_b16 v[36:37], v9 offset:36864
    ds_read_b64_tr_b16 v[38:39], v9 offset:38912
    v_mfma_f32_16x16x32_bf16 v[104:107], v[20:23], v[72:75], v[104:107]
    ds_read_b64_tr_b16 v[40:41], v10 offset:36864
    ds_read_b64_tr_b16 v[42:43], v10 offset:38912
    v_mfma_f32_16x16x32_bf16 v[120:123], v[20:23], v[76:79], v[120:123]
    ds_read_b64_tr_b16 v[44:45], v11 offset:36864
    ds_read_b64_tr_b16 v[46:47], v11 offset:38912
    v_mfma_f32_16x16x32_bf16 v[108:111], v[24:27], v[72:75], v[108:111]
    buffer_load_dwordx4 v[64:67], v98, s[16:19], s37 offen offset:0 sc1
    v_mfma_f32_16x16x32_bf16 v[124:127], v[24:27], v[76:79], v[124:127]
    v_mfma_f32_16x16x32_bf16 v[112:115], v[28:31], v[72:75], v[112:115]
    buffer_load_dwordx4 v[68:71], v97, s[16:19], s37 offen offset:0 sc1
    v_mfma_f32_16x16x32_bf16 v[128:131], v[28:31], v[76:79], v[128:131]
    s_waitcnt vmcnt(10) lgkmcnt(0)
    v_mfma_f32_16x16x32_bf16 v[100:103], v[32:35], v[80:83], v[100:103]
    ds_read_b64_tr_b16 v[16:17], v12 offset:0
    ds_read_b64_tr_b16 v[18:19], v12 offset:2048
    v_mfma_f32_16x16x32_bf16 v[116:119], v[32:35], v[84:87], v[116:119]
    ds_read_b64_tr_b16 v[20:21], v13 offset:0
    ds_read_b64_tr_b16 v[22:23], v13 offset:2048
    v_mfma_f32_16x16x32_bf16 v[104:107], v[36:39], v[80:83], v[104:107]
    ds_read_b64_tr_b16 v[24:25], v14 offset:0
    ds_read_b64_tr_b16 v[26:27], v14 offset:2048
    v_mfma_f32_16x16x32_bf16 v[120:123], v[36:39], v[84:87], v[120:123]
    ds_read_b64_tr_b16 v[28:29], v15 offset:0
    ds_read_b64_tr_b16 v[30:31], v15 offset:2048
    v_mfma_f32_16x16x32_bf16 v[108:111], v[40:43], v[80:83], v[108:111]
    buffer_load_dwordx4 v[72:75], v98, s[16:19], s37 offen offset:1024 sc1
    v_mfma_f32_16x16x32_bf16 v[124:127], v[40:43], v[84:87], v[124:127]
    v_mfma_f32_16x16x32_bf16 v[112:115], v[44:47], v[80:83], v[112:115]
    buffer_load_dwordx4 v[76:79], v97, s[16:19], s37 offen offset:1024 sc1
    v_mfma_f32_16x16x32_bf16 v[128:131], v[44:47], v[84:87], v[128:131]
    s_waitcnt vmcnt(10) lgkmcnt(0)
    v_mfma_f32_16x16x32_bf16 v[100:103], v[16:19], v[88:91], v[100:103]
    ds_read_b64_tr_b16 v[32:33], v12 offset:4096
    ds_read_b64_tr_b16 v[34:35], v12 offset:6144
    v_mfma_f32_16x16x32_bf16 v[116:119], v[16:19], v[92:95], v[116:119]
    ds_read_b64_tr_b16 v[36:37], v13 offset:4096
    ds_read_b64_tr_b16 v[38:39], v13 offset:6144
    v_mfma_f32_16x16x32_bf16 v[104:107], v[20:23], v[88:91], v[104:107]
    ds_read_b64_tr_b16 v[40:41], v14 offset:4096
    ds_read_b64_tr_b16 v[42:43], v14 offset:6144
    v_mfma_f32_16x16x32_bf16 v[120:123], v[20:23], v[92:95], v[120:123]
    ds_read_b64_tr_b16 v[44:45], v15 offset:4096
    ds_read_b64_tr_b16 v[46:47], v15 offset:6144
    v_mfma_f32_16x16x32_bf16 v[108:111], v[24:27], v[88:91], v[108:111]
    v_mfma_f32_16x16x32_bf16 v[124:127], v[24:27], v[92:95], v[124:127]
    v_mfma_f32_16x16x32_bf16 v[112:115], v[28:31], v[88:91], v[112:115]
    v_mfma_f32_16x16x32_bf16 v[128:131], v[28:31], v[92:95], v[128:131]
    s_waitcnt vmcnt(8) lgkmcnt(0)
    v_mfma_f32_16x16x32_bf16 v[100:103], v[32:35], v[132:135], v[100:103]
    ds_read_b64_tr_b16 v[16:17], v8 offset:49152
    ds_read_b64_tr_b16 v[18:19], v8 offset:51200
    v_mfma_f32_16x16x32_bf16 v[116:119], v[32:35], v[136:139], v[116:119]
    ds_read_b64_tr_b16 v[20:21], v9 offset:49152
    ds_read_b64_tr_b16 v[22:23], v9 offset:51200
    v_mfma_f32_16x16x32_bf16 v[104:107], v[36:39], v[132:135], v[104:107]
    ds_read_b64_tr_b16 v[24:25], v10 offset:49152
    ds_read_b64_tr_b16 v[26:27], v10 offset:51200
    v_mfma_f32_16x16x32_bf16 v[120:123], v[36:39], v[136:139], v[120:123]
    ds_read_b64_tr_b16 v[28:29], v11 offset:49152
    ds_read_b64_tr_b16 v[30:31], v11 offset:51200
    v_mfma_f32_16x16x32_bf16 v[108:111], v[40:43], v[132:135], v[108:111]
    v_mfma_f32_16x16x32_bf16 v[124:127], v[40:43], v[136:139], v[124:127]
    v_mfma_f32_16x16x32_bf16 v[112:115], v[44:47], v[132:135], v[112:115]
    v_mfma_f32_16x16x32_bf16 v[128:131], v[44:47], v[136:139], v[128:131]
    s_waitcnt vmcnt(6) lgkmcnt(0)
    v_mfma_f32_16x16x32_bf16 v[100:103], v[16:19], v[48:51], v[100:103]
    ds_read_b64_tr_b16 v[32:33], v8 offset:53248
    ds_read_b64_tr_b16 v[34:35], v8 offset:55296
    v_mfma_f32_16x16x32_bf16 v[116:119], v[16:19], v[52:55], v[116:119]
    ds_read_b64_tr_b16 v[36:37], v9 offset:53248
    ds_read_b64_tr_b16 v[38:39], v9 offset:55296
    v_mfma_f32_16x16x32_bf16 v[104:107], v[20:23], v[48:51], v[104:107]
    ds_read_b64_tr_b16 v[40:41], v10 offset:53248
    ds_read_b64_tr_b16 v[42:43], v10 offset:55296
    v_mfma_f32_16x16x32_bf16 v[120:123], v[20:23], v[52:55], v[120:123]
    ds_read_b64_tr_b16 v[44:45], v11 offset:53248
    ds_read_b64_tr_b16 v[46:47], v11 offset:55296
    v_mfma_f32_16x16x32_bf16 v[108:111], v[24:27], v[48:51], v[108:111]
    v_mfma_f32_16x16x32_bf16 v[124:127], v[24:27], v[52:55], v[124:127]
    v_mfma_f32_16x16x32_bf16 v[112:115], v[28:31], v[48:51], v[112:115]
    v_mfma_f32_16x16x32_bf16 v[128:131], v[28:31], v[52:55], v[128:131]
    s_waitcnt vmcnt(4) lgkmcnt(0)
    v_mfma_f32_16x16x32_bf16 v[100:103], v[32:35], v[56:59], v[100:103]
    ds_read_b64_tr_b16 v[16:17], v12 offset:8192
    ds_read_b64_tr_b16 v[18:19], v12 offset:10240
    v_mfma_f32_16x16x32_bf16 v[116:119], v[32:35], v[60:63], v[116:119]
    ds_read_b64_tr_b16 v[20:21], v13 offset:8192
    ds_read_b64_tr_b16 v[22:23], v13 offset:10240
    v_mfma_f32_16x16x32_bf16 v[104:107], v[36:39], v[56:59], v[104:107]
    ds_read_b64_tr_b16 v[24:25], v14 offset:8192
    ds_read_b64_tr_b16 v[26:27], v14 offset:10240
    v_mfma_f32_16x16x32_bf16 v[120:123], v[36:39], v[60:63], v[120:123]
    ds_read_b64_tr_b16 v[28:29], v15 offset:8192
    ds_read_b64_tr_b16 v[30:31], v15 offset:10240
    v_mfma_f32_16x16x32_bf16 v[108:111], v[40:43], v[56:59], v[108:111]
    v_mfma_f32_16x16x32_bf16 v[124:127], v[40:43], v[60:63], v[124:127]
    v_mfma_f32_16x16x32_bf16 v[112:115], v[44:47], v[56:59], v[112:115]
    v_mfma_f32_16x16x32_bf16 v[128:131], v[44:47], v[60:63], v[128:131]
    s_waitcnt vmcnt(2) lgkmcnt(0)
    v_mfma_f32_16x16x32_bf16 v[100:103], v[16:19], v[64:67], v[100:103]
    ds_read_b64_tr_b16 v[32:33], v12 offset:12288
    ds_read_b64_tr_b16 v[34:35], v12 offset:14336
    v_mfma_f32_16x16x32_bf16 v[116:119], v[16:19], v[68:71], v[116:119]
    ds_read_b64_tr_b16 v[36:37], v13 offset:12288
    ds_read_b64_tr_b16 v[38:39], v13 offset:14336
    v_mfma_f32_16x16x32_bf16 v[104:107], v[20:23], v[64:67], v[104:107]
    ds_read_b64_tr_b16 v[40:41], v14 offset:12288
    ds_read_b64_tr_b16 v[42:43], v14 offset:14336
    v_mfma_f32_16x16x32_bf16 v[120:123], v[20:23], v[68:71], v[120:123]
    ds_read_b64_tr_b16 v[44:45], v15 offset:12288
    ds_read_b64_tr_b16 v[46:47], v15 offset:14336
    v_mfma_f32_16x16x32_bf16 v[108:111], v[24:27], v[64:67], v[108:111]
    v_mfma_f32_16x16x32_bf16 v[124:127], v[24:27], v[68:71], v[124:127]
    v_mfma_f32_16x16x32_bf16 v[112:115], v[28:31], v[64:67], v[112:115]
    v_mfma_f32_16x16x32_bf16 v[128:131], v[28:31], v[68:71], v[128:131]
    s_waitcnt vmcnt(0) lgkmcnt(0)
    v_mfma_f32_16x16x32_bf16 v[100:103], v[32:35], v[72:75], v[100:103]
    v_mfma_f32_16x16x32_bf16 v[116:119], v[32:35], v[76:79], v[116:119]
    v_mfma_f32_16x16x32_bf16 v[104:107], v[36:39], v[72:75], v[104:107]
    v_mfma_f32_16x16x32_bf16 v[120:123], v[36:39], v[76:79], v[120:123]
    v_mfma_f32_16x16x32_bf16 v[108:111], v[40:43], v[72:75], v[108:111]
    v_mfma_f32_16x16x32_bf16 v[124:127], v[40:43], v[76:79], v[124:127]
    v_mfma_f32_16x16x32_bf16 v[112:115], v[44:47], v[72:75], v[112:115]
    v_mfma_f32_16x16x32_bf16 v[128:131], v[44:47], v[76:79], v[128:131]
    s_nop 2
    v_permlane16_swap_b32 v100, v104
    v_permlane16_swap_b32 v101, v105
    v_permlane16_swap_b32 v102, v106
    v_permlane16_swap_b32 v103, v107
    v_permlane16_swap_b32 v108, v112
    v_permlane16_swap_b32 v109, v113
    v_permlane16_swap_b32 v110, v114
    v_permlane16_swap_b32 v111, v115
    v_permlane16_swap_b32 v116, v120
    v_permlane16_swap_b32 v117, v121
    v_permlane16_swap_b32 v118, v122
    v_permlane16_swap_b32 v119, v123
    v_permlane16_swap_b32 v124, v128
    v_permlane16_swap_b32 v125, v129
    v_permlane16_swap_b32 v126, v130
    v_permlane16_swap_b32 v127, v131
    s_cmp_eq_u64 s[60:61], 0
    s_cbranch_scc1 F_fin
    s_mov_b32 s48, 0xbfb8aa3b
    v_and_b32 v7, 0x3f, v2
    v_lshlrev_b32 v7, 1, v7
    v_add_u32 v7, 159744, v7
    v_mov_b32 v6, 159136

    ds_read_b32 v5, v6 offset:0
FW_79:
    s_waitcnt lgkmcnt(0)
    v_cmp_gt_u32 vcc, 1, v5
    s_cbranch_vccz FO_80
    ds_read_b32 v5, v6 offset:0
    s_branch FW_79
FO_80:
    v_bfe_u32 v4, v164, 11, 3
    v_lshl_add_u32 v4, v4, 8, v7
    v_cmp_ne_u32 vcc, 0, v164
    s_nop 0
    s_and_saveexec_b64 s[50:51], vcc
    s_cbranch_execz F_rb_81
    ds_read_b128 v[16:19], v4 offset:0
    ds_read_b128 v[20:23], v4 offset:16
    ds_read_b128 v[24:27], v4 offset:128
    ds_read_b128 v[28:31], v4 offset:144
    v_and_b32 v5, 0xffff0000, v164
    v_ashrrev_i32 v6, 31, v5
    v_not_b32 v6, v6
    v_or_b32 v6, 0x80000000, v6
    v_xor_b32 v5, v5, v6
    v_and_b32 v5, 0xffff0000, v5
    v_mul_f32 v5, s48, v5
    v_exp_f32 v5, v5
    s_nop 0
    v_add_f32 v5, 1.0, v5
    v_rcp_f32 v5, v5
    s_nop 0
    v_cvt_pk_bf16_f32 v5, v5, v5
    v_lshlrev_b32 v5, 16, v5
    s_waitcnt lgkmcnt(0)
    v_fmac_f32 v100, v16, v5
    v_fmac_f32 v101, v17, v5
    v_fmac_f32 v102, v18, v5
    v_fmac_f32 v103, v19, v5
    v_fmac_f32 v104, v20, v5
    v_fmac_f32 v105, v21, v5
    v_fmac_f32 v106, v22, v5
    v_fmac_f32 v107, v23, v5
    v_fmac_f32 v108, v24, v5
    v_fmac_f32 v109, v25, v5
    v_fmac_f32 v110, v26, v5
    v_fmac_f32 v111, v27, v5
    v_fmac_f32 v112, v28, v5
    v_fmac_f32 v113, v29, v5
    v_fmac_f32 v114, v30, v5
    v_fmac_f32 v115, v31, v5
F_rb_81:
    s_mov_b64 exec, s[50:51]
    v_bfe_u32 v4, v165, 11, 3
    v_lshl_add_u32 v4, v4, 8, v7
    v_cmp_ne_u32 vcc, 0, v165
    s_nop 0
    s_and_saveexec_b64 s[50:51], vcc
    s_cbranch_execz F_rb_82
    ds_read_b128 v[16:19], v4 offset:0
    ds_read_b128 v[20:23], v4 offset:16
    ds_read_b128 v[24:27], v4 offset:128
    ds_read_b128 v[28:31], v4 offset:144
    v_and_b32 v5, 0xffff0000, v165
    v_ashrrev_i32 v6, 31, v5
    v_not_b32 v6, v6
    v_or_b32 v6, 0x80000000, v6
    v_xor_b32 v5, v5, v6
    v_and_b32 v5, 0xffff0000, v5
    v_mul_f32 v5, s48, v5
    v_exp_f32 v5, v5
    s_nop 0
    v_add_f32 v5, 1.0, v5
    v_rcp_f32 v5, v5
    s_nop 0
    v_cvt_pk_bf16_f32 v5, v5, v5
    v_lshlrev_b32 v5, 16, v5
    s_waitcnt lgkmcnt(0)
    v_fmac_f32 v116, v16, v5
    v_fmac_f32 v117, v17, v5
    v_fmac_f32 v118, v18, v5
    v_fmac_f32 v119, v19, v5
    v_fmac_f32 v120, v20, v5
    v_fmac_f32 v121, v21, v5
    v_fmac_f32 v122, v22, v5
    v_fmac_f32 v123, v23, v5
    v_fmac_f32 v124, v24, v5
    v_fmac_f32 v125, v25, v5
    v_fmac_f32 v126, v26, v5
    v_fmac_f32 v127, v27, v5
    v_fmac_f32 v128, v28, v5
    v_fmac_f32 v129, v29, v5
    v_fmac_f32 v130, v30, v5
    v_fmac_f32 v131, v31, v5
F_rb_82:
    s_mov_b64 exec, s[50:51]
F_fin:
    v_cvt_pk_bf16_f32 v48, v100, v101
    v_cvt_pk_bf16_f32 v49, v102, v103
    v_cvt_pk_bf16_f32 v50, v104, v105
    v_cvt_pk_bf16_f32 v51, v106, v107
    v_cvt_pk_bf16_f32 v52, v108, v109
    v_cvt_pk_bf16_f32 v53, v110, v111
    v_cvt_pk_bf16_f32 v54, v112, v113
    v_cvt_pk_bf16_f32 v55, v114, v115
    v_mov_b32 v64, v48
    v_mov_b32 v65, v49
    v_mov_b32 v66, v50
    v_mov_b32 v67, v51
    v_mov_b32_dpp v48, v52 row_ror:8 row_mask:0xf bank_mask:0xc
    v_mov_b32_dpp v49, v53 row_ror:8 row_mask:0xf bank_mask:0xc
    v_mov_b32_dpp v50, v54 row_ror:8 row_mask:0xf bank_mask:0xc
    v_mov_b32_dpp v51, v55 row_ror:8 row_mask:0xf bank_mask:0xc
    v_mov_b32_dpp v52, v64 row_ror:8 row_mask:0xf bank_mask:0x3
    v_mov_b32_dpp v53, v65 row_ror:8 row_mask:0xf bank_mask:0x3
    v_mov_b32_dpp v54, v66 row_ror:8 row_mask:0xf bank_mask:0x3
    v_mov_b32_dpp v55, v67 row_ror:8 row_mask:0xf bank_mask:0x3
    s_add_u32 s44, s42, 0x4000
    buffer_store_dwordx4 v[48:51], v1, s[12:15], s42 offen sc1
    buffer_store_dwordx4 v[52:55], v1, s[12:15], s44 offen sc1
    v_cvt_pk_bf16_f32 v56, v116, v117
    v_cvt_pk_bf16_f32 v57, v118, v119
    v_cvt_pk_bf16_f32 v58, v120, v121
    v_cvt_pk_bf16_f32 v59, v122, v123
    v_cvt_pk_bf16_f32 v60, v124, v125
    v_cvt_pk_bf16_f32 v61, v126, v127
    v_cvt_pk_bf16_f32 v62, v128, v129
    v_cvt_pk_bf16_f32 v63, v130, v131
    v_mov_b32 v64, v56
    v_mov_b32 v65, v57
    v_mov_b32 v66, v58
    v_mov_b32 v67, v59
    v_mov_b32_dpp v56, v60 row_ror:8 row_mask:0xf bank_mask:0xc
    v_mov_b32_dpp v57, v61 row_ror:8 row_mask:0xf bank_mask:0xc
    v_mov_b32_dpp v58, v62 row_ror:8 row_mask:0xf bank_mask:0xc
    v_mov_b32_dpp v59, v63 row_ror:8 row_mask:0xf bank_mask:0xc
    v_mov_b32_dpp v60, v64 row_ror:8 row_mask:0xf bank_mask:0x3
    v_mov_b32_dpp v61, v65 row_ror:8 row_mask:0xf bank_mask:0x3
    v_mov_b32_dpp v62, v66 row_ror:8 row_mask:0xf bank_mask:0x3
    v_mov_b32_dpp v63, v67 row_ror:8 row_mask:0xf bank_mask:0x3
    s_add_u32 s44, s43, 0x4000
    buffer_store_dwordx4 v[56:59], v1, s[12:15], s43 offen sc1
    buffer_store_dwordx4 v[60:63], v1, s[12:15], s44 offen sc1
    s_endpgm
F_aux:
    s_setprio 3
    s_sub_u32 s3, s3, 8
    s_mov_b32 s88, s3
    v_lshrrev_b32 v5, 4, v0
    s_cmp_eq_u32 s3, 1
    s_mov_b32 s45, 73728
    s_cselect_b32 s45, 65536, s45
    s_cmp_eq_u32 s3, 2
    s_cselect_b32 s45, 147456, s45
    v_bfe_u32 v60, v0, 2, 2
    v_lshl_add_u32 v62, v5, 3, v60
    v_lshrrev_b32 v60, 1, v60
    v_and_b32 v63, 1, v5
    v_lshl_add_u32 v60, v63, 1, v60
    v_lshlrev_b32 v60, 5, v60
    v_lshl_add_u32 v60, v62, 7, v60
    v_and_b32 v63, 3, v0
    v_lshl_add_u32 v60, v63, 3, v60
    v_add_u32 v62, s45, v60
    v_xor_b32 v63, 32, v62
    v_xor_b32 v64, 64, v62
    v_xor_b32 v65, 96, v62
    v_lshlrev_b32 v2, 4, v0
    v_lshlrev_b32 v3, 2, v0
    v_and_b32 v7, 15, v0
    v_and_b32 v8, 7, v0
    v_lshlrev_b32 v8, 4, v8
    v_lshl_add_u32 v8, v5, 7, v8
    v_bfe_u32 v9, v0, 3, 1
    v_lshl_add_u32 v4, v9, 11, v8
    v_and_b32 v9, 1, v0
    v_lshlrev_b32 v59, 2, v7
    s_lshl_b32 s76, s32, 4
    s_add_u32 s76, s76, s33
    s_lshl_b32 s77, s76, 3
    s_lshl_b32 s44, s3, 1
    s_add_u32 s77, s77, s44
    v_mov_b32 v12, 0
    v_mov_b32 v13, 0
    v_mov_b32 v14, 0
    v_mov_b32 v15, 0
    s_lshl_b32 s75, s3, 4
    s_add_u32 s75, s75, s33
    s_lshl_b32 s44, s3, 2
    s_add_u32 s44, s44, 159040
    v_mov_b32 v10, s44

    v_mov_b32 v32, 0x3f803f80
    v_mov_b32 v33, 0x3f803f80
    v_mov_b32 v34, 0x3f803f80
    v_mov_b32 v35, 0x3f803f80
    v_mov_b32 v36, 0x3f803f80
    v_mov_b32 v37, 0x3f803f80
    v_mov_b32 v38, 0x3f803f80
    v_mov_b32 v39, 0x3f803f80
    v_mov_b32 v40, 0x3f803f80
    v_mov_b32 v41, 0x3f803f80
    v_mov_b32 v42, 0x3f803f80
    v_mov_b32 v43, 0x3f803f80
    v_mov_b32 v44, 0x3f803f80
    v_mov_b32 v45, 0x3f803f80
    v_mov_b32 v46, 0x3f803f80
    v_mov_b32 v47, 0x3f803f80
    s_waitcnt lgkmcnt(0)
    s_mov_b32 s20, s4
    s_mov_b32 s21, s5
    s_mov_b32 s22, 0x400000
    s_mov_b32 s23, 0x00020000
    s_mov_b32 s19, 0x20000
    s_add_u32 s40, s72, 0x850000
    s_addc_u32 s41, s73, 0
    s_mov_b32 s42, 0xd000
    s_mov_b32 s43, 0x00020000
    s_cmp_lg_u32 s3, 0
    s_cbranch_scc1 F_z0
    s_getpc_b64 s[46:47]
F_pc:
    s_sub_u32 s46, s46, F_pc-parallel_sum__linear_attn_block__moe_arch_mod__prompt_kernel
    s_subb_u32 s47, s47, 0
    s_and_b32 s44, s31, 7
    s_lshl_b32 s44, s44, 13
    v_lshlrev_b32 v67, 7, v0
    v_add_u32 v67, s44, v67
    v_min_u32 v67, F_codeend-parallel_sum__linear_attn_block__moe_arch_mod__prompt_kernel-4, v67
    global_load_dword v61, v67, s[46:47]
    s_cmp_lg_u32 s75, 0
    s_cbranch_scc1 F_z0
    s_lshl_b32 s44, s32, 9
    s_add_u32 s44, s44, 32768
    s_mov_b32 exec_hi, 0
    buffer_store_dwordx4 v[12:15], v2, s[40:43], s44 offen sc0 sc1
    s_mul_i32 s44, s32, 768
    s_add_u32 s44, s44, 40960
    s_mov_b32 exec_hi, 0xffff
    buffer_store_dwordx4 v[12:15], v2, s[40:43], s44 offen sc0 sc1
    s_mov_b64 exec, -1
F_z0:

    s_barrier
    s_bitcmp0_b32 s3, 0
    s_cbranch_scc1 F_cs1
    ds_read_b64_tr_b16 v[72:73], v62 offset:0
    ds_read_b64_tr_b16 v[74:75], v62 offset:512
    ds_read_b64_tr_b16 v[76:77], v62 offset:4096
    ds_read_b64_tr_b16 v[78:79], v62 offset:4608
    ds_read_b64_tr_b16 v[80:81], v63 offset:0
    ds_read_b64_tr_b16 v[82:83], v63 offset:512
    ds_read_b64_tr_b16 v[84:85], v63 offset:4096
    ds_read_b64_tr_b16 v[86:87], v63 offset:4608
    s_waitcnt lgkmcnt(4)
    ds_read_b64_tr_b16 v[88:89], v64 offset:0
    ds_read_b64_tr_b16 v[90:91], v64 offset:512
    ds_read_b64_tr_b16 v[92:93], v64 offset:4096
    ds_read_b64_tr_b16 v[94:95], v64 offset:4608
    ds_read_b64_tr_b16 v[96:97], v65 offset:0
    ds_read_b64_tr_b16 v[98:99], v65 offset:512
    ds_read_b64_tr_b16 v[100:101], v65 offset:4096
    ds_read_b64_tr_b16 v[102:103], v65 offset:4608
    s_branch F_cs2
F_cs1:
    v_add_u32 v60, 159040, v3
    s_mov_b32 exec_hi, 0xffff
    ds_write_b32 v60, v12
    s_mov_b64 exec, -1
F_cs2:
    s_add_u32 s24, s72, 0x800000
    s_addc_u32 s25, s73, 0
    s_mov_b32 s26, 0x48000
    s_mov_b32 s27, 0x00020000
    s_mov_b32 s48, s70
    s_mov_b32 s49, s71
    s_mov_b32 s50, 0x100
    s_mov_b32 s51, 0x00020000
    s_lshl_b32 s47, s32, 9
    s_add_u32 s56, s47, 0x858000
    s_add_u32 s56, s72, s56
    s_addc_u32 s57, s73, 0
    s_lshl_b32 s47, s33, 9
    s_add_u32 s58, s47, 0x858100
    s_add_u32 s58, s72, s58
    s_addc_u32 s59, s73, 0
    v_mov_b32 v68, 0x3f803f80
    v_mov_b32 v69, 0x3f803f80
    v_mov_b32 v70, 0x3f803f80
    v_mov_b32 v71, 0x3f803f80
    s_waitcnt lgkmcnt(0)
    s_cmp_lg_u32 s75, 0
    s_cbranch_scc1 F_z4
    s_lshl_b32 s45, s32, 2
    s_add_u32 s44, s70, s45
    s_addc_u32 s45, s71, 0
    s_mov_b32 s46, 1
    s_waitcnt vmcnt(0)
    s_atomic_add s46, s[44:45], 0
F_z4:

    s_bitcmp0_b32 s3, 0
    s_cbranch_scc1 F_c2a
    v_mfma_f32_16x16x32_bf16 v[104:107], v[68:71], v[72:75], 0
    v_mfma_f32_16x16x32_bf16 v[108:111], v[68:71], v[80:83], 0
    v_mfma_f32_16x16x32_bf16 v[112:115], v[68:71], v[88:91], 0
    v_mfma_f32_16x16x32_bf16 v[116:119], v[68:71], v[96:99], 0
    v_mfma_f32_16x16x32_bf16 v[104:107], v[68:71], v[76:79], v[104:107]
    v_mfma_f32_16x16x32_bf16 v[108:111], v[68:71], v[84:87], v[108:111]
    v_mfma_f32_16x16x32_bf16 v[112:115], v[68:71], v[92:95], v[112:115]
    v_mfma_f32_16x16x32_bf16 v[116:119], v[68:71], v[100:103], v[116:119]
    v_cmp_eq_u32 vcc, 1, v5
    s_nop 4
    v_cndmask_b32 v66, v104, v108, vcc
    v_cmp_eq_u32 vcc, 2, v5
    s_nop 1
    v_cndmask_b32 v66, v66, v112, vcc
    v_cmp_eq_u32 vcc, 3, v5
    s_nop 1
    v_cndmask_b32 v66, v66, v116, vcc

F_c2a:
    s_barrier
    s_cmp_lg_u32 s3, 2
    s_cbranch_scc1 F_cs3
    ds_read_b64_tr_b16 v[72:73], v62 offset:0
    ds_read_b64_tr_b16 v[74:75], v62 offset:512
    ds_read_b64_tr_b16 v[76:77], v62 offset:4096
    ds_read_b64_tr_b16 v[78:79], v62 offset:4608
    ds_read_b64_tr_b16 v[80:81], v63 offset:0
    ds_read_b64_tr_b16 v[82:83], v63 offset:512
    ds_read_b64_tr_b16 v[84:85], v63 offset:4096
    ds_read_b64_tr_b16 v[86:87], v63 offset:4608
    s_waitcnt lgkmcnt(4)
    ds_read_b64_tr_b16 v[88:89], v64 offset:0
    ds_read_b64_tr_b16 v[90:91], v64 offset:512
    ds_read_b64_tr_b16 v[92:93], v64 offset:4096
    ds_read_b64_tr_b16 v[94:95], v64 offset:4608
    ds_read_b64_tr_b16 v[96:97], v65 offset:0
    ds_read_b64_tr_b16 v[98:99], v65 offset:512
    ds_read_b64_tr_b16 v[100:101], v65 offset:4096
    ds_read_b64_tr_b16 v[102:103], v65 offset:4608
    s_waitcnt lgkmcnt(0)
F_cs3:
    s_cmp_lg_u32 s3, 0
    s_cbranch_scc1 EV_84
    s_branch IW_w8
IW_r8:
EV_84:
    s_cmp_lg_u32 s3, 1
    s_cbranch_scc1 EV_85
    s_branch IW_w0
IW_r0:
EV_85:
    s_cmp_lg_u32 s3, 2
    s_cbranch_scc1 EV_86
    s_branch IW_w1
IW_r1:
EV_86:
    s_cmp_lg_u32 s3, 3
    s_cbranch_scc1 EV_87
    s_branch IW_w3
IW_r3:
EV_87:
    s_barrier
    s_cmp_lt_u32 s3, 2
    s_mov_b32 s44, 98304
    s_cselect_b32 s44, 98304, s44
    s_lshl_b32 s45, s3, 12
    s_add_u32 s44, s44, s45
    v_add_u32 v4, s44, v4
    v_add_u32 v8, 161792, v8
    ds_read_b128 v[16:19], v4 offset:0
    ds_read_b128 v[20:23], v4 offset:512
    ds_read_b128 v[24:27], v4 offset:1024
    ds_read_b128 v[28:31], v4 offset:1536
    s_mov_b32 exec_lo, 0x00ff00ff
    s_mov_b32 exec_hi, 0x00ff00ff
    ds_read_b128 v[32:35], v8 offset:0
    ds_read_b128 v[36:39], v8 offset:512
    ds_read_b128 v[40:43], v8 offset:1024
    s_branch IW_s8
IW_w8:
    s_branch IW_r8
IW_s8:
    ds_read_b128 v[44:47], v8 offset:1536
    s_mov_b64 exec, -1
    s_waitcnt lgkmcnt(0)
    v_mfma_f32_16x16x32_bf16 v[120:123], v[16:19], v[16:19], 0
    v_mfma_f32_16x16x32_bf16 v[124:127], v[16:19], v[32:35], 0
    v_mfma_f32_16x16x32_bf16 v[128:131], v[32:35], v[32:35], 0
    v_mfma_f32_16x16x32_bf16 v[120:123], v[20:23], v[20:23], v[120:123]
    v_mfma_f32_16x16x32_bf16 v[124:127], v[20:23], v[36:39], v[124:127]
    v_mfma_f32_16x16x32_bf16 v[128:131], v[36:39], v[36:39], v[128:131]
    v_mfma_f32_16x16x32_bf16 v[120:123], v[24:27], v[24:27], v[120:123]
    v_mfma_f32_16x16x32_bf16 v[124:127], v[24:27], v[40:43], v[124:127]
    v_mfma_f32_16x16x32_bf16 v[128:131], v[40:43], v[40:43], v[128:131]
    v_mfma_f32_16x16x32_bf16 v[120:123], v[28:31], v[28:31], v[120:123]
    v_mfma_f32_16x16x32_bf16 v[124:127], v[28:31], v[44:47], v[124:127]
    v_mfma_f32_16x16x32_bf16 v[128:131], v[44:47], v[44:47], v[128:131]
    s_cmp_lg_u32 s3, 2
    s_cbranch_scc1 F_c2b
    v_mfma_f32_16x16x32_bf16 v[104:107], v[68:71], v[72:75], 0
    v_mfma_f32_16x16x32_bf16 v[108:111], v[68:71], v[80:83], 0
    v_mfma_f32_16x16x32_bf16 v[112:115], v[68:71], v[88:91], 0
    v_mfma_f32_16x16x32_bf16 v[116:119], v[68:71], v[96:99], 0
    v_mfma_f32_16x16x32_bf16 v[104:107], v[68:71], v[76:79], v[104:107]
    v_mfma_f32_16x16x32_bf16 v[108:111], v[68:71], v[84:87], v[108:111]
    v_mfma_f32_16x16x32_bf16 v[112:115], v[68:71], v[92:95], v[112:115]
    v_mfma_f32_16x16x32_bf16 v[116:119], v[68:71], v[100:103], v[116:119]
    v_cmp_eq_u32 vcc, 1, v5
    s_nop 4
    v_cndmask_b32 v66, v104, v108, vcc
    v_cmp_eq_u32 vcc, 2, v5
    s_nop 1
    v_cndmask_b32 v66, v66, v112, vcc
    v_cmp_eq_u32 vcc, 3, v5
    s_nop 1
    v_cndmask_b32 v66, v66, v116, vcc

F_c2b:
    s_cmp_lg_u32 s3, 0
    s_cbranch_scc1 F_r1
    buffer_load_dword v11, v59, s[48:51], 0 offen sc0 sc1
F_r1:
    s_cmp_lg_u32 s3, 0
    s_cbranch_scc1 EV_89
    s_branch IW_w4
IW_r4:
EV_89:
    s_cmp_lg_u32 s3, 1
    s_cbranch_scc1 EV_90
    s_branch IW_w9
IW_r9:
EV_90:
    s_cmp_lg_u32 s3, 2
    s_cbranch_scc1 EV_91
    s_branch IW_w10
IW_r10:
EV_91:
    s_cmp_lg_u32 s3, 3
    s_cbranch_scc1 EV_92
    s_nop 0
EV_92:
    s_barrier
    v_and_b32 v52, 3, v0
    v_cmp_eq_u32 vcc, 1, v52
    s_nop 1
    v_cndmask_b32 v120, v120, v121, vcc
    v_cndmask_b32 v124, v124, v125, vcc
    v_cndmask_b32 v128, v128, v129, vcc
    v_cmp_eq_u32 vcc, 2, v52
    s_nop 1
    v_cndmask_b32 v120, v120, v122, vcc
    v_cndmask_b32 v124, v124, v126, vcc
    v_cndmask_b32 v128, v128, v130, vcc
    v_cmp_eq_u32 vcc, 3, v52
    s_nop 1
    v_cndmask_b32 v120, v120, v123, vcc
    v_cndmask_b32 v124, v124, v127, vcc
    v_cndmask_b32 v128, v128, v131, vcc
    v_add_f32_dpp v120, v120, v120 quad_perm:[1,0,3,2] row_mask:0xf bank_mask:0xf
    v_add_f32_dpp v124, v124, v124 quad_perm:[1,0,3,2] row_mask:0xf bank_mask:0xf
    v_add_f32_dpp v128, v128, v128 quad_perm:[1,0,3,2] row_mask:0xf bank_mask:0xf
    v_add_f32_dpp v120, v120, v120 quad_perm:[2,3,0,1] row_mask:0xf bank_mask:0xf
    v_add_f32_dpp v124, v124, v124 quad_perm:[2,3,0,1] row_mask:0xf bank_mask:0xf
    v_add_f32_dpp v128, v128, v128 quad_perm:[2,3,0,1] row_mask:0xf bank_mask:0xf
    v_readlane_b32 s44, v124, 8
    v_readlane_b32 s45, v124, 24
    v_readlane_b32 s46, v124, 40
    v_readlane_b32 s47, v124, 56
    v_mov_b32 v48, s44
    v_mov_b32 v52, s45
    s_nop 0
    v_writelane_b32 v48, s46, 1
    v_writelane_b32 v52, s47, 1
    v_readlane_b32 s44, v120, 0
    v_readlane_b32 s45, v120, 20
    v_readlane_b32 s46, v120, 40
    v_readlane_b32 s47, v120, 60
    v_mov_b32 v49, s44
    v_mov_b32 v53, s45
    s_nop 0
    v_writelane_b32 v49, s46, 1
    v_writelane_b32 v53, s47, 1
    v_readlane_b32 s44, v124, 0
    v_readlane_b32 s45, v124, 20
    v_readlane_b32 s46, v124, 32
    v_readlane_b32 s47, v124, 52
    v_mov_b32 v50, s44
    v_mov_b32 v54, s45
    s_nop 0
    v_writelane_b32 v50, s46, 1
    v_writelane_b32 v54, s47, 1
    v_readlane_b32 s44, v128, 8
    v_readlane_b32 s45, v128, 24
    v_readlane_b32 s46, v128, 8
    v_readlane_b32 s47, v128, 24
    v_mov_b32 v51, s44
    v_mov_b32 v55, s45
    s_nop 0
    v_writelane_b32 v51, s46, 1
    v_writelane_b32 v55, s47, 1
    v_add_f32 v48, v48, v52
    v_add_f32 v49, v49, v53
    v_add_f32 v50, v50, v54
    v_add_f32 v51, v51, v55
    v_mul_f32 v48, 0x3a800000, v48
    v_mul_f32 v49, 0x3a800000, v49
    v_fma_f32 v49, -v48, v48, v49
    v_max_f32 v49, 0, v49
    v_cvt_pk_bf16_f32 v52, v48, v49
    v_lshlrev_b32 v48, 16, v52
    v_and_b32 v49, 0xffff0000, v52
    v_add_f32 v49, 0x3727c5ac, v49
    v_cvt_pk_bf16_f32 v49, v49, v49
    v_lshlrev_b32 v49, 16, v49
    v_sqrt_f32 v49, v49
    s_nop 0
    v_cvt_pk_bf16_f32 v49, v49, v49
    v_lshlrev_b32 v49, 16, v49
    v_rcp_f32 v49, v49
    v_xor_b32 v48, 0x80000000, v48
    v_fma_f32 v50, v48, v51, v50
    v_mul_f32 v50, v50, v49
    v_cvt_pk_bf16_f32 v50, v50, v50
    v_and_b32 v50, 0xffff0000, v50
    v_ashrrev_i32 v51, 31, v50
    v_or_b32 v51, 0x80000000, v51
    v_xor_b32 v50, v50, v51
    v_and_b32 v50, 0xffff0000, v50
    s_sub_u32 s44, 2047, s77
    v_sub_u32 v51, s44, v9
    v_or_b32 v50, v50, v51
    s_lshl_b32 s44, s3, 1
    v_add_u32 v52, s44, v9
    v_lshlrev_b32 v53, 3, v52
    v_lshlrev_b32 v52, 2, v52
    v_add_u32 v53, 159744, v53
    v_add_u32 v52, 159808, v52
    s_mov_b64 exec, 3
    ds_write_b64 v53, v[48:49]
    ds_write_b32 v52, v50
    s_mov_b64 exec, -1
    s_waitcnt lgkmcnt(0)

    s_cmp_lg_u32 s3, 0
    s_cbranch_scc1 F_a0r
F_a0p:
    s_waitcnt vmcnt(0)
    v_cmp_eq_u32 vcc, 0, v11
    s_cbranch_vccz F_a0r
    s_sleep 4
    buffer_load_dword v11, v59, s[48:51], 0 offen sc0 sc1
    s_branch F_a0p
F_a0r:
    s_barrier
    s_cmp_eq_u32 s3, 0
    s_cbranch_scc1 F_ax0
    s_mul_i32 s44, s33, 768
    s_add_u32 s44, s44, 40960
    s_add_u32 s45, s3, 1
    s_lshr_b32 s45, s45, 1
    s_cmp_eq_u32 s3, 2
    s_cselect_b32 s45, 0, s45
    s_lshl_b32 s45, s45, 8
    s_add_u32 s44, s44, s45
    buffer_atomic_add_f32 v66, v3, s[40:43], s44 offen
    s_mul_i32 s44, s2, 1152
    s_mul_i32 s45, s3, 384
    s_add_u32 s44, s44, s45
    s_sub_u32 s44, s44, 384
    s_mov_b64 exec, 0xffffff
    buffer_store_dwordx4 v[12:15], v2, s[24:27], s44 offen sc0 sc1
    s_mov_b64 exec, -1
    s_branch F_s1
F_ax0:
    v_add_u32 v60, 159744, v3
    ds_read_b32 v60, v60
    s_lshl_b32 s44, s76, 7
    s_mov_b32 exec_hi, 0
    s_waitcnt lgkmcnt(0)
    buffer_store_dword v60, v3, s[40:43], s44 offen sc0 sc1
    s_mov_b64 exec, -1
F_s1:

    s_barrier
    v_mov_b32 v4, 159144
    v_mov_b32 v8, 1
    s_lshr_b32 s47, s32, 2
    s_lshl_b32 s47, s47, 11
    s_add_u32 s54, s47, 0x858180
    s_add_u32 s54, s72, s54
    s_addc_u32 s55, s73, 0
    s_waitcnt vmcnt(0)
    s_mov_b64 exec, 1
    ds_add_rtn_u32 v9, v4, v8
    s_waitcnt lgkmcnt(0)
    v_readfirstlane_b32 s44, v9
    s_mov_b64 exec, -1
    s_cmp_lg_u32 s44, 3
    s_cbranch_scc1 F_a0s
    s_mov_b32 s74, 1
    s_atomic_add s74, s[54:55], 0
    s_atomic_add s74, s[56:57], 0
    s_atomic_add s74, s[58:59], 0
F_a0s:

    s_barrier
    s_and_b32 s89, s2, 0xdd
    s_bfe_u32 s44, s2, 0x10005
    s_lshl_b32 s44, s44, 1
    s_or_b32 s89, s89, s44
    s_bfe_u32 s44, s2, 0x10001
    s_xor_b32 s44, s44, 1
    s_lshl_b32 s44, s44, 5
    s_or_b32 s89, s89, s44
    s_xor_b32 s89, s89, 0

    s_and_b32 s36, s89, 3
    s_bfe_u32 s37, s89, 0x10002
    s_lshr_b32 s38, s89, 3
    s_cmp_eq_u32 s37, 0
    s_cselect_b32 s16, s62, s64
    s_cselect_b32 s17, s63, s65
    s_cmp_lt_u32 s89, 224
    s_cselect_b32 s18, 7340032, 0
    v_mul_u32_u24 v6, 57344, v5
    v_lshl_add_u32 v6, v7, 4, v6
    s_lshl_b32 s44, s36, 2
    s_add_u32 s44, s44, s3
    s_waitcnt lgkmcnt(0)
    s_mul_i32 s54, s44, 458752
    s_lshl_b32 s45, s38, 8
    s_add_u32 s54, s54, s45
    s_lshl_b32 s55, s44, 7

    s_add_u32 s39, s35, 2
    s_and_b32 s39, s39, 7
    s_lshl_b32 s10, s34, 3
    s_add_u32 s10, s10, s30

    s_mul_i32 s10, s10, 112
    s_mul_i32 s79, s3, 28
    s_add_u32 s10, s10, s79
    s_lshl_b32 s78, s10, 11
    s_lshl_b32 s79, s39, 8
    s_add_u32 s78, s78, s79
    v_mul_u32_u24 v160, 14336, v5
    v_lshl_add_u32 v160, v7, 4, v160

    s_mov_b32 s80, s66
    s_mov_b32 s81, s67
    s_mov_b32 s82, 0x700000
    s_mov_b32 s83, 0x00020000
    s_mul_i32 s53, s2, 37
    s_and_b32 s53, s53, 255
    s_mul_i32 s53, s53, 4
    s_lshr_b32 s53, s53, 8
    s_branch F_swx
F_sw0:
    s_add_u32 s91, s54, 0
    buffer_load_dwordx4 v[72:75], v6, s[16:19], s91 offen nt
    s_add_u32 s91, s54, 7168
    buffer_load_dwordx4 v[76:79], v6, s[16:19], s91 offen nt
    s_add_u32 s91, s54, 14336
    buffer_load_dwordx4 v[80:83], v6, s[16:19], s91 offen nt
    s_add_u32 s91, s54, 21504
    buffer_load_dwordx4 v[84:87], v6, s[16:19], s91 offen nt
    s_add_u32 s91, s54, 28672
    buffer_load_dwordx4 v[88:91], v6, s[16:19], s91 offen nt
    s_add_u32 s91, s54, 35840
    buffer_load_dwordx4 v[92:95], v6, s[16:19], s91 offen nt
    s_add_u32 s91, s54, 43008
    buffer_load_dwordx4 v[96:99], v6, s[16:19], s91 offen nt
    s_add_u32 s91, s54, 50176
    buffer_load_dwordx4 v[100:103], v6, s[16:19], s91 offen nt
    s_setpc_b64 s[34:35]
F_swx:
    s_cmp_eq_u32 s3, 2
    s_cbranch_scc1 F_ax2
    s_cmp_eq_u32 s3, 1
    s_cbranch_scc1 F_ax1
    s_cmp_eq_u32 s3, 0
    s_cbranch_scc1 F_ax0b
    s_barrier
    s_cmp_lg_u32 s53, 0
    s_cbranch_scc1 SW_93
    s_call_b64 s[34:35], F_sw0
SW_93:
    s_branch IW_w5
IW_r5:
    s_barrier
    s_cmp_lg_u32 s53, 1
    s_cbranch_scc1 SW_94
    s_call_b64 s[34:35], F_sw0
SW_94:
    s_branch IW_w7
IW_r7:
    s_barrier
    s_cmp_lg_u32 s53, 2
    s_cbranch_scc1 SW_95
    s_call_b64 s[34:35], F_sw0
SW_95:
    s_nop 0
    s_barrier
    s_cmp_lg_u32 s53, 3
    s_cbranch_scc1 SW_96
    s_call_b64 s[34:35], F_sw0
SW_96:
    s_nop 0
    s_barrier
    s_nop 0
    s_barrier
    s_nop 0
    s_barrier
    s_add_u32 s91, s54, 229376
    buffer_load_dwordx4 v[104:107], v6, s[16:19], s91 offen nt
    s_add_u32 s91, s54, 236544
    buffer_load_dwordx4 v[108:111], v6, s[16:19], s91 offen nt
    s_add_u32 s91, s54, 243712
    buffer_load_dwordx4 v[112:115], v6, s[16:19], s91 offen nt
    s_add_u32 s91, s54, 250880
    buffer_load_dwordx4 v[116:119], v6, s[16:19], s91 offen nt
    s_nop 0
    s_load_dword s76, s[56:57], 0 glc
    s_barrier
    s_add_u32 s91, s54, 258048
    buffer_load_dwordx4 v[120:123], v6, s[16:19], s91 offen nt
    s_add_u32 s91, s54, 265216
    buffer_load_dwordx4 v[124:127], v6, s[16:19], s91 offen nt
    s_add_u32 s91, s54, 272384
    buffer_load_dwordx4 v[128:131], v6, s[16:19], s91 offen nt
    s_add_u32 s91, s54, 279552
    buffer_load_dwordx4 v[132:135], v6, s[16:19], s91 offen nt
    s_waitcnt lgkmcnt(0)
    s_cmp_lt_u32 s76, 1000
    s_cbranch_scc1 F_g3
    v_mov_b32 v4, 1
    s_mov_b64 exec, 1
    ds_write_b32 v10, v4 offset:48
    s_mov_b64 exec, -1
    s_mov_b32 s88, 0
F_g3:
    s_barrier
    s_branch F_aj
F_ax1:
    s_barrier
    s_cmp_lg_u32 s53, 0
    s_cbranch_scc1 SW_97
    s_call_b64 s[34:35], F_sw0
SW_97:
    s_branch IW_w6
IW_r6:
    s_barrier
    s_cmp_lg_u32 s53, 1
    s_cbranch_scc1 SW_98
    s_call_b64 s[34:35], F_sw0
SW_98:
    s_nop 0
    s_barrier
    s_cmp_lg_u32 s53, 2
    s_cbranch_scc1 SW_99
    s_call_b64 s[34:35], F_sw0
SW_99:
    s_nop 0
    s_mul_i32 s44, s33, 768
    s_add_u32 s44, s44, 40960
    s_barrier
    s_cmp_lg_u32 s53, 3
    s_cbranch_scc1 SW_100
    s_call_b64 s[34:35], F_sw0
SW_100:
    s_load_dword s76, s[58:59], 0 glc
    s_barrier
    s_waitcnt lgkmcnt(0)
    s_cmp_ge_u32 s76, 16
    s_cbranch_scc1 GC_101
SP_102:
    s_load_dword s76, s[58:59], 0 glc
    s_waitcnt lgkmcnt(0)
    s_cmp_ge_u32 s76, 16
    s_cbranch_scc1 SD_103
    s_sleep 3
    s_branch SP_102
SD_103:
GC_101:
    s_barrier
    s_sleep 4
    s_mov_b32 m0, 158208
    s_mov_b32 exec_hi, 0xffff
    buffer_load_dwordx4 v2, s[40:43], s44 offen sc0 sc1 lds
    s_mov_b64 exec, -1
    s_barrier
    s_add_u32 s91, s54, 229376
    buffer_load_dwordx4 v[104:107], v6, s[16:19], s91 offen nt
    s_add_u32 s91, s54, 236544
    buffer_load_dwordx4 v[108:111], v6, s[16:19], s91 offen nt
    s_add_u32 s91, s54, 243712
    buffer_load_dwordx4 v[112:115], v6, s[16:19], s91 offen nt
    s_add_u32 s91, s54, 250880
    buffer_load_dwordx4 v[116:119], v6, s[16:19], s91 offen nt
    s_barrier
    s_add_u32 s91, s54, 258048
    buffer_load_dwordx4 v[120:123], v6, s[16:19], s91 offen nt
    s_add_u32 s91, s54, 265216
    buffer_load_dwordx4 v[124:127], v6, s[16:19], s91 offen nt
    s_add_u32 s91, s54, 272384
    buffer_load_dwordx4 v[128:131], v6, s[16:19], s91 offen nt
    s_add_u32 s91, s54, 279552
    buffer_load_dwordx4 v[132:135], v6, s[16:19], s91 offen nt
    s_waitcnt vmcnt(8)
    v_mov_b32 v4, 1
    s_mov_b64 exec, 1
    ds_write_b32 v10, v4 offset:48
    s_mov_b64 exec, -1
    s_barrier
    s_branch F_aj
IW_w9:
    s_branch IW_r9
F_ax0b:
    s_barrier
    s_cmp_lg_u32 s53, 0
    s_cbranch_scc1 SW_104
    s_call_b64 s[34:35], F_sw0
SW_104:
    s_branch IW_w2
IW_r2:
    s_barrier
    s_cmp_lg_u32 s53, 1
    s_cbranch_scc1 SW_105
    s_call_b64 s[34:35], F_sw0
SW_105:
    s_nop 0
    s_barrier
    s_cmp_lg_u32 s53, 2
    s_cbranch_scc1 SW_106
    s_call_b64 s[34:35], F_sw0
SW_106:
    s_nop 0
    s_lshl_b32 s47, s28, 9
    s_add_u32 s58, s47, 0x858000
    s_add_u32 s58, s72, s58
    s_addc_u32 s59, s73, 0
    s_lshl_b32 s44, s32, 11
    s_lshl_b32 s45, s28, 11
    v_lshrrev_b32 v11, 2, v0
    v_and_b32 v9, 3, v0
    v_lshlrev_b32 v9, 4, v9
    v_lshl_add_u32 v11, v11, 7, v9

    s_barrier
    s_cmp_lg_u32 s53, 3
    s_cbranch_scc1 SW_107
    s_call_b64 s[34:35], F_sw0
SW_107:
    s_load_dword s76, s[56:57], 0 glc
    s_load_dword s77, s[58:59], 0 glc
    s_barrier
    s_waitcnt lgkmcnt(0)
    s_cmp_ge_u32 s76, 16
    s_cbranch_scc1 GC_108
SP_109:
    s_load_dword s76, s[56:57], 0 glc
    s_waitcnt lgkmcnt(0)
    s_cmp_ge_u32 s76, 16
    s_cbranch_scc1 SD_110
    s_sleep 3
    s_branch SP_109
SD_110:
GC_108:
    s_cmp_ge_u32 s77, 16
    s_cbranch_scc1 GC_111
SP_112:
    s_load_dword s77, s[58:59], 0 glc
    s_waitcnt lgkmcnt(0)
    s_cmp_ge_u32 s77, 16
    s_cbranch_scc1 SD_113
    s_sleep 3
    s_branch SP_112
SD_113:
GC_111:
    s_barrier
    s_sleep 4
    buffer_load_dwordx4 v[32:35], v11, s[40:43], s44 offen sc0 sc1
    buffer_load_dwordx4 v[36:39], v11, s[40:43], s45 offen sc0 sc1
    v_lshlrev_b32 v9, 3, v0
    v_add_u32 v9, 155648, v9
    s_mov_b32 s44, 0x3fb8aa3b

    s_barrier
    s_add_u32 s91, s54, 229376
    buffer_load_dwordx4 v[104:107], v6, s[16:19], s91 offen nt
    s_add_u32 s91, s54, 236544
    buffer_load_dwordx4 v[108:111], v6, s[16:19], s91 offen nt
    s_add_u32 s91, s54, 243712
    buffer_load_dwordx4 v[112:115], v6, s[16:19], s91 offen nt
    s_add_u32 s91, s54, 250880
    buffer_load_dwordx4 v[116:119], v6, s[16:19], s91 offen nt
    s_barrier
    s_add_u32 s91, s54, 258048
    buffer_load_dwordx4 v[120:123], v6, s[16:19], s91 offen nt
    s_add_u32 s91, s54, 265216
    buffer_load_dwordx4 v[124:127], v6, s[16:19], s91 offen nt
    s_add_u32 s91, s54, 272384
    buffer_load_dwordx4 v[128:131], v6, s[16:19], s91 offen nt
    s_add_u32 s91, s54, 279552
    buffer_load_dwordx4 v[132:135], v6, s[16:19], s91 offen nt
    s_waitcnt vmcnt(8)
    v_swap_b32 v33, v34
    v_swap_b32 v37, v38
    v_mul_f32 v40, s44, v34
    v_mul_f32 v41, s44, v35
    ds_write_b64 v9, v[32:33]
    ds_write_b64 v9, v[40:41] offset:1024
    ds_write_b64 v9, v[36:37] offset:1536
    ds_write_b64 v9, v[38:39] offset:2048

    v_mov_b32 v4, 1
    s_mov_b64 exec, 1
    ds_write_b32 v10, v4 offset:48
    s_mov_b64 exec, -1
    s_barrier
    s_branch F_aj
F_ax2:
    s_cmp_lg_u32 s2, 248
    s_cbranch_scc1 F_a2n
    s_waitcnt lgkmcnt(0)
    s_mov_b32 s74, 7
    v_lshrrev_b32 v11, 1, v0
    v_and_b32 v9, 1, v0
    v_lshlrev_b32 v9, 4, v9
    v_lshl_add_u32 v11, v11, 7, v9
    v_lshlrev_b32 v9, 9, v0
    v_mov_b32 v8, 1000
F_a2l:

    s_load_dword s60, s[40:41], 0x8180 glc
    s_load_dword s61, s[40:41], 0x8980 glc
    s_load_dword s62, s[40:41], 0x9180 glc
    s_load_dword s63, s[40:41], 0x9980 glc
    s_waitcnt lgkmcnt(0)
    s_add_u32 s60, s60, s61
    s_add_u32 s62, s62, s63
    s_add_u32 s60, s60, s62
    s_cmp_ge_u32 s60, 256
    s_cbranch_scc1 F_a2t

    s_cmp_ge_u32 s74, 17
    s_cbranch_scc1 DB_114
    s_barrier
    s_add_u32 s74, s74, 1
DB_114:
    s_branch F_a2l
F_a2t:
    s_movk_i32 s44, 0
    buffer_load_dwordx4 v[16:19], v11, s[40:43], s44 offen offset:64 sc0 sc1
    s_movk_i32 s44, 4096
    buffer_load_dwordx4 v[20:23], v11, s[40:43], s44 offen offset:64 sc0 sc1
    s_movk_i32 s44, 8192
    buffer_load_dwordx4 v[24:27], v11, s[40:43], s44 offen offset:64 sc0 sc1
    s_movk_i32 s44, 12288
    buffer_load_dwordx4 v[28:31], v11, s[40:43], s44 offen offset:64 sc0 sc1
    s_movk_i32 s44, 16384
    buffer_load_dwordx4 v[32:35], v11, s[40:43], s44 offen offset:64 sc0 sc1
    s_movk_i32 s44, 20480
    buffer_load_dwordx4 v[36:39], v11, s[40:43], s44 offen offset:64 sc0 sc1
    s_movk_i32 s44, 24576
    buffer_load_dwordx4 v[40:43], v11, s[40:43], s44 offen offset:64 sc0 sc1
    s_movk_i32 s44, 28672
    buffer_load_dwordx4 v[44:47], v11, s[40:43], s44 offen offset:64 sc0 sc1
    s_mov_b32 s44, 32768
    s_mov_b64 exec, 0xffff
    buffer_atomic_add v8, v9, s[40:43], s44 offen
    s_mov_b64 exec, -1

    s_cmp_ge_u32 s74, 17
    s_cbranch_scc1 DB_115
    s_barrier
    s_add_u32 s74, s74, 1
DB_115:
    s_waitcnt vmcnt(1)
    v_max3_u32 v48, v16, v17, v18
    v_med3_u32 v49, v16, v17, v18
    v_min3_u32 v50, v16, v17, v18
    v_med3_u32 v50, v49, v50, v19
    v_med3_u32 v49, v48, v49, v19
    v_max_u32 v48, v48, v19
    v_med3_u32 v50, v49, v50, v20
    v_med3_u32 v49, v48, v49, v20
    v_max_u32 v48, v48, v20
    v_med3_u32 v50, v49, v50, v21
    v_med3_u32 v49, v48, v49, v21
    v_max_u32 v48, v48, v21
    v_med3_u32 v50, v49, v50, v22
    v_med3_u32 v49, v48, v49, v22
    v_max_u32 v48, v48, v22
    v_med3_u32 v50, v49, v50, v23
    v_med3_u32 v49, v48, v49, v23
    v_max_u32 v48, v48, v23
    v_med3_u32 v50, v49, v50, v24
    v_med3_u32 v49, v48, v49, v24
    v_max_u32 v48, v48, v24
    v_med3_u32 v50, v49, v50, v25
    v_med3_u32 v49, v48, v49, v25
    v_max_u32 v48, v48, v25
    v_med3_u32 v50, v49, v50, v26
    v_med3_u32 v49, v48, v49, v26
    v_max_u32 v48, v48, v26
    v_med3_u32 v50, v49, v50, v27
    v_med3_u32 v49, v48, v49, v27
    v_max_u32 v48, v48, v27
    v_med3_u32 v50, v49, v50, v28
    v_med3_u32 v49, v48, v49, v28
    v_max_u32 v48, v48, v28
    v_med3_u32 v50, v49, v50, v29
    v_med3_u32 v49, v48, v49, v29
    v_max_u32 v48, v48, v29
    v_med3_u32 v50, v49, v50, v30
    v_med3_u32 v49, v48, v49, v30
    v_max_u32 v48, v48, v30
    v_med3_u32 v50, v49, v50, v31
    v_med3_u32 v49, v48, v49, v31
    v_max_u32 v48, v48, v31
    v_med3_u32 v50, v49, v50, v32
    v_med3_u32 v49, v48, v49, v32
    v_max_u32 v48, v48, v32
    v_med3_u32 v50, v49, v50, v33
    v_med3_u32 v49, v48, v49, v33
    v_max_u32 v48, v48, v33
    v_med3_u32 v50, v49, v50, v34
    v_med3_u32 v49, v48, v49, v34
    v_max_u32 v48, v48, v34
    v_med3_u32 v50, v49, v50, v35
    v_med3_u32 v49, v48, v49, v35
    v_max_u32 v48, v48, v35
    v_med3_u32 v50, v49, v50, v36
    v_med3_u32 v49, v48, v49, v36
    v_max_u32 v48, v48, v36
    v_med3_u32 v50, v49, v50, v37
    v_med3_u32 v49, v48, v49, v37
    v_max_u32 v48, v48, v37
    v_med3_u32 v50, v49, v50, v38
    v_med3_u32 v49, v48, v49, v38
    v_max_u32 v48, v48, v38
    v_med3_u32 v50, v49, v50, v39
    v_med3_u32 v49, v48, v49, v39
    v_max_u32 v48, v48, v39
    v_med3_u32 v50, v49, v50, v40
    v_med3_u32 v49, v48, v49, v40
    v_max_u32 v48, v48, v40
    v_med3_u32 v50, v49, v50, v41
    v_med3_u32 v49, v48, v49, v41
    v_max_u32 v48, v48, v41
    v_med3_u32 v50, v49, v50, v42
    v_med3_u32 v49, v48, v49, v42
    v_max_u32 v48, v48, v42
    v_med3_u32 v50, v49, v50, v43
    v_med3_u32 v49, v48, v49, v43
    v_max_u32 v48, v48, v43
    v_med3_u32 v50, v49, v50, v44
    v_med3_u32 v49, v48, v49, v44
    v_max_u32 v48, v48, v44
    v_med3_u32 v50, v49, v50, v45
    v_med3_u32 v49, v48, v49, v45
    v_max_u32 v48, v48, v45
    v_med3_u32 v50, v49, v50, v46
    v_med3_u32 v49, v48, v49, v46
    v_max_u32 v48, v48, v46
    v_med3_u32 v50, v49, v50, v47
    v_med3_u32 v49, v48, v49, v47
    v_max_u32 v48, v48, v47
    s_mov_b32 s53, 0
    v_max_u32 v4, v48, v49
    s_nop 1
    v_max_u32_dpp v4, v4, v4 row_shr:1 row_mask:0xf bank_mask:0xf bound_ctrl:0
    s_nop 1
    v_max_u32_dpp v4, v4, v4 row_shr:2 row_mask:0xf bank_mask:0xf bound_ctrl:0
    s_nop 1
    v_max_u32_dpp v4, v4, v4 row_shr:4 row_mask:0xf bank_mask:0xf bound_ctrl:0
    s_nop 1
    v_max_u32_dpp v4, v4, v4 row_shr:8 row_mask:0xf bank_mask:0xf bound_ctrl:0
    s_nop 1
    v_max_u32_dpp v4, v4, v4 row_bcast:15 row_mask:0xa bank_mask:0xf
    s_nop 1
    v_max_u32_dpp v4, v4, v4 row_bcast:31 row_mask:0xc bank_mask:0xf
    s_nop 0
    v_readlane_b32 s52, v4, 63
    s_nop 0
    s_add_u32 s53, s53, s52
    v_writelane_b32 v13, s53, 0
    v_subrev_u32 v48, s52, v48
    v_subrev_u32 v49, s52, v49
    v_max_u32 v4, v48, v49
    s_nop 1
    v_max_u32_dpp v4, v4, v4 row_shr:1 row_mask:0xf bank_mask:0xf bound_ctrl:0
    s_nop 1
    v_max_u32_dpp v4, v4, v4 row_shr:2 row_mask:0xf bank_mask:0xf bound_ctrl:0
    s_nop 1
    v_max_u32_dpp v4, v4, v4 row_shr:4 row_mask:0xf bank_mask:0xf bound_ctrl:0
    s_nop 1
    v_max_u32_dpp v4, v4, v4 row_shr:8 row_mask:0xf bank_mask:0xf bound_ctrl:0
    s_nop 1
    v_max_u32_dpp v4, v4, v4 row_bcast:15 row_mask:0xa bank_mask:0xf
    s_nop 1
    v_max_u32_dpp v4, v4, v4 row_bcast:31 row_mask:0xc bank_mask:0xf
    s_nop 0
    v_readlane_b32 s52, v4, 63
    s_nop 0
    s_add_u32 s53, s53, s52
    v_writelane_b32 v13, s53, 1
    v_subrev_u32 v48, s52, v48
    v_subrev_u32 v49, s52, v49
    v_max_u32 v4, v48, v49
    s_nop 1
    v_max_u32_dpp v4, v4, v4 row_shr:1 row_mask:0xf bank_mask:0xf bound_ctrl:0
    s_nop 1
    v_max_u32_dpp v4, v4, v4 row_shr:2 row_mask:0xf bank_mask:0xf bound_ctrl:0
    s_nop 1
    v_max_u32_dpp v4, v4, v4 row_shr:4 row_mask:0xf bank_mask:0xf bound_ctrl:0
    s_nop 1
    v_max_u32_dpp v4, v4, v4 row_shr:8 row_mask:0xf bank_mask:0xf bound_ctrl:0
    s_nop 1
    v_max_u32_dpp v4, v4, v4 row_bcast:15 row_mask:0xa bank_mask:0xf
    s_nop 1
    v_max_u32_dpp v4, v4, v4 row_bcast:31 row_mask:0xc bank_mask:0xf
    s_nop 0
    v_readlane_b32 s52, v4, 63
    s_nop 0
    s_add_u32 s53, s53, s52
    v_writelane_b32 v13, s53, 2
    v_subrev_u32 v48, s52, v48
    v_subrev_u32 v49, s52, v49
    v_max_u32 v4, v48, v49
    s_nop 1
    v_max_u32_dpp v4, v4, v4 row_shr:1 row_mask:0xf bank_mask:0xf bound_ctrl:0
    s_nop 1
    v_max_u32_dpp v4, v4, v4 row_shr:2 row_mask:0xf bank_mask:0xf bound_ctrl:0
    s_nop 1
    v_max_u32_dpp v4, v4, v4 row_shr:4 row_mask:0xf bank_mask:0xf bound_ctrl:0
    s_nop 1
    v_max_u32_dpp v4, v4, v4 row_shr:8 row_mask:0xf bank_mask:0xf bound_ctrl:0
    s_nop 1
    v_max_u32_dpp v4, v4, v4 row_bcast:15 row_mask:0xa bank_mask:0xf
    s_nop 1
    v_max_u32_dpp v4, v4, v4 row_bcast:31 row_mask:0xc bank_mask:0xf
    s_nop 0
    v_readlane_b32 s52, v4, 63
    s_nop 0
    s_add_u32 s53, s53, s52
    v_writelane_b32 v13, s53, 3
    v_subrev_u32 v48, s52, v48
    v_subrev_u32 v49, s52, v49
    v_max_u32 v4, v48, v49
    s_nop 1
    v_max_u32_dpp v4, v4, v4 row_shr:1 row_mask:0xf bank_mask:0xf bound_ctrl:0
    s_nop 1
    v_max_u32_dpp v4, v4, v4 row_shr:2 row_mask:0xf bank_mask:0xf bound_ctrl:0
    s_nop 1
    v_max_u32_dpp v4, v4, v4 row_shr:4 row_mask:0xf bank_mask:0xf bound_ctrl:0
    s_nop 1
    v_max_u32_dpp v4, v4, v4 row_shr:8 row_mask:0xf bank_mask:0xf bound_ctrl:0
    s_nop 1
    v_max_u32_dpp v4, v4, v4 row_bcast:15 row_mask:0xa bank_mask:0xf
    s_nop 1
    v_max_u32_dpp v4, v4, v4 row_bcast:31 row_mask:0xc bank_mask:0xf
    s_nop 0
    v_readlane_b32 s52, v4, 63
    s_nop 0
    s_add_u32 s53, s53, s52
    v_writelane_b32 v13, s53, 4
    v_subrev_u32 v48, s52, v48
    v_subrev_u32 v49, s52, v49
    v_max_u32 v4, v48, v49
    s_nop 1
    v_max_u32_dpp v4, v4, v4 row_shr:1 row_mask:0xf bank_mask:0xf bound_ctrl:0
    s_nop 1
    v_max_u32_dpp v4, v4, v4 row_shr:2 row_mask:0xf bank_mask:0xf bound_ctrl:0
    s_nop 1
    v_max_u32_dpp v4, v4, v4 row_shr:4 row_mask:0xf bank_mask:0xf bound_ctrl:0
    s_nop 1
    v_max_u32_dpp v4, v4, v4 row_shr:8 row_mask:0xf bank_mask:0xf bound_ctrl:0
    s_nop 1
    v_max_u32_dpp v4, v4, v4 row_bcast:15 row_mask:0xa bank_mask:0xf
    s_nop 1
    v_max_u32_dpp v4, v4, v4 row_bcast:31 row_mask:0xc bank_mask:0xf
    s_nop 0
    v_readlane_b32 s52, v4, 63
    s_nop 0
    s_add_u32 s53, s53, s52
    v_writelane_b32 v13, s53, 5
    v_subrev_u32 v48, s52, v48
    v_subrev_u32 v49, s52, v49
    v_max_u32 v4, v48, v49
    s_nop 1
    v_max_u32_dpp v4, v4, v4 row_shr:1 row_mask:0xf bank_mask:0xf bound_ctrl:0
    s_nop 1
    v_max_u32_dpp v4, v4, v4 row_shr:2 row_mask:0xf bank_mask:0xf bound_ctrl:0
    s_nop 1
    v_max_u32_dpp v4, v4, v4 row_shr:4 row_mask:0xf bank_mask:0xf bound_ctrl:0
    s_nop 1
    v_max_u32_dpp v4, v4, v4 row_shr:8 row_mask:0xf bank_mask:0xf bound_ctrl:0
    s_nop 1
    v_max_u32_dpp v4, v4, v4 row_bcast:15 row_mask:0xa bank_mask:0xf
    s_nop 1
    v_max_u32_dpp v4, v4, v4 row_bcast:31 row_mask:0xc bank_mask:0xf
    s_nop 0
    v_readlane_b32 s52, v4, 63
    s_nop 0
    s_add_u32 s53, s53, s52
    v_writelane_b32 v13, s53, 6
    v_subrev_u32 v48, s52, v48
    v_subrev_u32 v49, s52, v49
    v_max_u32 v4, v48, v49
    s_nop 1
    v_max_u32_dpp v4, v4, v4 row_shr:1 row_mask:0xf bank_mask:0xf bound_ctrl:0
    s_nop 1
    v_max_u32_dpp v4, v4, v4 row_shr:2 row_mask:0xf bank_mask:0xf bound_ctrl:0
    s_nop 1
    v_max_u32_dpp v4, v4, v4 row_shr:4 row_mask:0xf bank_mask:0xf bound_ctrl:0
    s_nop 1
    v_max_u32_dpp v4, v4, v4 row_shr:8 row_mask:0xf bank_mask:0xf bound_ctrl:0
    s_nop 1
    v_max_u32_dpp v4, v4, v4 row_bcast:15 row_mask:0xa bank_mask:0xf
    s_nop 1
    v_max_u32_dpp v4, v4, v4 row_bcast:31 row_mask:0xc bank_mask:0xf
    s_nop 0
    v_readlane_b32 s52, v4, 63
    s_nop 0
    s_add_u32 s53, s53, s52
    v_writelane_b32 v13, s53, 7
    v_cmp_lt_u32 vcc, s53, v50
    s_cbranch_vccz F_a2k
    s_mov_b32 s53, 0
    s_mov_b32 s52, 0
    s_mov_b32 s64, 0
F_a2f:
    v_subrev_u32 v16, s52, v16
    v_subrev_u32 v17, s52, v17
    v_subrev_u32 v18, s52, v18
    v_subrev_u32 v19, s52, v19
    v_subrev_u32 v20, s52, v20
    v_subrev_u32 v21, s52, v21
    v_subrev_u32 v22, s52, v22
    v_subrev_u32 v23, s52, v23
    v_subrev_u32 v24, s52, v24
    v_subrev_u32 v25, s52, v25
    v_subrev_u32 v26, s52, v26
    v_subrev_u32 v27, s52, v27
    v_subrev_u32 v28, s52, v28
    v_subrev_u32 v29, s52, v29
    v_subrev_u32 v30, s52, v30
    v_subrev_u32 v31, s52, v31
    v_subrev_u32 v32, s52, v32
    v_subrev_u32 v33, s52, v33
    v_subrev_u32 v34, s52, v34
    v_subrev_u32 v35, s52, v35
    v_subrev_u32 v36, s52, v36
    v_subrev_u32 v37, s52, v37
    v_subrev_u32 v38, s52, v38
    v_subrev_u32 v39, s52, v39
    v_subrev_u32 v40, s52, v40
    v_subrev_u32 v41, s52, v41
    v_subrev_u32 v42, s52, v42
    v_subrev_u32 v43, s52, v43
    v_subrev_u32 v44, s52, v44
    v_subrev_u32 v45, s52, v45
    v_subrev_u32 v46, s52, v46
    v_subrev_u32 v47, s52, v47
    v_max3_u32 v4, v16, v17, v18
    v_max3_u32 v12, v19, v20, v21
    v_max3_u32 v4, v4, v22, v23
    v_max3_u32 v12, v12, v24, v25
    v_max3_u32 v4, v4, v26, v27
    v_max3_u32 v12, v12, v28, v29
    v_max3_u32 v4, v4, v30, v31
    v_max3_u32 v12, v12, v32, v33
    v_max3_u32 v4, v4, v34, v35
    v_max3_u32 v12, v12, v36, v37
    v_max3_u32 v4, v4, v38, v39
    v_max3_u32 v12, v12, v40, v41
    v_max3_u32 v4, v4, v42, v43
    v_max3_u32 v12, v12, v44, v45
    v_max3_u32 v4, v4, v46, v47
    v_max_u32 v4, v4, v12
    s_nop 1
    v_max_u32_dpp v4, v4, v4 row_shr:1 row_mask:0xf bank_mask:0xf bound_ctrl:0
    s_nop 1
    v_max_u32_dpp v4, v4, v4 row_shr:2 row_mask:0xf bank_mask:0xf bound_ctrl:0
    s_nop 1
    v_max_u32_dpp v4, v4, v4 row_shr:4 row_mask:0xf bank_mask:0xf bound_ctrl:0
    s_nop 1
    v_max_u32_dpp v4, v4, v4 row_shr:8 row_mask:0xf bank_mask:0xf bound_ctrl:0
    s_nop 1
    v_max_u32_dpp v4, v4, v4 row_bcast:15 row_mask:0xa bank_mask:0xf
    s_nop 1
    v_max_u32_dpp v4, v4, v4 row_bcast:31 row_mask:0xc bank_mask:0xf
    s_nop 0
    v_readlane_b32 s52, v4, 63
    s_nop 0
    s_add_u32 s53, s53, s52
    s_mov_b32 m0, s64
    v_writelane_b32 v13, s53, m0
    s_cmp_ge_u32 s74, 17
    s_cbranch_scc1 DB_116
    s_barrier
    s_add_u32 s74, s74, 1
DB_116:
    s_add_u32 s64, s64, 1
    s_cmp_lt_u32 s64, 8
    s_cbranch_scc1 F_a2f
F_a2k:
    v_and_b32 v4, 7, v0
    v_lshlrev_b32 v4, 2, v4
    ds_bpermute_b32 v12, v4, v13
    v_lshrrev_b32 v9, 3, v0
    v_lshl_add_u32 v4, v9, 9, v4
    s_mov_b32 s44, 32896
    s_mov_b32 s45, 36992
    s_waitcnt lgkmcnt(0)
    v_or_b32 v12, 0x8000, v12
    buffer_store_dword v12, v4, s[40:43], s44 offen sc0 sc1
    buffer_store_dword v12, v4, s[40:43], s45 offen sc0 sc1

F_a2m:
    s_cmp_ge_u32 s74, 17
    s_cbranch_scc1 DB_117
    s_barrier
    s_add_u32 s74, s74, 1
DB_117:
    s_cmp_lt_u32 s74, 17
    s_cbranch_scc1 F_a2m
    s_add_u32 s91, s54, 0
    buffer_load_dwordx4 v[72:75], v6, s[16:19], s91 offen nt
    s_add_u32 s91, s54, 7168
    buffer_load_dwordx4 v[76:79], v6, s[16:19], s91 offen nt
    s_add_u32 s91, s54, 14336
    buffer_load_dwordx4 v[80:83], v6, s[16:19], s91 offen nt
    s_add_u32 s91, s54, 21504
    buffer_load_dwordx4 v[84:87], v6, s[16:19], s91 offen nt
    s_add_u32 s91, s54, 28672
    buffer_load_dwordx4 v[88:91], v6, s[16:19], s91 offen nt
    s_add_u32 s91, s54, 35840
    buffer_load_dwordx4 v[92:95], v6, s[16:19], s91 offen nt
    s_add_u32 s91, s54, 43008
    buffer_load_dwordx4 v[96:99], v6, s[16:19], s91 offen nt
    s_add_u32 s91, s54, 50176
    buffer_load_dwordx4 v[100:103], v6, s[16:19], s91 offen nt
    s_add_u32 s91, s54, 229376
    buffer_load_dwordx4 v[104:107], v6, s[16:19], s91 offen nt
    s_add_u32 s91, s54, 236544
    buffer_load_dwordx4 v[108:111], v6, s[16:19], s91 offen nt
    s_add_u32 s91, s54, 243712
    buffer_load_dwordx4 v[112:115], v6, s[16:19], s91 offen nt
    s_add_u32 s91, s54, 250880
    buffer_load_dwordx4 v[116:119], v6, s[16:19], s91 offen nt
    s_add_u32 s91, s54, 258048
    buffer_load_dwordx4 v[120:123], v6, s[16:19], s91 offen nt
    s_add_u32 s91, s54, 265216
    buffer_load_dwordx4 v[124:127], v6, s[16:19], s91 offen nt
    s_add_u32 s91, s54, 272384
    buffer_load_dwordx4 v[128:131], v6, s[16:19], s91 offen nt
    s_add_u32 s91, s54, 279552
    buffer_load_dwordx4 v[132:135], v6, s[16:19], s91 offen nt
    s_branch F_aj2
IW_w10:
    s_branch IW_r10
F_a2n:
    s_barrier
    s_cmp_lg_u32 s53, 0
    s_cbranch_scc1 SW_118
    s_call_b64 s[34:35], F_sw0
SW_118:
    s_branch IW_w11
IW_r11:
    s_barrier
    s_cmp_lg_u32 s53, 1
    s_cbranch_scc1 SW_119
    s_call_b64 s[34:35], F_sw0
SW_119:
    s_nop 0
    s_barrier
    s_cmp_lg_u32 s53, 2
    s_cbranch_scc1 SW_120
    s_call_b64 s[34:35], F_sw0
SW_120:
    s_nop 0
    s_barrier
    s_cmp_lg_u32 s53, 3
    s_cbranch_scc1 SW_121
    s_call_b64 s[34:35], F_sw0
SW_121:
    s_nop 0
    s_barrier
    s_nop 0
    s_barrier
    s_nop 0
    s_barrier
    s_add_u32 s91, s54, 229376
    buffer_load_dwordx4 v[104:107], v6, s[16:19], s91 offen nt
    s_add_u32 s91, s54, 236544
    buffer_load_dwordx4 v[108:111], v6, s[16:19], s91 offen nt
    s_add_u32 s91, s54, 243712
    buffer_load_dwordx4 v[112:115], v6, s[16:19], s91 offen nt
    s_add_u32 s91, s54, 250880
    buffer_load_dwordx4 v[116:119], v6, s[16:19], s91 offen nt
    s_nop 0
    s_load_dwordx8 s[60:67], s[56:57], 128 glc
    s_barrier
    s_add_u32 s91, s54, 258048
    buffer_load_dwordx4 v[120:123], v6, s[16:19], s91 offen nt
    s_add_u32 s91, s54, 265216
    buffer_load_dwordx4 v[124:127], v6, s[16:19], s91 offen nt
    s_add_u32 s91, s54, 272384
    buffer_load_dwordx4 v[128:131], v6, s[16:19], s91 offen nt
    s_add_u32 s91, s54, 279552
    buffer_load_dwordx4 v[132:135], v6, s[16:19], s91 offen nt
    s_waitcnt lgkmcnt(0)
    s_and_b64 s[44:45], s[60:61], s[62:63]
    s_and_b64 s[44:45], s[44:45], s[64:65]
    s_and_b64 s[44:45], s[44:45], s[66:67]
    s_and_b32 s44, s44, s45
    s_bitcmp1_b32 s44, 15
    s_cbranch_scc0 F_a2q
    s_andn2_b32 s60, s60, 0x8000
    v_writelane_b32 v12, s60, 0
    s_andn2_b32 s61, s61, 0x8000
    v_writelane_b32 v12, s61, 1
    s_andn2_b32 s62, s62, 0x8000
    v_writelane_b32 v12, s62, 2
    s_andn2_b32 s63, s63, 0x8000
    v_writelane_b32 v12, s63, 3
    s_andn2_b32 s64, s64, 0x8000
    v_writelane_b32 v12, s64, 4
    s_andn2_b32 s65, s65, 0x8000
    v_writelane_b32 v12, s65, 5
    s_andn2_b32 s66, s66, 0x8000
    v_writelane_b32 v12, s66, 6
    s_andn2_b32 s67, s67, 0x8000
    v_writelane_b32 v12, s67, 7
    v_add_u32 v4, 158976, v3
    s_mov_b64 exec, 0xff
    ds_write_b32 v4, v12
    s_mov_b64 exec, -1
    v_mov_b32 v4, 1
    s_mov_b64 exec, 1
    ds_write_b32 v10, v4 offset:48
    s_mov_b64 exec, -1
    s_waitcnt lgkmcnt(0)
    s_mov_b32 s88, 1
F_a2q:
    s_barrier
F_aj:
    s_mov_b32 s74, 0
F_aj2:
    v_and_b32 v13, 3, v0
    v_lshlrev_b32 v13, 2, v13
    v_add_u32 v13, 159040, v13

    s_cmp_lt_u32 s3, 2
    s_mov_b32 s75, 65536
    s_cselect_b32 s75, 32768, s75
    s_and_b32 s44, s3, 1
    s_lshl_b32 s44, s44, 12
    s_add_u32 s75, s75, s44
    s_add_u32 s12, s72, 0x900000
    s_addc_u32 s13, s73, 0
    s_mov_b32 s14, 0xe0000
    s_mov_b32 s15, 0x00020000
    s_mov_b32 s47, s10
    v_mov_b32 v4, 159096
    ds_read_b32 v9, v4
    s_waitcnt lgkmcnt(0)
    v_readfirstlane_b32 s79, v9
    s_nop 0
    s_cmp_eq_u32 s79, 0
    s_cbranch_scc1 F_xe
    v_and_b32 v4, 7, v0
    v_lshlrev_b32 v4, 2, v4
    v_add_u32 v4, 158976, v4
    ds_read_b32 v4, v4
    s_waitcnt lgkmcnt(0)
    v_and_b32 v4, 0x7ff, v4
    v_sub_u32 v4, 2047, v4
    v_and_b32 v11, 7, v4
    v_lshrrev_b32 v9, 3, v4
    v_lshlrev_b32 v9, 7, v9
    v_lshl_add_u32 v9, v11, 3, v9
    v_lshlrev_b32 v4, 11, v4
    v_lshl_add_u32 v4, v5, 4, v4
    buffer_load_dwordx4 v[64:67], v4, s[20:23], s55 offen
    buffer_load_dwordx4 v[68:71], v4, s[20:23], s55 offen offset:64
    buffer_load_dwordx2 v[14:15], v9, s[40:43], 0 offen sc0 sc1

F_xe:
    s_cmp_lg_u32 s74, 0
    s_cbranch_scc1 JB_122
    s_barrier
JB_122:
    s_cmp_lg_u32 s88, 3
    s_cbranch_scc1 F_g4
SP_123:
    s_load_dword s76, s[56:57], 0 glc
    s_waitcnt lgkmcnt(0)
    s_cmp_ge_u32 s76, 1000
    s_cbranch_scc1 SD_124
    s_sleep 3
    s_branch SP_123
SD_124:
    v_mov_b32 v4, 1
    s_mov_b64 exec, 1
    ds_write_b32 v10, v4 offset:48
    s_mov_b64 exec, -1
F_g4:
    s_setprio 1
    s_cmp_lg_u32 s79, 0
    s_cbranch_scc1 F_xd
    s_cmp_lg_u32 s88, 2
    s_cbranch_scc1 F_se
F_sc:
    s_load_dwordx8 s[60:67], s[56:57], 128 glc
    s_waitcnt lgkmcnt(0)
    s_and_b64 s[44:45], s[60:61], s[62:63]
    s_and_b64 s[44:45], s[44:45], s[64:65]
    s_and_b64 s[44:45], s[44:45], s[66:67]
    s_and_b32 s44, s44, s45
    s_bitcmp1_b32 s44, 15
    s_cbranch_scc1 F_sd
    s_sleep 4
    s_branch F_sc
F_sd:
    s_andn2_b32 s60, s60, 0x8000
    v_writelane_b32 v12, s60, 0
    s_andn2_b32 s61, s61, 0x8000
    v_writelane_b32 v12, s61, 1
    s_andn2_b32 s62, s62, 0x8000
    v_writelane_b32 v12, s62, 2
    s_andn2_b32 s63, s63, 0x8000
    v_writelane_b32 v12, s63, 3
    s_andn2_b32 s64, s64, 0x8000
    v_writelane_b32 v12, s64, 4
    s_andn2_b32 s65, s65, 0x8000
    v_writelane_b32 v12, s65, 5
    s_andn2_b32 s66, s66, 0x8000
    v_writelane_b32 v12, s66, 6
    s_andn2_b32 s67, s67, 0x8000
    v_writelane_b32 v12, s67, 7
    v_add_u32 v4, 158976, v3
    s_mov_b64 exec, 0xff
    ds_write_b32 v4, v12
    s_mov_b64 exec, -1
    v_mov_b32 v4, 1
    s_mov_b64 exec, 1
    ds_write_b32 v10, v4 offset:48
    s_mov_b64 exec, -1
F_se:
    v_mov_b32 v4, 159096
    ds_read_b32 v9, v4 offset:0
FW_125:
    s_waitcnt lgkmcnt(0)
    v_cmp_gt_u32 vcc, 1, v9
    s_cbranch_vccz FO_126
    s_sleep 1
    ds_read_b32 v9, v4 offset:0
    s_branch FW_125
FO_126:
    v_and_b32 v4, 7, v0
    v_lshlrev_b32 v4, 2, v4
    v_add_u32 v4, 158976, v4
    ds_read_b32 v4, v4
    s_waitcnt lgkmcnt(0)
    v_and_b32 v4, 0x7ff, v4
    v_sub_u32 v4, 2047, v4
    v_and_b32 v11, 7, v4
    v_lshrrev_b32 v9, 3, v4
    v_lshlrev_b32 v9, 7, v9
    v_lshl_add_u32 v9, v11, 3, v9
    v_lshlrev_b32 v4, 11, v4
    v_lshl_add_u32 v4, v5, 4, v4
    buffer_load_dwordx4 v[64:67], v4, s[20:23], s55 offen
    buffer_load_dwordx4 v[68:71], v4, s[20:23], s55 offen offset:64
    buffer_load_dwordx2 v[14:15], v9, s[40:43], 0 offen sc0 sc1

F_xd:
    s_mov_b32 s52, 0x05040100
    s_mov_b32 s53, 0x07060302
    s_setprio 1
    s_cmp_ge_u32 s89, 224
    s_cbranch_scc1 F_adown
    s_waitcnt vmcnt(0)
    v_lshlrev_b32 v34, 16, v64
    v_and_b32 v35, 0xffff0000, v64
    v_lshlrev_b32 v36, 16, v65
    v_and_b32 v37, 0xffff0000, v65
    v_lshlrev_b32 v38, 16, v66
    v_and_b32 v39, 0xffff0000, v66
    v_lshlrev_b32 v40, 16, v67
    v_and_b32 v41, 0xffff0000, v67
    v_lshlrev_b32 v42, 16, v68
    v_and_b32 v43, 0xffff0000, v68
    v_lshlrev_b32 v44, 16, v69
    v_and_b32 v45, 0xffff0000, v69
    v_lshlrev_b32 v46, 16, v70
    v_and_b32 v47, 0xffff0000, v70
    v_lshlrev_b32 v48, 16, v71
    v_and_b32 v49, 0xffff0000, v71
    v_add_f32 v34, v34, v14
    v_add_f32 v35, v35, v14
    v_add_f32 v36, v36, v14
    v_add_f32 v37, v37, v14
    v_add_f32 v38, v38, v14
    v_add_f32 v39, v39, v14
    v_add_f32 v40, v40, v14
    v_add_f32 v41, v41, v14
    v_add_f32 v42, v42, v14
    v_add_f32 v43, v43, v14
    v_add_f32 v44, v44, v14
    v_add_f32 v45, v45, v14
    v_add_f32 v46, v46, v14
    v_add_f32 v47, v47, v14
    v_add_f32 v48, v48, v14
    v_add_f32 v49, v49, v14
    v_cvt_pk_bf16_f32 v64, v34, v35
    v_cvt_pk_bf16_f32 v65, v36, v37
    v_cvt_pk_bf16_f32 v66, v38, v39
    v_cvt_pk_bf16_f32 v67, v40, v41
    v_cvt_pk_bf16_f32 v68, v42, v43
    v_cvt_pk_bf16_f32 v69, v44, v45
    v_cvt_pk_bf16_f32 v70, v46, v47
    v_cvt_pk_bf16_f32 v71, v48, v49
    v_lshlrev_b32 v34, 16, v64
    v_and_b32 v35, 0xffff0000, v64
    v_lshlrev_b32 v36, 16, v65
    v_and_b32 v37, 0xffff0000, v65
    v_lshlrev_b32 v38, 16, v66
    v_and_b32 v39, 0xffff0000, v66
    v_lshlrev_b32 v40, 16, v67
    v_and_b32 v41, 0xffff0000, v67
    v_lshlrev_b32 v42, 16, v68
    v_and_b32 v43, 0xffff0000, v68
    v_lshlrev_b32 v44, 16, v69
    v_and_b32 v45, 0xffff0000, v69
    v_lshlrev_b32 v46, 16, v70
    v_and_b32 v47, 0xffff0000, v70
    v_lshlrev_b32 v48, 16, v71
    v_and_b32 v49, 0xffff0000, v71
    v_mul_f32 v34, v34, v15
    v_mul_f32 v35, v35, v15
    v_mul_f32 v36, v36, v15
    v_mul_f32 v37, v37, v15
    v_mul_f32 v38, v38, v15
    v_mul_f32 v39, v39, v15
    v_mul_f32 v40, v40, v15
    v_mul_f32 v41, v41, v15
    v_mul_f32 v42, v42, v15
    v_mul_f32 v43, v43, v15
    v_mul_f32 v44, v44, v15
    v_mul_f32 v45, v45, v15
    v_mul_f32 v46, v46, v15
    v_mul_f32 v47, v47, v15
    v_mul_f32 v48, v48, v15
    v_mul_f32 v49, v49, v15
    v_cvt_pk_bf16_f32 v64, v34, v35
    v_cvt_pk_bf16_f32 v65, v36, v37
    v_cvt_pk_bf16_f32 v66, v38, v39
    v_cvt_pk_bf16_f32 v67, v40, v41
    v_cvt_pk_bf16_f32 v68, v42, v43
    v_cvt_pk_bf16_f32 v69, v44, v45
    v_cvt_pk_bf16_f32 v70, v46, v47
    v_cvt_pk_bf16_f32 v71, v48, v49
    s_waitcnt vmcnt(0)
    v_perm_b32 v136, v76, v72, s52
    v_perm_b32 v137, v84, v80, s52
    v_perm_b32 v138, v92, v88, s52
    v_perm_b32 v139, v100, v96, s52
    s_nop 1
    v_mfma_f32_16x16x32_bf16 v[32:35], v[64:67], v[136:139], 0
    v_perm_b32 v140, v76, v72, s53
    v_perm_b32 v141, v84, v80, s53
    v_perm_b32 v142, v92, v88, s53
    v_perm_b32 v143, v100, v96, s53
    s_nop 1
    v_mfma_f32_16x16x32_bf16 v[36:39], v[64:67], v[140:143], 0
    v_perm_b32 v136, v77, v73, s52
    v_perm_b32 v137, v85, v81, s52
    v_perm_b32 v138, v93, v89, s52
    v_perm_b32 v139, v101, v97, s52
    s_nop 1
    v_mfma_f32_16x16x32_bf16 v[40:43], v[64:67], v[136:139], 0
    v_perm_b32 v140, v77, v73, s53
    v_perm_b32 v141, v85, v81, s53
    v_perm_b32 v142, v93, v89, s53
    v_perm_b32 v143, v101, v97, s53
    s_nop 1
    v_mfma_f32_16x16x32_bf16 v[44:47], v[64:67], v[140:143], 0
    v_perm_b32 v136, v78, v74, s52
    v_perm_b32 v137, v86, v82, s52
    v_perm_b32 v138, v94, v90, s52
    v_perm_b32 v139, v102, v98, s52
    s_nop 1
    v_mfma_f32_16x16x32_bf16 v[48:51], v[64:67], v[136:139], 0
    v_perm_b32 v140, v78, v74, s53
    v_perm_b32 v141, v86, v82, s53
    v_perm_b32 v142, v94, v90, s53
    v_perm_b32 v143, v102, v98, s53
    s_nop 1
    v_mfma_f32_16x16x32_bf16 v[52:55], v[64:67], v[140:143], 0
    v_perm_b32 v136, v79, v75, s52
    v_perm_b32 v137, v87, v83, s52
    v_perm_b32 v138, v95, v91, s52
    v_perm_b32 v139, v103, v99, s52
    s_nop 1
    v_mfma_f32_16x16x32_bf16 v[56:59], v[64:67], v[136:139], 0
    v_perm_b32 v140, v79, v75, s53
    v_perm_b32 v141, v87, v83, s53
    v_perm_b32 v142, v95, v91, s53
    v_perm_b32 v143, v103, v99, s53
    s_nop 1
    v_mfma_f32_16x16x32_bf16 v[60:63], v[64:67], v[140:143], 0
    s_waitcnt vmcnt(0)
    v_perm_b32 v136, v108, v104, s52
    v_perm_b32 v137, v116, v112, s52
    v_perm_b32 v138, v124, v120, s52
    v_perm_b32 v139, v132, v128, s52
    s_nop 1
    v_mfma_f32_16x16x32_bf16 v[32:35], v[68:71], v[136:139], v[32:35]
    v_perm_b32 v140, v108, v104, s53
    v_perm_b32 v141, v116, v112, s53
    v_perm_b32 v142, v124, v120, s53
    v_perm_b32 v143, v132, v128, s53
    s_nop 1
    v_mfma_f32_16x16x32_bf16 v[36:39], v[68:71], v[140:143], v[36:39]
    v_perm_b32 v136, v109, v105, s52
    v_perm_b32 v137, v117, v113, s52
    v_perm_b32 v138, v125, v121, s52
    v_perm_b32 v139, v133, v129, s52
    s_nop 1
    v_mfma_f32_16x16x32_bf16 v[40:43], v[68:71], v[136:139], v[40:43]
    v_perm_b32 v140, v109, v105, s53
    v_perm_b32 v141, v117, v113, s53
    v_perm_b32 v142, v125, v121, s53
    v_perm_b32 v143, v133, v129, s53
    s_nop 1
    v_mfma_f32_16x16x32_bf16 v[44:47], v[68:71], v[140:143], v[44:47]
    v_perm_b32 v136, v110, v106, s52
    v_perm_b32 v137, v118, v114, s52
    v_perm_b32 v138, v126, v122, s52
    v_perm_b32 v139, v134, v130, s52
    s_nop 1
    v_mfma_f32_16x16x32_bf16 v[48:51], v[68:71], v[136:139], v[48:51]
    v_perm_b32 v140, v110, v106, s53
    v_perm_b32 v141, v118, v114, s53
    v_perm_b32 v142, v126, v122, s53
    v_perm_b32 v143, v134, v130, s53
    s_nop 1
    v_mfma_f32_16x16x32_bf16 v[52:55], v[68:71], v[140:143], v[52:55]
    v_perm_b32 v136, v111, v107, s52
    v_perm_b32 v137, v119, v115, s52
    v_perm_b32 v138, v127, v123, s52
    v_perm_b32 v139, v135, v131, s52
    s_nop 1
    v_mfma_f32_16x16x32_bf16 v[56:59], v[68:71], v[136:139], v[56:59]
    v_perm_b32 v140, v111, v107, s53
    v_perm_b32 v141, v119, v115, s53
    v_perm_b32 v142, v127, v123, s53
    v_perm_b32 v143, v135, v131, s53
    s_nop 1
    v_mfma_f32_16x16x32_bf16 v[60:63], v[68:71], v[140:143], v[60:63]
    s_setprio 3
    s_and_b32 s44, s3, 1
    s_lshl_b32 s44, s44, 12
    s_add_u32 s44, s44, 65536
    v_xor_b32 v4, v7, v5
    v_lshlrev_b32 v4, 4, v4
    v_lshl_add_u32 v4, v5, 8, v4
    v_add_u32 v72, s44, v4
    v_add_u32 v8, 8, v10

    v_xor_b32 v73, 32, v72
    v_xor_b32 v74, 64, v72
    v_xor_b32 v75, 96, v72
    v_xor_b32 v76, 128, v72
    v_xor_b32 v77, 160, v72
    v_xor_b32 v78, 192, v72
    v_xor_b32 v79, 224, v72
    ds_read_b32 v12, v13 offset:32
FW_127:
    s_waitcnt lgkmcnt(0)
    v_cmp_gt_u32 vcc, 2, v12
    s_cbranch_vccz FO_128
    s_sleep 1
    ds_read_b32 v12, v13 offset:32
    s_branch FW_127
FO_128:
    s_add_u32 s45, s78, 0
    buffer_load_dwordx4 v[16:19], v160, s[80:83], s45 offen nt
    s_add_u32 s45, s78, 2048
    buffer_load_dwordx4 v[20:23], v160, s[80:83], s45 offen nt
    s_add_u32 s45, s78, 4096
    buffer_load_dwordx4 v[24:27], v160, s[80:83], s45 offen nt
    s_add_u32 s45, s78, 6144
    buffer_load_dwordx4 v[28:31], v160, s[80:83], s45 offen nt
    s_add_u32 s45, s78, 8192
    buffer_load_dwordx4 v[144:147], v160, s[80:83], s45 offen nt
    s_add_u32 s45, s78, 10240
    buffer_load_dwordx4 v[148:151], v160, s[80:83], s45 offen nt
    s_add_u32 s45, s78, 12288
    buffer_load_dwordx4 v[152:155], v160, s[80:83], s45 offen nt
    s_cmp_lt_u32 s3, 2
    s_cbranch_scc1 F_t1
    ds_read_b32 v12, v13 offset:32
FW_129:
    s_waitcnt lgkmcnt(0)
    v_cmp_gt_u32 vcc, 2, v12
    s_cbranch_vccz FO_130
    s_sleep 1
    ds_read_b32 v12, v13 offset:32
    s_branch FW_129
FO_130:
    s_branch F_t2
F_t1:
    ds_read_b32 v12, v8 offset:64
FW_131:
    s_waitcnt lgkmcnt(0)
    v_cmp_gt_u32 vcc, 1, v12
    s_cbranch_vccz FO_132
    s_sleep 1
    ds_read_b32 v12, v8 offset:64
    s_branch FW_131
FO_132:
    ds_read_b128 v[80:83], v72 offset:0
    ds_read_b128 v[84:87], v73 offset:512
    ds_read_b128 v[88:91], v74 offset:1024
    ds_read_b128 v[92:95], v75 offset:1536
    ds_read_b128 v[96:99], v76 offset:2048
    ds_read_b128 v[100:103], v77 offset:2560
    ds_read_b128 v[104:107], v78 offset:3072
    ds_read_b128 v[108:111], v79 offset:3584
    s_waitcnt lgkmcnt(7)
    v_add_f32 v32, v32, v80
    v_add_f32 v33, v33, v81
    v_add_f32 v34, v34, v82
    v_add_f32 v35, v35, v83
    s_waitcnt lgkmcnt(6)
    v_add_f32 v36, v36, v84
    v_add_f32 v37, v37, v85
    v_add_f32 v38, v38, v86
    v_add_f32 v39, v39, v87
    s_waitcnt lgkmcnt(5)
    v_add_f32 v40, v40, v88
    v_add_f32 v41, v41, v89
    v_add_f32 v42, v42, v90
    v_add_f32 v43, v43, v91
    s_waitcnt lgkmcnt(4)
    v_add_f32 v44, v44, v92
    v_add_f32 v45, v45, v93
    v_add_f32 v46, v46, v94
    v_add_f32 v47, v47, v95
    s_waitcnt lgkmcnt(3)
    v_add_f32 v48, v48, v96
    v_add_f32 v49, v49, v97
    v_add_f32 v50, v50, v98
    v_add_f32 v51, v51, v99
    s_waitcnt lgkmcnt(2)
    v_add_f32 v52, v52, v100
    v_add_f32 v53, v53, v101
    v_add_f32 v54, v54, v102
    v_add_f32 v55, v55, v103
    s_waitcnt lgkmcnt(1)
    v_add_f32 v56, v56, v104
    v_add_f32 v57, v57, v105
    v_add_f32 v58, v58, v106
    v_add_f32 v59, v59, v107
    s_waitcnt lgkmcnt(0)
    v_add_f32 v60, v60, v108
    v_add_f32 v61, v61, v109
    v_add_f32 v62, v62, v110
    v_add_f32 v63, v63, v111
F_t2:
    s_mov_b32 exec_hi, 0
    ds_write_b128 v72, v[32:35] offset:0
    ds_write_b128 v73, v[36:39] offset:512
    ds_write_b128 v74, v[40:43] offset:1024
    ds_write_b128 v75, v[44:47] offset:1536
    ds_write_b128 v76, v[48:51] offset:2048
    ds_write_b128 v77, v[52:55] offset:2560
    ds_write_b128 v78, v[56:59] offset:3072
    ds_write_b128 v79, v[60:63] offset:3584
    s_branch IW_s11
IW_w11:
    s_branch IW_r11
IW_s11:
    s_mov_b64 exec, -1
    v_mov_b32 v4, 1
    s_mov_b64 exec, 1
    ds_write_b32 v10, v4 offset:64
    s_mov_b64 exec, -1
    s_lshl_b32 s44, s3, 2
    v_add_u32 v4, s44, v5
    v_xor_b32 v4, v4, v7
    v_lshlrev_b32 v4, 4, v4
    v_lshl_add_u32 v4, v7, 8, v4
    v_add_u32 v4, 65536, v4
    s_lshl_b32 s44, s3, 10
    s_lshl_b32 s77, s36, 1
    s_add_u32 s77, s77, s37
    s_mul_i32 s77, s77, 114688
    s_lshl_b32 s46, s38, 12
    s_add_u32 s77, s77, s46
    s_add_u32 s77, s77, s44
    s_lshl_b32 s46, s38, 9
    v_mov_b32 v9, 159148
    v_mov_b32 v11, 1

    s_add_u32 s56, s46, 0x829000
    s_add_u32 s56, s72, s56
    s_addc_u32 s57, s73, 0
    ds_read_b32 v12, v13 offset:64
FW_133:
    s_waitcnt lgkmcnt(0)
    v_cmp_gt_u32 vcc, 1, v12
    s_cbranch_vccz FO_134
    ds_read_b32 v12, v13 offset:64
    s_branch FW_133
FO_134:
    ds_read_b128 v[72:75], v4
    ds_read_b128 v[76:79], v4 offset:4096
    s_waitcnt lgkmcnt(0)
    v_add_f32 v72, v72, v76
    v_add_f32 v73, v73, v77
    v_add_f32 v74, v74, v78
    v_add_f32 v75, v75, v79
    buffer_store_dwordx4 v[72:75], v2, s[12:15], s77 offen sc0 sc1
    v_mov_b32 v4, 2
    s_mov_b64 exec, 1
    ds_write_b32 v10, v4 offset:64
    s_mov_b64 exec, -1
    s_waitcnt vmcnt(0)
    s_mov_b64 exec, 1
    ds_add_rtn_u32 v9, v9, v11
    s_waitcnt lgkmcnt(0)
    v_readfirstlane_b32 s44, v9
    s_mov_b64 exec, -1
    s_cmp_lg_u32 s44, 3
    s_cbranch_scc1 F_ad2

    s_mov_b32 s74, 1
    s_atomic_add s74, s[56:57], 0x0
    s_atomic_add s74, s[56:57], 0x80
    s_atomic_add s74, s[56:57], 0x100
    s_atomic_add s74, s[56:57], 0x180
    s_branch F_ad2
F_adown:
    s_add_u32 s45, s78, 0
    buffer_load_dwordx4 v[16:19], v160, s[80:83], s45 offen nt
    s_add_u32 s45, s78, 2048
    buffer_load_dwordx4 v[20:23], v160, s[80:83], s45 offen nt
    s_add_u32 s45, s78, 4096
    buffer_load_dwordx4 v[24:27], v160, s[80:83], s45 offen nt
    s_add_u32 s45, s78, 6144
    buffer_load_dwordx4 v[28:31], v160, s[80:83], s45 offen nt
    s_add_u32 s45, s78, 8192
    buffer_load_dwordx4 v[144:147], v160, s[80:83], s45 offen nt
    s_add_u32 s45, s78, 10240
    buffer_load_dwordx4 v[148:151], v160, s[80:83], s45 offen nt
    s_add_u32 s45, s78, 12288
    buffer_load_dwordx4 v[152:155], v160, s[80:83], s45 offen nt
    v_mov_b32 v4, 2
    s_mov_b64 exec, 1
    ds_write_b32 v10, v4 offset:64
    s_mov_b64 exec, -1
F_ad2:
    s_setprio 3
    v_min_u32 v4, 55, v0
    v_lshlrev_b32 v4, 4, v4
    s_lshl_b32 s38, s47, 5
    s_and_b32 s46, s39, 3
    s_lshr_b32 s44, s47, 7
    s_lshl_b32 s44, s44, 2
    s_add_u32 s44, s44, s46
    s_lshl_b32 s44, s44, 7
    s_add_u32 s45, s47, 111
    s_lshr_b32 s45, s45, 7
    s_lshl_b32 s45, s45, 2
    s_add_u32 s45, s45, s46
    s_lshl_b32 s45, s45, 7
    s_waitcnt lgkmcnt(0)

    s_add_u32 s56, s44, 0x829000
    s_add_u32 s56, s72, s56
    s_addc_u32 s57, s73, 0
    s_add_u32 s58, s45, 0x829000
    s_add_u32 s58, s72, s58
    s_addc_u32 s59, s73, 0
    v_mov_b32 v156, 0
    v_mov_b32 v157, 0
    v_mov_b32 v158, 0
    v_mov_b32 v159, 0
    s_mov_b32 s48, 0xbfb8aa3b
    ds_read_b32 v12, v13 offset:0
FW_135:
    s_waitcnt lgkmcnt(0)
    v_cmp_gt_u32 vcc, 4, v12
    s_cbranch_vccz FO_136
    s_sleep 1
    ds_read_b32 v12, v13 offset:0
    s_branch FW_135
FO_136:
    ds_read_b32 v12, v13 offset:64
FW_137:
    s_waitcnt lgkmcnt(0)
    v_cmp_gt_u32 vcc, 2, v12
    s_cbranch_vccz FO_138
    s_sleep 1
    ds_read_b32 v12, v13 offset:64
    s_branch FW_137
FO_138:
    ds_read_b32 v12, v13 offset:32
FW_139:
    s_waitcnt lgkmcnt(0)
    v_cmp_gt_u32 vcc, 2, v12
    s_cbranch_vccz FO_140
    s_sleep 1
    ds_read_b32 v12, v13 offset:32
    s_branch FW_139
FO_140:
    s_mov_b32 s44, s75
    v_lshlrev_b32 v9, 3, v0
    v_add_u32 v9, s44, v9
    ds_write_b64 v9, v[156:157]
    v_lshrrev_b32 v11, 1, v0
    v_mul_u32_u24 v9, 37, v11
    v_lshrrev_b32 v9, 8, v9
    v_add_u32 v11, v11, v9
    v_lshlrev_b32 v11, 1, v11
    v_and_b32 v9, 1, v0
    v_lshl_add_u32 v11, v9, 8, v11
    v_add_u32 v11, s44, v11
    v_and_b32 v9, 7, v0
    v_lshlrev_b32 v9, 6, v9
    v_lshl_add_u32 v9, v5, 4, v9
    v_add_u32 v9, s44, v9

    s_cmp_lg_u32 s3, 0
    s_cbranch_scc1 F_pp
SP_141:
    s_load_dword s76, s[56:57], 0 glc
    s_waitcnt lgkmcnt(0)
    s_cmp_ge_u32 s76, 8
    s_cbranch_scc1 SD_142
    s_sleep 2
    s_branch SP_141
SD_142:
SP_143:
    s_load_dword s76, s[58:59], 0 glc
    s_waitcnt lgkmcnt(0)
    s_cmp_ge_u32 s76, 8
    s_cbranch_scc1 SD_144
    s_sleep 2
    s_branch SP_143
SD_144:
    v_mov_b32 v12, 3
    s_mov_b64 exec, 1
    ds_write_b32 v10, v12 offset:64
    s_mov_b64 exec, -1
F_pp:
    v_mov_b32 v8, 159104
    ds_read_b32 v12, v8 offset:0
FW_145:
    s_waitcnt lgkmcnt(0)
    v_cmp_gt_u32 vcc, 3, v12
    s_cbranch_vccz FO_146
    s_sleep 1
    ds_read_b32 v12, v8 offset:0
    s_branch FW_145
FO_146:
    s_add_u32 s45, s38, 0
    buffer_load_dwordx4 v[32:35], v4, s[12:15], s45 offen sc0 sc1
    s_add_u32 s45, s38, 114688
    buffer_load_dwordx4 v[36:39], v4, s[12:15], s45 offen sc0 sc1
    s_add_u32 s45, s38, 229376
    buffer_load_dwordx4 v[40:43], v4, s[12:15], s45 offen sc0 sc1
    s_add_u32 s45, s38, 344064
    buffer_load_dwordx4 v[44:47], v4, s[12:15], s45 offen sc0 sc1
    s_add_u32 s45, s38, 458752
    buffer_load_dwordx4 v[48:51], v4, s[12:15], s45 offen sc0 sc1
    s_add_u32 s45, s38, 573440
    buffer_load_dwordx4 v[52:55], v4, s[12:15], s45 offen sc0 sc1
    s_add_u32 s45, s38, 688128
    buffer_load_dwordx4 v[56:59], v4, s[12:15], s45 offen sc0 sc1
    s_add_u32 s45, s38, 802816
    buffer_load_dwordx4 v[60:63], v4, s[12:15], s45 offen sc0 sc1
    s_waitcnt vmcnt(0)
    v_add_f32 v32, v32, v40
    v_add_f32 v48, v48, v56
    v_add_f32 v33, v33, v41
    v_add_f32 v49, v49, v57
    v_add_f32 v34, v34, v42
    v_add_f32 v50, v50, v58
    v_add_f32 v35, v35, v43
    v_add_f32 v51, v51, v59
    v_add_f32 v32, v32, v48
    v_add_f32 v33, v33, v49
    v_add_f32 v34, v34, v50
    v_add_f32 v35, v35, v51
    v_add_f32 v36, v36, v44
    v_add_f32 v52, v52, v60
    v_add_f32 v37, v37, v45
    v_add_f32 v53, v53, v61
    v_add_f32 v38, v38, v46
    v_add_f32 v54, v54, v62
    v_add_f32 v39, v39, v47
    v_add_f32 v55, v55, v63
    v_add_f32 v36, v36, v52
    v_add_f32 v37, v37, v53
    v_add_f32 v38, v38, v54
    v_add_f32 v39, v39, v55
    v_cvt_pk_bf16_f32 v40, v32, v36
    v_cvt_pk_bf16_f32 v41, v33, v37
    v_cvt_pk_bf16_f32 v42, v34, v38
    v_cvt_pk_bf16_f32 v43, v35, v39
    v_lshlrev_b32 v32, 16, v40
    v_and_b32 v36, 0xffff0000, v40
    v_lshlrev_b32 v33, 16, v41
    v_and_b32 v37, 0xffff0000, v41
    v_lshlrev_b32 v34, 16, v42
    v_and_b32 v38, 0xffff0000, v42
    v_lshlrev_b32 v35, 16, v43
    v_and_b32 v39, 0xffff0000, v43
    v_mul_f32 v40, s48, v32
    v_mul_f32 v41, s48, v33
    v_mul_f32 v42, s48, v34
    v_mul_f32 v43, s48, v35
    v_exp_f32 v40, v40
    v_exp_f32 v41, v41
    v_exp_f32 v42, v42
    v_exp_f32 v43, v43
    v_add_f32 v40, 1.0, v40
    v_add_f32 v41, 1.0, v41
    v_add_f32 v42, 1.0, v42
    v_add_f32 v43, 1.0, v43
    v_rcp_f32 v40, v40
    v_rcp_f32 v41, v41
    v_rcp_f32 v42, v42
    v_rcp_f32 v43, v43
    v_mul_f32 v32, v32, v40
    v_mul_f32 v33, v33, v41
    v_mul_f32 v34, v34, v42
    v_mul_f32 v35, v35, v43
    v_cvt_pk_bf16_f32 v32, v32, v32
    v_cvt_pk_bf16_f32 v33, v33, v33
    v_cvt_pk_bf16_f32 v34, v34, v34
    v_cvt_pk_bf16_f32 v35, v35, v35
    v_lshlrev_b32 v32, 16, v32
    v_lshlrev_b32 v33, 16, v33
    v_lshlrev_b32 v34, 16, v34
    v_lshlrev_b32 v35, 16, v35
    v_mul_f32 v32, v32, v36
    v_mul_f32 v33, v33, v37
    v_mul_f32 v34, v34, v38
    v_mul_f32 v35, v35, v39
    v_cvt_pk_bf16_f32 v32, v32, v32
    v_cvt_pk_bf16_f32 v33, v33, v33
    v_cvt_pk_bf16_f32 v34, v34, v34
    v_cvt_pk_bf16_f32 v35, v35, v35
    v_cmp_gt_u32 vcc, 56, v0
    s_nop 0
    s_and_saveexec_b64 s[44:45], vcc
    ds_write_b16 v11, v32 offset:0
    ds_write_b16 v11, v33 offset:64
    ds_write_b16 v11, v34 offset:128
    ds_write_b16 v11, v35 offset:192
    s_mov_b64 exec, s[44:45]
    ds_read_b128 v[64:67], v9
    s_waitcnt lgkmcnt(0)
    v_perm_b32 v136, v20, v16, s52
    v_perm_b32 v137, v28, v24, s52
    v_perm_b32 v138, v148, v144, s52
    v_perm_b32 v139, v156, v152, s52
    s_nop 1
    v_mfma_f32_16x16x32_bf16 v[104:107], v[64:67], v[136:139], 0
    v_perm_b32 v140, v20, v16, s53
    v_perm_b32 v141, v28, v24, s53
    v_perm_b32 v142, v148, v144, s53
    v_perm_b32 v143, v156, v152, s53
    s_nop 1
    v_mfma_f32_16x16x32_bf16 v[108:111], v[64:67], v[140:143], 0
    v_perm_b32 v136, v21, v17, s52
    v_perm_b32 v137, v29, v25, s52
    v_perm_b32 v138, v149, v145, s52
    v_perm_b32 v139, v157, v153, s52
    s_nop 1
    v_mfma_f32_16x16x32_bf16 v[112:115], v[64:67], v[136:139], 0
    v_perm_b32 v140, v21, v17, s53
    v_perm_b32 v141, v29, v25, s53
    v_perm_b32 v142, v149, v145, s53
    v_perm_b32 v143, v157, v153, s53
    s_nop 1
    v_mfma_f32_16x16x32_bf16 v[116:119], v[64:67], v[140:143], 0
    v_perm_b32 v136, v22, v18, s52
    v_perm_b32 v137, v30, v26, s52
    v_perm_b32 v138, v150, v146, s52
    v_perm_b32 v139, v158, v154, s52
    s_nop 1
    v_mfma_f32_16x16x32_bf16 v[120:123], v[64:67], v[136:139], 0
    v_perm_b32 v140, v22, v18, s53
    v_perm_b32 v141, v30, v26, s53
    v_perm_b32 v142, v150, v146, s53
    v_perm_b32 v143, v158, v154, s53
    s_nop 1
    v_mfma_f32_16x16x32_bf16 v[124:127], v[64:67], v[140:143], 0
    v_perm_b32 v136, v23, v19, s52
    v_perm_b32 v137, v31, v27, s52
    v_perm_b32 v138, v151, v147, s52
    v_perm_b32 v139, v159, v155, s52
    s_nop 1
    v_mfma_f32_16x16x32_bf16 v[128:131], v[64:67], v[136:139], 0
    v_perm_b32 v140, v23, v19, s53
    v_perm_b32 v141, v31, v27, s53
    v_perm_b32 v142, v151, v147, s53
    v_perm_b32 v143, v159, v155, s53
    s_nop 1
    v_mfma_f32_16x16x32_bf16 v[132:135], v[64:67], v[140:143], 0
    s_mov_b32 s44, s75
    v_and_b32 v4, 1, v5
    v_lshlrev_b32 v4, 11, v4
    v_lshl_add_u32 v4, v7, 5, v4
    v_lshrrev_b32 v8, 1, v5
    v_lshl_add_u32 v4, v8, 4, v4
    v_add_u32 v4, s44, v4
    v_cmp_gt_u32 vcc, 32, v0

    s_nop 1
    v_cndmask_b32 v72, v120, v104, vcc
    v_cndmask_b32 v73, v124, v108, vcc
    v_cndmask_b32 v74, v128, v112, vcc
    v_cndmask_b32 v75, v132, v116, vcc
    ds_write_b128 v4, v[72:75] offset:0
    v_cndmask_b32 v76, v121, v105, vcc
    v_cndmask_b32 v77, v125, v109, vcc
    v_cndmask_b32 v78, v129, v113, vcc
    v_cndmask_b32 v79, v133, v117, vcc
    ds_write_b128 v4, v[76:79] offset:512
    v_cndmask_b32 v80, v122, v106, vcc
    v_cndmask_b32 v81, v126, v110, vcc
    v_cndmask_b32 v82, v130, v114, vcc
    v_cndmask_b32 v83, v134, v118, vcc
    ds_write_b128 v4, v[80:83] offset:1024
    v_cndmask_b32 v84, v123, v107, vcc
    v_cndmask_b32 v85, v127, v111, vcc
    v_cndmask_b32 v86, v131, v115, vcc
    v_cndmask_b32 v87, v135, v119, vcc
    ds_write_b128 v4, v[84:87] offset:1536
    v_mov_b32 v4, 1
    s_mov_b64 exec, 1
    ds_write_b32 v10, v4 offset:80
    s_mov_b64 exec, -1
    ds_read_b32 v12, v13 offset:80
FW_147:
    s_waitcnt lgkmcnt(0)
    v_cmp_gt_u32 vcc, 1, v12
    s_cbranch_vccz FO_148
    s_sleep 1
    ds_read_b32 v12, v13 offset:80
    s_branch FW_147
FO_148:
    s_lshl_b32 s44, s3, 10
    s_add_u32 s44, s44, 32768
    v_add_u32 v4, s44, v3
    ds_read_b32 v32, v4 offset:0
    ds_read_b32 v33, v4 offset:256
    ds_read_b32 v34, v4 offset:512
    ds_read_b32 v35, v4 offset:768
    ds_read_b32 v36, v4 offset:4096
    ds_read_b32 v37, v4 offset:4352
    ds_read_b32 v38, v4 offset:4608
    ds_read_b32 v39, v4 offset:4864
    ds_read_b32 v40, v4 offset:32768
    ds_read_b32 v41, v4 offset:33024
    ds_read_b32 v42, v4 offset:33280
    ds_read_b32 v43, v4 offset:33536
    ds_read_b32 v44, v4 offset:36864
    ds_read_b32 v45, v4 offset:37120
    ds_read_b32 v46, v4 offset:37376
    s_waitcnt lgkmcnt(8)
    ds_read_b32 v47, v4 offset:37632
    s_lshl_b32 s44, s3, 13
    s_lshl_b32 s45, s39, 9
    s_add_u32 s44, s44, s45
    s_add_u32 s44, s44, 135168
    s_add_u32 s45, s44, 4096
    s_lshl_b32 s46, s39, 9
    s_waitcnt lgkmcnt(0)

    s_add_u32 s56, s46, 0x845000
    s_add_u32 s56, s72, s56
    s_addc_u32 s57, s73, 0
    v_add_f32 v32, v32, v36
    v_add_f32 v40, v40, v44
    v_add_f32 v33, v33, v37
    v_add_f32 v41, v41, v45
    v_add_f32 v34, v34, v38
    v_add_f32 v42, v42, v46
    v_add_f32 v35, v35, v39
    v_add_f32 v43, v43, v47
    v_add_f32 v32, v32, v40
    buffer_atomic_add_f32 v32, v3, s[24:27], s44 offen offset:0
    v_add_f32 v33, v33, v41
    buffer_atomic_add_f32 v33, v3, s[24:27], s44 offen offset:256
    v_add_f32 v34, v34, v42
    buffer_atomic_add_f32 v34, v3, s[24:27], s45 offen offset:0
    v_add_f32 v35, v35, v43
    buffer_atomic_add_f32 v35, v3, s[24:27], s45 offen offset:256
    v_mov_b32 v4, 159140
    v_mov_b32 v8, 1
    s_waitcnt vmcnt(0)
    s_mov_b64 exec, 1
    ds_add_rtn_u32 v9, v4, v8
    s_waitcnt lgkmcnt(0)
    v_readfirstlane_b32 s44, v9
    s_mov_b64 exec, -1
    s_cmp_lg_u32 s44, 3
    s_cbranch_scc1 F_ye
    s_mov_b32 s44, 1
    s_atomic_add s44, s[56:57], 0
    s_atomic_add s44, s[56:57], 0x80
    s_atomic_add s44, s[56:57], 0x100
    s_atomic_add s44, s[56:57], 0x180
F_ye:

    s_endpgm
F_codeend:
.section .rodata,"a"
.p2align 6
.amdhsa_kernel parallel_sum__linear_attn_block__moe_arch_mod__prompt_kernel
  .amdhsa_next_free_vgpr 168
  .amdhsa_next_free_sgpr 98
  .amdhsa_accum_offset 168
  .amdhsa_group_segment_fixed_size 0
  .amdhsa_kernarg_size 88
  .amdhsa_user_sgpr_count 2
  .amdhsa_user_sgpr_kernarg_segment_ptr 1
  .amdhsa_system_sgpr_workgroup_id_x 1
  .amdhsa_float_denorm_mode_32 3
  .amdhsa_float_denorm_mode_16_64 3
.end_amdhsa_kernel
```

```asm
; @launch grid=(256,1,1) block=(768,1,1) lds=163840
.amdgcn_target "amdgcn-amd-amdhsa--gfx950"
.text
.globl parallel_sum__linear_attn_block__moe_arch_mod__prompt_kernel
.p2align 12
.p2align 8
.type parallel_sum__linear_attn_block__moe_arch_mod__prompt_kernel,@function
parallel_sum__linear_attn_block__moe_arch_mod__prompt_kernel:
    s_load_dwordx4 s[4:7], s[0:1], 0
    s_load_dwordx2 s[8:9], s[0:1], 16
    s_load_dwordx8 s[60:67], s[0:1], 32
    s_load_dwordx4 s[68:71], s[0:1], 64
    s_load_dwordx2 s[72:73], s[0:1], 80
    s_cmp_ge_u32 s2, 256
    s_cbranch_scc1 F_end
    v_lshrrev_b32 v1, 6, v0
    v_and_b32 v0, 63, v0
    s_and_b32 s30, s2, 7
    v_readfirstlane_b32 s3, v1
    s_lshr_b32 s31, s2, 3
    s_and_b32 s36, s30, 1
    s_lshl_b32 s32, s36, 3
    s_and_b32 s35, s31, 7
    s_add_u32 s32, s32, s35
    s_lshr_b32 s37, s30, 1
    s_lshl_b32 s33, s37, 2
    s_lshr_b32 s34, s31, 3
    s_add_u32 s33, s33, s34
    s_add_u32 s10, s33, 0
    s_and_b32 s10, s10, 15
    s_add_u32 s11, s35, s34
    s_and_b32 s11, s11, 3
    s_and_b32 s28, s32, 11
    s_and_b32 s29, s37, 1
    s_lshl_b32 s29, s29, 2
    s_add_u32 s28, s28, s29
    s_lshr_b32 s29, s37, 1
    s_lshl_b32 s29, s29, 3
    s_and_b32 s38, s35, 4
    s_add_u32 s29, s29, s38
    s_add_u32 s38, s34, 1
    s_and_b32 s38, s38, 3
    s_add_u32 s29, s29, s38

    s_lshl_b32 s11, s34, 1
    s_add_u32 s11, s11, s35
    s_and_b32 s11, s11, 7
    s_mul_i32 s89, s36, 8
    s_mul_i32 s38, s37, 2
    s_add_u32 s89, s89, s38

    s_mov_b32 s94, 0x73156420
    s_mov_b32 s95, 0xfb9dea8c
    s_cmp_eq_u32 s11, 1
    s_cselect_b32 s94, 0x62047531, s94
    s_cselect_b32 s95, 0xea8cfb9d, s95
    s_cmp_eq_u32 s11, 2
    s_cselect_b32 s94, 0x53710642, s94
    s_cselect_b32 s95, 0xdbf9cae8, s95
    s_cmp_eq_u32 s11, 3
    s_cselect_b32 s94, 0x42601753, s94
    s_cselect_b32 s95, 0xcae8dbf9, s95
    s_cmp_eq_u32 s11, 4
    s_cselect_b32 s94, 0x58320164, s94
    s_cselect_b32 s95, 0xfdbec9a7, s95
    s_cmp_eq_u32 s11, 5
    s_cselect_b32 s94, 0x49231075, s94
    s_cselect_b32 s95, 0xecafd8b6, s95
    s_cmp_eq_u32 s11, 6
    s_cselect_b32 s94, 0xa5143206, s94
    s_cselect_b32 s95, 0xfd9ebc87, s95
    s_cmp_eq_u32 s11, 7
    s_cselect_b32 s94, 0xb4052317, s94
    s_cselect_b32 s95, 0xec8fad96, s95
    s_cmp_ge_u32 s3, 8
    s_cbranch_scc1 F_aux
    s_cmp_ge_u32 s3, 4
    s_cbranch_scc1 F_nl
    v_lshrrev_b32 v2, 3, v0
    v_and_b32 v3, 7, v0
    v_lshrrev_b32 v4, 1, v2
    v_xor_b32 v5, v3, v4
    v_xor_b32 v6, 4, v5
    v_lshlrev_b32 v5, 4, v5
    v_lshlrev_b32 v6, 4, v6
    v_lshlrev_b32 v7, 11, v2
    v_add_u32 v5, v5, v7
    v_add_u32 v6, v6, v7
    v_and_b32 v4, 1, v4
    v_lshlrev_b32 v4, 1, v4
    v_xor_b32 v8, v3, v4
    v_xor_b32 v9, 4, v8
    v_lshlrev_b32 v8, 4, v8
    v_lshlrev_b32 v9, 4, v9
    v_mul_u32_u24 v7, 6144, v2
    v_add_u32 v8, v8, v7
    v_add_u32 v9, v9, v7
    v_add_u32 v9, 49152, v9
    s_lshl_b32 s36, s32, 18
    s_lshl_b32 s37, s3, 16
    s_add_u32 s36, s36, s37
    s_lshl_b32 s38, s33, 7
    s_mul_i32 s37, s3, 98304
    s_add_u32 s38, s38, s37
    s_lshl_b32 s47, s10, 7
    s_add_u32 s47, s47, s37
    s_lshl_b32 s44, s3, 12
    s_lshl_b32 s45, s3, 11
    s_add_u32 s43, s45, 1024
    s_mov_b32 s14, 4194304
    s_mov_b32 s15, 0x20000
    s_mov_b32 s18, 6291456
    s_mov_b32 s19, 0x20000
    s_waitcnt lgkmcnt(0)
    s_mov_b32 s12, s4
    s_mov_b32 s13, s5
    s_mov_b32 s16, s6
    s_mov_b32 s17, s7

    s_setprio 3
    s_bfe_u32 s40, s94, 0x40000
    s_add_u32 s40, s89, s40
    s_and_b32 s40, s40, 15
    s_mul_i32 s41, s40, 393216
    s_lshl_b32 s40, s40, 7
    s_add_u32 s40, s40, s36
    s_add_u32 s42, s41, s47
    s_add_u32 s41, s41, s38
    s_add_u32 m0, s44, 0
    s_add_u32 s46, s40, 0
    buffer_load_dwordx4 v5, s[12:15], s46 offen lds
    s_add_u32 m0, s44, 1024
    s_add_u32 s46, s40, 16384
    buffer_load_dwordx4 v6, s[12:15], s46 offen lds
    s_add_u32 m0, s44, 2048
    s_add_u32 s46, s40, 32768
    buffer_load_dwordx4 v5, s[12:15], s46 offen lds
    s_add_u32 m0, s44, 3072
    s_add_u32 s46, s40, 49152
    buffer_load_dwordx4 v6, s[12:15], s46 offen lds
    s_add_u32 m0, s45, 65536
    s_add_u32 s46, s41, 2048
    buffer_load_dwordx4 v8, s[16:19], s46 offen lds
    s_add_u32 m0, s43, 65536
    s_add_u32 s46, s41, 2048
    buffer_load_dwordx4 v9, s[16:19], s46 offen lds
    s_add_u32 m0, s45, 73728
    s_add_u32 s46, s41, 4096
    buffer_load_dwordx4 v8, s[16:19], s46 offen lds
    s_add_u32 m0, s43, 73728
    s_add_u32 s46, s41, 4096
    buffer_load_dwordx4 v9, s[16:19], s46 offen lds
    s_add_u32 m0, s45, 147456
    s_nop 0
    buffer_load_dwordx4 v8, s[16:19], s42 offen lds
    s_add_u32 m0, s43, 147456
    s_nop 0
    buffer_load_dwordx4 v9, s[16:19], s42 offen lds
    s_bfe_u32 s40, s94, 0x40004
    s_add_u32 s40, s89, s40
    s_and_b32 s40, s40, 15
    s_mul_i32 s41, s40, 393216
    s_lshl_b32 s40, s40, 7
    s_add_u32 s40, s40, s36
    s_add_u32 s42, s41, s47
    s_add_u32 s41, s41, s38
    s_add_u32 m0, s44, 16384
    s_add_u32 s46, s40, 0
    buffer_load_dwordx4 v5, s[12:15], s46 offen lds
    s_add_u32 m0, s44, 17408
    s_add_u32 s46, s40, 16384
    buffer_load_dwordx4 v6, s[12:15], s46 offen lds
    s_add_u32 m0, s44, 18432
    s_add_u32 s46, s40, 32768
    buffer_load_dwordx4 v5, s[12:15], s46 offen lds
    s_add_u32 m0, s44, 19456
    s_add_u32 s46, s40, 49152
    buffer_load_dwordx4 v6, s[12:15], s46 offen lds
    s_add_u32 m0, s45, 81920
    s_add_u32 s46, s41, 2048
    buffer_load_dwordx4 v8, s[16:19], s46 offen lds
    s_add_u32 m0, s43, 81920
    s_add_u32 s46, s41, 2048
    buffer_load_dwordx4 v9, s[16:19], s46 offen lds
    v_and_b32 v1, 15, v0
    v_lshrrev_b32 v7, 4, v0
    v_lshrrev_b32 v3, 1, v1
    v_xor_b32 v3, v3, v7
    v_lshlrev_b32 v3, 4, v3
    v_lshlrev_b32 v1, 7, v1
    v_add3_u32 v2, v1, v3, s44
    v_xor_b32 v3, 64, v2
    v_add_u32 v14, 0x10000, v2
    v_add_u32 v15, 0x10000, v3
    v_bfe_u32 v1, v0, 2, 2
    v_lshl_add_u32 v4, v7, 3, v1
    v_lshrrev_b32 v1, 1, v1
    v_and_b32 v7, 1, v7
    v_lshl_add_u32 v1, v7, 1, v1
    v_lshlrev_b32 v1, 5, v1
    v_lshl_add_u32 v1, v4, 7, v1
    v_and_b32 v7, 3, v0
    v_lshl_add_u32 v1, v7, 3, v1
    v_add_u32 v10, 90112, v1
    v_xor_b32 v11, 32, v10
    v_xor_b32 v12, 64, v10
    v_xor_b32 v13, 96, v10
    v_lshlrev_b32 v1, 2, v7
    v_add_u32 v1, 159040, v1
    s_lshl_b32 s50, s3, 2
    s_add_u32 s50, s50, 159040
    v_mov_b32 v4, s50
    v_mov_b32 v164, 1

    s_waitcnt vmcnt(8)
    s_barrier
    s_add_u32 m0, s45, 90112
    s_add_u32 s46, s41, 4096
    buffer_load_dwordx4 v8, s[16:19], s46 offen lds
    ds_read_b128 v[48:51], v2 offset:0
    s_add_u32 m0, s43, 90112
    s_add_u32 s46, s41, 4096
    buffer_load_dwordx4 v9, s[16:19], s46 offen lds
    ds_read_b128 v[52:55], v2 offset:2048
    s_lshl_b32 s51, s32, 4
    s_add_u32 s51, s51, s33
    s_lshl_b32 s51, s51, 14
    s_add_u32 s51, s51, s45
    v_lshlrev_b32 v165, 4, v0
    s_mov_b32 s20, s60
    s_mov_b32 s21, s61
    s_mov_b32 s22, 0x800
    s_mov_b32 s23, 0x00020000
    s_add_u32 m0, s45, 98304
    s_add_u32 s46, s51, 0
    buffer_load_dwordx4 v165, s[12:15], s46 offen lds
    ds_read_b128 v[56:59], v3 offset:0
    s_add_u32 m0, s45, 99328
    s_add_u32 s46, s51, 1024
    buffer_load_dwordx4 v165, s[12:15], s46 offen lds
    ds_read_b128 v[60:63], v3 offset:2048
    s_and_b32 s46, s3, 1
    s_lshl_b32 s46, s46, 10
    s_add_u32 m0, s46, 161792
    s_nop 0
    buffer_load_dwordx4 v165, s[20:23], s46 offen lds
    s_add_u32 m0, s45, 106496
    s_add_u32 s46, s51, 8192
    buffer_load_dwordx4 v165, s[12:15], s46 offen lds
    s_add_u32 m0, s45, 107520
    s_add_u32 s46, s51, 9216
    buffer_load_dwordx4 v165, s[12:15], s46 offen lds
    s_bfe_u32 s40, s94, 0x40008
    s_add_u32 s40, s89, s40
    s_and_b32 s40, s40, 15
    s_mul_i32 s41, s40, 393216
    s_lshl_b32 s40, s40, 7
    s_add_u32 s40, s40, s36
    s_add_u32 s42, s41, s47
    s_add_u32 s41, s41, s38
    s_add_u32 m0, s44, 32768
    s_add_u32 s46, s40, 0
    buffer_load_dwordx4 v5, s[12:15], s46 offen lds
    s_add_u32 m0, s44, 33792
    s_add_u32 s46, s40, 16384
    buffer_load_dwordx4 v6, s[12:15], s46 offen lds
    s_add_u32 m0, s44, 34816
    s_add_u32 s46, s40, 32768
    buffer_load_dwordx4 v5, s[12:15], s46 offen lds
    s_add_u32 m0, s44, 35840
    s_add_u32 s46, s40, 49152
    buffer_load_dwordx4 v6, s[12:15], s46 offen lds
    s_waitcnt vmcnt(9) lgkmcnt(0)
    s_barrier
    s_add_u32 m0, s45, 114688
    s_add_u32 s46, s41, 2048
    buffer_load_dwordx4 v8, s[16:19], s46 offen lds
    ds_read_b64_tr_b16 v[64:65], v10 offset:57344
    ds_read_b64_tr_b16 v[66:67], v10 offset:57856
    s_add_u32 m0, s43, 114688
    s_add_u32 s46, s41, 2048
    buffer_load_dwordx4 v9, s[16:19], s46 offen lds
    ds_read_b128 v[68:71], v2 offset:16384
    s_add_u32 m0, s45, 122880
    s_add_u32 s46, s41, 4096
    buffer_load_dwordx4 v8, s[16:19], s46 offen lds
    ds_read_b64_tr_b16 v[72:73], v11 offset:57344
    ds_read_b64_tr_b16 v[74:75], v11 offset:57856
    s_add_u32 m0, s43, 122880
    s_add_u32 s46, s41, 4096
    buffer_load_dwordx4 v9, s[16:19], s46 offen lds
    ds_read_b128 v[76:79], v2 offset:18432
    s_bfe_u32 s40, s94, 0x40004
    s_add_u32 s40, s89, s40
    s_and_b32 s40, s40, 15
    s_mul_i32 s41, s40, 393216
    s_lshl_b32 s40, s40, 7
    s_add_u32 s40, s40, s36
    s_add_u32 s42, s41, s47
    s_add_u32 s41, s41, s38
    s_add_u32 m0, s45, 139264
    s_nop 0
    buffer_load_dwordx4 v8, s[16:19], s42 offen lds
    ds_read_b64_tr_b16 v[80:81], v12 offset:57344
    ds_read_b64_tr_b16 v[82:83], v12 offset:57856
    s_add_u32 m0, s43, 139264
    s_nop 0
    buffer_load_dwordx4 v9, s[16:19], s42 offen lds
    ds_read_b128 v[84:87], v3 offset:16384
    s_bfe_u32 s40, s94, 0x4000c
    s_add_u32 s40, s89, s40
    s_and_b32 s40, s40, 15
    s_mul_i32 s41, s40, 393216
    s_lshl_b32 s40, s40, 7
    s_add_u32 s40, s40, s36
    s_add_u32 s42, s41, s47
    s_add_u32 s41, s41, s38
    s_add_u32 m0, s44, 49152
    s_add_u32 s46, s40, 0
    buffer_load_dwordx4 v5, s[12:15], s46 offen lds
    ds_read_b64_tr_b16 v[88:89], v13 offset:57344
    ds_read_b64_tr_b16 v[90:91], v13 offset:57856
    s_add_u32 m0, s44, 50176
    s_add_u32 s46, s40, 16384
    buffer_load_dwordx4 v6, s[12:15], s46 offen lds
    ds_read_b128 v[92:95], v3 offset:18432
    s_add_u32 m0, s44, 51200
    s_add_u32 s46, s40, 32768
    buffer_load_dwordx4 v5, s[12:15], s46 offen lds
    s_add_u32 m0, s44, 52224
    s_add_u32 s46, s40, 49152
    buffer_load_dwordx4 v6, s[12:15], s46 offen lds
    s_add_u32 m0, s45, 131072
    s_add_u32 s46, s41, 2048
    buffer_load_dwordx4 v8, s[16:19], s46 offen lds
    s_waitcnt vmcnt(5) lgkmcnt(0)
    s_barrier
    s_add_u32 m0, s43, 131072
    s_add_u32 s46, s41, 2048
    buffer_load_dwordx4 v9, s[16:19], s46 offen lds
    v_mfma_f32_16x16x32_bf16 v[16:19], v[64:67], v[48:51], 0
    ds_read_b64_tr_b16 v[96:97], v10 offset:61440
    ds_read_b64_tr_b16 v[98:99], v10 offset:61952
    s_add_u32 m0, s45, 65536
    s_add_u32 s46, s41, 4096
    buffer_load_dwordx4 v8, s[16:19], s46 offen lds
    v_mfma_f32_16x16x32_bf16 v[32:35], v[64:67], v[52:55], 0
    ds_read_b128 v[100:103], v2 offset:32768
    s_add_u32 m0, s43, 65536
    s_add_u32 s46, s41, 4096
    buffer_load_dwordx4 v9, s[16:19], s46 offen lds
    v_mfma_f32_16x16x32_bf16 v[20:23], v[72:75], v[48:51], 0
    ds_read_b64_tr_b16 v[104:105], v11 offset:61440
    ds_read_b64_tr_b16 v[106:107], v11 offset:61952
    s_bfe_u32 s40, s94, 0x40008
    s_add_u32 s40, s89, s40
    s_and_b32 s40, s40, 15
    s_mul_i32 s41, s40, 393216
    s_lshl_b32 s40, s40, 7
    s_add_u32 s40, s40, s36
    s_add_u32 s42, s41, s47
    s_add_u32 s41, s41, s38
    s_add_u32 m0, s45, 90112
    s_nop 0
    buffer_load_dwordx4 v8, s[16:19], s42 offen lds
    v_mfma_f32_16x16x32_bf16 v[36:39], v[72:75], v[52:55], 0
    ds_read_b128 v[108:111], v2 offset:34816
    s_add_u32 m0, s43, 90112
    s_nop 0
    buffer_load_dwordx4 v9, s[16:19], s42 offen lds
    v_mfma_f32_16x16x32_bf16 v[24:27], v[80:83], v[48:51], 0
    ds_read_b64_tr_b16 v[112:113], v12 offset:61440
    ds_read_b64_tr_b16 v[114:115], v12 offset:61952
    s_bfe_u32 s40, s94, 0x40010
    s_add_u32 s40, s89, s40
    s_and_b32 s40, s40, 15
    s_mul_i32 s41, s40, 393216
    s_lshl_b32 s40, s40, 7
    s_add_u32 s40, s40, s36
    s_add_u32 s42, s41, s47
    s_add_u32 s41, s41, s38
    s_add_u32 m0, s44, 0
    s_add_u32 s46, s40, 0
    buffer_load_dwordx4 v5, s[12:15], s46 offen lds
    v_mfma_f32_16x16x32_bf16 v[40:43], v[80:83], v[52:55], 0
    ds_read_b128 v[116:119], v3 offset:32768
    s_add_u32 m0, s44, 1024
    s_add_u32 s46, s40, 16384
    buffer_load_dwordx4 v6, s[12:15], s46 offen lds
    v_mfma_f32_16x16x32_bf16 v[28:31], v[88:91], v[48:51], 0
    ds_read_b64_tr_b16 v[120:121], v13 offset:61440
    ds_read_b64_tr_b16 v[122:123], v13 offset:61952
    s_add_u32 m0, s44, 2048
    s_add_u32 s46, s40, 32768
    buffer_load_dwordx4 v5, s[12:15], s46 offen lds
    v_mfma_f32_16x16x32_bf16 v[44:47], v[88:91], v[52:55], 0
    ds_read_b128 v[124:127], v3 offset:34816
    s_add_u32 m0, s44, 3072
    s_add_u32 s46, s40, 49152
    buffer_load_dwordx4 v6, s[12:15], s46 offen lds
    ds_read_b64_tr_b16 v[128:129], v10 offset:49152
    ds_read_b64_tr_b16 v[130:131], v10 offset:49664
    s_add_u32 m0, s45, 73728
    s_add_u32 s46, s41, 2048
    buffer_load_dwordx4 v8, s[16:19], s46 offen lds
    ds_read_b64_tr_b16 v[132:133], v11 offset:49152
    s_waitcnt lgkmcnt(8)
    ds_read_b64_tr_b16 v[134:135], v11 offset:49664
    s_add_u32 m0, s43, 73728
    s_add_u32 s46, s41, 2048
    buffer_load_dwordx4 v9, s[16:19], s46 offen lds
    ds_read_b64_tr_b16 v[136:137], v12 offset:49152
    ds_read_b64_tr_b16 v[138:139], v12 offset:49664
    ds_read_b64_tr_b16 v[140:141], v13 offset:49152
    ds_read_b64_tr_b16 v[142:143], v13 offset:49664
    s_waitcnt vmcnt(6) lgkmcnt(0)
    s_barrier
    s_add_u32 m0, s45, 81920
    s_add_u32 s46, s41, 4096
    buffer_load_dwordx4 v8, s[16:19], s46 offen lds
    v_mfma_f32_16x16x32_bf16 v[16:19], v[96:99], v[56:59], v[16:19]
    ds_read_b64_tr_b16 v[144:145], v10 offset:53248
    ds_read_b64_tr_b16 v[146:147], v10 offset:53760
    s_add_u32 m0, s43, 81920
    s_add_u32 s46, s41, 4096
    buffer_load_dwordx4 v9, s[16:19], s46 offen lds
    v_mfma_f32_16x16x32_bf16 v[32:35], v[96:99], v[60:63], v[32:35]
    ds_read_b128 v[148:151], v2 offset:49152
    s_bfe_u32 s40, s94, 0x40014
    s_add_u32 s40, s89, s40
    s_and_b32 s40, s40, 15
    s_mul_i32 s41, s40, 393216
    s_lshl_b32 s40, s40, 7
    s_add_u32 s40, s40, s36
    s_add_u32 s42, s41, s47
    s_add_u32 s41, s41, s38
    s_add_u32 m0, s44, 16384
    s_add_u32 s46, s40, 0
    buffer_load_dwordx4 v5, s[12:15], s46 offen lds
    v_mfma_f32_16x16x32_bf16 v[20:23], v[104:107], v[56:59], v[20:23]
    ds_read_b64_tr_b16 v[152:153], v11 offset:53248
    ds_read_b64_tr_b16 v[154:155], v11 offset:53760
    s_add_u32 m0, s44, 17408
    s_add_u32 s46, s40, 16384
    buffer_load_dwordx4 v6, s[12:15], s46 offen lds
    v_mfma_f32_16x16x32_bf16 v[36:39], v[104:107], v[60:63], v[36:39]
    ds_read_b128 v[156:159], v2 offset:51200
    s_add_u32 m0, s44, 18432
    s_add_u32 s46, s40, 32768
    buffer_load_dwordx4 v5, s[12:15], s46 offen lds
    v_mfma_f32_16x16x32_bf16 v[24:27], v[112:115], v[56:59], v[24:27]
    ds_read_b64_tr_b16 v[160:161], v12 offset:53248
    ds_read_b64_tr_b16 v[162:163], v12 offset:53760
    s_add_u32 m0, s44, 19456
    s_add_u32 s46, s40, 49152
    buffer_load_dwordx4 v6, s[12:15], s46 offen lds
    v_mfma_f32_16x16x32_bf16 v[40:43], v[112:115], v[60:63], v[40:43]
    ds_read_b128 v[64:67], v3 offset:49152
    s_add_u32 m0, s45, 98304
    s_add_u32 s46, s41, 2048
    buffer_load_dwordx4 v8, s[16:19], s46 offen lds
    v_mfma_f32_16x16x32_bf16 v[28:31], v[120:123], v[56:59], v[28:31]
    ds_read_b64_tr_b16 v[72:73], v13 offset:53248
    ds_read_b64_tr_b16 v[74:75], v13 offset:53760
    s_add_u32 m0, s43, 98304
    s_add_u32 s46, s41, 2048
    buffer_load_dwordx4 v9, s[16:19], s46 offen lds
    v_mfma_f32_16x16x32_bf16 v[44:47], v[120:123], v[60:63], v[44:47]
    ds_read_b128 v[80:83], v3 offset:51200
    s_add_u32 m0, s45, 106496
    s_add_u32 s46, s41, 4096
    buffer_load_dwordx4 v8, s[16:19], s46 offen lds
    v_mfma_f32_16x16x32_bf16 v[16:19], v[128:131], v[68:71], v[16:19]
    ds_read_b64_tr_b16 v[48:49], v10 offset:0
    ds_read_b64_tr_b16 v[50:51], v10 offset:512
    s_add_u32 m0, s43, 106496
    s_add_u32 s46, s41, 4096
    buffer_load_dwordx4 v9, s[16:19], s46 offen lds
    v_mfma_f32_16x16x32_bf16 v[32:35], v[128:131], v[76:79], v[32:35]
    ds_read_b64_tr_b16 v[88:89], v11 offset:0
    s_waitcnt lgkmcnt(8)
    ds_read_b64_tr_b16 v[90:91], v11 offset:512
    s_bfe_u32 s40, s94, 0x4000c
    s_add_u32 s40, s89, s40
    s_and_b32 s40, s40, 15
    s_mul_i32 s41, s40, 393216
    s_lshl_b32 s40, s40, 7
    s_add_u32 s40, s40, s36
    s_add_u32 s42, s41, s47
    s_add_u32 s41, s41, s38
    s_add_u32 m0, s45, 147456
    s_nop 0
    buffer_load_dwordx4 v8, s[16:19], s42 offen lds
    v_mfma_f32_16x16x32_bf16 v[20:23], v[132:135], v[68:71], v[20:23]
    ds_read_b64_tr_b16 v[52:53], v12 offset:0
    ds_read_b64_tr_b16 v[54:55], v12 offset:512
    v_mfma_f32_16x16x32_bf16 v[36:39], v[132:135], v[76:79], v[36:39]
    ds_read_b64_tr_b16 v[96:97], v13 offset:0
    ds_read_b64_tr_b16 v[98:99], v13 offset:512
    v_mfma_f32_16x16x32_bf16 v[24:27], v[136:139], v[68:71], v[24:27]
    v_mfma_f32_16x16x32_bf16 v[40:43], v[136:139], v[76:79], v[40:43]
    v_mfma_f32_16x16x32_bf16 v[28:31], v[140:143], v[68:71], v[28:31]
    v_mfma_f32_16x16x32_bf16 v[44:47], v[140:143], v[76:79], v[44:47]
    s_waitcnt vmcnt(9) lgkmcnt(0)
    s_barrier
    s_add_u32 m0, s43, 147456
    s_nop 0
    buffer_load_dwordx4 v9, s[16:19], s42 offen lds
    v_mfma_f32_16x16x32_bf16 v[16:19], v[144:147], v[84:87], v[16:19]
    ds_read_b64_tr_b16 v[104:105], v10 offset:4096
    ds_read_b64_tr_b16 v[106:107], v10 offset:4608
    s_bfe_u32 s40, s94, 0x40018
    s_add_u32 s40, s89, s40
    s_and_b32 s40, s40, 15
    s_mul_i32 s41, s40, 393216
    s_lshl_b32 s40, s40, 7
    s_add_u32 s40, s40, s36
    s_add_u32 s42, s41, s47
    s_add_u32 s41, s41, s38
    s_add_u32 m0, s44, 32768
    s_add_u32 s46, s40, 0
    buffer_load_dwordx4 v5, s[12:15], s46 offen lds
    v_mfma_f32_16x16x32_bf16 v[32:35], v[144:147], v[92:95], v[32:35]
    ds_read_b128 v[112:115], v2 offset:0
    s_add_u32 m0, s44, 33792
    s_add_u32 s46, s40, 16384
    s_branch IW_s0
IW_w0:
    s_branch IW_r0
IW_s0:
    buffer_load_dwordx4 v6, s[12:15], s46 offen lds
    v_mfma_f32_16x16x32_bf16 v[20:23], v[152:155], v[84:87], v[20:23]
    ds_read_b64_tr_b16 v[56:57], v11 offset:4096
    ds_read_b64_tr_b16 v[58:59], v11 offset:4608
    s_add_u32 m0, s44, 34816
    s_add_u32 s46, s40, 32768
    buffer_load_dwordx4 v5, s[12:15], s46 offen lds
    v_mfma_f32_16x16x32_bf16 v[36:39], v[152:155], v[92:95], v[36:39]
    ds_read_b128 v[120:123], v2 offset:2048
    s_add_u32 m0, s44, 35840
    s_add_u32 s46, s40, 49152
    buffer_load_dwordx4 v6, s[12:15], s46 offen lds
    v_mfma_f32_16x16x32_bf16 v[24:27], v[160:163], v[84:87], v[24:27]
    ds_read_b64_tr_b16 v[60:61], v12 offset:4096
    ds_read_b64_tr_b16 v[62:63], v12 offset:4608
    s_add_u32 m0, s45, 114688
    s_add_u32 s46, s41, 2048
    buffer_load_dwordx4 v8, s[16:19], s46 offen lds
    v_mfma_f32_16x16x32_bf16 v[40:43], v[160:163], v[92:95], v[40:43]
    ds_read_b128 v[128:131], v3 offset:0
    s_add_u32 m0, s43, 114688
    s_add_u32 s46, s41, 2048
    buffer_load_dwordx4 v9, s[16:19], s46 offen lds
    v_mfma_f32_16x16x32_bf16 v[28:31], v[72:75], v[84:87], v[28:31]
    ds_read_b64_tr_b16 v[132:133], v13 offset:4096
    ds_read_b64_tr_b16 v[134:135], v13 offset:4608
    s_add_u32 m0, s45, 122880
    s_add_u32 s46, s41, 4096
    buffer_load_dwordx4 v8, s[16:19], s46 offen lds
    v_mfma_f32_16x16x32_bf16 v[44:47], v[72:75], v[92:95], v[44:47]
    ds_read_b128 v[136:139], v3 offset:2048
    s_add_u32 m0, s43, 122880
    s_add_u32 s46, s41, 4096
    buffer_load_dwordx4 v9, s[16:19], s46 offen lds
    v_mfma_f32_16x16x32_bf16 v[16:19], v[48:51], v[100:103], v[16:19]
    s_bfe_u32 s40, s94, 0x4001c
    s_add_u32 s40, s89, s40
    s_and_b32 s40, s40, 15
    s_mul_i32 s41, s40, 393216
    s_lshl_b32 s40, s40, 7
    s_add_u32 s40, s40, s36
    s_add_u32 s42, s41, s47
    s_add_u32 s41, s41, s38
    s_add_u32 m0, s44, 49152
    s_add_u32 s46, s40, 0
    buffer_load_dwordx4 v5, s[12:15], s46 offen lds
    v_mfma_f32_16x16x32_bf16 v[32:35], v[48:51], v[108:111], v[32:35]
    s_add_u32 m0, s44, 50176
    s_add_u32 s46, s40, 16384
    buffer_load_dwordx4 v6, s[12:15], s46 offen lds
    v_mfma_f32_16x16x32_bf16 v[20:23], v[88:91], v[100:103], v[20:23]
    v_mfma_f32_16x16x32_bf16 v[36:39], v[88:91], v[108:111], v[36:39]
    v_mfma_f32_16x16x32_bf16 v[24:27], v[52:55], v[100:103], v[24:27]
    v_mfma_f32_16x16x32_bf16 v[40:43], v[52:55], v[108:111], v[40:43]
    v_mfma_f32_16x16x32_bf16 v[28:31], v[96:99], v[100:103], v[28:31]
    v_mfma_f32_16x16x32_bf16 v[44:47], v[96:99], v[108:111], v[44:47]
    s_waitcnt vmcnt(10) lgkmcnt(0)
    s_barrier
    s_add_u32 m0, s44, 51200
    s_add_u32 s46, s40, 32768
    buffer_load_dwordx4 v5, s[12:15], s46 offen lds
    v_mfma_f32_16x16x32_bf16 v[16:19], v[104:107], v[116:119], v[16:19]
    ds_read_b64_tr_b16 v[68:69], v10 offset:57344
    ds_read_b64_tr_b16 v[70:71], v10 offset:57856
    s_add_u32 m0, s44, 52224
    s_add_u32 s46, s40, 49152
    buffer_load_dwordx4 v6, s[12:15], s46 offen lds
    v_mfma_f32_16x16x32_bf16 v[32:35], v[104:107], v[124:127], v[32:35]
    ds_read_b128 v[140:143], v2 offset:16384
    s_add_u32 m0, s45, 65536
    s_add_u32 s46, s41, 2048
    buffer_load_dwordx4 v8, s[16:19], s46 offen lds
    v_mfma_f32_16x16x32_bf16 v[20:23], v[56:59], v[116:119], v[20:23]
    ds_read_b64_tr_b16 v[76:77], v11 offset:57344
    ds_read_b64_tr_b16 v[78:79], v11 offset:57856
    s_add_u32 m0, s43, 65536
    s_add_u32 s46, s41, 2048
    buffer_load_dwordx4 v9, s[16:19], s46 offen lds
    v_mfma_f32_16x16x32_bf16 v[36:39], v[56:59], v[124:127], v[36:39]
    ds_read_b128 v[144:147], v2 offset:18432
    s_add_u32 m0, s45, 131072
    s_add_u32 s46, s41, 4096
    buffer_load_dwordx4 v8, s[16:19], s46 offen lds
    v_mfma_f32_16x16x32_bf16 v[24:27], v[60:63], v[116:119], v[24:27]
    ds_read_b64_tr_b16 v[152:153], v12 offset:57344
    ds_read_b64_tr_b16 v[154:155], v12 offset:57856
    s_add_u32 m0, s43, 131072
    s_add_u32 s46, s41, 4096
    buffer_load_dwordx4 v9, s[16:19], s46 offen lds
    v_mfma_f32_16x16x32_bf16 v[40:43], v[60:63], v[124:127], v[40:43]
    ds_read_b128 v[160:163], v3 offset:16384
    s_bfe_u32 s40, s94, 0x40010
    s_add_u32 s40, s89, s40
    s_and_b32 s40, s40, 15
    s_mul_i32 s41, s40, 393216
    s_lshl_b32 s40, s40, 7
    s_add_u32 s40, s40, s36
    s_add_u32 s42, s41, s47
    s_add_u32 s41, s41, s38
    s_add_u32 m0, s45, 139264
    s_nop 0
    buffer_load_dwordx4 v8, s[16:19], s42 offen lds
    v_mfma_f32_16x16x32_bf16 v[28:31], v[132:135], v[116:119], v[28:31]
    ds_read_b64_tr_b16 v[84:85], v13 offset:57344
    ds_read_b64_tr_b16 v[86:87], v13 offset:57856
    s_add_u32 m0, s43, 139264
    s_nop 0
    buffer_load_dwordx4 v9, s[16:19], s42 offen lds
    v_mfma_f32_16x16x32_bf16 v[44:47], v[132:135], v[124:127], v[44:47]
    ds_read_b128 v[72:75], v3 offset:18432
    s_bfe_u32 s40, s95, 0x40000
    s_add_u32 s40, s89, s40
    s_and_b32 s40, s40, 15
    s_mul_i32 s41, s40, 393216
    s_lshl_b32 s40, s40, 7
    s_add_u32 s40, s40, s36
    s_add_u32 s42, s41, s47
    s_add_u32 s41, s41, s38
    s_add_u32 m0, s44, 0
    s_add_u32 s46, s40, 0
    buffer_load_dwordx4 v5, s[12:15], s46 offen lds
    s_add_u32 m0, s44, 1024
    s_add_u32 s46, s40, 16384
    buffer_load_dwordx4 v6, s[12:15], s46 offen lds
    s_add_u32 m0, s44, 2048
    s_add_u32 s46, s40, 32768
    buffer_load_dwordx4 v5, s[12:15], s46 offen lds
    s_waitcnt vmcnt(13) lgkmcnt(0)
    s_barrier
    s_add_u32 m0, s44, 3072
    s_add_u32 s46, s40, 49152
    buffer_load_dwordx4 v6, s[12:15], s46 offen lds
    v_mfma_f32_16x16x32_bf16 v[16:19], v[68:71], v[148:151], v[16:19]
    ds_read_b64_tr_b16 v[92:93], v10 offset:61440
    ds_read_b64_tr_b16 v[94:95], v10 offset:61952
    s_add_u32 m0, s45, 73728
    s_add_u32 s46, s41, 2048
    buffer_load_dwordx4 v8, s[16:19], s46 offen lds
    v_mfma_f32_16x16x32_bf16 v[32:35], v[68:71], v[156:159], v[32:35]
    ds_read_b128 v[48:51], v2 offset:32768
    s_add_u32 m0, s43, 73728
    s_add_u32 s46, s41, 2048
    buffer_load_dwordx4 v9, s[16:19], s46 offen lds
    v_mfma_f32_16x16x32_bf16 v[20:23], v[76:79], v[148:151], v[20:23]
    ds_read_b64_tr_b16 v[88:89], v11 offset:61440
    ds_read_b64_tr_b16 v[90:91], v11 offset:61952
    s_add_u32 m0, s45, 81920
    s_add_u32 s46, s41, 4096
    buffer_load_dwordx4 v8, s[16:19], s46 offen lds
    v_mfma_f32_16x16x32_bf16 v[36:39], v[76:79], v[156:159], v[36:39]
    ds_read_b128 v[52:55], v2 offset:34816
    s_add_u32 m0, s43, 81920
    s_add_u32 s46, s41, 4096
    buffer_load_dwordx4 v9, s[16:19], s46 offen lds
    v_mfma_f32_16x16x32_bf16 v[24:27], v[152:155], v[148:151], v[24:27]
    ds_read_b64_tr_b16 v[100:101], v12 offset:61440
    ds_read_b64_tr_b16 v[102:103], v12 offset:61952
    s_bfe_u32 s40, s95, 0x40004
    s_add_u32 s40, s89, s40
    s_and_b32 s40, s40, 15
    s_mul_i32 s41, s40, 393216
    s_lshl_b32 s40, s40, 7
    s_add_u32 s40, s40, s36
    s_add_u32 s42, s41, s47
    s_add_u32 s41, s41, s38
    s_add_u32 m0, s44, 16384
    s_add_u32 s46, s40, 0
    buffer_load_dwordx4 v5, s[12:15], s46 offen lds
    v_mfma_f32_16x16x32_bf16 v[40:43], v[152:155], v[156:159], v[40:43]
    ds_read_b128 v[96:99], v3 offset:32768
    s_add_u32 m0, s44, 17408
    s_add_u32 s46, s40, 16384
    buffer_load_dwordx4 v6, s[12:15], s46 offen lds
    v_mfma_f32_16x16x32_bf16 v[28:31], v[84:87], v[148:151], v[28:31]
    ds_read_b64_tr_b16 v[108:109], v13 offset:61440
    ds_read_b64_tr_b16 v[110:111], v13 offset:61952
    s_add_u32 m0, s44, 18432
    s_add_u32 s46, s40, 32768
    buffer_load_dwordx4 v5, s[12:15], s46 offen lds
    v_mfma_f32_16x16x32_bf16 v[44:47], v[84:87], v[156:159], v[44:47]
    ds_read_b128 v[104:107], v3 offset:34816
    s_add_u32 m0, s44, 19456
    s_add_u32 s46, s40, 49152
    buffer_load_dwordx4 v6, s[12:15], s46 offen lds
    s_add_u32 m0, s45, 90112
    s_add_u32 s46, s41, 2048
    buffer_load_dwordx4 v8, s[16:19], s46 offen lds
    s_add_u32 m0, s43, 90112
    s_add_u32 s46, s41, 2048
    buffer_load_dwordx4 v9, s[16:19], s46 offen lds
    s_waitcnt vmcnt(14) lgkmcnt(0)
    s_barrier
    s_add_u32 m0, s45, 98304
    s_add_u32 s46, s41, 4096
    buffer_load_dwordx4 v8, s[16:19], s46 offen lds
    v_mfma_f32_16x16x32_bf16 v[16:19], v[92:95], v[64:67], v[16:19]
    ds_read_b64_tr_b16 v[56:57], v10 offset:49152
    ds_read_b64_tr_b16 v[58:59], v10 offset:49664
    s_add_u32 m0, s43, 98304
    s_add_u32 s46, s41, 4096
    buffer_load_dwordx4 v9, s[16:19], s46 offen lds
    v_mfma_f32_16x16x32_bf16 v[32:35], v[92:95], v[80:83], v[32:35]
    ds_read_b128 v[60:63], v2 offset:49152
    s_bfe_u32 s40, s94, 0x40014
    s_add_u32 s40, s89, s40
    s_and_b32 s40, s40, 15
    s_mul_i32 s41, s40, 393216
    s_lshl_b32 s40, s40, 7
    s_add_u32 s40, s40, s36
    s_add_u32 s42, s41, s47
    s_add_u32 s41, s41, s38
    s_add_u32 m0, s45, 106496
    s_nop 0
    buffer_load_dwordx4 v8, s[16:19], s42 offen lds
    v_mfma_f32_16x16x32_bf16 v[20:23], v[88:91], v[64:67], v[20:23]
    ds_read_b64_tr_b16 v[116:117], v11 offset:49152
    ds_read_b64_tr_b16 v[118:119], v11 offset:49664
    s_add_u32 m0, s43, 106496
    s_nop 0
    buffer_load_dwordx4 v9, s[16:19], s42 offen lds
    v_mfma_f32_16x16x32_bf16 v[36:39], v[88:91], v[80:83], v[36:39]
    ds_read_b128 v[132:135], v2 offset:51200
    s_bfe_u32 s40, s95, 0x40008
    s_add_u32 s40, s89, s40
    s_and_b32 s40, s40, 15
    s_mul_i32 s41, s40, 393216
    s_lshl_b32 s40, s40, 7
    s_add_u32 s40, s40, s36
    s_add_u32 s42, s41, s47
    s_add_u32 s41, s41, s38
    s_add_u32 m0, s44, 32768
    s_add_u32 s46, s40, 0
    buffer_load_dwordx4 v5, s[12:15], s46 offen lds
    v_mfma_f32_16x16x32_bf16 v[24:27], v[100:103], v[64:67], v[24:27]
    ds_read_b64_tr_b16 v[124:125], v12 offset:49152
    ds_read_b64_tr_b16 v[126:127], v12 offset:49664
    s_add_u32 m0, s44, 33792
    s_add_u32 s46, s40, 16384
    buffer_load_dwordx4 v6, s[12:15], s46 offen lds
    v_mfma_f32_16x16x32_bf16 v[40:43], v[100:103], v[80:83], v[40:43]
    ds_read_b128 v[68:71], v3 offset:49152
    s_add_u32 m0, s44, 34816
    s_add_u32 s46, s40, 32768
    buffer_load_dwordx4 v5, s[12:15], s46 offen lds
    v_mfma_f32_16x16x32_bf16 v[28:31], v[108:111], v[64:67], v[28:31]
    ds_read_b64_tr_b16 v[76:77], v13 offset:49152
    ds_read_b64_tr_b16 v[78:79], v13 offset:49664
    s_add_u32 m0, s44, 35840
    s_add_u32 s46, s40, 49152
    buffer_load_dwordx4 v6, s[12:15], s46 offen lds
    v_mfma_f32_16x16x32_bf16 v[44:47], v[108:111], v[80:83], v[44:47]
    ds_read_b128 v[152:155], v3 offset:51200
    s_add_u32 m0, s45, 114688
    s_add_u32 s46, s41, 2048
    buffer_load_dwordx4 v8, s[16:19], s46 offen lds
    s_add_u32 m0, s43, 114688
    s_add_u32 s46, s41, 2048
    buffer_load_dwordx4 v9, s[16:19], s46 offen lds
    s_add_u32 m0, s45, 122880
    s_add_u32 s46, s41, 4096
    buffer_load_dwordx4 v8, s[16:19], s46 offen lds
    s_waitcnt vmcnt(17) lgkmcnt(0)
    s_barrier
    s_add_u32 m0, s43, 122880
    s_add_u32 s46, s41, 4096
    buffer_load_dwordx4 v9, s[16:19], s46 offen lds
    v_mfma_f32_16x16x32_bf16 v[16:19], v[56:59], v[112:115], v[16:19]
    ds_read_b64_tr_b16 v[148:149], v10 offset:53248
    ds_read_b64_tr_b16 v[150:151], v10 offset:53760
    s_bfe_u32 s40, s95, 0x4000c
    s_add_u32 s40, s89, s40
    s_and_b32 s40, s40, 15
    s_mul_i32 s41, s40, 393216
    s_lshl_b32 s40, s40, 7
    s_add_u32 s40, s40, s36
    s_add_u32 s42, s41, s47
    s_add_u32 s41, s41, s38
    s_add_u32 m0, s44, 49152
    s_add_u32 s46, s40, 0
    buffer_load_dwordx4 v5, s[12:15], s46 offen lds
    v_mfma_f32_16x16x32_bf16 v[32:35], v[56:59], v[120:123], v[32:35]
    ds_read_b128 v[84:87], v2 offset:0
    s_add_u32 m0, s44, 50176
    s_add_u32 s46, s40, 16384
    buffer_load_dwordx4 v6, s[12:15], s46 offen lds
    v_mfma_f32_16x16x32_bf16 v[20:23], v[116:119], v[112:115], v[20:23]
    ds_read_b64_tr_b16 v[156:157], v11 offset:53248
    ds_read_b64_tr_b16 v[158:159], v11 offset:53760
    s_add_u32 m0, s44, 51200
    s_add_u32 s46, s40, 32768
    buffer_load_dwordx4 v5, s[12:15], s46 offen lds
    v_mfma_f32_16x16x32_bf16 v[36:39], v[116:119], v[120:123], v[36:39]
    ds_read_b128 v[92:95], v2 offset:2048
    s_add_u32 m0, s44, 52224
    s_add_u32 s46, s40, 49152
    buffer_load_dwordx4 v6, s[12:15], s46 offen lds
    v_mfma_f32_16x16x32_bf16 v[24:27], v[124:127], v[112:115], v[24:27]
    ds_read_b64_tr_b16 v[88:89], v12 offset:53248
    ds_read_b64_tr_b16 v[90:91], v12 offset:53760
    s_add_u32 m0, s45, 65536
    s_add_u32 s46, s41, 2048
    buffer_load_dwordx4 v8, s[16:19], s46 offen lds
    v_mfma_f32_16x16x32_bf16 v[40:43], v[124:127], v[120:123], v[40:43]
    ds_read_b128 v[100:103], v3 offset:0
    s_add_u32 m0, s43, 65536
    s_add_u32 s46, s41, 2048
    buffer_load_dwordx4 v9, s[16:19], s46 offen lds
    v_mfma_f32_16x16x32_bf16 v[28:31], v[76:79], v[112:115], v[28:31]
    ds_read_b64_tr_b16 v[64:65], v13 offset:53248
    ds_read_b64_tr_b16 v[66:67], v13 offset:53760
    s_add_u32 m0, s45, 131072
    s_add_u32 s46, s41, 4096
    buffer_load_dwordx4 v8, s[16:19], s46 offen lds
    v_mfma_f32_16x16x32_bf16 v[44:47], v[76:79], v[120:123], v[44:47]
    ds_read_b128 v[108:111], v3 offset:2048
    s_add_u32 m0, s43, 131072
    s_add_u32 s46, s41, 4096
    buffer_load_dwordx4 v9, s[16:19], s46 offen lds
    s_waitcnt vmcnt(16) lgkmcnt(0)
    s_barrier
    s_bfe_u32 s40, s95, 0x40010
    s_add_u32 s40, s89, s40
    s_and_b32 s40, s40, 15
    s_mul_i32 s41, s40, 393216
    s_lshl_b32 s40, s40, 7
    s_add_u32 s40, s40, s36
    s_add_u32 s42, s41, s47
    s_add_u32 s41, s41, s38
    s_add_u32 m0, s44, 0
    s_add_u32 s46, s40, 0
    buffer_load_dwordx4 v5, s[12:15], s46 offen lds
    v_mfma_f32_16x16x32_bf16 v[16:19], v[148:151], v[128:131], v[16:19]
    ds_read_b64_tr_b16 v[80:81], v10 offset:16384
    ds_read_b64_tr_b16 v[82:83], v10 offset:16896
    s_add_u32 m0, s44, 1024
    s_add_u32 s46, s40, 16384
    buffer_load_dwordx4 v6, s[12:15], s46 offen lds
    v_mfma_f32_16x16x32_bf16 v[32:35], v[148:151], v[136:139], v[32:35]
    ds_read_b128 v[56:59], v2 offset:16384
    s_add_u32 m0, s44, 2048
    s_add_u32 s46, s40, 32768
    buffer_load_dwordx4 v5, s[12:15], s46 offen lds
    v_mfma_f32_16x16x32_bf16 v[20:23], v[156:159], v[128:131], v[20:23]
    ds_read_b64_tr_b16 v[116:117], v11 offset:16384
    ds_read_b64_tr_b16 v[118:119], v11 offset:16896
    s_add_u32 m0, s44, 3072
    s_add_u32 s46, s40, 49152
    buffer_load_dwordx4 v6, s[12:15], s46 offen lds
    v_mfma_f32_16x16x32_bf16 v[36:39], v[156:159], v[136:139], v[36:39]
    ds_read_b128 v[124:127], v2 offset:18432
    s_add_u32 m0, s45, 73728
    s_add_u32 s46, s41, 2048
    buffer_load_dwordx4 v8, s[16:19], s46 offen lds
    v_mfma_f32_16x16x32_bf16 v[24:27], v[88:91], v[128:131], v[24:27]
    ds_read_b64_tr_b16 v[112:113], v12 offset:16384
    ds_read_b64_tr_b16 v[114:115], v12 offset:16896
    s_add_u32 m0, s43, 73728
    s_add_u32 s46, s41, 2048
    buffer_load_dwordx4 v9, s[16:19], s46 offen lds
    v_mfma_f32_16x16x32_bf16 v[40:43], v[88:91], v[136:139], v[40:43]
    ds_read_b128 v[76:79], v3 offset:16384
    s_add_u32 m0, s45, 81920
    s_add_u32 s46, s41, 4096
    buffer_load_dwordx4 v8, s[16:19], s46 offen lds
    v_mfma_f32_16x16x32_bf16 v[28:31], v[64:67], v[128:131], v[28:31]
    ds_read_b64_tr_b16 v[120:121], v13 offset:16384
    ds_read_b64_tr_b16 v[122:123], v13 offset:16896
    s_add_u32 m0, s43, 81920
    s_add_u32 s46, s41, 4096
    buffer_load_dwordx4 v9, s[16:19], s46 offen lds
    v_mfma_f32_16x16x32_bf16 v[44:47], v[64:67], v[136:139], v[44:47]
    ds_read_b128 v[148:151], v3 offset:18432
    s_waitcnt vmcnt(16) lgkmcnt(0)
    s_barrier
    s_bfe_u32 s40, s95, 0x40014
    s_add_u32 s40, s89, s40
    s_and_b32 s40, s40, 15
    s_mul_i32 s41, s40, 393216
    s_lshl_b32 s40, s40, 7
    s_add_u32 s40, s40, s36
    s_add_u32 s42, s41, s47
    s_add_u32 s41, s41, s38
    s_add_u32 m0, s44, 16384
    s_add_u32 s46, s40, 0
    buffer_load_dwordx4 v5, s[12:15], s46 offen lds
    v_mfma_f32_16x16x32_bf16 v[16:19], v[80:83], v[140:143], v[16:19]
    ds_read_b64_tr_b16 v[156:157], v10 offset:20480
    ds_read_b64_tr_b16 v[158:159], v10 offset:20992
    s_add_u32 m0, s44, 17408
    s_add_u32 s46, s40, 16384
    buffer_load_dwordx4 v6, s[12:15], s46 offen lds
    v_mfma_f32_16x16x32_bf16 v[32:35], v[80:83], v[144:147], v[32:35]
    ds_read_b128 v[88:91], v2 offset:32768
    s_add_u32 m0, s44, 18432
    s_add_u32 s46, s40, 32768
    buffer_load_dwordx4 v5, s[12:15], s46 offen lds
    v_mfma_f32_16x16x32_bf16 v[20:23], v[116:119], v[140:143], v[20:23]
    ds_read_b64_tr_b16 v[128:129], v11 offset:20480
    ds_read_b64_tr_b16 v[130:131], v11 offset:20992
    s_add_u32 m0, s44, 19456
    s_add_u32 s46, s40, 49152
    buffer_load_dwordx4 v6, s[12:15], s46 offen lds
    v_mfma_f32_16x16x32_bf16 v[36:39], v[116:119], v[144:147], v[36:39]
    ds_read_b128 v[64:67], v2 offset:34816
    s_add_u32 m0, s45, 90112
    s_add_u32 s46, s41, 2048
    buffer_load_dwordx4 v8, s[16:19], s46 offen lds
    v_mfma_f32_16x16x32_bf16 v[24:27], v[112:115], v[140:143], v[24:27]
    ds_read_b64_tr_b16 v[136:137], v12 offset:20480
    ds_read_b64_tr_b16 v[138:139], v12 offset:20992
    s_add_u32 m0, s43, 90112
    s_add_u32 s46, s41, 2048
    buffer_load_dwordx4 v9, s[16:19], s46 offen lds
    v_mfma_f32_16x16x32_bf16 v[40:43], v[112:115], v[144:147], v[40:43]
    ds_read_b128 v[80:83], v3 offset:32768
    s_add_u32 m0, s45, 98304
    s_add_u32 s46, s41, 4096
    buffer_load_dwordx4 v8, s[16:19], s46 offen lds
    v_mfma_f32_16x16x32_bf16 v[28:31], v[120:123], v[140:143], v[28:31]
    ds_read_b64_tr_b16 v[116:117], v13 offset:20480
    ds_read_b64_tr_b16 v[118:119], v13 offset:20992
    s_add_u32 m0, s43, 98304
    s_add_u32 s46, s41, 4096
    buffer_load_dwordx4 v9, s[16:19], s46 offen lds
    v_mfma_f32_16x16x32_bf16 v[44:47], v[120:123], v[144:147], v[44:47]
    ds_read_b128 v[112:115], v3 offset:34816
    s_waitcnt vmcnt(16) lgkmcnt(0)
    s_barrier
    s_bfe_u32 s40, s95, 0x40018
    s_add_u32 s40, s89, s40
    s_and_b32 s40, s40, 15
    s_mul_i32 s41, s40, 393216
    s_lshl_b32 s40, s40, 7
    s_add_u32 s40, s40, s36
    s_add_u32 s42, s41, s47
    s_add_u32 s41, s41, s38
    s_add_u32 m0, s44, 32768
    s_add_u32 s46, s40, 0
    buffer_load_dwordx4 v5, s[12:15], s46 offen lds
    v_mfma_f32_16x16x32_bf16 v[16:19], v[156:159], v[160:163], v[16:19]
    ds_read_b128 v[140:143], v2 offset:49152
    s_add_u32 m0, s44, 33792
    s_add_u32 s46, s40, 16384
    buffer_load_dwordx4 v6, s[12:15], s46 offen lds
    v_mfma_f32_16x16x32_bf16 v[32:35], v[156:159], v[72:75], v[32:35]
    ds_read_b128 v[120:123], v2 offset:51200
    s_add_u32 m0, s44, 34816
    s_add_u32 s46, s40, 32768
    buffer_load_dwordx4 v5, s[12:15], s46 offen lds
    v_mfma_f32_16x16x32_bf16 v[20:23], v[128:131], v[160:163], v[20:23]
    ds_read_b128 v[144:147], v3 offset:49152
    s_add_u32 m0, s44, 35840
    s_add_u32 s46, s40, 49152
    buffer_load_dwordx4 v6, s[12:15], s46 offen lds
    v_mfma_f32_16x16x32_bf16 v[36:39], v[128:131], v[72:75], v[36:39]
    ds_read_b128 v[156:159], v3 offset:51200
    s_add_u32 m0, s45, 106496
    s_add_u32 s46, s41, 2048
    buffer_load_dwordx4 v8, s[16:19], s46 offen lds
    v_mfma_f32_16x16x32_bf16 v[24:27], v[136:139], v[160:163], v[24:27]
    s_add_u32 m0, s43, 106496
    s_add_u32 s46, s41, 2048
    buffer_load_dwordx4 v9, s[16:19], s46 offen lds
    v_mfma_f32_16x16x32_bf16 v[40:43], v[136:139], v[72:75], v[40:43]
    s_add_u32 m0, s45, 114688
    s_add_u32 s46, s41, 4096
    buffer_load_dwordx4 v8, s[16:19], s46 offen lds
    v_mfma_f32_16x16x32_bf16 v[28:31], v[116:119], v[160:163], v[28:31]
    s_add_u32 m0, s43, 114688
    s_add_u32 s46, s41, 4096
    buffer_load_dwordx4 v9, s[16:19], s46 offen lds
    v_mfma_f32_16x16x32_bf16 v[44:47], v[116:119], v[72:75], v[44:47]
    s_waitcnt vmcnt(16) lgkmcnt(0)
    s_barrier
    s_bfe_u32 s40, s95, 0x4001c
    s_add_u32 s40, s89, s40
    s_and_b32 s40, s40, 15
    s_mul_i32 s41, s40, 393216
    s_lshl_b32 s40, s40, 7
    s_add_u32 s40, s40, s36
    s_add_u32 s42, s41, s47
    s_add_u32 s41, s41, s38
    s_add_u32 m0, s44, 49152
    s_add_u32 s46, s40, 0
    buffer_load_dwordx4 v5, s[12:15], s46 offen lds
    s_add_u32 m0, s44, 50176
    s_add_u32 s46, s40, 16384
    buffer_load_dwordx4 v6, s[12:15], s46 offen lds
    s_add_u32 m0, s44, 51200
    s_add_u32 s46, s40, 32768
    buffer_load_dwordx4 v5, s[12:15], s46 offen lds
    s_add_u32 m0, s44, 52224
    s_add_u32 s46, s40, 49152
    buffer_load_dwordx4 v6, s[12:15], s46 offen lds
    s_add_u32 m0, s45, 65536
    s_add_u32 s46, s41, 2048
    buffer_load_dwordx4 v8, s[16:19], s46 offen lds
    s_add_u32 m0, s43, 65536
    s_add_u32 s46, s41, 2048
    buffer_load_dwordx4 v9, s[16:19], s46 offen lds
    s_add_u32 m0, s45, 122880
    s_add_u32 s46, s41, 4096
    buffer_load_dwordx4 v8, s[16:19], s46 offen lds
    s_add_u32 m0, s43, 122880
    s_add_u32 s46, s41, 4096
    buffer_load_dwordx4 v9, s[16:19], s46 offen lds
    s_waitcnt vmcnt(16)
    s_barrier
    s_bfe_u32 s40, s94, 0x40018
    s_add_u32 s40, s89, s40
    s_and_b32 s40, s40, 15
    s_mul_i32 s41, s40, 393216
    s_lshl_b32 s40, s40, 7
    s_add_u32 s40, s40, s36
    s_add_u32 s42, s41, s47
    s_add_u32 s41, s41, s38
    s_add_u32 m0, s45, 147456
    s_nop 0
    buffer_load_dwordx4 v8, s[16:19], s42 offen lds
    s_add_u32 m0, s43, 147456
    s_nop 0
    buffer_load_dwordx4 v9, s[16:19], s42 offen lds
    s_waitcnt vmcnt(10)
    s_barrier
    s_bfe_u32 s40, s95, 0x40010
    s_add_u32 s40, s89, s40
    s_and_b32 s40, s40, 15
    s_mul_i32 s41, s40, 393216
    s_lshl_b32 s40, s40, 7
    s_add_u32 s40, s40, s36
    s_add_u32 s42, s41, s47
    s_add_u32 s41, s41, s38
    s_add_u32 m0, s45, 139264
    s_nop 0
    buffer_load_dwordx4 v8, s[16:19], s42 offen lds
    s_add_u32 m0, s43, 139264
    s_nop 0
    buffer_load_dwordx4 v9, s[16:19], s42 offen lds
    s_waitcnt vmcnt(4)
    s_barrier
    s_bfe_u32 s40, s95, 0x40014
    s_add_u32 s40, s89, s40
    s_and_b32 s40, s40, 15
    s_mul_i32 s41, s40, 393216
    s_lshl_b32 s40, s40, 7
    s_add_u32 s40, s40, s36
    s_add_u32 s42, s41, s47
    s_add_u32 s41, s41, s38
    s_add_u32 m0, s45, 131072
    s_nop 0
    buffer_load_dwordx4 v8, s[16:19], s42 offen lds
    s_add_u32 m0, s43, 131072
    s_nop 0
    buffer_load_dwordx4 v9, s[16:19], s42 offen lds
    s_waitcnt vmcnt(6)
    s_barrier
    s_bfe_u32 s40, s95, 0x40018
    s_add_u32 s40, s89, s40
    s_and_b32 s40, s40, 15
    s_mul_i32 s41, s40, 393216
    s_lshl_b32 s40, s40, 7
    s_add_u32 s40, s40, s36
    s_add_u32 s42, s41, s47
    s_add_u32 s41, s41, s38
    s_add_u32 m0, s45, 81920
    s_nop 0
    buffer_load_dwordx4 v8, s[16:19], s42 offen lds
    s_add_u32 m0, s43, 81920
    s_nop 0
    buffer_load_dwordx4 v9, s[16:19], s42 offen lds
    s_bfe_u32 s40, s95, 0x4001c
    s_add_u32 s40, s89, s40
    s_and_b32 s40, s40, 15
    s_mul_i32 s41, s40, 393216
    s_lshl_b32 s40, s40, 7
    s_add_u32 s40, s40, s36
    s_add_u32 s42, s41, s47
    s_add_u32 s41, s41, s38
    s_add_u32 m0, s45, 73728
    s_nop 0
    buffer_load_dwordx4 v8, s[16:19], s42 offen lds
    s_add_u32 m0, s43, 73728
    s_nop 0
    s_branch IW_s1
IW_w1:
    s_branch IW_r1
IW_s1:
    buffer_load_dwordx4 v9, s[16:19], s42 offen lds
    s_bfe_u32 s40, s94, 0x4001c
    s_add_u32 s40, s89, s40
    s_and_b32 s40, s40, 15
    s_mul_i32 s41, s40, 393216
    s_lshl_b32 s40, s40, 7
    s_add_u32 s40, s40, s36
    s_add_u32 s42, s41, s47
    s_add_u32 s41, s41, s38
    s_add_u32 m0, s45, 98304
    s_nop 0
    buffer_load_dwordx4 v8, s[16:19], s42 offen lds
    s_add_u32 m0, s43, 98304
    s_nop 0
    buffer_load_dwordx4 v9, s[16:19], s42 offen lds
    s_bfe_u32 s40, s95, 0x40000
    s_add_u32 s40, s89, s40
    s_and_b32 s40, s40, 15
    s_mul_i32 s41, s40, 393216
    s_lshl_b32 s40, s40, 7
    s_add_u32 s40, s40, s36
    s_add_u32 s42, s41, s47
    s_add_u32 s41, s41, s38
    s_add_u32 m0, s45, 90112
    s_nop 0
    buffer_load_dwordx4 v8, s[16:19], s42 offen lds
    s_add_u32 m0, s43, 90112
    s_nop 0
    buffer_load_dwordx4 v9, s[16:19], s42 offen lds
    s_bfe_u32 s40, s95, 0x40004
    s_add_u32 s40, s89, s40
    s_and_b32 s40, s40, 15
    s_mul_i32 s41, s40, 393216
    s_lshl_b32 s40, s40, 7
    s_add_u32 s40, s40, s36
    s_add_u32 s42, s41, s47
    s_add_u32 s41, s41, s38
    s_add_u32 m0, s45, 114688
    s_nop 0
    buffer_load_dwordx4 v8, s[16:19], s42 offen lds
    s_add_u32 m0, s43, 114688
    s_nop 0
    buffer_load_dwordx4 v9, s[16:19], s42 offen lds
    s_bfe_u32 s40, s95, 0x40008
    s_add_u32 s40, s89, s40
    s_and_b32 s40, s40, 15
    s_mul_i32 s41, s40, 393216
    s_lshl_b32 s40, s40, 7
    s_add_u32 s40, s40, s36
    s_add_u32 s42, s41, s47
    s_add_u32 s41, s41, s38
    s_add_u32 m0, s45, 106496
    s_nop 0
    buffer_load_dwordx4 v8, s[16:19], s42 offen lds
    s_add_u32 m0, s43, 106496
    s_nop 0
    buffer_load_dwordx4 v9, s[16:19], s42 offen lds
    s_bfe_u32 s40, s95, 0x4000c
    s_add_u32 s40, s89, s40
    s_and_b32 s40, s40, 15
    s_mul_i32 s41, s40, 393216
    s_lshl_b32 s40, s40, 7
    s_add_u32 s40, s40, s36
    s_add_u32 s42, s41, s47
    s_add_u32 s41, s41, s38
    s_add_u32 m0, s45, 122880
    s_nop 0
    buffer_load_dwordx4 v8, s[16:19], s42 offen lds
    s_add_u32 m0, s43, 122880
    s_nop 0
    buffer_load_dwordx4 v9, s[16:19], s42 offen lds
    s_setprio 1
    v_subrev_u32 v5, 24576, v10
    v_subrev_u32 v6, 24576, v11
    v_subrev_u32 v8, 24576, v12
    v_subrev_u32 v9, 24576, v13
    s_add_u32 s16, s72, 0x400000
    s_addc_u32 s17, s73, 0
    s_mov_b32 s18, 0x400000
    s_mov_b32 s19, 0x00020000
    s_add_u32 s24, s72, 0x800000
    s_addc_u32 s25, s73, 0
    s_mov_b32 s26, 0x48000
    s_mov_b32 s27, 0x00020000
    s_mov_b32 s40, 0x21317218
    s_mov_b32 s41, s40
    s_mov_b32 s74, 0x358637bd
    s_mov_b32 s75, s74
    s_mov_b32 s76, 0x5d800000
    s_mov_b32 s77, s76
    v_and_b32 v14, 15, v0
    v_lshlrev_b32 v14, 2, v14
    s_lshl_b32 s42, s3, 7
    s_add_u32 s42, s42, 155648
    v_add_u32 v14, s42, v14
    v_and_b32 v15, 0x30, v0
    v_add_u32 v15, 158208, v15
    v_and_b32 v165, 0xfffffff7, v1
    s_lshl_b32 s79, s32, 18
    s_lshl_b32 s80, s3, 16
    s_add_u32 s79, s79, s80
    s_lshl_b32 s80, s10, 11
    s_add_u32 s79, s79, s80
    s_add_u32 s80, s79, 0x8000
    s_lshl_b32 s45, s32, 2
    s_add_u32 s45, s45, s3
    s_lshl_b32 s45, s45, 10
    s_mov_b32 s46, 0x3fb8aa3b

    s_add_u32 s54, s45, 0x835000
    s_add_u32 s54, s72, s54
    s_addc_u32 s55, s73, 0
    ds_read_b32 v7, v165 offset:48
FW_1:
    s_waitcnt lgkmcnt(0)
    v_cmp_gt_u32 vcc, 1, v7
    s_cbranch_vccz FO_2
    s_sleep 1
    ds_read_b32 v7, v165 offset:48
    s_branch FW_1
FO_2:
    ds_read2_b32 v[72:73], v14 offset0:0 offset1:0
    ds_read2_b32 v[74:75], v14 offset0:16 offset1:16
    ds_read_b128 v[128:131], v15 offset:0
    ds_read_b128 v[136:139], v15 offset:64
    ds_read_b128 v[160:163], v15 offset:128
    ds_read_b128 v[116:119], v15 offset:192
    v_add_u32 v14, 1024, v14
    s_waitcnt lgkmcnt(3)
    v_pk_fma_f32 v[16:17], v[128:129], v[72:73], v[16:17]
    v_pk_fma_f32 v[18:19], v[130:131], v[72:73], v[18:19]
    v_pk_fma_f32 v[32:33], v[128:129], v[74:75], v[32:33]
    v_pk_fma_f32 v[34:35], v[130:131], v[74:75], v[34:35]
    s_waitcnt lgkmcnt(2)
    v_pk_fma_f32 v[20:21], v[136:137], v[72:73], v[20:21]
    v_pk_fma_f32 v[22:23], v[138:139], v[72:73], v[22:23]
    v_pk_fma_f32 v[36:37], v[136:137], v[74:75], v[36:37]
    v_pk_fma_f32 v[38:39], v[138:139], v[74:75], v[38:39]
    s_waitcnt lgkmcnt(1)
    v_pk_fma_f32 v[24:25], v[160:161], v[72:73], v[24:25]
    v_pk_fma_f32 v[26:27], v[162:163], v[72:73], v[26:27]
    v_pk_fma_f32 v[40:41], v[160:161], v[74:75], v[40:41]
    v_pk_fma_f32 v[42:43], v[162:163], v[74:75], v[42:43]
    s_waitcnt lgkmcnt(0)
    v_pk_fma_f32 v[28:29], v[116:117], v[72:73], v[28:29]
    v_pk_fma_f32 v[30:31], v[118:119], v[72:73], v[30:31]
    v_pk_fma_f32 v[44:45], v[116:117], v[74:75], v[44:45]
    v_pk_fma_f32 v[46:47], v[118:119], v[74:75], v[46:47]
    s_waitcnt vmcnt(8)
    s_mov_b64 exec, 1
    ds_add_u32 v4, v164 offset:112
    s_mov_b64 exec, -1
    ds_read_b32 v7, v1 offset:32
FW_3:
    s_waitcnt lgkmcnt(0)
    v_cmp_gt_u32 vcc, 1, v7
    s_cbranch_vccz FO_4
    s_sleep 2
    ds_read_b32 v7, v1 offset:32
    s_branch FW_3
FO_4:
    ds_read_b32 v7, v1 offset:112
FW_5:
    s_waitcnt lgkmcnt(0)
    v_cmp_gt_u32 vcc, 1, v7
    s_cbranch_vccz FO_6
    ds_read_b32 v7, v1 offset:112
    s_branch FW_5
FO_6:
    ds_read_b64_tr_b16 v[128:129], v10 offset:57344
    ds_read_b64_tr_b16 v[130:131], v10 offset:57856
    ds_read_b64_tr_b16 v[136:137], v11 offset:57344
    ds_read_b64_tr_b16 v[138:139], v11 offset:57856
    ds_read_b64_tr_b16 v[160:161], v12 offset:57344
    ds_read_b64_tr_b16 v[162:163], v12 offset:57856
    ds_read_b64_tr_b16 v[116:117], v13 offset:57344
    ds_read_b64_tr_b16 v[118:119], v13 offset:57856
    ds_read_b64_tr_b16 v[72:73], v10 offset:61440
    ds_read_b64_tr_b16 v[74:75], v10 offset:61952
    s_waitcnt lgkmcnt(8)
    v_mfma_f32_16x16x32_bf16 v[16:19], v[128:131], v[48:51], v[16:19]
    v_mfma_f32_16x16x32_bf16 v[32:35], v[128:131], v[52:55], v[32:35]
    ds_read_b64_tr_b16 v[128:129], v11 offset:61440
    ds_read_b64_tr_b16 v[130:131], v11 offset:61952
    s_waitcnt lgkmcnt(8)
    v_mfma_f32_16x16x32_bf16 v[20:23], v[136:139], v[48:51], v[20:23]
    v_mfma_f32_16x16x32_bf16 v[36:39], v[136:139], v[52:55], v[36:39]
    ds_read_b64_tr_b16 v[136:137], v12 offset:61440
    ds_read_b64_tr_b16 v[138:139], v12 offset:61952
    s_waitcnt lgkmcnt(8)
    v_mfma_f32_16x16x32_bf16 v[24:27], v[160:163], v[48:51], v[24:27]
    v_mfma_f32_16x16x32_bf16 v[40:43], v[160:163], v[52:55], v[40:43]
    ds_read_b64_tr_b16 v[160:161], v13 offset:61440
    ds_read_b64_tr_b16 v[162:163], v13 offset:61952
    s_waitcnt lgkmcnt(8)
    v_mfma_f32_16x16x32_bf16 v[28:31], v[116:119], v[48:51], v[28:31]
    ds_read_b128 v[48:51], v2 offset:0
    v_mfma_f32_16x16x32_bf16 v[44:47], v[116:119], v[52:55], v[44:47]
    ds_read_b64_tr_b16 v[116:117], v10 offset:49152
    ds_read_b64_tr_b16 v[118:119], v10 offset:49664
    s_waitcnt lgkmcnt(9)
    v_mfma_f32_16x16x32_bf16 v[16:19], v[72:75], v[96:99], v[16:19]
    ds_read_b128 v[52:55], v2 offset:2048
    v_mfma_f32_16x16x32_bf16 v[32:35], v[72:75], v[104:107], v[32:35]
    ds_read_b64_tr_b16 v[72:73], v11 offset:49152
    ds_read_b64_tr_b16 v[74:75], v11 offset:49664
    s_waitcnt lgkmcnt(10)
    v_mfma_f32_16x16x32_bf16 v[20:23], v[128:131], v[96:99], v[20:23]
    v_mfma_f32_16x16x32_bf16 v[36:39], v[128:131], v[104:107], v[36:39]
    ds_read_b64_tr_b16 v[128:129], v12 offset:49152
    ds_read_b64_tr_b16 v[130:131], v12 offset:49664
    s_waitcnt lgkmcnt(10)
    v_mfma_f32_16x16x32_bf16 v[24:27], v[136:139], v[96:99], v[24:27]
    v_mfma_f32_16x16x32_bf16 v[40:43], v[136:139], v[104:107], v[40:43]
    ds_read_b64_tr_b16 v[136:137], v13 offset:49152
    ds_read_b64_tr_b16 v[138:139], v13 offset:49664
    s_waitcnt lgkmcnt(10)
    v_mfma_f32_16x16x32_bf16 v[28:31], v[160:163], v[96:99], v[28:31]
    ds_read_b128 v[96:99], v3 offset:0
    v_mfma_f32_16x16x32_bf16 v[44:47], v[160:163], v[104:107], v[44:47]
    ds_read_b64_tr_b16 v[160:161], v10 offset:53248
    ds_read_b64_tr_b16 v[162:163], v10 offset:53760
    s_waitcnt lgkmcnt(10)
    v_mfma_f32_16x16x32_bf16 v[16:19], v[116:119], v[48:51], v[16:19]
    ds_read_b128 v[104:107], v3 offset:2048
    s_waitcnt lgkmcnt(10)
    v_mfma_f32_16x16x32_bf16 v[32:35], v[116:119], v[52:55], v[32:35]
    ds_read_b64_tr_b16 v[116:117], v11 offset:53248
    ds_read_b64_tr_b16 v[118:119], v11 offset:53760
    s_waitcnt lgkmcnt(10)
    v_mfma_f32_16x16x32_bf16 v[20:23], v[72:75], v[48:51], v[20:23]
    v_mfma_f32_16x16x32_bf16 v[36:39], v[72:75], v[52:55], v[36:39]
    ds_read_b64_tr_b16 v[72:73], v12 offset:53248
    ds_read_b64_tr_b16 v[74:75], v12 offset:53760
    s_waitcnt lgkmcnt(10)
    v_mfma_f32_16x16x32_bf16 v[24:27], v[128:131], v[48:51], v[24:27]
    v_mfma_f32_16x16x32_bf16 v[40:43], v[128:131], v[52:55], v[40:43]
    ds_read_b64_tr_b16 v[128:129], v13 offset:53248
    ds_read_b64_tr_b16 v[130:131], v13 offset:53760
    s_waitcnt lgkmcnt(10)
    v_mfma_f32_16x16x32_bf16 v[28:31], v[136:139], v[48:51], v[28:31]
    ds_read_b128 v[48:51], v2 offset:16384
    v_mfma_f32_16x16x32_bf16 v[44:47], v[136:139], v[52:55], v[44:47]
    ds_read_b64_tr_b16 v[136:137], v10 offset:40960
    ds_read_b64_tr_b16 v[138:139], v10 offset:41472
    s_waitcnt lgkmcnt(10)
    v_mfma_f32_16x16x32_bf16 v[16:19], v[160:163], v[96:99], v[16:19]
    ds_read_b128 v[52:55], v2 offset:18432
    s_waitcnt lgkmcnt(10)
    v_mfma_f32_16x16x32_bf16 v[32:35], v[160:163], v[104:107], v[32:35]
    ds_read_b64_tr_b16 v[160:161], v11 offset:40960
    ds_read_b64_tr_b16 v[162:163], v11 offset:41472
    s_waitcnt lgkmcnt(10)
    v_mfma_f32_16x16x32_bf16 v[20:23], v[116:119], v[96:99], v[20:23]
    v_mfma_f32_16x16x32_bf16 v[36:39], v[116:119], v[104:107], v[36:39]
    ds_read_b64_tr_b16 v[116:117], v12 offset:40960
    ds_read_b64_tr_b16 v[118:119], v12 offset:41472
    s_waitcnt lgkmcnt(10)
    v_mfma_f32_16x16x32_bf16 v[24:27], v[72:75], v[96:99], v[24:27]
    v_mfma_f32_16x16x32_bf16 v[40:43], v[72:75], v[104:107], v[40:43]
    ds_read_b64_tr_b16 v[72:73], v13 offset:40960
    ds_read_b64_tr_b16 v[74:75], v13 offset:41472
    s_waitcnt lgkmcnt(10)
    v_mfma_f32_16x16x32_bf16 v[28:31], v[128:131], v[96:99], v[28:31]
    ds_read_b128 v[96:99], v3 offset:16384
    v_mfma_f32_16x16x32_bf16 v[44:47], v[128:131], v[104:107], v[44:47]
    ds_read_b64_tr_b16 v[128:129], v10 offset:45056
    ds_read_b64_tr_b16 v[130:131], v10 offset:45568
    s_waitcnt lgkmcnt(10)
    v_mfma_f32_16x16x32_bf16 v[16:19], v[136:139], v[48:51], v[16:19]
    ds_read_b128 v[104:107], v3 offset:18432
    s_waitcnt lgkmcnt(10)
    v_mfma_f32_16x16x32_bf16 v[32:35], v[136:139], v[52:55], v[32:35]
    ds_read_b64_tr_b16 v[136:137], v11 offset:45056
    ds_read_b64_tr_b16 v[138:139], v11 offset:45568
    s_waitcnt lgkmcnt(10)
    v_mfma_f32_16x16x32_bf16 v[20:23], v[160:163], v[48:51], v[20:23]
    v_mfma_f32_16x16x32_bf16 v[36:39], v[160:163], v[52:55], v[36:39]
    ds_read_b64_tr_b16 v[160:161], v12 offset:45056
    ds_read_b64_tr_b16 v[162:163], v12 offset:45568
    s_waitcnt lgkmcnt(10)
    v_mfma_f32_16x16x32_bf16 v[24:27], v[116:119], v[48:51], v[24:27]
    v_mfma_f32_16x16x32_bf16 v[40:43], v[116:119], v[52:55], v[40:43]
    ds_read_b64_tr_b16 v[116:117], v13 offset:45056
    ds_read_b64_tr_b16 v[118:119], v13 offset:45568
    s_waitcnt lgkmcnt(10)
    v_mfma_f32_16x16x32_bf16 v[28:31], v[72:75], v[48:51], v[28:31]
    ds_read_b128 v[48:51], v2 offset:32768
    v_mfma_f32_16x16x32_bf16 v[44:47], v[72:75], v[52:55], v[44:47]
    ds_read_b64_tr_b16 v[72:73], v5 offset:16384
    ds_read_b64_tr_b16 v[74:75], v5 offset:16896
    s_waitcnt lgkmcnt(10)
    v_mfma_f32_16x16x32_bf16 v[16:19], v[128:131], v[96:99], v[16:19]
    ds_read_b128 v[52:55], v2 offset:34816
    s_waitcnt lgkmcnt(10)
    v_mfma_f32_16x16x32_bf16 v[32:35], v[128:131], v[104:107], v[32:35]
    ds_read_b64_tr_b16 v[128:129], v6 offset:16384
    ds_read_b64_tr_b16 v[130:131], v6 offset:16896
    s_waitcnt lgkmcnt(10)
    v_mfma_f32_16x16x32_bf16 v[20:23], v[136:139], v[96:99], v[20:23]
    v_mfma_f32_16x16x32_bf16 v[36:39], v[136:139], v[104:107], v[36:39]
    ds_read_b64_tr_b16 v[136:137], v8 offset:16384
    ds_read_b64_tr_b16 v[138:139], v8 offset:16896
    s_waitcnt lgkmcnt(10)
    v_mfma_f32_16x16x32_bf16 v[24:27], v[160:163], v[96:99], v[24:27]
    v_mfma_f32_16x16x32_bf16 v[40:43], v[160:163], v[104:107], v[40:43]
    ds_read_b64_tr_b16 v[160:161], v9 offset:16384
    ds_read_b64_tr_b16 v[162:163], v9 offset:16896
    s_waitcnt lgkmcnt(10)
    v_mfma_f32_16x16x32_bf16 v[28:31], v[116:119], v[96:99], v[28:31]
    ds_read_b128 v[96:99], v3 offset:32768
    v_mfma_f32_16x16x32_bf16 v[44:47], v[116:119], v[104:107], v[44:47]
    ds_read_b64_tr_b16 v[116:117], v5 offset:20480
    ds_read_b64_tr_b16 v[118:119], v5 offset:20992
    s_waitcnt lgkmcnt(10)
    v_mfma_f32_16x16x32_bf16 v[16:19], v[72:75], v[48:51], v[16:19]
    ds_read_b128 v[104:107], v3 offset:34816
    s_waitcnt lgkmcnt(10)
    v_mfma_f32_16x16x32_bf16 v[32:35], v[72:75], v[52:55], v[32:35]
    ds_read_b64_tr_b16 v[72:73], v6 offset:20480
    ds_read_b64_tr_b16 v[74:75], v6 offset:20992
    s_waitcnt lgkmcnt(10)
    v_mfma_f32_16x16x32_bf16 v[20:23], v[128:131], v[48:51], v[20:23]
    v_mfma_f32_16x16x32_bf16 v[36:39], v[128:131], v[52:55], v[36:39]
    ds_read_b64_tr_b16 v[128:129], v8 offset:20480
    ds_read_b64_tr_b16 v[130:131], v8 offset:20992
    s_waitcnt lgkmcnt(10)
    v_mfma_f32_16x16x32_bf16 v[24:27], v[136:139], v[48:51], v[24:27]
    v_mfma_f32_16x16x32_bf16 v[40:43], v[136:139], v[52:55], v[40:43]
    ds_read_b64_tr_b16 v[136:137], v9 offset:20480
    ds_read_b64_tr_b16 v[138:139], v9 offset:20992
    s_waitcnt lgkmcnt(10)
    v_mfma_f32_16x16x32_bf16 v[28:31], v[160:163], v[48:51], v[28:31]
    s_waitcnt vmcnt(0)
    s_mov_b64 exec, 1
    ds_add_u32 v4, v164 offset:112
    s_mov_b64 exec, -1
    ds_read_b128 v[48:51], v2 offset:49152
    v_mfma_f32_16x16x32_bf16 v[44:47], v[160:163], v[52:55], v[44:47]
    ds_read_b64_tr_b16 v[160:161], v5 offset:8192
    ds_read_b64_tr_b16 v[162:163], v5 offset:8704
    s_waitcnt lgkmcnt(11)
    v_mfma_f32_16x16x32_bf16 v[16:19], v[116:119], v[96:99], v[16:19]
    ds_read_b128 v[52:55], v2 offset:51200
    s_waitcnt lgkmcnt(11)
    v_mfma_f32_16x16x32_bf16 v[32:35], v[116:119], v[104:107], v[32:35]
    ds_read_b64_tr_b16 v[116:117], v6 offset:8192
    ds_read_b64_tr_b16 v[118:119], v6 offset:8704
    s_waitcnt lgkmcnt(11)
    v_mfma_f32_16x16x32_bf16 v[20:23], v[72:75], v[96:99], v[20:23]
    v_mfma_f32_16x16x32_bf16 v[36:39], v[72:75], v[104:107], v[36:39]
    ds_read_b64_tr_b16 v[72:73], v8 offset:8192
    ds_read_b64_tr_b16 v[74:75], v8 offset:8704
    s_waitcnt lgkmcnt(9)
    v_mov_b32 v165, 4
    s_mov_b64 exec, 1
    ds_write_b32 v4, v165 offset:0
    s_mov_b64 exec, -1
    v_mfma_f32_16x16x32_bf16 v[24:27], v[128:131], v[96:99], v[24:27]
    v_mfma_f32_16x16x32_bf16 v[40:43], v[128:131], v[104:107], v[40:43]
    ds_read_b64_tr_b16 v[128:129], v9 offset:8192
    ds_read_b64_tr_b16 v[130:131], v9 offset:8704
    v_mfma_f32_16x16x32_bf16 v[28:31], v[136:139], v[96:99], v[28:31]
    ds_read_b128 v[96:99], v3 offset:49152
    v_mfma_f32_16x16x32_bf16 v[44:47], v[136:139], v[104:107], v[44:47]
    ds_read_b64_tr_b16 v[136:137], v5 offset:12288
    ds_read_b64_tr_b16 v[138:139], v5 offset:12800
    s_waitcnt lgkmcnt(11)
    v_mfma_f32_16x16x32_bf16 v[16:19], v[160:163], v[48:51], v[16:19]
    ds_read_b128 v[104:107], v3 offset:51200
    s_waitcnt lgkmcnt(11)
    v_mfma_f32_16x16x32_bf16 v[32:35], v[160:163], v[52:55], v[32:35]
    ds_read_b64_tr_b16 v[160:161], v6 offset:12288
    ds_read_b64_tr_b16 v[162:163], v6 offset:12800
    s_waitcnt lgkmcnt(11)
    v_mfma_f32_16x16x32_bf16 v[20:23], v[116:119], v[48:51], v[20:23]
    v_mfma_f32_16x16x32_bf16 v[36:39], v[116:119], v[52:55], v[36:39]
    ds_read_b64_tr_b16 v[116:117], v8 offset:12288
    ds_read_b64_tr_b16 v[118:119], v8 offset:12800
    s_waitcnt lgkmcnt(11)
    v_mfma_f32_16x16x32_bf16 v[24:27], v[72:75], v[48:51], v[24:27]
    v_mfma_f32_16x16x32_bf16 v[40:43], v[72:75], v[52:55], v[40:43]
    ds_read_b64_tr_b16 v[72:73], v9 offset:12288
    ds_read_b64_tr_b16 v[74:75], v9 offset:12800
    s_waitcnt lgkmcnt(10)
    v_mfma_f32_16x16x32_bf16 v[28:31], v[128:131], v[48:51], v[28:31]
    ds_read_b64_tr_b16 v[48:49], v10 offset:8192
    v_mfma_f32_16x16x32_bf16 v[44:47], v[128:131], v[52:55], v[44:47]
    ds_read_b64_tr_b16 v[50:51], v10 offset:8704
    ds_read_b64_tr_b16 v[128:129], v11 offset:8192
    s_waitcnt lgkmcnt(10)
    v_mfma_f32_16x16x32_bf16 v[16:19], v[136:139], v[96:99], v[16:19]
    ds_read_b64_tr_b16 v[130:131], v11 offset:8704
    s_waitcnt lgkmcnt(10)
    v_mfma_f32_16x16x32_bf16 v[32:35], v[136:139], v[104:107], v[32:35]
    ds_read_b64_tr_b16 v[52:53], v12 offset:8192
    ds_read_b64_tr_b16 v[54:55], v12 offset:8704
    s_waitcnt lgkmcnt(10)
    v_mfma_f32_16x16x32_bf16 v[20:23], v[160:163], v[96:99], v[20:23]
    ds_read_b64_tr_b16 v[136:137], v13 offset:8192
    v_mfma_f32_16x16x32_bf16 v[36:39], v[160:163], v[104:107], v[36:39]
    ds_read_b64_tr_b16 v[138:139], v13 offset:8704
    ds_read_b64_tr_b16 v[160:161], v10 offset:12288
    s_waitcnt lgkmcnt(11)
    v_mfma_f32_16x16x32_bf16 v[24:27], v[116:119], v[96:99], v[24:27]
    ds_read_b64_tr_b16 v[162:163], v10 offset:12800
    v_mfma_f32_16x16x32_bf16 v[40:43], v[116:119], v[104:107], v[40:43]
    ds_read_b64_tr_b16 v[116:117], v11 offset:12288
    ds_read_b64_tr_b16 v[118:119], v11 offset:12800
    s_waitcnt lgkmcnt(12)
    v_mfma_f32_16x16x32_bf16 v[28:31], v[72:75], v[96:99], v[28:31]
    ds_read_b64_tr_b16 v[96:97], v12 offset:12288
    v_mfma_f32_16x16x32_bf16 v[44:47], v[72:75], v[104:107], v[44:47]
    ds_read_b64_tr_b16 v[98:99], v12 offset:12800
    ds_read_b64_tr_b16 v[72:73], v13 offset:12288
    s_waitcnt lgkmcnt(13)
    v_mfma_f32_16x16x32_bf16 v[16:19], v[48:51], v[60:63], v[16:19]
    ds_read_b64_tr_b16 v[74:75], v13 offset:12800
    v_mfma_f32_16x16x32_bf16 v[32:35], v[48:51], v[132:135], v[32:35]
    ds_read_b32 v7, v1 offset:112
FW_7:
    s_waitcnt lgkmcnt(0)
    v_cmp_gt_u32 vcc, 2, v7
    s_cbranch_vccz FO_8
    ds_read_b32 v7, v1 offset:112
    s_branch FW_7
FO_8:
    ds_read_b64_tr_b16 v[104:105], v10 offset:0
    ds_read_b64_tr_b16 v[106:107], v10 offset:512
    v_mfma_f32_16x16x32_bf16 v[20:23], v[128:131], v[60:63], v[20:23]
    ds_read_b64_tr_b16 v[48:49], v11 offset:0
    v_mfma_f32_16x16x32_bf16 v[36:39], v[128:131], v[132:135], v[36:39]
    ds_read_b64_tr_b16 v[50:51], v11 offset:512
    ds_read_b64_tr_b16 v[128:129], v12 offset:0
    v_mfma_f32_16x16x32_bf16 v[24:27], v[52:55], v[60:63], v[24:27]
    ds_read_b64_tr_b16 v[130:131], v12 offset:512
    v_mfma_f32_16x16x32_bf16 v[40:43], v[52:55], v[132:135], v[40:43]
    ds_read_b64_tr_b16 v[52:53], v13 offset:0
    ds_read_b64_tr_b16 v[54:55], v13 offset:512
    v_mfma_f32_16x16x32_bf16 v[28:31], v[136:139], v[60:63], v[28:31]
    v_mfma_f32_16x16x32_bf16 v[44:47], v[136:139], v[132:135], v[44:47]
    v_mfma_f32_16x16x32_bf16 v[16:19], v[160:163], v[68:71], v[16:19]
    ds_read_b64_tr_b16 v[60:61], v10 offset:4096
    v_mfma_f32_16x16x32_bf16 v[32:35], v[160:163], v[152:155], v[32:35]
    ds_read_b64_tr_b16 v[62:63], v10 offset:4608
    ds_read_b64_tr_b16 v[136:137], v11 offset:4096
    v_mfma_f32_16x16x32_bf16 v[20:23], v[116:119], v[68:71], v[20:23]
    ds_read_b64_tr_b16 v[138:139], v11 offset:4608
    v_mfma_f32_16x16x32_bf16 v[36:39], v[116:119], v[152:155], v[36:39]
    ds_read_b64_tr_b16 v[132:133], v12 offset:4096
    ds_read_b64_tr_b16 v[134:135], v12 offset:4608
    v_mfma_f32_16x16x32_bf16 v[24:27], v[96:99], v[68:71], v[24:27]
    ds_read_b64_tr_b16 v[160:161], v13 offset:4096
    v_mfma_f32_16x16x32_bf16 v[40:43], v[96:99], v[152:155], v[40:43]
    s_waitcnt lgkmcnt(8)
    ds_read_b64_tr_b16 v[162:163], v13 offset:4608
    v_mfma_f32_16x16x32_bf16 v[28:31], v[72:75], v[68:71], v[28:31]
    v_mfma_f32_16x16x32_bf16 v[44:47], v[72:75], v[152:155], v[44:47]
    s_waitcnt lgkmcnt(14)
    v_mfma_f32_16x16x32_bf16 v[16:19], v[104:107], v[84:87], v[16:19]
    ds_read_b64_tr_b16 v[116:117], v10 offset:24576
    v_mfma_f32_16x16x32_bf16 v[32:35], v[104:107], v[92:95], v[32:35]
    ds_read_b64_tr_b16 v[118:119], v10 offset:25088
    ds_read_b64_tr_b16 v[96:97], v11 offset:24576
    s_waitcnt lgkmcnt(15)
    v_mfma_f32_16x16x32_bf16 v[20:23], v[48:51], v[84:87], v[20:23]
    ds_read_b64_tr_b16 v[98:99], v11 offset:25088
    v_mfma_f32_16x16x32_bf16 v[36:39], v[48:51], v[92:95], v[36:39]
    ds_read_b64_tr_b16 v[68:69], v12 offset:24576
    ds_read_b64_tr_b16 v[70:71], v12 offset:25088
    s_waitcnt lgkmcnt(15)
    v_mfma_f32_16x16x32_bf16 v[24:27], v[128:131], v[84:87], v[24:27]
    s_waitcnt lgkmcnt(8)
    ds_read_b64_tr_b16 v[72:73], v13 offset:24576
    v_mfma_f32_16x16x32_bf16 v[40:43], v[128:131], v[92:95], v[40:43]
    ds_read_b64_tr_b16 v[74:75], v13 offset:25088
    s_waitcnt lgkmcnt(15)
    v_mfma_f32_16x16x32_bf16 v[28:31], v[52:55], v[84:87], v[28:31]
    v_mfma_f32_16x16x32_bf16 v[44:47], v[52:55], v[92:95], v[44:47]
    s_waitcnt lgkmcnt(14)
    v_mfma_f32_16x16x32_bf16 v[16:19], v[60:63], v[100:103], v[16:19]
    ds_read_b64_tr_b16 v[152:153], v10 offset:28672
    v_mfma_f32_16x16x32_bf16 v[32:35], v[60:63], v[108:111], v[32:35]
    ds_read_b64_tr_b16 v[154:155], v10 offset:29184
    ds_read_b64_tr_b16 v[104:105], v11 offset:28672
    s_waitcnt lgkmcnt(15)
    v_mfma_f32_16x16x32_bf16 v[20:23], v[136:139], v[100:103], v[20:23]
    ds_read_b64_tr_b16 v[106:107], v11 offset:29184
    v_mfma_f32_16x16x32_bf16 v[36:39], v[136:139], v[108:111], v[36:39]
    ds_read_b64_tr_b16 v[48:49], v12 offset:28672
    s_waitcnt lgkmcnt(8)
    ds_read_b64_tr_b16 v[50:51], v12 offset:29184
    s_waitcnt lgkmcnt(15)
    v_mfma_f32_16x16x32_bf16 v[24:27], v[132:135], v[100:103], v[24:27]
    ds_read_b64_tr_b16 v[128:129], v13 offset:28672
    v_mfma_f32_16x16x32_bf16 v[40:43], v[132:135], v[108:111], v[40:43]
    ds_read_b64_tr_b16 v[130:131], v13 offset:29184
    s_waitcnt lgkmcnt(15)
    v_mfma_f32_16x16x32_bf16 v[28:31], v[160:163], v[100:103], v[28:31]
    v_mfma_f32_16x16x32_bf16 v[44:47], v[160:163], v[108:111], v[44:47]
    s_waitcnt lgkmcnt(14)
    v_mfma_f32_16x16x32_bf16 v[16:19], v[116:119], v[56:59], v[16:19]
    ds_read_b64_tr_b16 v[84:85], v10 offset:16384
    v_mfma_f32_16x16x32_bf16 v[32:35], v[116:119], v[124:127], v[32:35]
    ds_read_b64_tr_b16 v[86:87], v10 offset:16896
    ds_read_b64_tr_b16 v[52:53], v11 offset:16384
    s_waitcnt lgkmcnt(15)
    v_mfma_f32_16x16x32_bf16 v[20:23], v[96:99], v[56:59], v[20:23]
    ds_read_b64_tr_b16 v[54:55], v11 offset:16896
    v_mfma_f32_16x16x32_bf16 v[36:39], v[96:99], v[124:127], v[36:39]
    s_waitcnt lgkmcnt(8)
    ds_read_b64_tr_b16 v[92:93], v12 offset:16384
    ds_read_b64_tr_b16 v[94:95], v12 offset:16896
    s_waitcnt lgkmcnt(15)
    v_mfma_f32_16x16x32_bf16 v[24:27], v[68:71], v[56:59], v[24:27]
    ds_read_b64_tr_b16 v[60:61], v13 offset:16384
    v_mfma_f32_16x16x32_bf16 v[40:43], v[68:71], v[124:127], v[40:43]
    ds_read_b64_tr_b16 v[62:63], v13 offset:16896
    s_waitcnt lgkmcnt(15)
    v_mfma_f32_16x16x32_bf16 v[28:31], v[72:75], v[56:59], v[28:31]
    v_mfma_f32_16x16x32_bf16 v[44:47], v[72:75], v[124:127], v[44:47]
    s_waitcnt lgkmcnt(14)
    v_mfma_f32_16x16x32_bf16 v[16:19], v[152:155], v[76:79], v[16:19]
    ds_read_b64_tr_b16 v[136:137], v10 offset:20480
    v_mfma_f32_16x16x32_bf16 v[32:35], v[152:155], v[148:151], v[32:35]
    ds_read_b64_tr_b16 v[138:139], v10 offset:20992
    ds_read_b64_tr_b16 v[132:133], v11 offset:20480
    s_waitcnt lgkmcnt(15)
    v_mfma_f32_16x16x32_bf16 v[20:23], v[104:107], v[76:79], v[20:23]
    s_waitcnt lgkmcnt(8)
    ds_read_b64_tr_b16 v[134:135], v11 offset:20992
    v_mfma_f32_16x16x32_bf16 v[36:39], v[104:107], v[148:151], v[36:39]
    ds_read_b64_tr_b16 v[100:101], v12 offset:20480
    ds_read_b64_tr_b16 v[102:103], v12 offset:20992
    s_waitcnt lgkmcnt(15)
    v_mfma_f32_16x16x32_bf16 v[24:27], v[48:51], v[76:79], v[24:27]
    ds_read_b64_tr_b16 v[160:161], v13 offset:20480
    v_mfma_f32_16x16x32_bf16 v[40:43], v[48:51], v[148:151], v[40:43]
    ds_read_b64_tr_b16 v[162:163], v13 offset:20992
    s_waitcnt lgkmcnt(15)
    v_mfma_f32_16x16x32_bf16 v[28:31], v[128:131], v[76:79], v[28:31]
    v_mfma_f32_16x16x32_bf16 v[44:47], v[128:131], v[148:151], v[44:47]
    s_waitcnt lgkmcnt(14)
    v_mfma_f32_16x16x32_bf16 v[16:19], v[84:87], v[88:91], v[16:19]
    ds_read_b64_tr_b16 v[108:109], v10 offset:32768
    v_mfma_f32_16x16x32_bf16 v[32:35], v[84:87], v[64:67], v[32:35]
    ds_read_b64_tr_b16 v[110:111], v10 offset:33280
    s_waitcnt lgkmcnt(8)
    ds_read_b64_tr_b16 v[116:117], v11 offset:32768
    s_waitcnt lgkmcnt(15)
    v_mfma_f32_16x16x32_bf16 v[20:23], v[52:55], v[88:91], v[20:23]
    ds_read_b64_tr_b16 v[118:119], v11 offset:33280
    v_mfma_f32_16x16x32_bf16 v[36:39], v[52:55], v[64:67], v[36:39]
    ds_read_b64_tr_b16 v[96:97], v12 offset:32768
    ds_read_b64_tr_b16 v[98:99], v12 offset:33280
    s_waitcnt lgkmcnt(15)
    v_mfma_f32_16x16x32_bf16 v[24:27], v[92:95], v[88:91], v[24:27]
    ds_read_b64_tr_b16 v[68:69], v13 offset:32768
    v_mfma_f32_16x16x32_bf16 v[40:43], v[92:95], v[64:67], v[40:43]
    ds_read_b64_tr_b16 v[70:71], v13 offset:33280
    s_waitcnt lgkmcnt(15)
    v_mfma_f32_16x16x32_bf16 v[28:31], v[60:63], v[88:91], v[28:31]
    v_mfma_f32_16x16x32_bf16 v[44:47], v[60:63], v[64:67], v[44:47]
    s_waitcnt lgkmcnt(14)
    v_mfma_f32_16x16x32_bf16 v[16:19], v[136:139], v[80:83], v[16:19]
    ds_read_b64_tr_b16 v[56:57], v10 offset:36864
    v_mfma_f32_16x16x32_bf16 v[32:35], v[136:139], v[112:115], v[32:35]
    s_waitcnt lgkmcnt(8)
    ds_read_b64_tr_b16 v[58:59], v10 offset:37376
    ds_read_b64_tr_b16 v[72:73], v11 offset:36864
    s_waitcnt lgkmcnt(15)
    v_mfma_f32_16x16x32_bf16 v[20:23], v[132:135], v[80:83], v[20:23]
    ds_read_b64_tr_b16 v[74:75], v11 offset:37376
    v_mfma_f32_16x16x32_bf16 v[36:39], v[132:135], v[112:115], v[36:39]
    ds_read_b64_tr_b16 v[124:125], v12 offset:36864
    ds_read_b64_tr_b16 v[126:127], v12 offset:37376
    s_waitcnt lgkmcnt(15)
    v_mfma_f32_16x16x32_bf16 v[24:27], v[100:103], v[80:83], v[24:27]
    ds_read_b64_tr_b16 v[152:153], v13 offset:36864
    v_mfma_f32_16x16x32_bf16 v[40:43], v[100:103], v[112:115], v[40:43]
    ds_read_b64_tr_b16 v[154:155], v13 offset:37376
    s_waitcnt lgkmcnt(15)
    v_mfma_f32_16x16x32_bf16 v[28:31], v[160:163], v[80:83], v[28:31]
    v_mfma_f32_16x16x32_bf16 v[44:47], v[160:163], v[112:115], v[44:47]
    s_waitcnt lgkmcnt(14)
    v_mfma_f32_16x16x32_bf16 v[16:19], v[108:111], v[140:143], v[16:19]
    ds_read2_b32 v[112:113], v14 offset0:0 offset1:0
    s_waitcnt lgkmcnt(8)
    ds_read2_b32 v[114:115], v14 offset0:16 offset1:16
    v_mfma_f32_16x16x32_bf16 v[32:35], v[108:111], v[120:123], v[32:35]
    s_waitcnt lgkmcnt(14)
    v_mfma_f32_16x16x32_bf16 v[20:23], v[116:119], v[140:143], v[20:23]
    s_waitcnt lgkmcnt(2)
    v_mov_b32 v165, 10
    s_mov_b64 exec, 1
    ds_write_b32 v4, v165 offset:0
    s_mov_b64 exec, -1
    v_mfma_f32_16x16x32_bf16 v[36:39], v[116:119], v[120:123], v[36:39]
    v_mfma_f32_16x16x32_bf16 v[24:27], v[96:99], v[140:143], v[24:27]
    v_mfma_f32_16x16x32_bf16 v[40:43], v[96:99], v[120:123], v[40:43]
    v_mfma_f32_16x16x32_bf16 v[28:31], v[68:71], v[140:143], v[28:31]
    v_mfma_f32_16x16x32_bf16 v[44:47], v[68:71], v[120:123], v[44:47]
    v_mfma_f32_16x16x32_bf16 v[16:19], v[56:59], v[144:147], v[16:19]
    v_mfma_f32_16x16x32_bf16 v[32:35], v[56:59], v[156:159], v[32:35]
    v_mfma_f32_16x16x32_bf16 v[20:23], v[72:75], v[144:147], v[20:23]
    v_mfma_f32_16x16x32_bf16 v[36:39], v[72:75], v[156:159], v[36:39]
    v_mfma_f32_16x16x32_bf16 v[24:27], v[124:127], v[144:147], v[24:27]
    v_mfma_f32_16x16x32_bf16 v[40:43], v[124:127], v[156:159], v[40:43]
    v_mfma_f32_16x16x32_bf16 v[28:31], v[152:155], v[144:147], v[28:31]
    v_mfma_f32_16x16x32_bf16 v[44:47], v[152:155], v[156:159], v[44:47]
    s_branch IW_s2
IW_w2:
    s_branch IW_r2
IW_s2:
    s_setprio 3
    v_lshlrev_b32 v6, 4, v0
    v_lshlrev_b32 v8, 2, v0
    v_add_u32 v8, 40960, v8
    v_mov_b32 v11, 0x35c1a2a0

    s_waitcnt lgkmcnt(2)
    v_pk_mul_f32 v[16:17], v[16:17], v[112:113]
    v_pk_mul_f32 v[18:19], v[18:19], v[112:113]
    v_pk_mul_f32 v[20:21], v[20:21], v[112:113]
    v_pk_mul_f32 v[22:23], v[22:23], v[112:113]
    v_pk_mul_f32 v[24:25], v[24:25], v[112:113]
    v_pk_mul_f32 v[26:27], v[26:27], v[112:113]
    v_pk_mul_f32 v[28:29], v[28:29], v[112:113]
    v_pk_mul_f32 v[30:31], v[30:31], v[112:113]
    s_waitcnt lgkmcnt(1)
    v_pk_mul_f32 v[32:33], v[32:33], v[114:115]
    v_pk_mul_f32 v[34:35], v[34:35], v[114:115]
    v_pk_mul_f32 v[36:37], v[36:37], v[114:115]
    v_pk_mul_f32 v[38:39], v[38:39], v[114:115]
    v_pk_mul_f32 v[40:41], v[40:41], v[114:115]
    v_pk_mul_f32 v[42:43], v[42:43], v[114:115]
    v_pk_mul_f32 v[44:45], v[44:45], v[114:115]
    v_pk_mul_f32 v[46:47], v[46:47], v[114:115]
    v_exp_f32 v80, v16 clamp
    v_exp_f32 v81, v17 clamp
    v_exp_f32 v82, v18 clamp
    v_exp_f32 v83, v19 clamp
    v_exp_f32 v84, v20 clamp
    v_exp_f32 v85, v21 clamp
    v_exp_f32 v86, v22 clamp
    v_exp_f32 v87, v23 clamp
    v_exp_f32 v88, v24 clamp
    v_exp_f32 v89, v25 clamp
    v_exp_f32 v90, v26 clamp
    v_exp_f32 v91, v27 clamp
    v_exp_f32 v92, v28 clamp
    v_exp_f32 v93, v29 clamp
    v_exp_f32 v94, v30 clamp
    v_exp_f32 v95, v31 clamp
    v_exp_f32 v96, v32 clamp
    v_exp_f32 v97, v33 clamp
    v_exp_f32 v98, v34 clamp
    v_exp_f32 v99, v35 clamp
    v_exp_f32 v100, v36 clamp
    v_exp_f32 v101, v37 clamp
    v_exp_f32 v102, v38 clamp
    v_exp_f32 v103, v39 clamp
    v_exp_f32 v104, v40 clamp
    v_exp_f32 v105, v41 clamp
    v_exp_f32 v106, v42 clamp
    v_exp_f32 v107, v43 clamp
    v_exp_f32 v108, v44 clamp
    v_exp_f32 v109, v45 clamp
    v_exp_f32 v110, v46 clamp
    v_exp_f32 v111, v47 clamp
    v_pk_mul_f32 v[16:17], v[16:17], s[40:41] clamp
    v_pk_mul_f32 v[18:19], v[18:19], s[40:41] clamp
    v_pk_mul_f32 v[20:21], v[20:21], s[40:41] clamp
    v_pk_mul_f32 v[22:23], v[22:23], s[40:41] clamp
    v_pk_mul_f32 v[24:25], v[24:25], s[40:41] clamp
    v_pk_mul_f32 v[26:27], v[26:27], s[40:41] clamp
    v_pk_mul_f32 v[28:29], v[28:29], s[40:41] clamp
    v_pk_mul_f32 v[30:31], v[30:31], s[40:41] clamp
    v_pk_mul_f32 v[32:33], v[32:33], s[40:41] clamp
    v_pk_mul_f32 v[34:35], v[34:35], s[40:41] clamp
    v_pk_mul_f32 v[36:37], v[36:37], s[40:41] clamp
    v_pk_mul_f32 v[38:39], v[38:39], s[40:41] clamp
    v_pk_mul_f32 v[40:41], v[40:41], s[40:41] clamp
    v_pk_mul_f32 v[42:43], v[42:43], s[40:41] clamp
    v_pk_mul_f32 v[44:45], v[44:45], s[40:41] clamp
    v_pk_mul_f32 v[46:47], v[46:47], s[40:41] clamp
    v_pk_add_f32 v[80:81], v[80:81], s[74:75]
    v_pk_add_f32 v[82:83], v[82:83], s[74:75]
    v_pk_add_f32 v[84:85], v[84:85], s[74:75]
    v_pk_add_f32 v[86:87], v[86:87], s[74:75]
    v_pk_add_f32 v[88:89], v[88:89], s[74:75]
    v_pk_add_f32 v[90:91], v[90:91], s[74:75]
    v_pk_add_f32 v[92:93], v[92:93], s[74:75]
    v_pk_add_f32 v[94:95], v[94:95], s[74:75]
    v_pk_add_f32 v[96:97], v[96:97], s[74:75]
    v_pk_add_f32 v[98:99], v[98:99], s[74:75]
    v_pk_add_f32 v[100:101], v[100:101], s[74:75]
    v_pk_add_f32 v[102:103], v[102:103], s[74:75]
    v_pk_add_f32 v[104:105], v[104:105], s[74:75]
    v_pk_add_f32 v[106:107], v[106:107], s[74:75]
    v_pk_add_f32 v[108:109], v[108:109], s[74:75]
    v_pk_add_f32 v[110:111], v[110:111], s[74:75]
    v_pk_fma_f32 v[16:17], v[16:17], s[76:77], v[80:81]
    v_pk_fma_f32 v[18:19], v[18:19], s[76:77], v[82:83]
    v_pk_fma_f32 v[20:21], v[20:21], s[76:77], v[84:85]
    v_pk_fma_f32 v[22:23], v[22:23], s[76:77], v[86:87]
    v_pk_fma_f32 v[24:25], v[24:25], s[76:77], v[88:89]
    v_pk_fma_f32 v[26:27], v[26:27], s[76:77], v[90:91]
    v_pk_fma_f32 v[28:29], v[28:29], s[76:77], v[92:93]
    v_pk_fma_f32 v[30:31], v[30:31], s[76:77], v[94:95]
    v_pk_fma_f32 v[32:33], v[32:33], s[76:77], v[96:97]
    v_pk_fma_f32 v[34:35], v[34:35], s[76:77], v[98:99]
    v_pk_fma_f32 v[36:37], v[36:37], s[76:77], v[100:101]
    v_pk_fma_f32 v[38:39], v[38:39], s[76:77], v[102:103]
    v_pk_fma_f32 v[40:41], v[40:41], s[76:77], v[104:105]
    v_pk_fma_f32 v[42:43], v[42:43], s[76:77], v[106:107]
    v_pk_fma_f32 v[44:45], v[44:45], s[76:77], v[108:109]
    v_pk_fma_f32 v[46:47], v[46:47], s[76:77], v[110:111]
    v_cvt_pk_bf16_f32 v112, v16, v17
    v_cvt_pk_bf16_f32 v113, v18, v19
    v_cvt_pk_bf16_f32 v114, v20, v21
    v_cvt_pk_bf16_f32 v115, v22, v23
    v_cvt_pk_bf16_f32 v116, v24, v25
    v_cvt_pk_bf16_f32 v117, v26, v27
    v_cvt_pk_bf16_f32 v118, v28, v29
    v_cvt_pk_bf16_f32 v119, v30, v31
    v_cvt_pk_bf16_f32 v120, v32, v33
    v_cvt_pk_bf16_f32 v121, v34, v35
    v_cvt_pk_bf16_f32 v122, v36, v37
    v_cvt_pk_bf16_f32 v123, v38, v39
    v_cvt_pk_bf16_f32 v124, v40, v41
    v_cvt_pk_bf16_f32 v125, v42, v43
    v_cvt_pk_bf16_f32 v126, v44, v45
    v_cvt_pk_bf16_f32 v127, v46, v47
    s_waitcnt lgkmcnt(0)
    v_and_b32 v9, 0xfffffff7, v1
    v_and_b32 v5, 0x30, v0
    v_add_u32 v5, 159232, v5
    ds_read_b32 v7, v9 offset:128
FW_9:
    s_waitcnt lgkmcnt(0)
    v_cmp_gt_u32 vcc, 1, v7
    s_cbranch_vccz FO_10
    s_sleep 1
    ds_read_b32 v7, v9 offset:128
    s_branch FW_9
FO_10:
    ds_read_b32 v7, v9 offset:128
FW_11:
    s_waitcnt lgkmcnt(0)
    v_cmp_gt_u32 vcc, 2, v7
    s_cbranch_vccz FO_12
    ds_read_b32 v7, v9 offset:128
    s_branch FW_11
FO_12:
    ds_read_b128 v[32:35], v5 offset:0
    ds_read_b128 v[36:39], v5 offset:64
    ds_read2st64_b32 v[16:17], v8 offset0:0 offset1:1
    ds_read2st64_b32 v[18:19], v8 offset0:2 offset1:3
    ds_read2st64_b32 v[20:21], v8 offset0:4 offset1:5
    ds_read2st64_b32 v[22:23], v8 offset0:6 offset1:7
    ds_read2st64_b32 v[24:25], v8 offset0:16 offset1:17
    ds_read2st64_b32 v[26:27], v8 offset0:18 offset1:19
    ds_read2st64_b32 v[28:29], v8 offset0:20 offset1:21
    ds_read2st64_b32 v[30:31], v8 offset0:22 offset1:23
    s_waitcnt lgkmcnt(5)
    ds_read_b128 v[56:59], v5 offset:128
    ds_read_b128 v[60:63], v5 offset:192
    ds_read2st64_b32 v[40:41], v8 offset0:8 offset1:9
    ds_read2st64_b32 v[42:43], v8 offset0:10 offset1:11
    ds_read2st64_b32 v[44:45], v8 offset0:12 offset1:13
    ds_read2st64_b32 v[46:47], v8 offset0:14 offset1:15
    ds_read2st64_b32 v[48:49], v8 offset0:24 offset1:25
    ds_read2st64_b32 v[50:51], v8 offset0:26 offset1:27
    ds_read2st64_b32 v[52:53], v8 offset0:28 offset1:29
    ds_read2st64_b32 v[54:55], v8 offset0:30 offset1:31
    s_waitcnt lgkmcnt(10)
    v_cvt_pk_bf16_f32 v136, v32, v33
    v_cvt_pk_bf16_f32 v137, v34, v35
    v_cvt_pk_bf16_f32 v138, v36, v37
    v_cvt_pk_bf16_f32 v139, v38, v39
    s_nop 1
    v_mfma_f32_16x16x32_bf16 v[72:75], v[136:139], v[112:115], 0
    v_mfma_f32_16x16x32_bf16 v[84:87], v[136:139], v[120:123], 0
    v_cvt_pk_bf16_f32 v128, v16, v17
    v_cvt_pk_bf16_f32 v129, v18, v19
    v_cvt_pk_bf16_f32 v130, v20, v21
    v_cvt_pk_bf16_f32 v131, v22, v23
    s_nop 1
    v_mfma_f32_16x16x32_bf16 v[64:67], v[128:131], v[112:115], 0
    v_mfma_f32_16x16x32_bf16 v[76:79], v[128:131], v[120:123], 0
    v_cvt_pk_bf16_f32 v132, v24, v25
    v_cvt_pk_bf16_f32 v133, v26, v27
    v_cvt_pk_bf16_f32 v134, v28, v29
    v_cvt_pk_bf16_f32 v135, v30, v31
    s_nop 1
    v_mfma_f32_16x16x32_bf16 v[68:71], v[132:135], v[112:115], 0
    v_mfma_f32_16x16x32_bf16 v[80:83], v[132:135], v[120:123], 0
    s_waitcnt lgkmcnt(0)
    v_cvt_pk_bf16_f32 v148, v56, v57
    v_cvt_pk_bf16_f32 v149, v58, v59
    v_cvt_pk_bf16_f32 v150, v60, v61
    v_cvt_pk_bf16_f32 v151, v62, v63
    v_fma_f32 v72, v72, s46, v11
    v_rcp_f32 v72, v72
    v_fma_f32 v84, v84, s46, v11
    v_rcp_f32 v84, v84
    v_mfma_f32_16x16x32_bf16 v[96:99], v[148:151], v[116:119], 0
    v_mfma_f32_16x16x32_bf16 v[108:111], v[148:151], v[124:127], 0
    v_cvt_pk_bf16_f32 v140, v40, v41
    v_cvt_pk_bf16_f32 v141, v42, v43
    v_cvt_pk_bf16_f32 v142, v44, v45
    v_cvt_pk_bf16_f32 v143, v46, v47
    s_nop 1
    v_mfma_f32_16x16x32_bf16 v[88:91], v[140:143], v[116:119], 0
    v_mfma_f32_16x16x32_bf16 v[100:103], v[140:143], v[124:127], 0
    v_mul_f32 v64, v64, v72
    v_mul_f32 v65, v65, v72
    v_mul_f32 v66, v66, v72
    v_mul_f32 v67, v67, v72
    v_mul_f32 v68, v68, v72
    v_mul_f32 v69, v69, v72
    v_mul_f32 v70, v70, v72
    v_mul_f32 v71, v71, v72
    v_cvt_pk_bf16_f32 v16, v64, v65
    v_cvt_pk_bf16_f32 v17, v66, v67
    v_cvt_pk_bf16_f32 v18, v68, v69
    v_cvt_pk_bf16_f32 v19, v70, v71
    buffer_store_dwordx4 v[16:19], v6, s[16:19], s79 offen offset:0 sc0 sc1
    v_cvt_pk_bf16_f32 v144, v48, v49
    v_cvt_pk_bf16_f32 v145, v50, v51
    v_cvt_pk_bf16_f32 v146, v52, v53
    v_cvt_pk_bf16_f32 v147, v54, v55
    s_nop 1
    v_mfma_f32_16x16x32_bf16 v[92:95], v[144:147], v[116:119], 0
    v_mfma_f32_16x16x32_bf16 v[104:107], v[144:147], v[124:127], 0
    v_mul_f32 v76, v76, v84
    v_mul_f32 v77, v77, v84
    v_mul_f32 v78, v78, v84
    v_mul_f32 v79, v79, v84
    v_mul_f32 v80, v80, v84
    v_mul_f32 v81, v81, v84
    v_mul_f32 v82, v82, v84
    v_mul_f32 v83, v83, v84
    v_cvt_pk_bf16_f32 v20, v76, v77
    v_cvt_pk_bf16_f32 v21, v78, v79
    v_cvt_pk_bf16_f32 v22, v80, v81
    v_cvt_pk_bf16_f32 v23, v82, v83
    buffer_store_dwordx4 v[20:23], v6, s[16:19], s80 offen offset:0 sc0 sc1
    v_fma_f32 v96, v96, s46, v11
    v_rcp_f32 v96, v96
    v_fma_f32 v108, v108, s46, v11
    v_rcp_f32 v108, v108
    v_mul_f32 v88, v88, v96
    v_mul_f32 v89, v89, v96
    v_mul_f32 v90, v90, v96
    v_mul_f32 v91, v91, v96
    v_mul_f32 v92, v92, v96
    v_mul_f32 v93, v93, v96
    v_mul_f32 v94, v94, v96
    v_mul_f32 v95, v95, v96
    v_cvt_pk_bf16_f32 v24, v88, v89
    v_cvt_pk_bf16_f32 v25, v90, v91
    v_cvt_pk_bf16_f32 v26, v92, v93
    v_cvt_pk_bf16_f32 v27, v94, v95
    buffer_store_dwordx4 v[24:27], v6, s[16:19], s79 offen offset:1024 sc0 sc1
    v_mul_f32 v100, v100, v108
    v_mul_f32 v101, v101, v108
    v_mul_f32 v102, v102, v108
    v_mul_f32 v103, v103, v108
    v_mul_f32 v104, v104, v108
    v_mul_f32 v105, v105, v108
    v_mul_f32 v106, v106, v108
    v_mul_f32 v107, v107, v108
    v_cvt_pk_bf16_f32 v28, v100, v101
    v_cvt_pk_bf16_f32 v29, v102, v103
    v_cvt_pk_bf16_f32 v30, v104, v105
    v_cvt_pk_bf16_f32 v31, v106, v107
    buffer_store_dwordx4 v[28:31], v6, s[16:19], s80 offen offset:1024 sc0 sc1
    s_mov_b64 exec, 1
    ds_write_b32 v4, v164 offset:144
    s_waitcnt vmcnt(0)
    s_mov_b32 s45, 1
    s_atomic_add s45, s[54:55], 0x0
    s_atomic_add s45, s[54:55], 0x80
    s_atomic_add s45, s[54:55], 0x100
    s_atomic_add s45, s[54:55], 0x180
    ds_add_u32 v4, v164 offset:144
    s_mov_b64 exec, -1
    s_cmp_lg_u32 s3, 0
    s_cbranch_scc1 F_end
    s_setprio 3
    s_lshr_b32 s50, s29, 1
    s_lshl_b32 s50, s50, 2
    s_and_b32 s51, s28, 3
    s_add_u32 s50, s50, s51
    s_lshl_b32 s50, s50, 7
    s_add_u32 s56, s50, 0x845000
    s_add_u32 s56, s72, s56
    s_addc_u32 s57, s73, 0
    v_mov_b32 v2, 159096
    ds_read_b32 v7, v2 offset:0
FW_13:
    s_waitcnt lgkmcnt(0)
    v_cmp_gt_u32 vcc, 1, v7
    s_cbranch_vccz FO_14
    s_sleep 2
    ds_read_b32 v7, v2 offset:0
    s_branch FW_13
FO_14:
    v_and_b32 v2, 7, v0
    v_lshlrev_b32 v2, 2, v2
    v_add_u32 v2, 158976, v2
    ds_read_b32 v2, v2
    s_sub_u32 s51, 15, s28
    s_waitcnt lgkmcnt(0)
    v_bfe_u32 v2, v2, 7, 4
    v_cmp_eq_u32 vcc, s51, v2
    s_cbranch_vccz F_ny

    v_lshrrev_b32 v2, 4, v0
    v_and_b32 v6, 15, v0
    v_lshlrev_b32 v6, 4, v6
    v_lshl_add_u32 v2, v2, 12, v6
    s_lshl_b32 s50, s29, 8
    s_add_u32 s50, s50, 135168

SP_15:
    s_load_dword s58, s[56:57], 0 glc
    s_waitcnt lgkmcnt(0)
    s_cmp_ge_u32 s58, 32
    s_cbranch_scc1 SD_16
    s_sleep 2
    s_branch SP_15
SD_16:
    s_mov_b32 m0, 159744
    s_nop 0
    buffer_load_dwordx4 v2, s[24:27], s50 offen sc0 sc1 lds
    s_add_u32 s50, s50, 16384
    s_add_u32 m0, m0, 1024
    s_nop 0
    buffer_load_dwordx4 v2, s[24:27], s50 offen sc0 sc1 lds
    s_waitcnt vmcnt(0)
    v_mov_b32 v7, 1
    s_mov_b64 exec, 1
    ds_write_b32 v4, v7 offset:96
    s_mov_b64 exec, -1
F_ny:
F_end:
    s_endpgm
F_nl:
    s_sub_u32 s3, s3, 4
    s_setprio 2
    s_lshr_b32 s36, s3, 1
    s_and_b32 s37, s3, 1
    v_and_b32 v1, 15, v0
    v_lshrrev_b32 v2, 4, v0
    v_lshrrev_b32 v3, 1, v1
    v_xor_b32 v3, v3, v2
    v_lshlrev_b32 v3, 4, v3
    v_lshlrev_b32 v1, 7, v1
    s_lshl_b32 s38, s36, 13
    v_add3_u32 v4, v1, v3, s38
    v_xor_b32 v5, 64, v4
    v_add_u32 v6, 0x10000, v4
    v_add_u32 v7, 0x10000, v5
    v_bfe_u32 v1, v0, 2, 2
    v_lshl_add_u32 v3, v2, 3, v1
    v_lshrrev_b32 v1, 1, v1
    v_and_b32 v2, 1, v2
    v_lshl_add_u32 v1, v2, 1, v1
    s_lshl_b32 s38, s37, 1
    s_add_u32 s38, s38, s36
    v_xor_b32 v1, s38, v1
    v_lshlrev_b32 v1, 5, v1
    v_lshl_add_u32 v1, v3, 7, v1
    v_and_b32 v2, 3, v0
    v_lshl_add_u32 v1, v2, 3, v1
    v_add_u32 v8, 0x10000, v1
    v_xor_b32 v9, 32, v8
    v_add_u32 v10, 0x8000, v8
    v_add_u32 v11, 0x8000, v9
    s_mov_b32 s40, 0x21317218
    s_mov_b32 s41, s40
    s_mov_b32 s74, 0x358637bd
    s_mov_b32 s75, s74
    s_mov_b32 s76, 0x5d800000
    s_mov_b32 s77, s76
    v_and_b32 v164, 0x30, v0
    s_lshl_b32 s42, s36, 8
    s_add_u32 s42, s42, 155648
    v_add_u32 v164, s42, v164
    v_and_b32 v165, 15, v0
    v_lshlrev_b32 v165, 2, v165
    s_lshl_b32 s42, s38, 6
    s_add_u32 s42, s42, 158208
    v_add_u32 v165, s42, v165
    s_lshl_b32 s42, s3, 2
    s_add_u32 s42, s42, 159040
    v_mov_b32 v3, s42
    v_lshlrev_b32 v1, 2, v2
    v_add_u32 v1, 159040, v1
    v_xor_b32 v2, 64, v165
    s_lshl_b32 s44, s33, 1
    s_add_u32 s44, s44, s37
    s_mul_i32 s45, s44, 4224
    s_mul_i32 s46, s36, 3072
    s_add_u32 s46, s46, s45
    s_lshl_b32 s47, s36, 10
    s_add_u32 s47, s47, 1024
    s_add_u32 s47, s47, s45
    s_lshl_b32 s48, s36, 6
    s_add_u32 s48, s48, 4096
    s_add_u32 s48, s48, s45
    s_lshl_b32 s49, s44, 10
    s_lshl_b32 s52, s3, 11
    s_add_u32 s52, s52, 65536
    s_lshl_b32 s53, s3, 7
    s_lshl_b32 s43, s36, 6
    s_add_u32 s53, s53, s43
    s_add_u32 s53, s53, 159232
    s_mov_b32 s50, 159068
    s_waitcnt lgkmcnt(0)
    s_lshl_b32 s64, s28, 7
    s_lshl_b32 s65, s3, 5
    s_add_u32 s64, s64, s65
    s_lshl_b32 s42, s64, 11
    s_lshl_b32 s65, s29, 7
    s_add_u32 s42, s42, s65
    s_add_u32 s43, s42, 0x8000
    s_lshl_b32 s66, s44, 1
    s_add_u32 s66, s66, s36
    s_lshl_b32 s66, s66, 4
    s_add_u32 s66, s66, s32
    s_lshl_b32 s66, s66, 10

    s_mov_b32 s12, s4
    s_mov_b32 s13, s5
    s_mov_b32 s14, 0x400000
    s_mov_b32 s15, 0x00020000
    s_mov_b32 s16, s6
    s_mov_b32 s17, s7
    s_mov_b32 s18, 0x600000
    s_mov_b32 s19, 0x00020000
    s_mov_b32 s20, s8
    s_mov_b32 s21, s9
    s_mov_b32 s22, 0x200000
    s_mov_b32 s23, 0x00020000
    s_add_u32 s24, s72, 0x800000
    s_addc_u32 s25, s73, 0
    s_mov_b32 s26, 0x48000
    s_mov_b32 s27, 0x00020000
    s_add_u32 s84, s72, 0xa00000
    s_addc_u32 s85, s73, 0
    s_mov_b32 s86, 0x100000
    s_mov_b32 s87, 0x00020000
    s_barrier
    ds_read_b128 v[12:15], v4 offset:0
    ds_read_b64_tr_b16 v[44:45], v8 offset:0
    ds_read_b64_tr_b16 v[46:47], v8 offset:512
    ds_read_b128 v[16:19], v4 offset:2048
    ds_read_b128 v[20:23], v4 offset:4096
    ds_read_b128 v[24:27], v4 offset:6144
    ds_read_b64_tr_b16 v[48:49], v9 offset:0
    ds_read_b64_tr_b16 v[50:51], v9 offset:512
    ds_read_b64_tr_b16 v[52:53], v8 offset:8192
    ds_read_b64_tr_b16 v[54:55], v8 offset:8704
    ds_read_b64_tr_b16 v[56:57], v9 offset:8192
    ds_read_b64_tr_b16 v[58:59], v9 offset:8704
    s_waitcnt lgkmcnt(9)
    v_mfma_f32_16x16x32_bf16 v[100:103], v[12:15], v[44:47], 0
    ds_read_b128 v[28:31], v5 offset:0
    s_waitcnt lgkmcnt(9)
    v_mfma_f32_16x16x32_bf16 v[104:107], v[16:19], v[44:47], 0
    ds_read_b64_tr_b16 v[60:61], v8 offset:4096
    s_waitcnt lgkmcnt(9)
    v_mfma_f32_16x16x32_bf16 v[108:111], v[20:23], v[44:47], 0
    ds_read_b64_tr_b16 v[62:63], v8 offset:4608
    s_waitcnt lgkmcnt(9)
    v_mfma_f32_16x16x32_bf16 v[112:115], v[24:27], v[44:47], 0
    ds_read_b128 v[32:35], v5 offset:2048
    s_waitcnt lgkmcnt(8)
    v_mfma_f32_16x16x32_bf16 v[116:119], v[12:15], v[48:51], 0
    ds_read_b128 v[36:39], v5 offset:4096
    v_mfma_f32_16x16x32_bf16 v[120:123], v[16:19], v[48:51], 0
    ds_read_b128 v[40:43], v5 offset:6144
    v_mfma_f32_16x16x32_bf16 v[124:127], v[20:23], v[48:51], 0
    ds_read_b64_tr_b16 v[64:65], v9 offset:4096
    v_mfma_f32_16x16x32_bf16 v[128:131], v[24:27], v[48:51], 0
    ds_read_b64_tr_b16 v[66:67], v9 offset:4608
    s_waitcnt lgkmcnt(10)
    v_mfma_f32_16x16x32_bf16 v[132:135], v[12:15], v[52:55], 0
    ds_read_b64_tr_b16 v[44:45], v8 offset:12288
    v_mfma_f32_16x16x32_bf16 v[136:139], v[16:19], v[52:55], 0
    ds_read_b64_tr_b16 v[46:47], v8 offset:12800
    v_mfma_f32_16x16x32_bf16 v[140:143], v[20:23], v[52:55], 0
    ds_read_b64_tr_b16 v[48:49], v9 offset:12288
    v_mfma_f32_16x16x32_bf16 v[144:147], v[24:27], v[52:55], 0
    ds_read_b64_tr_b16 v[50:51], v9 offset:12800
    s_waitcnt lgkmcnt(12)
    v_mfma_f32_16x16x32_bf16 v[148:151], v[12:15], v[56:59], 0
    v_mfma_f32_16x16x32_bf16 v[152:155], v[16:19], v[56:59], 0
    v_mfma_f32_16x16x32_bf16 v[156:159], v[20:23], v[56:59], 0
    v_mfma_f32_16x16x32_bf16 v[160:163], v[24:27], v[56:59], 0
    s_waitcnt lgkmcnt(9)
    v_mfma_f32_16x16x32_bf16 v[100:103], v[28:31], v[60:63], v[100:103]
    s_waitcnt lgkmcnt(8)
    v_mfma_f32_16x16x32_bf16 v[104:107], v[32:35], v[60:63], v[104:107]
    s_waitcnt lgkmcnt(0)
    s_barrier
    v_mfma_f32_16x16x32_bf16 v[108:111], v[36:39], v[60:63], v[108:111]
    ds_read_b128 v[12:15], v4 offset:16384
    v_mfma_f32_16x16x32_bf16 v[112:115], v[40:43], v[60:63], v[112:115]
    ds_read_b64_tr_b16 v[52:53], v8 offset:16384
    v_mfma_f32_16x16x32_bf16 v[116:119], v[28:31], v[64:67], v[116:119]
    ds_read_b64_tr_b16 v[54:55], v8 offset:16896
    v_mfma_f32_16x16x32_bf16 v[120:123], v[32:35], v[64:67], v[120:123]
    ds_read_b128 v[16:19], v4 offset:18432
    v_mfma_f32_16x16x32_bf16 v[124:127], v[36:39], v[64:67], v[124:127]
    ds_read_b128 v[20:23], v4 offset:20480
    v_mfma_f32_16x16x32_bf16 v[128:131], v[40:43], v[64:67], v[128:131]
    ds_read_b128 v[24:27], v4 offset:22528
    v_mfma_f32_16x16x32_bf16 v[132:135], v[28:31], v[44:47], v[132:135]
    ds_read_b64_tr_b16 v[56:57], v9 offset:16384
    v_mfma_f32_16x16x32_bf16 v[136:139], v[32:35], v[44:47], v[136:139]
    ds_read_b64_tr_b16 v[58:59], v9 offset:16896
    v_mfma_f32_16x16x32_bf16 v[140:143], v[36:39], v[44:47], v[140:143]
    ds_read_b64_tr_b16 v[60:61], v8 offset:24576
    v_mfma_f32_16x16x32_bf16 v[144:147], v[40:43], v[44:47], v[144:147]
    ds_read_b64_tr_b16 v[62:63], v8 offset:25088
    v_mfma_f32_16x16x32_bf16 v[148:151], v[28:31], v[48:51], v[148:151]
    ds_read_b64_tr_b16 v[64:65], v9 offset:24576
    v_mfma_f32_16x16x32_bf16 v[152:155], v[32:35], v[48:51], v[152:155]
    ds_read_b64_tr_b16 v[66:67], v9 offset:25088
    v_mfma_f32_16x16x32_bf16 v[156:159], v[36:39], v[48:51], v[156:159]
    v_mfma_f32_16x16x32_bf16 v[160:163], v[40:43], v[48:51], v[160:163]
    s_waitcnt lgkmcnt(9)
    v_mfma_f32_16x16x32_bf16 v[100:103], v[12:15], v[52:55], v[100:103]
    ds_read_b128 v[28:31], v5 offset:16384
    s_waitcnt lgkmcnt(9)
    v_mfma_f32_16x16x32_bf16 v[104:107], v[16:19], v[52:55], v[104:107]
    ds_read_b64_tr_b16 v[44:45], v8 offset:20480
    s_waitcnt lgkmcnt(9)
    v_mfma_f32_16x16x32_bf16 v[108:111], v[20:23], v[52:55], v[108:111]
    ds_read_b64_tr_b16 v[46:47], v8 offset:20992
    s_waitcnt lgkmcnt(9)
    v_mfma_f32_16x16x32_bf16 v[112:115], v[24:27], v[52:55], v[112:115]
    ds_read_b128 v[32:35], v5 offset:18432
    s_waitcnt lgkmcnt(8)
    v_mfma_f32_16x16x32_bf16 v[116:119], v[12:15], v[56:59], v[116:119]
    ds_read_b128 v[36:39], v5 offset:20480
    v_mfma_f32_16x16x32_bf16 v[120:123], v[16:19], v[56:59], v[120:123]
    ds_read_b128 v[40:43], v5 offset:22528
    v_mfma_f32_16x16x32_bf16 v[124:127], v[20:23], v[56:59], v[124:127]
    ds_read_b64_tr_b16 v[48:49], v9 offset:20480
    v_mfma_f32_16x16x32_bf16 v[128:131], v[24:27], v[56:59], v[128:131]
    ds_read_b64_tr_b16 v[50:51], v9 offset:20992
    s_waitcnt lgkmcnt(10)
    v_mfma_f32_16x16x32_bf16 v[132:135], v[12:15], v[60:63], v[132:135]
    ds_read_b64_tr_b16 v[52:53], v8 offset:28672
    v_mfma_f32_16x16x32_bf16 v[136:139], v[16:19], v[60:63], v[136:139]
    ds_read_b64_tr_b16 v[54:55], v8 offset:29184
    v_mfma_f32_16x16x32_bf16 v[140:143], v[20:23], v[60:63], v[140:143]
    ds_read_b64_tr_b16 v[56:57], v9 offset:28672
    v_mfma_f32_16x16x32_bf16 v[144:147], v[24:27], v[60:63], v[144:147]
    ds_read_b64_tr_b16 v[58:59], v9 offset:29184
    s_waitcnt lgkmcnt(12)
    v_mfma_f32_16x16x32_bf16 v[148:151], v[12:15], v[64:67], v[148:151]
    v_mfma_f32_16x16x32_bf16 v[152:155], v[16:19], v[64:67], v[152:155]
    v_mfma_f32_16x16x32_bf16 v[156:159], v[20:23], v[64:67], v[156:159]
    v_mfma_f32_16x16x32_bf16 v[160:163], v[24:27], v[64:67], v[160:163]
    s_waitcnt lgkmcnt(9)
    v_mfma_f32_16x16x32_bf16 v[100:103], v[28:31], v[44:47], v[100:103]
    s_waitcnt lgkmcnt(8)
    v_mfma_f32_16x16x32_bf16 v[104:107], v[32:35], v[44:47], v[104:107]
    s_waitcnt lgkmcnt(0)
    s_barrier
    v_mfma_f32_16x16x32_bf16 v[108:111], v[36:39], v[44:47], v[108:111]
    ds_read_b128 v[12:15], v4 offset:32768
    v_mfma_f32_16x16x32_bf16 v[112:115], v[40:43], v[44:47], v[112:115]
    ds_read_b64_tr_b16 v[60:61], v10 offset:16384
    v_mfma_f32_16x16x32_bf16 v[116:119], v[28:31], v[48:51], v[116:119]
    ds_read_b64_tr_b16 v[62:63], v10 offset:16896
    v_mfma_f32_16x16x32_bf16 v[120:123], v[32:35], v[48:51], v[120:123]
    ds_read_b128 v[16:19], v4 offset:34816
    v_mfma_f32_16x16x32_bf16 v[124:127], v[36:39], v[48:51], v[124:127]
    ds_read_b128 v[20:23], v4 offset:36864
    v_mfma_f32_16x16x32_bf16 v[128:131], v[40:43], v[48:51], v[128:131]
    ds_read_b128 v[24:27], v4 offset:38912
    v_mfma_f32_16x16x32_bf16 v[132:135], v[28:31], v[52:55], v[132:135]
    ds_read_b64_tr_b16 v[64:65], v11 offset:16384
    v_mfma_f32_16x16x32_bf16 v[136:139], v[32:35], v[52:55], v[136:139]
    ds_read_b64_tr_b16 v[66:67], v11 offset:16896
    v_mfma_f32_16x16x32_bf16 v[140:143], v[36:39], v[52:55], v[140:143]
    ds_read_b64_tr_b16 v[44:45], v10 offset:24576
    v_mfma_f32_16x16x32_bf16 v[144:147], v[40:43], v[52:55], v[144:147]
    ds_read_b64_tr_b16 v[46:47], v10 offset:25088
    v_mfma_f32_16x16x32_bf16 v[148:151], v[28:31], v[56:59], v[148:151]
    ds_read_b64_tr_b16 v[48:49], v11 offset:24576
    v_mfma_f32_16x16x32_bf16 v[152:155], v[32:35], v[56:59], v[152:155]
    ds_read_b64_tr_b16 v[50:51], v11 offset:25088
    v_mfma_f32_16x16x32_bf16 v[156:159], v[36:39], v[56:59], v[156:159]
    v_mfma_f32_16x16x32_bf16 v[160:163], v[40:43], v[56:59], v[160:163]
    s_waitcnt lgkmcnt(9)
    v_mfma_f32_16x16x32_bf16 v[100:103], v[12:15], v[60:63], v[100:103]
    ds_read_b128 v[28:31], v5 offset:32768
    s_waitcnt lgkmcnt(9)
    v_mfma_f32_16x16x32_bf16 v[104:107], v[16:19], v[60:63], v[104:107]
    ds_read_b64_tr_b16 v[52:53], v10 offset:20480
    s_waitcnt lgkmcnt(9)
    v_mfma_f32_16x16x32_bf16 v[108:111], v[20:23], v[60:63], v[108:111]
    ds_read_b64_tr_b16 v[54:55], v10 offset:20992
    s_waitcnt lgkmcnt(9)
    v_mfma_f32_16x16x32_bf16 v[112:115], v[24:27], v[60:63], v[112:115]
    ds_read_b128 v[32:35], v5 offset:34816
    s_waitcnt lgkmcnt(8)
    v_mfma_f32_16x16x32_bf16 v[116:119], v[12:15], v[64:67], v[116:119]
    ds_read_b128 v[36:39], v5 offset:36864
    v_mfma_f32_16x16x32_bf16 v[120:123], v[16:19], v[64:67], v[120:123]
    ds_read_b128 v[40:43], v5 offset:38912
    v_mfma_f32_16x16x32_bf16 v[124:127], v[20:23], v[64:67], v[124:127]
    ds_read_b64_tr_b16 v[56:57], v11 offset:20480
    v_mfma_f32_16x16x32_bf16 v[128:131], v[24:27], v[64:67], v[128:131]
    ds_read_b64_tr_b16 v[58:59], v11 offset:20992
    s_waitcnt lgkmcnt(10)
    v_mfma_f32_16x16x32_bf16 v[132:135], v[12:15], v[44:47], v[132:135]
    ds_read_b64_tr_b16 v[60:61], v10 offset:28672
    v_mfma_f32_16x16x32_bf16 v[136:139], v[16:19], v[44:47], v[136:139]
    ds_read_b64_tr_b16 v[62:63], v10 offset:29184
    v_mfma_f32_16x16x32_bf16 v[140:143], v[20:23], v[44:47], v[140:143]
    ds_read_b64_tr_b16 v[64:65], v11 offset:28672
    v_mfma_f32_16x16x32_bf16 v[144:147], v[24:27], v[44:47], v[144:147]
    ds_read_b64_tr_b16 v[66:67], v11 offset:29184
    s_waitcnt lgkmcnt(12)
    v_mfma_f32_16x16x32_bf16 v[148:151], v[12:15], v[48:51], v[148:151]
    v_mfma_f32_16x16x32_bf16 v[152:155], v[16:19], v[48:51], v[152:155]
    v_mfma_f32_16x16x32_bf16 v[156:159], v[20:23], v[48:51], v[156:159]
    v_mfma_f32_16x16x32_bf16 v[160:163], v[24:27], v[48:51], v[160:163]
    s_waitcnt lgkmcnt(9)
    s_branch IW_s3
IW_w3:
    s_branch IW_r3
IW_s3:
    v_mfma_f32_16x16x32_bf16 v[100:103], v[28:31], v[52:55], v[100:103]
    s_waitcnt lgkmcnt(8)
    v_mfma_f32_16x16x32_bf16 v[104:107], v[32:35], v[52:55], v[104:107]
    s_waitcnt lgkmcnt(0)
    s_barrier
    v_mfma_f32_16x16x32_bf16 v[108:111], v[36:39], v[52:55], v[108:111]
    ds_read_b128 v[12:15], v4 offset:49152
    v_mfma_f32_16x16x32_bf16 v[112:115], v[40:43], v[52:55], v[112:115]
    ds_read_b64_tr_b16 v[44:45], v10 offset:32768
    v_mfma_f32_16x16x32_bf16 v[116:119], v[28:31], v[56:59], v[116:119]
    ds_read_b64_tr_b16 v[46:47], v10 offset:33280
    v_mfma_f32_16x16x32_bf16 v[120:123], v[32:35], v[56:59], v[120:123]
    ds_read_b128 v[16:19], v4 offset:51200
    v_mfma_f32_16x16x32_bf16 v[124:127], v[36:39], v[56:59], v[124:127]
    ds_read_b128 v[20:23], v4 offset:53248
    v_mfma_f32_16x16x32_bf16 v[128:131], v[40:43], v[56:59], v[128:131]
    ds_read_b128 v[24:27], v4 offset:55296
    v_mfma_f32_16x16x32_bf16 v[132:135], v[28:31], v[60:63], v[132:135]
    ds_read_b64_tr_b16 v[48:49], v11 offset:32768
    v_mfma_f32_16x16x32_bf16 v[136:139], v[32:35], v[60:63], v[136:139]
    ds_read_b64_tr_b16 v[50:51], v11 offset:33280
    v_mfma_f32_16x16x32_bf16 v[140:143], v[36:39], v[60:63], v[140:143]
    ds_read_b64_tr_b16 v[52:53], v8 offset:0
    v_mfma_f32_16x16x32_bf16 v[144:147], v[40:43], v[60:63], v[144:147]
    ds_read_b64_tr_b16 v[54:55], v8 offset:512
    v_mfma_f32_16x16x32_bf16 v[148:151], v[28:31], v[64:67], v[148:151]
    ds_read_b64_tr_b16 v[56:57], v9 offset:0
    v_mfma_f32_16x16x32_bf16 v[152:155], v[32:35], v[64:67], v[152:155]
    ds_read_b64_tr_b16 v[58:59], v9 offset:512
    v_mfma_f32_16x16x32_bf16 v[156:159], v[36:39], v[64:67], v[156:159]
    v_mfma_f32_16x16x32_bf16 v[160:163], v[40:43], v[64:67], v[160:163]
    s_waitcnt lgkmcnt(9)
    v_mfma_f32_16x16x32_bf16 v[100:103], v[12:15], v[44:47], v[100:103]
    ds_read_b128 v[28:31], v5 offset:49152
    s_waitcnt lgkmcnt(9)
    v_mfma_f32_16x16x32_bf16 v[104:107], v[16:19], v[44:47], v[104:107]
    ds_read_b64_tr_b16 v[60:61], v10 offset:36864
    s_waitcnt lgkmcnt(9)
    v_mfma_f32_16x16x32_bf16 v[108:111], v[20:23], v[44:47], v[108:111]
    ds_read_b64_tr_b16 v[62:63], v10 offset:37376
    s_waitcnt lgkmcnt(9)
    v_mfma_f32_16x16x32_bf16 v[112:115], v[24:27], v[44:47], v[112:115]
    ds_read_b128 v[32:35], v5 offset:51200
    s_waitcnt lgkmcnt(8)
    v_mfma_f32_16x16x32_bf16 v[116:119], v[12:15], v[48:51], v[116:119]
    ds_read_b128 v[36:39], v5 offset:53248
    v_mfma_f32_16x16x32_bf16 v[120:123], v[16:19], v[48:51], v[120:123]
    ds_read_b128 v[40:43], v5 offset:55296
    v_mfma_f32_16x16x32_bf16 v[124:127], v[20:23], v[48:51], v[124:127]
    ds_read_b64_tr_b16 v[64:65], v11 offset:36864
    v_mfma_f32_16x16x32_bf16 v[128:131], v[24:27], v[48:51], v[128:131]
    ds_read_b64_tr_b16 v[66:67], v11 offset:37376
    s_waitcnt lgkmcnt(10)
    v_mfma_f32_16x16x32_bf16 v[132:135], v[12:15], v[52:55], v[132:135]
    ds_read_b64_tr_b16 v[44:45], v8 offset:4096
    v_mfma_f32_16x16x32_bf16 v[136:139], v[16:19], v[52:55], v[136:139]
    ds_read_b64_tr_b16 v[46:47], v8 offset:4608
    v_mfma_f32_16x16x32_bf16 v[140:143], v[20:23], v[52:55], v[140:143]
    ds_read_b64_tr_b16 v[48:49], v9 offset:4096
    v_mfma_f32_16x16x32_bf16 v[144:147], v[24:27], v[52:55], v[144:147]
    ds_read_b64_tr_b16 v[50:51], v9 offset:4608
    s_waitcnt lgkmcnt(12)
    v_mfma_f32_16x16x32_bf16 v[148:151], v[12:15], v[56:59], v[148:151]
    v_mfma_f32_16x16x32_bf16 v[152:155], v[16:19], v[56:59], v[152:155]
    v_mfma_f32_16x16x32_bf16 v[156:159], v[20:23], v[56:59], v[156:159]
    v_mfma_f32_16x16x32_bf16 v[160:163], v[24:27], v[56:59], v[160:163]
    s_waitcnt lgkmcnt(9)
    v_mfma_f32_16x16x32_bf16 v[100:103], v[28:31], v[60:63], v[100:103]
    s_waitcnt lgkmcnt(8)
    v_mfma_f32_16x16x32_bf16 v[104:107], v[32:35], v[60:63], v[104:107]
    s_waitcnt lgkmcnt(0)
    s_barrier
    v_mfma_f32_16x16x32_bf16 v[108:111], v[36:39], v[60:63], v[108:111]
    ds_read_b128 v[12:15], v4 offset:0
    v_mfma_f32_16x16x32_bf16 v[112:115], v[40:43], v[60:63], v[112:115]
    ds_read_b64_tr_b16 v[52:53], v8 offset:8192
    v_mfma_f32_16x16x32_bf16 v[116:119], v[28:31], v[64:67], v[116:119]
    ds_read_b64_tr_b16 v[54:55], v8 offset:8704
    v_mfma_f32_16x16x32_bf16 v[120:123], v[32:35], v[64:67], v[120:123]
    ds_read_b128 v[16:19], v4 offset:2048
    v_mfma_f32_16x16x32_bf16 v[124:127], v[36:39], v[64:67], v[124:127]
    ds_read_b128 v[20:23], v4 offset:4096
    v_mfma_f32_16x16x32_bf16 v[128:131], v[40:43], v[64:67], v[128:131]
    ds_read_b128 v[24:27], v4 offset:6144
    v_mfma_f32_16x16x32_bf16 v[132:135], v[28:31], v[44:47], v[132:135]
    ds_read_b64_tr_b16 v[56:57], v9 offset:8192
    v_mfma_f32_16x16x32_bf16 v[136:139], v[32:35], v[44:47], v[136:139]
    ds_read_b64_tr_b16 v[58:59], v9 offset:8704
    v_mfma_f32_16x16x32_bf16 v[140:143], v[36:39], v[44:47], v[140:143]
    ds_read_b64_tr_b16 v[60:61], v8 offset:16384
    v_mfma_f32_16x16x32_bf16 v[144:147], v[40:43], v[44:47], v[144:147]
    ds_read_b64_tr_b16 v[62:63], v8 offset:16896
    v_mfma_f32_16x16x32_bf16 v[148:151], v[28:31], v[48:51], v[148:151]
    ds_read_b64_tr_b16 v[64:65], v9 offset:16384
    v_mfma_f32_16x16x32_bf16 v[152:155], v[32:35], v[48:51], v[152:155]
    ds_read_b64_tr_b16 v[66:67], v9 offset:16896
    v_mfma_f32_16x16x32_bf16 v[156:159], v[36:39], v[48:51], v[156:159]
    v_mfma_f32_16x16x32_bf16 v[160:163], v[40:43], v[48:51], v[160:163]
    s_waitcnt lgkmcnt(9)
    v_mfma_f32_16x16x32_bf16 v[100:103], v[12:15], v[52:55], v[100:103]
    ds_read_b128 v[28:31], v5 offset:0
    s_waitcnt lgkmcnt(9)
    v_mfma_f32_16x16x32_bf16 v[104:107], v[16:19], v[52:55], v[104:107]
    ds_read_b64_tr_b16 v[44:45], v8 offset:12288
    s_waitcnt lgkmcnt(9)
    v_mfma_f32_16x16x32_bf16 v[108:111], v[20:23], v[52:55], v[108:111]
    ds_read_b64_tr_b16 v[46:47], v8 offset:12800
    s_waitcnt lgkmcnt(9)
    v_mfma_f32_16x16x32_bf16 v[112:115], v[24:27], v[52:55], v[112:115]
    ds_read_b128 v[32:35], v5 offset:2048
    s_waitcnt lgkmcnt(8)
    v_mfma_f32_16x16x32_bf16 v[116:119], v[12:15], v[56:59], v[116:119]
    ds_read_b128 v[36:39], v5 offset:4096
    v_mfma_f32_16x16x32_bf16 v[120:123], v[16:19], v[56:59], v[120:123]
    ds_read_b128 v[40:43], v5 offset:6144
    v_mfma_f32_16x16x32_bf16 v[124:127], v[20:23], v[56:59], v[124:127]
    ds_read_b64_tr_b16 v[48:49], v9 offset:12288
    v_mfma_f32_16x16x32_bf16 v[128:131], v[24:27], v[56:59], v[128:131]
    ds_read_b64_tr_b16 v[50:51], v9 offset:12800
    s_waitcnt lgkmcnt(10)
    v_mfma_f32_16x16x32_bf16 v[132:135], v[12:15], v[60:63], v[132:135]
    ds_read_b64_tr_b16 v[52:53], v8 offset:20480
    v_mfma_f32_16x16x32_bf16 v[136:139], v[16:19], v[60:63], v[136:139]
    ds_read_b64_tr_b16 v[54:55], v8 offset:20992
    v_mfma_f32_16x16x32_bf16 v[140:143], v[20:23], v[60:63], v[140:143]
    ds_read_b64_tr_b16 v[56:57], v9 offset:20480
    v_mfma_f32_16x16x32_bf16 v[144:147], v[24:27], v[60:63], v[144:147]
    ds_read_b64_tr_b16 v[58:59], v9 offset:20992
    s_waitcnt lgkmcnt(12)
    v_mfma_f32_16x16x32_bf16 v[148:151], v[12:15], v[64:67], v[148:151]
    v_mfma_f32_16x16x32_bf16 v[152:155], v[16:19], v[64:67], v[152:155]
    v_mfma_f32_16x16x32_bf16 v[156:159], v[20:23], v[64:67], v[156:159]
    v_mfma_f32_16x16x32_bf16 v[160:163], v[24:27], v[64:67], v[160:163]
    s_waitcnt lgkmcnt(9)
    v_mfma_f32_16x16x32_bf16 v[100:103], v[28:31], v[44:47], v[100:103]
    s_waitcnt lgkmcnt(8)
    v_mfma_f32_16x16x32_bf16 v[104:107], v[32:35], v[44:47], v[104:107]
    s_waitcnt lgkmcnt(0)
    s_barrier
    v_mfma_f32_16x16x32_bf16 v[108:111], v[36:39], v[44:47], v[108:111]
    ds_read_b128 v[12:15], v4 offset:16384
    v_mfma_f32_16x16x32_bf16 v[112:115], v[40:43], v[44:47], v[112:115]
    ds_read_b64_tr_b16 v[60:61], v10 offset:0
    v_mfma_f32_16x16x32_bf16 v[116:119], v[28:31], v[48:51], v[116:119]
    ds_read_b64_tr_b16 v[62:63], v10 offset:512
    v_mfma_f32_16x16x32_bf16 v[120:123], v[32:35], v[48:51], v[120:123]
    ds_read_b128 v[16:19], v4 offset:18432
    v_mfma_f32_16x16x32_bf16 v[124:127], v[36:39], v[48:51], v[124:127]
    ds_read_b128 v[20:23], v4 offset:20480
    v_mfma_f32_16x16x32_bf16 v[128:131], v[40:43], v[48:51], v[128:131]
    ds_read_b128 v[24:27], v4 offset:22528
    v_mfma_f32_16x16x32_bf16 v[132:135], v[28:31], v[52:55], v[132:135]
    ds_read_b64_tr_b16 v[64:65], v11 offset:0
    v_mfma_f32_16x16x32_bf16 v[136:139], v[32:35], v[52:55], v[136:139]
    ds_read_b64_tr_b16 v[66:67], v11 offset:512
    v_mfma_f32_16x16x32_bf16 v[140:143], v[36:39], v[52:55], v[140:143]
    ds_read_b64_tr_b16 v[44:45], v10 offset:8192
    v_mfma_f32_16x16x32_bf16 v[144:147], v[40:43], v[52:55], v[144:147]
    ds_read_b64_tr_b16 v[46:47], v10 offset:8704
    v_mfma_f32_16x16x32_bf16 v[148:151], v[28:31], v[56:59], v[148:151]
    ds_read_b64_tr_b16 v[48:49], v11 offset:8192
    v_mfma_f32_16x16x32_bf16 v[152:155], v[32:35], v[56:59], v[152:155]
    ds_read_b64_tr_b16 v[50:51], v11 offset:8704
    v_mfma_f32_16x16x32_bf16 v[156:159], v[36:39], v[56:59], v[156:159]
    v_mfma_f32_16x16x32_bf16 v[160:163], v[40:43], v[56:59], v[160:163]
    s_waitcnt lgkmcnt(9)
    v_mfma_f32_16x16x32_bf16 v[100:103], v[12:15], v[60:63], v[100:103]
    ds_read_b128 v[28:31], v5 offset:16384
    s_waitcnt lgkmcnt(9)
    v_mfma_f32_16x16x32_bf16 v[104:107], v[16:19], v[60:63], v[104:107]
    ds_read_b64_tr_b16 v[52:53], v10 offset:4096
    s_waitcnt lgkmcnt(9)
    v_mfma_f32_16x16x32_bf16 v[108:111], v[20:23], v[60:63], v[108:111]
    ds_read_b64_tr_b16 v[54:55], v10 offset:4608
    s_waitcnt lgkmcnt(9)
    v_mfma_f32_16x16x32_bf16 v[112:115], v[24:27], v[60:63], v[112:115]
    ds_read_b128 v[32:35], v5 offset:18432
    s_waitcnt lgkmcnt(8)
    v_mfma_f32_16x16x32_bf16 v[116:119], v[12:15], v[64:67], v[116:119]
    ds_read_b128 v[36:39], v5 offset:20480
    v_mfma_f32_16x16x32_bf16 v[120:123], v[16:19], v[64:67], v[120:123]
    ds_read_b128 v[40:43], v5 offset:22528
    v_mfma_f32_16x16x32_bf16 v[124:127], v[20:23], v[64:67], v[124:127]
    ds_read_b64_tr_b16 v[56:57], v11 offset:4096
    v_mfma_f32_16x16x32_bf16 v[128:131], v[24:27], v[64:67], v[128:131]
    ds_read_b64_tr_b16 v[58:59], v11 offset:4608
    s_waitcnt lgkmcnt(10)
    v_mfma_f32_16x16x32_bf16 v[132:135], v[12:15], v[44:47], v[132:135]
    ds_read_b64_tr_b16 v[60:61], v10 offset:12288
    v_mfma_f32_16x16x32_bf16 v[136:139], v[16:19], v[44:47], v[136:139]
    ds_read_b64_tr_b16 v[62:63], v10 offset:12800
    v_mfma_f32_16x16x32_bf16 v[140:143], v[20:23], v[44:47], v[140:143]
    ds_read_b64_tr_b16 v[64:65], v11 offset:12288
    v_mfma_f32_16x16x32_bf16 v[144:147], v[24:27], v[44:47], v[144:147]
    ds_read_b64_tr_b16 v[66:67], v11 offset:12800
    s_waitcnt lgkmcnt(12)
    v_mfma_f32_16x16x32_bf16 v[148:151], v[12:15], v[48:51], v[148:151]
    v_mfma_f32_16x16x32_bf16 v[152:155], v[16:19], v[48:51], v[152:155]
    v_mfma_f32_16x16x32_bf16 v[156:159], v[20:23], v[48:51], v[156:159]
    v_mfma_f32_16x16x32_bf16 v[160:163], v[24:27], v[48:51], v[160:163]
    s_waitcnt lgkmcnt(9)
    v_mfma_f32_16x16x32_bf16 v[100:103], v[28:31], v[52:55], v[100:103]
    s_waitcnt lgkmcnt(8)
    v_mfma_f32_16x16x32_bf16 v[104:107], v[32:35], v[52:55], v[104:107]
    s_waitcnt lgkmcnt(0)
    s_barrier
    v_mfma_f32_16x16x32_bf16 v[108:111], v[36:39], v[52:55], v[108:111]
    ds_read_b128 v[12:15], v4 offset:32768
    v_mfma_f32_16x16x32_bf16 v[112:115], v[40:43], v[52:55], v[112:115]
    ds_read_b64_tr_b16 v[44:45], v10 offset:16384
    v_mfma_f32_16x16x32_bf16 v[116:119], v[28:31], v[56:59], v[116:119]
    ds_read_b64_tr_b16 v[46:47], v10 offset:16896
    v_mfma_f32_16x16x32_bf16 v[120:123], v[32:35], v[56:59], v[120:123]
    ds_read_b128 v[16:19], v4 offset:34816
    v_mfma_f32_16x16x32_bf16 v[124:127], v[36:39], v[56:59], v[124:127]
    ds_read_b128 v[20:23], v4 offset:36864
    v_mfma_f32_16x16x32_bf16 v[128:131], v[40:43], v[56:59], v[128:131]
    ds_read_b128 v[24:27], v4 offset:38912
    v_mfma_f32_16x16x32_bf16 v[132:135], v[28:31], v[60:63], v[132:135]
    ds_read_b64_tr_b16 v[48:49], v11 offset:16384
    v_mfma_f32_16x16x32_bf16 v[136:139], v[32:35], v[60:63], v[136:139]
    ds_read_b64_tr_b16 v[50:51], v11 offset:16896
    v_mfma_f32_16x16x32_bf16 v[140:143], v[36:39], v[60:63], v[140:143]
    ds_read_b64_tr_b16 v[52:53], v10 offset:24576
    v_mfma_f32_16x16x32_bf16 v[144:147], v[40:43], v[60:63], v[144:147]
    ds_read_b64_tr_b16 v[54:55], v10 offset:25088
    v_mfma_f32_16x16x32_bf16 v[148:151], v[28:31], v[64:67], v[148:151]
    ds_read_b64_tr_b16 v[56:57], v11 offset:24576
    v_mfma_f32_16x16x32_bf16 v[152:155], v[32:35], v[64:67], v[152:155]
    ds_read_b64_tr_b16 v[58:59], v11 offset:25088
    v_mfma_f32_16x16x32_bf16 v[156:159], v[36:39], v[64:67], v[156:159]
    v_mfma_f32_16x16x32_bf16 v[160:163], v[40:43], v[64:67], v[160:163]
    s_waitcnt lgkmcnt(9)
    v_mfma_f32_16x16x32_bf16 v[100:103], v[12:15], v[44:47], v[100:103]
    ds_read_b128 v[28:31], v5 offset:32768
    s_waitcnt lgkmcnt(9)
    v_mfma_f32_16x16x32_bf16 v[104:107], v[16:19], v[44:47], v[104:107]
    ds_read_b64_tr_b16 v[60:61], v10 offset:20480
    s_waitcnt lgkmcnt(9)
    v_mfma_f32_16x16x32_bf16 v[108:111], v[20:23], v[44:47], v[108:111]
    ds_read_b64_tr_b16 v[62:63], v10 offset:20992
    s_waitcnt lgkmcnt(9)
    v_mfma_f32_16x16x32_bf16 v[112:115], v[24:27], v[44:47], v[112:115]
    ds_read_b128 v[32:35], v5 offset:34816
    s_waitcnt lgkmcnt(8)
    v_mfma_f32_16x16x32_bf16 v[116:119], v[12:15], v[48:51], v[116:119]
    ds_read_b128 v[36:39], v5 offset:36864
    v_mfma_f32_16x16x32_bf16 v[120:123], v[16:19], v[48:51], v[120:123]
    ds_read_b128 v[40:43], v5 offset:38912
    v_mfma_f32_16x16x32_bf16 v[124:127], v[20:23], v[48:51], v[124:127]
    ds_read_b64_tr_b16 v[64:65], v11 offset:20480
    v_mfma_f32_16x16x32_bf16 v[128:131], v[24:27], v[48:51], v[128:131]
    ds_read_b64_tr_b16 v[66:67], v11 offset:20992
    s_waitcnt lgkmcnt(10)
    v_mfma_f32_16x16x32_bf16 v[132:135], v[12:15], v[52:55], v[132:135]
    ds_read_b64_tr_b16 v[44:45], v10 offset:28672
    v_mfma_f32_16x16x32_bf16 v[136:139], v[16:19], v[52:55], v[136:139]
    ds_read_b64_tr_b16 v[46:47], v10 offset:29184
    v_mfma_f32_16x16x32_bf16 v[140:143], v[20:23], v[52:55], v[140:143]
    ds_read_b64_tr_b16 v[48:49], v11 offset:28672
    v_mfma_f32_16x16x32_bf16 v[144:147], v[24:27], v[52:55], v[144:147]
    ds_read_b64_tr_b16 v[50:51], v11 offset:29184
    s_waitcnt lgkmcnt(12)
    v_mfma_f32_16x16x32_bf16 v[148:151], v[12:15], v[56:59], v[148:151]
    v_mfma_f32_16x16x32_bf16 v[152:155], v[16:19], v[56:59], v[152:155]
    v_mfma_f32_16x16x32_bf16 v[156:159], v[20:23], v[56:59], v[156:159]
    v_mfma_f32_16x16x32_bf16 v[160:163], v[24:27], v[56:59], v[160:163]
    s_waitcnt lgkmcnt(9)
    v_mfma_f32_16x16x32_bf16 v[100:103], v[28:31], v[60:63], v[100:103]
    s_waitcnt lgkmcnt(8)
    v_mfma_f32_16x16x32_bf16 v[104:107], v[32:35], v[60:63], v[104:107]
    s_waitcnt lgkmcnt(0)
    s_barrier
    v_mfma_f32_16x16x32_bf16 v[108:111], v[36:39], v[60:63], v[108:111]
    ds_read_b128 v[12:15], v4 offset:49152
    v_mfma_f32_16x16x32_bf16 v[112:115], v[40:43], v[60:63], v[112:115]
    ds_read_b64_tr_b16 v[52:53], v8 offset:0
    v_mfma_f32_16x16x32_bf16 v[116:119], v[28:31], v[64:67], v[116:119]
    ds_read_b64_tr_b16 v[54:55], v8 offset:512
    v_mfma_f32_16x16x32_bf16 v[120:123], v[32:35], v[64:67], v[120:123]
    ds_read_b128 v[16:19], v4 offset:51200
    v_mfma_f32_16x16x32_bf16 v[124:127], v[36:39], v[64:67], v[124:127]
    ds_read_b128 v[20:23], v4 offset:53248
    v_mfma_f32_16x16x32_bf16 v[128:131], v[40:43], v[64:67], v[128:131]
    ds_read_b128 v[24:27], v4 offset:55296
    v_mfma_f32_16x16x32_bf16 v[132:135], v[28:31], v[44:47], v[132:135]
    ds_read_b64_tr_b16 v[56:57], v9 offset:0
    v_mfma_f32_16x16x32_bf16 v[136:139], v[32:35], v[44:47], v[136:139]
    ds_read_b64_tr_b16 v[58:59], v9 offset:512
    v_mfma_f32_16x16x32_bf16 v[140:143], v[36:39], v[44:47], v[140:143]
    ds_read_b64_tr_b16 v[60:61], v10 offset:32768
    v_mfma_f32_16x16x32_bf16 v[144:147], v[40:43], v[44:47], v[144:147]
    ds_read_b64_tr_b16 v[62:63], v10 offset:33280
    v_mfma_f32_16x16x32_bf16 v[148:151], v[28:31], v[48:51], v[148:151]
    ds_read_b64_tr_b16 v[64:65], v11 offset:32768
    v_mfma_f32_16x16x32_bf16 v[152:155], v[32:35], v[48:51], v[152:155]
    ds_read_b64_tr_b16 v[66:67], v11 offset:33280
    v_mfma_f32_16x16x32_bf16 v[156:159], v[36:39], v[48:51], v[156:159]
    v_mfma_f32_16x16x32_bf16 v[160:163], v[40:43], v[48:51], v[160:163]
    s_waitcnt lgkmcnt(9)
    v_mfma_f32_16x16x32_bf16 v[100:103], v[12:15], v[52:55], v[100:103]
    ds_read_b128 v[28:31], v5 offset:49152
    s_waitcnt lgkmcnt(9)
    v_mfma_f32_16x16x32_bf16 v[104:107], v[16:19], v[52:55], v[104:107]
    ds_read_b64_tr_b16 v[44:45], v8 offset:4096
    s_waitcnt lgkmcnt(9)
    v_mfma_f32_16x16x32_bf16 v[108:111], v[20:23], v[52:55], v[108:111]
    ds_read_b64_tr_b16 v[46:47], v8 offset:4608
    s_waitcnt lgkmcnt(9)
    v_mfma_f32_16x16x32_bf16 v[112:115], v[24:27], v[52:55], v[112:115]
    ds_read_b128 v[32:35], v5 offset:51200
    s_waitcnt lgkmcnt(8)
    v_mfma_f32_16x16x32_bf16 v[116:119], v[12:15], v[56:59], v[116:119]
    ds_read_b128 v[36:39], v5 offset:53248
    v_mfma_f32_16x16x32_bf16 v[120:123], v[16:19], v[56:59], v[120:123]
    ds_read_b128 v[40:43], v5 offset:55296
    v_mfma_f32_16x16x32_bf16 v[124:127], v[20:23], v[56:59], v[124:127]
    ds_read_b64_tr_b16 v[48:49], v9 offset:4096
    v_mfma_f32_16x16x32_bf16 v[128:131], v[24:27], v[56:59], v[128:131]
    ds_read_b64_tr_b16 v[50:51], v9 offset:4608
    s_waitcnt lgkmcnt(10)
    v_mfma_f32_16x16x32_bf16 v[132:135], v[12:15], v[60:63], v[132:135]
    ds_read_b64_tr_b16 v[52:53], v10 offset:36864
    v_mfma_f32_16x16x32_bf16 v[136:139], v[16:19], v[60:63], v[136:139]
    ds_read_b64_tr_b16 v[54:55], v10 offset:37376
    v_mfma_f32_16x16x32_bf16 v[140:143], v[20:23], v[60:63], v[140:143]
    ds_read_b64_tr_b16 v[56:57], v11 offset:36864
    v_mfma_f32_16x16x32_bf16 v[144:147], v[24:27], v[60:63], v[144:147]
    ds_read_b64_tr_b16 v[58:59], v11 offset:37376
    s_waitcnt lgkmcnt(12)
    v_mfma_f32_16x16x32_bf16 v[148:151], v[12:15], v[64:67], v[148:151]
    v_mfma_f32_16x16x32_bf16 v[152:155], v[16:19], v[64:67], v[152:155]
    v_mfma_f32_16x16x32_bf16 v[156:159], v[20:23], v[64:67], v[156:159]
    v_mfma_f32_16x16x32_bf16 v[160:163], v[24:27], v[64:67], v[160:163]
    s_waitcnt lgkmcnt(9)
    v_mfma_f32_16x16x32_bf16 v[100:103], v[28:31], v[44:47], v[100:103]
    s_waitcnt lgkmcnt(8)
    v_mfma_f32_16x16x32_bf16 v[104:107], v[32:35], v[44:47], v[104:107]
    s_waitcnt lgkmcnt(0)
    s_barrier
    v_mfma_f32_16x16x32_bf16 v[108:111], v[36:39], v[44:47], v[108:111]
    ds_read_b128 v[12:15], v4 offset:0
    v_mfma_f32_16x16x32_bf16 v[112:115], v[40:43], v[44:47], v[112:115]
    ds_read_b64_tr_b16 v[60:61], v8 offset:8192
    v_mfma_f32_16x16x32_bf16 v[116:119], v[28:31], v[48:51], v[116:119]
    ds_read_b64_tr_b16 v[62:63], v8 offset:8704
    v_mfma_f32_16x16x32_bf16 v[120:123], v[32:35], v[48:51], v[120:123]
    ds_read_b128 v[16:19], v4 offset:2048
    v_mfma_f32_16x16x32_bf16 v[124:127], v[36:39], v[48:51], v[124:127]
    ds_read_b128 v[20:23], v4 offset:4096
    v_mfma_f32_16x16x32_bf16 v[128:131], v[40:43], v[48:51], v[128:131]
    ds_read_b128 v[24:27], v4 offset:6144
    v_mfma_f32_16x16x32_bf16 v[132:135], v[28:31], v[52:55], v[132:135]
    ds_read_b64_tr_b16 v[64:65], v9 offset:8192
    v_mfma_f32_16x16x32_bf16 v[136:139], v[32:35], v[52:55], v[136:139]
    ds_read_b64_tr_b16 v[66:67], v9 offset:8704
    v_mfma_f32_16x16x32_bf16 v[140:143], v[36:39], v[52:55], v[140:143]
    ds_read_b64_tr_b16 v[44:45], v8 offset:16384
    v_mfma_f32_16x16x32_bf16 v[144:147], v[40:43], v[52:55], v[144:147]
    ds_read_b64_tr_b16 v[46:47], v8 offset:16896
    v_mfma_f32_16x16x32_bf16 v[148:151], v[28:31], v[56:59], v[148:151]
    ds_read_b64_tr_b16 v[48:49], v9 offset:16384
    v_mfma_f32_16x16x32_bf16 v[152:155], v[32:35], v[56:59], v[152:155]
    ds_read_b64_tr_b16 v[50:51], v9 offset:16896
    v_mfma_f32_16x16x32_bf16 v[156:159], v[36:39], v[56:59], v[156:159]
    v_mfma_f32_16x16x32_bf16 v[160:163], v[40:43], v[56:59], v[160:163]
    s_waitcnt lgkmcnt(9)
    v_mfma_f32_16x16x32_bf16 v[100:103], v[12:15], v[60:63], v[100:103]
    ds_read_b128 v[28:31], v5 offset:0
    s_waitcnt lgkmcnt(9)
    v_mfma_f32_16x16x32_bf16 v[104:107], v[16:19], v[60:63], v[104:107]
    ds_read_b64_tr_b16 v[52:53], v8 offset:12288
    s_waitcnt lgkmcnt(9)
    v_mfma_f32_16x16x32_bf16 v[108:111], v[20:23], v[60:63], v[108:111]
    ds_read_b64_tr_b16 v[54:55], v8 offset:12800
    s_waitcnt lgkmcnt(9)
    v_mfma_f32_16x16x32_bf16 v[112:115], v[24:27], v[60:63], v[112:115]
    ds_read_b128 v[32:35], v5 offset:2048
    s_waitcnt lgkmcnt(8)
    v_mfma_f32_16x16x32_bf16 v[116:119], v[12:15], v[64:67], v[116:119]
    ds_read_b128 v[36:39], v5 offset:4096
    v_mfma_f32_16x16x32_bf16 v[120:123], v[16:19], v[64:67], v[120:123]
    ds_read_b128 v[40:43], v5 offset:6144
    v_mfma_f32_16x16x32_bf16 v[124:127], v[20:23], v[64:67], v[124:127]
    ds_read_b64_tr_b16 v[56:57], v9 offset:12288
    v_mfma_f32_16x16x32_bf16 v[128:131], v[24:27], v[64:67], v[128:131]
    ds_read_b64_tr_b16 v[58:59], v9 offset:12800
    s_waitcnt lgkmcnt(10)
    v_mfma_f32_16x16x32_bf16 v[132:135], v[12:15], v[44:47], v[132:135]
    ds_read_b64_tr_b16 v[60:61], v8 offset:20480
    v_mfma_f32_16x16x32_bf16 v[136:139], v[16:19], v[44:47], v[136:139]
    ds_read_b64_tr_b16 v[62:63], v8 offset:20992
    v_mfma_f32_16x16x32_bf16 v[140:143], v[20:23], v[44:47], v[140:143]
    ds_read_b64_tr_b16 v[64:65], v9 offset:20480
    v_mfma_f32_16x16x32_bf16 v[144:147], v[24:27], v[44:47], v[144:147]
    ds_read_b64_tr_b16 v[66:67], v9 offset:20992
    s_waitcnt lgkmcnt(12)
    v_mfma_f32_16x16x32_bf16 v[148:151], v[12:15], v[48:51], v[148:151]
    v_mfma_f32_16x16x32_bf16 v[152:155], v[16:19], v[48:51], v[152:155]
    v_mfma_f32_16x16x32_bf16 v[156:159], v[20:23], v[48:51], v[156:159]
    v_mfma_f32_16x16x32_bf16 v[160:163], v[24:27], v[48:51], v[160:163]
    s_waitcnt lgkmcnt(9)
    v_mfma_f32_16x16x32_bf16 v[100:103], v[28:31], v[52:55], v[100:103]
    s_waitcnt lgkmcnt(8)
    v_mfma_f32_16x16x32_bf16 v[104:107], v[32:35], v[52:55], v[104:107]
    s_waitcnt lgkmcnt(0)
    s_barrier
    v_mfma_f32_16x16x32_bf16 v[108:111], v[36:39], v[52:55], v[108:111]
    ds_read_b128 v[12:15], v4 offset:16384
    v_mfma_f32_16x16x32_bf16 v[112:115], v[40:43], v[52:55], v[112:115]
    ds_read_b64_tr_b16 v[44:45], v8 offset:24576
    v_mfma_f32_16x16x32_bf16 v[116:119], v[28:31], v[56:59], v[116:119]
    ds_read_b64_tr_b16 v[46:47], v8 offset:25088
    v_mfma_f32_16x16x32_bf16 v[120:123], v[32:35], v[56:59], v[120:123]
    ds_read_b128 v[16:19], v4 offset:18432
    v_mfma_f32_16x16x32_bf16 v[124:127], v[36:39], v[56:59], v[124:127]
    ds_read_b128 v[20:23], v4 offset:20480
    v_mfma_f32_16x16x32_bf16 v[128:131], v[40:43], v[56:59], v[128:131]
    ds_read_b128 v[24:27], v4 offset:22528
    v_mfma_f32_16x16x32_bf16 v[132:135], v[28:31], v[60:63], v[132:135]
    ds_read_b64_tr_b16 v[48:49], v9 offset:24576
    v_mfma_f32_16x16x32_bf16 v[136:139], v[32:35], v[60:63], v[136:139]
    ds_read_b64_tr_b16 v[50:51], v9 offset:25088
    v_mfma_f32_16x16x32_bf16 v[140:143], v[36:39], v[60:63], v[140:143]
    ds_read_b64_tr_b16 v[52:53], v10 offset:0
    v_mfma_f32_16x16x32_bf16 v[144:147], v[40:43], v[60:63], v[144:147]
    ds_read_b64_tr_b16 v[54:55], v10 offset:512
    v_mfma_f32_16x16x32_bf16 v[148:151], v[28:31], v[64:67], v[148:151]
    ds_read_b64_tr_b16 v[56:57], v11 offset:0
    v_mfma_f32_16x16x32_bf16 v[152:155], v[32:35], v[64:67], v[152:155]
    ds_read_b64_tr_b16 v[58:59], v11 offset:512
    v_mfma_f32_16x16x32_bf16 v[156:159], v[36:39], v[64:67], v[156:159]
    v_mfma_f32_16x16x32_bf16 v[160:163], v[40:43], v[64:67], v[160:163]
    s_waitcnt lgkmcnt(9)
    v_mfma_f32_16x16x32_bf16 v[100:103], v[12:15], v[44:47], v[100:103]
    ds_read_b128 v[28:31], v5 offset:16384
    s_waitcnt lgkmcnt(9)
    v_mfma_f32_16x16x32_bf16 v[104:107], v[16:19], v[44:47], v[104:107]
    ds_read_b64_tr_b16 v[60:61], v8 offset:28672
    s_waitcnt lgkmcnt(9)
    v_mfma_f32_16x16x32_bf16 v[108:111], v[20:23], v[44:47], v[108:111]
    ds_read_b64_tr_b16 v[62:63], v8 offset:29184
    s_waitcnt lgkmcnt(9)
    v_mfma_f32_16x16x32_bf16 v[112:115], v[24:27], v[44:47], v[112:115]
    ds_read_b128 v[32:35], v5 offset:18432
    s_waitcnt lgkmcnt(8)
    v_mfma_f32_16x16x32_bf16 v[116:119], v[12:15], v[48:51], v[116:119]
    ds_read_b128 v[36:39], v5 offset:20480
    v_mfma_f32_16x16x32_bf16 v[120:123], v[16:19], v[48:51], v[120:123]
    ds_read_b128 v[40:43], v5 offset:22528
    v_mfma_f32_16x16x32_bf16 v[124:127], v[20:23], v[48:51], v[124:127]
    ds_read_b64_tr_b16 v[64:65], v9 offset:28672
    v_mfma_f32_16x16x32_bf16 v[128:131], v[24:27], v[48:51], v[128:131]
    ds_read_b64_tr_b16 v[66:67], v9 offset:29184
    s_waitcnt lgkmcnt(10)
    v_mfma_f32_16x16x32_bf16 v[132:135], v[12:15], v[52:55], v[132:135]
    ds_read_b64_tr_b16 v[44:45], v10 offset:4096
    v_mfma_f32_16x16x32_bf16 v[136:139], v[16:19], v[52:55], v[136:139]
    ds_read_b64_tr_b16 v[46:47], v10 offset:4608
    v_mfma_f32_16x16x32_bf16 v[140:143], v[20:23], v[52:55], v[140:143]
    ds_read_b64_tr_b16 v[48:49], v11 offset:4096
    v_mfma_f32_16x16x32_bf16 v[144:147], v[24:27], v[52:55], v[144:147]
    ds_read_b64_tr_b16 v[50:51], v11 offset:4608
    s_waitcnt lgkmcnt(12)
    v_mfma_f32_16x16x32_bf16 v[148:151], v[12:15], v[56:59], v[148:151]
    v_mfma_f32_16x16x32_bf16 v[152:155], v[16:19], v[56:59], v[152:155]
    v_mfma_f32_16x16x32_bf16 v[156:159], v[20:23], v[56:59], v[156:159]
    v_mfma_f32_16x16x32_bf16 v[160:163], v[24:27], v[56:59], v[160:163]
    s_waitcnt lgkmcnt(9)
    v_mfma_f32_16x16x32_bf16 v[100:103], v[28:31], v[60:63], v[100:103]
    s_waitcnt lgkmcnt(8)
    v_mfma_f32_16x16x32_bf16 v[104:107], v[32:35], v[60:63], v[104:107]
    s_waitcnt lgkmcnt(0)
    s_barrier
    v_mfma_f32_16x16x32_bf16 v[108:111], v[36:39], v[60:63], v[108:111]
    ds_read_b128 v[12:15], v4 offset:32768
    v_mfma_f32_16x16x32_bf16 v[112:115], v[40:43], v[60:63], v[112:115]
    ds_read_b64_tr_b16 v[52:53], v10 offset:16384
    v_mfma_f32_16x16x32_bf16 v[116:119], v[28:31], v[64:67], v[116:119]
    ds_read_b64_tr_b16 v[54:55], v10 offset:16896
    v_mfma_f32_16x16x32_bf16 v[120:123], v[32:35], v[64:67], v[120:123]
    ds_read_b128 v[16:19], v4 offset:34816
    v_mfma_f32_16x16x32_bf16 v[124:127], v[36:39], v[64:67], v[124:127]
    ds_read_b128 v[20:23], v4 offset:36864
    v_mfma_f32_16x16x32_bf16 v[128:131], v[40:43], v[64:67], v[128:131]
    ds_read_b128 v[24:27], v4 offset:38912
    v_mfma_f32_16x16x32_bf16 v[132:135], v[28:31], v[44:47], v[132:135]
    ds_read_b64_tr_b16 v[56:57], v11 offset:16384
    v_mfma_f32_16x16x32_bf16 v[136:139], v[32:35], v[44:47], v[136:139]
    ds_read_b64_tr_b16 v[58:59], v11 offset:16896
    v_mfma_f32_16x16x32_bf16 v[140:143], v[36:39], v[44:47], v[140:143]
    ds_read_b64_tr_b16 v[60:61], v10 offset:24576
    v_mfma_f32_16x16x32_bf16 v[144:147], v[40:43], v[44:47], v[144:147]
    ds_read_b64_tr_b16 v[62:63], v10 offset:25088
    v_mfma_f32_16x16x32_bf16 v[148:151], v[28:31], v[48:51], v[148:151]
    ds_read_b64_tr_b16 v[64:65], v11 offset:24576
    v_mfma_f32_16x16x32_bf16 v[152:155], v[32:35], v[48:51], v[152:155]
    ds_read_b64_tr_b16 v[66:67], v11 offset:25088
    v_mfma_f32_16x16x32_bf16 v[156:159], v[36:39], v[48:51], v[156:159]
    v_mfma_f32_16x16x32_bf16 v[160:163], v[40:43], v[48:51], v[160:163]
    s_waitcnt lgkmcnt(9)
    v_mfma_f32_16x16x32_bf16 v[100:103], v[12:15], v[52:55], v[100:103]
    ds_read_b128 v[28:31], v5 offset:32768
    s_waitcnt lgkmcnt(9)
    v_mfma_f32_16x16x32_bf16 v[104:107], v[16:19], v[52:55], v[104:107]
    ds_read_b64_tr_b16 v[44:45], v10 offset:20480
    s_waitcnt lgkmcnt(9)
    v_mfma_f32_16x16x32_bf16 v[108:111], v[20:23], v[52:55], v[108:111]
    ds_read_b64_tr_b16 v[46:47], v10 offset:20992
    s_waitcnt lgkmcnt(9)
    v_mfma_f32_16x16x32_bf16 v[112:115], v[24:27], v[52:55], v[112:115]
    ds_read_b128 v[32:35], v5 offset:34816
    s_waitcnt lgkmcnt(8)
    v_mfma_f32_16x16x32_bf16 v[116:119], v[12:15], v[56:59], v[116:119]
    ds_read_b128 v[36:39], v5 offset:36864
    v_mfma_f32_16x16x32_bf16 v[120:123], v[16:19], v[56:59], v[120:123]
    ds_read_b128 v[40:43], v5 offset:38912
    v_mfma_f32_16x16x32_bf16 v[124:127], v[20:23], v[56:59], v[124:127]
    ds_read_b64_tr_b16 v[48:49], v11 offset:20480
    v_mfma_f32_16x16x32_bf16 v[128:131], v[24:27], v[56:59], v[128:131]
    ds_read_b64_tr_b16 v[50:51], v11 offset:20992
    s_waitcnt lgkmcnt(10)
    v_mfma_f32_16x16x32_bf16 v[132:135], v[12:15], v[60:63], v[132:135]
    ds_read_b64_tr_b16 v[52:53], v10 offset:28672
    v_mfma_f32_16x16x32_bf16 v[136:139], v[16:19], v[60:63], v[136:139]
    ds_read_b64_tr_b16 v[54:55], v10 offset:29184
    v_mfma_f32_16x16x32_bf16 v[140:143], v[20:23], v[60:63], v[140:143]
    ds_read_b64_tr_b16 v[56:57], v11 offset:28672
    v_mfma_f32_16x16x32_bf16 v[144:147], v[24:27], v[60:63], v[144:147]
    ds_read_b64_tr_b16 v[58:59], v11 offset:29184
    s_waitcnt lgkmcnt(12)
    v_mfma_f32_16x16x32_bf16 v[148:151], v[12:15], v[64:67], v[148:151]
    v_mfma_f32_16x16x32_bf16 v[152:155], v[16:19], v[64:67], v[152:155]
    v_mfma_f32_16x16x32_bf16 v[156:159], v[20:23], v[64:67], v[156:159]
    v_mfma_f32_16x16x32_bf16 v[160:163], v[24:27], v[64:67], v[160:163]
    s_waitcnt lgkmcnt(9)
    v_mfma_f32_16x16x32_bf16 v[100:103], v[28:31], v[44:47], v[100:103]
    s_waitcnt lgkmcnt(8)
    v_mfma_f32_16x16x32_bf16 v[104:107], v[32:35], v[44:47], v[104:107]
    s_waitcnt lgkmcnt(0)
    s_barrier
    v_mfma_f32_16x16x32_bf16 v[108:111], v[36:39], v[44:47], v[108:111]
    ds_read_b128 v[12:15], v4 offset:49152
    v_mfma_f32_16x16x32_bf16 v[112:115], v[40:43], v[44:47], v[112:115]
    ds_read_b64_tr_b16 v[60:61], v8 offset:0
    v_mfma_f32_16x16x32_bf16 v[116:119], v[28:31], v[48:51], v[116:119]
    ds_read_b64_tr_b16 v[62:63], v8 offset:512
    v_mfma_f32_16x16x32_bf16 v[120:123], v[32:35], v[48:51], v[120:123]
    ds_read_b128 v[16:19], v4 offset:51200
    v_mfma_f32_16x16x32_bf16 v[124:127], v[36:39], v[48:51], v[124:127]
    ds_read_b128 v[20:23], v4 offset:53248
    v_mfma_f32_16x16x32_bf16 v[128:131], v[40:43], v[48:51], v[128:131]
    ds_read_b128 v[24:27], v4 offset:55296
    v_mfma_f32_16x16x32_bf16 v[132:135], v[28:31], v[52:55], v[132:135]
    ds_read_b64_tr_b16 v[64:65], v9 offset:0
    v_mfma_f32_16x16x32_bf16 v[136:139], v[32:35], v[52:55], v[136:139]
    ds_read_b64_tr_b16 v[66:67], v9 offset:512
    s_branch IW_s4
IW_w4:
    s_branch IW_r4
IW_s4:
    v_mfma_f32_16x16x32_bf16 v[140:143], v[36:39], v[52:55], v[140:143]
    ds_read_b64_tr_b16 v[44:45], v10 offset:32768
    v_mfma_f32_16x16x32_bf16 v[144:147], v[40:43], v[52:55], v[144:147]
    ds_read_b64_tr_b16 v[46:47], v10 offset:33280
    v_mfma_f32_16x16x32_bf16 v[148:151], v[28:31], v[56:59], v[148:151]
    ds_read_b64_tr_b16 v[48:49], v11 offset:32768
    v_mfma_f32_16x16x32_bf16 v[152:155], v[32:35], v[56:59], v[152:155]
    ds_read_b64_tr_b16 v[50:51], v11 offset:33280
    v_mfma_f32_16x16x32_bf16 v[156:159], v[36:39], v[56:59], v[156:159]
    v_mfma_f32_16x16x32_bf16 v[160:163], v[40:43], v[56:59], v[160:163]
    s_waitcnt lgkmcnt(9)
    v_mfma_f32_16x16x32_bf16 v[100:103], v[12:15], v[60:63], v[100:103]
    ds_read_b128 v[28:31], v5 offset:49152
    s_waitcnt lgkmcnt(9)
    v_mfma_f32_16x16x32_bf16 v[104:107], v[16:19], v[60:63], v[104:107]
    ds_read_b64_tr_b16 v[52:53], v8 offset:4096
    s_waitcnt lgkmcnt(9)
    v_mfma_f32_16x16x32_bf16 v[108:111], v[20:23], v[60:63], v[108:111]
    ds_read_b64_tr_b16 v[54:55], v8 offset:4608
    s_waitcnt lgkmcnt(9)
    v_mfma_f32_16x16x32_bf16 v[112:115], v[24:27], v[60:63], v[112:115]
    ds_read_b128 v[32:35], v5 offset:51200
    s_waitcnt lgkmcnt(8)
    v_mfma_f32_16x16x32_bf16 v[116:119], v[12:15], v[64:67], v[116:119]
    ds_read_b128 v[36:39], v5 offset:53248
    v_mfma_f32_16x16x32_bf16 v[120:123], v[16:19], v[64:67], v[120:123]
    ds_read_b128 v[40:43], v5 offset:55296
    v_mfma_f32_16x16x32_bf16 v[124:127], v[20:23], v[64:67], v[124:127]
    ds_read_b64_tr_b16 v[56:57], v9 offset:4096
    v_mfma_f32_16x16x32_bf16 v[128:131], v[24:27], v[64:67], v[128:131]
    ds_read_b64_tr_b16 v[58:59], v9 offset:4608
    s_waitcnt lgkmcnt(10)
    v_mfma_f32_16x16x32_bf16 v[132:135], v[12:15], v[44:47], v[132:135]
    ds_read_b64_tr_b16 v[60:61], v10 offset:36864
    v_mfma_f32_16x16x32_bf16 v[136:139], v[16:19], v[44:47], v[136:139]
    ds_read_b64_tr_b16 v[62:63], v10 offset:37376
    v_mfma_f32_16x16x32_bf16 v[140:143], v[20:23], v[44:47], v[140:143]
    ds_read_b64_tr_b16 v[64:65], v11 offset:36864
    v_mfma_f32_16x16x32_bf16 v[144:147], v[24:27], v[44:47], v[144:147]
    ds_read_b64_tr_b16 v[66:67], v11 offset:37376
    s_waitcnt lgkmcnt(12)
    v_mfma_f32_16x16x32_bf16 v[148:151], v[12:15], v[48:51], v[148:151]
    v_mfma_f32_16x16x32_bf16 v[152:155], v[16:19], v[48:51], v[152:155]
    v_mfma_f32_16x16x32_bf16 v[156:159], v[20:23], v[48:51], v[156:159]
    v_mfma_f32_16x16x32_bf16 v[160:163], v[24:27], v[48:51], v[160:163]
    s_waitcnt lgkmcnt(9)
    v_mfma_f32_16x16x32_bf16 v[100:103], v[28:31], v[52:55], v[100:103]
    s_waitcnt lgkmcnt(8)
    v_mfma_f32_16x16x32_bf16 v[104:107], v[32:35], v[52:55], v[104:107]
    s_waitcnt lgkmcnt(0)
    s_barrier
    v_mfma_f32_16x16x32_bf16 v[108:111], v[36:39], v[52:55], v[108:111]
    ds_read_b128 v[12:15], v4 offset:0
    v_mfma_f32_16x16x32_bf16 v[112:115], v[40:43], v[52:55], v[112:115]
    ds_read_b64_tr_b16 v[44:45], v8 offset:8192
    v_mfma_f32_16x16x32_bf16 v[116:119], v[28:31], v[56:59], v[116:119]
    ds_read_b64_tr_b16 v[46:47], v8 offset:8704
    v_mfma_f32_16x16x32_bf16 v[120:123], v[32:35], v[56:59], v[120:123]
    ds_read_b128 v[16:19], v4 offset:2048
    v_mfma_f32_16x16x32_bf16 v[124:127], v[36:39], v[56:59], v[124:127]
    ds_read_b128 v[20:23], v4 offset:4096
    v_mfma_f32_16x16x32_bf16 v[128:131], v[40:43], v[56:59], v[128:131]
    ds_read_b128 v[24:27], v4 offset:6144
    v_mfma_f32_16x16x32_bf16 v[132:135], v[28:31], v[60:63], v[132:135]
    ds_read_b64_tr_b16 v[48:49], v9 offset:8192
    v_mfma_f32_16x16x32_bf16 v[136:139], v[32:35], v[60:63], v[136:139]
    ds_read_b64_tr_b16 v[50:51], v9 offset:8704
    v_mfma_f32_16x16x32_bf16 v[140:143], v[36:39], v[60:63], v[140:143]
    ds_read_b64_tr_b16 v[52:53], v8 offset:16384
    v_mfma_f32_16x16x32_bf16 v[144:147], v[40:43], v[60:63], v[144:147]
    ds_read_b64_tr_b16 v[54:55], v8 offset:16896
    v_mfma_f32_16x16x32_bf16 v[148:151], v[28:31], v[64:67], v[148:151]
    ds_read_b64_tr_b16 v[56:57], v9 offset:16384
    v_mfma_f32_16x16x32_bf16 v[152:155], v[32:35], v[64:67], v[152:155]
    ds_read_b64_tr_b16 v[58:59], v9 offset:16896
    v_mfma_f32_16x16x32_bf16 v[156:159], v[36:39], v[64:67], v[156:159]
    v_mfma_f32_16x16x32_bf16 v[160:163], v[40:43], v[64:67], v[160:163]
    s_waitcnt lgkmcnt(9)
    v_mfma_f32_16x16x32_bf16 v[100:103], v[12:15], v[44:47], v[100:103]
    ds_read_b128 v[28:31], v5 offset:0
    s_waitcnt lgkmcnt(9)
    v_mfma_f32_16x16x32_bf16 v[104:107], v[16:19], v[44:47], v[104:107]
    ds_read_b64_tr_b16 v[60:61], v8 offset:12288
    s_waitcnt lgkmcnt(9)
    v_mfma_f32_16x16x32_bf16 v[108:111], v[20:23], v[44:47], v[108:111]
    ds_read_b64_tr_b16 v[62:63], v8 offset:12800
    s_waitcnt lgkmcnt(9)
    v_mfma_f32_16x16x32_bf16 v[112:115], v[24:27], v[44:47], v[112:115]
    ds_read_b128 v[32:35], v5 offset:2048
    s_waitcnt lgkmcnt(8)
    v_mfma_f32_16x16x32_bf16 v[116:119], v[12:15], v[48:51], v[116:119]
    ds_read_b128 v[36:39], v5 offset:4096
    v_mfma_f32_16x16x32_bf16 v[120:123], v[16:19], v[48:51], v[120:123]
    ds_read_b128 v[40:43], v5 offset:6144
    v_mfma_f32_16x16x32_bf16 v[124:127], v[20:23], v[48:51], v[124:127]
    ds_read_b64_tr_b16 v[64:65], v9 offset:12288
    v_mfma_f32_16x16x32_bf16 v[128:131], v[24:27], v[48:51], v[128:131]
    ds_read_b64_tr_b16 v[66:67], v9 offset:12800
    s_waitcnt lgkmcnt(10)
    v_mfma_f32_16x16x32_bf16 v[132:135], v[12:15], v[52:55], v[132:135]
    ds_read_b64_tr_b16 v[44:45], v8 offset:20480
    v_mfma_f32_16x16x32_bf16 v[136:139], v[16:19], v[52:55], v[136:139]
    ds_read_b64_tr_b16 v[46:47], v8 offset:20992
    v_mfma_f32_16x16x32_bf16 v[140:143], v[20:23], v[52:55], v[140:143]
    ds_read_b64_tr_b16 v[48:49], v9 offset:20480
    v_mfma_f32_16x16x32_bf16 v[144:147], v[24:27], v[52:55], v[144:147]
    ds_read_b64_tr_b16 v[50:51], v9 offset:20992
    s_waitcnt lgkmcnt(12)
    v_mfma_f32_16x16x32_bf16 v[148:151], v[12:15], v[56:59], v[148:151]
    v_mfma_f32_16x16x32_bf16 v[152:155], v[16:19], v[56:59], v[152:155]
    v_mfma_f32_16x16x32_bf16 v[156:159], v[20:23], v[56:59], v[156:159]
    v_mfma_f32_16x16x32_bf16 v[160:163], v[24:27], v[56:59], v[160:163]
    s_waitcnt lgkmcnt(9)
    v_mfma_f32_16x16x32_bf16 v[100:103], v[28:31], v[60:63], v[100:103]
    s_waitcnt lgkmcnt(8)
    v_mfma_f32_16x16x32_bf16 v[104:107], v[32:35], v[60:63], v[104:107]
    s_waitcnt lgkmcnt(0)
    s_barrier
    v_mfma_f32_16x16x32_bf16 v[108:111], v[36:39], v[60:63], v[108:111]
    ds_read_b128 v[12:15], v4 offset:16384
    v_mfma_f32_16x16x32_bf16 v[112:115], v[40:43], v[60:63], v[112:115]
    ds_read_b64_tr_b16 v[52:53], v8 offset:24576
    v_mfma_f32_16x16x32_bf16 v[116:119], v[28:31], v[64:67], v[116:119]
    ds_read_b64_tr_b16 v[54:55], v8 offset:25088
    v_mfma_f32_16x16x32_bf16 v[120:123], v[32:35], v[64:67], v[120:123]
    ds_read_b128 v[16:19], v4 offset:18432
    v_mfma_f32_16x16x32_bf16 v[124:127], v[36:39], v[64:67], v[124:127]
    ds_read_b128 v[20:23], v4 offset:20480
    v_mfma_f32_16x16x32_bf16 v[128:131], v[40:43], v[64:67], v[128:131]
    ds_read_b128 v[24:27], v4 offset:22528
    v_mfma_f32_16x16x32_bf16 v[132:135], v[28:31], v[44:47], v[132:135]
    ds_read_b64_tr_b16 v[56:57], v9 offset:24576
    v_mfma_f32_16x16x32_bf16 v[136:139], v[32:35], v[44:47], v[136:139]
    ds_read_b64_tr_b16 v[58:59], v9 offset:25088
    v_mfma_f32_16x16x32_bf16 v[140:143], v[36:39], v[44:47], v[140:143]
    ds_read_b64_tr_b16 v[60:61], v10 offset:0
    v_mfma_f32_16x16x32_bf16 v[144:147], v[40:43], v[44:47], v[144:147]
    ds_read_b64_tr_b16 v[62:63], v10 offset:512
    v_mfma_f32_16x16x32_bf16 v[148:151], v[28:31], v[48:51], v[148:151]
    ds_read_b64_tr_b16 v[64:65], v11 offset:0
    v_mfma_f32_16x16x32_bf16 v[152:155], v[32:35], v[48:51], v[152:155]
    ds_read_b64_tr_b16 v[66:67], v11 offset:512
    v_mfma_f32_16x16x32_bf16 v[156:159], v[36:39], v[48:51], v[156:159]
    v_mfma_f32_16x16x32_bf16 v[160:163], v[40:43], v[48:51], v[160:163]
    s_waitcnt lgkmcnt(9)
    v_mfma_f32_16x16x32_bf16 v[100:103], v[12:15], v[52:55], v[100:103]
    ds_read_b128 v[28:31], v5 offset:16384
    s_waitcnt lgkmcnt(9)
    v_mfma_f32_16x16x32_bf16 v[104:107], v[16:19], v[52:55], v[104:107]
    ds_read_b64_tr_b16 v[44:45], v8 offset:28672
    s_waitcnt lgkmcnt(9)
    v_mfma_f32_16x16x32_bf16 v[108:111], v[20:23], v[52:55], v[108:111]
    ds_read_b64_tr_b16 v[46:47], v8 offset:29184
    s_waitcnt lgkmcnt(9)
    v_mfma_f32_16x16x32_bf16 v[112:115], v[24:27], v[52:55], v[112:115]
    ds_read_b128 v[32:35], v5 offset:18432
    s_waitcnt lgkmcnt(8)
    v_mfma_f32_16x16x32_bf16 v[116:119], v[12:15], v[56:59], v[116:119]
    ds_read_b128 v[36:39], v5 offset:20480
    v_mfma_f32_16x16x32_bf16 v[120:123], v[16:19], v[56:59], v[120:123]
    ds_read_b128 v[40:43], v5 offset:22528
    v_mfma_f32_16x16x32_bf16 v[124:127], v[20:23], v[56:59], v[124:127]
    ds_read_b64_tr_b16 v[48:49], v9 offset:28672
    v_mfma_f32_16x16x32_bf16 v[128:131], v[24:27], v[56:59], v[128:131]
    ds_read_b64_tr_b16 v[50:51], v9 offset:29184
    s_waitcnt lgkmcnt(10)
    v_mfma_f32_16x16x32_bf16 v[132:135], v[12:15], v[60:63], v[132:135]
    ds_read_b64_tr_b16 v[52:53], v10 offset:4096
    v_mfma_f32_16x16x32_bf16 v[136:139], v[16:19], v[60:63], v[136:139]
    ds_read_b64_tr_b16 v[54:55], v10 offset:4608
    v_mfma_f32_16x16x32_bf16 v[140:143], v[20:23], v[60:63], v[140:143]
    ds_read_b64_tr_b16 v[56:57], v11 offset:4096
    v_mfma_f32_16x16x32_bf16 v[144:147], v[24:27], v[60:63], v[144:147]
    ds_read_b64_tr_b16 v[58:59], v11 offset:4608
    s_waitcnt lgkmcnt(12)
    v_mfma_f32_16x16x32_bf16 v[148:151], v[12:15], v[64:67], v[148:151]
    v_mfma_f32_16x16x32_bf16 v[152:155], v[16:19], v[64:67], v[152:155]
    v_mfma_f32_16x16x32_bf16 v[156:159], v[20:23], v[64:67], v[156:159]
    v_mfma_f32_16x16x32_bf16 v[160:163], v[24:27], v[64:67], v[160:163]
    s_waitcnt lgkmcnt(9)
    v_mfma_f32_16x16x32_bf16 v[100:103], v[28:31], v[44:47], v[100:103]
    s_waitcnt lgkmcnt(8)
    v_mfma_f32_16x16x32_bf16 v[104:107], v[32:35], v[44:47], v[104:107]
    s_waitcnt lgkmcnt(0)
    s_barrier
    v_mfma_f32_16x16x32_bf16 v[108:111], v[36:39], v[44:47], v[108:111]
    ds_read_b128 v[12:15], v4 offset:32768
    v_mfma_f32_16x16x32_bf16 v[112:115], v[40:43], v[44:47], v[112:115]
    ds_read_b64_tr_b16 v[60:61], v10 offset:8192
    v_mfma_f32_16x16x32_bf16 v[116:119], v[28:31], v[48:51], v[116:119]
    ds_read_b64_tr_b16 v[62:63], v10 offset:8704
    v_mfma_f32_16x16x32_bf16 v[120:123], v[32:35], v[48:51], v[120:123]
    ds_read_b128 v[16:19], v4 offset:34816
    v_mfma_f32_16x16x32_bf16 v[124:127], v[36:39], v[48:51], v[124:127]
    ds_read_b128 v[20:23], v4 offset:36864
    v_mfma_f32_16x16x32_bf16 v[128:131], v[40:43], v[48:51], v[128:131]
    ds_read_b128 v[24:27], v4 offset:38912
    v_mfma_f32_16x16x32_bf16 v[132:135], v[28:31], v[52:55], v[132:135]
    ds_read_b64_tr_b16 v[64:65], v11 offset:8192
    v_mfma_f32_16x16x32_bf16 v[136:139], v[32:35], v[52:55], v[136:139]
    ds_read_b64_tr_b16 v[66:67], v11 offset:8704
    v_mfma_f32_16x16x32_bf16 v[140:143], v[36:39], v[52:55], v[140:143]
    ds_read_b64_tr_b16 v[44:45], v10 offset:16384
    v_mfma_f32_16x16x32_bf16 v[144:147], v[40:43], v[52:55], v[144:147]
    ds_read_b64_tr_b16 v[46:47], v10 offset:16896
    v_mfma_f32_16x16x32_bf16 v[148:151], v[28:31], v[56:59], v[148:151]
    ds_read_b64_tr_b16 v[48:49], v11 offset:16384
    v_mfma_f32_16x16x32_bf16 v[152:155], v[32:35], v[56:59], v[152:155]
    ds_read_b64_tr_b16 v[50:51], v11 offset:16896
    v_mfma_f32_16x16x32_bf16 v[156:159], v[36:39], v[56:59], v[156:159]
    v_mfma_f32_16x16x32_bf16 v[160:163], v[40:43], v[56:59], v[160:163]
    s_waitcnt lgkmcnt(9)
    v_mfma_f32_16x16x32_bf16 v[100:103], v[12:15], v[60:63], v[100:103]
    ds_read_b128 v[28:31], v5 offset:32768
    s_waitcnt lgkmcnt(9)
    v_mfma_f32_16x16x32_bf16 v[104:107], v[16:19], v[60:63], v[104:107]
    ds_read_b64_tr_b16 v[52:53], v10 offset:12288
    s_waitcnt lgkmcnt(9)
    v_mfma_f32_16x16x32_bf16 v[108:111], v[20:23], v[60:63], v[108:111]
    ds_read_b64_tr_b16 v[54:55], v10 offset:12800
    s_waitcnt lgkmcnt(9)
    v_mfma_f32_16x16x32_bf16 v[112:115], v[24:27], v[60:63], v[112:115]
    ds_read_b128 v[32:35], v5 offset:34816
    s_waitcnt lgkmcnt(8)
    v_mfma_f32_16x16x32_bf16 v[116:119], v[12:15], v[64:67], v[116:119]
    ds_read_b128 v[36:39], v5 offset:36864
    v_mfma_f32_16x16x32_bf16 v[120:123], v[16:19], v[64:67], v[120:123]
    ds_read_b128 v[40:43], v5 offset:38912
    v_mfma_f32_16x16x32_bf16 v[124:127], v[20:23], v[64:67], v[124:127]
    ds_read_b64_tr_b16 v[56:57], v11 offset:12288
    v_mfma_f32_16x16x32_bf16 v[128:131], v[24:27], v[64:67], v[128:131]
    ds_read_b64_tr_b16 v[58:59], v11 offset:12800
    s_waitcnt lgkmcnt(10)
    v_mfma_f32_16x16x32_bf16 v[132:135], v[12:15], v[44:47], v[132:135]
    ds_read_b64_tr_b16 v[60:61], v10 offset:20480
    v_mfma_f32_16x16x32_bf16 v[136:139], v[16:19], v[44:47], v[136:139]
    ds_read_b64_tr_b16 v[62:63], v10 offset:20992
    v_mfma_f32_16x16x32_bf16 v[140:143], v[20:23], v[44:47], v[140:143]
    ds_read_b64_tr_b16 v[64:65], v11 offset:20480
    v_mfma_f32_16x16x32_bf16 v[144:147], v[24:27], v[44:47], v[144:147]
    ds_read_b64_tr_b16 v[66:67], v11 offset:20992
    s_waitcnt lgkmcnt(12)
    v_mfma_f32_16x16x32_bf16 v[148:151], v[12:15], v[48:51], v[148:151]
    v_mfma_f32_16x16x32_bf16 v[152:155], v[16:19], v[48:51], v[152:155]
    v_mfma_f32_16x16x32_bf16 v[156:159], v[20:23], v[48:51], v[156:159]
    v_mfma_f32_16x16x32_bf16 v[160:163], v[24:27], v[48:51], v[160:163]
    s_waitcnt lgkmcnt(9)
    v_mfma_f32_16x16x32_bf16 v[100:103], v[28:31], v[52:55], v[100:103]
    s_waitcnt lgkmcnt(8)
    v_mfma_f32_16x16x32_bf16 v[104:107], v[32:35], v[52:55], v[104:107]
    s_waitcnt lgkmcnt(0)
    s_barrier
    v_mfma_f32_16x16x32_bf16 v[108:111], v[36:39], v[52:55], v[108:111]
    ds_read_b128 v[12:15], v4 offset:49152
    v_mfma_f32_16x16x32_bf16 v[112:115], v[40:43], v[52:55], v[112:115]
    ds_read_b64_tr_b16 v[44:45], v8 offset:0
    v_mfma_f32_16x16x32_bf16 v[116:119], v[28:31], v[56:59], v[116:119]
    ds_read_b64_tr_b16 v[46:47], v8 offset:512
    v_mfma_f32_16x16x32_bf16 v[120:123], v[32:35], v[56:59], v[120:123]
    ds_read_b128 v[16:19], v4 offset:51200
    v_mfma_f32_16x16x32_bf16 v[124:127], v[36:39], v[56:59], v[124:127]
    ds_read_b128 v[20:23], v4 offset:53248
    v_mfma_f32_16x16x32_bf16 v[128:131], v[40:43], v[56:59], v[128:131]
    ds_read_b128 v[24:27], v4 offset:55296
    v_mfma_f32_16x16x32_bf16 v[132:135], v[28:31], v[60:63], v[132:135]
    ds_read_b64_tr_b16 v[48:49], v9 offset:0
    v_mfma_f32_16x16x32_bf16 v[136:139], v[32:35], v[60:63], v[136:139]
    ds_read_b64_tr_b16 v[50:51], v9 offset:512
    v_mfma_f32_16x16x32_bf16 v[140:143], v[36:39], v[60:63], v[140:143]
    ds_read_b64_tr_b16 v[52:53], v10 offset:24576
    v_mfma_f32_16x16x32_bf16 v[144:147], v[40:43], v[60:63], v[144:147]
    ds_read_b64_tr_b16 v[54:55], v10 offset:25088
    v_mfma_f32_16x16x32_bf16 v[148:151], v[28:31], v[64:67], v[148:151]
    ds_read_b64_tr_b16 v[56:57], v11 offset:24576
    v_mfma_f32_16x16x32_bf16 v[152:155], v[32:35], v[64:67], v[152:155]
    ds_read_b64_tr_b16 v[58:59], v11 offset:25088
    v_mfma_f32_16x16x32_bf16 v[156:159], v[36:39], v[64:67], v[156:159]
    v_mfma_f32_16x16x32_bf16 v[160:163], v[40:43], v[64:67], v[160:163]
    ds_read_b32 v68, v1 offset:48
    s_waitcnt lgkmcnt(10)
    v_mfma_f32_16x16x32_bf16 v[100:103], v[12:15], v[44:47], v[100:103]
    ds_read_b128 v[28:31], v5 offset:49152
    s_waitcnt lgkmcnt(10)
    v_mfma_f32_16x16x32_bf16 v[104:107], v[16:19], v[44:47], v[104:107]
    ds_read_b64_tr_b16 v[60:61], v8 offset:4096
    s_waitcnt lgkmcnt(10)
    v_mfma_f32_16x16x32_bf16 v[108:111], v[20:23], v[44:47], v[108:111]
    ds_read_b64_tr_b16 v[62:63], v8 offset:4608
    s_waitcnt lgkmcnt(10)
    v_mfma_f32_16x16x32_bf16 v[112:115], v[24:27], v[44:47], v[112:115]
    ds_read_b128 v[32:35], v5 offset:51200
    s_waitcnt lgkmcnt(9)
    v_mfma_f32_16x16x32_bf16 v[116:119], v[12:15], v[48:51], v[116:119]
    ds_read_b128 v[36:39], v5 offset:53248
    v_mfma_f32_16x16x32_bf16 v[120:123], v[16:19], v[48:51], v[120:123]
    ds_read_b128 v[40:43], v5 offset:55296
    v_mfma_f32_16x16x32_bf16 v[124:127], v[20:23], v[48:51], v[124:127]
    ds_read_b64_tr_b16 v[64:65], v9 offset:4096
    v_mfma_f32_16x16x32_bf16 v[128:131], v[24:27], v[48:51], v[128:131]
    ds_read_b64_tr_b16 v[66:67], v9 offset:4608
    s_waitcnt lgkmcnt(11)
    v_mfma_f32_16x16x32_bf16 v[132:135], v[12:15], v[52:55], v[132:135]
    ds_read_b64_tr_b16 v[44:45], v10 offset:28672
    v_mfma_f32_16x16x32_bf16 v[136:139], v[16:19], v[52:55], v[136:139]
    ds_read_b64_tr_b16 v[46:47], v10 offset:29184
    v_mfma_f32_16x16x32_bf16 v[140:143], v[20:23], v[52:55], v[140:143]
    ds_read_b64_tr_b16 v[48:49], v11 offset:28672
    v_mfma_f32_16x16x32_bf16 v[144:147], v[24:27], v[52:55], v[144:147]
    ds_read_b64_tr_b16 v[50:51], v11 offset:29184
    s_waitcnt lgkmcnt(13)
    v_mfma_f32_16x16x32_bf16 v[148:151], v[12:15], v[56:59], v[148:151]
    v_mfma_f32_16x16x32_bf16 v[152:155], v[16:19], v[56:59], v[152:155]
    v_mfma_f32_16x16x32_bf16 v[156:159], v[20:23], v[56:59], v[156:159]
    v_mfma_f32_16x16x32_bf16 v[160:163], v[24:27], v[56:59], v[160:163]
    s_waitcnt lgkmcnt(9)
    v_mfma_f32_16x16x32_bf16 v[100:103], v[28:31], v[60:63], v[100:103]
    v_lshlrev_b32 v18, 4, v0
    v_add_u32 v12, s52, v18
    s_waitcnt lgkmcnt(8)
    v_mfma_f32_16x16x32_bf16 v[104:107], v[32:35], v[60:63], v[104:107]
    v_xor_b32 v13, 4096, v12
    v_and_b32 v14, 0x30, v0
    s_waitcnt lgkmcnt(0)
    s_barrier
    v_cmp_gt_u32 vcc, 1, v68
    s_nop 0
    s_and_b32 vcc_lo, vcc_lo, 3
    s_cbranch_scc0 SCK_17
    v_and_b32 v69, 1, v0
    v_lshlrev_b32 v69, 2, v69
    v_add_u32 v69, 159088, v69
    ds_read_b32 v68, v69 offset:0
FW_18:
    s_waitcnt lgkmcnt(0)
    v_cmp_gt_u32 vcc, 1, v68
    s_cbranch_vccz FO_19
    ds_read_b32 v68, v69 offset:0
    s_branch FW_18
FO_19:
SCK_17:
    v_mfma_f32_16x16x32_bf16 v[108:111], v[36:39], v[60:63], v[108:111]
    ds_read_b128 v[68:71], v164 offset:0
    v_add_u32 v14, s53, v14
    v_mfma_f32_16x16x32_bf16 v[112:115], v[40:43], v[60:63], v[112:115]
    ds_read2_b32 v[52:53], v165 offset0:64 offset1:64
    v_xor_b32 v15, 64, v14
    v_mfma_f32_16x16x32_bf16 v[116:119], v[28:31], v[64:67], v[116:119]
    ds_read2_b32 v[54:55], v2 offset0:64 offset1:64
    v_lshlrev_b32 v19, 2, v0
    v_mfma_f32_16x16x32_bf16 v[120:123], v[32:35], v[64:67], v[120:123]
    ds_read2_b32 v[56:57], v165 offset0:128 offset1:128
    v_add_u32 v16, s53, v19
    v_mfma_f32_16x16x32_bf16 v[124:127], v[36:39], v[64:67], v[124:127]
    ds_read2_b32 v[58:59], v2 offset0:128 offset1:128
    v_xor_b32 v17, 256, v16
    v_mfma_f32_16x16x32_bf16 v[128:131], v[40:43], v[64:67], v[128:131]
    ds_read_b128 v[72:75], v164 offset:1024
    v_xor_b32 v18, 8, v3
    v_mfma_f32_16x16x32_bf16 v[132:135], v[28:31], v[44:47], v[132:135]
    ds_read_b128 v[76:79], v164 offset:64
    v_writelane_b32 v18, s50, 1
    v_mfma_f32_16x16x32_bf16 v[136:139], v[32:35], v[44:47], v[136:139]
    ds_read_b128 v[80:83], v164 offset:1088
    v_mov_b32 v20, 0x3f803f80
    v_mfma_f32_16x16x32_bf16 v[140:143], v[36:39], v[44:47], v[140:143]
    ds_read_b128 v[84:87], v164 offset:128
    v_mov_b32 v21, 0x3f803f80
    v_mfma_f32_16x16x32_bf16 v[144:147], v[40:43], v[44:47], v[144:147]
    ds_read_b128 v[88:91], v164 offset:1152
    v_mov_b32 v22, 0x3f803f80
    v_mfma_f32_16x16x32_bf16 v[148:151], v[28:31], v[48:51], v[148:151]
    ds_read_b128 v[92:95], v164 offset:192
    v_mov_b32 v23, 0x3f803f80
    v_mfma_f32_16x16x32_bf16 v[152:155], v[32:35], v[48:51], v[152:155]
    ds_read_b128 v[96:99], v164 offset:1216
    v_mov_b32 v24, 1
    v_and_b32 v4, 15, v0
    v_mfma_f32_16x16x32_bf16 v[156:159], v[36:39], v[48:51], v[156:159]
    v_bfe_u32 v5, v0, 4, 1
    v_lshlrev_b32 v5, 5, v5
    v_mfma_f32_16x16x32_bf16 v[160:163], v[40:43], v[48:51], v[160:163]
    v_lshrrev_b32 v6, 5, v0
    v_lshl_add_u32 v5, v6, 4, v5
    v_lshl_add_u32 v7, v4, 11, v5
    v_lshlrev_b32 v6, 4, v0
    s_waitcnt lgkmcnt(10)
    v_pk_fma_f32 v[100:101], v[68:69], v[52:53], v[100:101]
    v_pk_fma_f32 v[102:103], v[70:71], v[52:53], v[102:103]
    s_waitcnt lgkmcnt(9)
    v_pk_fma_f32 v[116:117], v[68:69], v[54:55], v[116:117]
    v_pk_fma_f32 v[118:119], v[70:71], v[54:55], v[118:119]
    s_waitcnt lgkmcnt(8)
    v_pk_fma_f32 v[132:133], v[68:69], v[56:57], v[132:133]
    v_pk_fma_f32 v[134:135], v[70:71], v[56:57], v[134:135]
    s_waitcnt lgkmcnt(7)
    v_pk_fma_f32 v[148:149], v[68:69], v[58:59], v[148:149]
    v_pk_fma_f32 v[150:151], v[70:71], v[58:59], v[150:151]
    s_waitcnt lgkmcnt(6)
    v_pk_mul_f32 v[100:101], v[100:101], v[72:73]
    v_pk_mul_f32 v[102:103], v[102:103], v[74:75]
    v_pk_mul_f32 v[116:117], v[116:117], v[72:73]
    v_pk_mul_f32 v[118:119], v[118:119], v[74:75]
    v_pk_mul_f32 v[132:133], v[132:133], v[72:73]
    v_pk_mul_f32 v[134:135], v[134:135], v[74:75]
    v_pk_mul_f32 v[148:149], v[148:149], v[72:73]
    v_pk_mul_f32 v[150:151], v[150:151], v[74:75]
    v_exp_f32 v28, v100 clamp
    v_exp_f32 v29, v101 clamp
    v_exp_f32 v30, v102 clamp
    v_exp_f32 v31, v103 clamp
    v_exp_f32 v32, v116 clamp
    v_exp_f32 v33, v117 clamp
    v_exp_f32 v34, v118 clamp
    v_exp_f32 v35, v119 clamp
    v_cvt_pk_bf16_f32 v132, v132, v133
    v_cvt_pk_bf16_f32 v133, v134, v135
    v_cvt_pk_bf16_f32 v148, v148, v149
    v_cvt_pk_bf16_f32 v149, v150, v151
    v_pk_mul_f32 v[100:101], v[100:101], s[40:41] clamp
    v_pk_mul_f32 v[102:103], v[102:103], s[40:41] clamp
    v_pk_mul_f32 v[116:117], v[116:117], s[40:41] clamp
    v_pk_mul_f32 v[118:119], v[118:119], s[40:41] clamp
    v_pk_add_f32 v[28:29], v[28:29], s[74:75]
    v_pk_add_f32 v[30:31], v[30:31], s[74:75]
    v_pk_add_f32 v[32:33], v[32:33], s[74:75]
    v_pk_add_f32 v[34:35], v[34:35], s[74:75]
    v_pk_fma_f32 v[100:101], v[100:101], s[76:77], v[28:29]
    v_pk_fma_f32 v[102:103], v[102:103], s[76:77], v[30:31]
    v_pk_fma_f32 v[116:117], v[116:117], s[76:77], v[32:33]
    v_pk_fma_f32 v[118:119], v[118:119], s[76:77], v[34:35]
    v_cvt_pk_bf16_f32 v100, v100, v101
    v_cvt_pk_bf16_f32 v101, v102, v103
    v_cvt_pk_bf16_f32 v116, v116, v117
    v_cvt_pk_bf16_f32 v117, v118, v119
    s_waitcnt lgkmcnt(5)
    v_pk_fma_f32 v[104:105], v[76:77], v[52:53], v[104:105]
    v_pk_fma_f32 v[106:107], v[78:79], v[52:53], v[106:107]
    v_pk_fma_f32 v[120:121], v[76:77], v[54:55], v[120:121]
    v_pk_fma_f32 v[122:123], v[78:79], v[54:55], v[122:123]
    v_pk_fma_f32 v[136:137], v[76:77], v[56:57], v[136:137]
    v_pk_fma_f32 v[138:139], v[78:79], v[56:57], v[138:139]
    v_pk_fma_f32 v[152:153], v[76:77], v[58:59], v[152:153]
    v_pk_fma_f32 v[154:155], v[78:79], v[58:59], v[154:155]
    s_waitcnt lgkmcnt(4)
    v_pk_mul_f32 v[104:105], v[104:105], v[80:81]
    v_pk_mul_f32 v[106:107], v[106:107], v[82:83]
    v_pk_mul_f32 v[120:121], v[120:121], v[80:81]
    v_pk_mul_f32 v[122:123], v[122:123], v[82:83]
    v_pk_mul_f32 v[136:137], v[136:137], v[80:81]
    v_pk_mul_f32 v[138:139], v[138:139], v[82:83]
    v_pk_mul_f32 v[152:153], v[152:153], v[80:81]
    v_pk_mul_f32 v[154:155], v[154:155], v[82:83]
    v_exp_f32 v36, v104 clamp
    v_exp_f32 v37, v105 clamp
    v_exp_f32 v38, v106 clamp
    v_exp_f32 v39, v107 clamp
    v_exp_f32 v40, v120 clamp
    v_exp_f32 v41, v121 clamp
    v_exp_f32 v42, v122 clamp
    v_exp_f32 v43, v123 clamp
    v_cvt_pk_bf16_f32 v134, v136, v137
    v_cvt_pk_bf16_f32 v135, v138, v139
    v_cvt_pk_bf16_f32 v150, v152, v153
    v_cvt_pk_bf16_f32 v151, v154, v155
    v_pk_mul_f32 v[104:105], v[104:105], s[40:41] clamp
    v_pk_mul_f32 v[106:107], v[106:107], s[40:41] clamp
    v_pk_mul_f32 v[120:121], v[120:121], s[40:41] clamp
    v_pk_mul_f32 v[122:123], v[122:123], s[40:41] clamp
    v_pk_add_f32 v[36:37], v[36:37], s[74:75]
    v_pk_add_f32 v[38:39], v[38:39], s[74:75]
    v_pk_add_f32 v[40:41], v[40:41], s[74:75]
    v_pk_add_f32 v[42:43], v[42:43], s[74:75]
    v_pk_fma_f32 v[104:105], v[104:105], s[76:77], v[36:37]
    v_pk_fma_f32 v[106:107], v[106:107], s[76:77], v[38:39]
    v_pk_fma_f32 v[120:121], v[120:121], s[76:77], v[40:41]
    v_pk_fma_f32 v[122:123], v[122:123], s[76:77], v[42:43]
    v_cvt_pk_bf16_f32 v102, v104, v105
    v_cvt_pk_bf16_f32 v103, v106, v107
    v_cvt_pk_bf16_f32 v118, v120, v121
    v_cvt_pk_bf16_f32 v119, v122, v123
    s_waitcnt lgkmcnt(3)
    v_pk_fma_f32 v[108:109], v[84:85], v[52:53], v[108:109]
    v_pk_fma_f32 v[110:111], v[86:87], v[52:53], v[110:111]
    v_pk_fma_f32 v[124:125], v[84:85], v[54:55], v[124:125]
    v_pk_fma_f32 v[126:127], v[86:87], v[54:55], v[126:127]
    v_pk_fma_f32 v[140:141], v[84:85], v[56:57], v[140:141]
    v_pk_fma_f32 v[142:143], v[86:87], v[56:57], v[142:143]
    v_pk_fma_f32 v[156:157], v[84:85], v[58:59], v[156:157]
    v_pk_fma_f32 v[158:159], v[86:87], v[58:59], v[158:159]
    s_waitcnt lgkmcnt(2)
    v_pk_mul_f32 v[108:109], v[108:109], v[88:89]
    v_pk_mul_f32 v[110:111], v[110:111], v[90:91]
    v_pk_mul_f32 v[124:125], v[124:125], v[88:89]
    v_pk_mul_f32 v[126:127], v[126:127], v[90:91]
    v_pk_mul_f32 v[140:141], v[140:141], v[88:89]
    v_pk_mul_f32 v[142:143], v[142:143], v[90:91]
    v_pk_mul_f32 v[156:157], v[156:157], v[88:89]
    v_pk_mul_f32 v[158:159], v[158:159], v[90:91]
    v_mfma_f32_16x16x32_bf16 v[60:63], v[100:103], v[148:151], 0
    v_exp_f32 v28, v108 clamp
    v_exp_f32 v29, v109 clamp
    v_mfma_f32_16x16x32_bf16 v[64:67], v[116:119], v[148:151], 0
    v_exp_f32 v30, v110 clamp
    v_exp_f32 v31, v111 clamp
    v_mfma_f32_16x16x32_bf16 v[68:71], v[100:103], v[20:23], 0
    v_exp_f32 v32, v124 clamp
    v_exp_f32 v33, v125 clamp
    v_exp_f32 v34, v126 clamp
    v_exp_f32 v35, v127 clamp
    v_cvt_pk_bf16_f32 v136, v140, v141
    v_cvt_pk_bf16_f32 v137, v142, v143
    v_cvt_pk_bf16_f32 v152, v156, v157
    v_cvt_pk_bf16_f32 v153, v158, v159
    v_pk_mul_f32 v[108:109], v[108:109], s[40:41] clamp
    v_pk_mul_f32 v[110:111], v[110:111], s[40:41] clamp
    v_pk_mul_f32 v[124:125], v[124:125], s[40:41] clamp
    v_pk_mul_f32 v[126:127], v[126:127], s[40:41] clamp
    v_pk_add_f32 v[28:29], v[28:29], s[74:75]
    v_pk_add_f32 v[30:31], v[30:31], s[74:75]
    v_pk_add_f32 v[32:33], v[32:33], s[74:75]
    v_pk_add_f32 v[34:35], v[34:35], s[74:75]
    v_pk_fma_f32 v[108:109], v[108:109], s[76:77], v[28:29]
    v_pk_fma_f32 v[110:111], v[110:111], s[76:77], v[30:31]
    v_pk_fma_f32 v[124:125], v[124:125], s[76:77], v[32:33]
    v_pk_fma_f32 v[126:127], v[126:127], s[76:77], v[34:35]
    v_cvt_pk_bf16_f32 v104, v108, v109
    v_cvt_pk_bf16_f32 v105, v110, v111
    v_cvt_pk_bf16_f32 v120, v124, v125
    v_cvt_pk_bf16_f32 v121, v126, v127
    s_waitcnt lgkmcnt(1)
    v_pk_fma_f32 v[112:113], v[92:93], v[52:53], v[112:113]
    v_pk_fma_f32 v[114:115], v[94:95], v[52:53], v[114:115]
    v_pk_fma_f32 v[128:129], v[92:93], v[54:55], v[128:129]
    v_pk_fma_f32 v[130:131], v[94:95], v[54:55], v[130:131]
    v_pk_fma_f32 v[144:145], v[92:93], v[56:57], v[144:145]
    v_pk_fma_f32 v[146:147], v[94:95], v[56:57], v[146:147]
    v_pk_fma_f32 v[160:161], v[92:93], v[58:59], v[160:161]
    v_pk_fma_f32 v[162:163], v[94:95], v[58:59], v[162:163]
    s_waitcnt lgkmcnt(0)
    v_pk_mul_f32 v[112:113], v[112:113], v[96:97]
    v_pk_mul_f32 v[114:115], v[114:115], v[98:99]
    v_pk_mul_f32 v[128:129], v[128:129], v[96:97]
    v_pk_mul_f32 v[130:131], v[130:131], v[98:99]
    v_pk_mul_f32 v[144:145], v[144:145], v[96:97]
    v_pk_mul_f32 v[146:147], v[146:147], v[98:99]
    v_pk_mul_f32 v[160:161], v[160:161], v[96:97]
    v_pk_mul_f32 v[162:163], v[162:163], v[98:99]
    v_mfma_f32_16x16x32_bf16 v[72:75], v[116:119], v[20:23], 0
    v_exp_f32 v36, v112 clamp
    v_exp_f32 v37, v113 clamp
    v_mfma_f32_16x16x32_bf16 v[44:47], v[100:103], v[132:135], 0
    v_exp_f32 v38, v114 clamp
    v_exp_f32 v39, v115 clamp
    v_mfma_f32_16x16x32_bf16 v[48:51], v[116:119], v[132:135], 0
    v_exp_f32 v40, v128 clamp
    v_exp_f32 v41, v129 clamp
    v_exp_f32 v42, v130 clamp
    v_exp_f32 v43, v131 clamp
    s_branch IW_s5
IW_w5:
    s_branch IW_r5
IW_s5:
    v_cvt_pk_bf16_f32 v138, v144, v145
    v_cvt_pk_bf16_f32 v139, v146, v147
    v_cvt_pk_bf16_f32 v154, v160, v161
    v_cvt_pk_bf16_f32 v155, v162, v163
    v_pk_mul_f32 v[112:113], v[112:113], s[40:41] clamp
    v_pk_mul_f32 v[114:115], v[114:115], s[40:41] clamp
    v_pk_mul_f32 v[128:129], v[128:129], s[40:41] clamp
    v_pk_mul_f32 v[130:131], v[130:131], s[40:41] clamp
    v_pk_add_f32 v[36:37], v[36:37], s[74:75]
    v_pk_add_f32 v[38:39], v[38:39], s[74:75]
    v_pk_add_f32 v[40:41], v[40:41], s[74:75]
    v_pk_add_f32 v[42:43], v[42:43], s[74:75]
    v_pk_fma_f32 v[112:113], v[112:113], s[76:77], v[36:37]
    v_pk_fma_f32 v[114:115], v[114:115], s[76:77], v[38:39]
    v_pk_fma_f32 v[128:129], v[128:129], s[76:77], v[40:41]
    v_pk_fma_f32 v[130:131], v[130:131], s[76:77], v[42:43]
    v_cvt_pk_bf16_f32 v106, v112, v113
    v_cvt_pk_bf16_f32 v107, v114, v115
    v_cvt_pk_bf16_f32 v122, v128, v129
    v_cvt_pk_bf16_f32 v123, v130, v131
    v_mfma_f32_16x16x32_bf16 v[60:63], v[104:107], v[152:155], v[60:63]
    s_nop 0
    v_mfma_f32_16x16x32_bf16 v[64:67], v[120:123], v[152:155], v[64:67]
    v_mfma_f32_16x16x32_bf16 v[68:71], v[104:107], v[20:23], v[68:71]
    v_mfma_f32_16x16x32_bf16 v[72:75], v[120:123], v[20:23], v[72:75]
    v_mfma_f32_16x16x32_bf16 v[44:47], v[104:107], v[136:139], v[44:47]
    v_mfma_f32_16x16x32_bf16 v[48:51], v[120:123], v[136:139], v[48:51]
    buffer_load_dwordx4 v[140:143], v7, s[12:15], s42 offen offset:0
    buffer_load_dwordx4 v[144:147], v7, s[12:15], s42 offen offset:64
    buffer_load_dwordx4 v[156:159], v7, s[12:15], s43 offen offset:0
    buffer_load_dwordx4 v[160:163], v7, s[12:15], s43 offen offset:64
    ds_write_b128 v12, v[60:63] offset:0
    ds_write_b128 v12, v[64:67] offset:1024
    s_mov_b32 exec_lo, 0x10001
    s_mov_b32 exec_hi, 0x10001
    ds_write_b128 v14, v[68:71]
    ds_write_b128 v15, v[72:75]
    s_mov_b64 exec, 1
    ds_write_b32 v3, v24 offset:32
    s_mov_b64 exec, -1
F_xw:
    ds_read_b32 v25, v18 offset:32
    ds_read_b128 v[28:31], v13 offset:1024
    ds_read_b128 v[32:35], v13
    ds_read_b32 v26, v16
    ds_read_b32 v27, v17
    s_waitcnt lgkmcnt(4)
    v_cmp_eq_u32 vcc, 0, v25
    s_cbranch_vccz F_xx
    s_waitcnt lgkmcnt(0)
    s_branch F_xw
F_xx:
    s_waitcnt lgkmcnt(3)
    v_add_f32 v44, v44, v28
    v_add_f32 v45, v45, v29
    v_add_f32 v46, v46, v30
    v_add_f32 v47, v47, v31
    buffer_atomic_add_f32 v44, v19, s[24:27], s46 offen offset:0
    buffer_atomic_add_f32 v45, v19, s[24:27], s46 offen offset:256
    buffer_atomic_add_f32 v46, v19, s[24:27], s46 offen offset:512
    buffer_atomic_add_f32 v47, v19, s[24:27], s46 offen offset:768
    s_waitcnt lgkmcnt(2)
    v_add_f32 v48, v48, v32
    v_add_f32 v49, v49, v33
    v_add_f32 v50, v50, v34
    v_add_f32 v51, v51, v35
    buffer_atomic_add_f32 v48, v19, s[24:27], s47 offen offset:0
    buffer_atomic_add_f32 v49, v19, s[24:27], s47 offen offset:256
    buffer_atomic_add_f32 v50, v19, s[24:27], s47 offen offset:512
    buffer_atomic_add_f32 v51, v19, s[24:27], s47 offen offset:768
    s_waitcnt lgkmcnt(0)
    v_add_f32 v26, v26, v27
    s_mov_b64 exec, 0xffff
    buffer_atomic_add_f32 v26, v19, s[24:27], s48 offen
    s_mov_b64 exec, 1
    ds_add_u32 v3, v24 offset:32
    s_mov_b64 exec, -1
    s_setprio 2
    v_mov_b32 v2, v7
    s_lshl_b32 s47, s3, 7
    s_add_u32 s47, s47, 157184
    v_lshlrev_b32 v5, 2, v4
    v_add_u32 v5, s47, v5
    ds_read2_b32 v[76:77], v5 offset0:0 offset1:128
    ds_read2_b32 v[78:79], v5 offset0:16 offset1:144
    v_lshrrev_b32 v4, 3, v0
    v_and_b32 v5, 7, v0
    v_lshrrev_b32 v6, 1, v4
    v_lshlrev_b32 v7, 1, v6
    v_xor_b32 v7, v5, v7
    v_lshlrev_b32 v7, 4, v7
    v_lshl_add_u32 v40, v4, 11, v7
    v_and_b32 v6, 1, v6
    v_lshlrev_b32 v6, 1, v6
    v_xor_b32 v41, v5, v6
    v_xor_b32 v42, 4, v41
    v_lshlrev_b32 v41, 4, v41
    v_lshlrev_b32 v42, 4, v42
    v_mul_u32_u24 v7, 6144, v4
    v_add_u32 v41, v41, v7
    v_add_u32 v42, v42, v7
    v_add_u32 v42, 49152, v42
    s_mul_i32 s56, s3, 98304
    s_lshl_b32 s47, s10, 7
    s_add_u32 s56, s56, s47
    s_lshl_b32 s57, s29, 7
    s_lshl_b32 s47, s3, 15
    s_add_u32 s57, s57, s47
    s_and_b32 s81, s28, 3
    s_mul_i32 s81, s81, 4
    s_lshr_b32 s47, s28, 2
    s_mul_i32 s47, s47, 1
    s_add_u32 s81, s81, s47
    s_lshl_b32 s78, s3, 11
    s_lshl_b32 s44, s10, 1
    s_add_u32 s44, s44, s37
    s_mul_i32 s45, s44, 4224
    s_mov_b32 s52, s45
    s_add_u32 s53, s45, 4096
    s_lshl_b32 s51, s44, 3
    s_and_b32 s47, s32, 3
    s_add_u32 s51, s51, s47
    s_lshl_b32 s51, s51, 7
    v_xor_b32 v18, 8, v3
    v_mov_b32 v25, 0

    s_add_u32 s54, s51, 0x82d000
    s_add_u32 s54, s72, s54
    s_addc_u32 s55, s73, 0
    s_add_u32 s82, s49, 0x82d000
    s_add_u32 s82, s72, s82
    s_addc_u32 s83, s73, 0
    s_lshl_b32 s57, s29, 7
    s_and_b32 s47, s3, 1
    s_lshl_b32 s79, s47, 12
    s_lshl_b32 s47, s47, 16
    s_add_u32 s57, s57, s47

    s_setprio 2
    s_waitcnt lgkmcnt(0)
    v_mul_f32 v76, v76, v77
    v_add_f32 v77, 1.0, v77
    v_mul_f32 v78, v78, v79
    v_add_f32 v79, 1.0, v79
    s_waitcnt vmcnt(9)
    v_lshlrev_b32 v100, 16, v140
    v_and_b32 v101, 0xffff0000, v140
    v_lshlrev_b32 v102, 16, v141
    v_and_b32 v103, 0xffff0000, v141
    v_lshlrev_b32 v104, 16, v142
    v_and_b32 v105, 0xffff0000, v142
    v_lshlrev_b32 v106, 16, v143
    v_and_b32 v107, 0xffff0000, v143
    v_fma_f32 v100, v100, v77, v76
    v_fma_f32 v101, v101, v77, v76
    v_fma_f32 v102, v102, v77, v76
    v_fma_f32 v103, v103, v77, v76
    v_fma_f32 v104, v104, v77, v76
    v_fma_f32 v105, v105, v77, v76
    v_fma_f32 v106, v106, v77, v76
    v_fma_f32 v107, v107, v77, v76
    v_lshlrev_b32 v108, 16, v144
    v_and_b32 v109, 0xffff0000, v144
    v_lshlrev_b32 v110, 16, v145
    v_and_b32 v111, 0xffff0000, v145
    v_lshlrev_b32 v112, 16, v146
    v_and_b32 v113, 0xffff0000, v146
    v_lshlrev_b32 v114, 16, v147
    v_and_b32 v115, 0xffff0000, v147
    v_fma_f32 v108, v108, v77, v76
    v_fma_f32 v109, v109, v77, v76
    v_fma_f32 v110, v110, v77, v76
    v_fma_f32 v111, v111, v77, v76
    v_fma_f32 v112, v112, v77, v76
    v_fma_f32 v113, v113, v77, v76
    v_fma_f32 v114, v114, v77, v76
    v_fma_f32 v115, v115, v77, v76
    v_lshlrev_b32 v116, 16, v156
    v_and_b32 v117, 0xffff0000, v156
    v_lshlrev_b32 v118, 16, v157
    v_and_b32 v119, 0xffff0000, v157
    v_lshlrev_b32 v120, 16, v158
    v_and_b32 v121, 0xffff0000, v158
    v_lshlrev_b32 v122, 16, v159
    v_and_b32 v123, 0xffff0000, v159
    v_fma_f32 v116, v116, v79, v78
    v_fma_f32 v117, v117, v79, v78
    v_fma_f32 v118, v118, v79, v78
    v_fma_f32 v119, v119, v79, v78
    v_fma_f32 v120, v120, v79, v78
    v_fma_f32 v121, v121, v79, v78
    v_fma_f32 v122, v122, v79, v78
    v_fma_f32 v123, v123, v79, v78
    v_lshlrev_b32 v124, 16, v160
    v_and_b32 v125, 0xffff0000, v160
    v_lshlrev_b32 v126, 16, v161
    v_and_b32 v127, 0xffff0000, v161
    v_lshlrev_b32 v128, 16, v162
    v_and_b32 v129, 0xffff0000, v162
    v_lshlrev_b32 v130, 16, v163
    v_and_b32 v131, 0xffff0000, v163
    v_fma_f32 v124, v124, v79, v78
    v_fma_f32 v125, v125, v79, v78
    v_fma_f32 v126, v126, v79, v78
    v_fma_f32 v127, v127, v79, v78
    v_fma_f32 v128, v128, v79, v78
    v_fma_f32 v129, v129, v79, v78
    v_fma_f32 v130, v130, v79, v78
    v_fma_f32 v131, v131, v79, v78
    v_permlane16_swap_b32 v100, v104
    v_permlane16_swap_b32 v101, v105
    v_permlane16_swap_b32 v102, v106
    v_permlane16_swap_b32 v103, v107
    v_permlane16_swap_b32 v108, v112
    v_permlane16_swap_b32 v109, v113
    v_permlane16_swap_b32 v110, v114
    v_permlane16_swap_b32 v111, v115
    v_permlane16_swap_b32 v116, v120
    v_permlane16_swap_b32 v117, v121
    v_permlane16_swap_b32 v118, v122
    v_permlane16_swap_b32 v119, v123
    v_permlane16_swap_b32 v124, v128
    v_permlane16_swap_b32 v125, v129
    v_permlane16_swap_b32 v126, v130
    v_permlane16_swap_b32 v127, v131
    s_setprio 2
    s_cmp_lt_u32 s3, 2
    s_cbranch_scc1 F_w0
    v_cmp_gt_u32 vcc, 1, v25
    s_cbranch_vccz CW_20
    ds_read_b32 v25, v1 offset:0
FW_21:
    s_waitcnt lgkmcnt(0)
    v_cmp_gt_u32 vcc, 1, v25
    s_cbranch_vccz FO_22
    s_sleep 2
    ds_read_b32 v25, v1 offset:0
    s_branch FW_21
FO_22:
CW_20:
    s_add_u32 s47, s81, 0
    s_and_b32 s47, s47, 15
    s_lshl_b32 s47, s47, 17
    s_add_u32 m0, s79, 147456
    s_add_u32 s47, s47, s57
    buffer_load_dwordx4 v40, s[20:23], s47 offen lds
    s_add_u32 m0, m0, 1024
    s_add_u32 s47, s47, 16384
    buffer_load_dwordx4 v40, s[20:23], s47 offen lds
    s_add_u32 m0, m0, 1024
    s_add_u32 s47, s47, 16384
    buffer_load_dwordx4 v40, s[20:23], s47 offen lds
    s_add_u32 m0, m0, 1024
    s_add_u32 s47, s47, 16384
    buffer_load_dwordx4 v40, s[20:23], s47 offen lds
    v_cmp_gt_u32 vcc, 2, v25
    s_cbranch_vccz CW_23
    ds_read_b32 v25, v1 offset:0
FW_24:
    s_waitcnt lgkmcnt(0)
    v_cmp_gt_u32 vcc, 2, v25
    s_cbranch_vccz FO_25
    s_sleep 2
    ds_read_b32 v25, v1 offset:0
    s_branch FW_24
FO_25:
CW_23:
    s_add_u32 s47, s81, 1
    s_and_b32 s47, s47, 15
    s_lshl_b32 s47, s47, 17
    s_add_u32 m0, s79, 0
    s_add_u32 s47, s47, s57
    buffer_load_dwordx4 v40, s[20:23], s47 offen lds
    s_add_u32 m0, m0, 1024
    s_add_u32 s47, s47, 16384
    buffer_load_dwordx4 v40, s[20:23], s47 offen lds
    s_add_u32 m0, m0, 1024
    s_add_u32 s47, s47, 16384
    buffer_load_dwordx4 v40, s[20:23], s47 offen lds
    s_add_u32 m0, m0, 1024
    s_add_u32 s47, s47, 16384
    buffer_load_dwordx4 v40, s[20:23], s47 offen lds
    s_waitcnt vmcnt(8)
    s_branch F_w1
F_w0:
    s_waitcnt vmcnt(0)
F_w1:
    s_mov_b32 s49, 1
    s_atomic_add s49, s[82:83], 0x0
    s_atomic_add s49, s[82:83], 0x80
    s_atomic_add s49, s[82:83], 0x100
    s_atomic_add s49, s[82:83], 0x180
    v_mov_b32 v26, 3
    s_mov_b64 exec, 1
    ds_write_b32 v3, v26 offset:32
    s_mov_b64 exec, -1
    s_cmp_ge_u32 s3, 2
    s_cbranch_scc1 F_wo
    ds_read_b32 v26, v18 offset:32
FW_26:
    s_waitcnt lgkmcnt(0)
    v_cmp_gt_u32 vcc, 2, v26
    s_cbranch_vccz FO_27
    ds_read_b32 v26, v18 offset:32
    s_branch FW_26
FO_27:
    v_cmp_gt_u32 vcc, 4, v25
    s_cbranch_vccz CW_28
    ds_read_b32 v25, v1 offset:0
FW_29:
    s_waitcnt lgkmcnt(0)
    v_cmp_gt_u32 vcc, 4, v25
    s_cbranch_vccz FO_30
    s_sleep 2
    ds_read_b32 v25, v1 offset:0
    s_branch FW_29
FO_30:
CW_28:
    v_lshlrev_b32 v9, 4, v0
    s_lshl_b32 s50, s3, 7
    s_add_u32 s50, s50, 159232
    s_add_u32 m0, s78, 40960
SP_31:
    s_load_dword s58, s[54:55], 0 glc
    s_waitcnt lgkmcnt(0)
    s_cmp_ge_u32 s58, 32
    s_cbranch_scc1 SD_32
    s_sleep 1
    s_branch SP_31
SD_32:
    buffer_load_dwordx4 v9, s[24:27], s52 offen offset:0 sc1 lds
    buffer_load_dwordx4 v9, s[24:27], s52 offen offset:1024 sc1 lds
    s_add_u32 m0, m0, 2048
    s_nop 0
    buffer_load_dwordx4 v9, s[24:27], s52 offen offset:2048 sc1 lds
    buffer_load_dwordx4 v9, s[24:27], s52 offen offset:3072 sc1 lds
    s_mov_b32 m0, s50
    s_mov_b32 exec_hi, 0
    buffer_load_dword v19, s[24:27], s53 offen sc1 lds
    s_mov_b64 exec, 1
    s_lshl_b32 s50, s3, 2
    s_add_u32 m0, s50, 159168
    s_add_u32 s51, s51, 184320
    buffer_load_dword v19, s[24:27], s51 offen sc1 lds
    s_waitcnt vmcnt(0)
    s_mov_b64 exec, 1
    v_mov_b32 v26, 32
    ds_write_b32 v3, v26 offset:128
    s_mov_b64 exec, -1
    s_branch F_wj
F_wo:
    v_cmp_gt_u32 vcc, 2, v25
    s_cbranch_vccz CW_33
    ds_read_b32 v25, v1 offset:0
FW_34:
    s_waitcnt lgkmcnt(0)
    v_cmp_gt_u32 vcc, 2, v25
    s_cbranch_vccz FO_35
    s_sleep 2
    ds_read_b32 v25, v1 offset:0
    s_branch FW_34
FO_35:
CW_33:
    s_add_u32 s47, s81, 2
    s_and_b32 s47, s47, 15
    s_lshl_b32 s47, s47, 17
    s_add_u32 m0, s79, 8192
    s_add_u32 s47, s47, s57
    buffer_load_dwordx4 v40, s[20:23], s47 offen lds
    s_add_u32 m0, m0, 1024
    s_add_u32 s47, s47, 16384
    buffer_load_dwordx4 v40, s[20:23], s47 offen lds
    s_add_u32 m0, m0, 1024
    s_add_u32 s47, s47, 16384
    buffer_load_dwordx4 v40, s[20:23], s47 offen lds
    s_add_u32 m0, m0, 1024
    s_add_u32 s47, s47, 16384
    buffer_load_dwordx4 v40, s[20:23], s47 offen lds
    v_cmp_gt_u32 vcc, 2, v25
    s_cbranch_vccz CW_36
    ds_read_b32 v25, v1 offset:0
FW_37:
    s_waitcnt lgkmcnt(0)
    v_cmp_gt_u32 vcc, 2, v25
    s_cbranch_vccz FO_38
    s_sleep 2
    ds_read_b32 v25, v1 offset:0
    s_branch FW_37
FO_38:
CW_36:
    s_waitcnt vmcnt(8)
    s_add_u32 s47, s81, 3
    s_and_b32 s47, s47, 15
    s_lshl_b32 s47, s47, 17
    s_add_u32 m0, s79, 139264
    s_add_u32 s47, s47, s57
    buffer_load_dwordx4 v40, s[20:23], s47 offen lds
    s_add_u32 m0, m0, 1024
    s_add_u32 s47, s47, 16384
    buffer_load_dwordx4 v40, s[20:23], s47 offen lds
    s_add_u32 m0, m0, 1024
    s_add_u32 s47, s47, 16384
    buffer_load_dwordx4 v40, s[20:23], s47 offen lds
    s_add_u32 m0, m0, 1024
    s_add_u32 s47, s47, 16384
    buffer_load_dwordx4 v40, s[20:23], s47 offen lds
    v_cmp_gt_u32 vcc, 3, v25
    s_cbranch_vccz CW_39
    ds_read_b32 v25, v1 offset:0
FW_40:
    s_waitcnt lgkmcnt(0)
    v_cmp_gt_u32 vcc, 3, v25
    s_cbranch_vccz FO_41
    s_sleep 2
    ds_read_b32 v25, v1 offset:0
    s_branch FW_40
FO_41:
CW_39:
    s_waitcnt vmcnt(8)
    s_add_u32 s47, s81, 4
    s_and_b32 s47, s47, 15
    s_lshl_b32 s47, s47, 17
    s_add_u32 m0, s79, 16384
    s_add_u32 s47, s47, s57
    buffer_load_dwordx4 v40, s[20:23], s47 offen lds
    s_add_u32 m0, m0, 1024
    s_add_u32 s47, s47, 16384
    buffer_load_dwordx4 v40, s[20:23], s47 offen lds
    s_add_u32 m0, m0, 1024
    s_add_u32 s47, s47, 16384
    buffer_load_dwordx4 v40, s[20:23], s47 offen lds
    s_add_u32 m0, m0, 1024
    s_add_u32 s47, s47, 16384
    buffer_load_dwordx4 v40, s[20:23], s47 offen lds
    v_cmp_gt_u32 vcc, 3, v25
    s_cbranch_vccz CW_42
    ds_read_b32 v25, v1 offset:0
FW_43:
    s_waitcnt lgkmcnt(0)
    v_cmp_gt_u32 vcc, 3, v25
    s_cbranch_vccz FO_44
    s_sleep 2
    ds_read_b32 v25, v1 offset:0
    s_branch FW_43
FO_44:
CW_42:
    s_waitcnt vmcnt(8)
    s_add_u32 s47, s81, 5
    s_and_b32 s47, s47, 15
    s_lshl_b32 s47, s47, 17
    s_add_u32 m0, s79, 24576
    s_add_u32 s47, s47, s57
    buffer_load_dwordx4 v40, s[20:23], s47 offen lds
    s_add_u32 m0, m0, 1024
    s_add_u32 s47, s47, 16384
    buffer_load_dwordx4 v40, s[20:23], s47 offen lds
    s_add_u32 m0, m0, 1024
    s_add_u32 s47, s47, 16384
    buffer_load_dwordx4 v40, s[20:23], s47 offen lds
    s_add_u32 m0, m0, 1024
    s_add_u32 s47, s47, 16384
    buffer_load_dwordx4 v40, s[20:23], s47 offen lds
    v_cmp_gt_u32 vcc, 3, v25
    s_cbranch_vccz CW_45
    ds_read_b32 v25, v1 offset:0
FW_46:
    s_waitcnt lgkmcnt(0)
    v_cmp_gt_u32 vcc, 3, v25
    s_cbranch_vccz FO_47
    s_sleep 2
    ds_read_b32 v25, v1 offset:0
    s_branch FW_46
FO_47:
CW_45:
    s_waitcnt vmcnt(8)
    s_add_u32 s47, s81, 6
    s_and_b32 s47, s47, 15
    s_lshl_b32 s47, s47, 17
    s_add_u32 m0, s79, 131072
    s_add_u32 s47, s47, s57
    buffer_load_dwordx4 v40, s[20:23], s47 offen lds
    s_add_u32 m0, m0, 1024
    s_add_u32 s47, s47, 16384
    buffer_load_dwordx4 v40, s[20:23], s47 offen lds
    s_add_u32 m0, m0, 1024
    s_add_u32 s47, s47, 16384
    buffer_load_dwordx4 v40, s[20:23], s47 offen lds
    s_add_u32 m0, m0, 1024
    s_add_u32 s47, s47, 16384
    buffer_load_dwordx4 v40, s[20:23], s47 offen lds
    v_cmp_gt_u32 vcc, 4, v25
    s_cbranch_vccz CW_48
    ds_read_b32 v25, v1 offset:0
FW_49:
    s_waitcnt lgkmcnt(0)
    v_cmp_gt_u32 vcc, 4, v25
    s_cbranch_vccz FO_50
    s_sleep 2
    ds_read_b32 v25, v1 offset:0
    s_branch FW_49
FO_50:
CW_48:
    s_waitcnt vmcnt(8)
    s_add_u32 s47, s81, 7
    s_and_b32 s47, s47, 15
    s_lshl_b32 s47, s47, 17
    s_add_u32 m0, s79, 81920
    s_add_u32 s47, s47, s57
    buffer_load_dwordx4 v40, s[20:23], s47 offen lds
    s_add_u32 m0, m0, 1024
    s_add_u32 s47, s47, 16384
    buffer_load_dwordx4 v40, s[20:23], s47 offen lds
    s_add_u32 m0, m0, 1024
    s_add_u32 s47, s47, 16384
    buffer_load_dwordx4 v40, s[20:23], s47 offen lds
    s_add_u32 m0, m0, 1024
    s_add_u32 s47, s47, 16384
    buffer_load_dwordx4 v40, s[20:23], s47 offen lds
    v_cmp_gt_u32 vcc, 5, v25
    s_cbranch_vccz CW_51
    ds_read_b32 v25, v1 offset:0
FW_52:
    s_waitcnt lgkmcnt(0)
    v_cmp_gt_u32 vcc, 5, v25
    s_cbranch_vccz FO_53
    s_sleep 2
    ds_read_b32 v25, v1 offset:0
    s_branch FW_52
FO_53:
CW_51:
    s_waitcnt vmcnt(8)
    s_add_u32 s47, s81, 8
    s_and_b32 s47, s47, 15
    s_lshl_b32 s47, s47, 17
    s_add_u32 m0, s79, 49152
    s_add_u32 s47, s47, s57
    buffer_load_dwordx4 v40, s[20:23], s47 offen lds
    s_add_u32 m0, m0, 1024
    s_add_u32 s47, s47, 16384
    buffer_load_dwordx4 v40, s[20:23], s47 offen lds
    s_add_u32 m0, m0, 1024
    s_add_u32 s47, s47, 16384
    buffer_load_dwordx4 v40, s[20:23], s47 offen lds
    s_add_u32 m0, m0, 1024
    s_add_u32 s47, s47, 16384
    buffer_load_dwordx4 v40, s[20:23], s47 offen lds
    v_cmp_gt_u32 vcc, 5, v25
    s_cbranch_vccz CW_54
    ds_read_b32 v25, v1 offset:0
FW_55:
    s_waitcnt lgkmcnt(0)
    v_cmp_gt_u32 vcc, 5, v25
    s_cbranch_vccz FO_56
    s_sleep 2
    ds_read_b32 v25, v1 offset:0
    s_branch FW_55
FO_56:
CW_54:
    s_waitcnt vmcnt(8)
    s_add_u32 s47, s81, 9
    s_and_b32 s47, s47, 15
    s_lshl_b32 s47, s47, 17
    s_add_u32 m0, s79, 57344
    s_add_u32 s47, s47, s57
    buffer_load_dwordx4 v40, s[20:23], s47 offen lds
    s_add_u32 m0, m0, 1024
    s_add_u32 s47, s47, 16384
    buffer_load_dwordx4 v40, s[20:23], s47 offen lds
    s_add_u32 m0, m0, 1024
    s_add_u32 s47, s47, 16384
    buffer_load_dwordx4 v40, s[20:23], s47 offen lds
    s_add_u32 m0, m0, 1024
    s_add_u32 s47, s47, 16384
    buffer_load_dwordx4 v40, s[20:23], s47 offen lds
    v_cmp_gt_u32 vcc, 5, v25
    s_cbranch_vccz CW_57
    ds_read_b32 v25, v1 offset:0
FW_58:
    s_waitcnt lgkmcnt(0)
    v_cmp_gt_u32 vcc, 5, v25
    s_cbranch_vccz FO_59
    s_sleep 2
    ds_read_b32 v25, v1 offset:0
    s_branch FW_58
FO_59:
CW_57:
    s_waitcnt vmcnt(8)
    s_add_u32 s47, s81, 10
    s_and_b32 s47, s47, 15
    s_lshl_b32 s47, s47, 17
    s_add_u32 m0, s79, 73728
    s_add_u32 s47, s47, s57
    buffer_load_dwordx4 v40, s[20:23], s47 offen lds
    s_add_u32 m0, m0, 1024
    s_add_u32 s47, s47, 16384
    buffer_load_dwordx4 v40, s[20:23], s47 offen lds
    s_add_u32 m0, m0, 1024
    s_add_u32 s47, s47, 16384
    buffer_load_dwordx4 v40, s[20:23], s47 offen lds
    s_add_u32 m0, m0, 1024
    s_add_u32 s47, s47, 16384
    buffer_load_dwordx4 v40, s[20:23], s47 offen lds
    v_cmp_gt_u32 vcc, 6, v25
    s_cbranch_vccz CW_60
    ds_read_b32 v25, v1 offset:0
FW_61:
    s_waitcnt lgkmcnt(0)
    v_cmp_gt_u32 vcc, 6, v25
    s_cbranch_vccz FO_62
    s_sleep 2
    ds_read_b32 v25, v1 offset:0
    s_branch FW_61
FO_62:
CW_60:
    s_waitcnt vmcnt(8)
    s_add_u32 s47, s81, 11
    s_and_b32 s47, s47, 15
    s_lshl_b32 s47, s47, 17
    s_add_u32 m0, s79, 98304
    s_add_u32 s47, s47, s57
    buffer_load_dwordx4 v40, s[20:23], s47 offen lds
    s_add_u32 m0, m0, 1024
    s_add_u32 s47, s47, 16384
    buffer_load_dwordx4 v40, s[20:23], s47 offen lds
    s_add_u32 m0, m0, 1024
    s_add_u32 s47, s47, 16384
    buffer_load_dwordx4 v40, s[20:23], s47 offen lds
    s_add_u32 m0, m0, 1024
    s_add_u32 s47, s47, 16384
    buffer_load_dwordx4 v40, s[20:23], s47 offen lds
    v_cmp_gt_u32 vcc, 7, v25
    s_cbranch_vccz CW_63
    ds_read_b32 v25, v1 offset:0
FW_64:
    s_waitcnt lgkmcnt(0)
    v_cmp_gt_u32 vcc, 7, v25
    s_cbranch_vccz FO_65
    s_sleep 2
    ds_read_b32 v25, v1 offset:0
    s_branch FW_64
FO_65:
CW_63:
    s_waitcnt vmcnt(8)
    s_add_u32 s47, s81, 12
    s_and_b32 s47, s47, 15
    s_lshl_b32 s47, s47, 17
    s_add_u32 m0, s79, 90112
    s_add_u32 s47, s47, s57
    buffer_load_dwordx4 v40, s[20:23], s47 offen lds
    s_add_u32 m0, m0, 1024
    s_add_u32 s47, s47, 16384
    buffer_load_dwordx4 v40, s[20:23], s47 offen lds
    s_add_u32 m0, m0, 1024
    s_add_u32 s47, s47, 16384
    buffer_load_dwordx4 v40, s[20:23], s47 offen lds
    s_add_u32 m0, m0, 1024
    s_add_u32 s47, s47, 16384
    buffer_load_dwordx4 v40, s[20:23], s47 offen lds
    v_cmp_gt_u32 vcc, 8, v25
    s_cbranch_vccz CW_66
    ds_read_b32 v25, v1 offset:0
FW_67:
    s_waitcnt lgkmcnt(0)
    v_cmp_gt_u32 vcc, 8, v25
    s_cbranch_vccz FO_68
    s_sleep 2
    ds_read_b32 v25, v1 offset:0
    s_branch FW_67
FO_68:
CW_66:
    s_waitcnt vmcnt(8)
    s_add_u32 s47, s81, 13
    s_and_b32 s47, s47, 15
    s_lshl_b32 s47, s47, 17
    s_add_u32 m0, s79, 114688
    s_add_u32 s47, s47, s57
    buffer_load_dwordx4 v40, s[20:23], s47 offen lds
    s_add_u32 m0, m0, 1024
    s_add_u32 s47, s47, 16384
    buffer_load_dwordx4 v40, s[20:23], s47 offen lds
    s_add_u32 m0, m0, 1024
    s_add_u32 s47, s47, 16384
    buffer_load_dwordx4 v40, s[20:23], s47 offen lds
    s_add_u32 m0, m0, 1024
    s_add_u32 s47, s47, 16384
    buffer_load_dwordx4 v40, s[20:23], s47 offen lds
    v_cmp_gt_u32 vcc, 9, v25
    s_cbranch_vccz CW_69
    ds_read_b32 v25, v1 offset:0
FW_70:
    s_waitcnt lgkmcnt(0)
    v_cmp_gt_u32 vcc, 9, v25
    s_cbranch_vccz FO_71
    s_sleep 2
    ds_read_b32 v25, v1 offset:0
    s_branch FW_70
FO_71:
CW_69:
    s_waitcnt vmcnt(8)
    s_add_u32 s47, s81, 14
    s_and_b32 s47, s47, 15
    s_lshl_b32 s47, s47, 17
    s_add_u32 m0, s79, 106496
    s_add_u32 s47, s47, s57
    buffer_load_dwordx4 v40, s[20:23], s47 offen lds
    s_add_u32 m0, m0, 1024
    s_add_u32 s47, s47, 16384
    buffer_load_dwordx4 v40, s[20:23], s47 offen lds
    s_add_u32 m0, m0, 1024
    s_add_u32 s47, s47, 16384
    buffer_load_dwordx4 v40, s[20:23], s47 offen lds
    s_add_u32 m0, m0, 1024
    s_add_u32 s47, s47, 16384
    buffer_load_dwordx4 v40, s[20:23], s47 offen lds
    v_cmp_gt_u32 vcc, 10, v25
    s_cbranch_vccz CW_72
    ds_read_b32 v25, v1 offset:0
FW_73:
    s_waitcnt lgkmcnt(0)
    v_cmp_gt_u32 vcc, 10, v25
    s_cbranch_vccz FO_74
    s_sleep 2
    ds_read_b32 v25, v1 offset:0
    s_branch FW_73
FO_74:
CW_72:
    s_waitcnt vmcnt(8)
    s_add_u32 s47, s81, 15
    s_and_b32 s47, s47, 15
    s_lshl_b32 s47, s47, 17
    s_add_u32 m0, s79, 122880
    s_add_u32 s47, s47, s57
    buffer_load_dwordx4 v40, s[20:23], s47 offen lds
    s_add_u32 m0, m0, 1024
    s_add_u32 s47, s47, 16384
    buffer_load_dwordx4 v40, s[20:23], s47 offen lds
    s_add_u32 m0, m0, 1024
    s_add_u32 s47, s47, 16384
    buffer_load_dwordx4 v40, s[20:23], s47 offen lds
    s_add_u32 m0, m0, 1024
    s_add_u32 s47, s47, 16384
    buffer_load_dwordx4 v40, s[20:23], s47 offen lds
F_wj:
    v_mov_b32 v5, 159096
    s_branch IW_s6
IW_w6:
    s_branch IW_r6
IW_s6:
    ds_read_b32 v6, v5 offset:0
FW_75:
    s_waitcnt lgkmcnt(0)
    v_cmp_gt_u32 vcc, 1, v6
    s_cbranch_vccz FO_76
    s_sleep 1
    ds_read_b32 v6, v5 offset:0
    s_branch FW_75
FO_76:
    v_and_b32 v5, 7, v0
    v_lshlrev_b32 v5, 2, v5
    v_add_u32 v5, 158976, v5
    ds_read_b32 v5, v5
    s_lshr_b32 s47, s64, 5
    s_sub_u32 s47, 63, s47
    s_mov_b64 s[60:61], 0
    s_waitcnt lgkmcnt(0)
    v_bfe_u32 v5, v5, 5, 6
    v_cmp_eq_u32 vcc, s47, v5
    s_cbranch_vccz F_ns

    v_mov_b32 v5, 158976
    ds_read_b128 v[44:47], v5
    ds_read_b128 v[48:51], v5 offset:16
    v_and_b32 v6, 15, v0
    v_add_u32 v6, s64, v6
    v_sub_u32 v6, 2047, v6
    v_subrev_u32 v7, 16, v6
    v_mov_b32 v164, 0
    v_mov_b32 v165, 0
    s_waitcnt lgkmcnt(0)
    v_and_b32 v5, 0x7ff, v44
    v_or_b32 v44, 0x4000, v44
    v_cmp_eq_u32 vcc, v5, v6
    v_cmp_eq_u32 s[62:63], v5, v7
    s_nop 0
    v_cndmask_b32 v164, v164, v44, vcc
    v_cndmask_b32 v165, v165, v44, s[62:63]
    v_and_b32 v5, 0x7ff, v45
    v_or_b32 v45, 0x4800, v45
    v_cmp_eq_u32 vcc, v5, v6
    v_cmp_eq_u32 s[62:63], v5, v7
    s_nop 0
    v_cndmask_b32 v164, v164, v45, vcc
    v_cndmask_b32 v165, v165, v45, s[62:63]
    v_and_b32 v5, 0x7ff, v46
    v_or_b32 v46, 0x5000, v46
    v_cmp_eq_u32 vcc, v5, v6
    v_cmp_eq_u32 s[62:63], v5, v7
    s_nop 0
    v_cndmask_b32 v164, v164, v46, vcc
    v_cndmask_b32 v165, v165, v46, s[62:63]
    v_and_b32 v5, 0x7ff, v47
    v_or_b32 v47, 0x5800, v47
    v_cmp_eq_u32 vcc, v5, v6
    v_cmp_eq_u32 s[62:63], v5, v7
    s_nop 0
    v_cndmask_b32 v164, v164, v47, vcc
    v_cndmask_b32 v165, v165, v47, s[62:63]
    v_and_b32 v5, 0x7ff, v48
    v_or_b32 v48, 0x6000, v48
    v_cmp_eq_u32 vcc, v5, v6
    v_cmp_eq_u32 s[62:63], v5, v7
    s_nop 0
    v_cndmask_b32 v164, v164, v48, vcc
    v_cndmask_b32 v165, v165, v48, s[62:63]
    v_and_b32 v5, 0x7ff, v49
    v_or_b32 v49, 0x6800, v49
    v_cmp_eq_u32 vcc, v5, v6
    v_cmp_eq_u32 s[62:63], v5, v7
    s_nop 0
    v_cndmask_b32 v164, v164, v49, vcc
    v_cndmask_b32 v165, v165, v49, s[62:63]
    v_and_b32 v5, 0x7ff, v50
    v_or_b32 v50, 0x7000, v50
    v_cmp_eq_u32 vcc, v5, v6
    v_cmp_eq_u32 s[62:63], v5, v7
    s_nop 0
    v_cndmask_b32 v164, v164, v50, vcc
    v_cndmask_b32 v165, v165, v50, s[62:63]
    v_and_b32 v5, 0x7ff, v51
    v_or_b32 v51, 0x7800, v51
    v_cmp_eq_u32 vcc, v5, v6
    v_cmp_eq_u32 s[62:63], v5, v7
    s_nop 0
    v_cndmask_b32 v164, v164, v51, vcc
    v_cndmask_b32 v165, v165, v51, s[62:63]
    s_mov_b64 s[60:61], 1
F_ns:
    s_lshl_b32 s51, s28, 2
    s_add_u32 s51, s51, s3
    s_lshl_b32 s51, s51, 3
    s_and_b32 s47, s29, 3
    s_add_u32 s51, s51, s47
    s_lshl_b32 s51, s51, 7

    s_add_u32 s54, s51, 0x835000
    s_add_u32 s54, s72, s54
    s_addc_u32 s55, s73, 0
    v_lshlrev_b32 v98, 4, v0
    v_lshrrev_b32 v16, 4, v0
    v_bfe_u32 v17, v0, 2, 2
    v_lshl_add_u32 v17, v16, 2, v17
    v_bfe_u32 v16, v17, 1, 2
    v_lshlrev_b32 v16, 5, v16
    v_lshl_add_u32 v16, v17, 7, v16
    v_and_b32 v17, 3, v0
    v_lshl_add_u32 v4, v17, 3, v16
    v_xor_b32 v5, 32, v4
    v_xor_b32 v6, 64, v4
    v_xor_b32 v7, 96, v4
    s_lshl_b32 s79, s28, 18
    s_lshl_b32 s80, s3, 16
    s_add_u32 s79, s79, s80
    s_lshl_b32 s81, s81, 11
    v_mov_b32 v99, 1

    v_add_u32 v8, 57344, v4
    v_add_u32 v9, 57344, v5
    v_add_u32 v10, 57344, v6
    v_add_u32 v11, 57344, v7
    v_add_u32 v12, 114688, v4
    v_add_u32 v13, 114688, v5
    v_add_u32 v14, 114688, v6
    v_add_u32 v15, 114688, v7
    s_add_u32 s16, s72, 0x400000
    s_addc_u32 s17, s73, 0
    s_mov_b32 s18, 0x400000
    s_mov_b32 s19, 0x00020000
    s_mov_b32 s12, s68
    s_mov_b32 s13, s69
    s_mov_b32 s14, 0x400000
    s_mov_b32 s15, 0x00020000
    s_add_u32 s80, s81, 0
    s_and_b32 s80, s80, 0x7fff
    s_add_u32 s4, s80, s79
    s_add_u32 s80, s81, 2048
    s_and_b32 s80, s80, 0x7fff
    s_add_u32 s5, s80, s79
    s_add_u32 s80, s81, 4096
    s_and_b32 s80, s80, 0x7fff
    s_add_u32 s6, s80, s79
    s_add_u32 s80, s81, 6144
    s_and_b32 s80, s80, 0x7fff
    s_add_u32 s7, s80, s79
    s_add_u32 s80, s81, 8192
    s_and_b32 s80, s80, 0x7fff
    s_add_u32 s8, s80, s79
    s_add_u32 s80, s81, 10240
    s_and_b32 s80, s80, 0x7fff
    s_add_u32 s9, s80, s79
    s_add_u32 s80, s81, 12288
    s_and_b32 s80, s80, 0x7fff
    s_add_u32 s10, s80, s79
    s_add_u32 s80, s81, 14336
    s_and_b32 s80, s80, 0x7fff
    s_add_u32 s11, s80, s79
    s_add_u32 s80, s81, 16384
    s_and_b32 s80, s80, 0x7fff
    s_add_u32 s30, s80, s79
    s_add_u32 s80, s81, 18432
    s_and_b32 s80, s80, 0x7fff
    s_add_u32 s31, s80, s79
    s_add_u32 s80, s81, 20480
    s_and_b32 s80, s80, 0x7fff
    s_add_u32 s32, s80, s79
    s_add_u32 s80, s81, 22528
    s_and_b32 s80, s80, 0x7fff
    s_add_u32 s33, s80, s79
    s_add_u32 s80, s81, 24576
    s_and_b32 s80, s80, 0x7fff
    s_add_u32 s34, s80, s79
    s_add_u32 s80, s81, 26624
    s_and_b32 s80, s80, 0x7fff
    s_add_u32 s35, s80, s79
    s_add_u32 s80, s81, 28672
    s_and_b32 s80, s80, 0x7fff
    s_add_u32 s36, s80, s79
    s_add_u32 s80, s81, 30720
    s_and_b32 s80, s80, 0x7fff
    s_add_u32 s37, s80, s79
    v_add_u32 v97, 0x8000, v98
    s_setprio 2
    s_mov_b32 s50, 0
F_op:
    s_load_dword s47, s[54:55], 0 glc
    s_getreg_b32 s51, hwreg(HW_REG_IB_STS)
    s_and_b32 s51, s51, 0xc0000f
    s_or_b32 s51, s51, s50
    s_cbranch_scc1 F_oq
    s_mov_b64 exec, 1
    ds_write_b32 v3, v99 offset:160
    s_mov_b64 exec, -1
    s_mov_b32 s50, 1
F_oq:
    s_waitcnt lgkmcnt(0)
    s_cmp_lt_u32 s47, 16
    s_cbranch_scc1 F_op
    buffer_load_dwordx4 v[48:51], v98, s[16:19], s4 offen offset:0 sc1
    buffer_load_dwordx4 v[52:55], v97, s[16:19], s4 offen offset:0 sc1
    buffer_load_dwordx4 v[56:59], v98, s[16:19], s4 offen offset:1024 sc1
    buffer_load_dwordx4 v[60:63], v97, s[16:19], s4 offen offset:1024 sc1
    buffer_load_dwordx4 v[64:67], v98, s[16:19], s5 offen offset:0 sc1
    buffer_load_dwordx4 v[68:71], v97, s[16:19], s5 offen offset:0 sc1
    buffer_load_dwordx4 v[72:75], v98, s[16:19], s5 offen offset:1024 sc1
    buffer_load_dwordx4 v[76:79], v97, s[16:19], s5 offen offset:1024 sc1
    buffer_load_dwordx4 v[80:83], v98, s[16:19], s6 offen offset:0 sc1
    buffer_load_dwordx4 v[84:87], v97, s[16:19], s6 offen offset:0 sc1
    buffer_load_dwordx4 v[88:91], v98, s[16:19], s6 offen offset:1024 sc1
    buffer_load_dwordx4 v[92:95], v97, s[16:19], s6 offen offset:1024 sc1
    s_cmp_lg_u32 s50, 0
    s_cbranch_scc1 F_or
    s_waitcnt vmcnt(12)
    s_mov_b64 exec, 1
    ds_write_b32 v3, v99 offset:160
    s_mov_b64 exec, -1
F_or:
    v_or_b32 v17, 8, v1
    ds_read_b32 v16, v17 offset:160
FW_77:
    s_waitcnt lgkmcnt(0)
    v_cmp_gt_u32 vcc, 1, v16
    s_cbranch_vccz FO_78
    ds_read_b32 v16, v17 offset:160
    s_branch FW_77
FO_78:
    v_and_b32 v1, 0x3fff, v2
    v_bfe_u32 v99, v0, 3, 1
    v_lshl_add_u32 v1, v99, 6, v1
    ds_read_b64_tr_b16 v[16:17], v12 offset:32768
    ds_read_b64_tr_b16 v[18:19], v12 offset:34816
    ds_read_b64_tr_b16 v[20:21], v13 offset:32768
    ds_read_b64_tr_b16 v[22:23], v13 offset:34816
    ds_read_b64_tr_b16 v[24:25], v14 offset:32768
    ds_read_b64_tr_b16 v[26:27], v14 offset:34816
    ds_read_b64_tr_b16 v[28:29], v15 offset:32768
    ds_read_b64_tr_b16 v[30:31], v15 offset:34816
    s_waitcnt vmcnt(10) lgkmcnt(0)
    v_mfma_f32_16x16x32_bf16 v[100:103], v[16:19], v[48:51], v[100:103]
    ds_read_b64_tr_b16 v[32:33], v12 offset:36864
    ds_read_b64_tr_b16 v[34:35], v12 offset:38912
    v_mfma_f32_16x16x32_bf16 v[116:119], v[16:19], v[52:55], v[116:119]
    ds_read_b64_tr_b16 v[36:37], v13 offset:36864
    ds_read_b64_tr_b16 v[38:39], v13 offset:38912
    v_mfma_f32_16x16x32_bf16 v[104:107], v[20:23], v[48:51], v[104:107]
    ds_read_b64_tr_b16 v[40:41], v14 offset:36864
    ds_read_b64_tr_b16 v[42:43], v14 offset:38912
    v_mfma_f32_16x16x32_bf16 v[120:123], v[20:23], v[52:55], v[120:123]
    ds_read_b64_tr_b16 v[44:45], v15 offset:36864
    ds_read_b64_tr_b16 v[46:47], v15 offset:38912
    v_mfma_f32_16x16x32_bf16 v[108:111], v[24:27], v[48:51], v[108:111]
    buffer_load_dwordx4 v[132:135], v98, s[16:19], s7 offen offset:0 sc1
    v_mfma_f32_16x16x32_bf16 v[124:127], v[24:27], v[52:55], v[124:127]
    v_mfma_f32_16x16x32_bf16 v[112:115], v[28:31], v[48:51], v[112:115]
    buffer_load_dwordx4 v[136:139], v97, s[16:19], s7 offen offset:0 sc1
    v_mfma_f32_16x16x32_bf16 v[128:131], v[28:31], v[52:55], v[128:131]
    s_waitcnt vmcnt(10) lgkmcnt(0)
    v_mfma_f32_16x16x32_bf16 v[100:103], v[32:35], v[56:59], v[100:103]
    ds_read_b64_tr_b16 v[16:17], v4 offset:0
    ds_read_b64_tr_b16 v[18:19], v4 offset:2048
    v_mfma_f32_16x16x32_bf16 v[116:119], v[32:35], v[60:63], v[116:119]
    ds_read_b64_tr_b16 v[20:21], v5 offset:0
    ds_read_b64_tr_b16 v[22:23], v5 offset:2048
    v_mfma_f32_16x16x32_bf16 v[104:107], v[36:39], v[56:59], v[104:107]
    ds_read_b64_tr_b16 v[24:25], v6 offset:0
    ds_read_b64_tr_b16 v[26:27], v6 offset:2048
    v_mfma_f32_16x16x32_bf16 v[120:123], v[36:39], v[60:63], v[120:123]
    ds_read_b64_tr_b16 v[28:29], v7 offset:0
    ds_read_b64_tr_b16 v[30:31], v7 offset:2048
    v_mfma_f32_16x16x32_bf16 v[108:111], v[40:43], v[56:59], v[108:111]
    buffer_load_dwordx4 v[48:51], v98, s[16:19], s7 offen offset:1024 sc1
    v_mfma_f32_16x16x32_bf16 v[124:127], v[40:43], v[60:63], v[124:127]
    v_mfma_f32_16x16x32_bf16 v[112:115], v[44:47], v[56:59], v[112:115]
    buffer_load_dwordx4 v[52:55], v97, s[16:19], s7 offen offset:1024 sc1
    v_mfma_f32_16x16x32_bf16 v[128:131], v[44:47], v[60:63], v[128:131]
    s_waitcnt vmcnt(10) lgkmcnt(0)
    v_mfma_f32_16x16x32_bf16 v[100:103], v[16:19], v[64:67], v[100:103]
    ds_read_b64_tr_b16 v[32:33], v4 offset:4096
    ds_read_b64_tr_b16 v[34:35], v4 offset:6144
    v_mfma_f32_16x16x32_bf16 v[116:119], v[16:19], v[68:71], v[116:119]
    ds_read_b64_tr_b16 v[36:37], v5 offset:4096
    ds_read_b64_tr_b16 v[38:39], v5 offset:6144
    v_mfma_f32_16x16x32_bf16 v[104:107], v[20:23], v[64:67], v[104:107]
    ds_read_b64_tr_b16 v[40:41], v6 offset:4096
    ds_read_b64_tr_b16 v[42:43], v6 offset:6144
    v_mfma_f32_16x16x32_bf16 v[120:123], v[20:23], v[68:71], v[120:123]
    ds_read_b64_tr_b16 v[44:45], v7 offset:4096
    ds_read_b64_tr_b16 v[46:47], v7 offset:6144
    v_mfma_f32_16x16x32_bf16 v[108:111], v[24:27], v[64:67], v[108:111]
    buffer_load_dwordx4 v[56:59], v98, s[16:19], s8 offen offset:0 sc1
    v_mfma_f32_16x16x32_bf16 v[124:127], v[24:27], v[68:71], v[124:127]
    v_mfma_f32_16x16x32_bf16 v[112:115], v[28:31], v[64:67], v[112:115]
    buffer_load_dwordx4 v[60:63], v97, s[16:19], s8 offen offset:0 sc1
    v_mfma_f32_16x16x32_bf16 v[128:131], v[28:31], v[68:71], v[128:131]
    s_waitcnt vmcnt(10) lgkmcnt(0)
    v_mfma_f32_16x16x32_bf16 v[100:103], v[32:35], v[72:75], v[100:103]
    ds_read_b64_tr_b16 v[16:17], v4 offset:8192
    ds_read_b64_tr_b16 v[18:19], v4 offset:10240
    v_mfma_f32_16x16x32_bf16 v[116:119], v[32:35], v[76:79], v[116:119]
    ds_read_b64_tr_b16 v[20:21], v5 offset:8192
    ds_read_b64_tr_b16 v[22:23], v5 offset:10240
    v_mfma_f32_16x16x32_bf16 v[104:107], v[36:39], v[72:75], v[104:107]
    ds_read_b64_tr_b16 v[24:25], v6 offset:8192
    ds_read_b64_tr_b16 v[26:27], v6 offset:10240
    v_mfma_f32_16x16x32_bf16 v[120:123], v[36:39], v[76:79], v[120:123]
    ds_read_b64_tr_b16 v[28:29], v7 offset:8192
    ds_read_b64_tr_b16 v[30:31], v7 offset:10240
    v_mfma_f32_16x16x32_bf16 v[108:111], v[40:43], v[72:75], v[108:111]
    buffer_load_dwordx4 v[64:67], v98, s[16:19], s8 offen offset:1024 sc1
    v_mfma_f32_16x16x32_bf16 v[124:127], v[40:43], v[76:79], v[124:127]
    v_mfma_f32_16x16x32_bf16 v[112:115], v[44:47], v[72:75], v[112:115]
    buffer_load_dwordx4 v[68:71], v97, s[16:19], s8 offen offset:1024 sc1
    v_mfma_f32_16x16x32_bf16 v[128:131], v[44:47], v[76:79], v[128:131]
    s_waitcnt vmcnt(10) lgkmcnt(0)
    v_mfma_f32_16x16x32_bf16 v[100:103], v[16:19], v[80:83], v[100:103]
    ds_read_b64_tr_b16 v[32:33], v4 offset:12288
    ds_read_b64_tr_b16 v[34:35], v4 offset:14336
    v_mfma_f32_16x16x32_bf16 v[116:119], v[16:19], v[84:87], v[116:119]
    ds_read_b64_tr_b16 v[36:37], v5 offset:12288
    ds_read_b64_tr_b16 v[38:39], v5 offset:14336
    v_mfma_f32_16x16x32_bf16 v[104:107], v[20:23], v[80:83], v[104:107]
    ds_read_b64_tr_b16 v[40:41], v6 offset:12288
    ds_read_b64_tr_b16 v[42:43], v6 offset:14336
    v_mfma_f32_16x16x32_bf16 v[120:123], v[20:23], v[84:87], v[120:123]
    ds_read_b64_tr_b16 v[44:45], v7 offset:12288
    ds_read_b64_tr_b16 v[46:47], v7 offset:14336
    v_mfma_f32_16x16x32_bf16 v[108:111], v[24:27], v[80:83], v[108:111]
    buffer_load_dwordx4 v[72:75], v98, s[16:19], s9 offen offset:0 sc1
    v_mfma_f32_16x16x32_bf16 v[124:127], v[24:27], v[84:87], v[124:127]
    v_mfma_f32_16x16x32_bf16 v[112:115], v[28:31], v[80:83], v[112:115]
    buffer_load_dwordx4 v[76:79], v97, s[16:19], s9 offen offset:0 sc1
    v_mfma_f32_16x16x32_bf16 v[128:131], v[28:31], v[84:87], v[128:131]
    s_waitcnt vmcnt(10) lgkmcnt(0)
    v_mfma_f32_16x16x32_bf16 v[100:103], v[32:35], v[88:91], v[100:103]
    ds_read_b64_tr_b16 v[16:17], v12 offset:24576
    ds_read_b64_tr_b16 v[18:19], v12 offset:26624
    v_mfma_f32_16x16x32_bf16 v[116:119], v[32:35], v[92:95], v[116:119]
    ds_read_b64_tr_b16 v[20:21], v13 offset:24576
    ds_read_b64_tr_b16 v[22:23], v13 offset:26624
    v_mfma_f32_16x16x32_bf16 v[104:107], v[36:39], v[88:91], v[104:107]
    ds_read_b64_tr_b16 v[24:25], v14 offset:24576
    ds_read_b64_tr_b16 v[26:27], v14 offset:26624
    v_mfma_f32_16x16x32_bf16 v[120:123], v[36:39], v[92:95], v[120:123]
    ds_read_b64_tr_b16 v[28:29], v15 offset:24576
    ds_read_b64_tr_b16 v[30:31], v15 offset:26624
    v_mfma_f32_16x16x32_bf16 v[108:111], v[40:43], v[88:91], v[108:111]
    buffer_load_dwordx4 v[80:83], v98, s[16:19], s9 offen offset:1024 sc1
    v_mfma_f32_16x16x32_bf16 v[124:127], v[40:43], v[92:95], v[124:127]
    v_mfma_f32_16x16x32_bf16 v[112:115], v[44:47], v[88:91], v[112:115]
    buffer_load_dwordx4 v[84:87], v97, s[16:19], s9 offen offset:1024 sc1
    v_mfma_f32_16x16x32_bf16 v[128:131], v[44:47], v[92:95], v[128:131]
    s_waitcnt vmcnt(10) lgkmcnt(0)
    v_mfma_f32_16x16x32_bf16 v[100:103], v[16:19], v[132:135], v[100:103]
    ds_read_b64_tr_b16 v[32:33], v12 offset:28672
    ds_read_b64_tr_b16 v[34:35], v12 offset:30720
    v_mfma_f32_16x16x32_bf16 v[116:119], v[16:19], v[136:139], v[116:119]
    ds_read_b64_tr_b16 v[36:37], v13 offset:28672
    ds_read_b64_tr_b16 v[38:39], v13 offset:30720
    v_mfma_f32_16x16x32_bf16 v[104:107], v[20:23], v[132:135], v[104:107]
    ds_read_b64_tr_b16 v[40:41], v14 offset:28672
    ds_read_b64_tr_b16 v[42:43], v14 offset:30720
    v_mfma_f32_16x16x32_bf16 v[120:123], v[20:23], v[136:139], v[120:123]
    ds_read_b64_tr_b16 v[44:45], v15 offset:28672
    ds_read_b64_tr_b16 v[46:47], v15 offset:30720
    v_mfma_f32_16x16x32_bf16 v[108:111], v[24:27], v[132:135], v[108:111]
    buffer_load_dwordx4 v[88:91], v98, s[16:19], s10 offen offset:0 sc1
    v_mfma_f32_16x16x32_bf16 v[124:127], v[24:27], v[136:139], v[124:127]
    v_mfma_f32_16x16x32_bf16 v[112:115], v[28:31], v[132:135], v[112:115]
    buffer_load_dwordx4 v[92:95], v97, s[16:19], s10 offen offset:0 sc1
    v_mfma_f32_16x16x32_bf16 v[128:131], v[28:31], v[136:139], v[128:131]
    s_waitcnt vmcnt(10) lgkmcnt(0)
    v_mfma_f32_16x16x32_bf16 v[100:103], v[32:35], v[48:51], v[100:103]
    ds_read_b64_tr_b16 v[16:17], v4 offset:16384
    ds_read_b64_tr_b16 v[18:19], v4 offset:18432
    v_mfma_f32_16x16x32_bf16 v[116:119], v[32:35], v[52:55], v[116:119]
    ds_read_b64_tr_b16 v[20:21], v5 offset:16384
    ds_read_b64_tr_b16 v[22:23], v5 offset:18432
    v_mfma_f32_16x16x32_bf16 v[104:107], v[36:39], v[48:51], v[104:107]
    ds_read_b64_tr_b16 v[24:25], v6 offset:16384
    ds_read_b64_tr_b16 v[26:27], v6 offset:18432
    v_mfma_f32_16x16x32_bf16 v[120:123], v[36:39], v[52:55], v[120:123]
    ds_read_b64_tr_b16 v[28:29], v7 offset:16384
    ds_read_b64_tr_b16 v[30:31], v7 offset:18432
    v_mfma_f32_16x16x32_bf16 v[108:111], v[40:43], v[48:51], v[108:111]
    buffer_load_dwordx4 v[132:135], v98, s[16:19], s10 offen offset:1024 sc1
    v_mfma_f32_16x16x32_bf16 v[124:127], v[40:43], v[52:55], v[124:127]
    v_mfma_f32_16x16x32_bf16 v[112:115], v[44:47], v[48:51], v[112:115]
    buffer_load_dwordx4 v[136:139], v97, s[16:19], s10 offen offset:1024 sc1
    v_mfma_f32_16x16x32_bf16 v[128:131], v[44:47], v[52:55], v[128:131]
    s_waitcnt vmcnt(10) lgkmcnt(0)
    v_mfma_f32_16x16x32_bf16 v[100:103], v[16:19], v[56:59], v[100:103]
    ds_read_b64_tr_b16 v[32:33], v4 offset:20480
    ds_read_b64_tr_b16 v[34:35], v4 offset:22528
    v_mfma_f32_16x16x32_bf16 v[116:119], v[16:19], v[60:63], v[116:119]
    ds_read_b64_tr_b16 v[36:37], v5 offset:20480
    ds_read_b64_tr_b16 v[38:39], v5 offset:22528
    v_mfma_f32_16x16x32_bf16 v[104:107], v[20:23], v[56:59], v[104:107]
    ds_read_b64_tr_b16 v[40:41], v6 offset:20480
    ds_read_b64_tr_b16 v[42:43], v6 offset:22528
    v_mfma_f32_16x16x32_bf16 v[120:123], v[20:23], v[60:63], v[120:123]
    ds_read_b64_tr_b16 v[44:45], v7 offset:20480
    ds_read_b64_tr_b16 v[46:47], v7 offset:22528
    v_mfma_f32_16x16x32_bf16 v[108:111], v[24:27], v[56:59], v[108:111]
    buffer_load_dwordx4 v[48:51], v98, s[16:19], s11 offen offset:0 sc1
    v_mfma_f32_16x16x32_bf16 v[124:127], v[24:27], v[60:63], v[124:127]
    v_mfma_f32_16x16x32_bf16 v[112:115], v[28:31], v[56:59], v[112:115]
    buffer_load_dwordx4 v[52:55], v97, s[16:19], s11 offen offset:0 sc1
    v_mfma_f32_16x16x32_bf16 v[128:131], v[28:31], v[60:63], v[128:131]
    s_waitcnt vmcnt(10) lgkmcnt(0)
    v_mfma_f32_16x16x32_bf16 v[100:103], v[32:35], v[64:67], v[100:103]
    ds_read_b64_tr_b16 v[16:17], v4 offset:24576
    ds_read_b64_tr_b16 v[18:19], v4 offset:26624
    v_mfma_f32_16x16x32_bf16 v[116:119], v[32:35], v[68:71], v[116:119]
    ds_read_b64_tr_b16 v[20:21], v5 offset:24576
    ds_read_b64_tr_b16 v[22:23], v5 offset:26624
    v_mfma_f32_16x16x32_bf16 v[104:107], v[36:39], v[64:67], v[104:107]
    ds_read_b64_tr_b16 v[24:25], v6 offset:24576
    ds_read_b64_tr_b16 v[26:27], v6 offset:26624
    v_mfma_f32_16x16x32_bf16 v[120:123], v[36:39], v[68:71], v[120:123]
    ds_read_b64_tr_b16 v[28:29], v7 offset:24576
    ds_read_b64_tr_b16 v[30:31], v7 offset:26624
    v_mfma_f32_16x16x32_bf16 v[108:111], v[40:43], v[64:67], v[108:111]
    buffer_load_dwordx4 v[56:59], v98, s[16:19], s11 offen offset:1024 sc1
    v_mfma_f32_16x16x32_bf16 v[124:127], v[40:43], v[68:71], v[124:127]
    v_mfma_f32_16x16x32_bf16 v[112:115], v[44:47], v[64:67], v[112:115]
    buffer_load_dwordx4 v[60:63], v97, s[16:19], s11 offen offset:1024 sc1
    v_mfma_f32_16x16x32_bf16 v[128:131], v[44:47], v[68:71], v[128:131]
    s_waitcnt vmcnt(10) lgkmcnt(0)
    v_mfma_f32_16x16x32_bf16 v[100:103], v[16:19], v[72:75], v[100:103]
    ds_read_b64_tr_b16 v[32:33], v4 offset:28672
    ds_read_b64_tr_b16 v[34:35], v4 offset:30720
    v_mfma_f32_16x16x32_bf16 v[116:119], v[16:19], v[76:79], v[116:119]
    ds_read_b64_tr_b16 v[36:37], v5 offset:28672
    ds_read_b64_tr_b16 v[38:39], v5 offset:30720
    v_mfma_f32_16x16x32_bf16 v[104:107], v[20:23], v[72:75], v[104:107]
    ds_read_b64_tr_b16 v[40:41], v6 offset:28672
    ds_read_b64_tr_b16 v[42:43], v6 offset:30720
    v_mfma_f32_16x16x32_bf16 v[120:123], v[20:23], v[76:79], v[120:123]
    ds_read_b64_tr_b16 v[44:45], v7 offset:28672
    ds_read_b64_tr_b16 v[46:47], v7 offset:30720
    v_mfma_f32_16x16x32_bf16 v[108:111], v[24:27], v[72:75], v[108:111]
    buffer_load_dwordx4 v[64:67], v98, s[16:19], s30 offen offset:0 sc1
    v_mfma_f32_16x16x32_bf16 v[124:127], v[24:27], v[76:79], v[124:127]
    v_mfma_f32_16x16x32_bf16 v[112:115], v[28:31], v[72:75], v[112:115]
    buffer_load_dwordx4 v[68:71], v97, s[16:19], s30 offen offset:0 sc1
    v_mfma_f32_16x16x32_bf16 v[128:131], v[28:31], v[76:79], v[128:131]
    s_waitcnt vmcnt(10) lgkmcnt(0)
    v_mfma_f32_16x16x32_bf16 v[100:103], v[32:35], v[80:83], v[100:103]
    ds_read_b64_tr_b16 v[16:17], v12 offset:16384
    ds_read_b64_tr_b16 v[18:19], v12 offset:18432
    v_mfma_f32_16x16x32_bf16 v[116:119], v[32:35], v[84:87], v[116:119]
    ds_read_b64_tr_b16 v[20:21], v13 offset:16384
    ds_read_b64_tr_b16 v[22:23], v13 offset:18432
    v_mfma_f32_16x16x32_bf16 v[104:107], v[36:39], v[80:83], v[104:107]
    ds_read_b64_tr_b16 v[24:25], v14 offset:16384
    ds_read_b64_tr_b16 v[26:27], v14 offset:18432
    v_mfma_f32_16x16x32_bf16 v[120:123], v[36:39], v[84:87], v[120:123]
    ds_read_b64_tr_b16 v[28:29], v15 offset:16384
    ds_read_b64_tr_b16 v[30:31], v15 offset:18432
    v_mfma_f32_16x16x32_bf16 v[108:111], v[40:43], v[80:83], v[108:111]
    buffer_load_dwordx4 v[72:75], v98, s[16:19], s30 offen offset:1024 sc1
    v_mfma_f32_16x16x32_bf16 v[124:127], v[40:43], v[84:87], v[124:127]
    v_mfma_f32_16x16x32_bf16 v[112:115], v[44:47], v[80:83], v[112:115]
    buffer_load_dwordx4 v[76:79], v97, s[16:19], s30 offen offset:1024 sc1
    v_mfma_f32_16x16x32_bf16 v[128:131], v[44:47], v[84:87], v[128:131]
    s_waitcnt vmcnt(10) lgkmcnt(0)
    v_mfma_f32_16x16x32_bf16 v[100:103], v[16:19], v[88:91], v[100:103]
    ds_read_b64_tr_b16 v[32:33], v12 offset:20480
    ds_read_b64_tr_b16 v[34:35], v12 offset:22528
    v_mfma_f32_16x16x32_bf16 v[116:119], v[16:19], v[92:95], v[116:119]
    ds_read_b64_tr_b16 v[36:37], v13 offset:20480
    ds_read_b64_tr_b16 v[38:39], v13 offset:22528
    v_mfma_f32_16x16x32_bf16 v[104:107], v[20:23], v[88:91], v[104:107]
    ds_read_b64_tr_b16 v[40:41], v14 offset:20480
    ds_read_b64_tr_b16 v[42:43], v14 offset:22528
    v_mfma_f32_16x16x32_bf16 v[120:123], v[20:23], v[92:95], v[120:123]
    ds_read_b64_tr_b16 v[44:45], v15 offset:20480
    ds_read_b64_tr_b16 v[46:47], v15 offset:22528
    v_mfma_f32_16x16x32_bf16 v[108:111], v[24:27], v[88:91], v[108:111]
    buffer_load_dwordx4 v[80:83], v98, s[16:19], s31 offen offset:0 sc1
    v_mfma_f32_16x16x32_bf16 v[124:127], v[24:27], v[92:95], v[124:127]
    v_mfma_f32_16x16x32_bf16 v[112:115], v[28:31], v[88:91], v[112:115]
    buffer_load_dwordx4 v[84:87], v97, s[16:19], s31 offen offset:0 sc1
    v_mfma_f32_16x16x32_bf16 v[128:131], v[28:31], v[92:95], v[128:131]
    s_waitcnt vmcnt(10) lgkmcnt(0)
    v_mfma_f32_16x16x32_bf16 v[100:103], v[32:35], v[132:135], v[100:103]
    ds_read_b64_tr_b16 v[16:17], v8 offset:24576
    ds_read_b64_tr_b16 v[18:19], v8 offset:26624
    v_mfma_f32_16x16x32_bf16 v[116:119], v[32:35], v[136:139], v[116:119]
    ds_read_b64_tr_b16 v[20:21], v9 offset:24576
    ds_read_b64_tr_b16 v[22:23], v9 offset:26624
    v_mfma_f32_16x16x32_bf16 v[104:107], v[36:39], v[132:135], v[104:107]
    ds_read_b64_tr_b16 v[24:25], v10 offset:24576
    ds_read_b64_tr_b16 v[26:27], v10 offset:26624
    v_mfma_f32_16x16x32_bf16 v[120:123], v[36:39], v[136:139], v[120:123]
    ds_read_b64_tr_b16 v[28:29], v11 offset:24576
    ds_read_b64_tr_b16 v[30:31], v11 offset:26624
    v_mfma_f32_16x16x32_bf16 v[108:111], v[40:43], v[132:135], v[108:111]
    buffer_load_dwordx4 v[88:91], v98, s[16:19], s31 offen offset:1024 sc1
    v_mfma_f32_16x16x32_bf16 v[124:127], v[40:43], v[136:139], v[124:127]
    v_mfma_f32_16x16x32_bf16 v[112:115], v[44:47], v[132:135], v[112:115]
    buffer_load_dwordx4 v[92:95], v97, s[16:19], s31 offen offset:1024 sc1
    v_mfma_f32_16x16x32_bf16 v[128:131], v[44:47], v[136:139], v[128:131]
    s_waitcnt vmcnt(10) lgkmcnt(0)
    v_mfma_f32_16x16x32_bf16 v[100:103], v[16:19], v[48:51], v[100:103]
    ds_read_b64_tr_b16 v[32:33], v8 offset:28672
    ds_read_b64_tr_b16 v[34:35], v8 offset:30720
    v_mfma_f32_16x16x32_bf16 v[116:119], v[16:19], v[52:55], v[116:119]
    ds_read_b64_tr_b16 v[36:37], v9 offset:28672
    ds_read_b64_tr_b16 v[38:39], v9 offset:30720
    v_mfma_f32_16x16x32_bf16 v[104:107], v[20:23], v[48:51], v[104:107]
    ds_read_b64_tr_b16 v[40:41], v10 offset:28672
    ds_read_b64_tr_b16 v[42:43], v10 offset:30720
    v_mfma_f32_16x16x32_bf16 v[120:123], v[20:23], v[52:55], v[120:123]
    ds_read_b64_tr_b16 v[44:45], v11 offset:28672
    ds_read_b64_tr_b16 v[46:47], v11 offset:30720
    v_mfma_f32_16x16x32_bf16 v[108:111], v[24:27], v[48:51], v[108:111]
    buffer_load_dwordx4 v[132:135], v98, s[16:19], s32 offen offset:0 sc1
    v_mfma_f32_16x16x32_bf16 v[124:127], v[24:27], v[52:55], v[124:127]
    v_mfma_f32_16x16x32_bf16 v[112:115], v[28:31], v[48:51], v[112:115]
    buffer_load_dwordx4 v[136:139], v97, s[16:19], s32 offen offset:0 sc1
    v_mfma_f32_16x16x32_bf16 v[128:131], v[28:31], v[52:55], v[128:131]
    s_waitcnt vmcnt(10) lgkmcnt(0)
    v_mfma_f32_16x16x32_bf16 v[100:103], v[32:35], v[56:59], v[100:103]
    ds_read_b64_tr_b16 v[16:17], v4 offset:49152
    ds_read_b64_tr_b16 v[18:19], v4 offset:51200
    v_mfma_f32_16x16x32_bf16 v[116:119], v[32:35], v[60:63], v[116:119]
    ds_read_b64_tr_b16 v[20:21], v5 offset:49152
    ds_read_b64_tr_b16 v[22:23], v5 offset:51200
    v_mfma_f32_16x16x32_bf16 v[104:107], v[36:39], v[56:59], v[104:107]
    ds_read_b64_tr_b16 v[24:25], v6 offset:49152
    ds_read_b64_tr_b16 v[26:27], v6 offset:51200
    v_mfma_f32_16x16x32_bf16 v[120:123], v[36:39], v[60:63], v[120:123]
    ds_read_b64_tr_b16 v[28:29], v7 offset:49152
    ds_read_b64_tr_b16 v[30:31], v7 offset:51200
    v_mfma_f32_16x16x32_bf16 v[108:111], v[40:43], v[56:59], v[108:111]
    buffer_load_dwordx4 v[48:51], v98, s[16:19], s32 offen offset:1024 sc1
    v_mfma_f32_16x16x32_bf16 v[124:127], v[40:43], v[60:63], v[124:127]
    v_mfma_f32_16x16x32_bf16 v[112:115], v[44:47], v[56:59], v[112:115]
    buffer_load_dwordx4 v[52:55], v97, s[16:19], s32 offen offset:1024 sc1
    v_mfma_f32_16x16x32_bf16 v[128:131], v[44:47], v[60:63], v[128:131]
    s_waitcnt vmcnt(10) lgkmcnt(0)
    v_mfma_f32_16x16x32_bf16 v[100:103], v[16:19], v[64:67], v[100:103]
    ds_read_b64_tr_b16 v[32:33], v4 offset:53248
    ds_read_b64_tr_b16 v[34:35], v4 offset:55296
    v_mfma_f32_16x16x32_bf16 v[116:119], v[16:19], v[68:71], v[116:119]
    ds_read_b64_tr_b16 v[36:37], v5 offset:53248
    ds_read_b64_tr_b16 v[38:39], v5 offset:55296
    v_mfma_f32_16x16x32_bf16 v[104:107], v[20:23], v[64:67], v[104:107]
    ds_read_b64_tr_b16 v[40:41], v6 offset:53248
    ds_read_b64_tr_b16 v[42:43], v6 offset:55296
    v_mfma_f32_16x16x32_bf16 v[120:123], v[20:23], v[68:71], v[120:123]
    ds_read_b64_tr_b16 v[44:45], v7 offset:53248
    ds_read_b64_tr_b16 v[46:47], v7 offset:55296
    v_mfma_f32_16x16x32_bf16 v[108:111], v[24:27], v[64:67], v[108:111]
    buffer_load_dwordx4 v[56:59], v98, s[16:19], s33 offen offset:0 sc1
    v_mfma_f32_16x16x32_bf16 v[124:127], v[24:27], v[68:71], v[124:127]
    v_mfma_f32_16x16x32_bf16 v[112:115], v[28:31], v[64:67], v[112:115]
    buffer_load_dwordx4 v[60:63], v97, s[16:19], s33 offen offset:0 sc1
    v_mfma_f32_16x16x32_bf16 v[128:131], v[28:31], v[68:71], v[128:131]
    s_waitcnt vmcnt(10) lgkmcnt(0)
    v_mfma_f32_16x16x32_bf16 v[100:103], v[32:35], v[72:75], v[100:103]
    ds_read_b64_tr_b16 v[16:17], v8 offset:0
    ds_read_b64_tr_b16 v[18:19], v8 offset:2048
    v_mfma_f32_16x16x32_bf16 v[116:119], v[32:35], v[76:79], v[116:119]
    ds_read_b64_tr_b16 v[20:21], v9 offset:0
    ds_read_b64_tr_b16 v[22:23], v9 offset:2048
    v_mfma_f32_16x16x32_bf16 v[104:107], v[36:39], v[72:75], v[104:107]
    ds_read_b64_tr_b16 v[24:25], v10 offset:0
    ds_read_b64_tr_b16 v[26:27], v10 offset:2048
    v_mfma_f32_16x16x32_bf16 v[120:123], v[36:39], v[76:79], v[120:123]
    ds_read_b64_tr_b16 v[28:29], v11 offset:0
    ds_read_b64_tr_b16 v[30:31], v11 offset:2048
    v_mfma_f32_16x16x32_bf16 v[108:111], v[40:43], v[72:75], v[108:111]
    buffer_load_dwordx4 v[64:67], v98, s[16:19], s33 offen offset:1024 sc1
    v_mfma_f32_16x16x32_bf16 v[124:127], v[40:43], v[76:79], v[124:127]
    v_mfma_f32_16x16x32_bf16 v[112:115], v[44:47], v[72:75], v[112:115]
    buffer_load_dwordx4 v[68:71], v97, s[16:19], s33 offen offset:1024 sc1
    v_mfma_f32_16x16x32_bf16 v[128:131], v[44:47], v[76:79], v[128:131]
    s_waitcnt vmcnt(10) lgkmcnt(0)
    v_mfma_f32_16x16x32_bf16 v[100:103], v[16:19], v[80:83], v[100:103]
    ds_read_b64_tr_b16 v[32:33], v8 offset:4096
    ds_read_b64_tr_b16 v[34:35], v8 offset:6144
    s_branch IW_s7
IW_w7:
    s_branch IW_r7
IW_s7:
    v_mfma_f32_16x16x32_bf16 v[116:119], v[16:19], v[84:87], v[116:119]
    ds_read_b64_tr_b16 v[36:37], v9 offset:4096
    ds_read_b64_tr_b16 v[38:39], v9 offset:6144
    v_mfma_f32_16x16x32_bf16 v[104:107], v[20:23], v[80:83], v[104:107]
    ds_read_b64_tr_b16 v[40:41], v10 offset:4096
    ds_read_b64_tr_b16 v[42:43], v10 offset:6144
    v_mfma_f32_16x16x32_bf16 v[120:123], v[20:23], v[84:87], v[120:123]
    ds_read_b64_tr_b16 v[44:45], v11 offset:4096
    ds_read_b64_tr_b16 v[46:47], v11 offset:6144
    v_mfma_f32_16x16x32_bf16 v[108:111], v[24:27], v[80:83], v[108:111]
    buffer_load_dwordx4 v[72:75], v98, s[16:19], s34 offen offset:0 sc1
    v_mfma_f32_16x16x32_bf16 v[124:127], v[24:27], v[84:87], v[124:127]
    v_mfma_f32_16x16x32_bf16 v[112:115], v[28:31], v[80:83], v[112:115]
    buffer_load_dwordx4 v[76:79], v97, s[16:19], s34 offen offset:0 sc1
    v_mfma_f32_16x16x32_bf16 v[128:131], v[28:31], v[84:87], v[128:131]
    s_waitcnt vmcnt(10) lgkmcnt(0)
    v_mfma_f32_16x16x32_bf16 v[100:103], v[32:35], v[88:91], v[100:103]
    ds_read_b64_tr_b16 v[16:17], v8 offset:16384
    ds_read_b64_tr_b16 v[18:19], v8 offset:18432
    v_mfma_f32_16x16x32_bf16 v[116:119], v[32:35], v[92:95], v[116:119]
    ds_read_b64_tr_b16 v[20:21], v9 offset:16384
    ds_read_b64_tr_b16 v[22:23], v9 offset:18432
    v_mfma_f32_16x16x32_bf16 v[104:107], v[36:39], v[88:91], v[104:107]
    ds_read_b64_tr_b16 v[24:25], v10 offset:16384
    ds_read_b64_tr_b16 v[26:27], v10 offset:18432
    v_mfma_f32_16x16x32_bf16 v[120:123], v[36:39], v[92:95], v[120:123]
    ds_read_b64_tr_b16 v[28:29], v11 offset:16384
    ds_read_b64_tr_b16 v[30:31], v11 offset:18432
    v_mfma_f32_16x16x32_bf16 v[108:111], v[40:43], v[88:91], v[108:111]
    buffer_load_dwordx4 v[80:83], v98, s[16:19], s34 offen offset:1024 sc1
    v_mfma_f32_16x16x32_bf16 v[124:127], v[40:43], v[92:95], v[124:127]
    v_mfma_f32_16x16x32_bf16 v[112:115], v[44:47], v[88:91], v[112:115]
    buffer_load_dwordx4 v[84:87], v97, s[16:19], s34 offen offset:1024 sc1
    v_mfma_f32_16x16x32_bf16 v[128:131], v[44:47], v[92:95], v[128:131]
    s_waitcnt vmcnt(10) lgkmcnt(0)
    v_mfma_f32_16x16x32_bf16 v[100:103], v[16:19], v[132:135], v[100:103]
    ds_read_b64_tr_b16 v[32:33], v8 offset:20480
    ds_read_b64_tr_b16 v[34:35], v8 offset:22528
    v_mfma_f32_16x16x32_bf16 v[116:119], v[16:19], v[136:139], v[116:119]
    ds_read_b64_tr_b16 v[36:37], v9 offset:20480
    ds_read_b64_tr_b16 v[38:39], v9 offset:22528
    v_mfma_f32_16x16x32_bf16 v[104:107], v[20:23], v[132:135], v[104:107]
    ds_read_b64_tr_b16 v[40:41], v10 offset:20480
    ds_read_b64_tr_b16 v[42:43], v10 offset:22528
    v_mfma_f32_16x16x32_bf16 v[120:123], v[20:23], v[136:139], v[120:123]
    ds_read_b64_tr_b16 v[44:45], v11 offset:20480
    ds_read_b64_tr_b16 v[46:47], v11 offset:22528
    v_mfma_f32_16x16x32_bf16 v[108:111], v[24:27], v[132:135], v[108:111]
    buffer_load_dwordx4 v[88:91], v98, s[16:19], s35 offen offset:0 sc1
    v_mfma_f32_16x16x32_bf16 v[124:127], v[24:27], v[136:139], v[124:127]
    v_mfma_f32_16x16x32_bf16 v[112:115], v[28:31], v[132:135], v[112:115]
    buffer_load_dwordx4 v[92:95], v97, s[16:19], s35 offen offset:0 sc1
    v_mfma_f32_16x16x32_bf16 v[128:131], v[28:31], v[136:139], v[128:131]
    s_waitcnt vmcnt(10) lgkmcnt(0)
    v_mfma_f32_16x16x32_bf16 v[100:103], v[32:35], v[48:51], v[100:103]
    ds_read_b64_tr_b16 v[16:17], v8 offset:40960
    ds_read_b64_tr_b16 v[18:19], v8 offset:43008
    v_mfma_f32_16x16x32_bf16 v[116:119], v[32:35], v[52:55], v[116:119]
    ds_read_b64_tr_b16 v[20:21], v9 offset:40960
    ds_read_b64_tr_b16 v[22:23], v9 offset:43008
    v_mfma_f32_16x16x32_bf16 v[104:107], v[36:39], v[48:51], v[104:107]
    ds_read_b64_tr_b16 v[24:25], v10 offset:40960
    ds_read_b64_tr_b16 v[26:27], v10 offset:43008
    v_mfma_f32_16x16x32_bf16 v[120:123], v[36:39], v[52:55], v[120:123]
    ds_read_b64_tr_b16 v[28:29], v11 offset:40960
    ds_read_b64_tr_b16 v[30:31], v11 offset:43008
    v_mfma_f32_16x16x32_bf16 v[108:111], v[40:43], v[48:51], v[108:111]
    buffer_load_dwordx4 v[132:135], v98, s[16:19], s35 offen offset:1024 sc1
    v_mfma_f32_16x16x32_bf16 v[124:127], v[40:43], v[52:55], v[124:127]
    v_mfma_f32_16x16x32_bf16 v[112:115], v[44:47], v[48:51], v[112:115]
    buffer_load_dwordx4 v[136:139], v97, s[16:19], s35 offen offset:1024 sc1
    v_mfma_f32_16x16x32_bf16 v[128:131], v[44:47], v[52:55], v[128:131]
    s_waitcnt vmcnt(10) lgkmcnt(0)
    v_mfma_f32_16x16x32_bf16 v[100:103], v[16:19], v[56:59], v[100:103]
    ds_read_b64_tr_b16 v[32:33], v8 offset:45056
    ds_read_b64_tr_b16 v[34:35], v8 offset:47104
    v_mfma_f32_16x16x32_bf16 v[116:119], v[16:19], v[60:63], v[116:119]
    ds_read_b64_tr_b16 v[36:37], v9 offset:45056
    ds_read_b64_tr_b16 v[38:39], v9 offset:47104
    v_mfma_f32_16x16x32_bf16 v[104:107], v[20:23], v[56:59], v[104:107]
    ds_read_b64_tr_b16 v[40:41], v10 offset:45056
    ds_read_b64_tr_b16 v[42:43], v10 offset:47104
    v_mfma_f32_16x16x32_bf16 v[120:123], v[20:23], v[60:63], v[120:123]
    ds_read_b64_tr_b16 v[44:45], v11 offset:45056
    ds_read_b64_tr_b16 v[46:47], v11 offset:47104
    v_mfma_f32_16x16x32_bf16 v[108:111], v[24:27], v[56:59], v[108:111]
    buffer_load_dwordx4 v[48:51], v98, s[16:19], s36 offen offset:0 sc1
    v_mfma_f32_16x16x32_bf16 v[124:127], v[24:27], v[60:63], v[124:127]
    v_mfma_f32_16x16x32_bf16 v[112:115], v[28:31], v[56:59], v[112:115]
    buffer_load_dwordx4 v[52:55], v97, s[16:19], s36 offen offset:0 sc1
    v_mfma_f32_16x16x32_bf16 v[128:131], v[28:31], v[60:63], v[128:131]
    s_waitcnt vmcnt(10) lgkmcnt(0)
    v_mfma_f32_16x16x32_bf16 v[100:103], v[32:35], v[64:67], v[100:103]
    ds_read_b64_tr_b16 v[16:17], v8 offset:32768
    ds_read_b64_tr_b16 v[18:19], v8 offset:34816
    v_mfma_f32_16x16x32_bf16 v[116:119], v[32:35], v[68:71], v[116:119]
    ds_read_b64_tr_b16 v[20:21], v9 offset:32768
    ds_read_b64_tr_b16 v[22:23], v9 offset:34816
    v_mfma_f32_16x16x32_bf16 v[104:107], v[36:39], v[64:67], v[104:107]
    ds_read_b64_tr_b16 v[24:25], v10 offset:32768
    ds_read_b64_tr_b16 v[26:27], v10 offset:34816
    v_mfma_f32_16x16x32_bf16 v[120:123], v[36:39], v[68:71], v[120:123]
    ds_read_b64_tr_b16 v[28:29], v11 offset:32768
    ds_read_b64_tr_b16 v[30:31], v11 offset:34816
    v_mfma_f32_16x16x32_bf16 v[108:111], v[40:43], v[64:67], v[108:111]
    buffer_load_dwordx4 v[56:59], v98, s[16:19], s36 offen offset:1024 sc1
    v_mfma_f32_16x16x32_bf16 v[124:127], v[40:43], v[68:71], v[124:127]
    v_mfma_f32_16x16x32_bf16 v[112:115], v[44:47], v[64:67], v[112:115]
    buffer_load_dwordx4 v[60:63], v97, s[16:19], s36 offen offset:1024 sc1
    v_mfma_f32_16x16x32_bf16 v[128:131], v[44:47], v[68:71], v[128:131]
    s_waitcnt vmcnt(10) lgkmcnt(0)
    v_mfma_f32_16x16x32_bf16 v[100:103], v[16:19], v[72:75], v[100:103]
    ds_read_b64_tr_b16 v[32:33], v8 offset:36864
    ds_read_b64_tr_b16 v[34:35], v8 offset:38912
    v_mfma_f32_16x16x32_bf16 v[116:119], v[16:19], v[76:79], v[116:119]
    ds_read_b64_tr_b16 v[36:37], v9 offset:36864
    ds_read_b64_tr_b16 v[38:39], v9 offset:38912
    v_mfma_f32_16x16x32_bf16 v[104:107], v[20:23], v[72:75], v[104:107]
    ds_read_b64_tr_b16 v[40:41], v10 offset:36864
    ds_read_b64_tr_b16 v[42:43], v10 offset:38912
    v_mfma_f32_16x16x32_bf16 v[120:123], v[20:23], v[76:79], v[120:123]
    ds_read_b64_tr_b16 v[44:45], v11 offset:36864
    ds_read_b64_tr_b16 v[46:47], v11 offset:38912
    v_mfma_f32_16x16x32_bf16 v[108:111], v[24:27], v[72:75], v[108:111]
    buffer_load_dwordx4 v[64:67], v98, s[16:19], s37 offen offset:0 sc1
    v_mfma_f32_16x16x32_bf16 v[124:127], v[24:27], v[76:79], v[124:127]
    v_mfma_f32_16x16x32_bf16 v[112:115], v[28:31], v[72:75], v[112:115]
    buffer_load_dwordx4 v[68:71], v97, s[16:19], s37 offen offset:0 sc1
    v_mfma_f32_16x16x32_bf16 v[128:131], v[28:31], v[76:79], v[128:131]
    s_waitcnt vmcnt(10) lgkmcnt(0)
    v_mfma_f32_16x16x32_bf16 v[100:103], v[32:35], v[80:83], v[100:103]
    ds_read_b64_tr_b16 v[16:17], v12 offset:0
    ds_read_b64_tr_b16 v[18:19], v12 offset:2048
    v_mfma_f32_16x16x32_bf16 v[116:119], v[32:35], v[84:87], v[116:119]
    ds_read_b64_tr_b16 v[20:21], v13 offset:0
    ds_read_b64_tr_b16 v[22:23], v13 offset:2048
    v_mfma_f32_16x16x32_bf16 v[104:107], v[36:39], v[80:83], v[104:107]
    ds_read_b64_tr_b16 v[24:25], v14 offset:0
    ds_read_b64_tr_b16 v[26:27], v14 offset:2048
    v_mfma_f32_16x16x32_bf16 v[120:123], v[36:39], v[84:87], v[120:123]
    ds_read_b64_tr_b16 v[28:29], v15 offset:0
    ds_read_b64_tr_b16 v[30:31], v15 offset:2048
    v_mfma_f32_16x16x32_bf16 v[108:111], v[40:43], v[80:83], v[108:111]
    buffer_load_dwordx4 v[72:75], v98, s[16:19], s37 offen offset:1024 sc1
    v_mfma_f32_16x16x32_bf16 v[124:127], v[40:43], v[84:87], v[124:127]
    v_mfma_f32_16x16x32_bf16 v[112:115], v[44:47], v[80:83], v[112:115]
    buffer_load_dwordx4 v[76:79], v97, s[16:19], s37 offen offset:1024 sc1
    v_mfma_f32_16x16x32_bf16 v[128:131], v[44:47], v[84:87], v[128:131]
    s_waitcnt vmcnt(10) lgkmcnt(0)
    v_mfma_f32_16x16x32_bf16 v[100:103], v[16:19], v[88:91], v[100:103]
    ds_read_b64_tr_b16 v[32:33], v12 offset:4096
    ds_read_b64_tr_b16 v[34:35], v12 offset:6144
    v_mfma_f32_16x16x32_bf16 v[116:119], v[16:19], v[92:95], v[116:119]
    ds_read_b64_tr_b16 v[36:37], v13 offset:4096
    ds_read_b64_tr_b16 v[38:39], v13 offset:6144
    v_mfma_f32_16x16x32_bf16 v[104:107], v[20:23], v[88:91], v[104:107]
    ds_read_b64_tr_b16 v[40:41], v14 offset:4096
    ds_read_b64_tr_b16 v[42:43], v14 offset:6144
    v_mfma_f32_16x16x32_bf16 v[120:123], v[20:23], v[92:95], v[120:123]
    ds_read_b64_tr_b16 v[44:45], v15 offset:4096
    ds_read_b64_tr_b16 v[46:47], v15 offset:6144
    v_mfma_f32_16x16x32_bf16 v[108:111], v[24:27], v[88:91], v[108:111]
    v_mfma_f32_16x16x32_bf16 v[124:127], v[24:27], v[92:95], v[124:127]
    v_mfma_f32_16x16x32_bf16 v[112:115], v[28:31], v[88:91], v[112:115]
    v_mfma_f32_16x16x32_bf16 v[128:131], v[28:31], v[92:95], v[128:131]
    s_waitcnt vmcnt(8) lgkmcnt(0)
    v_mfma_f32_16x16x32_bf16 v[100:103], v[32:35], v[132:135], v[100:103]
    ds_read_b64_tr_b16 v[16:17], v8 offset:49152
    ds_read_b64_tr_b16 v[18:19], v8 offset:51200
    v_mfma_f32_16x16x32_bf16 v[116:119], v[32:35], v[136:139], v[116:119]
    ds_read_b64_tr_b16 v[20:21], v9 offset:49152
    ds_read_b64_tr_b16 v[22:23], v9 offset:51200
    v_mfma_f32_16x16x32_bf16 v[104:107], v[36:39], v[132:135], v[104:107]
    ds_read_b64_tr_b16 v[24:25], v10 offset:49152
    ds_read_b64_tr_b16 v[26:27], v10 offset:51200
    v_mfma_f32_16x16x32_bf16 v[120:123], v[36:39], v[136:139], v[120:123]
    ds_read_b64_tr_b16 v[28:29], v11 offset:49152
    ds_read_b64_tr_b16 v[30:31], v11 offset:51200
    v_mfma_f32_16x16x32_bf16 v[108:111], v[40:43], v[132:135], v[108:111]
    v_mfma_f32_16x16x32_bf16 v[124:127], v[40:43], v[136:139], v[124:127]
    v_mfma_f32_16x16x32_bf16 v[112:115], v[44:47], v[132:135], v[112:115]
    v_mfma_f32_16x16x32_bf16 v[128:131], v[44:47], v[136:139], v[128:131]
    s_waitcnt vmcnt(6) lgkmcnt(0)
    v_mfma_f32_16x16x32_bf16 v[100:103], v[16:19], v[48:51], v[100:103]
    ds_read_b64_tr_b16 v[32:33], v8 offset:53248
    ds_read_b64_tr_b16 v[34:35], v8 offset:55296
    v_mfma_f32_16x16x32_bf16 v[116:119], v[16:19], v[52:55], v[116:119]
    ds_read_b64_tr_b16 v[36:37], v9 offset:53248
    ds_read_b64_tr_b16 v[38:39], v9 offset:55296
    v_mfma_f32_16x16x32_bf16 v[104:107], v[20:23], v[48:51], v[104:107]
    ds_read_b64_tr_b16 v[40:41], v10 offset:53248
    ds_read_b64_tr_b16 v[42:43], v10 offset:55296
    v_mfma_f32_16x16x32_bf16 v[120:123], v[20:23], v[52:55], v[120:123]
    ds_read_b64_tr_b16 v[44:45], v11 offset:53248
    ds_read_b64_tr_b16 v[46:47], v11 offset:55296
    v_mfma_f32_16x16x32_bf16 v[108:111], v[24:27], v[48:51], v[108:111]
    v_mfma_f32_16x16x32_bf16 v[124:127], v[24:27], v[52:55], v[124:127]
    v_mfma_f32_16x16x32_bf16 v[112:115], v[28:31], v[48:51], v[112:115]
    v_mfma_f32_16x16x32_bf16 v[128:131], v[28:31], v[52:55], v[128:131]
    s_waitcnt vmcnt(4) lgkmcnt(0)
    v_mfma_f32_16x16x32_bf16 v[100:103], v[32:35], v[56:59], v[100:103]
    ds_read_b64_tr_b16 v[16:17], v12 offset:8192
    ds_read_b64_tr_b16 v[18:19], v12 offset:10240
    v_mfma_f32_16x16x32_bf16 v[116:119], v[32:35], v[60:63], v[116:119]
    ds_read_b64_tr_b16 v[20:21], v13 offset:8192
    ds_read_b64_tr_b16 v[22:23], v13 offset:10240
    v_mfma_f32_16x16x32_bf16 v[104:107], v[36:39], v[56:59], v[104:107]
    ds_read_b64_tr_b16 v[24:25], v14 offset:8192
    ds_read_b64_tr_b16 v[26:27], v14 offset:10240
    v_mfma_f32_16x16x32_bf16 v[120:123], v[36:39], v[60:63], v[120:123]
    ds_read_b64_tr_b16 v[28:29], v15 offset:8192
    ds_read_b64_tr_b16 v[30:31], v15 offset:10240
    v_mfma_f32_16x16x32_bf16 v[108:111], v[40:43], v[56:59], v[108:111]
    v_mfma_f32_16x16x32_bf16 v[124:127], v[40:43], v[60:63], v[124:127]
    v_mfma_f32_16x16x32_bf16 v[112:115], v[44:47], v[56:59], v[112:115]
    v_mfma_f32_16x16x32_bf16 v[128:131], v[44:47], v[60:63], v[128:131]
    s_waitcnt vmcnt(2) lgkmcnt(0)
    v_mfma_f32_16x16x32_bf16 v[100:103], v[16:19], v[64:67], v[100:103]
    ds_read_b64_tr_b16 v[32:33], v12 offset:12288
    ds_read_b64_tr_b16 v[34:35], v12 offset:14336
    v_mfma_f32_16x16x32_bf16 v[116:119], v[16:19], v[68:71], v[116:119]
    ds_read_b64_tr_b16 v[36:37], v13 offset:12288
    ds_read_b64_tr_b16 v[38:39], v13 offset:14336
    v_mfma_f32_16x16x32_bf16 v[104:107], v[20:23], v[64:67], v[104:107]
    ds_read_b64_tr_b16 v[40:41], v14 offset:12288
    ds_read_b64_tr_b16 v[42:43], v14 offset:14336
    v_mfma_f32_16x16x32_bf16 v[120:123], v[20:23], v[68:71], v[120:123]
    ds_read_b64_tr_b16 v[44:45], v15 offset:12288
    ds_read_b64_tr_b16 v[46:47], v15 offset:14336
    v_mfma_f32_16x16x32_bf16 v[108:111], v[24:27], v[64:67], v[108:111]
    v_mfma_f32_16x16x32_bf16 v[124:127], v[24:27], v[68:71], v[124:127]
    v_mfma_f32_16x16x32_bf16 v[112:115], v[28:31], v[64:67], v[112:115]
    v_mfma_f32_16x16x32_bf16 v[128:131], v[28:31], v[68:71], v[128:131]
    s_waitcnt vmcnt(0) lgkmcnt(0)
    v_mfma_f32_16x16x32_bf16 v[100:103], v[32:35], v[72:75], v[100:103]
    v_mfma_f32_16x16x32_bf16 v[116:119], v[32:35], v[76:79], v[116:119]
    v_mfma_f32_16x16x32_bf16 v[104:107], v[36:39], v[72:75], v[104:107]
    v_mfma_f32_16x16x32_bf16 v[120:123], v[36:39], v[76:79], v[120:123]
    v_mfma_f32_16x16x32_bf16 v[108:111], v[40:43], v[72:75], v[108:111]
    v_mfma_f32_16x16x32_bf16 v[124:127], v[40:43], v[76:79], v[124:127]
    v_mfma_f32_16x16x32_bf16 v[112:115], v[44:47], v[72:75], v[112:115]
    v_mfma_f32_16x16x32_bf16 v[128:131], v[44:47], v[76:79], v[128:131]
    s_nop 2
    v_permlane16_swap_b32 v100, v104
    v_permlane16_swap_b32 v101, v105
    v_permlane16_swap_b32 v102, v106
    v_permlane16_swap_b32 v103, v107
    v_permlane16_swap_b32 v108, v112
    v_permlane16_swap_b32 v109, v113
    v_permlane16_swap_b32 v110, v114
    v_permlane16_swap_b32 v111, v115
    v_permlane16_swap_b32 v116, v120
    v_permlane16_swap_b32 v117, v121
    v_permlane16_swap_b32 v118, v122
    v_permlane16_swap_b32 v119, v123
    v_permlane16_swap_b32 v124, v128
    v_permlane16_swap_b32 v125, v129
    v_permlane16_swap_b32 v126, v130
    v_permlane16_swap_b32 v127, v131
    s_cmp_eq_u64 s[60:61], 0
    s_cbranch_scc1 F_fin
    s_mov_b32 s48, 0xbfb8aa3b
    v_and_b32 v7, 0x3f, v2
    v_lshlrev_b32 v7, 1, v7
    v_add_u32 v7, 159744, v7
    v_mov_b32 v6, 159136

    ds_read_b32 v5, v6 offset:0
FW_79:
    s_waitcnt lgkmcnt(0)
    v_cmp_gt_u32 vcc, 1, v5
    s_cbranch_vccz FO_80
    ds_read_b32 v5, v6 offset:0
    s_branch FW_79
FO_80:
    v_bfe_u32 v4, v164, 11, 3
    v_lshl_add_u32 v4, v4, 8, v7
    v_cmp_ne_u32 vcc, 0, v164
    s_nop 0
    s_and_saveexec_b64 s[50:51], vcc
    s_cbranch_execz F_rb_81
    ds_read_b128 v[16:19], v4 offset:0
    ds_read_b128 v[20:23], v4 offset:16
    ds_read_b128 v[24:27], v4 offset:128
    ds_read_b128 v[28:31], v4 offset:144
    v_and_b32 v5, 0xffff0000, v164
    v_ashrrev_i32 v6, 31, v5
    v_not_b32 v6, v6
    v_or_b32 v6, 0x80000000, v6
    v_xor_b32 v5, v5, v6
    v_and_b32 v5, 0xffff0000, v5
    v_mul_f32 v5, s48, v5
    v_exp_f32 v5, v5
    s_nop 0
    v_add_f32 v5, 1.0, v5
    v_rcp_f32 v5, v5
    s_nop 0
    v_cvt_pk_bf16_f32 v5, v5, v5
    v_lshlrev_b32 v5, 16, v5
    s_waitcnt lgkmcnt(0)
    v_fmac_f32 v100, v16, v5
    v_fmac_f32 v101, v17, v5
    v_fmac_f32 v102, v18, v5
    v_fmac_f32 v103, v19, v5
    v_fmac_f32 v104, v20, v5
    v_fmac_f32 v105, v21, v5
    v_fmac_f32 v106, v22, v5
    v_fmac_f32 v107, v23, v5
    v_fmac_f32 v108, v24, v5
    v_fmac_f32 v109, v25, v5
    v_fmac_f32 v110, v26, v5
    v_fmac_f32 v111, v27, v5
    v_fmac_f32 v112, v28, v5
    v_fmac_f32 v113, v29, v5
    v_fmac_f32 v114, v30, v5
    v_fmac_f32 v115, v31, v5
F_rb_81:
    s_mov_b64 exec, s[50:51]
    v_bfe_u32 v4, v165, 11, 3
    v_lshl_add_u32 v4, v4, 8, v7
    v_cmp_ne_u32 vcc, 0, v165
    s_nop 0
    s_and_saveexec_b64 s[50:51], vcc
    s_cbranch_execz F_rb_82
    ds_read_b128 v[16:19], v4 offset:0
    ds_read_b128 v[20:23], v4 offset:16
    ds_read_b128 v[24:27], v4 offset:128
    ds_read_b128 v[28:31], v4 offset:144
    v_and_b32 v5, 0xffff0000, v165
    v_ashrrev_i32 v6, 31, v5
    v_not_b32 v6, v6
    v_or_b32 v6, 0x80000000, v6
    v_xor_b32 v5, v5, v6
    v_and_b32 v5, 0xffff0000, v5
    v_mul_f32 v5, s48, v5
    v_exp_f32 v5, v5
    s_nop 0
    v_add_f32 v5, 1.0, v5
    v_rcp_f32 v5, v5
    s_nop 0
    v_cvt_pk_bf16_f32 v5, v5, v5
    v_lshlrev_b32 v5, 16, v5
    s_waitcnt lgkmcnt(0)
    v_fmac_f32 v116, v16, v5
    v_fmac_f32 v117, v17, v5
    v_fmac_f32 v118, v18, v5
    v_fmac_f32 v119, v19, v5
    v_fmac_f32 v120, v20, v5
    v_fmac_f32 v121, v21, v5
    v_fmac_f32 v122, v22, v5
    v_fmac_f32 v123, v23, v5
    v_fmac_f32 v124, v24, v5
    v_fmac_f32 v125, v25, v5
    v_fmac_f32 v126, v26, v5
    v_fmac_f32 v127, v27, v5
    v_fmac_f32 v128, v28, v5
    v_fmac_f32 v129, v29, v5
    v_fmac_f32 v130, v30, v5
    v_fmac_f32 v131, v31, v5
F_rb_82:
    s_mov_b64 exec, s[50:51]
F_fin:
    v_cvt_pk_bf16_f32 v48, v100, v101
    v_cvt_pk_bf16_f32 v49, v102, v103
    v_cvt_pk_bf16_f32 v50, v104, v105
    v_cvt_pk_bf16_f32 v51, v106, v107
    v_cvt_pk_bf16_f32 v52, v108, v109
    v_cvt_pk_bf16_f32 v53, v110, v111
    v_cvt_pk_bf16_f32 v54, v112, v113
    v_cvt_pk_bf16_f32 v55, v114, v115
    v_mov_b32 v64, v48
    v_mov_b32 v65, v49
    v_mov_b32 v66, v50
    v_mov_b32 v67, v51
    v_mov_b32_dpp v48, v52 row_ror:8 row_mask:0xf bank_mask:0xc
    v_mov_b32_dpp v49, v53 row_ror:8 row_mask:0xf bank_mask:0xc
    v_mov_b32_dpp v50, v54 row_ror:8 row_mask:0xf bank_mask:0xc
    v_mov_b32_dpp v51, v55 row_ror:8 row_mask:0xf bank_mask:0xc
    v_mov_b32_dpp v52, v64 row_ror:8 row_mask:0xf bank_mask:0x3
    v_mov_b32_dpp v53, v65 row_ror:8 row_mask:0xf bank_mask:0x3
    v_mov_b32_dpp v54, v66 row_ror:8 row_mask:0xf bank_mask:0x3
    v_mov_b32_dpp v55, v67 row_ror:8 row_mask:0xf bank_mask:0x3
    s_add_u32 s44, s42, 0x4000
    buffer_store_dwordx4 v[48:51], v1, s[12:15], s42 offen sc1
    buffer_store_dwordx4 v[52:55], v1, s[12:15], s44 offen sc1
    v_cvt_pk_bf16_f32 v56, v116, v117
    v_cvt_pk_bf16_f32 v57, v118, v119
    v_cvt_pk_bf16_f32 v58, v120, v121
    v_cvt_pk_bf16_f32 v59, v122, v123
    v_cvt_pk_bf16_f32 v60, v124, v125
    v_cvt_pk_bf16_f32 v61, v126, v127
    v_cvt_pk_bf16_f32 v62, v128, v129
    v_cvt_pk_bf16_f32 v63, v130, v131
    v_mov_b32 v64, v56
    v_mov_b32 v65, v57
    v_mov_b32 v66, v58
    v_mov_b32 v67, v59
    v_mov_b32_dpp v56, v60 row_ror:8 row_mask:0xf bank_mask:0xc
    v_mov_b32_dpp v57, v61 row_ror:8 row_mask:0xf bank_mask:0xc
    v_mov_b32_dpp v58, v62 row_ror:8 row_mask:0xf bank_mask:0xc
    v_mov_b32_dpp v59, v63 row_ror:8 row_mask:0xf bank_mask:0xc
    v_mov_b32_dpp v60, v64 row_ror:8 row_mask:0xf bank_mask:0x3
    v_mov_b32_dpp v61, v65 row_ror:8 row_mask:0xf bank_mask:0x3
    v_mov_b32_dpp v62, v66 row_ror:8 row_mask:0xf bank_mask:0x3
    v_mov_b32_dpp v63, v67 row_ror:8 row_mask:0xf bank_mask:0x3
    s_add_u32 s44, s43, 0x4000
    buffer_store_dwordx4 v[56:59], v1, s[12:15], s43 offen sc1
    buffer_store_dwordx4 v[60:63], v1, s[12:15], s44 offen sc1
    s_endpgm
F_aux:
    s_setprio 3
    s_sub_u32 s3, s3, 8
    s_mov_b32 s88, s3
    v_lshrrev_b32 v5, 4, v0
    s_cmp_eq_u32 s3, 1
    s_mov_b32 s45, 73728
    s_cselect_b32 s45, 65536, s45
    s_cmp_eq_u32 s3, 2
    s_cselect_b32 s45, 147456, s45
    v_bfe_u32 v60, v0, 2, 2
    v_lshl_add_u32 v62, v5, 3, v60
    v_lshrrev_b32 v60, 1, v60
    v_and_b32 v63, 1, v5
    v_lshl_add_u32 v60, v63, 1, v60
    v_lshlrev_b32 v60, 5, v60
    v_lshl_add_u32 v60, v62, 7, v60
    v_and_b32 v63, 3, v0
    v_lshl_add_u32 v60, v63, 3, v60
    v_add_u32 v62, s45, v60
    v_xor_b32 v63, 32, v62
    v_xor_b32 v64, 64, v62
    v_xor_b32 v65, 96, v62
    v_lshlrev_b32 v2, 4, v0
    v_lshlrev_b32 v3, 2, v0
    v_and_b32 v7, 15, v0
    v_and_b32 v8, 7, v0
    v_lshlrev_b32 v8, 4, v8
    v_lshl_add_u32 v8, v5, 7, v8
    v_bfe_u32 v9, v0, 3, 1
    v_lshl_add_u32 v4, v9, 11, v8
    v_and_b32 v9, 1, v0
    v_lshlrev_b32 v59, 2, v7
    s_lshl_b32 s76, s32, 4
    s_add_u32 s76, s76, s33
    s_lshl_b32 s77, s76, 3
    s_lshl_b32 s44, s3, 1
    s_add_u32 s77, s77, s44
    v_mov_b32 v12, 0
    v_mov_b32 v13, 0
    v_mov_b32 v14, 0
    v_mov_b32 v15, 0
    s_lshl_b32 s75, s3, 4
    s_add_u32 s75, s75, s33
    s_lshl_b32 s44, s3, 2
    s_add_u32 s44, s44, 159040
    v_mov_b32 v10, s44

    v_mov_b32 v32, 0x3f803f80
    v_mov_b32 v33, 0x3f803f80
    v_mov_b32 v34, 0x3f803f80
    v_mov_b32 v35, 0x3f803f80
    v_mov_b32 v36, 0x3f803f80
    v_mov_b32 v37, 0x3f803f80
    v_mov_b32 v38, 0x3f803f80
    v_mov_b32 v39, 0x3f803f80
    v_mov_b32 v40, 0x3f803f80
    v_mov_b32 v41, 0x3f803f80
    v_mov_b32 v42, 0x3f803f80
    v_mov_b32 v43, 0x3f803f80
    v_mov_b32 v44, 0x3f803f80
    v_mov_b32 v45, 0x3f803f80
    v_mov_b32 v46, 0x3f803f80
    v_mov_b32 v47, 0x3f803f80
    s_waitcnt lgkmcnt(0)
    s_mov_b32 s20, s4
    s_mov_b32 s21, s5
    s_mov_b32 s22, 0x400000
    s_mov_b32 s23, 0x00020000
    s_mov_b32 s19, 0x20000
    s_add_u32 s40, s72, 0x850000
    s_addc_u32 s41, s73, 0
    s_mov_b32 s42, 0xd000
    s_mov_b32 s43, 0x00020000
    s_cmp_lg_u32 s3, 0
    s_cbranch_scc1 F_z0
    s_getpc_b64 s[46:47]
F_pc:
    s_sub_u32 s46, s46, F_pc-parallel_sum__linear_attn_block__moe_arch_mod__prompt_kernel
    s_subb_u32 s47, s47, 0
    s_and_b32 s44, s31, 7
    s_lshl_b32 s44, s44, 13
    v_lshlrev_b32 v67, 7, v0
    v_add_u32 v67, s44, v67
    v_min_u32 v67, F_codeend-parallel_sum__linear_attn_block__moe_arch_mod__prompt_kernel-4, v67
    global_load_dword v61, v67, s[46:47]
    s_cmp_lg_u32 s75, 0
    s_cbranch_scc1 F_z0
    s_lshl_b32 s44, s32, 9
    s_add_u32 s44, s44, 32768
    s_mov_b32 exec_hi, 0
    buffer_store_dwordx4 v[12:15], v2, s[40:43], s44 offen sc0 sc1
    s_mul_i32 s44, s32, 768
    s_add_u32 s44, s44, 40960
    s_mov_b32 exec_hi, 0xffff
    buffer_store_dwordx4 v[12:15], v2, s[40:43], s44 offen sc0 sc1
    s_mov_b64 exec, -1
F_z0:

    s_and_b32 s89, s2, 0xdd
    s_bfe_u32 s44, s2, 0x10005
    s_lshl_b32 s44, s44, 1
    s_or_b32 s89, s89, s44
    s_bfe_u32 s44, s2, 0x10001
    s_xor_b32 s44, s44, 1
    s_lshl_b32 s44, s44, 5
    s_or_b32 s89, s89, s44
    s_xor_b32 s89, s89, 0

    s_and_b32 s36, s89, 3
    s_bfe_u32 s37, s89, 0x10002
    s_lshr_b32 s38, s89, 3
    s_cmp_eq_u32 s37, 0
    s_cselect_b32 s16, s62, s64
    s_cselect_b32 s17, s63, s65
    s_cmp_lt_u32 s89, 224
    s_cselect_b32 s18, 7340032, 0
    v_mul_u32_u24 v6, 57344, v5
    v_lshl_add_u32 v6, v7, 4, v6
    s_lshl_b32 s44, s36, 2
    s_add_u32 s44, s44, s3
    s_mul_i32 s54, s44, 458752
    s_lshl_b32 s45, s38, 8
    s_add_u32 s54, s54, s45
    s_lshl_b32 s55, s44, 7

    s_add_u32 s39, s35, 2
    s_and_b32 s39, s39, 7
    s_lshl_b32 s10, s34, 3
    s_add_u32 s10, s10, s30

    s_mul_i32 s10, s10, 112
    s_mul_i32 s79, s3, 28
    s_add_u32 s10, s10, s79
    s_lshl_b32 s78, s10, 11
    s_lshl_b32 s79, s39, 8
    s_add_u32 s78, s78, s79
    v_mul_u32_u24 v160, 14336, v5
    v_lshl_add_u32 v160, v7, 4, v160

    s_mov_b32 s80, s66
    s_mov_b32 s81, s67
    s_mov_b32 s82, 0x700000
    s_mov_b32 s83, 0x00020000
    s_barrier
    s_bitcmp0_b32 s3, 0
    s_cbranch_scc1 F_cs1
    ds_read_b64_tr_b16 v[72:73], v62 offset:0
    ds_read_b64_tr_b16 v[74:75], v62 offset:512
    ds_read_b64_tr_b16 v[76:77], v62 offset:4096
    ds_read_b64_tr_b16 v[78:79], v62 offset:4608
    ds_read_b64_tr_b16 v[80:81], v63 offset:0
    ds_read_b64_tr_b16 v[82:83], v63 offset:512
    ds_read_b64_tr_b16 v[84:85], v63 offset:4096
    ds_read_b64_tr_b16 v[86:87], v63 offset:4608
    s_waitcnt lgkmcnt(4)
    ds_read_b64_tr_b16 v[88:89], v64 offset:0
    ds_read_b64_tr_b16 v[90:91], v64 offset:512
    ds_read_b64_tr_b16 v[92:93], v64 offset:4096
    ds_read_b64_tr_b16 v[94:95], v64 offset:4608
    ds_read_b64_tr_b16 v[96:97], v65 offset:0
    ds_read_b64_tr_b16 v[98:99], v65 offset:512
    ds_read_b64_tr_b16 v[100:101], v65 offset:4096
    ds_read_b64_tr_b16 v[102:103], v65 offset:4608
    s_branch F_cs2
F_cs1:
    v_add_u32 v60, 159040, v3
    s_mov_b32 exec_hi, 0xffff
    ds_write_b32 v60, v12
    s_mov_b64 exec, -1
F_cs2:
    s_add_u32 s24, s72, 0x800000
    s_addc_u32 s25, s73, 0
    s_mov_b32 s26, 0x48000
    s_mov_b32 s27, 0x00020000
    s_mov_b32 s48, s70
    s_mov_b32 s49, s71
    s_mov_b32 s50, 0x100
    s_mov_b32 s51, 0x00020000
    s_lshl_b32 s47, s32, 9
    s_add_u32 s56, s47, 0x858000
    s_add_u32 s56, s72, s56
    s_addc_u32 s57, s73, 0
    s_lshl_b32 s47, s33, 9
    s_add_u32 s58, s47, 0x858100
    s_add_u32 s58, s72, s58
    s_addc_u32 s59, s73, 0
    v_mov_b32 v68, 0x3f803f80
    v_mov_b32 v69, 0x3f803f80
    v_mov_b32 v70, 0x3f803f80
    v_mov_b32 v71, 0x3f803f80
    s_waitcnt lgkmcnt(0)
    s_cmp_lg_u32 s75, 0
    s_cbranch_scc1 F_z4
    s_lshl_b32 s45, s32, 2
    s_add_u32 s44, s70, s45
    s_addc_u32 s45, s71, 0
    s_mov_b32 s46, 1
    s_waitcnt vmcnt(0)
    s_atomic_add s46, s[44:45], 0
F_z4:

    s_bitcmp0_b32 s3, 0
    s_cbranch_scc1 F_c2a
    v_mfma_f32_16x16x32_bf16 v[104:107], v[68:71], v[72:75], 0
    v_mfma_f32_16x16x32_bf16 v[108:111], v[68:71], v[80:83], 0
    v_mfma_f32_16x16x32_bf16 v[112:115], v[68:71], v[88:91], 0
    v_mfma_f32_16x16x32_bf16 v[116:119], v[68:71], v[96:99], 0
    v_mfma_f32_16x16x32_bf16 v[104:107], v[68:71], v[76:79], v[104:107]
    v_mfma_f32_16x16x32_bf16 v[108:111], v[68:71], v[84:87], v[108:111]
    v_mfma_f32_16x16x32_bf16 v[112:115], v[68:71], v[92:95], v[112:115]
    v_mfma_f32_16x16x32_bf16 v[116:119], v[68:71], v[100:103], v[116:119]
    v_cmp_eq_u32 vcc, 1, v5
    s_nop 4
    v_cndmask_b32 v66, v104, v108, vcc
    v_cmp_eq_u32 vcc, 2, v5
    s_nop 1
    v_cndmask_b32 v66, v66, v112, vcc
    v_cmp_eq_u32 vcc, 3, v5
    s_nop 1
    v_cndmask_b32 v66, v66, v116, vcc

F_c2a:
    s_barrier
    s_cmp_lg_u32 s3, 2
    s_cbranch_scc1 F_cs3
    ds_read_b64_tr_b16 v[72:73], v62 offset:0
    ds_read_b64_tr_b16 v[74:75], v62 offset:512
    ds_read_b64_tr_b16 v[76:77], v62 offset:4096
    ds_read_b64_tr_b16 v[78:79], v62 offset:4608
    ds_read_b64_tr_b16 v[80:81], v63 offset:0
    ds_read_b64_tr_b16 v[82:83], v63 offset:512
    ds_read_b64_tr_b16 v[84:85], v63 offset:4096
    ds_read_b64_tr_b16 v[86:87], v63 offset:4608
    s_waitcnt lgkmcnt(4)
    ds_read_b64_tr_b16 v[88:89], v64 offset:0
    s_branch IW_s8
IW_w8:
    s_branch IW_r8
IW_s8:
    ds_read_b64_tr_b16 v[90:91], v64 offset:512
    ds_read_b64_tr_b16 v[92:93], v64 offset:4096
    ds_read_b64_tr_b16 v[94:95], v64 offset:4608
    ds_read_b64_tr_b16 v[96:97], v65 offset:0
    ds_read_b64_tr_b16 v[98:99], v65 offset:512
    ds_read_b64_tr_b16 v[100:101], v65 offset:4096
    ds_read_b64_tr_b16 v[102:103], v65 offset:4608
    s_waitcnt lgkmcnt(0)
F_cs3:
    s_cmp_lg_u32 s3, 0
    s_cbranch_scc1 EV_84
    s_branch IW_w8
IW_r8:
EV_84:
    s_cmp_lg_u32 s3, 1
    s_cbranch_scc1 EV_85
    s_branch IW_w0
IW_r0:
EV_85:
    s_cmp_lg_u32 s3, 2
    s_cbranch_scc1 EV_86
    s_branch IW_w1
IW_r1:
EV_86:
    s_cmp_lg_u32 s3, 3
    s_cbranch_scc1 EV_87
    s_branch IW_w3
IW_r3:
EV_87:
    s_barrier
    s_cmp_lt_u32 s3, 2
    s_mov_b32 s44, 98304
    s_cselect_b32 s44, 98304, s44
    s_lshl_b32 s45, s3, 12
    s_add_u32 s44, s44, s45
    v_add_u32 v4, s44, v4
    v_add_u32 v8, 161792, v8
    ds_read_b128 v[16:19], v4 offset:0
    ds_read_b128 v[20:23], v4 offset:512
    ds_read_b128 v[24:27], v4 offset:1024
    ds_read_b128 v[28:31], v4 offset:1536
    s_mov_b32 exec_lo, 0x00ff00ff
    s_mov_b32 exec_hi, 0x00ff00ff
    ds_read_b128 v[32:35], v8 offset:0
    ds_read_b128 v[36:39], v8 offset:512
    ds_read_b128 v[40:43], v8 offset:1024
    ds_read_b128 v[44:47], v8 offset:1536
    s_mov_b64 exec, -1
    s_waitcnt lgkmcnt(0)
    v_mfma_f32_16x16x32_bf16 v[120:123], v[16:19], v[16:19], 0
    v_mfma_f32_16x16x32_bf16 v[124:127], v[16:19], v[32:35], 0
    v_mfma_f32_16x16x32_bf16 v[128:131], v[32:35], v[32:35], 0
    v_mfma_f32_16x16x32_bf16 v[120:123], v[20:23], v[20:23], v[120:123]
    v_mfma_f32_16x16x32_bf16 v[124:127], v[20:23], v[36:39], v[124:127]
    v_mfma_f32_16x16x32_bf16 v[128:131], v[36:39], v[36:39], v[128:131]
    v_mfma_f32_16x16x32_bf16 v[120:123], v[24:27], v[24:27], v[120:123]
    v_mfma_f32_16x16x32_bf16 v[124:127], v[24:27], v[40:43], v[124:127]
    v_mfma_f32_16x16x32_bf16 v[128:131], v[40:43], v[40:43], v[128:131]
    v_mfma_f32_16x16x32_bf16 v[120:123], v[28:31], v[28:31], v[120:123]
    v_mfma_f32_16x16x32_bf16 v[124:127], v[28:31], v[44:47], v[124:127]
    v_mfma_f32_16x16x32_bf16 v[128:131], v[44:47], v[44:47], v[128:131]
    s_cmp_lg_u32 s3, 2
    s_cbranch_scc1 F_c2b
    v_mfma_f32_16x16x32_bf16 v[104:107], v[68:71], v[72:75], 0
    v_mfma_f32_16x16x32_bf16 v[108:111], v[68:71], v[80:83], 0
    v_mfma_f32_16x16x32_bf16 v[112:115], v[68:71], v[88:91], 0
    v_mfma_f32_16x16x32_bf16 v[116:119], v[68:71], v[96:99], 0
    v_mfma_f32_16x16x32_bf16 v[104:107], v[68:71], v[76:79], v[104:107]
    v_mfma_f32_16x16x32_bf16 v[108:111], v[68:71], v[84:87], v[108:111]
    v_mfma_f32_16x16x32_bf16 v[112:115], v[68:71], v[92:95], v[112:115]
    v_mfma_f32_16x16x32_bf16 v[116:119], v[68:71], v[100:103], v[116:119]
    v_cmp_eq_u32 vcc, 1, v5
    s_nop 4
    v_cndmask_b32 v66, v104, v108, vcc
    v_cmp_eq_u32 vcc, 2, v5
    s_nop 1
    v_cndmask_b32 v66, v66, v112, vcc
    v_cmp_eq_u32 vcc, 3, v5
    s_nop 1
    v_cndmask_b32 v66, v66, v116, vcc

F_c2b:
    s_cmp_lg_u32 s3, 0
    s_cbranch_scc1 F_r1
    buffer_load_dword v11, v59, s[48:51], 0 offen sc0 sc1
F_r1:
    s_cmp_lg_u32 s3, 0
    s_cbranch_scc1 EV_89
    s_branch IW_w4
IW_r4:
EV_89:
    s_cmp_lg_u32 s3, 1
    s_cbranch_scc1 EV_90
    s_branch IW_w9
IW_r9:
EV_90:
    s_cmp_lg_u32 s3, 2
    s_cbranch_scc1 EV_91
    s_branch IW_w10
IW_r10:
EV_91:
    s_cmp_lg_u32 s3, 3
    s_cbranch_scc1 EV_92
    s_nop 0
EV_92:
    s_barrier
    v_and_b32 v52, 3, v0
    v_cmp_eq_u32 vcc, 1, v52
    s_nop 1
    v_cndmask_b32 v120, v120, v121, vcc
    v_cndmask_b32 v124, v124, v125, vcc
    v_cndmask_b32 v128, v128, v129, vcc
    v_cmp_eq_u32 vcc, 2, v52
    s_nop 1
    v_cndmask_b32 v120, v120, v122, vcc
    v_cndmask_b32 v124, v124, v126, vcc
    v_cndmask_b32 v128, v128, v130, vcc
    v_cmp_eq_u32 vcc, 3, v52
    s_nop 1
    v_cndmask_b32 v120, v120, v123, vcc
    v_cndmask_b32 v124, v124, v127, vcc
    v_cndmask_b32 v128, v128, v131, vcc
    v_add_f32_dpp v120, v120, v120 quad_perm:[1,0,3,2] row_mask:0xf bank_mask:0xf
    v_add_f32_dpp v124, v124, v124 quad_perm:[1,0,3,2] row_mask:0xf bank_mask:0xf
    v_add_f32_dpp v128, v128, v128 quad_perm:[1,0,3,2] row_mask:0xf bank_mask:0xf
    v_add_f32_dpp v120, v120, v120 quad_perm:[2,3,0,1] row_mask:0xf bank_mask:0xf
    v_add_f32_dpp v124, v124, v124 quad_perm:[2,3,0,1] row_mask:0xf bank_mask:0xf
    v_add_f32_dpp v128, v128, v128 quad_perm:[2,3,0,1] row_mask:0xf bank_mask:0xf
    v_readlane_b32 s44, v124, 8
    v_readlane_b32 s45, v124, 24
    v_readlane_b32 s46, v124, 40
    v_readlane_b32 s47, v124, 56
    v_mov_b32 v48, s44
    v_mov_b32 v52, s45
    s_nop 0
    v_writelane_b32 v48, s46, 1
    v_writelane_b32 v52, s47, 1
    v_readlane_b32 s44, v120, 0
    v_readlane_b32 s45, v120, 20
    v_readlane_b32 s46, v120, 40
    v_readlane_b32 s47, v120, 60
    v_mov_b32 v49, s44
    v_mov_b32 v53, s45
    s_nop 0
    v_writelane_b32 v49, s46, 1
    v_writelane_b32 v53, s47, 1
    v_readlane_b32 s44, v124, 0
    v_readlane_b32 s45, v124, 20
    v_readlane_b32 s46, v124, 32
    v_readlane_b32 s47, v124, 52
    v_mov_b32 v50, s44
    v_mov_b32 v54, s45
    s_nop 0
    v_writelane_b32 v50, s46, 1
    v_writelane_b32 v54, s47, 1
    v_readlane_b32 s44, v128, 8
    v_readlane_b32 s45, v128, 24
    v_readlane_b32 s46, v128, 8
    v_readlane_b32 s47, v128, 24
    v_mov_b32 v51, s44
    v_mov_b32 v55, s45
    s_nop 0
    v_writelane_b32 v51, s46, 1
    v_writelane_b32 v55, s47, 1
    v_add_f32 v48, v48, v52
    v_add_f32 v49, v49, v53
    v_add_f32 v50, v50, v54
    v_add_f32 v51, v51, v55
    v_mul_f32 v48, 0x3a800000, v48
    v_mul_f32 v49, 0x3a800000, v49
    v_fma_f32 v49, -v48, v48, v49
    v_max_f32 v49, 0, v49
    v_cvt_pk_bf16_f32 v52, v48, v49
    v_lshlrev_b32 v48, 16, v52
    v_and_b32 v49, 0xffff0000, v52
    v_add_f32 v49, 0x3727c5ac, v49
    v_cvt_pk_bf16_f32 v49, v49, v49
    v_lshlrev_b32 v49, 16, v49
    v_sqrt_f32 v49, v49
    s_nop 0
    v_cvt_pk_bf16_f32 v49, v49, v49
    v_lshlrev_b32 v49, 16, v49
    v_rcp_f32 v49, v49
    v_xor_b32 v48, 0x80000000, v48
    v_fma_f32 v50, v48, v51, v50
    v_mul_f32 v50, v50, v49
    v_cvt_pk_bf16_f32 v50, v50, v50
    v_and_b32 v50, 0xffff0000, v50
    v_ashrrev_i32 v51, 31, v50
    v_or_b32 v51, 0x80000000, v51
    v_xor_b32 v50, v50, v51
    v_and_b32 v50, 0xffff0000, v50
    s_sub_u32 s44, 2047, s77
    v_sub_u32 v51, s44, v9
    v_or_b32 v50, v50, v51
    s_lshl_b32 s44, s3, 1
    v_add_u32 v52, s44, v9
    v_lshlrev_b32 v53, 3, v52
    v_lshlrev_b32 v52, 2, v52
    v_add_u32 v53, 159744, v53
    v_add_u32 v52, 159808, v52
    s_mov_b64 exec, 3
    ds_write_b64 v53, v[48:49]
    ds_write_b32 v52, v50
    s_mov_b64 exec, -1
    s_waitcnt lgkmcnt(0)

    s_cmp_lg_u32 s3, 0
    s_cbranch_scc1 F_a0r
F_a0p:
    s_waitcnt vmcnt(0)
    v_cmp_eq_u32 vcc, 0, v11
    s_cbranch_vccz F_a0r
    s_sleep 4
    buffer_load_dword v11, v59, s[48:51], 0 offen sc0 sc1
    s_branch F_a0p
F_a0r:
    s_barrier
    s_cmp_eq_u32 s3, 0
    s_cbranch_scc1 F_ax0
    s_mul_i32 s44, s33, 768
    s_add_u32 s44, s44, 40960
    s_add_u32 s45, s3, 1
    s_lshr_b32 s45, s45, 1
    s_cmp_eq_u32 s3, 2
    s_cselect_b32 s45, 0, s45
    s_lshl_b32 s45, s45, 8
    s_add_u32 s44, s44, s45
    buffer_atomic_add_f32 v66, v3, s[40:43], s44 offen
    s_mul_i32 s44, s2, 1152
    s_mul_i32 s45, s3, 384
    s_add_u32 s44, s44, s45
    s_sub_u32 s44, s44, 384
    s_mov_b64 exec, 0xffffff
    buffer_store_dwordx4 v[12:15], v2, s[24:27], s44 offen sc0 sc1
    s_mov_b64 exec, -1
    s_branch F_s1
F_ax0:
    v_add_u32 v60, 159744, v3
    ds_read_b32 v60, v60
    s_lshl_b32 s44, s76, 7
    s_mov_b32 exec_hi, 0
    s_waitcnt lgkmcnt(0)
    buffer_store_dword v60, v3, s[40:43], s44 offen sc0 sc1
    s_mov_b64 exec, -1
F_s1:

    s_barrier
    v_mov_b32 v4, 159144
    v_mov_b32 v8, 1
    s_lshr_b32 s47, s32, 2
    s_lshl_b32 s47, s47, 11
    s_add_u32 s86, s47, 0x858180
    s_add_u32 s86, s72, s86
    s_addc_u32 s87, s73, 0
    s_waitcnt vmcnt(0)
    s_mov_b64 exec, 1
    ds_add_rtn_u32 v9, v4, v8
    s_waitcnt lgkmcnt(0)
    v_readfirstlane_b32 s44, v9
    s_mov_b64 exec, -1
    s_cmp_lg_u32 s44, 3
    s_cbranch_scc1 F_a0s
    s_mov_b32 s74, 1
    s_atomic_add s74, s[86:87], 0
    s_atomic_add s74, s[56:57], 0
    s_atomic_add s74, s[58:59], 0
F_a0s:

    s_barrier
    s_mul_i32 s53, s2, 37
    s_and_b32 s53, s53, 255
    s_mul_i32 s53, s53, 4
    s_lshr_b32 s53, s53, 8
    s_branch F_swx
F_sw0:
    s_add_u32 s91, s54, 0
    buffer_load_dwordx4 v[72:75], v6, s[16:19], s91 offen nt
    s_add_u32 s91, s54, 7168
    buffer_load_dwordx4 v[76:79], v6, s[16:19], s91 offen nt
    s_add_u32 s91, s54, 14336
    buffer_load_dwordx4 v[80:83], v6, s[16:19], s91 offen nt
    s_add_u32 s91, s54, 21504
    buffer_load_dwordx4 v[84:87], v6, s[16:19], s91 offen nt
    s_add_u32 s91, s54, 28672
    buffer_load_dwordx4 v[88:91], v6, s[16:19], s91 offen nt
    s_add_u32 s91, s54, 35840
    buffer_load_dwordx4 v[92:95], v6, s[16:19], s91 offen nt
    s_add_u32 s91, s54, 43008
    buffer_load_dwordx4 v[96:99], v6, s[16:19], s91 offen nt
    s_add_u32 s91, s54, 50176
    buffer_load_dwordx4 v[100:103], v6, s[16:19], s91 offen nt
    s_setpc_b64 s[34:35]
F_swx:
    s_cmp_eq_u32 s3, 2
    s_cbranch_scc1 F_ax2
    s_cmp_eq_u32 s3, 1
    s_cbranch_scc1 F_ax1
    s_cmp_eq_u32 s3, 0
    s_cbranch_scc1 F_ax0b
    s_barrier
    s_cmp_lg_u32 s53, 0
    s_cbranch_scc1 SW_93
    s_call_b64 s[34:35], F_sw0
SW_93:
    s_branch IW_w5
IW_r5:
    s_barrier
    s_cmp_lg_u32 s53, 1
    s_cbranch_scc1 SW_94
    s_call_b64 s[34:35], F_sw0
SW_94:
    s_branch IW_w7
IW_r7:
    s_barrier
    s_cmp_lg_u32 s53, 2
    s_cbranch_scc1 SW_95
    s_call_b64 s[34:35], F_sw0
SW_95:
    s_nop 0
    s_barrier
    s_cmp_lg_u32 s53, 3
    s_cbranch_scc1 SW_96
    s_call_b64 s[34:35], F_sw0
SW_96:
    s_nop 0
    s_barrier
    s_nop 0
    s_barrier
    s_nop 0
    s_barrier
    s_add_u32 s91, s54, 229376
    buffer_load_dwordx4 v[104:107], v6, s[16:19], s91 offen nt
    s_add_u32 s91, s54, 236544
    buffer_load_dwordx4 v[108:111], v6, s[16:19], s91 offen nt
    s_add_u32 s91, s54, 243712
    buffer_load_dwordx4 v[112:115], v6, s[16:19], s91 offen nt
    s_add_u32 s91, s54, 250880
    buffer_load_dwordx4 v[116:119], v6, s[16:19], s91 offen nt
    s_nop 0
    s_load_dword s76, s[56:57], 0 glc
    s_barrier
    s_add_u32 s91, s54, 258048
    buffer_load_dwordx4 v[120:123], v6, s[16:19], s91 offen nt
    s_add_u32 s91, s54, 265216
    buffer_load_dwordx4 v[124:127], v6, s[16:19], s91 offen nt
    s_add_u32 s91, s54, 272384
    buffer_load_dwordx4 v[128:131], v6, s[16:19], s91 offen nt
    s_add_u32 s91, s54, 279552
    buffer_load_dwordx4 v[132:135], v6, s[16:19], s91 offen nt
    s_waitcnt lgkmcnt(0)
    s_cmp_lt_u32 s76, 1000
    s_cbranch_scc1 F_g3
    v_mov_b32 v4, 1
    s_mov_b64 exec, 1
    ds_write_b32 v10, v4 offset:48
    s_mov_b64 exec, -1
    s_mov_b32 s88, 0
F_g3:
    s_barrier
    s_branch F_aj
F_ax1:
    s_barrier
    s_cmp_lg_u32 s53, 0
    s_cbranch_scc1 SW_97
    s_call_b64 s[34:35], F_sw0
SW_97:
    s_branch IW_w6
IW_r6:
    s_barrier
    s_cmp_lg_u32 s53, 1
    s_cbranch_scc1 SW_98
    s_call_b64 s[34:35], F_sw0
SW_98:
    s_nop 0
    s_barrier
    s_cmp_lg_u32 s53, 2
    s_cbranch_scc1 SW_99
    s_call_b64 s[34:35], F_sw0
SW_99:
    s_nop 0
    s_mul_i32 s44, s33, 768
    s_add_u32 s44, s44, 40960
    s_barrier
    s_cmp_lg_u32 s53, 3
    s_cbranch_scc1 SW_100
    s_call_b64 s[34:35], F_sw0
SW_100:
    s_load_dword s76, s[58:59], 0 glc
    s_barrier
    s_waitcnt lgkmcnt(0)
    s_cmp_ge_u32 s76, 16
    s_cbranch_scc1 GC_101
SP_102:
    s_load_dword s76, s[58:59], 0 glc
    s_waitcnt lgkmcnt(0)
    s_cmp_ge_u32 s76, 16
    s_cbranch_scc1 SD_103
    s_sleep 3
    s_branch SP_102
SD_103:
GC_101:
    s_barrier
    s_sleep 4
    s_mov_b32 m0, 158208
    s_mov_b32 exec_hi, 0xffff
    buffer_load_dwordx4 v2, s[40:43], s44 offen sc0 sc1 lds
    s_mov_b64 exec, -1
    s_barrier
    s_add_u32 s91, s54, 229376
    buffer_load_dwordx4 v[104:107], v6, s[16:19], s91 offen nt
    s_add_u32 s91, s54, 236544
    buffer_load_dwordx4 v[108:111], v6, s[16:19], s91 offen nt
    s_add_u32 s91, s54, 243712
    buffer_load_dwordx4 v[112:115], v6, s[16:19], s91 offen nt
    s_add_u32 s91, s54, 250880
    buffer_load_dwordx4 v[116:119], v6, s[16:19], s91 offen nt
    s_barrier
    s_add_u32 s91, s54, 258048
    buffer_load_dwordx4 v[120:123], v6, s[16:19], s91 offen nt
    s_add_u32 s91, s54, 265216
    buffer_load_dwordx4 v[124:127], v6, s[16:19], s91 offen nt
    s_add_u32 s91, s54, 272384
    buffer_load_dwordx4 v[128:131], v6, s[16:19], s91 offen nt
    s_add_u32 s91, s54, 279552
    buffer_load_dwordx4 v[132:135], v6, s[16:19], s91 offen nt
    s_waitcnt vmcnt(8)
    v_mov_b32 v4, 1
    s_mov_b64 exec, 1
    ds_write_b32 v10, v4 offset:48
    s_mov_b64 exec, -1
    s_barrier
    s_branch F_aj
IW_w9:
    s_branch IW_r9
F_ax0b:
    s_barrier
    s_cmp_lg_u32 s53, 0
    s_cbranch_scc1 SW_104
    s_call_b64 s[34:35], F_sw0
SW_104:
    s_branch IW_w2
IW_r2:
    s_barrier
    s_cmp_lg_u32 s53, 1
    s_cbranch_scc1 SW_105
    s_call_b64 s[34:35], F_sw0
SW_105:
    s_nop 0
    s_barrier
    s_cmp_lg_u32 s53, 2
    s_cbranch_scc1 SW_106
    s_call_b64 s[34:35], F_sw0
SW_106:
    s_nop 0
    s_lshl_b32 s47, s28, 9
    s_waitcnt lgkmcnt(0)
    s_add_u32 s58, s47, 0x858000
    s_add_u32 s58, s72, s58
    s_addc_u32 s59, s73, 0
    s_lshl_b32 s44, s32, 11
    s_lshl_b32 s45, s28, 11
    v_lshrrev_b32 v11, 2, v0
    v_and_b32 v9, 3, v0
    v_lshlrev_b32 v9, 4, v9
    v_lshl_add_u32 v11, v11, 7, v9

    s_barrier
    s_cmp_lg_u32 s53, 3
    s_cbranch_scc1 SW_107
    s_call_b64 s[34:35], F_sw0
SW_107:
    s_load_dword s76, s[56:57], 0 glc
    s_load_dword s77, s[58:59], 0 glc
    s_barrier
    s_waitcnt lgkmcnt(0)
    s_cmp_ge_u32 s76, 16
    s_cbranch_scc1 GC_108
SP_109:
    s_load_dword s76, s[56:57], 0 glc
    s_waitcnt lgkmcnt(0)
    s_cmp_ge_u32 s76, 16
    s_cbranch_scc1 SD_110
    s_sleep 3
    s_branch SP_109
SD_110:
GC_108:
    s_cmp_ge_u32 s77, 16
    s_cbranch_scc1 GC_111
SP_112:
    s_load_dword s77, s[58:59], 0 glc
    s_waitcnt lgkmcnt(0)
    s_cmp_ge_u32 s77, 16
    s_cbranch_scc1 SD_113
    s_sleep 3
    s_branch SP_112
SD_113:
GC_111:
    s_barrier
    s_sleep 4
    buffer_load_dwordx4 v[32:35], v11, s[40:43], s44 offen sc0 sc1
    buffer_load_dwordx4 v[36:39], v11, s[40:43], s45 offen sc0 sc1
    v_lshlrev_b32 v9, 3, v0
    v_add_u32 v9, 155648, v9
    s_mov_b32 s44, 0x3fb8aa3b

    s_barrier
    s_add_u32 s91, s54, 229376
    buffer_load_dwordx4 v[104:107], v6, s[16:19], s91 offen nt
    s_add_u32 s91, s54, 236544
    buffer_load_dwordx4 v[108:111], v6, s[16:19], s91 offen nt
    s_add_u32 s91, s54, 243712
    buffer_load_dwordx4 v[112:115], v6, s[16:19], s91 offen nt
    s_add_u32 s91, s54, 250880
    buffer_load_dwordx4 v[116:119], v6, s[16:19], s91 offen nt
    s_barrier
    s_add_u32 s91, s54, 258048
    buffer_load_dwordx4 v[120:123], v6, s[16:19], s91 offen nt
    s_add_u32 s91, s54, 265216
    buffer_load_dwordx4 v[124:127], v6, s[16:19], s91 offen nt
    s_add_u32 s91, s54, 272384
    buffer_load_dwordx4 v[128:131], v6, s[16:19], s91 offen nt
    s_add_u32 s91, s54, 279552
    buffer_load_dwordx4 v[132:135], v6, s[16:19], s91 offen nt
    s_waitcnt vmcnt(8)
    v_swap_b32 v33, v34
    v_swap_b32 v37, v38
    v_mul_f32 v40, s44, v34
    v_mul_f32 v41, s44, v35
    ds_write_b64 v9, v[32:33]
    ds_write_b64 v9, v[40:41] offset:1024
    ds_write_b64 v9, v[36:37] offset:1536
    ds_write_b64 v9, v[38:39] offset:2048

    v_mov_b32 v4, 1
    s_mov_b64 exec, 1
    ds_write_b32 v10, v4 offset:48
    s_mov_b64 exec, -1
    s_barrier
    s_branch F_aj
F_ax2:
    s_cmp_lg_u32 s2, 248
    s_cbranch_scc1 F_a2n
    s_waitcnt lgkmcnt(0)
    s_mov_b32 s74, 7
    v_lshrrev_b32 v11, 1, v0
    v_and_b32 v9, 1, v0
    v_lshlrev_b32 v9, 4, v9
    v_lshl_add_u32 v11, v11, 7, v9
    v_lshlrev_b32 v9, 9, v0
    v_mov_b32 v8, 1000
F_a2l:

    s_load_dword s60, s[40:41], 0x8180 glc
    s_load_dword s61, s[40:41], 0x8980 glc
    s_load_dword s62, s[40:41], 0x9180 glc
    s_load_dword s63, s[40:41], 0x9980 glc
    s_waitcnt lgkmcnt(0)
    s_add_u32 s60, s60, s61
    s_add_u32 s62, s62, s63
    s_add_u32 s60, s60, s62
    s_cmp_ge_u32 s60, 256
    s_cbranch_scc1 F_a2t

    s_cmp_ge_u32 s74, 17
    s_cbranch_scc1 DB_114
    s_barrier
    s_add_u32 s74, s74, 1
DB_114:
    s_branch F_a2l
F_a2t:
    s_movk_i32 s44, 0
    buffer_load_dwordx4 v[16:19], v11, s[40:43], s44 offen offset:64 sc0 sc1
    s_movk_i32 s44, 4096
    buffer_load_dwordx4 v[20:23], v11, s[40:43], s44 offen offset:64 sc0 sc1
    s_movk_i32 s44, 8192
    buffer_load_dwordx4 v[24:27], v11, s[40:43], s44 offen offset:64 sc0 sc1
    s_movk_i32 s44, 12288
    buffer_load_dwordx4 v[28:31], v11, s[40:43], s44 offen offset:64 sc0 sc1
    s_movk_i32 s44, 16384
    buffer_load_dwordx4 v[32:35], v11, s[40:43], s44 offen offset:64 sc0 sc1
    s_movk_i32 s44, 20480
    buffer_load_dwordx4 v[36:39], v11, s[40:43], s44 offen offset:64 sc0 sc1
    s_movk_i32 s44, 24576
    buffer_load_dwordx4 v[40:43], v11, s[40:43], s44 offen offset:64 sc0 sc1
    s_movk_i32 s44, 28672
    buffer_load_dwordx4 v[44:47], v11, s[40:43], s44 offen offset:64 sc0 sc1
    s_mov_b32 s44, 32768
    s_mov_b64 exec, 0xffff
    buffer_atomic_add v8, v9, s[40:43], s44 offen
    s_mov_b64 exec, -1

    s_cmp_ge_u32 s74, 17
    s_cbranch_scc1 DB_115
    s_barrier
    s_add_u32 s74, s74, 1
DB_115:
    s_waitcnt vmcnt(1)
    v_max3_u32 v48, v16, v17, v18
    v_med3_u32 v49, v16, v17, v18
    v_min3_u32 v50, v16, v17, v18
    v_med3_u32 v50, v49, v50, v19
    v_med3_u32 v49, v48, v49, v19
    v_max_u32 v48, v48, v19
    v_med3_u32 v50, v49, v50, v20
    v_med3_u32 v49, v48, v49, v20
    v_max_u32 v48, v48, v20
    v_med3_u32 v50, v49, v50, v21
    v_med3_u32 v49, v48, v49, v21
    v_max_u32 v48, v48, v21
    v_med3_u32 v50, v49, v50, v22
    v_med3_u32 v49, v48, v49, v22
    v_max_u32 v48, v48, v22
    v_med3_u32 v50, v49, v50, v23
    v_med3_u32 v49, v48, v49, v23
    v_max_u32 v48, v48, v23
    v_med3_u32 v50, v49, v50, v24
    v_med3_u32 v49, v48, v49, v24
    v_max_u32 v48, v48, v24
    v_med3_u32 v50, v49, v50, v25
    v_med3_u32 v49, v48, v49, v25
    v_max_u32 v48, v48, v25
    v_med3_u32 v50, v49, v50, v26
    v_med3_u32 v49, v48, v49, v26
    v_max_u32 v48, v48, v26
    v_med3_u32 v50, v49, v50, v27
    v_med3_u32 v49, v48, v49, v27
    v_max_u32 v48, v48, v27
    v_med3_u32 v50, v49, v50, v28
    v_med3_u32 v49, v48, v49, v28
    v_max_u32 v48, v48, v28
    v_med3_u32 v50, v49, v50, v29
    v_med3_u32 v49, v48, v49, v29
    v_max_u32 v48, v48, v29
    v_med3_u32 v50, v49, v50, v30
    v_med3_u32 v49, v48, v49, v30
    v_max_u32 v48, v48, v30
    v_med3_u32 v50, v49, v50, v31
    v_med3_u32 v49, v48, v49, v31
    v_max_u32 v48, v48, v31
    v_med3_u32 v50, v49, v50, v32
    v_med3_u32 v49, v48, v49, v32
    v_max_u32 v48, v48, v32
    v_med3_u32 v50, v49, v50, v33
    v_med3_u32 v49, v48, v49, v33
    v_max_u32 v48, v48, v33
    v_med3_u32 v50, v49, v50, v34
    v_med3_u32 v49, v48, v49, v34
    v_max_u32 v48, v48, v34
    v_med3_u32 v50, v49, v50, v35
    v_med3_u32 v49, v48, v49, v35
    v_max_u32 v48, v48, v35
    v_med3_u32 v50, v49, v50, v36
    v_med3_u32 v49, v48, v49, v36
    v_max_u32 v48, v48, v36
    v_med3_u32 v50, v49, v50, v37
    v_med3_u32 v49, v48, v49, v37
    v_max_u32 v48, v48, v37
    v_med3_u32 v50, v49, v50, v38
    v_med3_u32 v49, v48, v49, v38
    v_max_u32 v48, v48, v38
    v_med3_u32 v50, v49, v50, v39
    v_med3_u32 v49, v48, v49, v39
    v_max_u32 v48, v48, v39
    v_med3_u32 v50, v49, v50, v40
    v_med3_u32 v49, v48, v49, v40
    v_max_u32 v48, v48, v40
    v_med3_u32 v50, v49, v50, v41
    v_med3_u32 v49, v48, v49, v41
    v_max_u32 v48, v48, v41
    v_med3_u32 v50, v49, v50, v42
    v_med3_u32 v49, v48, v49, v42
    v_max_u32 v48, v48, v42
    v_med3_u32 v50, v49, v50, v43
    v_med3_u32 v49, v48, v49, v43
    v_max_u32 v48, v48, v43
    v_med3_u32 v50, v49, v50, v44
    v_med3_u32 v49, v48, v49, v44
    v_max_u32 v48, v48, v44
    v_med3_u32 v50, v49, v50, v45
    v_med3_u32 v49, v48, v49, v45
    v_max_u32 v48, v48, v45
    v_med3_u32 v50, v49, v50, v46
    v_med3_u32 v49, v48, v49, v46
    v_max_u32 v48, v48, v46
    v_med3_u32 v50, v49, v50, v47
    v_med3_u32 v49, v48, v49, v47
    v_max_u32 v48, v48, v47
    s_mov_b32 s53, 0
    v_max_u32 v4, v48, v49
    s_nop 1
    v_max_u32_dpp v4, v4, v4 row_shr:1 row_mask:0xf bank_mask:0xf bound_ctrl:0
    s_nop 1
    v_max_u32_dpp v4, v4, v4 row_shr:2 row_mask:0xf bank_mask:0xf bound_ctrl:0
    s_nop 1
    v_max_u32_dpp v4, v4, v4 row_shr:4 row_mask:0xf bank_mask:0xf bound_ctrl:0
    s_nop 1
    v_max_u32_dpp v4, v4, v4 row_shr:8 row_mask:0xf bank_mask:0xf bound_ctrl:0
    s_nop 1
    v_max_u32_dpp v4, v4, v4 row_bcast:15 row_mask:0xa bank_mask:0xf
    s_nop 1
    v_max_u32_dpp v4, v4, v4 row_bcast:31 row_mask:0xc bank_mask:0xf
    s_nop 0
    v_readlane_b32 s52, v4, 63
    s_nop 0
    s_add_u32 s53, s53, s52
    v_writelane_b32 v13, s53, 0
    v_subrev_u32 v48, s52, v48
    v_subrev_u32 v49, s52, v49
    v_max_u32 v4, v48, v49
    s_nop 1
    v_max_u32_dpp v4, v4, v4 row_shr:1 row_mask:0xf bank_mask:0xf bound_ctrl:0
    s_nop 1
    v_max_u32_dpp v4, v4, v4 row_shr:2 row_mask:0xf bank_mask:0xf bound_ctrl:0
    s_nop 1
    v_max_u32_dpp v4, v4, v4 row_shr:4 row_mask:0xf bank_mask:0xf bound_ctrl:0
    s_nop 1
    v_max_u32_dpp v4, v4, v4 row_shr:8 row_mask:0xf bank_mask:0xf bound_ctrl:0
    s_nop 1
    v_max_u32_dpp v4, v4, v4 row_bcast:15 row_mask:0xa bank_mask:0xf
    s_nop 1
    v_max_u32_dpp v4, v4, v4 row_bcast:31 row_mask:0xc bank_mask:0xf
    s_nop 0
    v_readlane_b32 s52, v4, 63
    s_nop 0
    s_add_u32 s53, s53, s52
    v_writelane_b32 v13, s53, 1
    v_subrev_u32 v48, s52, v48
    v_subrev_u32 v49, s52, v49
    v_max_u32 v4, v48, v49
    s_nop 1
    v_max_u32_dpp v4, v4, v4 row_shr:1 row_mask:0xf bank_mask:0xf bound_ctrl:0
    s_nop 1
    v_max_u32_dpp v4, v4, v4 row_shr:2 row_mask:0xf bank_mask:0xf bound_ctrl:0
    s_nop 1
    v_max_u32_dpp v4, v4, v4 row_shr:4 row_mask:0xf bank_mask:0xf bound_ctrl:0
    s_nop 1
    v_max_u32_dpp v4, v4, v4 row_shr:8 row_mask:0xf bank_mask:0xf bound_ctrl:0
    s_nop 1
    v_max_u32_dpp v4, v4, v4 row_bcast:15 row_mask:0xa bank_mask:0xf
    s_nop 1
    v_max_u32_dpp v4, v4, v4 row_bcast:31 row_mask:0xc bank_mask:0xf
    s_nop 0
    v_readlane_b32 s52, v4, 63
    s_nop 0
    s_add_u32 s53, s53, s52
    v_writelane_b32 v13, s53, 2
    v_subrev_u32 v48, s52, v48
    v_subrev_u32 v49, s52, v49
    v_max_u32 v4, v48, v49
    s_nop 1
    v_max_u32_dpp v4, v4, v4 row_shr:1 row_mask:0xf bank_mask:0xf bound_ctrl:0
    s_nop 1
    v_max_u32_dpp v4, v4, v4 row_shr:2 row_mask:0xf bank_mask:0xf bound_ctrl:0
    s_nop 1
    v_max_u32_dpp v4, v4, v4 row_shr:4 row_mask:0xf bank_mask:0xf bound_ctrl:0
    s_nop 1
    v_max_u32_dpp v4, v4, v4 row_shr:8 row_mask:0xf bank_mask:0xf bound_ctrl:0
    s_nop 1
    v_max_u32_dpp v4, v4, v4 row_bcast:15 row_mask:0xa bank_mask:0xf
    s_nop 1
    v_max_u32_dpp v4, v4, v4 row_bcast:31 row_mask:0xc bank_mask:0xf
    s_nop 0
    v_readlane_b32 s52, v4, 63
    s_nop 0
    s_add_u32 s53, s53, s52
    v_writelane_b32 v13, s53, 3
    v_subrev_u32 v48, s52, v48
    v_subrev_u32 v49, s52, v49
    v_max_u32 v4, v48, v49
    s_nop 1
    v_max_u32_dpp v4, v4, v4 row_shr:1 row_mask:0xf bank_mask:0xf bound_ctrl:0
    s_nop 1
    v_max_u32_dpp v4, v4, v4 row_shr:2 row_mask:0xf bank_mask:0xf bound_ctrl:0
    s_nop 1
    v_max_u32_dpp v4, v4, v4 row_shr:4 row_mask:0xf bank_mask:0xf bound_ctrl:0
    s_nop 1
    v_max_u32_dpp v4, v4, v4 row_shr:8 row_mask:0xf bank_mask:0xf bound_ctrl:0
    s_nop 1
    v_max_u32_dpp v4, v4, v4 row_bcast:15 row_mask:0xa bank_mask:0xf
    s_nop 1
    v_max_u32_dpp v4, v4, v4 row_bcast:31 row_mask:0xc bank_mask:0xf
    s_nop 0
    v_readlane_b32 s52, v4, 63
    s_nop 0
    s_add_u32 s53, s53, s52
    v_writelane_b32 v13, s53, 4
    v_subrev_u32 v48, s52, v48
    v_subrev_u32 v49, s52, v49
    v_max_u32 v4, v48, v49
    s_nop 1
    v_max_u32_dpp v4, v4, v4 row_shr:1 row_mask:0xf bank_mask:0xf bound_ctrl:0
    s_nop 1
    v_max_u32_dpp v4, v4, v4 row_shr:2 row_mask:0xf bank_mask:0xf bound_ctrl:0
    s_nop 1
    v_max_u32_dpp v4, v4, v4 row_shr:4 row_mask:0xf bank_mask:0xf bound_ctrl:0
    s_nop 1
    v_max_u32_dpp v4, v4, v4 row_shr:8 row_mask:0xf bank_mask:0xf bound_ctrl:0
    s_nop 1
    v_max_u32_dpp v4, v4, v4 row_bcast:15 row_mask:0xa bank_mask:0xf
    s_nop 1
    v_max_u32_dpp v4, v4, v4 row_bcast:31 row_mask:0xc bank_mask:0xf
    s_nop 0
    v_readlane_b32 s52, v4, 63
    s_nop 0
    s_add_u32 s53, s53, s52
    v_writelane_b32 v13, s53, 5
    v_subrev_u32 v48, s52, v48
    v_subrev_u32 v49, s52, v49
    v_max_u32 v4, v48, v49
    s_nop 1
    v_max_u32_dpp v4, v4, v4 row_shr:1 row_mask:0xf bank_mask:0xf bound_ctrl:0
    s_nop 1
    v_max_u32_dpp v4, v4, v4 row_shr:2 row_mask:0xf bank_mask:0xf bound_ctrl:0
    s_nop 1
    v_max_u32_dpp v4, v4, v4 row_shr:4 row_mask:0xf bank_mask:0xf bound_ctrl:0
    s_nop 1
    v_max_u32_dpp v4, v4, v4 row_shr:8 row_mask:0xf bank_mask:0xf bound_ctrl:0
    s_nop 1
    v_max_u32_dpp v4, v4, v4 row_bcast:15 row_mask:0xa bank_mask:0xf
    s_nop 1
    v_max_u32_dpp v4, v4, v4 row_bcast:31 row_mask:0xc bank_mask:0xf
    s_nop 0
    v_readlane_b32 s52, v4, 63
    s_nop 0
    s_add_u32 s53, s53, s52
    v_writelane_b32 v13, s53, 6
    v_subrev_u32 v48, s52, v48
    v_subrev_u32 v49, s52, v49
    v_max_u32 v4, v48, v49
    s_nop 1
    v_max_u32_dpp v4, v4, v4 row_shr:1 row_mask:0xf bank_mask:0xf bound_ctrl:0
    s_nop 1
    v_max_u32_dpp v4, v4, v4 row_shr:2 row_mask:0xf bank_mask:0xf bound_ctrl:0
    s_nop 1
    v_max_u32_dpp v4, v4, v4 row_shr:4 row_mask:0xf bank_mask:0xf bound_ctrl:0
    s_nop 1
    v_max_u32_dpp v4, v4, v4 row_shr:8 row_mask:0xf bank_mask:0xf bound_ctrl:0
    s_nop 1
    v_max_u32_dpp v4, v4, v4 row_bcast:15 row_mask:0xa bank_mask:0xf
    s_nop 1
    v_max_u32_dpp v4, v4, v4 row_bcast:31 row_mask:0xc bank_mask:0xf
    s_nop 0
    v_readlane_b32 s52, v4, 63
    s_nop 0
    s_add_u32 s53, s53, s52
    v_writelane_b32 v13, s53, 7
    v_cmp_lt_u32 vcc, s53, v50
    s_cbranch_vccz F_a2k
    s_mov_b32 s53, 0
    s_mov_b32 s52, 0
    s_mov_b32 s64, 0
F_a2f:
    v_subrev_u32 v16, s52, v16
    v_subrev_u32 v17, s52, v17
    v_subrev_u32 v18, s52, v18
    v_subrev_u32 v19, s52, v19
    v_subrev_u32 v20, s52, v20
    v_subrev_u32 v21, s52, v21
    v_subrev_u32 v22, s52, v22
    v_subrev_u32 v23, s52, v23
    v_subrev_u32 v24, s52, v24
    v_subrev_u32 v25, s52, v25
    v_subrev_u32 v26, s52, v26
    v_subrev_u32 v27, s52, v27
    v_subrev_u32 v28, s52, v28
    v_subrev_u32 v29, s52, v29
    v_subrev_u32 v30, s52, v30
    v_subrev_u32 v31, s52, v31
    v_subrev_u32 v32, s52, v32
    v_subrev_u32 v33, s52, v33
    v_subrev_u32 v34, s52, v34
    v_subrev_u32 v35, s52, v35
    v_subrev_u32 v36, s52, v36
    v_subrev_u32 v37, s52, v37
    v_subrev_u32 v38, s52, v38
    v_subrev_u32 v39, s52, v39
    v_subrev_u32 v40, s52, v40
    v_subrev_u32 v41, s52, v41
    v_subrev_u32 v42, s52, v42
    v_subrev_u32 v43, s52, v43
    v_subrev_u32 v44, s52, v44
    v_subrev_u32 v45, s52, v45
    v_subrev_u32 v46, s52, v46
    v_subrev_u32 v47, s52, v47
    v_max3_u32 v4, v16, v17, v18
    v_max3_u32 v12, v19, v20, v21
    v_max3_u32 v4, v4, v22, v23
    v_max3_u32 v12, v12, v24, v25
    v_max3_u32 v4, v4, v26, v27
    v_max3_u32 v12, v12, v28, v29
    v_max3_u32 v4, v4, v30, v31
    v_max3_u32 v12, v12, v32, v33
    v_max3_u32 v4, v4, v34, v35
    v_max3_u32 v12, v12, v36, v37
    v_max3_u32 v4, v4, v38, v39
    v_max3_u32 v12, v12, v40, v41
    v_max3_u32 v4, v4, v42, v43
    v_max3_u32 v12, v12, v44, v45
    v_max3_u32 v4, v4, v46, v47
    v_max_u32 v4, v4, v12
    s_nop 1
    v_max_u32_dpp v4, v4, v4 row_shr:1 row_mask:0xf bank_mask:0xf bound_ctrl:0
    s_nop 1
    v_max_u32_dpp v4, v4, v4 row_shr:2 row_mask:0xf bank_mask:0xf bound_ctrl:0
    s_nop 1
    v_max_u32_dpp v4, v4, v4 row_shr:4 row_mask:0xf bank_mask:0xf bound_ctrl:0
    s_nop 1
    v_max_u32_dpp v4, v4, v4 row_shr:8 row_mask:0xf bank_mask:0xf bound_ctrl:0
    s_nop 1
    v_max_u32_dpp v4, v4, v4 row_bcast:15 row_mask:0xa bank_mask:0xf
    s_nop 1
    v_max_u32_dpp v4, v4, v4 row_bcast:31 row_mask:0xc bank_mask:0xf
    s_nop 0
    v_readlane_b32 s52, v4, 63
    s_nop 0
    s_add_u32 s53, s53, s52
    s_mov_b32 m0, s64
    v_writelane_b32 v13, s53, m0
    s_cmp_ge_u32 s74, 17
    s_cbranch_scc1 DB_116
    s_barrier
    s_add_u32 s74, s74, 1
DB_116:
    s_add_u32 s64, s64, 1
    s_cmp_lt_u32 s64, 8
    s_cbranch_scc1 F_a2f
F_a2k:
    v_and_b32 v4, 7, v0
    v_lshlrev_b32 v4, 2, v4
    ds_bpermute_b32 v12, v4, v13
    v_lshrrev_b32 v9, 3, v0
    v_lshl_add_u32 v4, v9, 9, v4
    s_mov_b32 s44, 32896
    s_mov_b32 s45, 36992
    s_waitcnt lgkmcnt(0)
    v_or_b32 v12, 0x8000, v12
    buffer_store_dword v12, v4, s[40:43], s44 offen sc0 sc1
    buffer_store_dword v12, v4, s[40:43], s45 offen sc0 sc1

F_a2m:
    s_cmp_ge_u32 s74, 17
    s_cbranch_scc1 DB_117
    s_barrier
    s_add_u32 s74, s74, 1
DB_117:
    s_cmp_lt_u32 s74, 17
    s_cbranch_scc1 F_a2m
    s_add_u32 s91, s54, 0
    buffer_load_dwordx4 v[72:75], v6, s[16:19], s91 offen nt
    s_add_u32 s91, s54, 7168
    buffer_load_dwordx4 v[76:79], v6, s[16:19], s91 offen nt
    s_add_u32 s91, s54, 14336
    buffer_load_dwordx4 v[80:83], v6, s[16:19], s91 offen nt
    s_add_u32 s91, s54, 21504
    buffer_load_dwordx4 v[84:87], v6, s[16:19], s91 offen nt
    s_add_u32 s91, s54, 28672
    buffer_load_dwordx4 v[88:91], v6, s[16:19], s91 offen nt
    s_add_u32 s91, s54, 35840
    buffer_load_dwordx4 v[92:95], v6, s[16:19], s91 offen nt
    s_add_u32 s91, s54, 43008
    buffer_load_dwordx4 v[96:99], v6, s[16:19], s91 offen nt
    s_add_u32 s91, s54, 50176
    buffer_load_dwordx4 v[100:103], v6, s[16:19], s91 offen nt
    s_add_u32 s91, s54, 229376
    buffer_load_dwordx4 v[104:107], v6, s[16:19], s91 offen nt
    s_add_u32 s91, s54, 236544
    buffer_load_dwordx4 v[108:111], v6, s[16:19], s91 offen nt
    s_add_u32 s91, s54, 243712
    buffer_load_dwordx4 v[112:115], v6, s[16:19], s91 offen nt
    s_add_u32 s91, s54, 250880
    buffer_load_dwordx4 v[116:119], v6, s[16:19], s91 offen nt
    s_add_u32 s91, s54, 258048
    buffer_load_dwordx4 v[120:123], v6, s[16:19], s91 offen nt
    s_add_u32 s91, s54, 265216
    buffer_load_dwordx4 v[124:127], v6, s[16:19], s91 offen nt
    s_add_u32 s91, s54, 272384
    buffer_load_dwordx4 v[128:131], v6, s[16:19], s91 offen nt
    s_add_u32 s91, s54, 279552
    buffer_load_dwordx4 v[132:135], v6, s[16:19], s91 offen nt
    s_branch F_aj2
IW_w10:
    s_branch IW_r10
F_a2n:
    s_barrier
    s_cmp_lg_u32 s53, 0
    s_cbranch_scc1 SW_118
    s_call_b64 s[34:35], F_sw0
SW_118:
    s_branch IW_w11
IW_r11:
    s_barrier
    s_cmp_lg_u32 s53, 1
    s_cbranch_scc1 SW_119
    s_call_b64 s[34:35], F_sw0
SW_119:
    s_nop 0
    s_barrier
    s_cmp_lg_u32 s53, 2
    s_cbranch_scc1 SW_120
    s_call_b64 s[34:35], F_sw0
SW_120:
    s_nop 0
    s_barrier
    s_cmp_lg_u32 s53, 3
    s_cbranch_scc1 SW_121
    s_call_b64 s[34:35], F_sw0
SW_121:
    s_nop 0
    s_barrier
    s_nop 0
    s_barrier
    s_nop 0
    s_barrier
    s_add_u32 s91, s54, 229376
    buffer_load_dwordx4 v[104:107], v6, s[16:19], s91 offen nt
    s_add_u32 s91, s54, 236544
    buffer_load_dwordx4 v[108:111], v6, s[16:19], s91 offen nt
    s_add_u32 s91, s54, 243712
    buffer_load_dwordx4 v[112:115], v6, s[16:19], s91 offen nt
    s_add_u32 s91, s54, 250880
    buffer_load_dwordx4 v[116:119], v6, s[16:19], s91 offen nt
    s_nop 0
    s_load_dwordx8 s[60:67], s[56:57], 128 glc
    s_barrier
    s_add_u32 s91, s54, 258048
    buffer_load_dwordx4 v[120:123], v6, s[16:19], s91 offen nt
    s_add_u32 s91, s54, 265216
    buffer_load_dwordx4 v[124:127], v6, s[16:19], s91 offen nt
    s_add_u32 s91, s54, 272384
    buffer_load_dwordx4 v[128:131], v6, s[16:19], s91 offen nt
    s_add_u32 s91, s54, 279552
    buffer_load_dwordx4 v[132:135], v6, s[16:19], s91 offen nt
    s_waitcnt lgkmcnt(0)
    s_and_b64 s[44:45], s[60:61], s[62:63]
    s_and_b64 s[44:45], s[44:45], s[64:65]
    s_and_b64 s[44:45], s[44:45], s[66:67]
    s_and_b32 s44, s44, s45
    s_bitcmp1_b32 s44, 15
    s_cbranch_scc0 F_a2q
    s_andn2_b32 s60, s60, 0x8000
    v_writelane_b32 v12, s60, 0
    s_andn2_b32 s61, s61, 0x8000
    v_writelane_b32 v12, s61, 1
    s_andn2_b32 s62, s62, 0x8000
    v_writelane_b32 v12, s62, 2
    s_andn2_b32 s63, s63, 0x8000
    v_writelane_b32 v12, s63, 3
    s_andn2_b32 s64, s64, 0x8000
    v_writelane_b32 v12, s64, 4
    s_andn2_b32 s65, s65, 0x8000
    v_writelane_b32 v12, s65, 5
    s_andn2_b32 s66, s66, 0x8000
    v_writelane_b32 v12, s66, 6
    s_andn2_b32 s67, s67, 0x8000
    v_writelane_b32 v12, s67, 7
    v_add_u32 v4, 158976, v3
    s_mov_b64 exec, 0xff
    ds_write_b32 v4, v12
    s_mov_b64 exec, -1
    v_mov_b32 v4, 1
    s_mov_b64 exec, 1
    ds_write_b32 v10, v4 offset:48
    s_mov_b64 exec, -1
    s_waitcnt lgkmcnt(0)
    s_mov_b32 s88, 1
    s_branch F_a2r
F_a2q:
    s_load_dwordx8 s[60:67], s[56:57], 128 glc
F_a2r:
    s_barrier
    s_cmp_lg_u32 s88, 2
    s_cbranch_scc1 F_aj
    s_waitcnt lgkmcnt(0)
    s_and_b64 s[44:45], s[60:61], s[62:63]
    s_and_b64 s[44:45], s[44:45], s[64:65]
    s_and_b64 s[44:45], s[44:45], s[66:67]
    s_and_b32 s44, s44, s45
    s_bitcmp1_b32 s44, 15
    s_cbranch_scc0 F_a2s
    s_andn2_b32 s60, s60, 0x8000
    v_writelane_b32 v12, s60, 0
    s_andn2_b32 s61, s61, 0x8000
    v_writelane_b32 v12, s61, 1
    s_andn2_b32 s62, s62, 0x8000
    v_writelane_b32 v12, s62, 2
    s_andn2_b32 s63, s63, 0x8000
    v_writelane_b32 v12, s63, 3
    s_andn2_b32 s64, s64, 0x8000
    v_writelane_b32 v12, s64, 4
    s_andn2_b32 s65, s65, 0x8000
    v_writelane_b32 v12, s65, 5
    s_andn2_b32 s66, s66, 0x8000
    v_writelane_b32 v12, s66, 6
    s_andn2_b32 s67, s67, 0x8000
    v_writelane_b32 v12, s67, 7
    v_add_u32 v4, 158976, v3
    s_mov_b64 exec, 0xff
    ds_write_b32 v4, v12
    s_mov_b64 exec, -1
    v_mov_b32 v4, 1
    s_mov_b64 exec, 1
    ds_write_b32 v10, v4 offset:48
    s_mov_b64 exec, -1
    s_mov_b32 s88, 1
F_a2s:
    v_mov_b32 v4, 1
    s_mov_b64 exec, 1
    ds_write_b32 v10, v4 offset:176
    s_mov_b64 exec, -1
F_aj:
    s_mov_b32 s74, 0
F_aj2:
    v_and_b32 v13, 3, v0
    v_lshlrev_b32 v13, 2, v13
    v_add_u32 v13, 159040, v13

    s_cmp_lt_u32 s3, 2
    s_mov_b32 s75, 65536
    s_cselect_b32 s75, 32768, s75
    s_and_b32 s44, s3, 1
    s_lshl_b32 s44, s44, 12
    s_add_u32 s75, s75, s44
    s_add_u32 s12, s72, 0x900000
    s_addc_u32 s13, s73, 0
    s_mov_b32 s14, 0xe0000
    s_mov_b32 s15, 0x00020000
    s_mov_b32 s47, s10
    v_mov_b32 v4, 159096
    ds_read_b32 v9, v4
    s_waitcnt lgkmcnt(0)
    v_readfirstlane_b32 s79, v9
    s_nop 0
    s_cmp_lg_u32 s79, 0
    s_cbranch_scc1 F_xf
    s_cmp_eq_u32 s2, 248
    s_cbranch_scc1 F_xe
    ds_read_b32 v9, v4 offset:128
FW_122:
    s_waitcnt lgkmcnt(0)
    v_cmp_gt_u32 vcc, 1, v9
    s_cbranch_vccz FO_123
    ds_read_b32 v9, v4 offset:128
    s_branch FW_122
FO_123:
    ds_read_b32 v9, v4
    s_waitcnt lgkmcnt(0)
    v_readfirstlane_b32 s79, v9
    s_nop 0
    s_cmp_eq_u32 s79, 0
    s_cbranch_scc1 F_xe
F_xf:
    v_and_b32 v4, 7, v0
    v_lshlrev_b32 v4, 2, v4
    v_add_u32 v4, 158976, v4
    ds_read_b32 v4, v4
    s_waitcnt lgkmcnt(0)
    v_and_b32 v4, 0x7ff, v4
    v_sub_u32 v4, 2047, v4
    v_and_b32 v11, 7, v4
    v_lshrrev_b32 v9, 3, v4
    v_lshlrev_b32 v9, 7, v9
    v_lshl_add_u32 v9, v11, 3, v9
    v_lshlrev_b32 v4, 11, v4
    v_lshl_add_u32 v4, v5, 4, v4
    buffer_load_dwordx4 v[64:67], v4, s[20:23], s55 offen
    buffer_load_dwordx4 v[68:71], v4, s[20:23], s55 offen offset:64
    buffer_load_dwordx2 v[14:15], v9, s[40:43], 0 offen sc0 sc1

F_xe:
    s_cmp_lg_u32 s74, 0
    s_cbranch_scc1 JB_124
    s_barrier
JB_124:
    s_cmp_lg_u32 s88, 3
    s_cbranch_scc1 F_g4
SP_125:
    s_load_dword s76, s[56:57], 0 glc
    s_waitcnt lgkmcnt(0)
    s_cmp_ge_u32 s76, 1000
    s_cbranch_scc1 SD_126
    s_sleep 3
    s_branch SP_125
SD_126:
    v_mov_b32 v4, 1
    s_mov_b64 exec, 1
    ds_write_b32 v10, v4 offset:48
    s_mov_b64 exec, -1
F_g4:
    s_setprio 1
    s_cmp_lg_u32 s79, 0
    s_cbranch_scc1 F_xd
    s_cmp_lg_u32 s88, 2
    s_cbranch_scc1 F_se
F_sc:
    s_load_dwordx8 s[60:67], s[56:57], 128 glc
    s_waitcnt lgkmcnt(0)
    s_and_b64 s[44:45], s[60:61], s[62:63]
    s_and_b64 s[44:45], s[44:45], s[64:65]
    s_and_b64 s[44:45], s[44:45], s[66:67]
    s_and_b32 s44, s44, s45
    s_bitcmp1_b32 s44, 15
    s_cbranch_scc1 F_sd
    s_sleep 4
    s_branch F_sc
F_sd:
    s_andn2_b32 s60, s60, 0x8000
    v_writelane_b32 v12, s60, 0
    s_andn2_b32 s61, s61, 0x8000
    v_writelane_b32 v12, s61, 1
    s_andn2_b32 s62, s62, 0x8000
    v_writelane_b32 v12, s62, 2
    s_andn2_b32 s63, s63, 0x8000
    v_writelane_b32 v12, s63, 3
    s_andn2_b32 s64, s64, 0x8000
    v_writelane_b32 v12, s64, 4
    s_andn2_b32 s65, s65, 0x8000
    v_writelane_b32 v12, s65, 5
    s_andn2_b32 s66, s66, 0x8000
    v_writelane_b32 v12, s66, 6
    s_andn2_b32 s67, s67, 0x8000
    v_writelane_b32 v12, s67, 7
    v_add_u32 v4, 158976, v3
    s_mov_b64 exec, 0xff
    ds_write_b32 v4, v12
    s_mov_b64 exec, -1
    v_mov_b32 v4, 1
    s_mov_b64 exec, 1
    ds_write_b32 v10, v4 offset:48
    s_mov_b64 exec, -1
F_se:
    v_mov_b32 v4, 159096
    ds_read_b32 v9, v4 offset:0
FW_127:
    s_waitcnt lgkmcnt(0)
    v_cmp_gt_u32 vcc, 1, v9
    s_cbranch_vccz FO_128
    s_sleep 1
    ds_read_b32 v9, v4 offset:0
    s_branch FW_127
FO_128:
    v_and_b32 v4, 7, v0
    v_lshlrev_b32 v4, 2, v4
    v_add_u32 v4, 158976, v4
    ds_read_b32 v4, v4
    s_waitcnt lgkmcnt(0)
    v_and_b32 v4, 0x7ff, v4
    v_sub_u32 v4, 2047, v4
    v_and_b32 v11, 7, v4
    v_lshrrev_b32 v9, 3, v4
    v_lshlrev_b32 v9, 7, v9
    v_lshl_add_u32 v9, v11, 3, v9
    v_lshlrev_b32 v4, 11, v4
    v_lshl_add_u32 v4, v5, 4, v4
    buffer_load_dwordx4 v[64:67], v4, s[20:23], s55 offen
    buffer_load_dwordx4 v[68:71], v4, s[20:23], s55 offen offset:64
    buffer_load_dwordx2 v[14:15], v9, s[40:43], 0 offen sc0 sc1

F_xd:
    s_mov_b32 s52, 0x05040100
    s_mov_b32 s53, 0x07060302
    s_setprio 1
    s_cmp_ge_u32 s89, 224
    s_cbranch_scc1 F_adown
    s_waitcnt vmcnt(0)
    v_lshlrev_b32 v34, 16, v64
    v_and_b32 v35, 0xffff0000, v64
    v_lshlrev_b32 v36, 16, v65
    v_and_b32 v37, 0xffff0000, v65
    v_lshlrev_b32 v38, 16, v66
    v_and_b32 v39, 0xffff0000, v66
    v_lshlrev_b32 v40, 16, v67
    v_and_b32 v41, 0xffff0000, v67
    v_lshlrev_b32 v42, 16, v68
    v_and_b32 v43, 0xffff0000, v68
    v_lshlrev_b32 v44, 16, v69
    v_and_b32 v45, 0xffff0000, v69
    v_lshlrev_b32 v46, 16, v70
    v_and_b32 v47, 0xffff0000, v70
    v_lshlrev_b32 v48, 16, v71
    v_and_b32 v49, 0xffff0000, v71
    v_add_f32 v34, v34, v14
    v_add_f32 v35, v35, v14
    v_add_f32 v36, v36, v14
    v_add_f32 v37, v37, v14
    v_add_f32 v38, v38, v14
    v_add_f32 v39, v39, v14
    v_add_f32 v40, v40, v14
    v_add_f32 v41, v41, v14
    v_add_f32 v42, v42, v14
    v_add_f32 v43, v43, v14
    v_add_f32 v44, v44, v14
    v_add_f32 v45, v45, v14
    v_add_f32 v46, v46, v14
    v_add_f32 v47, v47, v14
    v_add_f32 v48, v48, v14
    v_add_f32 v49, v49, v14
    v_cvt_pk_bf16_f32 v64, v34, v35
    v_cvt_pk_bf16_f32 v65, v36, v37
    v_cvt_pk_bf16_f32 v66, v38, v39
    v_cvt_pk_bf16_f32 v67, v40, v41
    v_cvt_pk_bf16_f32 v68, v42, v43
    v_cvt_pk_bf16_f32 v69, v44, v45
    v_cvt_pk_bf16_f32 v70, v46, v47
    v_cvt_pk_bf16_f32 v71, v48, v49
    v_lshlrev_b32 v34, 16, v64
    v_and_b32 v35, 0xffff0000, v64
    v_lshlrev_b32 v36, 16, v65
    v_and_b32 v37, 0xffff0000, v65
    v_lshlrev_b32 v38, 16, v66
    v_and_b32 v39, 0xffff0000, v66
    v_lshlrev_b32 v40, 16, v67
    v_and_b32 v41, 0xffff0000, v67
    v_lshlrev_b32 v42, 16, v68
    v_and_b32 v43, 0xffff0000, v68
    v_lshlrev_b32 v44, 16, v69
    v_and_b32 v45, 0xffff0000, v69
    v_lshlrev_b32 v46, 16, v70
    v_and_b32 v47, 0xffff0000, v70
    v_lshlrev_b32 v48, 16, v71
    v_and_b32 v49, 0xffff0000, v71
    v_mul_f32 v34, v34, v15
    v_mul_f32 v35, v35, v15
    v_mul_f32 v36, v36, v15
    v_mul_f32 v37, v37, v15
    v_mul_f32 v38, v38, v15
    v_mul_f32 v39, v39, v15
    v_mul_f32 v40, v40, v15
    v_mul_f32 v41, v41, v15
    v_mul_f32 v42, v42, v15
    v_mul_f32 v43, v43, v15
    v_mul_f32 v44, v44, v15
    v_mul_f32 v45, v45, v15
    v_mul_f32 v46, v46, v15
    v_mul_f32 v47, v47, v15
    v_mul_f32 v48, v48, v15
    v_mul_f32 v49, v49, v15
    v_cvt_pk_bf16_f32 v64, v34, v35
    v_cvt_pk_bf16_f32 v65, v36, v37
    v_cvt_pk_bf16_f32 v66, v38, v39
    v_cvt_pk_bf16_f32 v67, v40, v41
    v_cvt_pk_bf16_f32 v68, v42, v43
    v_cvt_pk_bf16_f32 v69, v44, v45
    v_cvt_pk_bf16_f32 v70, v46, v47
    v_cvt_pk_bf16_f32 v71, v48, v49
    s_waitcnt vmcnt(0)
    v_perm_b32 v136, v76, v72, s52
    v_perm_b32 v137, v84, v80, s52
    v_perm_b32 v138, v92, v88, s52
    v_perm_b32 v139, v100, v96, s52
    s_nop 1
    v_mfma_f32_16x16x32_bf16 v[32:35], v[64:67], v[136:139], 0
    v_perm_b32 v140, v76, v72, s53
    v_perm_b32 v141, v84, v80, s53
    v_perm_b32 v142, v92, v88, s53
    v_perm_b32 v143, v100, v96, s53
    s_nop 1
    v_mfma_f32_16x16x32_bf16 v[36:39], v[64:67], v[140:143], 0
    v_perm_b32 v136, v77, v73, s52
    v_perm_b32 v137, v85, v81, s52
    v_perm_b32 v138, v93, v89, s52
    v_perm_b32 v139, v101, v97, s52
    s_nop 1
    v_mfma_f32_16x16x32_bf16 v[40:43], v[64:67], v[136:139], 0
    v_perm_b32 v140, v77, v73, s53
    v_perm_b32 v141, v85, v81, s53
    v_perm_b32 v142, v93, v89, s53
    v_perm_b32 v143, v101, v97, s53
    s_nop 1
    v_mfma_f32_16x16x32_bf16 v[44:47], v[64:67], v[140:143], 0
    v_perm_b32 v136, v78, v74, s52
    v_perm_b32 v137, v86, v82, s52
    v_perm_b32 v138, v94, v90, s52
    v_perm_b32 v139, v102, v98, s52
    s_nop 1
    v_mfma_f32_16x16x32_bf16 v[48:51], v[64:67], v[136:139], 0
    v_perm_b32 v140, v78, v74, s53
    v_perm_b32 v141, v86, v82, s53
    v_perm_b32 v142, v94, v90, s53
    v_perm_b32 v143, v102, v98, s53
    s_nop 1
    v_mfma_f32_16x16x32_bf16 v[52:55], v[64:67], v[140:143], 0
    v_perm_b32 v136, v79, v75, s52
    v_perm_b32 v137, v87, v83, s52
    v_perm_b32 v138, v95, v91, s52
    v_perm_b32 v139, v103, v99, s52
    s_nop 1
    v_mfma_f32_16x16x32_bf16 v[56:59], v[64:67], v[136:139], 0
    v_perm_b32 v140, v79, v75, s53
    v_perm_b32 v141, v87, v83, s53
    v_perm_b32 v142, v95, v91, s53
    v_perm_b32 v143, v103, v99, s53
    s_nop 1
    v_mfma_f32_16x16x32_bf16 v[60:63], v[64:67], v[140:143], 0
    s_waitcnt vmcnt(0)
    v_perm_b32 v136, v108, v104, s52
    v_perm_b32 v137, v116, v112, s52
    v_perm_b32 v138, v124, v120, s52
    v_perm_b32 v139, v132, v128, s52
    s_nop 1
    v_mfma_f32_16x16x32_bf16 v[32:35], v[68:71], v[136:139], v[32:35]
    v_perm_b32 v140, v108, v104, s53
    v_perm_b32 v141, v116, v112, s53
    v_perm_b32 v142, v124, v120, s53
    v_perm_b32 v143, v132, v128, s53
    s_nop 1
    v_mfma_f32_16x16x32_bf16 v[36:39], v[68:71], v[140:143], v[36:39]
    v_perm_b32 v136, v109, v105, s52
    v_perm_b32 v137, v117, v113, s52
    v_perm_b32 v138, v125, v121, s52
    v_perm_b32 v139, v133, v129, s52
    s_nop 1
    v_mfma_f32_16x16x32_bf16 v[40:43], v[68:71], v[136:139], v[40:43]
    v_perm_b32 v140, v109, v105, s53
    v_perm_b32 v141, v117, v113, s53
    v_perm_b32 v142, v125, v121, s53
    v_perm_b32 v143, v133, v129, s53
    s_nop 1
    v_mfma_f32_16x16x32_bf16 v[44:47], v[68:71], v[140:143], v[44:47]
    v_perm_b32 v136, v110, v106, s52
    v_perm_b32 v137, v118, v114, s52
    v_perm_b32 v138, v126, v122, s52
    v_perm_b32 v139, v134, v130, s52
    s_nop 1
    v_mfma_f32_16x16x32_bf16 v[48:51], v[68:71], v[136:139], v[48:51]
    v_perm_b32 v140, v110, v106, s53
    v_perm_b32 v141, v118, v114, s53
    v_perm_b32 v142, v126, v122, s53
    v_perm_b32 v143, v134, v130, s53
    s_nop 1
    v_mfma_f32_16x16x32_bf16 v[52:55], v[68:71], v[140:143], v[52:55]
    v_perm_b32 v136, v111, v107, s52
    v_perm_b32 v137, v119, v115, s52
    v_perm_b32 v138, v127, v123, s52
    v_perm_b32 v139, v135, v131, s52
    s_nop 1
    v_mfma_f32_16x16x32_bf16 v[56:59], v[68:71], v[136:139], v[56:59]
    v_perm_b32 v140, v111, v107, s53
    v_perm_b32 v141, v119, v115, s53
    v_perm_b32 v142, v127, v123, s53
    v_perm_b32 v143, v135, v131, s53
    s_nop 1
    v_mfma_f32_16x16x32_bf16 v[60:63], v[68:71], v[140:143], v[60:63]
    s_setprio 3
    s_and_b32 s44, s3, 1
    s_lshl_b32 s44, s44, 12
    s_add_u32 s44, s44, 65536
    v_xor_b32 v4, v7, v5
    v_lshlrev_b32 v4, 4, v4
    v_lshl_add_u32 v4, v5, 8, v4
    v_add_u32 v72, s44, v4
    v_add_u32 v8, 8, v10

    v_xor_b32 v73, 32, v72
    v_xor_b32 v74, 64, v72
    v_xor_b32 v75, 96, v72
    v_xor_b32 v76, 128, v72
    v_xor_b32 v77, 160, v72
    v_xor_b32 v78, 192, v72
    v_xor_b32 v79, 224, v72
    ds_read_b32 v12, v13 offset:32
FW_129:
    s_waitcnt lgkmcnt(0)
    v_cmp_gt_u32 vcc, 2, v12
    s_cbranch_vccz FO_130
    s_sleep 1
    ds_read_b32 v12, v13 offset:32
    s_branch FW_129
FO_130:
    s_add_u32 s45, s78, 0
    buffer_load_dwordx4 v[16:19], v160, s[80:83], s45 offen nt
    s_add_u32 s45, s78, 2048
    buffer_load_dwordx4 v[20:23], v160, s[80:83], s45 offen nt
    s_add_u32 s45, s78, 4096
    buffer_load_dwordx4 v[24:27], v160, s[80:83], s45 offen nt
    s_add_u32 s45, s78, 6144
    buffer_load_dwordx4 v[28:31], v160, s[80:83], s45 offen nt
    s_add_u32 s45, s78, 8192
    buffer_load_dwordx4 v[144:147], v160, s[80:83], s45 offen nt
    s_add_u32 s45, s78, 10240
    buffer_load_dwordx4 v[148:151], v160, s[80:83], s45 offen nt
    s_add_u32 s45, s78, 12288
    buffer_load_dwordx4 v[152:155], v160, s[80:83], s45 offen nt
    s_cmp_lt_u32 s3, 2
    s_cbranch_scc1 F_t1
    ds_read_b32 v12, v13 offset:32
FW_131:
    s_waitcnt lgkmcnt(0)
    v_cmp_gt_u32 vcc, 2, v12
    s_cbranch_vccz FO_132
    s_sleep 1
    ds_read_b32 v12, v13 offset:32
    s_branch FW_131
FO_132:
    s_branch F_t2
F_t1:
    ds_read_b32 v12, v8 offset:64
FW_133:
    s_branch IW_s11
IW_w11:
    s_branch IW_r11
IW_s11:
    s_waitcnt lgkmcnt(0)
    v_cmp_gt_u32 vcc, 1, v12
    s_cbranch_vccz FO_134
    s_sleep 1
    ds_read_b32 v12, v8 offset:64
    s_branch FW_133
FO_134:
    ds_read_b128 v[80:83], v72 offset:0
    ds_read_b128 v[84:87], v73 offset:512
    ds_read_b128 v[88:91], v74 offset:1024
    ds_read_b128 v[92:95], v75 offset:1536
    ds_read_b128 v[96:99], v76 offset:2048
    ds_read_b128 v[100:103], v77 offset:2560
    ds_read_b128 v[104:107], v78 offset:3072
    ds_read_b128 v[108:111], v79 offset:3584
    s_waitcnt lgkmcnt(7)
    v_add_f32 v32, v32, v80
    v_add_f32 v33, v33, v81
    v_add_f32 v34, v34, v82
    v_add_f32 v35, v35, v83
    s_waitcnt lgkmcnt(6)
    v_add_f32 v36, v36, v84
    v_add_f32 v37, v37, v85
    v_add_f32 v38, v38, v86
    v_add_f32 v39, v39, v87
    s_waitcnt lgkmcnt(5)
    v_add_f32 v40, v40, v88
    v_add_f32 v41, v41, v89
    v_add_f32 v42, v42, v90
    v_add_f32 v43, v43, v91
    s_waitcnt lgkmcnt(4)
    v_add_f32 v44, v44, v92
    v_add_f32 v45, v45, v93
    v_add_f32 v46, v46, v94
    v_add_f32 v47, v47, v95
    s_waitcnt lgkmcnt(3)
    v_add_f32 v48, v48, v96
    v_add_f32 v49, v49, v97
    v_add_f32 v50, v50, v98
    v_add_f32 v51, v51, v99
    s_waitcnt lgkmcnt(2)
    v_add_f32 v52, v52, v100
    v_add_f32 v53, v53, v101
    v_add_f32 v54, v54, v102
    v_add_f32 v55, v55, v103
    s_waitcnt lgkmcnt(1)
    v_add_f32 v56, v56, v104
    v_add_f32 v57, v57, v105
    v_add_f32 v58, v58, v106
    v_add_f32 v59, v59, v107
    s_waitcnt lgkmcnt(0)
    v_add_f32 v60, v60, v108
    v_add_f32 v61, v61, v109
    v_add_f32 v62, v62, v110
    v_add_f32 v63, v63, v111
F_t2:
    s_mov_b32 exec_hi, 0
    ds_write_b128 v72, v[32:35] offset:0
    ds_write_b128 v73, v[36:39] offset:512
    ds_write_b128 v74, v[40:43] offset:1024
    ds_write_b128 v75, v[44:47] offset:1536
    ds_write_b128 v76, v[48:51] offset:2048
    ds_write_b128 v77, v[52:55] offset:2560
    ds_write_b128 v78, v[56:59] offset:3072
    ds_write_b128 v79, v[60:63] offset:3584
    s_mov_b64 exec, -1
    v_mov_b32 v4, 1
    s_mov_b64 exec, 1
    ds_write_b32 v10, v4 offset:64
    s_mov_b64 exec, -1
    s_lshl_b32 s44, s3, 2
    v_add_u32 v4, s44, v5
    v_xor_b32 v4, v4, v7
    v_lshlrev_b32 v4, 4, v4
    v_lshl_add_u32 v4, v7, 8, v4
    v_add_u32 v4, 65536, v4
    s_lshl_b32 s44, s3, 10
    s_lshl_b32 s77, s36, 1
    s_add_u32 s77, s77, s37
    s_mul_i32 s77, s77, 114688
    s_lshl_b32 s46, s38, 12
    s_add_u32 s77, s77, s46
    s_add_u32 s77, s77, s44
    s_lshl_b32 s46, s38, 9
    v_mov_b32 v9, 159148
    v_mov_b32 v11, 1

    s_add_u32 s56, s46, 0x829000
    s_add_u32 s56, s72, s56
    s_addc_u32 s57, s73, 0
    ds_read_b32 v12, v13 offset:64
FW_135:
    s_waitcnt lgkmcnt(0)
    v_cmp_gt_u32 vcc, 1, v12
    s_cbranch_vccz FO_136
    ds_read_b32 v12, v13 offset:64
    s_branch FW_135
FO_136:
    ds_read_b128 v[72:75], v4
    ds_read_b128 v[76:79], v4 offset:4096
    s_waitcnt lgkmcnt(0)
    v_add_f32 v72, v72, v76
    v_add_f32 v73, v73, v77
    v_add_f32 v74, v74, v78
    v_add_f32 v75, v75, v79
    buffer_store_dwordx4 v[72:75], v2, s[12:15], s77 offen sc0 sc1
    v_mov_b32 v4, 2
    s_mov_b64 exec, 1
    ds_write_b32 v10, v4 offset:64
    s_mov_b64 exec, -1
    s_waitcnt vmcnt(0)
    s_mov_b64 exec, 1
    ds_add_rtn_u32 v9, v9, v11
    s_waitcnt lgkmcnt(0)
    v_readfirstlane_b32 s44, v9
    s_mov_b64 exec, -1
    s_cmp_lg_u32 s44, 3
    s_cbranch_scc1 F_ad2

    s_mov_b32 s74, 1
    s_atomic_add s74, s[56:57], 0x0
    s_atomic_add s74, s[56:57], 0x80
    s_atomic_add s74, s[56:57], 0x100
    s_atomic_add s74, s[56:57], 0x180
    s_branch F_ad2
F_adown:
    s_add_u32 s45, s78, 0
    buffer_load_dwordx4 v[16:19], v160, s[80:83], s45 offen nt
    s_add_u32 s45, s78, 2048
    buffer_load_dwordx4 v[20:23], v160, s[80:83], s45 offen nt
    s_add_u32 s45, s78, 4096
    buffer_load_dwordx4 v[24:27], v160, s[80:83], s45 offen nt
    s_add_u32 s45, s78, 6144
    buffer_load_dwordx4 v[28:31], v160, s[80:83], s45 offen nt
    s_add_u32 s45, s78, 8192
    buffer_load_dwordx4 v[144:147], v160, s[80:83], s45 offen nt
    s_add_u32 s45, s78, 10240
    buffer_load_dwordx4 v[148:151], v160, s[80:83], s45 offen nt
    s_add_u32 s45, s78, 12288
    buffer_load_dwordx4 v[152:155], v160, s[80:83], s45 offen nt
    v_mov_b32 v4, 2
    s_mov_b64 exec, 1
    ds_write_b32 v10, v4 offset:64
    s_mov_b64 exec, -1
F_ad2:
    s_setprio 3
    v_min_u32 v4, 55, v0
    v_lshlrev_b32 v4, 4, v4
    s_lshl_b32 s38, s47, 5
    s_and_b32 s46, s39, 3
    s_lshr_b32 s44, s47, 7
    s_lshl_b32 s44, s44, 2
    s_add_u32 s44, s44, s46
    s_lshl_b32 s44, s44, 7
    s_add_u32 s45, s47, 111
    s_lshr_b32 s45, s45, 7
    s_lshl_b32 s45, s45, 2
    s_add_u32 s45, s45, s46
    s_lshl_b32 s45, s45, 7
    s_waitcnt lgkmcnt(0)

    s_add_u32 s56, s44, 0x829000
    s_add_u32 s56, s72, s56
    s_addc_u32 s57, s73, 0
    s_add_u32 s58, s45, 0x829000
    s_add_u32 s58, s72, s58
    s_addc_u32 s59, s73, 0
    v_mov_b32 v156, 0
    v_mov_b32 v157, 0
    v_mov_b32 v158, 0
    v_mov_b32 v159, 0
    s_mov_b32 s48, 0xbfb8aa3b
    ds_read_b32 v12, v13 offset:0
FW_137:
    s_waitcnt lgkmcnt(0)
    v_cmp_gt_u32 vcc, 4, v12
    s_cbranch_vccz FO_138
    s_sleep 1
    ds_read_b32 v12, v13 offset:0
    s_branch FW_137
FO_138:
    ds_read_b32 v12, v13 offset:64
FW_139:
    s_waitcnt lgkmcnt(0)
    v_cmp_gt_u32 vcc, 2, v12
    s_cbranch_vccz FO_140
    s_sleep 1
    ds_read_b32 v12, v13 offset:64
    s_branch FW_139
FO_140:
    ds_read_b32 v12, v13 offset:32
FW_141:
    s_waitcnt lgkmcnt(0)
    v_cmp_gt_u32 vcc, 2, v12
    s_cbranch_vccz FO_142
    s_sleep 1
    ds_read_b32 v12, v13 offset:32
    s_branch FW_141
FO_142:
    s_mov_b32 s44, s75
    v_lshlrev_b32 v9, 3, v0
    v_add_u32 v9, s44, v9
    ds_write_b64 v9, v[156:157]
    v_lshrrev_b32 v11, 1, v0
    v_mul_u32_u24 v9, 37, v11
    v_lshrrev_b32 v9, 8, v9
    v_add_u32 v11, v11, v9
    v_lshlrev_b32 v11, 1, v11
    v_and_b32 v9, 1, v0
    v_lshl_add_u32 v11, v9, 8, v11
    v_add_u32 v11, s44, v11
    v_and_b32 v9, 7, v0
    v_lshlrev_b32 v9, 6, v9
    v_lshl_add_u32 v9, v5, 4, v9
    v_add_u32 v9, s44, v9

    s_cmp_lg_u32 s3, 0
    s_cbranch_scc1 F_pp
SP_143:
    s_load_dword s76, s[56:57], 0 glc
    s_waitcnt lgkmcnt(0)
    s_cmp_ge_u32 s76, 8
    s_cbranch_scc1 SD_144
    s_sleep 2
    s_branch SP_143
SD_144:
SP_145:
    s_load_dword s76, s[58:59], 0 glc
    s_waitcnt lgkmcnt(0)
    s_cmp_ge_u32 s76, 8
    s_cbranch_scc1 SD_146
    s_sleep 2
    s_branch SP_145
SD_146:
    v_mov_b32 v12, 3
    s_mov_b64 exec, 1
    ds_write_b32 v10, v12 offset:64
    s_mov_b64 exec, -1
F_pp:
    v_mov_b32 v8, 159104
    ds_read_b32 v12, v8 offset:0
FW_147:
    s_waitcnt lgkmcnt(0)
    v_cmp_gt_u32 vcc, 3, v12
    s_cbranch_vccz FO_148
    s_sleep 1
    ds_read_b32 v12, v8 offset:0
    s_branch FW_147
FO_148:
    s_add_u32 s45, s38, 0
    buffer_load_dwordx4 v[32:35], v4, s[12:15], s45 offen sc0 sc1
    s_add_u32 s45, s38, 114688
    buffer_load_dwordx4 v[36:39], v4, s[12:15], s45 offen sc0 sc1
    s_add_u32 s45, s38, 229376
    buffer_load_dwordx4 v[40:43], v4, s[12:15], s45 offen sc0 sc1
    s_add_u32 s45, s38, 344064
    buffer_load_dwordx4 v[44:47], v4, s[12:15], s45 offen sc0 sc1
    s_add_u32 s45, s38, 458752
    buffer_load_dwordx4 v[48:51], v4, s[12:15], s45 offen sc0 sc1
    s_add_u32 s45, s38, 573440
    buffer_load_dwordx4 v[52:55], v4, s[12:15], s45 offen sc0 sc1
    s_add_u32 s45, s38, 688128
    buffer_load_dwordx4 v[56:59], v4, s[12:15], s45 offen sc0 sc1
    s_add_u32 s45, s38, 802816
    buffer_load_dwordx4 v[60:63], v4, s[12:15], s45 offen sc0 sc1
    s_waitcnt vmcnt(0)
    v_add_f32 v32, v32, v40
    v_add_f32 v48, v48, v56
    v_add_f32 v33, v33, v41
    v_add_f32 v49, v49, v57
    v_add_f32 v34, v34, v42
    v_add_f32 v50, v50, v58
    v_add_f32 v35, v35, v43
    v_add_f32 v51, v51, v59
    v_add_f32 v32, v32, v48
    v_add_f32 v33, v33, v49
    v_add_f32 v34, v34, v50
    v_add_f32 v35, v35, v51
    v_add_f32 v36, v36, v44
    v_add_f32 v52, v52, v60
    v_add_f32 v37, v37, v45
    v_add_f32 v53, v53, v61
    v_add_f32 v38, v38, v46
    v_add_f32 v54, v54, v62
    v_add_f32 v39, v39, v47
    v_add_f32 v55, v55, v63
    v_add_f32 v36, v36, v52
    v_add_f32 v37, v37, v53
    v_add_f32 v38, v38, v54
    v_add_f32 v39, v39, v55
    v_cvt_pk_bf16_f32 v40, v32, v36
    v_cvt_pk_bf16_f32 v41, v33, v37
    v_cvt_pk_bf16_f32 v42, v34, v38
    v_cvt_pk_bf16_f32 v43, v35, v39
    v_lshlrev_b32 v32, 16, v40
    v_and_b32 v36, 0xffff0000, v40
    v_lshlrev_b32 v33, 16, v41
    v_and_b32 v37, 0xffff0000, v41
    v_lshlrev_b32 v34, 16, v42
    v_and_b32 v38, 0xffff0000, v42
    v_lshlrev_b32 v35, 16, v43
    v_and_b32 v39, 0xffff0000, v43
    v_mul_f32 v40, s48, v32
    v_mul_f32 v41, s48, v33
    v_mul_f32 v42, s48, v34
    v_mul_f32 v43, s48, v35
    v_exp_f32 v40, v40
    v_exp_f32 v41, v41
    v_exp_f32 v42, v42
    v_exp_f32 v43, v43
    v_add_f32 v40, 1.0, v40
    v_add_f32 v41, 1.0, v41
    v_add_f32 v42, 1.0, v42
    v_add_f32 v43, 1.0, v43
    v_rcp_f32 v40, v40
    v_rcp_f32 v41, v41
    v_rcp_f32 v42, v42
    v_rcp_f32 v43, v43
    v_mul_f32 v32, v32, v40
    v_mul_f32 v33, v33, v41
    v_mul_f32 v34, v34, v42
    v_mul_f32 v35, v35, v43
    v_cvt_pk_bf16_f32 v32, v32, v32
    v_cvt_pk_bf16_f32 v33, v33, v33
    v_cvt_pk_bf16_f32 v34, v34, v34
    v_cvt_pk_bf16_f32 v35, v35, v35
    v_lshlrev_b32 v32, 16, v32
    v_lshlrev_b32 v33, 16, v33
    v_lshlrev_b32 v34, 16, v34
    v_lshlrev_b32 v35, 16, v35
    v_mul_f32 v32, v32, v36
    v_mul_f32 v33, v33, v37
    v_mul_f32 v34, v34, v38
    v_mul_f32 v35, v35, v39
    v_cvt_pk_bf16_f32 v32, v32, v32
    v_cvt_pk_bf16_f32 v33, v33, v33
    v_cvt_pk_bf16_f32 v34, v34, v34
    v_cvt_pk_bf16_f32 v35, v35, v35
    v_cmp_gt_u32 vcc, 56, v0
    s_nop 0
    s_and_saveexec_b64 s[44:45], vcc
    ds_write_b16 v11, v32 offset:0
    ds_write_b16 v11, v33 offset:64
    ds_write_b16 v11, v34 offset:128
    ds_write_b16 v11, v35 offset:192
    s_mov_b64 exec, s[44:45]
    ds_read_b128 v[64:67], v9
    s_waitcnt lgkmcnt(0)
    v_perm_b32 v136, v20, v16, s52
    v_perm_b32 v137, v28, v24, s52
    v_perm_b32 v138, v148, v144, s52
    v_perm_b32 v139, v156, v152, s52
    s_nop 1
    v_mfma_f32_16x16x32_bf16 v[104:107], v[64:67], v[136:139], 0
    v_perm_b32 v140, v20, v16, s53
    v_perm_b32 v141, v28, v24, s53
    v_perm_b32 v142, v148, v144, s53
    v_perm_b32 v143, v156, v152, s53
    s_nop 1
    v_mfma_f32_16x16x32_bf16 v[108:111], v[64:67], v[140:143], 0
    v_perm_b32 v136, v21, v17, s52
    v_perm_b32 v137, v29, v25, s52
    v_perm_b32 v138, v149, v145, s52
    v_perm_b32 v139, v157, v153, s52
    s_nop 1
    v_mfma_f32_16x16x32_bf16 v[112:115], v[64:67], v[136:139], 0
    v_perm_b32 v140, v21, v17, s53
    v_perm_b32 v141, v29, v25, s53
    v_perm_b32 v142, v149, v145, s53
    v_perm_b32 v143, v157, v153, s53
    s_nop 1
    v_mfma_f32_16x16x32_bf16 v[116:119], v[64:67], v[140:143], 0
    v_perm_b32 v136, v22, v18, s52
    v_perm_b32 v137, v30, v26, s52
    v_perm_b32 v138, v150, v146, s52
    v_perm_b32 v139, v158, v154, s52
    s_nop 1
    v_mfma_f32_16x16x32_bf16 v[120:123], v[64:67], v[136:139], 0
    v_perm_b32 v140, v22, v18, s53
    v_perm_b32 v141, v30, v26, s53
    v_perm_b32 v142, v150, v146, s53
    v_perm_b32 v143, v158, v154, s53
    s_nop 1
    v_mfma_f32_16x16x32_bf16 v[124:127], v[64:67], v[140:143], 0
    v_perm_b32 v136, v23, v19, s52
    v_perm_b32 v137, v31, v27, s52
    v_perm_b32 v138, v151, v147, s52
    v_perm_b32 v139, v159, v155, s52
    s_nop 1
    v_mfma_f32_16x16x32_bf16 v[128:131], v[64:67], v[136:139], 0
    v_perm_b32 v140, v23, v19, s53
    v_perm_b32 v141, v31, v27, s53
    v_perm_b32 v142, v151, v147, s53
    v_perm_b32 v143, v159, v155, s53
    s_nop 1
    v_mfma_f32_16x16x32_bf16 v[132:135], v[64:67], v[140:143], 0
    s_mov_b32 s44, s75
    v_and_b32 v4, 1, v5
    v_lshlrev_b32 v4, 11, v4
    v_lshl_add_u32 v4, v7, 5, v4
    v_lshrrev_b32 v8, 1, v5
    v_lshl_add_u32 v4, v8, 4, v4
    v_add_u32 v4, s44, v4
    v_cmp_gt_u32 vcc, 32, v0

    s_nop 1
    v_cndmask_b32 v72, v120, v104, vcc
    v_cndmask_b32 v73, v124, v108, vcc
    v_cndmask_b32 v74, v128, v112, vcc
    v_cndmask_b32 v75, v132, v116, vcc
    ds_write_b128 v4, v[72:75] offset:0
    v_cndmask_b32 v76, v121, v105, vcc
    v_cndmask_b32 v77, v125, v109, vcc
    v_cndmask_b32 v78, v129, v113, vcc
    v_cndmask_b32 v79, v133, v117, vcc
    ds_write_b128 v4, v[76:79] offset:512
    v_cndmask_b32 v80, v122, v106, vcc
    v_cndmask_b32 v81, v126, v110, vcc
    v_cndmask_b32 v82, v130, v114, vcc
    v_cndmask_b32 v83, v134, v118, vcc
    ds_write_b128 v4, v[80:83] offset:1024
    v_cndmask_b32 v84, v123, v107, vcc
    v_cndmask_b32 v85, v127, v111, vcc
    v_cndmask_b32 v86, v131, v115, vcc
    v_cndmask_b32 v87, v135, v119, vcc
    ds_write_b128 v4, v[84:87] offset:1536
    v_mov_b32 v4, 1
    s_mov_b64 exec, 1
    ds_write_b32 v10, v4 offset:80
    s_mov_b64 exec, -1
    ds_read_b32 v12, v13 offset:80
FW_149:
    s_waitcnt lgkmcnt(0)
    v_cmp_gt_u32 vcc, 1, v12
    s_cbranch_vccz FO_150
    s_sleep 1
    ds_read_b32 v12, v13 offset:80
    s_branch FW_149
FO_150:
    s_lshl_b32 s44, s3, 10
    s_add_u32 s44, s44, 32768
    v_add_u32 v4, s44, v3
    ds_read_b32 v32, v4 offset:0
    ds_read_b32 v33, v4 offset:256
    ds_read_b32 v34, v4 offset:512
    ds_read_b32 v35, v4 offset:768
    ds_read_b32 v36, v4 offset:4096
    ds_read_b32 v37, v4 offset:4352
    ds_read_b32 v38, v4 offset:4608
    ds_read_b32 v39, v4 offset:4864
    ds_read_b32 v40, v4 offset:32768
    ds_read_b32 v41, v4 offset:33024
    ds_read_b32 v42, v4 offset:33280
    ds_read_b32 v43, v4 offset:33536
    ds_read_b32 v44, v4 offset:36864
    ds_read_b32 v45, v4 offset:37120
    ds_read_b32 v46, v4 offset:37376
    s_waitcnt lgkmcnt(8)
    ds_read_b32 v47, v4 offset:37632
    s_lshl_b32 s44, s3, 13
    s_lshl_b32 s45, s39, 9
    s_add_u32 s44, s44, s45
    s_add_u32 s44, s44, 135168
    s_add_u32 s45, s44, 4096
    s_lshl_b32 s46, s39, 9
    s_waitcnt lgkmcnt(0)

    s_add_u32 s56, s46, 0x845000
    s_add_u32 s56, s72, s56
    s_addc_u32 s57, s73, 0
    v_add_f32 v32, v32, v36
    v_add_f32 v40, v40, v44
    v_add_f32 v33, v33, v37
    v_add_f32 v41, v41, v45
    v_add_f32 v34, v34, v38
    v_add_f32 v42, v42, v46
    v_add_f32 v35, v35, v39
    v_add_f32 v43, v43, v47
    v_add_f32 v32, v32, v40
    buffer_atomic_add_f32 v32, v3, s[24:27], s44 offen offset:0
    v_add_f32 v33, v33, v41
    buffer_atomic_add_f32 v33, v3, s[24:27], s44 offen offset:256
    v_add_f32 v34, v34, v42
    buffer_atomic_add_f32 v34, v3, s[24:27], s45 offen offset:0
    v_add_f32 v35, v35, v43
    buffer_atomic_add_f32 v35, v3, s[24:27], s45 offen offset:256
    v_mov_b32 v4, 159140
    v_mov_b32 v8, 1
    s_waitcnt vmcnt(0)
    s_mov_b64 exec, 1
    ds_add_rtn_u32 v9, v4, v8
    s_waitcnt lgkmcnt(0)
    v_readfirstlane_b32 s44, v9
    s_mov_b64 exec, -1
    s_cmp_lg_u32 s44, 3
    s_cbranch_scc1 F_ye
    s_mov_b32 s44, 1
    s_atomic_add s44, s[56:57], 0
    s_atomic_add s44, s[56:57], 0x80
    s_atomic_add s44, s[56:57], 0x100
    s_atomic_add s44, s[56:57], 0x180
F_ye:

    s_endpgm
F_codeend:
.section .rodata,"a"
.p2align 6
.amdhsa_kernel parallel_sum__linear_attn_block__moe_arch_mod__prompt_kernel
  .amdhsa_next_free_vgpr 168
  .amdhsa_next_free_sgpr 98
  .amdhsa_accum_offset 168
  .amdhsa_group_segment_fixed_size 0
  .amdhsa_kernarg_size 88
  .amdhsa_user_sgpr_count 2
  .amdhsa_user_sgpr_kernarg_segment_ptr 1
  .amdhsa_system_sgpr_workgroup_id_x 1
  .amdhsa_float_denorm_mode_32 3
  .amdhsa_float_denorm_mode_16_64 3
.end_amdhsa_kernel
```

```asm
; @launch grid=(256,1,1) block=(768,1,1) lds=163840
.amdgcn_target "amdgcn-amd-amdhsa--gfx950"
.text
.globl parallel_sum__linear_attn_block__moe_arch_mod__prompt_kernel
.p2align 12
.p2align 8
.type parallel_sum__linear_attn_block__moe_arch_mod__prompt_kernel,@function
parallel_sum__linear_attn_block__moe_arch_mod__prompt_kernel:
    s_load_dwordx4 s[4:7], s[0:1], 0
    s_load_dwordx2 s[8:9], s[0:1], 16
    s_load_dwordx8 s[60:67], s[0:1], 32
    s_load_dwordx4 s[68:71], s[0:1], 64
    s_load_dwordx2 s[72:73], s[0:1], 80
    s_cmp_ge_u32 s2, 256
    s_cbranch_scc1 F_end
    v_lshrrev_b32 v1, 6, v0
    v_and_b32 v0, 63, v0
    s_and_b32 s30, s2, 7
    v_readfirstlane_b32 s3, v1
    s_lshr_b32 s31, s2, 3
    s_and_b32 s36, s30, 1
    s_lshl_b32 s32, s36, 3
    s_and_b32 s35, s31, 7
    s_add_u32 s32, s32, s35
    s_lshr_b32 s37, s30, 1
    s_lshl_b32 s33, s37, 2
    s_lshr_b32 s34, s31, 3
    s_add_u32 s33, s33, s34
    s_add_u32 s10, s33, 0
    s_and_b32 s10, s10, 15
    s_add_u32 s11, s35, s34
    s_and_b32 s11, s11, 3
    s_and_b32 s28, s32, 11
    s_and_b32 s29, s37, 1
    s_lshl_b32 s29, s29, 2
    s_add_u32 s28, s28, s29
    s_lshr_b32 s29, s37, 1
    s_lshl_b32 s29, s29, 3
    s_and_b32 s38, s35, 4
    s_add_u32 s29, s29, s38
    s_add_u32 s38, s34, 1
    s_and_b32 s38, s38, 3
    s_add_u32 s29, s29, s38

    s_lshl_b32 s11, s34, 1
    s_add_u32 s11, s11, s35
    s_and_b32 s11, s11, 7
    s_mul_i32 s89, s36, 8
    s_mul_i32 s38, s37, 2
    s_add_u32 s89, s89, s38

    s_mov_b32 s94, 0x73156420
    s_mov_b32 s95, 0xfb9dea8c
    s_cmp_eq_u32 s11, 1
    s_cselect_b32 s94, 0x62047531, s94
    s_cselect_b32 s95, 0xea8cfb9d, s95
    s_cmp_eq_u32 s11, 2
    s_cselect_b32 s94, 0x53710642, s94
    s_cselect_b32 s95, 0xdbf9cae8, s95
    s_cmp_eq_u32 s11, 3
    s_cselect_b32 s94, 0x42601753, s94
    s_cselect_b32 s95, 0xcae8dbf9, s95
    s_cmp_eq_u32 s11, 4
    s_cselect_b32 s94, 0x58320164, s94
    s_cselect_b32 s95, 0xfdbec9a7, s95
    s_cmp_eq_u32 s11, 5
    s_cselect_b32 s94, 0x49231075, s94
    s_cselect_b32 s95, 0xecafd8b6, s95
    s_cmp_eq_u32 s11, 6
    s_cselect_b32 s94, 0xa5143206, s94
    s_cselect_b32 s95, 0xfd9ebc87, s95
    s_cmp_eq_u32 s11, 7
    s_cselect_b32 s94, 0xb4052317, s94
    s_cselect_b32 s95, 0xec8fad96, s95
    s_cmp_ge_u32 s3, 8
    s_cbranch_scc1 F_aux
    s_cmp_ge_u32 s3, 4
    s_cbranch_scc1 F_nl
    v_lshrrev_b32 v2, 3, v0
    v_and_b32 v3, 7, v0
    v_lshrrev_b32 v4, 1, v2
    v_xor_b32 v5, v3, v4
    v_xor_b32 v6, 4, v5
    v_lshlrev_b32 v5, 4, v5
    v_lshlrev_b32 v6, 4, v6
    v_lshlrev_b32 v7, 11, v2
    v_add_u32 v5, v5, v7
    v_add_u32 v6, v6, v7
    v_and_b32 v4, 1, v4
    v_lshlrev_b32 v4, 1, v4
    v_xor_b32 v8, v3, v4
    v_xor_b32 v9, 4, v8
    v_lshlrev_b32 v8, 4, v8
    v_lshlrev_b32 v9, 4, v9
    v_mul_u32_u24 v7, 6144, v2
    v_add_u32 v8, v8, v7
    v_add_u32 v9, v9, v7
    v_add_u32 v9, 49152, v9
    s_lshl_b32 s36, s32, 18
    s_lshl_b32 s37, s3, 16
    s_add_u32 s36, s36, s37
    s_lshl_b32 s38, s33, 7
    s_mul_i32 s37, s3, 98304
    s_add_u32 s38, s38, s37
    s_lshl_b32 s47, s10, 7
    s_add_u32 s47, s47, s37
    s_lshl_b32 s44, s3, 12
    s_lshl_b32 s45, s3, 11
    s_add_u32 s43, s45, 1024
    s_mov_b32 s14, 4194304
    s_mov_b32 s15, 0x20000
    s_mov_b32 s18, 6291456
    s_mov_b32 s19, 0x20000
    s_waitcnt lgkmcnt(0)
    s_mov_b32 s12, s4
    s_mov_b32 s13, s5
    s_mov_b32 s16, s6
    s_mov_b32 s17, s7

    s_setprio 3
    s_bfe_u32 s40, s94, 0x40000
    s_add_u32 s40, s89, s40
    s_and_b32 s40, s40, 15
    s_mul_i32 s41, s40, 393216
    s_lshl_b32 s40, s40, 7
    s_add_u32 s40, s40, s36
    s_add_u32 s42, s41, s47
    s_add_u32 s41, s41, s38
    s_add_u32 m0, s44, 0
    s_add_u32 s46, s40, 0
    buffer_load_dwordx4 v5, s[12:15], s46 offen lds
    s_add_u32 m0, s44, 1024
    s_add_u32 s46, s40, 16384
    buffer_load_dwordx4 v6, s[12:15], s46 offen lds
    s_add_u32 m0, s44, 2048
    s_add_u32 s46, s40, 32768
    buffer_load_dwordx4 v5, s[12:15], s46 offen lds
    s_add_u32 m0, s44, 3072
    s_add_u32 s46, s40, 49152
    buffer_load_dwordx4 v6, s[12:15], s46 offen lds
    s_add_u32 m0, s45, 65536
    s_add_u32 s46, s41, 2048
    buffer_load_dwordx4 v8, s[16:19], s46 offen lds
    s_add_u32 m0, s43, 65536
    s_add_u32 s46, s41, 2048
    buffer_load_dwordx4 v9, s[16:19], s46 offen lds
    s_add_u32 m0, s45, 73728
    s_add_u32 s46, s41, 4096
    buffer_load_dwordx4 v8, s[16:19], s46 offen lds
    s_add_u32 m0, s43, 73728
    s_add_u32 s46, s41, 4096
    buffer_load_dwordx4 v9, s[16:19], s46 offen lds
    s_add_u32 m0, s45, 147456
    s_nop 0
    buffer_load_dwordx4 v8, s[16:19], s42 offen lds
    s_add_u32 m0, s43, 147456
    s_nop 0
    buffer_load_dwordx4 v9, s[16:19], s42 offen lds
    s_bfe_u32 s40, s94, 0x40004
    s_add_u32 s40, s89, s40
    s_and_b32 s40, s40, 15
    s_mul_i32 s41, s40, 393216
    s_lshl_b32 s40, s40, 7
    s_add_u32 s40, s40, s36
    s_add_u32 s42, s41, s47
    s_add_u32 s41, s41, s38
    s_add_u32 m0, s44, 16384
    s_add_u32 s46, s40, 0
    buffer_load_dwordx4 v5, s[12:15], s46 offen lds
    s_add_u32 m0, s44, 17408
    s_add_u32 s46, s40, 16384
    buffer_load_dwordx4 v6, s[12:15], s46 offen lds
    s_add_u32 m0, s44, 18432
    s_add_u32 s46, s40, 32768
    buffer_load_dwordx4 v5, s[12:15], s46 offen lds
    s_add_u32 m0, s44, 19456
    s_add_u32 s46, s40, 49152
    buffer_load_dwordx4 v6, s[12:15], s46 offen lds
    s_add_u32 m0, s45, 81920
    s_add_u32 s46, s41, 2048
    buffer_load_dwordx4 v8, s[16:19], s46 offen lds
    s_add_u32 m0, s43, 81920
    s_add_u32 s46, s41, 2048
    buffer_load_dwordx4 v9, s[16:19], s46 offen lds
    v_and_b32 v1, 15, v0
    v_lshrrev_b32 v7, 4, v0
    v_lshrrev_b32 v3, 1, v1
    v_xor_b32 v3, v3, v7
    v_lshlrev_b32 v3, 4, v3
    v_lshlrev_b32 v1, 7, v1
    v_add3_u32 v2, v1, v3, s44
    v_xor_b32 v3, 64, v2
    v_add_u32 v14, 0x10000, v2
    v_add_u32 v15, 0x10000, v3
    v_bfe_u32 v1, v0, 2, 2
    v_lshl_add_u32 v4, v7, 3, v1
    v_lshrrev_b32 v1, 1, v1
    v_and_b32 v7, 1, v7
    v_lshl_add_u32 v1, v7, 1, v1
    v_lshlrev_b32 v1, 5, v1
    v_lshl_add_u32 v1, v4, 7, v1
    v_and_b32 v7, 3, v0
    v_lshl_add_u32 v1, v7, 3, v1
    v_add_u32 v10, 90112, v1
    v_xor_b32 v11, 32, v10
    v_xor_b32 v12, 64, v10
    v_xor_b32 v13, 96, v10
    v_lshlrev_b32 v1, 2, v7
    v_add_u32 v1, 159040, v1
    s_lshl_b32 s50, s3, 2
    s_add_u32 s50, s50, 159040
    v_mov_b32 v4, s50
    v_mov_b32 v164, 1

    s_waitcnt vmcnt(8)
    s_barrier
    s_add_u32 m0, s45, 90112
    s_add_u32 s46, s41, 4096
    buffer_load_dwordx4 v8, s[16:19], s46 offen lds
    ds_read_b128 v[48:51], v2 offset:0
    s_add_u32 m0, s43, 90112
    s_add_u32 s46, s41, 4096
    buffer_load_dwordx4 v9, s[16:19], s46 offen lds
    ds_read_b128 v[52:55], v2 offset:2048
    s_lshl_b32 s51, s32, 4
    s_add_u32 s51, s51, s33
    s_lshl_b32 s51, s51, 14
    s_add_u32 s51, s51, s45
    v_lshlrev_b32 v165, 4, v0
    s_mov_b32 s20, s60
    s_mov_b32 s21, s61
    s_mov_b32 s22, 0x800
    s_mov_b32 s23, 0x00020000
    s_add_u32 m0, s45, 98304
    s_add_u32 s46, s51, 0
    buffer_load_dwordx4 v165, s[12:15], s46 offen lds
    ds_read_b128 v[56:59], v3 offset:0
    s_add_u32 m0, s45, 99328
    s_add_u32 s46, s51, 1024
    buffer_load_dwordx4 v165, s[12:15], s46 offen lds
    ds_read_b128 v[60:63], v3 offset:2048
    s_and_b32 s46, s3, 1
    s_lshl_b32 s46, s46, 10
    s_add_u32 m0, s46, 161792
    s_nop 0
    buffer_load_dwordx4 v165, s[20:23], s46 offen lds
    s_add_u32 m0, s45, 106496
    s_add_u32 s46, s51, 8192
    buffer_load_dwordx4 v165, s[12:15], s46 offen lds
    s_add_u32 m0, s45, 107520
    s_add_u32 s46, s51, 9216
    buffer_load_dwordx4 v165, s[12:15], s46 offen lds
    s_bfe_u32 s40, s94, 0x40008
    s_add_u32 s40, s89, s40
    s_and_b32 s40, s40, 15
    s_mul_i32 s41, s40, 393216
    s_lshl_b32 s40, s40, 7
    s_add_u32 s40, s40, s36
    s_add_u32 s42, s41, s47
    s_add_u32 s41, s41, s38
    s_add_u32 m0, s44, 32768
    s_add_u32 s46, s40, 0
    buffer_load_dwordx4 v5, s[12:15], s46 offen lds
    s_add_u32 m0, s44, 33792
    s_add_u32 s46, s40, 16384
    buffer_load_dwordx4 v6, s[12:15], s46 offen lds
    s_add_u32 m0, s44, 34816
    s_add_u32 s46, s40, 32768
    buffer_load_dwordx4 v5, s[12:15], s46 offen lds
    s_add_u32 m0, s44, 35840
    s_add_u32 s46, s40, 49152
    buffer_load_dwordx4 v6, s[12:15], s46 offen lds
    s_waitcnt vmcnt(9) lgkmcnt(0)
    s_barrier
    s_add_u32 m0, s45, 114688
    s_add_u32 s46, s41, 2048
    buffer_load_dwordx4 v8, s[16:19], s46 offen lds
    ds_read_b64_tr_b16 v[64:65], v10 offset:57344
    ds_read_b64_tr_b16 v[66:67], v10 offset:57856
    s_add_u32 m0, s43, 114688
    s_add_u32 s46, s41, 2048
    buffer_load_dwordx4 v9, s[16:19], s46 offen lds
    ds_read_b128 v[68:71], v2 offset:16384
    s_add_u32 m0, s45, 122880
    s_add_u32 s46, s41, 4096
    buffer_load_dwordx4 v8, s[16:19], s46 offen lds
    ds_read_b64_tr_b16 v[72:73], v11 offset:57344
    ds_read_b64_tr_b16 v[74:75], v11 offset:57856
    s_add_u32 m0, s43, 122880
    s_add_u32 s46, s41, 4096
    buffer_load_dwordx4 v9, s[16:19], s46 offen lds
    ds_read_b128 v[76:79], v2 offset:18432
    s_bfe_u32 s40, s94, 0x40004
    s_add_u32 s40, s89, s40
    s_and_b32 s40, s40, 15
    s_mul_i32 s41, s40, 393216
    s_lshl_b32 s40, s40, 7
    s_add_u32 s40, s40, s36
    s_add_u32 s42, s41, s47
    s_add_u32 s41, s41, s38
    s_add_u32 m0, s45, 139264
    s_nop 0
    buffer_load_dwordx4 v8, s[16:19], s42 offen lds
    ds_read_b64_tr_b16 v[80:81], v12 offset:57344
    ds_read_b64_tr_b16 v[82:83], v12 offset:57856
    s_add_u32 m0, s43, 139264
    s_nop 0
    buffer_load_dwordx4 v9, s[16:19], s42 offen lds
    ds_read_b128 v[84:87], v3 offset:16384
    s_bfe_u32 s40, s94, 0x4000c
    s_add_u32 s40, s89, s40
    s_and_b32 s40, s40, 15
    s_mul_i32 s41, s40, 393216
    s_lshl_b32 s40, s40, 7
    s_add_u32 s40, s40, s36
    s_add_u32 s42, s41, s47
    s_add_u32 s41, s41, s38
    s_add_u32 m0, s44, 49152
    s_add_u32 s46, s40, 0
    buffer_load_dwordx4 v5, s[12:15], s46 offen lds
    ds_read_b64_tr_b16 v[88:89], v13 offset:57344
    ds_read_b64_tr_b16 v[90:91], v13 offset:57856
    s_add_u32 m0, s44, 50176
    s_add_u32 s46, s40, 16384
    buffer_load_dwordx4 v6, s[12:15], s46 offen lds
    ds_read_b128 v[92:95], v3 offset:18432
    s_add_u32 m0, s44, 51200
    s_add_u32 s46, s40, 32768
    buffer_load_dwordx4 v5, s[12:15], s46 offen lds
    s_add_u32 m0, s44, 52224
    s_add_u32 s46, s40, 49152
    buffer_load_dwordx4 v6, s[12:15], s46 offen lds
    s_add_u32 m0, s45, 131072
    s_add_u32 s46, s41, 2048
    buffer_load_dwordx4 v8, s[16:19], s46 offen lds
    s_waitcnt vmcnt(5) lgkmcnt(0)
    s_barrier
    s_add_u32 m0, s43, 131072
    s_add_u32 s46, s41, 2048
    buffer_load_dwordx4 v9, s[16:19], s46 offen lds
    v_mfma_f32_16x16x32_bf16 v[16:19], v[64:67], v[48:51], 0
    ds_read_b64_tr_b16 v[96:97], v10 offset:61440
    ds_read_b64_tr_b16 v[98:99], v10 offset:61952
    s_add_u32 m0, s45, 65536
    s_add_u32 s46, s41, 4096
    buffer_load_dwordx4 v8, s[16:19], s46 offen lds
    v_mfma_f32_16x16x32_bf16 v[32:35], v[64:67], v[52:55], 0
    ds_read_b128 v[100:103], v2 offset:32768
    s_add_u32 m0, s43, 65536
    s_add_u32 s46, s41, 4096
    buffer_load_dwordx4 v9, s[16:19], s46 offen lds
    v_mfma_f32_16x16x32_bf16 v[20:23], v[72:75], v[48:51], 0
    ds_read_b64_tr_b16 v[104:105], v11 offset:61440
    ds_read_b64_tr_b16 v[106:107], v11 offset:61952
    s_bfe_u32 s40, s94, 0x40008
    s_add_u32 s40, s89, s40
    s_and_b32 s40, s40, 15
    s_mul_i32 s41, s40, 393216
    s_lshl_b32 s40, s40, 7
    s_add_u32 s40, s40, s36
    s_add_u32 s42, s41, s47
    s_add_u32 s41, s41, s38
    s_add_u32 m0, s45, 90112
    s_nop 0
    buffer_load_dwordx4 v8, s[16:19], s42 offen lds
    v_mfma_f32_16x16x32_bf16 v[36:39], v[72:75], v[52:55], 0
    ds_read_b128 v[108:111], v2 offset:34816
    s_add_u32 m0, s43, 90112
    s_nop 0
    buffer_load_dwordx4 v9, s[16:19], s42 offen lds
    v_mfma_f32_16x16x32_bf16 v[24:27], v[80:83], v[48:51], 0
    ds_read_b64_tr_b16 v[112:113], v12 offset:61440
    ds_read_b64_tr_b16 v[114:115], v12 offset:61952
    s_bfe_u32 s40, s94, 0x40010
    s_add_u32 s40, s89, s40
    s_and_b32 s40, s40, 15
    s_mul_i32 s41, s40, 393216
    s_lshl_b32 s40, s40, 7
    s_add_u32 s40, s40, s36
    s_add_u32 s42, s41, s47
    s_add_u32 s41, s41, s38
    s_add_u32 m0, s44, 0
    s_add_u32 s46, s40, 0
    buffer_load_dwordx4 v5, s[12:15], s46 offen lds
    v_mfma_f32_16x16x32_bf16 v[40:43], v[80:83], v[52:55], 0
    ds_read_b128 v[116:119], v3 offset:32768
    s_add_u32 m0, s44, 1024
    s_add_u32 s46, s40, 16384
    buffer_load_dwordx4 v6, s[12:15], s46 offen lds
    v_mfma_f32_16x16x32_bf16 v[28:31], v[88:91], v[48:51], 0
    ds_read_b64_tr_b16 v[120:121], v13 offset:61440
    ds_read_b64_tr_b16 v[122:123], v13 offset:61952
    s_add_u32 m0, s44, 2048
    s_add_u32 s46, s40, 32768
    buffer_load_dwordx4 v5, s[12:15], s46 offen lds
    v_mfma_f32_16x16x32_bf16 v[44:47], v[88:91], v[52:55], 0
    ds_read_b128 v[124:127], v3 offset:34816
    s_add_u32 m0, s44, 3072
    s_add_u32 s46, s40, 49152
    buffer_load_dwordx4 v6, s[12:15], s46 offen lds
    ds_read_b64_tr_b16 v[128:129], v10 offset:49152
    ds_read_b64_tr_b16 v[130:131], v10 offset:49664
    s_add_u32 m0, s45, 73728
    s_add_u32 s46, s41, 2048
    buffer_load_dwordx4 v8, s[16:19], s46 offen lds
    ds_read_b64_tr_b16 v[132:133], v11 offset:49152
    s_waitcnt lgkmcnt(8)
    ds_read_b64_tr_b16 v[134:135], v11 offset:49664
    s_add_u32 m0, s43, 73728
    s_add_u32 s46, s41, 2048
    buffer_load_dwordx4 v9, s[16:19], s46 offen lds
    ds_read_b64_tr_b16 v[136:137], v12 offset:49152
    ds_read_b64_tr_b16 v[138:139], v12 offset:49664
    ds_read_b64_tr_b16 v[140:141], v13 offset:49152
    ds_read_b64_tr_b16 v[142:143], v13 offset:49664
    s_waitcnt vmcnt(6) lgkmcnt(0)
    s_barrier
    s_add_u32 m0, s45, 81920
    s_add_u32 s46, s41, 4096
    buffer_load_dwordx4 v8, s[16:19], s46 offen lds
    v_mfma_f32_16x16x32_bf16 v[16:19], v[96:99], v[56:59], v[16:19]
    ds_read_b64_tr_b16 v[144:145], v10 offset:53248
    ds_read_b64_tr_b16 v[146:147], v10 offset:53760
    s_add_u32 m0, s43, 81920
    s_add_u32 s46, s41, 4096
    buffer_load_dwordx4 v9, s[16:19], s46 offen lds
    v_mfma_f32_16x16x32_bf16 v[32:35], v[96:99], v[60:63], v[32:35]
    ds_read_b128 v[148:151], v2 offset:49152
    s_bfe_u32 s40, s94, 0x40014
    s_add_u32 s40, s89, s40
    s_and_b32 s40, s40, 15
    s_mul_i32 s41, s40, 393216
    s_lshl_b32 s40, s40, 7
    s_add_u32 s40, s40, s36
    s_add_u32 s42, s41, s47
    s_add_u32 s41, s41, s38
    s_add_u32 m0, s44, 16384
    s_add_u32 s46, s40, 0
    buffer_load_dwordx4 v5, s[12:15], s46 offen lds
    v_mfma_f32_16x16x32_bf16 v[20:23], v[104:107], v[56:59], v[20:23]
    ds_read_b64_tr_b16 v[152:153], v11 offset:53248
    ds_read_b64_tr_b16 v[154:155], v11 offset:53760
    s_add_u32 m0, s44, 17408
    s_add_u32 s46, s40, 16384
    buffer_load_dwordx4 v6, s[12:15], s46 offen lds
    v_mfma_f32_16x16x32_bf16 v[36:39], v[104:107], v[60:63], v[36:39]
    ds_read_b128 v[156:159], v2 offset:51200
    s_add_u32 m0, s44, 18432
    s_add_u32 s46, s40, 32768
    buffer_load_dwordx4 v5, s[12:15], s46 offen lds
    v_mfma_f32_16x16x32_bf16 v[24:27], v[112:115], v[56:59], v[24:27]
    ds_read_b64_tr_b16 v[160:161], v12 offset:53248
    ds_read_b64_tr_b16 v[162:163], v12 offset:53760
    s_add_u32 m0, s44, 19456
    s_add_u32 s46, s40, 49152
    buffer_load_dwordx4 v6, s[12:15], s46 offen lds
    v_mfma_f32_16x16x32_bf16 v[40:43], v[112:115], v[60:63], v[40:43]
    ds_read_b128 v[64:67], v3 offset:49152
    s_add_u32 m0, s45, 98304
    s_add_u32 s46, s41, 2048
    buffer_load_dwordx4 v8, s[16:19], s46 offen lds
    v_mfma_f32_16x16x32_bf16 v[28:31], v[120:123], v[56:59], v[28:31]
    ds_read_b64_tr_b16 v[72:73], v13 offset:53248
    ds_read_b64_tr_b16 v[74:75], v13 offset:53760
    s_add_u32 m0, s43, 98304
    s_add_u32 s46, s41, 2048
    buffer_load_dwordx4 v9, s[16:19], s46 offen lds
    v_mfma_f32_16x16x32_bf16 v[44:47], v[120:123], v[60:63], v[44:47]
    ds_read_b128 v[80:83], v3 offset:51200
    s_add_u32 m0, s45, 106496
    s_add_u32 s46, s41, 4096
    buffer_load_dwordx4 v8, s[16:19], s46 offen lds
    v_mfma_f32_16x16x32_bf16 v[16:19], v[128:131], v[68:71], v[16:19]
    ds_read_b64_tr_b16 v[48:49], v10 offset:0
    ds_read_b64_tr_b16 v[50:51], v10 offset:512
    s_add_u32 m0, s43, 106496
    s_add_u32 s46, s41, 4096
    buffer_load_dwordx4 v9, s[16:19], s46 offen lds
    v_mfma_f32_16x16x32_bf16 v[32:35], v[128:131], v[76:79], v[32:35]
    ds_read_b64_tr_b16 v[88:89], v11 offset:0
    s_waitcnt lgkmcnt(8)
    ds_read_b64_tr_b16 v[90:91], v11 offset:512
    s_bfe_u32 s40, s94, 0x4000c
    s_add_u32 s40, s89, s40
    s_and_b32 s40, s40, 15
    s_mul_i32 s41, s40, 393216
    s_lshl_b32 s40, s40, 7
    s_add_u32 s40, s40, s36
    s_add_u32 s42, s41, s47
    s_add_u32 s41, s41, s38
    s_add_u32 m0, s45, 147456
    s_nop 0
    buffer_load_dwordx4 v8, s[16:19], s42 offen lds
    v_mfma_f32_16x16x32_bf16 v[20:23], v[132:135], v[68:71], v[20:23]
    ds_read_b64_tr_b16 v[52:53], v12 offset:0
    ds_read_b64_tr_b16 v[54:55], v12 offset:512
    v_mfma_f32_16x16x32_bf16 v[36:39], v[132:135], v[76:79], v[36:39]
    ds_read_b64_tr_b16 v[96:97], v13 offset:0
    ds_read_b64_tr_b16 v[98:99], v13 offset:512
    v_mfma_f32_16x16x32_bf16 v[24:27], v[136:139], v[68:71], v[24:27]
    v_mfma_f32_16x16x32_bf16 v[40:43], v[136:139], v[76:79], v[40:43]
    v_mfma_f32_16x16x32_bf16 v[28:31], v[140:143], v[68:71], v[28:31]
    v_mfma_f32_16x16x32_bf16 v[44:47], v[140:143], v[76:79], v[44:47]
    s_waitcnt vmcnt(9) lgkmcnt(0)
    s_barrier
    s_add_u32 m0, s43, 147456
    s_nop 0
    buffer_load_dwordx4 v9, s[16:19], s42 offen lds
    v_mfma_f32_16x16x32_bf16 v[16:19], v[144:147], v[84:87], v[16:19]
    ds_read_b64_tr_b16 v[104:105], v10 offset:4096
    ds_read_b64_tr_b16 v[106:107], v10 offset:4608
    s_bfe_u32 s40, s94, 0x40018
    s_add_u32 s40, s89, s40
    s_and_b32 s40, s40, 15
    s_mul_i32 s41, s40, 393216
    s_lshl_b32 s40, s40, 7
    s_add_u32 s40, s40, s36
    s_add_u32 s42, s41, s47
    s_add_u32 s41, s41, s38
    s_add_u32 m0, s44, 32768
    s_add_u32 s46, s40, 0
    buffer_load_dwordx4 v5, s[12:15], s46 offen lds
    v_mfma_f32_16x16x32_bf16 v[32:35], v[144:147], v[92:95], v[32:35]
    ds_read_b128 v[112:115], v2 offset:0
    s_add_u32 m0, s44, 33792
    s_add_u32 s46, s40, 16384
    s_branch IW_s0
IW_w0:
    s_branch IW_r0
IW_s0:
    buffer_load_dwordx4 v6, s[12:15], s46 offen lds
    v_mfma_f32_16x16x32_bf16 v[20:23], v[152:155], v[84:87], v[20:23]
    ds_read_b64_tr_b16 v[56:57], v11 offset:4096
    ds_read_b64_tr_b16 v[58:59], v11 offset:4608
    s_add_u32 m0, s44, 34816
    s_add_u32 s46, s40, 32768
    buffer_load_dwordx4 v5, s[12:15], s46 offen lds
    v_mfma_f32_16x16x32_bf16 v[36:39], v[152:155], v[92:95], v[36:39]
    ds_read_b128 v[120:123], v2 offset:2048
    s_add_u32 m0, s44, 35840
    s_add_u32 s46, s40, 49152
    buffer_load_dwordx4 v6, s[12:15], s46 offen lds
    v_mfma_f32_16x16x32_bf16 v[24:27], v[160:163], v[84:87], v[24:27]
    ds_read_b64_tr_b16 v[60:61], v12 offset:4096
    ds_read_b64_tr_b16 v[62:63], v12 offset:4608
    s_add_u32 m0, s45, 114688
    s_add_u32 s46, s41, 2048
    buffer_load_dwordx4 v8, s[16:19], s46 offen lds
    v_mfma_f32_16x16x32_bf16 v[40:43], v[160:163], v[92:95], v[40:43]
    ds_read_b128 v[128:131], v3 offset:0
    s_add_u32 m0, s43, 114688
    s_add_u32 s46, s41, 2048
    buffer_load_dwordx4 v9, s[16:19], s46 offen lds
    v_mfma_f32_16x16x32_bf16 v[28:31], v[72:75], v[84:87], v[28:31]
    ds_read_b64_tr_b16 v[132:133], v13 offset:4096
    ds_read_b64_tr_b16 v[134:135], v13 offset:4608
    s_add_u32 m0, s45, 122880
    s_add_u32 s46, s41, 4096
    buffer_load_dwordx4 v8, s[16:19], s46 offen lds
    v_mfma_f32_16x16x32_bf16 v[44:47], v[72:75], v[92:95], v[44:47]
    ds_read_b128 v[136:139], v3 offset:2048
    s_add_u32 m0, s43, 122880
    s_add_u32 s46, s41, 4096
    buffer_load_dwordx4 v9, s[16:19], s46 offen lds
    v_mfma_f32_16x16x32_bf16 v[16:19], v[48:51], v[100:103], v[16:19]
    s_bfe_u32 s40, s94, 0x4001c
    s_add_u32 s40, s89, s40
    s_and_b32 s40, s40, 15
    s_mul_i32 s41, s40, 393216
    s_lshl_b32 s40, s40, 7
    s_add_u32 s40, s40, s36
    s_add_u32 s42, s41, s47
    s_add_u32 s41, s41, s38
    s_add_u32 m0, s44, 49152
    s_add_u32 s46, s40, 0
    buffer_load_dwordx4 v5, s[12:15], s46 offen lds
    v_mfma_f32_16x16x32_bf16 v[32:35], v[48:51], v[108:111], v[32:35]
    s_add_u32 m0, s44, 50176
    s_add_u32 s46, s40, 16384
    buffer_load_dwordx4 v6, s[12:15], s46 offen lds
    v_mfma_f32_16x16x32_bf16 v[20:23], v[88:91], v[100:103], v[20:23]
    v_mfma_f32_16x16x32_bf16 v[36:39], v[88:91], v[108:111], v[36:39]
    v_mfma_f32_16x16x32_bf16 v[24:27], v[52:55], v[100:103], v[24:27]
    v_mfma_f32_16x16x32_bf16 v[40:43], v[52:55], v[108:111], v[40:43]
    v_mfma_f32_16x16x32_bf16 v[28:31], v[96:99], v[100:103], v[28:31]
    v_mfma_f32_16x16x32_bf16 v[44:47], v[96:99], v[108:111], v[44:47]
    s_waitcnt vmcnt(10) lgkmcnt(0)
    s_barrier
    s_add_u32 m0, s44, 51200
    s_add_u32 s46, s40, 32768
    buffer_load_dwordx4 v5, s[12:15], s46 offen lds
    v_mfma_f32_16x16x32_bf16 v[16:19], v[104:107], v[116:119], v[16:19]
    ds_read_b64_tr_b16 v[68:69], v10 offset:57344
    ds_read_b64_tr_b16 v[70:71], v10 offset:57856
    s_add_u32 m0, s44, 52224
    s_add_u32 s46, s40, 49152
    buffer_load_dwordx4 v6, s[12:15], s46 offen lds
    v_mfma_f32_16x16x32_bf16 v[32:35], v[104:107], v[124:127], v[32:35]
    ds_read_b128 v[140:143], v2 offset:16384
    s_add_u32 m0, s45, 65536
    s_add_u32 s46, s41, 2048
    buffer_load_dwordx4 v8, s[16:19], s46 offen lds
    v_mfma_f32_16x16x32_bf16 v[20:23], v[56:59], v[116:119], v[20:23]
    ds_read_b64_tr_b16 v[76:77], v11 offset:57344
    ds_read_b64_tr_b16 v[78:79], v11 offset:57856
    s_add_u32 m0, s43, 65536
    s_add_u32 s46, s41, 2048
    buffer_load_dwordx4 v9, s[16:19], s46 offen lds
    v_mfma_f32_16x16x32_bf16 v[36:39], v[56:59], v[124:127], v[36:39]
    ds_read_b128 v[144:147], v2 offset:18432
    s_add_u32 m0, s45, 131072
    s_add_u32 s46, s41, 4096
    buffer_load_dwordx4 v8, s[16:19], s46 offen lds
    v_mfma_f32_16x16x32_bf16 v[24:27], v[60:63], v[116:119], v[24:27]
    ds_read_b64_tr_b16 v[152:153], v12 offset:57344
    ds_read_b64_tr_b16 v[154:155], v12 offset:57856
    s_add_u32 m0, s43, 131072
    s_add_u32 s46, s41, 4096
    buffer_load_dwordx4 v9, s[16:19], s46 offen lds
    v_mfma_f32_16x16x32_bf16 v[40:43], v[60:63], v[124:127], v[40:43]
    ds_read_b128 v[160:163], v3 offset:16384
    s_bfe_u32 s40, s94, 0x40010
    s_add_u32 s40, s89, s40
    s_and_b32 s40, s40, 15
    s_mul_i32 s41, s40, 393216
    s_lshl_b32 s40, s40, 7
    s_add_u32 s40, s40, s36
    s_add_u32 s42, s41, s47
    s_add_u32 s41, s41, s38
    s_add_u32 m0, s45, 139264
    s_nop 0
    buffer_load_dwordx4 v8, s[16:19], s42 offen lds
    v_mfma_f32_16x16x32_bf16 v[28:31], v[132:135], v[116:119], v[28:31]
    ds_read_b64_tr_b16 v[84:85], v13 offset:57344
    ds_read_b64_tr_b16 v[86:87], v13 offset:57856
    s_add_u32 m0, s43, 139264
    s_nop 0
    buffer_load_dwordx4 v9, s[16:19], s42 offen lds
    v_mfma_f32_16x16x32_bf16 v[44:47], v[132:135], v[124:127], v[44:47]
    ds_read_b128 v[72:75], v3 offset:18432
    s_bfe_u32 s40, s95, 0x40000
    s_add_u32 s40, s89, s40
    s_and_b32 s40, s40, 15
    s_mul_i32 s41, s40, 393216
    s_lshl_b32 s40, s40, 7
    s_add_u32 s40, s40, s36
    s_add_u32 s42, s41, s47
    s_add_u32 s41, s41, s38
    s_add_u32 m0, s44, 0
    s_add_u32 s46, s40, 0
    buffer_load_dwordx4 v5, s[12:15], s46 offen lds
    s_add_u32 m0, s44, 1024
    s_add_u32 s46, s40, 16384
    buffer_load_dwordx4 v6, s[12:15], s46 offen lds
    s_add_u32 m0, s44, 2048
    s_add_u32 s46, s40, 32768
    buffer_load_dwordx4 v5, s[12:15], s46 offen lds
    s_waitcnt vmcnt(13) lgkmcnt(0)
    s_barrier
    s_add_u32 m0, s44, 3072
    s_add_u32 s46, s40, 49152
    buffer_load_dwordx4 v6, s[12:15], s46 offen lds
    v_mfma_f32_16x16x32_bf16 v[16:19], v[68:71], v[148:151], v[16:19]
    ds_read_b64_tr_b16 v[92:93], v10 offset:61440
    ds_read_b64_tr_b16 v[94:95], v10 offset:61952
    s_add_u32 m0, s45, 73728
    s_add_u32 s46, s41, 2048
    buffer_load_dwordx4 v8, s[16:19], s46 offen lds
    v_mfma_f32_16x16x32_bf16 v[32:35], v[68:71], v[156:159], v[32:35]
    ds_read_b128 v[48:51], v2 offset:32768
    s_add_u32 m0, s43, 73728
    s_add_u32 s46, s41, 2048
    buffer_load_dwordx4 v9, s[16:19], s46 offen lds
    v_mfma_f32_16x16x32_bf16 v[20:23], v[76:79], v[148:151], v[20:23]
    ds_read_b64_tr_b16 v[88:89], v11 offset:61440
    ds_read_b64_tr_b16 v[90:91], v11 offset:61952
    s_add_u32 m0, s45, 81920
    s_add_u32 s46, s41, 4096
    buffer_load_dwordx4 v8, s[16:19], s46 offen lds
    v_mfma_f32_16x16x32_bf16 v[36:39], v[76:79], v[156:159], v[36:39]
    ds_read_b128 v[52:55], v2 offset:34816
    s_add_u32 m0, s43, 81920
    s_add_u32 s46, s41, 4096
    buffer_load_dwordx4 v9, s[16:19], s46 offen lds
    v_mfma_f32_16x16x32_bf16 v[24:27], v[152:155], v[148:151], v[24:27]
    ds_read_b64_tr_b16 v[100:101], v12 offset:61440
    ds_read_b64_tr_b16 v[102:103], v12 offset:61952
    s_bfe_u32 s40, s95, 0x40004
    s_add_u32 s40, s89, s40
    s_and_b32 s40, s40, 15
    s_mul_i32 s41, s40, 393216
    s_lshl_b32 s40, s40, 7
    s_add_u32 s40, s40, s36
    s_add_u32 s42, s41, s47
    s_add_u32 s41, s41, s38
    s_add_u32 m0, s44, 16384
    s_add_u32 s46, s40, 0
    buffer_load_dwordx4 v5, s[12:15], s46 offen lds
    v_mfma_f32_16x16x32_bf16 v[40:43], v[152:155], v[156:159], v[40:43]
    ds_read_b128 v[96:99], v3 offset:32768
    s_add_u32 m0, s44, 17408
    s_add_u32 s46, s40, 16384
    buffer_load_dwordx4 v6, s[12:15], s46 offen lds
    v_mfma_f32_16x16x32_bf16 v[28:31], v[84:87], v[148:151], v[28:31]
    ds_read_b64_tr_b16 v[108:109], v13 offset:61440
    ds_read_b64_tr_b16 v[110:111], v13 offset:61952
    s_add_u32 m0, s44, 18432
    s_add_u32 s46, s40, 32768
    buffer_load_dwordx4 v5, s[12:15], s46 offen lds
    v_mfma_f32_16x16x32_bf16 v[44:47], v[84:87], v[156:159], v[44:47]
    ds_read_b128 v[104:107], v3 offset:34816
    s_add_u32 m0, s44, 19456
    s_add_u32 s46, s40, 49152
    buffer_load_dwordx4 v6, s[12:15], s46 offen lds
    s_add_u32 m0, s45, 90112
    s_add_u32 s46, s41, 2048
    buffer_load_dwordx4 v8, s[16:19], s46 offen lds
    s_add_u32 m0, s43, 90112
    s_add_u32 s46, s41, 2048
    buffer_load_dwordx4 v9, s[16:19], s46 offen lds
    s_waitcnt vmcnt(14) lgkmcnt(0)
    s_barrier
    s_add_u32 m0, s45, 98304
    s_add_u32 s46, s41, 4096
    buffer_load_dwordx4 v8, s[16:19], s46 offen lds
    v_mfma_f32_16x16x32_bf16 v[16:19], v[92:95], v[64:67], v[16:19]
    ds_read_b64_tr_b16 v[56:57], v10 offset:49152
    ds_read_b64_tr_b16 v[58:59], v10 offset:49664
    s_add_u32 m0, s43, 98304
    s_add_u32 s46, s41, 4096
    buffer_load_dwordx4 v9, s[16:19], s46 offen lds
    v_mfma_f32_16x16x32_bf16 v[32:35], v[92:95], v[80:83], v[32:35]
    ds_read_b128 v[60:63], v2 offset:49152
    s_bfe_u32 s40, s94, 0x40014
    s_add_u32 s40, s89, s40
    s_and_b32 s40, s40, 15
    s_mul_i32 s41, s40, 393216
    s_lshl_b32 s40, s40, 7
    s_add_u32 s40, s40, s36
    s_add_u32 s42, s41, s47
    s_add_u32 s41, s41, s38
    s_add_u32 m0, s45, 106496
    s_nop 0
    buffer_load_dwordx4 v8, s[16:19], s42 offen lds
    v_mfma_f32_16x16x32_bf16 v[20:23], v[88:91], v[64:67], v[20:23]
    ds_read_b64_tr_b16 v[116:117], v11 offset:49152
    ds_read_b64_tr_b16 v[118:119], v11 offset:49664
    s_add_u32 m0, s43, 106496
    s_nop 0
    buffer_load_dwordx4 v9, s[16:19], s42 offen lds
    v_mfma_f32_16x16x32_bf16 v[36:39], v[88:91], v[80:83], v[36:39]
    ds_read_b128 v[132:135], v2 offset:51200
    s_bfe_u32 s40, s95, 0x40008
    s_add_u32 s40, s89, s40
    s_and_b32 s40, s40, 15
    s_mul_i32 s41, s40, 393216
    s_lshl_b32 s40, s40, 7
    s_add_u32 s40, s40, s36
    s_add_u32 s42, s41, s47
    s_add_u32 s41, s41, s38
    s_add_u32 m0, s44, 32768
    s_add_u32 s46, s40, 0
    buffer_load_dwordx4 v5, s[12:15], s46 offen lds
    v_mfma_f32_16x16x32_bf16 v[24:27], v[100:103], v[64:67], v[24:27]
    ds_read_b64_tr_b16 v[124:125], v12 offset:49152
    ds_read_b64_tr_b16 v[126:127], v12 offset:49664
    s_add_u32 m0, s44, 33792
    s_add_u32 s46, s40, 16384
    buffer_load_dwordx4 v6, s[12:15], s46 offen lds
    v_mfma_f32_16x16x32_bf16 v[40:43], v[100:103], v[80:83], v[40:43]
    ds_read_b128 v[68:71], v3 offset:49152
    s_add_u32 m0, s44, 34816
    s_add_u32 s46, s40, 32768
    buffer_load_dwordx4 v5, s[12:15], s46 offen lds
    v_mfma_f32_16x16x32_bf16 v[28:31], v[108:111], v[64:67], v[28:31]
    ds_read_b64_tr_b16 v[76:77], v13 offset:49152
    ds_read_b64_tr_b16 v[78:79], v13 offset:49664
    s_add_u32 m0, s44, 35840
    s_add_u32 s46, s40, 49152
    buffer_load_dwordx4 v6, s[12:15], s46 offen lds
    v_mfma_f32_16x16x32_bf16 v[44:47], v[108:111], v[80:83], v[44:47]
    ds_read_b128 v[152:155], v3 offset:51200
    s_add_u32 m0, s45, 114688
    s_add_u32 s46, s41, 2048
    buffer_load_dwordx4 v8, s[16:19], s46 offen lds
    s_add_u32 m0, s43, 114688
    s_add_u32 s46, s41, 2048
    buffer_load_dwordx4 v9, s[16:19], s46 offen lds
    s_add_u32 m0, s45, 122880
    s_add_u32 s46, s41, 4096
    buffer_load_dwordx4 v8, s[16:19], s46 offen lds
    s_waitcnt vmcnt(17) lgkmcnt(0)
    s_barrier
    s_add_u32 m0, s43, 122880
    s_add_u32 s46, s41, 4096
    buffer_load_dwordx4 v9, s[16:19], s46 offen lds
    v_mfma_f32_16x16x32_bf16 v[16:19], v[56:59], v[112:115], v[16:19]
    ds_read_b64_tr_b16 v[148:149], v10 offset:53248
    ds_read_b64_tr_b16 v[150:151], v10 offset:53760
    s_bfe_u32 s40, s95, 0x4000c
    s_add_u32 s40, s89, s40
    s_and_b32 s40, s40, 15
    s_mul_i32 s41, s40, 393216
    s_lshl_b32 s40, s40, 7
    s_add_u32 s40, s40, s36
    s_add_u32 s42, s41, s47
    s_add_u32 s41, s41, s38
    s_add_u32 m0, s44, 49152
    s_add_u32 s46, s40, 0
    buffer_load_dwordx4 v5, s[12:15], s46 offen lds
    v_mfma_f32_16x16x32_bf16 v[32:35], v[56:59], v[120:123], v[32:35]
    ds_read_b128 v[84:87], v2 offset:0
    s_add_u32 m0, s44, 50176
    s_add_u32 s46, s40, 16384
    buffer_load_dwordx4 v6, s[12:15], s46 offen lds
    v_mfma_f32_16x16x32_bf16 v[20:23], v[116:119], v[112:115], v[20:23]
    ds_read_b64_tr_b16 v[156:157], v11 offset:53248
    ds_read_b64_tr_b16 v[158:159], v11 offset:53760
    s_add_u32 m0, s44, 51200
    s_add_u32 s46, s40, 32768
    buffer_load_dwordx4 v5, s[12:15], s46 offen lds
    v_mfma_f32_16x16x32_bf16 v[36:39], v[116:119], v[120:123], v[36:39]
    ds_read_b128 v[92:95], v2 offset:2048
    s_add_u32 m0, s44, 52224
    s_add_u32 s46, s40, 49152
    buffer_load_dwordx4 v6, s[12:15], s46 offen lds
    v_mfma_f32_16x16x32_bf16 v[24:27], v[124:127], v[112:115], v[24:27]
    ds_read_b64_tr_b16 v[88:89], v12 offset:53248
    ds_read_b64_tr_b16 v[90:91], v12 offset:53760
    s_add_u32 m0, s45, 65536
    s_add_u32 s46, s41, 2048
    buffer_load_dwordx4 v8, s[16:19], s46 offen lds
    v_mfma_f32_16x16x32_bf16 v[40:43], v[124:127], v[120:123], v[40:43]
    ds_read_b128 v[100:103], v3 offset:0
    s_add_u32 m0, s43, 65536
    s_add_u32 s46, s41, 2048
    buffer_load_dwordx4 v9, s[16:19], s46 offen lds
    v_mfma_f32_16x16x32_bf16 v[28:31], v[76:79], v[112:115], v[28:31]
    ds_read_b64_tr_b16 v[64:65], v13 offset:53248
    ds_read_b64_tr_b16 v[66:67], v13 offset:53760
    s_add_u32 m0, s45, 131072
    s_add_u32 s46, s41, 4096
    buffer_load_dwordx4 v8, s[16:19], s46 offen lds
    v_mfma_f32_16x16x32_bf16 v[44:47], v[76:79], v[120:123], v[44:47]
    ds_read_b128 v[108:111], v3 offset:2048
    s_add_u32 m0, s43, 131072
    s_add_u32 s46, s41, 4096
    buffer_load_dwordx4 v9, s[16:19], s46 offen lds
    s_waitcnt vmcnt(16) lgkmcnt(0)
    s_barrier
    s_bfe_u32 s40, s95, 0x40010
    s_add_u32 s40, s89, s40
    s_and_b32 s40, s40, 15
    s_mul_i32 s41, s40, 393216
    s_lshl_b32 s40, s40, 7
    s_add_u32 s40, s40, s36
    s_add_u32 s42, s41, s47
    s_add_u32 s41, s41, s38
    s_add_u32 m0, s44, 0
    s_add_u32 s46, s40, 0
    buffer_load_dwordx4 v5, s[12:15], s46 offen lds
    v_mfma_f32_16x16x32_bf16 v[16:19], v[148:151], v[128:131], v[16:19]
    ds_read_b64_tr_b16 v[80:81], v10 offset:16384
    ds_read_b64_tr_b16 v[82:83], v10 offset:16896
    s_add_u32 m0, s44, 1024
    s_add_u32 s46, s40, 16384
    buffer_load_dwordx4 v6, s[12:15], s46 offen lds
    v_mfma_f32_16x16x32_bf16 v[32:35], v[148:151], v[136:139], v[32:35]
    ds_read_b128 v[56:59], v2 offset:16384
    s_add_u32 m0, s44, 2048
    s_add_u32 s46, s40, 32768
    buffer_load_dwordx4 v5, s[12:15], s46 offen lds
    v_mfma_f32_16x16x32_bf16 v[20:23], v[156:159], v[128:131], v[20:23]
    ds_read_b64_tr_b16 v[116:117], v11 offset:16384
    ds_read_b64_tr_b16 v[118:119], v11 offset:16896
    s_add_u32 m0, s44, 3072
    s_add_u32 s46, s40, 49152
    buffer_load_dwordx4 v6, s[12:15], s46 offen lds
    v_mfma_f32_16x16x32_bf16 v[36:39], v[156:159], v[136:139], v[36:39]
    ds_read_b128 v[124:127], v2 offset:18432
    s_add_u32 m0, s45, 73728
    s_add_u32 s46, s41, 2048
    buffer_load_dwordx4 v8, s[16:19], s46 offen lds
    v_mfma_f32_16x16x32_bf16 v[24:27], v[88:91], v[128:131], v[24:27]
    ds_read_b64_tr_b16 v[112:113], v12 offset:16384
    ds_read_b64_tr_b16 v[114:115], v12 offset:16896
    s_add_u32 m0, s43, 73728
    s_add_u32 s46, s41, 2048
    buffer_load_dwordx4 v9, s[16:19], s46 offen lds
    v_mfma_f32_16x16x32_bf16 v[40:43], v[88:91], v[136:139], v[40:43]
    ds_read_b128 v[76:79], v3 offset:16384
    s_add_u32 m0, s45, 81920
    s_add_u32 s46, s41, 4096
    buffer_load_dwordx4 v8, s[16:19], s46 offen lds
    v_mfma_f32_16x16x32_bf16 v[28:31], v[64:67], v[128:131], v[28:31]
    ds_read_b64_tr_b16 v[120:121], v13 offset:16384
    ds_read_b64_tr_b16 v[122:123], v13 offset:16896
    s_add_u32 m0, s43, 81920
    s_add_u32 s46, s41, 4096
    buffer_load_dwordx4 v9, s[16:19], s46 offen lds
    v_mfma_f32_16x16x32_bf16 v[44:47], v[64:67], v[136:139], v[44:47]
    ds_read_b128 v[148:151], v3 offset:18432
    s_waitcnt vmcnt(16) lgkmcnt(0)
    s_barrier
    s_bfe_u32 s40, s95, 0x40014
    s_add_u32 s40, s89, s40
    s_and_b32 s40, s40, 15
    s_mul_i32 s41, s40, 393216
    s_lshl_b32 s40, s40, 7
    s_add_u32 s40, s40, s36
    s_add_u32 s42, s41, s47
    s_add_u32 s41, s41, s38
    s_add_u32 m0, s44, 16384
    s_add_u32 s46, s40, 0
    buffer_load_dwordx4 v5, s[12:15], s46 offen lds
    v_mfma_f32_16x16x32_bf16 v[16:19], v[80:83], v[140:143], v[16:19]
    ds_read_b64_tr_b16 v[156:157], v10 offset:20480
    ds_read_b64_tr_b16 v[158:159], v10 offset:20992
    s_add_u32 m0, s44, 17408
    s_add_u32 s46, s40, 16384
    buffer_load_dwordx4 v6, s[12:15], s46 offen lds
    v_mfma_f32_16x16x32_bf16 v[32:35], v[80:83], v[144:147], v[32:35]
    ds_read_b128 v[88:91], v2 offset:32768
    s_add_u32 m0, s44, 18432
    s_add_u32 s46, s40, 32768
    buffer_load_dwordx4 v5, s[12:15], s46 offen lds
    v_mfma_f32_16x16x32_bf16 v[20:23], v[116:119], v[140:143], v[20:23]
    ds_read_b64_tr_b16 v[128:129], v11 offset:20480
    ds_read_b64_tr_b16 v[130:131], v11 offset:20992
    s_add_u32 m0, s44, 19456
    s_add_u32 s46, s40, 49152
    buffer_load_dwordx4 v6, s[12:15], s46 offen lds
    v_mfma_f32_16x16x32_bf16 v[36:39], v[116:119], v[144:147], v[36:39]
    ds_read_b128 v[64:67], v2 offset:34816
    s_add_u32 m0, s45, 90112
    s_add_u32 s46, s41, 2048
    buffer_load_dwordx4 v8, s[16:19], s46 offen lds
    v_mfma_f32_16x16x32_bf16 v[24:27], v[112:115], v[140:143], v[24:27]
    ds_read_b64_tr_b16 v[136:137], v12 offset:20480
    ds_read_b64_tr_b16 v[138:139], v12 offset:20992
    s_add_u32 m0, s43, 90112
    s_add_u32 s46, s41, 2048
    buffer_load_dwordx4 v9, s[16:19], s46 offen lds
    v_mfma_f32_16x16x32_bf16 v[40:43], v[112:115], v[144:147], v[40:43]
    ds_read_b128 v[80:83], v3 offset:32768
    s_add_u32 m0, s45, 98304
    s_add_u32 s46, s41, 4096
    buffer_load_dwordx4 v8, s[16:19], s46 offen lds
    v_mfma_f32_16x16x32_bf16 v[28:31], v[120:123], v[140:143], v[28:31]
    ds_read_b64_tr_b16 v[116:117], v13 offset:20480
    ds_read_b64_tr_b16 v[118:119], v13 offset:20992
    s_add_u32 m0, s43, 98304
    s_add_u32 s46, s41, 4096
    buffer_load_dwordx4 v9, s[16:19], s46 offen lds
    v_mfma_f32_16x16x32_bf16 v[44:47], v[120:123], v[144:147], v[44:47]
    ds_read_b128 v[112:115], v3 offset:34816
    s_waitcnt vmcnt(16) lgkmcnt(0)
    s_barrier
    s_bfe_u32 s40, s95, 0x40018
    s_add_u32 s40, s89, s40
    s_and_b32 s40, s40, 15
    s_mul_i32 s41, s40, 393216
    s_lshl_b32 s40, s40, 7
    s_add_u32 s40, s40, s36
    s_add_u32 s42, s41, s47
    s_add_u32 s41, s41, s38
    s_add_u32 m0, s44, 32768
    s_add_u32 s46, s40, 0
    buffer_load_dwordx4 v5, s[12:15], s46 offen lds
    v_mfma_f32_16x16x32_bf16 v[16:19], v[156:159], v[160:163], v[16:19]
    ds_read_b128 v[140:143], v2 offset:49152
    s_add_u32 m0, s44, 33792
    s_add_u32 s46, s40, 16384
    buffer_load_dwordx4 v6, s[12:15], s46 offen lds
    v_mfma_f32_16x16x32_bf16 v[32:35], v[156:159], v[72:75], v[32:35]
    ds_read_b128 v[120:123], v2 offset:51200
    s_add_u32 m0, s44, 34816
    s_add_u32 s46, s40, 32768
    buffer_load_dwordx4 v5, s[12:15], s46 offen lds
    v_mfma_f32_16x16x32_bf16 v[20:23], v[128:131], v[160:163], v[20:23]
    ds_read_b128 v[144:147], v3 offset:49152
    s_add_u32 m0, s44, 35840
    s_add_u32 s46, s40, 49152
    buffer_load_dwordx4 v6, s[12:15], s46 offen lds
    v_mfma_f32_16x16x32_bf16 v[36:39], v[128:131], v[72:75], v[36:39]
    ds_read_b128 v[156:159], v3 offset:51200
    s_add_u32 m0, s45, 106496
    s_add_u32 s46, s41, 2048
    buffer_load_dwordx4 v8, s[16:19], s46 offen lds
    v_mfma_f32_16x16x32_bf16 v[24:27], v[136:139], v[160:163], v[24:27]
    s_add_u32 m0, s43, 106496
    s_add_u32 s46, s41, 2048
    buffer_load_dwordx4 v9, s[16:19], s46 offen lds
    v_mfma_f32_16x16x32_bf16 v[40:43], v[136:139], v[72:75], v[40:43]
    s_add_u32 m0, s45, 114688
    s_add_u32 s46, s41, 4096
    buffer_load_dwordx4 v8, s[16:19], s46 offen lds
    v_mfma_f32_16x16x32_bf16 v[28:31], v[116:119], v[160:163], v[28:31]
    s_add_u32 m0, s43, 114688
    s_add_u32 s46, s41, 4096
    buffer_load_dwordx4 v9, s[16:19], s46 offen lds
    v_mfma_f32_16x16x32_bf16 v[44:47], v[116:119], v[72:75], v[44:47]
    s_waitcnt vmcnt(16) lgkmcnt(0)
    s_barrier
    s_bfe_u32 s40, s95, 0x4001c
    s_add_u32 s40, s89, s40
    s_and_b32 s40, s40, 15
    s_mul_i32 s41, s40, 393216
    s_lshl_b32 s40, s40, 7
    s_add_u32 s40, s40, s36
    s_add_u32 s42, s41, s47
    s_add_u32 s41, s41, s38
    s_add_u32 m0, s44, 49152
    s_add_u32 s46, s40, 0
    buffer_load_dwordx4 v5, s[12:15], s46 offen lds
    s_add_u32 m0, s44, 50176
    s_add_u32 s46, s40, 16384
    buffer_load_dwordx4 v6, s[12:15], s46 offen lds
    s_add_u32 m0, s44, 51200
    s_add_u32 s46, s40, 32768
    buffer_load_dwordx4 v5, s[12:15], s46 offen lds
    s_add_u32 m0, s44, 52224
    s_add_u32 s46, s40, 49152
    buffer_load_dwordx4 v6, s[12:15], s46 offen lds
    s_add_u32 m0, s45, 65536
    s_add_u32 s46, s41, 2048
    buffer_load_dwordx4 v8, s[16:19], s46 offen lds
    s_add_u32 m0, s43, 65536
    s_add_u32 s46, s41, 2048
    buffer_load_dwordx4 v9, s[16:19], s46 offen lds
    s_add_u32 m0, s45, 122880
    s_add_u32 s46, s41, 4096
    buffer_load_dwordx4 v8, s[16:19], s46 offen lds
    s_add_u32 m0, s43, 122880
    s_add_u32 s46, s41, 4096
    buffer_load_dwordx4 v9, s[16:19], s46 offen lds
    s_waitcnt vmcnt(16)
    s_barrier
    s_bfe_u32 s40, s94, 0x40018
    s_add_u32 s40, s89, s40
    s_and_b32 s40, s40, 15
    s_mul_i32 s41, s40, 393216
    s_lshl_b32 s40, s40, 7
    s_add_u32 s40, s40, s36
    s_add_u32 s42, s41, s47
    s_add_u32 s41, s41, s38
    s_add_u32 m0, s45, 147456
    s_nop 0
    buffer_load_dwordx4 v8, s[16:19], s42 offen lds
    s_add_u32 m0, s43, 147456
    s_nop 0
    buffer_load_dwordx4 v9, s[16:19], s42 offen lds
    s_waitcnt vmcnt(10)
    s_barrier
    s_bfe_u32 s40, s95, 0x40010
    s_add_u32 s40, s89, s40
    s_and_b32 s40, s40, 15
    s_mul_i32 s41, s40, 393216
    s_lshl_b32 s40, s40, 7
    s_add_u32 s40, s40, s36
    s_add_u32 s42, s41, s47
    s_add_u32 s41, s41, s38
    s_add_u32 m0, s45, 139264
    s_nop 0
    buffer_load_dwordx4 v8, s[16:19], s42 offen lds
    s_add_u32 m0, s43, 139264
    s_nop 0
    buffer_load_dwordx4 v9, s[16:19], s42 offen lds
    s_waitcnt vmcnt(4)
    s_barrier
    s_bfe_u32 s40, s95, 0x40014
    s_add_u32 s40, s89, s40
    s_and_b32 s40, s40, 15
    s_mul_i32 s41, s40, 393216
    s_lshl_b32 s40, s40, 7
    s_add_u32 s40, s40, s36
    s_add_u32 s42, s41, s47
    s_add_u32 s41, s41, s38
    s_add_u32 m0, s45, 131072
    s_nop 0
    buffer_load_dwordx4 v8, s[16:19], s42 offen lds
    s_add_u32 m0, s43, 131072
    s_nop 0
    buffer_load_dwordx4 v9, s[16:19], s42 offen lds
    s_waitcnt vmcnt(6)
    s_barrier
    s_bfe_u32 s40, s95, 0x40018
    s_add_u32 s40, s89, s40
    s_and_b32 s40, s40, 15
    s_mul_i32 s41, s40, 393216
    s_lshl_b32 s40, s40, 7
    s_add_u32 s40, s40, s36
    s_add_u32 s42, s41, s47
    s_add_u32 s41, s41, s38
    s_add_u32 m0, s45, 81920
    s_nop 0
    buffer_load_dwordx4 v8, s[16:19], s42 offen lds
    s_add_u32 m0, s43, 81920
    s_nop 0
    buffer_load_dwordx4 v9, s[16:19], s42 offen lds
    s_bfe_u32 s40, s95, 0x4001c
    s_add_u32 s40, s89, s40
    s_and_b32 s40, s40, 15
    s_mul_i32 s41, s40, 393216
    s_lshl_b32 s40, s40, 7
    s_add_u32 s40, s40, s36
    s_add_u32 s42, s41, s47
    s_add_u32 s41, s41, s38
    s_add_u32 m0, s45, 73728
    s_nop 0
    buffer_load_dwordx4 v8, s[16:19], s42 offen lds
    s_add_u32 m0, s43, 73728
    s_nop 0
    s_branch IW_s1
IW_w1:
    s_branch IW_r1
IW_s1:
    buffer_load_dwordx4 v9, s[16:19], s42 offen lds
    s_bfe_u32 s40, s94, 0x4001c
    s_add_u32 s40, s89, s40
    s_and_b32 s40, s40, 15
    s_mul_i32 s41, s40, 393216
    s_lshl_b32 s40, s40, 7
    s_add_u32 s40, s40, s36
    s_add_u32 s42, s41, s47
    s_add_u32 s41, s41, s38
    s_add_u32 m0, s45, 98304
    s_nop 0
    buffer_load_dwordx4 v8, s[16:19], s42 offen lds
    s_add_u32 m0, s43, 98304
    s_nop 0
    buffer_load_dwordx4 v9, s[16:19], s42 offen lds
    s_bfe_u32 s40, s95, 0x40000
    s_add_u32 s40, s89, s40
    s_and_b32 s40, s40, 15
    s_mul_i32 s41, s40, 393216
    s_lshl_b32 s40, s40, 7
    s_add_u32 s40, s40, s36
    s_add_u32 s42, s41, s47
    s_add_u32 s41, s41, s38
    s_add_u32 m0, s45, 90112
    s_nop 0
    buffer_load_dwordx4 v8, s[16:19], s42 offen lds
    s_add_u32 m0, s43, 90112
    s_nop 0
    buffer_load_dwordx4 v9, s[16:19], s42 offen lds
    s_bfe_u32 s40, s95, 0x40004
    s_add_u32 s40, s89, s40
    s_and_b32 s40, s40, 15
    s_mul_i32 s41, s40, 393216
    s_lshl_b32 s40, s40, 7
    s_add_u32 s40, s40, s36
    s_add_u32 s42, s41, s47
    s_add_u32 s41, s41, s38
    s_add_u32 m0, s45, 114688
    s_nop 0
    buffer_load_dwordx4 v8, s[16:19], s42 offen lds
    s_add_u32 m0, s43, 114688
    s_nop 0
    buffer_load_dwordx4 v9, s[16:19], s42 offen lds
    s_bfe_u32 s40, s95, 0x40008
    s_add_u32 s40, s89, s40
    s_and_b32 s40, s40, 15
    s_mul_i32 s41, s40, 393216
    s_lshl_b32 s40, s40, 7
    s_add_u32 s40, s40, s36
    s_add_u32 s42, s41, s47
    s_add_u32 s41, s41, s38
    s_add_u32 m0, s45, 106496
    s_nop 0
    buffer_load_dwordx4 v8, s[16:19], s42 offen lds
    s_add_u32 m0, s43, 106496
    s_nop 0
    buffer_load_dwordx4 v9, s[16:19], s42 offen lds
    s_bfe_u32 s40, s95, 0x4000c
    s_add_u32 s40, s89, s40
    s_and_b32 s40, s40, 15
    s_mul_i32 s41, s40, 393216
    s_lshl_b32 s40, s40, 7
    s_add_u32 s40, s40, s36
    s_add_u32 s42, s41, s47
    s_add_u32 s41, s41, s38
    s_add_u32 m0, s45, 122880
    s_nop 0
    buffer_load_dwordx4 v8, s[16:19], s42 offen lds
    s_add_u32 m0, s43, 122880
    s_nop 0
    buffer_load_dwordx4 v9, s[16:19], s42 offen lds
    s_setprio 1
    v_subrev_u32 v5, 24576, v10
    v_subrev_u32 v6, 24576, v11
    v_subrev_u32 v8, 24576, v12
    v_subrev_u32 v9, 24576, v13
    s_add_u32 s16, s72, 0x400000
    s_addc_u32 s17, s73, 0
    s_mov_b32 s18, 0x400000
    s_mov_b32 s19, 0x00020000
    s_add_u32 s24, s72, 0x800000
    s_addc_u32 s25, s73, 0
    s_mov_b32 s26, 0x48000
    s_mov_b32 s27, 0x00020000
    s_mov_b32 s40, 0x21317218
    s_mov_b32 s41, s40
    s_mov_b32 s74, 0x358637bd
    s_mov_b32 s75, s74
    s_mov_b32 s76, 0x5d800000
    s_mov_b32 s77, s76
    v_and_b32 v14, 15, v0
    v_lshlrev_b32 v14, 2, v14
    s_lshl_b32 s42, s3, 7
    s_add_u32 s42, s42, 155648
    v_add_u32 v14, s42, v14
    v_and_b32 v15, 0x30, v0
    v_add_u32 v15, 158208, v15
    v_and_b32 v165, 0xfffffff7, v1
    s_lshl_b32 s79, s32, 18
    s_lshl_b32 s80, s3, 16
    s_add_u32 s79, s79, s80
    s_lshl_b32 s80, s10, 11
    s_add_u32 s79, s79, s80
    s_add_u32 s80, s79, 0x8000
    s_lshl_b32 s45, s32, 2
    s_add_u32 s45, s45, s3
    s_lshl_b32 s45, s45, 10
    s_mov_b32 s46, 0x3fb8aa3b

    s_add_u32 s54, s45, 0x835000
    s_add_u32 s54, s72, s54
    s_addc_u32 s55, s73, 0
    ds_read_b32 v7, v165 offset:48
FW_1:
    s_waitcnt lgkmcnt(0)
    v_cmp_gt_u32 vcc, 1, v7
    s_cbranch_vccz FO_2
    s_sleep 1
    ds_read_b32 v7, v165 offset:48
    s_branch FW_1
FO_2:
    ds_read2_b32 v[72:73], v14 offset0:0 offset1:0
    ds_read2_b32 v[74:75], v14 offset0:16 offset1:16
    ds_read_b128 v[128:131], v15 offset:0
    ds_read_b128 v[136:139], v15 offset:64
    ds_read_b128 v[160:163], v15 offset:128
    ds_read_b128 v[116:119], v15 offset:192
    v_add_u32 v14, 1024, v14
    s_waitcnt lgkmcnt(3)
    v_pk_fma_f32 v[16:17], v[128:129], v[72:73], v[16:17]
    v_pk_fma_f32 v[18:19], v[130:131], v[72:73], v[18:19]
    v_pk_fma_f32 v[32:33], v[128:129], v[74:75], v[32:33]
    v_pk_fma_f32 v[34:35], v[130:131], v[74:75], v[34:35]
    s_waitcnt lgkmcnt(2)
    v_pk_fma_f32 v[20:21], v[136:137], v[72:73], v[20:21]
    v_pk_fma_f32 v[22:23], v[138:139], v[72:73], v[22:23]
    v_pk_fma_f32 v[36:37], v[136:137], v[74:75], v[36:37]
    v_pk_fma_f32 v[38:39], v[138:139], v[74:75], v[38:39]
    s_waitcnt lgkmcnt(1)
    v_pk_fma_f32 v[24:25], v[160:161], v[72:73], v[24:25]
    v_pk_fma_f32 v[26:27], v[162:163], v[72:73], v[26:27]
    v_pk_fma_f32 v[40:41], v[160:161], v[74:75], v[40:41]
    v_pk_fma_f32 v[42:43], v[162:163], v[74:75], v[42:43]
    s_waitcnt lgkmcnt(0)
    v_pk_fma_f32 v[28:29], v[116:117], v[72:73], v[28:29]
    v_pk_fma_f32 v[30:31], v[118:119], v[72:73], v[30:31]
    v_pk_fma_f32 v[44:45], v[116:117], v[74:75], v[44:45]
    v_pk_fma_f32 v[46:47], v[118:119], v[74:75], v[46:47]
    s_waitcnt vmcnt(8)
    s_mov_b64 exec, 1
    ds_add_u32 v4, v164 offset:112
    s_mov_b64 exec, -1
    ds_read_b32 v7, v1 offset:32
FW_3:
    s_waitcnt lgkmcnt(0)
    v_cmp_gt_u32 vcc, 1, v7
    s_cbranch_vccz FO_4
    s_sleep 2
    ds_read_b32 v7, v1 offset:32
    s_branch FW_3
FO_4:
    ds_read_b32 v7, v1 offset:112
FW_5:
    s_waitcnt lgkmcnt(0)
    v_cmp_gt_u32 vcc, 1, v7
    s_cbranch_vccz FO_6
    ds_read_b32 v7, v1 offset:112
    s_branch FW_5
FO_6:
    ds_read_b64_tr_b16 v[128:129], v10 offset:57344
    ds_read_b64_tr_b16 v[130:131], v10 offset:57856
    ds_read_b64_tr_b16 v[136:137], v11 offset:57344
    ds_read_b64_tr_b16 v[138:139], v11 offset:57856
    ds_read_b64_tr_b16 v[160:161], v12 offset:57344
    ds_read_b64_tr_b16 v[162:163], v12 offset:57856
    ds_read_b64_tr_b16 v[116:117], v13 offset:57344
    ds_read_b64_tr_b16 v[118:119], v13 offset:57856
    ds_read_b64_tr_b16 v[72:73], v10 offset:61440
    ds_read_b64_tr_b16 v[74:75], v10 offset:61952
    s_waitcnt lgkmcnt(8)
    v_mfma_f32_16x16x32_bf16 v[16:19], v[128:131], v[48:51], v[16:19]
    v_mfma_f32_16x16x32_bf16 v[32:35], v[128:131], v[52:55], v[32:35]
    ds_read_b64_tr_b16 v[128:129], v11 offset:61440
    ds_read_b64_tr_b16 v[130:131], v11 offset:61952
    s_waitcnt lgkmcnt(8)
    v_mfma_f32_16x16x32_bf16 v[20:23], v[136:139], v[48:51], v[20:23]
    v_mfma_f32_16x16x32_bf16 v[36:39], v[136:139], v[52:55], v[36:39]
    ds_read_b64_tr_b16 v[136:137], v12 offset:61440
    ds_read_b64_tr_b16 v[138:139], v12 offset:61952
    s_waitcnt lgkmcnt(8)
    v_mfma_f32_16x16x32_bf16 v[24:27], v[160:163], v[48:51], v[24:27]
    v_mfma_f32_16x16x32_bf16 v[40:43], v[160:163], v[52:55], v[40:43]
    ds_read_b64_tr_b16 v[160:161], v13 offset:61440
    ds_read_b64_tr_b16 v[162:163], v13 offset:61952
    s_waitcnt lgkmcnt(8)
    v_mfma_f32_16x16x32_bf16 v[28:31], v[116:119], v[48:51], v[28:31]
    ds_read_b128 v[48:51], v2 offset:0
    v_mfma_f32_16x16x32_bf16 v[44:47], v[116:119], v[52:55], v[44:47]
    ds_read_b64_tr_b16 v[116:117], v10 offset:49152
    ds_read_b64_tr_b16 v[118:119], v10 offset:49664
    s_waitcnt lgkmcnt(9)
    v_mfma_f32_16x16x32_bf16 v[16:19], v[72:75], v[96:99], v[16:19]
    ds_read_b128 v[52:55], v2 offset:2048
    v_mfma_f32_16x16x32_bf16 v[32:35], v[72:75], v[104:107], v[32:35]
    ds_read_b64_tr_b16 v[72:73], v11 offset:49152
    ds_read_b64_tr_b16 v[74:75], v11 offset:49664
    s_waitcnt lgkmcnt(10)
    v_mfma_f32_16x16x32_bf16 v[20:23], v[128:131], v[96:99], v[20:23]
    v_mfma_f32_16x16x32_bf16 v[36:39], v[128:131], v[104:107], v[36:39]
    ds_read_b64_tr_b16 v[128:129], v12 offset:49152
    ds_read_b64_tr_b16 v[130:131], v12 offset:49664
    s_waitcnt lgkmcnt(10)
    v_mfma_f32_16x16x32_bf16 v[24:27], v[136:139], v[96:99], v[24:27]
    v_mfma_f32_16x16x32_bf16 v[40:43], v[136:139], v[104:107], v[40:43]
    ds_read_b64_tr_b16 v[136:137], v13 offset:49152
    ds_read_b64_tr_b16 v[138:139], v13 offset:49664
    s_waitcnt lgkmcnt(10)
    v_mfma_f32_16x16x32_bf16 v[28:31], v[160:163], v[96:99], v[28:31]
    ds_read_b128 v[96:99], v3 offset:0
    v_mfma_f32_16x16x32_bf16 v[44:47], v[160:163], v[104:107], v[44:47]
    ds_read_b64_tr_b16 v[160:161], v10 offset:53248
    ds_read_b64_tr_b16 v[162:163], v10 offset:53760
    s_waitcnt lgkmcnt(10)
    v_mfma_f32_16x16x32_bf16 v[16:19], v[116:119], v[48:51], v[16:19]
    ds_read_b128 v[104:107], v3 offset:2048
    s_waitcnt lgkmcnt(10)
    v_mfma_f32_16x16x32_bf16 v[32:35], v[116:119], v[52:55], v[32:35]
    ds_read_b64_tr_b16 v[116:117], v11 offset:53248
    ds_read_b64_tr_b16 v[118:119], v11 offset:53760
    s_waitcnt lgkmcnt(10)
    v_mfma_f32_16x16x32_bf16 v[20:23], v[72:75], v[48:51], v[20:23]
    v_mfma_f32_16x16x32_bf16 v[36:39], v[72:75], v[52:55], v[36:39]
    ds_read_b64_tr_b16 v[72:73], v12 offset:53248
    ds_read_b64_tr_b16 v[74:75], v12 offset:53760
    s_waitcnt lgkmcnt(10)
    v_mfma_f32_16x16x32_bf16 v[24:27], v[128:131], v[48:51], v[24:27]
    v_mfma_f32_16x16x32_bf16 v[40:43], v[128:131], v[52:55], v[40:43]
    ds_read_b64_tr_b16 v[128:129], v13 offset:53248
    ds_read_b64_tr_b16 v[130:131], v13 offset:53760
    s_waitcnt lgkmcnt(10)
    v_mfma_f32_16x16x32_bf16 v[28:31], v[136:139], v[48:51], v[28:31]
    ds_read_b128 v[48:51], v2 offset:16384
    v_mfma_f32_16x16x32_bf16 v[44:47], v[136:139], v[52:55], v[44:47]
    ds_read_b64_tr_b16 v[136:137], v10 offset:40960
    ds_read_b64_tr_b16 v[138:139], v10 offset:41472
    s_waitcnt lgkmcnt(10)
    v_mfma_f32_16x16x32_bf16 v[16:19], v[160:163], v[96:99], v[16:19]
    ds_read_b128 v[52:55], v2 offset:18432
    s_waitcnt lgkmcnt(10)
    v_mfma_f32_16x16x32_bf16 v[32:35], v[160:163], v[104:107], v[32:35]
    ds_read_b64_tr_b16 v[160:161], v11 offset:40960
    ds_read_b64_tr_b16 v[162:163], v11 offset:41472
    s_waitcnt lgkmcnt(10)
    v_mfma_f32_16x16x32_bf16 v[20:23], v[116:119], v[96:99], v[20:23]
    v_mfma_f32_16x16x32_bf16 v[36:39], v[116:119], v[104:107], v[36:39]
    ds_read_b64_tr_b16 v[116:117], v12 offset:40960
    ds_read_b64_tr_b16 v[118:119], v12 offset:41472
    s_waitcnt lgkmcnt(8)
    v_mov_b32 v165, 2
    s_mov_b64 exec, 1
    ds_write_b32 v4, v165 offset:0
    s_mov_b64 exec, -1
    v_mfma_f32_16x16x32_bf16 v[24:27], v[72:75], v[96:99], v[24:27]
    v_mfma_f32_16x16x32_bf16 v[40:43], v[72:75], v[104:107], v[40:43]
    ds_read_b64_tr_b16 v[72:73], v13 offset:40960
    ds_read_b64_tr_b16 v[74:75], v13 offset:41472
    v_mfma_f32_16x16x32_bf16 v[28:31], v[128:131], v[96:99], v[28:31]
    ds_read_b128 v[96:99], v3 offset:16384
    v_mfma_f32_16x16x32_bf16 v[44:47], v[128:131], v[104:107], v[44:47]
    ds_read_b64_tr_b16 v[128:129], v10 offset:45056
    ds_read_b64_tr_b16 v[130:131], v10 offset:45568
    s_waitcnt lgkmcnt(11)
    v_mfma_f32_16x16x32_bf16 v[16:19], v[136:139], v[48:51], v[16:19]
    ds_read_b128 v[104:107], v3 offset:18432
    s_waitcnt lgkmcnt(11)
    v_mfma_f32_16x16x32_bf16 v[32:35], v[136:139], v[52:55], v[32:35]
    ds_read_b64_tr_b16 v[136:137], v11 offset:45056
    ds_read_b64_tr_b16 v[138:139], v11 offset:45568
    s_waitcnt lgkmcnt(11)
    v_mfma_f32_16x16x32_bf16 v[20:23], v[160:163], v[48:51], v[20:23]
    v_mfma_f32_16x16x32_bf16 v[36:39], v[160:163], v[52:55], v[36:39]
    ds_read_b64_tr_b16 v[160:161], v12 offset:45056
    ds_read_b64_tr_b16 v[162:163], v12 offset:45568
    s_waitcnt lgkmcnt(11)
    v_mfma_f32_16x16x32_bf16 v[24:27], v[116:119], v[48:51], v[24:27]
    v_mfma_f32_16x16x32_bf16 v[40:43], v[116:119], v[52:55], v[40:43]
    ds_read_b64_tr_b16 v[116:117], v13 offset:45056
    ds_read_b64_tr_b16 v[118:119], v13 offset:45568
    s_waitcnt lgkmcnt(10)
    v_mfma_f32_16x16x32_bf16 v[28:31], v[72:75], v[48:51], v[28:31]
    ds_read_b128 v[48:51], v2 offset:32768
    v_mfma_f32_16x16x32_bf16 v[44:47], v[72:75], v[52:55], v[44:47]
    ds_read_b64_tr_b16 v[72:73], v5 offset:16384
    ds_read_b64_tr_b16 v[74:75], v5 offset:16896
    s_waitcnt lgkmcnt(10)
    v_mfma_f32_16x16x32_bf16 v[16:19], v[128:131], v[96:99], v[16:19]
    ds_read_b128 v[52:55], v2 offset:34816
    s_waitcnt lgkmcnt(10)
    v_mfma_f32_16x16x32_bf16 v[32:35], v[128:131], v[104:107], v[32:35]
    ds_read_b64_tr_b16 v[128:129], v6 offset:16384
    ds_read_b64_tr_b16 v[130:131], v6 offset:16896
    s_waitcnt lgkmcnt(10)
    v_mfma_f32_16x16x32_bf16 v[20:23], v[136:139], v[96:99], v[20:23]
    v_mfma_f32_16x16x32_bf16 v[36:39], v[136:139], v[104:107], v[36:39]
    ds_read_b64_tr_b16 v[136:137], v8 offset:16384
    ds_read_b64_tr_b16 v[138:139], v8 offset:16896
    s_waitcnt lgkmcnt(10)
    v_mfma_f32_16x16x32_bf16 v[24:27], v[160:163], v[96:99], v[24:27]
    v_mfma_f32_16x16x32_bf16 v[40:43], v[160:163], v[104:107], v[40:43]
    ds_read_b64_tr_b16 v[160:161], v9 offset:16384
    ds_read_b64_tr_b16 v[162:163], v9 offset:16896
    s_waitcnt lgkmcnt(10)
    v_mfma_f32_16x16x32_bf16 v[28:31], v[116:119], v[96:99], v[28:31]
    ds_read_b128 v[96:99], v3 offset:32768
    v_mfma_f32_16x16x32_bf16 v[44:47], v[116:119], v[104:107], v[44:47]
    ds_read_b64_tr_b16 v[116:117], v5 offset:20480
    ds_read_b64_tr_b16 v[118:119], v5 offset:20992
    s_waitcnt lgkmcnt(10)
    v_mfma_f32_16x16x32_bf16 v[16:19], v[72:75], v[48:51], v[16:19]
    ds_read_b128 v[104:107], v3 offset:34816
    s_waitcnt lgkmcnt(10)
    v_mfma_f32_16x16x32_bf16 v[32:35], v[72:75], v[52:55], v[32:35]
    ds_read_b64_tr_b16 v[72:73], v6 offset:20480
    ds_read_b64_tr_b16 v[74:75], v6 offset:20992
    s_waitcnt lgkmcnt(10)
    v_mfma_f32_16x16x32_bf16 v[20:23], v[128:131], v[48:51], v[20:23]
    v_mfma_f32_16x16x32_bf16 v[36:39], v[128:131], v[52:55], v[36:39]
    ds_read_b64_tr_b16 v[128:129], v8 offset:20480
    ds_read_b64_tr_b16 v[130:131], v8 offset:20992
    s_waitcnt lgkmcnt(10)
    v_mfma_f32_16x16x32_bf16 v[24:27], v[136:139], v[48:51], v[24:27]
    v_mfma_f32_16x16x32_bf16 v[40:43], v[136:139], v[52:55], v[40:43]
    ds_read_b64_tr_b16 v[136:137], v9 offset:20480
    ds_read_b64_tr_b16 v[138:139], v9 offset:20992
    s_waitcnt lgkmcnt(10)
    v_mfma_f32_16x16x32_bf16 v[28:31], v[160:163], v[48:51], v[28:31]
    s_waitcnt vmcnt(0)
    s_mov_b64 exec, 1
    ds_add_u32 v4, v164 offset:112
    s_mov_b64 exec, -1
    ds_read_b128 v[48:51], v2 offset:49152
    v_mfma_f32_16x16x32_bf16 v[44:47], v[160:163], v[52:55], v[44:47]
    ds_read_b64_tr_b16 v[160:161], v5 offset:8192
    ds_read_b64_tr_b16 v[162:163], v5 offset:8704
    s_waitcnt lgkmcnt(11)
    v_mfma_f32_16x16x32_bf16 v[16:19], v[116:119], v[96:99], v[16:19]
    ds_read_b128 v[52:55], v2 offset:51200
    s_waitcnt lgkmcnt(11)
    v_mfma_f32_16x16x32_bf16 v[32:35], v[116:119], v[104:107], v[32:35]
    ds_read_b64_tr_b16 v[116:117], v6 offset:8192
    ds_read_b64_tr_b16 v[118:119], v6 offset:8704
    s_waitcnt lgkmcnt(11)
    v_mfma_f32_16x16x32_bf16 v[20:23], v[72:75], v[96:99], v[20:23]
    v_mfma_f32_16x16x32_bf16 v[36:39], v[72:75], v[104:107], v[36:39]
    ds_read_b64_tr_b16 v[72:73], v8 offset:8192
    ds_read_b64_tr_b16 v[74:75], v8 offset:8704
    s_waitcnt lgkmcnt(9)
    v_mov_b32 v165, 4
    s_mov_b64 exec, 1
    ds_write_b32 v4, v165 offset:0
    s_mov_b64 exec, -1
    v_mfma_f32_16x16x32_bf16 v[24:27], v[128:131], v[96:99], v[24:27]
    v_mfma_f32_16x16x32_bf16 v[40:43], v[128:131], v[104:107], v[40:43]
    ds_read_b64_tr_b16 v[128:129], v9 offset:8192
    ds_read_b64_tr_b16 v[130:131], v9 offset:8704
    v_mfma_f32_16x16x32_bf16 v[28:31], v[136:139], v[96:99], v[28:31]
    ds_read_b128 v[96:99], v3 offset:49152
    v_mfma_f32_16x16x32_bf16 v[44:47], v[136:139], v[104:107], v[44:47]
    ds_read_b64_tr_b16 v[136:137], v5 offset:12288
    ds_read_b64_tr_b16 v[138:139], v5 offset:12800
    s_waitcnt lgkmcnt(11)
    v_mfma_f32_16x16x32_bf16 v[16:19], v[160:163], v[48:51], v[16:19]
    ds_read_b128 v[104:107], v3 offset:51200
    s_waitcnt lgkmcnt(11)
    v_mfma_f32_16x16x32_bf16 v[32:35], v[160:163], v[52:55], v[32:35]
    ds_read_b64_tr_b16 v[160:161], v6 offset:12288
    ds_read_b64_tr_b16 v[162:163], v6 offset:12800
    s_waitcnt lgkmcnt(11)
    v_mfma_f32_16x16x32_bf16 v[20:23], v[116:119], v[48:51], v[20:23]
    v_mfma_f32_16x16x32_bf16 v[36:39], v[116:119], v[52:55], v[36:39]
    ds_read_b64_tr_b16 v[116:117], v8 offset:12288
    ds_read_b64_tr_b16 v[118:119], v8 offset:12800
    s_waitcnt lgkmcnt(11)
    v_mfma_f32_16x16x32_bf16 v[24:27], v[72:75], v[48:51], v[24:27]
    v_mfma_f32_16x16x32_bf16 v[40:43], v[72:75], v[52:55], v[40:43]
    ds_read_b64_tr_b16 v[72:73], v9 offset:12288
    ds_read_b64_tr_b16 v[74:75], v9 offset:12800
    s_waitcnt lgkmcnt(10)
    v_mfma_f32_16x16x32_bf16 v[28:31], v[128:131], v[48:51], v[28:31]
    ds_read_b64_tr_b16 v[48:49], v10 offset:8192
    v_mfma_f32_16x16x32_bf16 v[44:47], v[128:131], v[52:55], v[44:47]
    ds_read_b64_tr_b16 v[50:51], v10 offset:8704
    ds_read_b64_tr_b16 v[128:129], v11 offset:8192
    s_waitcnt lgkmcnt(10)
    v_mfma_f32_16x16x32_bf16 v[16:19], v[136:139], v[96:99], v[16:19]
    ds_read_b64_tr_b16 v[130:131], v11 offset:8704
    s_waitcnt lgkmcnt(10)
    v_mfma_f32_16x16x32_bf16 v[32:35], v[136:139], v[104:107], v[32:35]
    ds_read_b64_tr_b16 v[52:53], v12 offset:8192
    ds_read_b64_tr_b16 v[54:55], v12 offset:8704
    s_waitcnt lgkmcnt(10)
    v_mfma_f32_16x16x32_bf16 v[20:23], v[160:163], v[96:99], v[20:23]
    ds_read_b64_tr_b16 v[136:137], v13 offset:8192
    v_mfma_f32_16x16x32_bf16 v[36:39], v[160:163], v[104:107], v[36:39]
    ds_read_b64_tr_b16 v[138:139], v13 offset:8704
    ds_read_b64_tr_b16 v[160:161], v10 offset:12288
    s_waitcnt lgkmcnt(9)
    v_mov_b32 v165, 5
    s_mov_b64 exec, 1
    ds_write_b32 v4, v165 offset:0
    s_mov_b64 exec, -1
    v_mfma_f32_16x16x32_bf16 v[24:27], v[116:119], v[96:99], v[24:27]
    ds_read_b64_tr_b16 v[162:163], v10 offset:12800
    v_mfma_f32_16x16x32_bf16 v[40:43], v[116:119], v[104:107], v[40:43]
    ds_read_b64_tr_b16 v[116:117], v11 offset:12288
    ds_read_b64_tr_b16 v[118:119], v11 offset:12800
    v_mfma_f32_16x16x32_bf16 v[28:31], v[72:75], v[96:99], v[28:31]
    ds_read_b64_tr_b16 v[96:97], v12 offset:12288
    v_mfma_f32_16x16x32_bf16 v[44:47], v[72:75], v[104:107], v[44:47]
    ds_read_b64_tr_b16 v[98:99], v12 offset:12800
    s_waitcnt lgkmcnt(8)
    ds_read_b64_tr_b16 v[72:73], v13 offset:12288
    s_waitcnt lgkmcnt(14)
    v_mfma_f32_16x16x32_bf16 v[16:19], v[48:51], v[60:63], v[16:19]
    ds_read_b64_tr_b16 v[74:75], v13 offset:12800
    v_mfma_f32_16x16x32_bf16 v[32:35], v[48:51], v[132:135], v[32:35]
    ds_read_b32 v7, v1 offset:112
FW_7:
    s_waitcnt lgkmcnt(0)
    v_cmp_gt_u32 vcc, 2, v7
    s_cbranch_vccz FO_8
    ds_read_b32 v7, v1 offset:112
    s_branch FW_7
FO_8:
    ds_read_b64_tr_b16 v[104:105], v10 offset:0
    ds_read_b64_tr_b16 v[106:107], v10 offset:512
    v_mfma_f32_16x16x32_bf16 v[20:23], v[128:131], v[60:63], v[20:23]
    ds_read_b64_tr_b16 v[48:49], v11 offset:0
    v_mfma_f32_16x16x32_bf16 v[36:39], v[128:131], v[132:135], v[36:39]
    ds_read_b64_tr_b16 v[50:51], v11 offset:512
    ds_read_b64_tr_b16 v[128:129], v12 offset:0
    v_mfma_f32_16x16x32_bf16 v[24:27], v[52:55], v[60:63], v[24:27]
    ds_read_b64_tr_b16 v[130:131], v12 offset:512
    v_mfma_f32_16x16x32_bf16 v[40:43], v[52:55], v[132:135], v[40:43]
    ds_read_b64_tr_b16 v[52:53], v13 offset:0
    ds_read_b64_tr_b16 v[54:55], v13 offset:512
    v_mfma_f32_16x16x32_bf16 v[28:31], v[136:139], v[60:63], v[28:31]
    v_mfma_f32_16x16x32_bf16 v[44:47], v[136:139], v[132:135], v[44:47]
    v_mfma_f32_16x16x32_bf16 v[16:19], v[160:163], v[68:71], v[16:19]
    ds_read_b64_tr_b16 v[60:61], v10 offset:4096
    v_mfma_f32_16x16x32_bf16 v[32:35], v[160:163], v[152:155], v[32:35]
    ds_read_b64_tr_b16 v[62:63], v10 offset:4608
    ds_read_b64_tr_b16 v[136:137], v11 offset:4096
    v_mfma_f32_16x16x32_bf16 v[20:23], v[116:119], v[68:71], v[20:23]
    ds_read_b64_tr_b16 v[138:139], v11 offset:4608
    v_mfma_f32_16x16x32_bf16 v[36:39], v[116:119], v[152:155], v[36:39]
    ds_read_b64_tr_b16 v[132:133], v12 offset:4096
    ds_read_b64_tr_b16 v[134:135], v12 offset:4608
    v_mfma_f32_16x16x32_bf16 v[24:27], v[96:99], v[68:71], v[24:27]
    ds_read_b64_tr_b16 v[160:161], v13 offset:4096
    v_mfma_f32_16x16x32_bf16 v[40:43], v[96:99], v[152:155], v[40:43]
    s_waitcnt lgkmcnt(8)
    ds_read_b64_tr_b16 v[162:163], v13 offset:4608
    v_mfma_f32_16x16x32_bf16 v[28:31], v[72:75], v[68:71], v[28:31]
    v_mfma_f32_16x16x32_bf16 v[44:47], v[72:75], v[152:155], v[44:47]
    s_waitcnt lgkmcnt(14)
    v_mfma_f32_16x16x32_bf16 v[16:19], v[104:107], v[84:87], v[16:19]
    ds_read_b64_tr_b16 v[116:117], v10 offset:24576
    v_mfma_f32_16x16x32_bf16 v[32:35], v[104:107], v[92:95], v[32:35]
    ds_read_b64_tr_b16 v[118:119], v10 offset:25088
    ds_read_b64_tr_b16 v[96:97], v11 offset:24576
    s_waitcnt lgkmcnt(15)
    v_mfma_f32_16x16x32_bf16 v[20:23], v[48:51], v[84:87], v[20:23]
    ds_read_b64_tr_b16 v[98:99], v11 offset:25088
    s_waitcnt lgkmcnt(4)
    v_mov_b32 v165, 7
    s_mov_b64 exec, 1
    ds_write_b32 v4, v165 offset:0
    s_mov_b64 exec, -1
    v_mfma_f32_16x16x32_bf16 v[36:39], v[48:51], v[92:95], v[36:39]
    ds_read_b64_tr_b16 v[68:69], v12 offset:24576
    ds_read_b64_tr_b16 v[70:71], v12 offset:25088
    v_mfma_f32_16x16x32_bf16 v[24:27], v[128:131], v[84:87], v[24:27]
    ds_read_b64_tr_b16 v[72:73], v13 offset:24576
    v_mfma_f32_16x16x32_bf16 v[40:43], v[128:131], v[92:95], v[40:43]
    ds_read_b64_tr_b16 v[74:75], v13 offset:25088
    v_mfma_f32_16x16x32_bf16 v[28:31], v[52:55], v[84:87], v[28:31]
    v_mfma_f32_16x16x32_bf16 v[44:47], v[52:55], v[92:95], v[44:47]
    v_mfma_f32_16x16x32_bf16 v[16:19], v[60:63], v[100:103], v[16:19]
    ds_read_b64_tr_b16 v[152:153], v10 offset:28672
    v_mfma_f32_16x16x32_bf16 v[32:35], v[60:63], v[108:111], v[32:35]
    ds_read_b64_tr_b16 v[154:155], v10 offset:29184
    ds_read_b64_tr_b16 v[104:105], v11 offset:28672
    v_mfma_f32_16x16x32_bf16 v[20:23], v[136:139], v[100:103], v[20:23]
    ds_read_b64_tr_b16 v[106:107], v11 offset:29184
    v_mfma_f32_16x16x32_bf16 v[36:39], v[136:139], v[108:111], v[36:39]
    ds_read_b64_tr_b16 v[48:49], v12 offset:28672
    ds_read_b64_tr_b16 v[50:51], v12 offset:29184
    v_mfma_f32_16x16x32_bf16 v[24:27], v[132:135], v[100:103], v[24:27]
    s_waitcnt lgkmcnt(8)
    ds_read_b64_tr_b16 v[128:129], v13 offset:28672
    v_mfma_f32_16x16x32_bf16 v[40:43], v[132:135], v[108:111], v[40:43]
    ds_read_b64_tr_b16 v[130:131], v13 offset:29184
    v_mfma_f32_16x16x32_bf16 v[28:31], v[160:163], v[100:103], v[28:31]
    v_mfma_f32_16x16x32_bf16 v[44:47], v[160:163], v[108:111], v[44:47]
    s_waitcnt lgkmcnt(15)
    v_mfma_f32_16x16x32_bf16 v[16:19], v[116:119], v[56:59], v[16:19]
    ds_read_b64_tr_b16 v[84:85], v10 offset:16384
    v_mfma_f32_16x16x32_bf16 v[32:35], v[116:119], v[124:127], v[32:35]
    ds_read_b64_tr_b16 v[86:87], v10 offset:16896
    ds_read_b64_tr_b16 v[52:53], v11 offset:16384
    s_waitcnt lgkmcnt(15)
    v_mfma_f32_16x16x32_bf16 v[20:23], v[96:99], v[56:59], v[20:23]
    ds_read_b64_tr_b16 v[54:55], v11 offset:16896
    v_mfma_f32_16x16x32_bf16 v[36:39], v[96:99], v[124:127], v[36:39]
    ds_read_b64_tr_b16 v[92:93], v12 offset:16384
    s_waitcnt lgkmcnt(8)
    ds_read_b64_tr_b16 v[94:95], v12 offset:16896
    s_waitcnt lgkmcnt(15)
    v_mfma_f32_16x16x32_bf16 v[24:27], v[68:71], v[56:59], v[24:27]
    ds_read_b64_tr_b16 v[60:61], v13 offset:16384
    v_mfma_f32_16x16x32_bf16 v[40:43], v[68:71], v[124:127], v[40:43]
    ds_read_b64_tr_b16 v[62:63], v13 offset:16896
    s_waitcnt lgkmcnt(15)
    v_mfma_f32_16x16x32_bf16 v[28:31], v[72:75], v[56:59], v[28:31]
    v_mfma_f32_16x16x32_bf16 v[44:47], v[72:75], v[124:127], v[44:47]
    s_waitcnt lgkmcnt(14)
    v_mfma_f32_16x16x32_bf16 v[16:19], v[152:155], v[76:79], v[16:19]
    ds_read_b64_tr_b16 v[136:137], v10 offset:20480
    v_mfma_f32_16x16x32_bf16 v[32:35], v[152:155], v[148:151], v[32:35]
    ds_read_b64_tr_b16 v[138:139], v10 offset:20992
    ds_read_b64_tr_b16 v[132:133], v11 offset:20480
    s_waitcnt lgkmcnt(15)
    v_mfma_f32_16x16x32_bf16 v[20:23], v[104:107], v[76:79], v[20:23]
    ds_read_b64_tr_b16 v[134:135], v11 offset:20992
    v_mfma_f32_16x16x32_bf16 v[36:39], v[104:107], v[148:151], v[36:39]
    s_waitcnt lgkmcnt(8)
    ds_read_b64_tr_b16 v[100:101], v12 offset:20480
    ds_read_b64_tr_b16 v[102:103], v12 offset:20992
    s_waitcnt lgkmcnt(15)
    v_mfma_f32_16x16x32_bf16 v[24:27], v[48:51], v[76:79], v[24:27]
    ds_read_b64_tr_b16 v[160:161], v13 offset:20480
    v_mfma_f32_16x16x32_bf16 v[40:43], v[48:51], v[148:151], v[40:43]
    ds_read_b64_tr_b16 v[162:163], v13 offset:20992
    s_waitcnt lgkmcnt(15)
    v_mfma_f32_16x16x32_bf16 v[28:31], v[128:131], v[76:79], v[28:31]
    v_mfma_f32_16x16x32_bf16 v[44:47], v[128:131], v[148:151], v[44:47]
    s_waitcnt lgkmcnt(14)
    v_mfma_f32_16x16x32_bf16 v[16:19], v[84:87], v[88:91], v[16:19]
    ds_read_b64_tr_b16 v[108:109], v10 offset:32768
    v_mfma_f32_16x16x32_bf16 v[32:35], v[84:87], v[64:67], v[32:35]
    ds_read_b64_tr_b16 v[110:111], v10 offset:33280
    ds_read_b64_tr_b16 v[116:117], v11 offset:32768
    s_waitcnt lgkmcnt(15)
    v_mfma_f32_16x16x32_bf16 v[20:23], v[52:55], v[88:91], v[20:23]
    s_waitcnt lgkmcnt(8)
    ds_read_b64_tr_b16 v[118:119], v11 offset:33280
    v_mfma_f32_16x16x32_bf16 v[36:39], v[52:55], v[64:67], v[36:39]
    ds_read_b64_tr_b16 v[96:97], v12 offset:32768
    ds_read_b64_tr_b16 v[98:99], v12 offset:33280
    s_waitcnt lgkmcnt(15)
    v_mfma_f32_16x16x32_bf16 v[24:27], v[92:95], v[88:91], v[24:27]
    ds_read_b64_tr_b16 v[68:69], v13 offset:32768
    v_mfma_f32_16x16x32_bf16 v[40:43], v[92:95], v[64:67], v[40:43]
    ds_read_b64_tr_b16 v[70:71], v13 offset:33280
    s_waitcnt lgkmcnt(15)
    v_mfma_f32_16x16x32_bf16 v[28:31], v[60:63], v[88:91], v[28:31]
    v_mfma_f32_16x16x32_bf16 v[44:47], v[60:63], v[64:67], v[44:47]
    s_waitcnt lgkmcnt(14)
    v_mfma_f32_16x16x32_bf16 v[16:19], v[136:139], v[80:83], v[16:19]
    ds_read_b64_tr_b16 v[56:57], v10 offset:36864
    v_mfma_f32_16x16x32_bf16 v[32:35], v[136:139], v[112:115], v[32:35]
    ds_read_b64_tr_b16 v[58:59], v10 offset:37376
    s_waitcnt lgkmcnt(8)
    ds_read_b64_tr_b16 v[72:73], v11 offset:36864
    s_waitcnt lgkmcnt(15)
    v_mfma_f32_16x16x32_bf16 v[20:23], v[132:135], v[80:83], v[20:23]
    ds_read_b64_tr_b16 v[74:75], v11 offset:37376
    v_mfma_f32_16x16x32_bf16 v[36:39], v[132:135], v[112:115], v[36:39]
    ds_read_b64_tr_b16 v[124:125], v12 offset:36864
    ds_read_b64_tr_b16 v[126:127], v12 offset:37376
    s_waitcnt lgkmcnt(15)
    v_mfma_f32_16x16x32_bf16 v[24:27], v[100:103], v[80:83], v[24:27]
    ds_read_b64_tr_b16 v[152:153], v13 offset:36864
    v_mfma_f32_16x16x32_bf16 v[40:43], v[100:103], v[112:115], v[40:43]
    ds_read_b64_tr_b16 v[154:155], v13 offset:37376
    s_waitcnt lgkmcnt(15)
    v_mfma_f32_16x16x32_bf16 v[28:31], v[160:163], v[80:83], v[28:31]
    v_mfma_f32_16x16x32_bf16 v[44:47], v[160:163], v[112:115], v[44:47]
    s_waitcnt lgkmcnt(14)
    v_mfma_f32_16x16x32_bf16 v[16:19], v[108:111], v[140:143], v[16:19]
    ds_read2_b32 v[112:113], v14 offset0:0 offset1:0
    s_waitcnt lgkmcnt(8)
    ds_read2_b32 v[114:115], v14 offset0:16 offset1:16
    v_mfma_f32_16x16x32_bf16 v[32:35], v[108:111], v[120:123], v[32:35]
    s_waitcnt lgkmcnt(14)
    v_mfma_f32_16x16x32_bf16 v[20:23], v[116:119], v[140:143], v[20:23]
    s_waitcnt lgkmcnt(2)
    v_mov_b32 v165, 10
    s_mov_b64 exec, 1
    ds_write_b32 v4, v165 offset:0
    s_mov_b64 exec, -1
    v_mfma_f32_16x16x32_bf16 v[36:39], v[116:119], v[120:123], v[36:39]
    v_mfma_f32_16x16x32_bf16 v[24:27], v[96:99], v[140:143], v[24:27]
    v_mfma_f32_16x16x32_bf16 v[40:43], v[96:99], v[120:123], v[40:43]
    v_mfma_f32_16x16x32_bf16 v[28:31], v[68:71], v[140:143], v[28:31]
    v_mfma_f32_16x16x32_bf16 v[44:47], v[68:71], v[120:123], v[44:47]
    v_mfma_f32_16x16x32_bf16 v[16:19], v[56:59], v[144:147], v[16:19]
    v_mfma_f32_16x16x32_bf16 v[32:35], v[56:59], v[156:159], v[32:35]
    v_mfma_f32_16x16x32_bf16 v[20:23], v[72:75], v[144:147], v[20:23]
    v_mfma_f32_16x16x32_bf16 v[36:39], v[72:75], v[156:159], v[36:39]
    s_branch IW_s2
IW_w2:
    s_branch IW_r2
IW_s2:
    v_mfma_f32_16x16x32_bf16 v[24:27], v[124:127], v[144:147], v[24:27]
    v_mfma_f32_16x16x32_bf16 v[40:43], v[124:127], v[156:159], v[40:43]
    v_mfma_f32_16x16x32_bf16 v[28:31], v[152:155], v[144:147], v[28:31]
    v_mfma_f32_16x16x32_bf16 v[44:47], v[152:155], v[156:159], v[44:47]
    s_setprio 3
    v_lshlrev_b32 v6, 4, v0
    v_lshlrev_b32 v8, 2, v0
    v_add_u32 v8, 40960, v8
    v_mov_b32 v11, 0x35c1a2a0

    s_waitcnt lgkmcnt(2)
    v_pk_mul_f32 v[16:17], v[16:17], v[112:113]
    v_pk_mul_f32 v[18:19], v[18:19], v[112:113]
    v_pk_mul_f32 v[20:21], v[20:21], v[112:113]
    v_pk_mul_f32 v[22:23], v[22:23], v[112:113]
    v_pk_mul_f32 v[24:25], v[24:25], v[112:113]
    v_pk_mul_f32 v[26:27], v[26:27], v[112:113]
    v_pk_mul_f32 v[28:29], v[28:29], v[112:113]
    v_pk_mul_f32 v[30:31], v[30:31], v[112:113]
    s_waitcnt lgkmcnt(1)
    v_pk_mul_f32 v[32:33], v[32:33], v[114:115]
    v_pk_mul_f32 v[34:35], v[34:35], v[114:115]
    v_pk_mul_f32 v[36:37], v[36:37], v[114:115]
    v_pk_mul_f32 v[38:39], v[38:39], v[114:115]
    v_pk_mul_f32 v[40:41], v[40:41], v[114:115]
    v_pk_mul_f32 v[42:43], v[42:43], v[114:115]
    v_pk_mul_f32 v[44:45], v[44:45], v[114:115]
    v_pk_mul_f32 v[46:47], v[46:47], v[114:115]
    v_exp_f32 v80, v16 clamp
    v_exp_f32 v81, v17 clamp
    v_exp_f32 v82, v18 clamp
    v_exp_f32 v83, v19 clamp
    v_exp_f32 v84, v20 clamp
    v_exp_f32 v85, v21 clamp
    v_exp_f32 v86, v22 clamp
    v_exp_f32 v87, v23 clamp
    v_exp_f32 v88, v24 clamp
    v_exp_f32 v89, v25 clamp
    v_exp_f32 v90, v26 clamp
    v_exp_f32 v91, v27 clamp
    v_exp_f32 v92, v28 clamp
    v_exp_f32 v93, v29 clamp
    v_exp_f32 v94, v30 clamp
    v_exp_f32 v95, v31 clamp
    v_exp_f32 v96, v32 clamp
    v_exp_f32 v97, v33 clamp
    v_exp_f32 v98, v34 clamp
    v_exp_f32 v99, v35 clamp
    v_exp_f32 v100, v36 clamp
    v_exp_f32 v101, v37 clamp
    v_exp_f32 v102, v38 clamp
    v_exp_f32 v103, v39 clamp
    v_exp_f32 v104, v40 clamp
    v_exp_f32 v105, v41 clamp
    v_exp_f32 v106, v42 clamp
    v_exp_f32 v107, v43 clamp
    v_exp_f32 v108, v44 clamp
    v_exp_f32 v109, v45 clamp
    v_exp_f32 v110, v46 clamp
    v_exp_f32 v111, v47 clamp
    v_pk_mul_f32 v[16:17], v[16:17], s[40:41] clamp
    v_pk_mul_f32 v[18:19], v[18:19], s[40:41] clamp
    v_pk_mul_f32 v[20:21], v[20:21], s[40:41] clamp
    v_pk_mul_f32 v[22:23], v[22:23], s[40:41] clamp
    v_pk_mul_f32 v[24:25], v[24:25], s[40:41] clamp
    v_pk_mul_f32 v[26:27], v[26:27], s[40:41] clamp
    v_pk_mul_f32 v[28:29], v[28:29], s[40:41] clamp
    v_pk_mul_f32 v[30:31], v[30:31], s[40:41] clamp
    v_pk_mul_f32 v[32:33], v[32:33], s[40:41] clamp
    v_pk_mul_f32 v[34:35], v[34:35], s[40:41] clamp
    v_pk_mul_f32 v[36:37], v[36:37], s[40:41] clamp
    v_pk_mul_f32 v[38:39], v[38:39], s[40:41] clamp
    v_pk_mul_f32 v[40:41], v[40:41], s[40:41] clamp
    v_pk_mul_f32 v[42:43], v[42:43], s[40:41] clamp
    v_pk_mul_f32 v[44:45], v[44:45], s[40:41] clamp
    v_pk_mul_f32 v[46:47], v[46:47], s[40:41] clamp
    v_pk_add_f32 v[80:81], v[80:81], s[74:75]
    v_pk_add_f32 v[82:83], v[82:83], s[74:75]
    v_pk_add_f32 v[84:85], v[84:85], s[74:75]
    v_pk_add_f32 v[86:87], v[86:87], s[74:75]
    v_pk_add_f32 v[88:89], v[88:89], s[74:75]
    v_pk_add_f32 v[90:91], v[90:91], s[74:75]
    v_pk_add_f32 v[92:93], v[92:93], s[74:75]
    v_pk_add_f32 v[94:95], v[94:95], s[74:75]
    v_pk_add_f32 v[96:97], v[96:97], s[74:75]
    v_pk_add_f32 v[98:99], v[98:99], s[74:75]
    v_pk_add_f32 v[100:101], v[100:101], s[74:75]
    v_pk_add_f32 v[102:103], v[102:103], s[74:75]
    v_pk_add_f32 v[104:105], v[104:105], s[74:75]
    v_pk_add_f32 v[106:107], v[106:107], s[74:75]
    v_pk_add_f32 v[108:109], v[108:109], s[74:75]
    v_pk_add_f32 v[110:111], v[110:111], s[74:75]
    v_pk_fma_f32 v[16:17], v[16:17], s[76:77], v[80:81]
    v_pk_fma_f32 v[18:19], v[18:19], s[76:77], v[82:83]
    v_pk_fma_f32 v[20:21], v[20:21], s[76:77], v[84:85]
    v_pk_fma_f32 v[22:23], v[22:23], s[76:77], v[86:87]
    v_pk_fma_f32 v[24:25], v[24:25], s[76:77], v[88:89]
    v_pk_fma_f32 v[26:27], v[26:27], s[76:77], v[90:91]
    v_pk_fma_f32 v[28:29], v[28:29], s[76:77], v[92:93]
    v_pk_fma_f32 v[30:31], v[30:31], s[76:77], v[94:95]
    v_pk_fma_f32 v[32:33], v[32:33], s[76:77], v[96:97]
    v_pk_fma_f32 v[34:35], v[34:35], s[76:77], v[98:99]
    v_pk_fma_f32 v[36:37], v[36:37], s[76:77], v[100:101]
    v_pk_fma_f32 v[38:39], v[38:39], s[76:77], v[102:103]
    v_pk_fma_f32 v[40:41], v[40:41], s[76:77], v[104:105]
    v_pk_fma_f32 v[42:43], v[42:43], s[76:77], v[106:107]
    v_pk_fma_f32 v[44:45], v[44:45], s[76:77], v[108:109]
    v_pk_fma_f32 v[46:47], v[46:47], s[76:77], v[110:111]
    v_cvt_pk_bf16_f32 v112, v16, v17
    v_cvt_pk_bf16_f32 v113, v18, v19
    v_cvt_pk_bf16_f32 v114, v20, v21
    v_cvt_pk_bf16_f32 v115, v22, v23
    v_cvt_pk_bf16_f32 v116, v24, v25
    v_cvt_pk_bf16_f32 v117, v26, v27
    v_cvt_pk_bf16_f32 v118, v28, v29
    v_cvt_pk_bf16_f32 v119, v30, v31
    v_cvt_pk_bf16_f32 v120, v32, v33
    v_cvt_pk_bf16_f32 v121, v34, v35
    v_cvt_pk_bf16_f32 v122, v36, v37
    v_cvt_pk_bf16_f32 v123, v38, v39
    v_cvt_pk_bf16_f32 v124, v40, v41
    v_cvt_pk_bf16_f32 v125, v42, v43
    v_cvt_pk_bf16_f32 v126, v44, v45
    v_cvt_pk_bf16_f32 v127, v46, v47
    s_waitcnt lgkmcnt(0)
    v_and_b32 v9, 0xfffffff7, v1
    v_and_b32 v5, 0x30, v0
    v_add_u32 v5, 159232, v5
    v_and_b32 v8, 15, v0
    v_lshlrev_b32 v8, 6, v8
    v_and_b32 v10, 0x30, v0
    v_add_u32 v8, v8, v10
    v_add_u32 v8, 40960, v8
F_kw:
    ds_read_b32 v7, v9 offset:128
    ds_read_b128 v[32:35], v5 offset:0
    ds_read_b128 v[36:39], v5 offset:64
    ds_read_b128 v[16:19], v8 offset:0
    ds_read_b128 v[20:23], v8 offset:1024
    ds_read_b128 v[24:27], v8 offset:4096
    ds_read_b128 v[28:31], v8 offset:5120
    ds_read_b128 v[56:59], v5 offset:128
    ds_read_b128 v[60:63], v5 offset:192
    ds_read_b128 v[40:43], v8 offset:2048
    ds_read_b128 v[44:47], v8 offset:3072
    ds_read_b128 v[48:51], v8 offset:6144
    ds_read_b128 v[52:55], v8 offset:7168
    s_waitcnt lgkmcnt(12)
    v_cmp_gt_u32 vcc, 2, v7
    s_cbranch_vccz F_kx
    s_waitcnt lgkmcnt(0)
    s_branch F_kw
F_kx:
    s_waitcnt lgkmcnt(10)
    v_cvt_pk_bf16_f32 v136, v32, v33
    v_cvt_pk_bf16_f32 v137, v34, v35
    v_cvt_pk_bf16_f32 v138, v36, v37
    v_cvt_pk_bf16_f32 v139, v38, v39
    s_nop 1
    v_mfma_f32_16x16x32_bf16 v[72:75], v[136:139], v[112:115], 0
    v_mfma_f32_16x16x32_bf16 v[84:87], v[136:139], v[120:123], 0
    s_waitcnt lgkmcnt(8)
    v_cvt_pk_bf16_f32 v128, v16, v17
    v_cvt_pk_bf16_f32 v129, v18, v19
    v_cvt_pk_bf16_f32 v130, v20, v21
    v_cvt_pk_bf16_f32 v131, v22, v23
    s_nop 1
    v_mfma_f32_16x16x32_bf16 v[64:67], v[128:131], v[112:115], 0
    v_mfma_f32_16x16x32_bf16 v[76:79], v[128:131], v[120:123], 0
    s_waitcnt lgkmcnt(6)
    v_cvt_pk_bf16_f32 v132, v24, v25
    v_cvt_pk_bf16_f32 v133, v26, v27
    v_cvt_pk_bf16_f32 v134, v28, v29
    v_cvt_pk_bf16_f32 v135, v30, v31
    s_nop 1
    v_mfma_f32_16x16x32_bf16 v[68:71], v[132:135], v[112:115], 0
    v_mfma_f32_16x16x32_bf16 v[80:83], v[132:135], v[120:123], 0
    s_waitcnt lgkmcnt(4)
    v_cvt_pk_bf16_f32 v148, v56, v57
    v_cvt_pk_bf16_f32 v149, v58, v59
    v_cvt_pk_bf16_f32 v150, v60, v61
    v_cvt_pk_bf16_f32 v151, v62, v63
    v_fma_f32 v72, v72, s46, v11
    v_rcp_f32 v72, v72
    v_fma_f32 v84, v84, s46, v11
    v_rcp_f32 v84, v84
    v_mfma_f32_16x16x32_bf16 v[96:99], v[148:151], v[116:119], 0
    v_mfma_f32_16x16x32_bf16 v[108:111], v[148:151], v[124:127], 0
    s_waitcnt lgkmcnt(2)
    v_cvt_pk_bf16_f32 v140, v40, v41
    v_cvt_pk_bf16_f32 v141, v42, v43
    v_cvt_pk_bf16_f32 v142, v44, v45
    v_cvt_pk_bf16_f32 v143, v46, v47
    s_nop 1
    v_mfma_f32_16x16x32_bf16 v[88:91], v[140:143], v[116:119], 0
    v_mfma_f32_16x16x32_bf16 v[100:103], v[140:143], v[124:127], 0
    s_waitcnt lgkmcnt(0)
    v_cvt_pk_bf16_f32 v144, v48, v49
    v_cvt_pk_bf16_f32 v145, v50, v51
    v_cvt_pk_bf16_f32 v146, v52, v53
    v_cvt_pk_bf16_f32 v147, v54, v55
    s_nop 1
    v_mfma_f32_16x16x32_bf16 v[92:95], v[144:147], v[116:119], 0
    v_mfma_f32_16x16x32_bf16 v[104:107], v[144:147], v[124:127], 0
    v_mul_f32 v64, v64, v72
    v_mul_f32 v65, v65, v72
    v_mul_f32 v66, v66, v72
    v_mul_f32 v67, v67, v72
    v_mul_f32 v68, v68, v72
    v_mul_f32 v69, v69, v72
    v_mul_f32 v70, v70, v72
    v_mul_f32 v71, v71, v72
    v_cvt_pk_bf16_f32 v152, v64, v65
    v_cvt_pk_bf16_f32 v153, v66, v67
    v_cvt_pk_bf16_f32 v154, v68, v69
    v_cvt_pk_bf16_f32 v155, v70, v71
    buffer_store_dwordx4 v[152:155], v6, s[16:19], s79 offen offset:0 sc0 sc1
    v_fma_f32 v96, v96, s46, v11
    v_rcp_f32 v96, v96
    v_fma_f32 v108, v108, s46, v11
    v_rcp_f32 v108, v108
    v_mov_b32 v85, v84
    v_pk_mul_f32 v[76:77], v[76:77], v[84:85]
    v_pk_mul_f32 v[78:79], v[78:79], v[84:85]
    v_pk_mul_f32 v[80:81], v[80:81], v[84:85]
    v_pk_mul_f32 v[82:83], v[82:83], v[84:85]
    v_cvt_pk_bf16_f32 v156, v76, v77
    v_cvt_pk_bf16_f32 v157, v78, v79
    v_cvt_pk_bf16_f32 v158, v80, v81
    v_cvt_pk_bf16_f32 v159, v82, v83
    buffer_store_dwordx4 v[156:159], v6, s[16:19], s80 offen offset:0 sc0 sc1
    v_mov_b32 v97, v96
    v_pk_mul_f32 v[88:89], v[88:89], v[96:97]
    v_pk_mul_f32 v[90:91], v[90:91], v[96:97]
    v_pk_mul_f32 v[92:93], v[92:93], v[96:97]
    v_pk_mul_f32 v[94:95], v[94:95], v[96:97]
    v_cvt_pk_bf16_f32 v160, v88, v89
    v_cvt_pk_bf16_f32 v161, v90, v91
    v_cvt_pk_bf16_f32 v162, v92, v93
    v_cvt_pk_bf16_f32 v163, v94, v95
    buffer_store_dwordx4 v[160:163], v6, s[16:19], s79 offen offset:1024 sc0 sc1
    v_mov_b32 v109, v108
    v_pk_mul_f32 v[100:101], v[100:101], v[108:109]
    v_pk_mul_f32 v[102:103], v[102:103], v[108:109]
    v_pk_mul_f32 v[104:105], v[104:105], v[108:109]
    v_pk_mul_f32 v[106:107], v[106:107], v[108:109]
    v_cvt_pk_bf16_f32 v16, v100, v101
    v_cvt_pk_bf16_f32 v17, v102, v103
    v_cvt_pk_bf16_f32 v18, v104, v105
    v_cvt_pk_bf16_f32 v19, v106, v107
    buffer_store_dwordx4 v[16:19], v6, s[16:19], s80 offen offset:1024 sc0 sc1
    s_mov_b64 exec, 1
    ds_write_b32 v4, v164 offset:144
    s_waitcnt vmcnt(0)
    s_mov_b32 s45, 1
    s_atomic_add s45, s[54:55], 0x0
    s_atomic_add s45, s[54:55], 0x80
    s_atomic_add s45, s[54:55], 0x100
    s_atomic_add s45, s[54:55], 0x180
    ds_add_u32 v4, v164 offset:144
    s_mov_b64 exec, -1
    s_cmp_lg_u32 s3, 0
    s_cbranch_scc1 F_end
    s_setprio 3
    s_lshr_b32 s50, s29, 1
    s_lshl_b32 s50, s50, 2
    s_and_b32 s51, s28, 3
    s_add_u32 s50, s50, s51
    s_lshl_b32 s50, s50, 7
    s_add_u32 s56, s50, 0x845000
    s_add_u32 s56, s72, s56
    s_addc_u32 s57, s73, 0
    v_mov_b32 v2, 159096
    ds_read_b32 v7, v2 offset:0
FW_9:
    s_waitcnt lgkmcnt(0)
    v_cmp_gt_u32 vcc, 1, v7
    s_cbranch_vccz FO_10
    s_sleep 2
    ds_read_b32 v7, v2 offset:0
    s_branch FW_9
FO_10:
    v_and_b32 v2, 7, v0
    v_lshlrev_b32 v2, 2, v2
    v_add_u32 v2, 158976, v2
    ds_read_b32 v2, v2
    s_sub_u32 s51, 15, s28
    s_waitcnt lgkmcnt(0)
    v_bfe_u32 v2, v2, 7, 4
    v_cmp_eq_u32 vcc, s51, v2
    s_cbranch_vccz F_ny

    v_lshrrev_b32 v2, 4, v0
    v_and_b32 v6, 15, v0
    v_lshlrev_b32 v6, 4, v6
    v_lshl_add_u32 v2, v2, 12, v6
    s_lshl_b32 s50, s29, 8
    s_add_u32 s50, s50, 135168

SP_11:
    s_load_dword s58, s[56:57], 0 glc
    s_waitcnt lgkmcnt(0)
    s_cmp_ge_u32 s58, 32
    s_cbranch_scc1 SD_12
    s_sleep 2
    s_branch SP_11
SD_12:
    s_mov_b32 m0, 159744
    s_nop 0
    buffer_load_dwordx4 v2, s[24:27], s50 offen sc0 sc1 lds
    s_add_u32 s50, s50, 16384
    s_add_u32 m0, m0, 1024
    s_nop 0
    buffer_load_dwordx4 v2, s[24:27], s50 offen sc0 sc1 lds
    s_waitcnt vmcnt(0)
    v_mov_b32 v7, 1
    s_mov_b64 exec, 1
    ds_write_b32 v4, v7 offset:96
    s_mov_b64 exec, -1
F_ny:
F_end:
    s_endpgm
F_nl:
    s_sub_u32 s3, s3, 4
    s_setprio 2
    s_lshr_b32 s36, s3, 1
    s_and_b32 s37, s3, 1
    v_and_b32 v1, 15, v0
    v_lshrrev_b32 v2, 4, v0
    v_lshrrev_b32 v3, 1, v1
    v_xor_b32 v3, v3, v2
    v_lshlrev_b32 v3, 4, v3
    v_lshlrev_b32 v1, 7, v1
    s_lshl_b32 s38, s36, 13
    v_add3_u32 v4, v1, v3, s38
    v_xor_b32 v5, 64, v4
    v_add_u32 v6, 0x10000, v4
    v_add_u32 v7, 0x10000, v5
    v_bfe_u32 v1, v0, 2, 2
    v_lshl_add_u32 v3, v2, 3, v1
    v_lshrrev_b32 v1, 1, v1
    v_and_b32 v2, 1, v2
    v_lshl_add_u32 v1, v2, 1, v1
    s_lshl_b32 s38, s37, 1
    s_add_u32 s38, s38, s36
    v_xor_b32 v1, s38, v1
    v_lshlrev_b32 v1, 5, v1
    v_lshl_add_u32 v1, v3, 7, v1
    v_and_b32 v2, 3, v0
    v_lshl_add_u32 v1, v2, 3, v1
    v_add_u32 v8, 0x10000, v1
    v_xor_b32 v9, 32, v8
    v_add_u32 v10, 0x8000, v8
    v_add_u32 v11, 0x8000, v9
    s_mov_b32 s40, 0x21317218
    s_mov_b32 s41, s40
    s_mov_b32 s74, 0x358637bd
    s_mov_b32 s75, s74
    s_mov_b32 s76, 0x5d800000
    s_mov_b32 s77, s76
    v_and_b32 v164, 0x30, v0
    s_lshl_b32 s42, s36, 8
    s_add_u32 s42, s42, 155648
    v_add_u32 v164, s42, v164
    v_and_b32 v165, 15, v0
    v_lshlrev_b32 v165, 2, v165
    s_lshl_b32 s42, s38, 6
    s_add_u32 s42, s42, 158208
    v_add_u32 v165, s42, v165
    s_lshl_b32 s42, s3, 2
    s_add_u32 s42, s42, 159040
    v_mov_b32 v3, s42
    v_lshlrev_b32 v1, 2, v2
    v_add_u32 v1, 159040, v1
    v_xor_b32 v2, 64, v165
    s_lshl_b32 s44, s33, 1
    s_add_u32 s44, s44, s37
    s_mul_i32 s45, s44, 4224
    s_mul_i32 s46, s36, 3072
    s_add_u32 s46, s46, s45
    s_lshl_b32 s47, s36, 10
    s_add_u32 s47, s47, 1024
    s_add_u32 s47, s47, s45
    s_lshl_b32 s48, s36, 6
    s_add_u32 s48, s48, 4096
    s_add_u32 s48, s48, s45
    s_lshl_b32 s49, s44, 10
    s_lshl_b32 s52, s3, 11
    s_add_u32 s52, s52, 65536
    s_lshl_b32 s53, s3, 7
    s_lshl_b32 s43, s36, 6
    s_add_u32 s53, s53, s43
    s_add_u32 s53, s53, 159232
    s_mov_b32 s50, 159068
    s_waitcnt lgkmcnt(0)
    s_lshl_b32 s64, s28, 7
    s_lshl_b32 s65, s3, 5
    s_add_u32 s64, s64, s65
    s_lshl_b32 s42, s64, 11
    s_lshl_b32 s65, s29, 7
    s_add_u32 s42, s42, s65
    s_add_u32 s43, s42, 0x8000
    s_lshl_b32 s66, s44, 1
    s_add_u32 s66, s66, s36
    s_lshl_b32 s66, s66, 4
    s_add_u32 s66, s66, s32
    s_lshl_b32 s66, s66, 10

    s_mov_b32 s12, s4
    s_mov_b32 s13, s5
    s_mov_b32 s14, 0x400000
    s_mov_b32 s15, 0x00020000
    s_mov_b32 s16, s6
    s_mov_b32 s17, s7
    s_mov_b32 s18, 0x600000
    s_mov_b32 s19, 0x00020000
    s_mov_b32 s20, s8
    s_mov_b32 s21, s9
    s_mov_b32 s22, 0x200000
    s_mov_b32 s23, 0x00020000
    s_add_u32 s24, s72, 0x800000
    s_addc_u32 s25, s73, 0
    s_mov_b32 s26, 0x48000
    s_mov_b32 s27, 0x00020000
    s_add_u32 s84, s72, 0xa00000
    s_addc_u32 s85, s73, 0
    s_mov_b32 s86, 0x100000
    s_mov_b32 s87, 0x00020000
    s_barrier
    ds_read_b128 v[12:15], v4 offset:0
    ds_read_b64_tr_b16 v[44:45], v8 offset:0
    ds_read_b64_tr_b16 v[46:47], v8 offset:512
    ds_read_b128 v[16:19], v4 offset:2048
    ds_read_b128 v[20:23], v4 offset:4096
    ds_read_b128 v[24:27], v4 offset:6144
    ds_read_b64_tr_b16 v[48:49], v9 offset:0
    ds_read_b64_tr_b16 v[50:51], v9 offset:512
    ds_read_b64_tr_b16 v[52:53], v8 offset:8192
    ds_read_b64_tr_b16 v[54:55], v8 offset:8704
    ds_read_b64_tr_b16 v[56:57], v9 offset:8192
    ds_read_b64_tr_b16 v[58:59], v9 offset:8704
    s_waitcnt lgkmcnt(9)
    v_mfma_f32_16x16x32_bf16 v[100:103], v[12:15], v[44:47], 0
    ds_read_b128 v[28:31], v5 offset:0
    s_waitcnt lgkmcnt(9)
    v_mfma_f32_16x16x32_bf16 v[104:107], v[16:19], v[44:47], 0
    ds_read_b64_tr_b16 v[60:61], v8 offset:4096
    s_waitcnt lgkmcnt(9)
    v_mfma_f32_16x16x32_bf16 v[108:111], v[20:23], v[44:47], 0
    ds_read_b64_tr_b16 v[62:63], v8 offset:4608
    s_waitcnt lgkmcnt(9)
    v_mfma_f32_16x16x32_bf16 v[112:115], v[24:27], v[44:47], 0
    ds_read_b128 v[32:35], v5 offset:2048
    s_waitcnt lgkmcnt(8)
    v_mfma_f32_16x16x32_bf16 v[116:119], v[12:15], v[48:51], 0
    ds_read_b128 v[36:39], v5 offset:4096
    v_mfma_f32_16x16x32_bf16 v[120:123], v[16:19], v[48:51], 0
    ds_read_b128 v[40:43], v5 offset:6144
    v_mfma_f32_16x16x32_bf16 v[124:127], v[20:23], v[48:51], 0
    ds_read_b64_tr_b16 v[64:65], v9 offset:4096
    v_mfma_f32_16x16x32_bf16 v[128:131], v[24:27], v[48:51], 0
    ds_read_b64_tr_b16 v[66:67], v9 offset:4608
    s_waitcnt lgkmcnt(10)
    v_mfma_f32_16x16x32_bf16 v[132:135], v[12:15], v[52:55], 0
    ds_read_b64_tr_b16 v[44:45], v8 offset:12288
    v_mfma_f32_16x16x32_bf16 v[136:139], v[16:19], v[52:55], 0
    ds_read_b64_tr_b16 v[46:47], v8 offset:12800
    v_mfma_f32_16x16x32_bf16 v[140:143], v[20:23], v[52:55], 0
    ds_read_b64_tr_b16 v[48:49], v9 offset:12288
    v_mfma_f32_16x16x32_bf16 v[144:147], v[24:27], v[52:55], 0
    ds_read_b64_tr_b16 v[50:51], v9 offset:12800
    s_waitcnt lgkmcnt(12)
    v_mfma_f32_16x16x32_bf16 v[148:151], v[12:15], v[56:59], 0
    v_mfma_f32_16x16x32_bf16 v[152:155], v[16:19], v[56:59], 0
    v_mfma_f32_16x16x32_bf16 v[156:159], v[20:23], v[56:59], 0
    v_mfma_f32_16x16x32_bf16 v[160:163], v[24:27], v[56:59], 0
    s_waitcnt lgkmcnt(9)
    v_mfma_f32_16x16x32_bf16 v[100:103], v[28:31], v[60:63], v[100:103]
    s_waitcnt lgkmcnt(8)
    v_mfma_f32_16x16x32_bf16 v[104:107], v[32:35], v[60:63], v[104:107]
    s_waitcnt lgkmcnt(0)
    s_barrier
    v_mfma_f32_16x16x32_bf16 v[108:111], v[36:39], v[60:63], v[108:111]
    ds_read_b128 v[12:15], v4 offset:16384
    v_mfma_f32_16x16x32_bf16 v[112:115], v[40:43], v[60:63], v[112:115]
    ds_read_b64_tr_b16 v[52:53], v8 offset:16384
    v_mfma_f32_16x16x32_bf16 v[116:119], v[28:31], v[64:67], v[116:119]
    ds_read_b64_tr_b16 v[54:55], v8 offset:16896
    v_mfma_f32_16x16x32_bf16 v[120:123], v[32:35], v[64:67], v[120:123]
    ds_read_b128 v[16:19], v4 offset:18432
    v_mfma_f32_16x16x32_bf16 v[124:127], v[36:39], v[64:67], v[124:127]
    ds_read_b128 v[20:23], v4 offset:20480
    v_mfma_f32_16x16x32_bf16 v[128:131], v[40:43], v[64:67], v[128:131]
    ds_read_b128 v[24:27], v4 offset:22528
    v_mfma_f32_16x16x32_bf16 v[132:135], v[28:31], v[44:47], v[132:135]
    ds_read_b64_tr_b16 v[56:57], v9 offset:16384
    v_mfma_f32_16x16x32_bf16 v[136:139], v[32:35], v[44:47], v[136:139]
    ds_read_b64_tr_b16 v[58:59], v9 offset:16896
    v_mfma_f32_16x16x32_bf16 v[140:143], v[36:39], v[44:47], v[140:143]
    ds_read_b64_tr_b16 v[60:61], v8 offset:24576
    v_mfma_f32_16x16x32_bf16 v[144:147], v[40:43], v[44:47], v[144:147]
    ds_read_b64_tr_b16 v[62:63], v8 offset:25088
    v_mfma_f32_16x16x32_bf16 v[148:151], v[28:31], v[48:51], v[148:151]
    ds_read_b64_tr_b16 v[64:65], v9 offset:24576
    v_mfma_f32_16x16x32_bf16 v[152:155], v[32:35], v[48:51], v[152:155]
    ds_read_b64_tr_b16 v[66:67], v9 offset:25088
    v_mfma_f32_16x16x32_bf16 v[156:159], v[36:39], v[48:51], v[156:159]
    v_mfma_f32_16x16x32_bf16 v[160:163], v[40:43], v[48:51], v[160:163]
    s_waitcnt lgkmcnt(9)
    v_mfma_f32_16x16x32_bf16 v[100:103], v[12:15], v[52:55], v[100:103]
    ds_read_b128 v[28:31], v5 offset:16384
    s_waitcnt lgkmcnt(9)
    v_mfma_f32_16x16x32_bf16 v[104:107], v[16:19], v[52:55], v[104:107]
    ds_read_b64_tr_b16 v[44:45], v8 offset:20480
    s_waitcnt lgkmcnt(9)
    v_mfma_f32_16x16x32_bf16 v[108:111], v[20:23], v[52:55], v[108:111]
    ds_read_b64_tr_b16 v[46:47], v8 offset:20992
    s_waitcnt lgkmcnt(9)
    v_mfma_f32_16x16x32_bf16 v[112:115], v[24:27], v[52:55], v[112:115]
    ds_read_b128 v[32:35], v5 offset:18432
    s_waitcnt lgkmcnt(8)
    v_mfma_f32_16x16x32_bf16 v[116:119], v[12:15], v[56:59], v[116:119]
    ds_read_b128 v[36:39], v5 offset:20480
    v_mfma_f32_16x16x32_bf16 v[120:123], v[16:19], v[56:59], v[120:123]
    ds_read_b128 v[40:43], v5 offset:22528
    v_mfma_f32_16x16x32_bf16 v[124:127], v[20:23], v[56:59], v[124:127]
    ds_read_b64_tr_b16 v[48:49], v9 offset:20480
    v_mfma_f32_16x16x32_bf16 v[128:131], v[24:27], v[56:59], v[128:131]
    ds_read_b64_tr_b16 v[50:51], v9 offset:20992
    s_waitcnt lgkmcnt(10)
    v_mfma_f32_16x16x32_bf16 v[132:135], v[12:15], v[60:63], v[132:135]
    ds_read_b64_tr_b16 v[52:53], v8 offset:28672
    v_mfma_f32_16x16x32_bf16 v[136:139], v[16:19], v[60:63], v[136:139]
    ds_read_b64_tr_b16 v[54:55], v8 offset:29184
    v_mfma_f32_16x16x32_bf16 v[140:143], v[20:23], v[60:63], v[140:143]
    ds_read_b64_tr_b16 v[56:57], v9 offset:28672
    v_mfma_f32_16x16x32_bf16 v[144:147], v[24:27], v[60:63], v[144:147]
    ds_read_b64_tr_b16 v[58:59], v9 offset:29184
    s_waitcnt lgkmcnt(12)
    v_mfma_f32_16x16x32_bf16 v[148:151], v[12:15], v[64:67], v[148:151]
    v_mfma_f32_16x16x32_bf16 v[152:155], v[16:19], v[64:67], v[152:155]
    v_mfma_f32_16x16x32_bf16 v[156:159], v[20:23], v[64:67], v[156:159]
    v_mfma_f32_16x16x32_bf16 v[160:163], v[24:27], v[64:67], v[160:163]
    s_waitcnt lgkmcnt(9)
    v_mfma_f32_16x16x32_bf16 v[100:103], v[28:31], v[44:47], v[100:103]
    s_waitcnt lgkmcnt(8)
    v_mfma_f32_16x16x32_bf16 v[104:107], v[32:35], v[44:47], v[104:107]
    s_waitcnt lgkmcnt(0)
    s_barrier
    v_mfma_f32_16x16x32_bf16 v[108:111], v[36:39], v[44:47], v[108:111]
    ds_read_b128 v[12:15], v4 offset:32768
    v_mfma_f32_16x16x32_bf16 v[112:115], v[40:43], v[44:47], v[112:115]
    ds_read_b64_tr_b16 v[60:61], v10 offset:16384
    v_mfma_f32_16x16x32_bf16 v[116:119], v[28:31], v[48:51], v[116:119]
    ds_read_b64_tr_b16 v[62:63], v10 offset:16896
    v_mfma_f32_16x16x32_bf16 v[120:123], v[32:35], v[48:51], v[120:123]
    ds_read_b128 v[16:19], v4 offset:34816
    v_mfma_f32_16x16x32_bf16 v[124:127], v[36:39], v[48:51], v[124:127]
    ds_read_b128 v[20:23], v4 offset:36864
    v_mfma_f32_16x16x32_bf16 v[128:131], v[40:43], v[48:51], v[128:131]
    ds_read_b128 v[24:27], v4 offset:38912
    v_mfma_f32_16x16x32_bf16 v[132:135], v[28:31], v[52:55], v[132:135]
    ds_read_b64_tr_b16 v[64:65], v11 offset:16384
    v_mfma_f32_16x16x32_bf16 v[136:139], v[32:35], v[52:55], v[136:139]
    ds_read_b64_tr_b16 v[66:67], v11 offset:16896
    v_mfma_f32_16x16x32_bf16 v[140:143], v[36:39], v[52:55], v[140:143]
    ds_read_b64_tr_b16 v[44:45], v10 offset:24576
    v_mfma_f32_16x16x32_bf16 v[144:147], v[40:43], v[52:55], v[144:147]
    ds_read_b64_tr_b16 v[46:47], v10 offset:25088
    v_mfma_f32_16x16x32_bf16 v[148:151], v[28:31], v[56:59], v[148:151]
    ds_read_b64_tr_b16 v[48:49], v11 offset:24576
    v_mfma_f32_16x16x32_bf16 v[152:155], v[32:35], v[56:59], v[152:155]
    ds_read_b64_tr_b16 v[50:51], v11 offset:25088
    v_mfma_f32_16x16x32_bf16 v[156:159], v[36:39], v[56:59], v[156:159]
    v_mfma_f32_16x16x32_bf16 v[160:163], v[40:43], v[56:59], v[160:163]
    s_waitcnt lgkmcnt(9)
    v_mfma_f32_16x16x32_bf16 v[100:103], v[12:15], v[60:63], v[100:103]
    ds_read_b128 v[28:31], v5 offset:32768
    s_waitcnt lgkmcnt(9)
    v_mfma_f32_16x16x32_bf16 v[104:107], v[16:19], v[60:63], v[104:107]
    ds_read_b64_tr_b16 v[52:53], v10 offset:20480
    s_waitcnt lgkmcnt(9)
    v_mfma_f32_16x16x32_bf16 v[108:111], v[20:23], v[60:63], v[108:111]
    ds_read_b64_tr_b16 v[54:55], v10 offset:20992
    s_waitcnt lgkmcnt(9)
    v_mfma_f32_16x16x32_bf16 v[112:115], v[24:27], v[60:63], v[112:115]
    ds_read_b128 v[32:35], v5 offset:34816
    s_waitcnt lgkmcnt(8)
    v_mfma_f32_16x16x32_bf16 v[116:119], v[12:15], v[64:67], v[116:119]
    ds_read_b128 v[36:39], v5 offset:36864
    v_mfma_f32_16x16x32_bf16 v[120:123], v[16:19], v[64:67], v[120:123]
    ds_read_b128 v[40:43], v5 offset:38912
    v_mfma_f32_16x16x32_bf16 v[124:127], v[20:23], v[64:67], v[124:127]
    ds_read_b64_tr_b16 v[56:57], v11 offset:20480
    v_mfma_f32_16x16x32_bf16 v[128:131], v[24:27], v[64:67], v[128:131]
    ds_read_b64_tr_b16 v[58:59], v11 offset:20992
    s_waitcnt lgkmcnt(10)
    v_mfma_f32_16x16x32_bf16 v[132:135], v[12:15], v[44:47], v[132:135]
    ds_read_b64_tr_b16 v[60:61], v10 offset:28672
    v_mfma_f32_16x16x32_bf16 v[136:139], v[16:19], v[44:47], v[136:139]
    ds_read_b64_tr_b16 v[62:63], v10 offset:29184
    v_mfma_f32_16x16x32_bf16 v[140:143], v[20:23], v[44:47], v[140:143]
    ds_read_b64_tr_b16 v[64:65], v11 offset:28672
    v_mfma_f32_16x16x32_bf16 v[144:147], v[24:27], v[44:47], v[144:147]
    ds_read_b64_tr_b16 v[66:67], v11 offset:29184
    s_waitcnt lgkmcnt(12)
    v_mfma_f32_16x16x32_bf16 v[148:151], v[12:15], v[48:51], v[148:151]
    v_mfma_f32_16x16x32_bf16 v[152:155], v[16:19], v[48:51], v[152:155]
    v_mfma_f32_16x16x32_bf16 v[156:159], v[20:23], v[48:51], v[156:159]
    v_mfma_f32_16x16x32_bf16 v[160:163], v[24:27], v[48:51], v[160:163]
    s_waitcnt lgkmcnt(9)
    v_mfma_f32_16x16x32_bf16 v[100:103], v[28:31], v[52:55], v[100:103]
    s_waitcnt lgkmcnt(8)
    v_mfma_f32_16x16x32_bf16 v[104:107], v[32:35], v[52:55], v[104:107]
    s_waitcnt lgkmcnt(0)
    s_branch IW_s3
IW_w3:
    s_branch IW_r3
IW_s3:
    s_barrier
    v_mfma_f32_16x16x32_bf16 v[108:111], v[36:39], v[52:55], v[108:111]
    ds_read_b128 v[12:15], v4 offset:49152
    v_mfma_f32_16x16x32_bf16 v[112:115], v[40:43], v[52:55], v[112:115]
    ds_read_b64_tr_b16 v[44:45], v10 offset:32768
    v_mfma_f32_16x16x32_bf16 v[116:119], v[28:31], v[56:59], v[116:119]
    ds_read_b64_tr_b16 v[46:47], v10 offset:33280
    v_mfma_f32_16x16x32_bf16 v[120:123], v[32:35], v[56:59], v[120:123]
    ds_read_b128 v[16:19], v4 offset:51200
    v_mfma_f32_16x16x32_bf16 v[124:127], v[36:39], v[56:59], v[124:127]
    ds_read_b128 v[20:23], v4 offset:53248
    v_mfma_f32_16x16x32_bf16 v[128:131], v[40:43], v[56:59], v[128:131]
    ds_read_b128 v[24:27], v4 offset:55296
    v_mfma_f32_16x16x32_bf16 v[132:135], v[28:31], v[60:63], v[132:135]
    ds_read_b64_tr_b16 v[48:49], v11 offset:32768
    v_mfma_f32_16x16x32_bf16 v[136:139], v[32:35], v[60:63], v[136:139]
    ds_read_b64_tr_b16 v[50:51], v11 offset:33280
    v_mfma_f32_16x16x32_bf16 v[140:143], v[36:39], v[60:63], v[140:143]
    ds_read_b64_tr_b16 v[52:53], v8 offset:0
    v_mfma_f32_16x16x32_bf16 v[144:147], v[40:43], v[60:63], v[144:147]
    ds_read_b64_tr_b16 v[54:55], v8 offset:512
    v_mfma_f32_16x16x32_bf16 v[148:151], v[28:31], v[64:67], v[148:151]
    ds_read_b64_tr_b16 v[56:57], v9 offset:0
    v_mfma_f32_16x16x32_bf16 v[152:155], v[32:35], v[64:67], v[152:155]
    ds_read_b64_tr_b16 v[58:59], v9 offset:512
    v_mfma_f32_16x16x32_bf16 v[156:159], v[36:39], v[64:67], v[156:159]
    v_mfma_f32_16x16x32_bf16 v[160:163], v[40:43], v[64:67], v[160:163]
    s_waitcnt lgkmcnt(9)
    v_mfma_f32_16x16x32_bf16 v[100:103], v[12:15], v[44:47], v[100:103]
    ds_read_b128 v[28:31], v5 offset:49152
    s_waitcnt lgkmcnt(9)
    v_mfma_f32_16x16x32_bf16 v[104:107], v[16:19], v[44:47], v[104:107]
    ds_read_b64_tr_b16 v[60:61], v10 offset:36864
    s_waitcnt lgkmcnt(9)
    v_mfma_f32_16x16x32_bf16 v[108:111], v[20:23], v[44:47], v[108:111]
    ds_read_b64_tr_b16 v[62:63], v10 offset:37376
    s_waitcnt lgkmcnt(9)
    v_mfma_f32_16x16x32_bf16 v[112:115], v[24:27], v[44:47], v[112:115]
    ds_read_b128 v[32:35], v5 offset:51200
    s_waitcnt lgkmcnt(8)
    v_mfma_f32_16x16x32_bf16 v[116:119], v[12:15], v[48:51], v[116:119]
    ds_read_b128 v[36:39], v5 offset:53248
    v_mfma_f32_16x16x32_bf16 v[120:123], v[16:19], v[48:51], v[120:123]
    ds_read_b128 v[40:43], v5 offset:55296
    v_mfma_f32_16x16x32_bf16 v[124:127], v[20:23], v[48:51], v[124:127]
    ds_read_b64_tr_b16 v[64:65], v11 offset:36864
    v_mfma_f32_16x16x32_bf16 v[128:131], v[24:27], v[48:51], v[128:131]
    ds_read_b64_tr_b16 v[66:67], v11 offset:37376
    s_waitcnt lgkmcnt(10)
    v_mfma_f32_16x16x32_bf16 v[132:135], v[12:15], v[52:55], v[132:135]
    ds_read_b64_tr_b16 v[44:45], v8 offset:4096
    v_mfma_f32_16x16x32_bf16 v[136:139], v[16:19], v[52:55], v[136:139]
    ds_read_b64_tr_b16 v[46:47], v8 offset:4608
    v_mfma_f32_16x16x32_bf16 v[140:143], v[20:23], v[52:55], v[140:143]
    ds_read_b64_tr_b16 v[48:49], v9 offset:4096
    v_mfma_f32_16x16x32_bf16 v[144:147], v[24:27], v[52:55], v[144:147]
    ds_read_b64_tr_b16 v[50:51], v9 offset:4608
    s_waitcnt lgkmcnt(12)
    v_mfma_f32_16x16x32_bf16 v[148:151], v[12:15], v[56:59], v[148:151]
    v_mfma_f32_16x16x32_bf16 v[152:155], v[16:19], v[56:59], v[152:155]
    v_mfma_f32_16x16x32_bf16 v[156:159], v[20:23], v[56:59], v[156:159]
    v_mfma_f32_16x16x32_bf16 v[160:163], v[24:27], v[56:59], v[160:163]
    s_waitcnt lgkmcnt(9)
    v_mfma_f32_16x16x32_bf16 v[100:103], v[28:31], v[60:63], v[100:103]
    s_waitcnt lgkmcnt(8)
    v_mfma_f32_16x16x32_bf16 v[104:107], v[32:35], v[60:63], v[104:107]
    s_waitcnt lgkmcnt(0)
    s_barrier
    v_mfma_f32_16x16x32_bf16 v[108:111], v[36:39], v[60:63], v[108:111]
    ds_read_b128 v[12:15], v4 offset:0
    v_mfma_f32_16x16x32_bf16 v[112:115], v[40:43], v[60:63], v[112:115]
    ds_read_b64_tr_b16 v[52:53], v8 offset:8192
    v_mfma_f32_16x16x32_bf16 v[116:119], v[28:31], v[64:67], v[116:119]
    ds_read_b64_tr_b16 v[54:55], v8 offset:8704
    v_mfma_f32_16x16x32_bf16 v[120:123], v[32:35], v[64:67], v[120:123]
    ds_read_b128 v[16:19], v4 offset:2048
    v_mfma_f32_16x16x32_bf16 v[124:127], v[36:39], v[64:67], v[124:127]
    ds_read_b128 v[20:23], v4 offset:4096
    v_mfma_f32_16x16x32_bf16 v[128:131], v[40:43], v[64:67], v[128:131]
    ds_read_b128 v[24:27], v4 offset:6144
    v_mfma_f32_16x16x32_bf16 v[132:135], v[28:31], v[44:47], v[132:135]
    ds_read_b64_tr_b16 v[56:57], v9 offset:8192
    v_mfma_f32_16x16x32_bf16 v[136:139], v[32:35], v[44:47], v[136:139]
    ds_read_b64_tr_b16 v[58:59], v9 offset:8704
    v_mfma_f32_16x16x32_bf16 v[140:143], v[36:39], v[44:47], v[140:143]
    ds_read_b64_tr_b16 v[60:61], v8 offset:16384
    v_mfma_f32_16x16x32_bf16 v[144:147], v[40:43], v[44:47], v[144:147]
    ds_read_b64_tr_b16 v[62:63], v8 offset:16896
    v_mfma_f32_16x16x32_bf16 v[148:151], v[28:31], v[48:51], v[148:151]
    ds_read_b64_tr_b16 v[64:65], v9 offset:16384
    v_mfma_f32_16x16x32_bf16 v[152:155], v[32:35], v[48:51], v[152:155]
    ds_read_b64_tr_b16 v[66:67], v9 offset:16896
    v_mfma_f32_16x16x32_bf16 v[156:159], v[36:39], v[48:51], v[156:159]
    v_mfma_f32_16x16x32_bf16 v[160:163], v[40:43], v[48:51], v[160:163]
    s_waitcnt lgkmcnt(9)
    v_mfma_f32_16x16x32_bf16 v[100:103], v[12:15], v[52:55], v[100:103]
    ds_read_b128 v[28:31], v5 offset:0
    s_waitcnt lgkmcnt(9)
    v_mfma_f32_16x16x32_bf16 v[104:107], v[16:19], v[52:55], v[104:107]
    ds_read_b64_tr_b16 v[44:45], v8 offset:12288
    s_waitcnt lgkmcnt(9)
    v_mfma_f32_16x16x32_bf16 v[108:111], v[20:23], v[52:55], v[108:111]
    ds_read_b64_tr_b16 v[46:47], v8 offset:12800
    s_waitcnt lgkmcnt(9)
    v_mfma_f32_16x16x32_bf16 v[112:115], v[24:27], v[52:55], v[112:115]
    ds_read_b128 v[32:35], v5 offset:2048
    s_waitcnt lgkmcnt(8)
    v_mfma_f32_16x16x32_bf16 v[116:119], v[12:15], v[56:59], v[116:119]
    ds_read_b128 v[36:39], v5 offset:4096
    v_mfma_f32_16x16x32_bf16 v[120:123], v[16:19], v[56:59], v[120:123]
    ds_read_b128 v[40:43], v5 offset:6144
    v_mfma_f32_16x16x32_bf16 v[124:127], v[20:23], v[56:59], v[124:127]
    ds_read_b64_tr_b16 v[48:49], v9 offset:12288
    v_mfma_f32_16x16x32_bf16 v[128:131], v[24:27], v[56:59], v[128:131]
    ds_read_b64_tr_b16 v[50:51], v9 offset:12800
    s_waitcnt lgkmcnt(10)
    v_mfma_f32_16x16x32_bf16 v[132:135], v[12:15], v[60:63], v[132:135]
    ds_read_b64_tr_b16 v[52:53], v8 offset:20480
    v_mfma_f32_16x16x32_bf16 v[136:139], v[16:19], v[60:63], v[136:139]
    ds_read_b64_tr_b16 v[54:55], v8 offset:20992
    v_mfma_f32_16x16x32_bf16 v[140:143], v[20:23], v[60:63], v[140:143]
    ds_read_b64_tr_b16 v[56:57], v9 offset:20480
    v_mfma_f32_16x16x32_bf16 v[144:147], v[24:27], v[60:63], v[144:147]
    ds_read_b64_tr_b16 v[58:59], v9 offset:20992
    s_waitcnt lgkmcnt(12)
    v_mfma_f32_16x16x32_bf16 v[148:151], v[12:15], v[64:67], v[148:151]
    v_mfma_f32_16x16x32_bf16 v[152:155], v[16:19], v[64:67], v[152:155]
    v_mfma_f32_16x16x32_bf16 v[156:159], v[20:23], v[64:67], v[156:159]
    v_mfma_f32_16x16x32_bf16 v[160:163], v[24:27], v[64:67], v[160:163]
    s_waitcnt lgkmcnt(9)
    v_mfma_f32_16x16x32_bf16 v[100:103], v[28:31], v[44:47], v[100:103]
    s_waitcnt lgkmcnt(8)
    v_mfma_f32_16x16x32_bf16 v[104:107], v[32:35], v[44:47], v[104:107]
    s_waitcnt lgkmcnt(0)
    s_barrier
    v_mfma_f32_16x16x32_bf16 v[108:111], v[36:39], v[44:47], v[108:111]
    ds_read_b128 v[12:15], v4 offset:16384
    v_mfma_f32_16x16x32_bf16 v[112:115], v[40:43], v[44:47], v[112:115]
    ds_read_b64_tr_b16 v[60:61], v10 offset:0
    v_mfma_f32_16x16x32_bf16 v[116:119], v[28:31], v[48:51], v[116:119]
    ds_read_b64_tr_b16 v[62:63], v10 offset:512
    v_mfma_f32_16x16x32_bf16 v[120:123], v[32:35], v[48:51], v[120:123]
    ds_read_b128 v[16:19], v4 offset:18432
    v_mfma_f32_16x16x32_bf16 v[124:127], v[36:39], v[48:51], v[124:127]
    ds_read_b128 v[20:23], v4 offset:20480
    v_mfma_f32_16x16x32_bf16 v[128:131], v[40:43], v[48:51], v[128:131]
    ds_read_b128 v[24:27], v4 offset:22528
    v_mfma_f32_16x16x32_bf16 v[132:135], v[28:31], v[52:55], v[132:135]
    ds_read_b64_tr_b16 v[64:65], v11 offset:0
    v_mfma_f32_16x16x32_bf16 v[136:139], v[32:35], v[52:55], v[136:139]
    ds_read_b64_tr_b16 v[66:67], v11 offset:512
    v_mfma_f32_16x16x32_bf16 v[140:143], v[36:39], v[52:55], v[140:143]
    ds_read_b64_tr_b16 v[44:45], v10 offset:8192
    v_mfma_f32_16x16x32_bf16 v[144:147], v[40:43], v[52:55], v[144:147]
    ds_read_b64_tr_b16 v[46:47], v10 offset:8704
    v_mfma_f32_16x16x32_bf16 v[148:151], v[28:31], v[56:59], v[148:151]
    ds_read_b64_tr_b16 v[48:49], v11 offset:8192
    v_mfma_f32_16x16x32_bf16 v[152:155], v[32:35], v[56:59], v[152:155]
    ds_read_b64_tr_b16 v[50:51], v11 offset:8704
    v_mfma_f32_16x16x32_bf16 v[156:159], v[36:39], v[56:59], v[156:159]
    v_mfma_f32_16x16x32_bf16 v[160:163], v[40:43], v[56:59], v[160:163]
    s_waitcnt lgkmcnt(9)
    v_mfma_f32_16x16x32_bf16 v[100:103], v[12:15], v[60:63], v[100:103]
    ds_read_b128 v[28:31], v5 offset:16384
    s_waitcnt lgkmcnt(9)
    v_mfma_f32_16x16x32_bf16 v[104:107], v[16:19], v[60:63], v[104:107]
    ds_read_b64_tr_b16 v[52:53], v10 offset:4096
    s_waitcnt lgkmcnt(9)
    v_mfma_f32_16x16x32_bf16 v[108:111], v[20:23], v[60:63], v[108:111]
    ds_read_b64_tr_b16 v[54:55], v10 offset:4608
    s_waitcnt lgkmcnt(9)
    v_mfma_f32_16x16x32_bf16 v[112:115], v[24:27], v[60:63], v[112:115]
    ds_read_b128 v[32:35], v5 offset:18432
    s_waitcnt lgkmcnt(8)
    v_mfma_f32_16x16x32_bf16 v[116:119], v[12:15], v[64:67], v[116:119]
    ds_read_b128 v[36:39], v5 offset:20480
    v_mfma_f32_16x16x32_bf16 v[120:123], v[16:19], v[64:67], v[120:123]
    ds_read_b128 v[40:43], v5 offset:22528
    v_mfma_f32_16x16x32_bf16 v[124:127], v[20:23], v[64:67], v[124:127]
    ds_read_b64_tr_b16 v[56:57], v11 offset:4096
    v_mfma_f32_16x16x32_bf16 v[128:131], v[24:27], v[64:67], v[128:131]
    ds_read_b64_tr_b16 v[58:59], v11 offset:4608
    s_waitcnt lgkmcnt(10)
    v_mfma_f32_16x16x32_bf16 v[132:135], v[12:15], v[44:47], v[132:135]
    ds_read_b64_tr_b16 v[60:61], v10 offset:12288
    v_mfma_f32_16x16x32_bf16 v[136:139], v[16:19], v[44:47], v[136:139]
    ds_read_b64_tr_b16 v[62:63], v10 offset:12800
    v_mfma_f32_16x16x32_bf16 v[140:143], v[20:23], v[44:47], v[140:143]
    ds_read_b64_tr_b16 v[64:65], v11 offset:12288
    v_mfma_f32_16x16x32_bf16 v[144:147], v[24:27], v[44:47], v[144:147]
    ds_read_b64_tr_b16 v[66:67], v11 offset:12800
    s_waitcnt lgkmcnt(12)
    v_mfma_f32_16x16x32_bf16 v[148:151], v[12:15], v[48:51], v[148:151]
    v_mfma_f32_16x16x32_bf16 v[152:155], v[16:19], v[48:51], v[152:155]
    v_mfma_f32_16x16x32_bf16 v[156:159], v[20:23], v[48:51], v[156:159]
    v_mfma_f32_16x16x32_bf16 v[160:163], v[24:27], v[48:51], v[160:163]
    s_waitcnt lgkmcnt(9)
    v_mfma_f32_16x16x32_bf16 v[100:103], v[28:31], v[52:55], v[100:103]
    s_waitcnt lgkmcnt(8)
    v_mfma_f32_16x16x32_bf16 v[104:107], v[32:35], v[52:55], v[104:107]
    s_waitcnt lgkmcnt(0)
    s_barrier
    v_mfma_f32_16x16x32_bf16 v[108:111], v[36:39], v[52:55], v[108:111]
    ds_read_b128 v[12:15], v4 offset:32768
    v_mfma_f32_16x16x32_bf16 v[112:115], v[40:43], v[52:55], v[112:115]
    ds_read_b64_tr_b16 v[44:45], v10 offset:16384
    v_mfma_f32_16x16x32_bf16 v[116:119], v[28:31], v[56:59], v[116:119]
    ds_read_b64_tr_b16 v[46:47], v10 offset:16896
    v_mfma_f32_16x16x32_bf16 v[120:123], v[32:35], v[56:59], v[120:123]
    ds_read_b128 v[16:19], v4 offset:34816
    v_mfma_f32_16x16x32_bf16 v[124:127], v[36:39], v[56:59], v[124:127]
    ds_read_b128 v[20:23], v4 offset:36864
    v_mfma_f32_16x16x32_bf16 v[128:131], v[40:43], v[56:59], v[128:131]
    ds_read_b128 v[24:27], v4 offset:38912
    v_mfma_f32_16x16x32_bf16 v[132:135], v[28:31], v[60:63], v[132:135]
    ds_read_b64_tr_b16 v[48:49], v11 offset:16384
    v_mfma_f32_16x16x32_bf16 v[136:139], v[32:35], v[60:63], v[136:139]
    ds_read_b64_tr_b16 v[50:51], v11 offset:16896
    v_mfma_f32_16x16x32_bf16 v[140:143], v[36:39], v[60:63], v[140:143]
    ds_read_b64_tr_b16 v[52:53], v10 offset:24576
    v_mfma_f32_16x16x32_bf16 v[144:147], v[40:43], v[60:63], v[144:147]
    ds_read_b64_tr_b16 v[54:55], v10 offset:25088
    v_mfma_f32_16x16x32_bf16 v[148:151], v[28:31], v[64:67], v[148:151]
    ds_read_b64_tr_b16 v[56:57], v11 offset:24576
    v_mfma_f32_16x16x32_bf16 v[152:155], v[32:35], v[64:67], v[152:155]
    ds_read_b64_tr_b16 v[58:59], v11 offset:25088
    v_mfma_f32_16x16x32_bf16 v[156:159], v[36:39], v[64:67], v[156:159]
    v_mfma_f32_16x16x32_bf16 v[160:163], v[40:43], v[64:67], v[160:163]
    s_waitcnt lgkmcnt(9)
    v_mfma_f32_16x16x32_bf16 v[100:103], v[12:15], v[44:47], v[100:103]
    ds_read_b128 v[28:31], v5 offset:32768
    s_waitcnt lgkmcnt(9)
    v_mfma_f32_16x16x32_bf16 v[104:107], v[16:19], v[44:47], v[104:107]
    ds_read_b64_tr_b16 v[60:61], v10 offset:20480
    s_waitcnt lgkmcnt(9)
    v_mfma_f32_16x16x32_bf16 v[108:111], v[20:23], v[44:47], v[108:111]
    ds_read_b64_tr_b16 v[62:63], v10 offset:20992
    s_waitcnt lgkmcnt(9)
    v_mfma_f32_16x16x32_bf16 v[112:115], v[24:27], v[44:47], v[112:115]
    ds_read_b128 v[32:35], v5 offset:34816
    s_waitcnt lgkmcnt(8)
    v_mfma_f32_16x16x32_bf16 v[116:119], v[12:15], v[48:51], v[116:119]
    ds_read_b128 v[36:39], v5 offset:36864
    v_mfma_f32_16x16x32_bf16 v[120:123], v[16:19], v[48:51], v[120:123]
    ds_read_b128 v[40:43], v5 offset:38912
    v_mfma_f32_16x16x32_bf16 v[124:127], v[20:23], v[48:51], v[124:127]
    ds_read_b64_tr_b16 v[64:65], v11 offset:20480
    v_mfma_f32_16x16x32_bf16 v[128:131], v[24:27], v[48:51], v[128:131]
    ds_read_b64_tr_b16 v[66:67], v11 offset:20992
    s_waitcnt lgkmcnt(10)
    v_mfma_f32_16x16x32_bf16 v[132:135], v[12:15], v[52:55], v[132:135]
    ds_read_b64_tr_b16 v[44:45], v10 offset:28672
    v_mfma_f32_16x16x32_bf16 v[136:139], v[16:19], v[52:55], v[136:139]
    ds_read_b64_tr_b16 v[46:47], v10 offset:29184
    v_mfma_f32_16x16x32_bf16 v[140:143], v[20:23], v[52:55], v[140:143]
    ds_read_b64_tr_b16 v[48:49], v11 offset:28672
    v_mfma_f32_16x16x32_bf16 v[144:147], v[24:27], v[52:55], v[144:147]
    ds_read_b64_tr_b16 v[50:51], v11 offset:29184
    s_waitcnt lgkmcnt(12)
    v_mfma_f32_16x16x32_bf16 v[148:151], v[12:15], v[56:59], v[148:151]
    v_mfma_f32_16x16x32_bf16 v[152:155], v[16:19], v[56:59], v[152:155]
    v_mfma_f32_16x16x32_bf16 v[156:159], v[20:23], v[56:59], v[156:159]
    v_mfma_f32_16x16x32_bf16 v[160:163], v[24:27], v[56:59], v[160:163]
    s_waitcnt lgkmcnt(9)
    v_mfma_f32_16x16x32_bf16 v[100:103], v[28:31], v[60:63], v[100:103]
    s_waitcnt lgkmcnt(8)
    v_mfma_f32_16x16x32_bf16 v[104:107], v[32:35], v[60:63], v[104:107]
    s_waitcnt lgkmcnt(0)
    s_barrier
    v_mfma_f32_16x16x32_bf16 v[108:111], v[36:39], v[60:63], v[108:111]
    ds_read_b128 v[12:15], v4 offset:49152
    v_mfma_f32_16x16x32_bf16 v[112:115], v[40:43], v[60:63], v[112:115]
    ds_read_b64_tr_b16 v[52:53], v8 offset:0
    v_mfma_f32_16x16x32_bf16 v[116:119], v[28:31], v[64:67], v[116:119]
    ds_read_b64_tr_b16 v[54:55], v8 offset:512
    v_mfma_f32_16x16x32_bf16 v[120:123], v[32:35], v[64:67], v[120:123]
    ds_read_b128 v[16:19], v4 offset:51200
    v_mfma_f32_16x16x32_bf16 v[124:127], v[36:39], v[64:67], v[124:127]
    ds_read_b128 v[20:23], v4 offset:53248
    v_mfma_f32_16x16x32_bf16 v[128:131], v[40:43], v[64:67], v[128:131]
    ds_read_b128 v[24:27], v4 offset:55296
    v_mfma_f32_16x16x32_bf16 v[132:135], v[28:31], v[44:47], v[132:135]
    ds_read_b64_tr_b16 v[56:57], v9 offset:0
    v_mfma_f32_16x16x32_bf16 v[136:139], v[32:35], v[44:47], v[136:139]
    ds_read_b64_tr_b16 v[58:59], v9 offset:512
    v_mfma_f32_16x16x32_bf16 v[140:143], v[36:39], v[44:47], v[140:143]
    ds_read_b64_tr_b16 v[60:61], v10 offset:32768
    v_mfma_f32_16x16x32_bf16 v[144:147], v[40:43], v[44:47], v[144:147]
    ds_read_b64_tr_b16 v[62:63], v10 offset:33280
    v_mfma_f32_16x16x32_bf16 v[148:151], v[28:31], v[48:51], v[148:151]
    ds_read_b64_tr_b16 v[64:65], v11 offset:32768
    v_mfma_f32_16x16x32_bf16 v[152:155], v[32:35], v[48:51], v[152:155]
    ds_read_b64_tr_b16 v[66:67], v11 offset:33280
    v_mfma_f32_16x16x32_bf16 v[156:159], v[36:39], v[48:51], v[156:159]
    v_mfma_f32_16x16x32_bf16 v[160:163], v[40:43], v[48:51], v[160:163]
    s_waitcnt lgkmcnt(9)
    v_mfma_f32_16x16x32_bf16 v[100:103], v[12:15], v[52:55], v[100:103]
    ds_read_b128 v[28:31], v5 offset:49152
    s_waitcnt lgkmcnt(9)
    v_mfma_f32_16x16x32_bf16 v[104:107], v[16:19], v[52:55], v[104:107]
    ds_read_b64_tr_b16 v[44:45], v8 offset:4096
    s_waitcnt lgkmcnt(9)
    v_mfma_f32_16x16x32_bf16 v[108:111], v[20:23], v[52:55], v[108:111]
    ds_read_b64_tr_b16 v[46:47], v8 offset:4608
    s_waitcnt lgkmcnt(9)
    v_mfma_f32_16x16x32_bf16 v[112:115], v[24:27], v[52:55], v[112:115]
    ds_read_b128 v[32:35], v5 offset:51200
    s_waitcnt lgkmcnt(8)
    v_mfma_f32_16x16x32_bf16 v[116:119], v[12:15], v[56:59], v[116:119]
    ds_read_b128 v[36:39], v5 offset:53248
    v_mfma_f32_16x16x32_bf16 v[120:123], v[16:19], v[56:59], v[120:123]
    ds_read_b128 v[40:43], v5 offset:55296
    v_mfma_f32_16x16x32_bf16 v[124:127], v[20:23], v[56:59], v[124:127]
    ds_read_b64_tr_b16 v[48:49], v9 offset:4096
    v_mfma_f32_16x16x32_bf16 v[128:131], v[24:27], v[56:59], v[128:131]
    ds_read_b64_tr_b16 v[50:51], v9 offset:4608
    s_waitcnt lgkmcnt(10)
    v_mfma_f32_16x16x32_bf16 v[132:135], v[12:15], v[60:63], v[132:135]
    ds_read_b64_tr_b16 v[52:53], v10 offset:36864
    v_mfma_f32_16x16x32_bf16 v[136:139], v[16:19], v[60:63], v[136:139]
    ds_read_b64_tr_b16 v[54:55], v10 offset:37376
    v_mfma_f32_16x16x32_bf16 v[140:143], v[20:23], v[60:63], v[140:143]
    ds_read_b64_tr_b16 v[56:57], v11 offset:36864
    v_mfma_f32_16x16x32_bf16 v[144:147], v[24:27], v[60:63], v[144:147]
    ds_read_b64_tr_b16 v[58:59], v11 offset:37376
    s_waitcnt lgkmcnt(12)
    v_mfma_f32_16x16x32_bf16 v[148:151], v[12:15], v[64:67], v[148:151]
    v_mfma_f32_16x16x32_bf16 v[152:155], v[16:19], v[64:67], v[152:155]
    v_mfma_f32_16x16x32_bf16 v[156:159], v[20:23], v[64:67], v[156:159]
    v_mfma_f32_16x16x32_bf16 v[160:163], v[24:27], v[64:67], v[160:163]
    s_waitcnt lgkmcnt(9)
    v_mfma_f32_16x16x32_bf16 v[100:103], v[28:31], v[44:47], v[100:103]
    s_waitcnt lgkmcnt(8)
    v_mfma_f32_16x16x32_bf16 v[104:107], v[32:35], v[44:47], v[104:107]
    s_waitcnt lgkmcnt(0)
    s_barrier
    v_mfma_f32_16x16x32_bf16 v[108:111], v[36:39], v[44:47], v[108:111]
    ds_read_b128 v[12:15], v4 offset:0
    v_mfma_f32_16x16x32_bf16 v[112:115], v[40:43], v[44:47], v[112:115]
    ds_read_b64_tr_b16 v[60:61], v8 offset:8192
    v_mfma_f32_16x16x32_bf16 v[116:119], v[28:31], v[48:51], v[116:119]
    ds_read_b64_tr_b16 v[62:63], v8 offset:8704
    v_mfma_f32_16x16x32_bf16 v[120:123], v[32:35], v[48:51], v[120:123]
    ds_read_b128 v[16:19], v4 offset:2048
    v_mfma_f32_16x16x32_bf16 v[124:127], v[36:39], v[48:51], v[124:127]
    ds_read_b128 v[20:23], v4 offset:4096
    v_mfma_f32_16x16x32_bf16 v[128:131], v[40:43], v[48:51], v[128:131]
    ds_read_b128 v[24:27], v4 offset:6144
    v_mfma_f32_16x16x32_bf16 v[132:135], v[28:31], v[52:55], v[132:135]
    ds_read_b64_tr_b16 v[64:65], v9 offset:8192
    v_mfma_f32_16x16x32_bf16 v[136:139], v[32:35], v[52:55], v[136:139]
    ds_read_b64_tr_b16 v[66:67], v9 offset:8704
    v_mfma_f32_16x16x32_bf16 v[140:143], v[36:39], v[52:55], v[140:143]
    ds_read_b64_tr_b16 v[44:45], v8 offset:16384
    v_mfma_f32_16x16x32_bf16 v[144:147], v[40:43], v[52:55], v[144:147]
    ds_read_b64_tr_b16 v[46:47], v8 offset:16896
    v_mfma_f32_16x16x32_bf16 v[148:151], v[28:31], v[56:59], v[148:151]
    ds_read_b64_tr_b16 v[48:49], v9 offset:16384
    v_mfma_f32_16x16x32_bf16 v[152:155], v[32:35], v[56:59], v[152:155]
    ds_read_b64_tr_b16 v[50:51], v9 offset:16896
    v_mfma_f32_16x16x32_bf16 v[156:159], v[36:39], v[56:59], v[156:159]
    v_mfma_f32_16x16x32_bf16 v[160:163], v[40:43], v[56:59], v[160:163]
    s_waitcnt lgkmcnt(9)
    v_mfma_f32_16x16x32_bf16 v[100:103], v[12:15], v[60:63], v[100:103]
    ds_read_b128 v[28:31], v5 offset:0
    s_waitcnt lgkmcnt(9)
    v_mfma_f32_16x16x32_bf16 v[104:107], v[16:19], v[60:63], v[104:107]
    ds_read_b64_tr_b16 v[52:53], v8 offset:12288
    s_waitcnt lgkmcnt(9)
    v_mfma_f32_16x16x32_bf16 v[108:111], v[20:23], v[60:63], v[108:111]
    ds_read_b64_tr_b16 v[54:55], v8 offset:12800
    s_waitcnt lgkmcnt(9)
    v_mfma_f32_16x16x32_bf16 v[112:115], v[24:27], v[60:63], v[112:115]
    ds_read_b128 v[32:35], v5 offset:2048
    s_waitcnt lgkmcnt(8)
    v_mfma_f32_16x16x32_bf16 v[116:119], v[12:15], v[64:67], v[116:119]
    ds_read_b128 v[36:39], v5 offset:4096
    v_mfma_f32_16x16x32_bf16 v[120:123], v[16:19], v[64:67], v[120:123]
    ds_read_b128 v[40:43], v5 offset:6144
    v_mfma_f32_16x16x32_bf16 v[124:127], v[20:23], v[64:67], v[124:127]
    ds_read_b64_tr_b16 v[56:57], v9 offset:12288
    v_mfma_f32_16x16x32_bf16 v[128:131], v[24:27], v[64:67], v[128:131]
    ds_read_b64_tr_b16 v[58:59], v9 offset:12800
    s_waitcnt lgkmcnt(10)
    v_mfma_f32_16x16x32_bf16 v[132:135], v[12:15], v[44:47], v[132:135]
    ds_read_b64_tr_b16 v[60:61], v8 offset:20480
    v_mfma_f32_16x16x32_bf16 v[136:139], v[16:19], v[44:47], v[136:139]
    ds_read_b64_tr_b16 v[62:63], v8 offset:20992
    v_mfma_f32_16x16x32_bf16 v[140:143], v[20:23], v[44:47], v[140:143]
    ds_read_b64_tr_b16 v[64:65], v9 offset:20480
    v_mfma_f32_16x16x32_bf16 v[144:147], v[24:27], v[44:47], v[144:147]
    ds_read_b64_tr_b16 v[66:67], v9 offset:20992
    s_waitcnt lgkmcnt(12)
    v_mfma_f32_16x16x32_bf16 v[148:151], v[12:15], v[48:51], v[148:151]
    v_mfma_f32_16x16x32_bf16 v[152:155], v[16:19], v[48:51], v[152:155]
    v_mfma_f32_16x16x32_bf16 v[156:159], v[20:23], v[48:51], v[156:159]
    v_mfma_f32_16x16x32_bf16 v[160:163], v[24:27], v[48:51], v[160:163]
    s_waitcnt lgkmcnt(9)
    v_mfma_f32_16x16x32_bf16 v[100:103], v[28:31], v[52:55], v[100:103]
    s_waitcnt lgkmcnt(8)
    v_mfma_f32_16x16x32_bf16 v[104:107], v[32:35], v[52:55], v[104:107]
    s_waitcnt lgkmcnt(0)
    s_barrier
    v_mfma_f32_16x16x32_bf16 v[108:111], v[36:39], v[52:55], v[108:111]
    ds_read_b128 v[12:15], v4 offset:16384
    v_mfma_f32_16x16x32_bf16 v[112:115], v[40:43], v[52:55], v[112:115]
    ds_read_b64_tr_b16 v[44:45], v8 offset:24576
    v_mfma_f32_16x16x32_bf16 v[116:119], v[28:31], v[56:59], v[116:119]
    ds_read_b64_tr_b16 v[46:47], v8 offset:25088
    v_mfma_f32_16x16x32_bf16 v[120:123], v[32:35], v[56:59], v[120:123]
    ds_read_b128 v[16:19], v4 offset:18432
    v_mfma_f32_16x16x32_bf16 v[124:127], v[36:39], v[56:59], v[124:127]
    ds_read_b128 v[20:23], v4 offset:20480
    v_mfma_f32_16x16x32_bf16 v[128:131], v[40:43], v[56:59], v[128:131]
    ds_read_b128 v[24:27], v4 offset:22528
    v_mfma_f32_16x16x32_bf16 v[132:135], v[28:31], v[60:63], v[132:135]
    ds_read_b64_tr_b16 v[48:49], v9 offset:24576
    v_mfma_f32_16x16x32_bf16 v[136:139], v[32:35], v[60:63], v[136:139]
    ds_read_b64_tr_b16 v[50:51], v9 offset:25088
    v_mfma_f32_16x16x32_bf16 v[140:143], v[36:39], v[60:63], v[140:143]
    ds_read_b64_tr_b16 v[52:53], v10 offset:0
    v_mfma_f32_16x16x32_bf16 v[144:147], v[40:43], v[60:63], v[144:147]
    ds_read_b64_tr_b16 v[54:55], v10 offset:512
    v_mfma_f32_16x16x32_bf16 v[148:151], v[28:31], v[64:67], v[148:151]
    ds_read_b64_tr_b16 v[56:57], v11 offset:0
    v_mfma_f32_16x16x32_bf16 v[152:155], v[32:35], v[64:67], v[152:155]
    ds_read_b64_tr_b16 v[58:59], v11 offset:512
    v_mfma_f32_16x16x32_bf16 v[156:159], v[36:39], v[64:67], v[156:159]
    v_mfma_f32_16x16x32_bf16 v[160:163], v[40:43], v[64:67], v[160:163]
    s_waitcnt lgkmcnt(9)
    v_mfma_f32_16x16x32_bf16 v[100:103], v[12:15], v[44:47], v[100:103]
    ds_read_b128 v[28:31], v5 offset:16384
    s_waitcnt lgkmcnt(9)
    v_mfma_f32_16x16x32_bf16 v[104:107], v[16:19], v[44:47], v[104:107]
    ds_read_b64_tr_b16 v[60:61], v8 offset:28672
    s_waitcnt lgkmcnt(9)
    v_mfma_f32_16x16x32_bf16 v[108:111], v[20:23], v[44:47], v[108:111]
    ds_read_b64_tr_b16 v[62:63], v8 offset:29184
    s_waitcnt lgkmcnt(9)
    v_mfma_f32_16x16x32_bf16 v[112:115], v[24:27], v[44:47], v[112:115]
    ds_read_b128 v[32:35], v5 offset:18432
    s_waitcnt lgkmcnt(8)
    v_mfma_f32_16x16x32_bf16 v[116:119], v[12:15], v[48:51], v[116:119]
    ds_read_b128 v[36:39], v5 offset:20480
    v_mfma_f32_16x16x32_bf16 v[120:123], v[16:19], v[48:51], v[120:123]
    ds_read_b128 v[40:43], v5 offset:22528
    v_mfma_f32_16x16x32_bf16 v[124:127], v[20:23], v[48:51], v[124:127]
    ds_read_b64_tr_b16 v[64:65], v9 offset:28672
    v_mfma_f32_16x16x32_bf16 v[128:131], v[24:27], v[48:51], v[128:131]
    ds_read_b64_tr_b16 v[66:67], v9 offset:29184
    s_waitcnt lgkmcnt(10)
    v_mfma_f32_16x16x32_bf16 v[132:135], v[12:15], v[52:55], v[132:135]
    ds_read_b64_tr_b16 v[44:45], v10 offset:4096
    v_mfma_f32_16x16x32_bf16 v[136:139], v[16:19], v[52:55], v[136:139]
    ds_read_b64_tr_b16 v[46:47], v10 offset:4608
    v_mfma_f32_16x16x32_bf16 v[140:143], v[20:23], v[52:55], v[140:143]
    ds_read_b64_tr_b16 v[48:49], v11 offset:4096
    v_mfma_f32_16x16x32_bf16 v[144:147], v[24:27], v[52:55], v[144:147]
    ds_read_b64_tr_b16 v[50:51], v11 offset:4608
    s_waitcnt lgkmcnt(12)
    v_mfma_f32_16x16x32_bf16 v[148:151], v[12:15], v[56:59], v[148:151]
    v_mfma_f32_16x16x32_bf16 v[152:155], v[16:19], v[56:59], v[152:155]
    v_mfma_f32_16x16x32_bf16 v[156:159], v[20:23], v[56:59], v[156:159]
    v_mfma_f32_16x16x32_bf16 v[160:163], v[24:27], v[56:59], v[160:163]
    s_waitcnt lgkmcnt(9)
    v_mfma_f32_16x16x32_bf16 v[100:103], v[28:31], v[60:63], v[100:103]
    s_waitcnt lgkmcnt(8)
    v_mfma_f32_16x16x32_bf16 v[104:107], v[32:35], v[60:63], v[104:107]
    s_waitcnt lgkmcnt(0)
    s_barrier
    v_mfma_f32_16x16x32_bf16 v[108:111], v[36:39], v[60:63], v[108:111]
    ds_read_b128 v[12:15], v4 offset:32768
    v_mfma_f32_16x16x32_bf16 v[112:115], v[40:43], v[60:63], v[112:115]
    ds_read_b64_tr_b16 v[52:53], v10 offset:16384
    v_mfma_f32_16x16x32_bf16 v[116:119], v[28:31], v[64:67], v[116:119]
    ds_read_b64_tr_b16 v[54:55], v10 offset:16896
    v_mfma_f32_16x16x32_bf16 v[120:123], v[32:35], v[64:67], v[120:123]
    ds_read_b128 v[16:19], v4 offset:34816
    v_mfma_f32_16x16x32_bf16 v[124:127], v[36:39], v[64:67], v[124:127]
    ds_read_b128 v[20:23], v4 offset:36864
    v_mfma_f32_16x16x32_bf16 v[128:131], v[40:43], v[64:67], v[128:131]
    ds_read_b128 v[24:27], v4 offset:38912
    v_mfma_f32_16x16x32_bf16 v[132:135], v[28:31], v[44:47], v[132:135]
    ds_read_b64_tr_b16 v[56:57], v11 offset:16384
    v_mfma_f32_16x16x32_bf16 v[136:139], v[32:35], v[44:47], v[136:139]
    ds_read_b64_tr_b16 v[58:59], v11 offset:16896
    v_mfma_f32_16x16x32_bf16 v[140:143], v[36:39], v[44:47], v[140:143]
    ds_read_b64_tr_b16 v[60:61], v10 offset:24576
    v_mfma_f32_16x16x32_bf16 v[144:147], v[40:43], v[44:47], v[144:147]
    ds_read_b64_tr_b16 v[62:63], v10 offset:25088
    v_mfma_f32_16x16x32_bf16 v[148:151], v[28:31], v[48:51], v[148:151]
    ds_read_b64_tr_b16 v[64:65], v11 offset:24576
    v_mfma_f32_16x16x32_bf16 v[152:155], v[32:35], v[48:51], v[152:155]
    ds_read_b64_tr_b16 v[66:67], v11 offset:25088
    v_mfma_f32_16x16x32_bf16 v[156:159], v[36:39], v[48:51], v[156:159]
    v_mfma_f32_16x16x32_bf16 v[160:163], v[40:43], v[48:51], v[160:163]
    s_waitcnt lgkmcnt(9)
    v_mfma_f32_16x16x32_bf16 v[100:103], v[12:15], v[52:55], v[100:103]
    ds_read_b128 v[28:31], v5 offset:32768
    s_waitcnt lgkmcnt(9)
    v_mfma_f32_16x16x32_bf16 v[104:107], v[16:19], v[52:55], v[104:107]
    ds_read_b64_tr_b16 v[44:45], v10 offset:20480
    s_waitcnt lgkmcnt(9)
    v_mfma_f32_16x16x32_bf16 v[108:111], v[20:23], v[52:55], v[108:111]
    ds_read_b64_tr_b16 v[46:47], v10 offset:20992
    s_waitcnt lgkmcnt(9)
    v_mfma_f32_16x16x32_bf16 v[112:115], v[24:27], v[52:55], v[112:115]
    ds_read_b128 v[32:35], v5 offset:34816
    s_waitcnt lgkmcnt(8)
    v_mfma_f32_16x16x32_bf16 v[116:119], v[12:15], v[56:59], v[116:119]
    ds_read_b128 v[36:39], v5 offset:36864
    v_mfma_f32_16x16x32_bf16 v[120:123], v[16:19], v[56:59], v[120:123]
    ds_read_b128 v[40:43], v5 offset:38912
    v_mfma_f32_16x16x32_bf16 v[124:127], v[20:23], v[56:59], v[124:127]
    ds_read_b64_tr_b16 v[48:49], v11 offset:20480
    v_mfma_f32_16x16x32_bf16 v[128:131], v[24:27], v[56:59], v[128:131]
    ds_read_b64_tr_b16 v[50:51], v11 offset:20992
    s_waitcnt lgkmcnt(10)
    v_mfma_f32_16x16x32_bf16 v[132:135], v[12:15], v[60:63], v[132:135]
    ds_read_b64_tr_b16 v[52:53], v10 offset:28672
    v_mfma_f32_16x16x32_bf16 v[136:139], v[16:19], v[60:63], v[136:139]
    ds_read_b64_tr_b16 v[54:55], v10 offset:29184
    v_mfma_f32_16x16x32_bf16 v[140:143], v[20:23], v[60:63], v[140:143]
    ds_read_b64_tr_b16 v[56:57], v11 offset:28672
    v_mfma_f32_16x16x32_bf16 v[144:147], v[24:27], v[60:63], v[144:147]
    ds_read_b64_tr_b16 v[58:59], v11 offset:29184
    s_waitcnt lgkmcnt(12)
    v_mfma_f32_16x16x32_bf16 v[148:151], v[12:15], v[64:67], v[148:151]
    v_mfma_f32_16x16x32_bf16 v[152:155], v[16:19], v[64:67], v[152:155]
    v_mfma_f32_16x16x32_bf16 v[156:159], v[20:23], v[64:67], v[156:159]
    v_mfma_f32_16x16x32_bf16 v[160:163], v[24:27], v[64:67], v[160:163]
    s_waitcnt lgkmcnt(9)
    v_mfma_f32_16x16x32_bf16 v[100:103], v[28:31], v[44:47], v[100:103]
    s_waitcnt lgkmcnt(8)
    v_mfma_f32_16x16x32_bf16 v[104:107], v[32:35], v[44:47], v[104:107]
    s_waitcnt lgkmcnt(0)
    s_barrier
    v_mfma_f32_16x16x32_bf16 v[108:111], v[36:39], v[44:47], v[108:111]
    ds_read_b128 v[12:15], v4 offset:49152
    v_mfma_f32_16x16x32_bf16 v[112:115], v[40:43], v[44:47], v[112:115]
    ds_read_b64_tr_b16 v[60:61], v8 offset:0
    v_mfma_f32_16x16x32_bf16 v[116:119], v[28:31], v[48:51], v[116:119]
    ds_read_b64_tr_b16 v[62:63], v8 offset:512
    v_mfma_f32_16x16x32_bf16 v[120:123], v[32:35], v[48:51], v[120:123]
    ds_read_b128 v[16:19], v4 offset:51200
    v_mfma_f32_16x16x32_bf16 v[124:127], v[36:39], v[48:51], v[124:127]
    ds_read_b128 v[20:23], v4 offset:53248
    v_mfma_f32_16x16x32_bf16 v[128:131], v[40:43], v[48:51], v[128:131]
    ds_read_b128 v[24:27], v4 offset:55296
    v_mfma_f32_16x16x32_bf16 v[132:135], v[28:31], v[52:55], v[132:135]
    ds_read_b64_tr_b16 v[64:65], v9 offset:0
    v_mfma_f32_16x16x32_bf16 v[136:139], v[32:35], v[52:55], v[136:139]
    ds_read_b64_tr_b16 v[66:67], v9 offset:512
    v_mfma_f32_16x16x32_bf16 v[140:143], v[36:39], v[52:55], v[140:143]
    ds_read_b64_tr_b16 v[44:45], v10 offset:32768
    v_mfma_f32_16x16x32_bf16 v[144:147], v[40:43], v[52:55], v[144:147]
    s_branch IW_s4
IW_w4:
    s_branch IW_r4
IW_s4:
    ds_read_b64_tr_b16 v[46:47], v10 offset:33280
    v_mfma_f32_16x16x32_bf16 v[148:151], v[28:31], v[56:59], v[148:151]
    ds_read_b64_tr_b16 v[48:49], v11 offset:32768
    v_mfma_f32_16x16x32_bf16 v[152:155], v[32:35], v[56:59], v[152:155]
    ds_read_b64_tr_b16 v[50:51], v11 offset:33280
    v_mfma_f32_16x16x32_bf16 v[156:159], v[36:39], v[56:59], v[156:159]
    v_mfma_f32_16x16x32_bf16 v[160:163], v[40:43], v[56:59], v[160:163]
    s_waitcnt lgkmcnt(9)
    v_mfma_f32_16x16x32_bf16 v[100:103], v[12:15], v[60:63], v[100:103]
    ds_read_b128 v[28:31], v5 offset:49152
    s_waitcnt lgkmcnt(9)
    v_mfma_f32_16x16x32_bf16 v[104:107], v[16:19], v[60:63], v[104:107]
    ds_read_b64_tr_b16 v[52:53], v8 offset:4096
    s_waitcnt lgkmcnt(9)
    v_mfma_f32_16x16x32_bf16 v[108:111], v[20:23], v[60:63], v[108:111]
    ds_read_b64_tr_b16 v[54:55], v8 offset:4608
    s_waitcnt lgkmcnt(9)
    v_mfma_f32_16x16x32_bf16 v[112:115], v[24:27], v[60:63], v[112:115]
    ds_read_b128 v[32:35], v5 offset:51200
    s_waitcnt lgkmcnt(8)
    v_mfma_f32_16x16x32_bf16 v[116:119], v[12:15], v[64:67], v[116:119]
    ds_read_b128 v[36:39], v5 offset:53248
    v_mfma_f32_16x16x32_bf16 v[120:123], v[16:19], v[64:67], v[120:123]
    ds_read_b128 v[40:43], v5 offset:55296
    v_mfma_f32_16x16x32_bf16 v[124:127], v[20:23], v[64:67], v[124:127]
    ds_read_b64_tr_b16 v[56:57], v9 offset:4096
    v_mfma_f32_16x16x32_bf16 v[128:131], v[24:27], v[64:67], v[128:131]
    ds_read_b64_tr_b16 v[58:59], v9 offset:4608
    s_waitcnt lgkmcnt(10)
    v_mfma_f32_16x16x32_bf16 v[132:135], v[12:15], v[44:47], v[132:135]
    ds_read_b64_tr_b16 v[60:61], v10 offset:36864
    v_mfma_f32_16x16x32_bf16 v[136:139], v[16:19], v[44:47], v[136:139]
    ds_read_b64_tr_b16 v[62:63], v10 offset:37376
    v_mfma_f32_16x16x32_bf16 v[140:143], v[20:23], v[44:47], v[140:143]
    ds_read_b64_tr_b16 v[64:65], v11 offset:36864
    v_mfma_f32_16x16x32_bf16 v[144:147], v[24:27], v[44:47], v[144:147]
    ds_read_b64_tr_b16 v[66:67], v11 offset:37376
    s_waitcnt lgkmcnt(12)
    v_mfma_f32_16x16x32_bf16 v[148:151], v[12:15], v[48:51], v[148:151]
    v_mfma_f32_16x16x32_bf16 v[152:155], v[16:19], v[48:51], v[152:155]
    v_mfma_f32_16x16x32_bf16 v[156:159], v[20:23], v[48:51], v[156:159]
    v_mfma_f32_16x16x32_bf16 v[160:163], v[24:27], v[48:51], v[160:163]
    s_waitcnt lgkmcnt(9)
    v_mfma_f32_16x16x32_bf16 v[100:103], v[28:31], v[52:55], v[100:103]
    s_waitcnt lgkmcnt(8)
    v_mfma_f32_16x16x32_bf16 v[104:107], v[32:35], v[52:55], v[104:107]
    s_waitcnt lgkmcnt(0)
    s_barrier
    v_mfma_f32_16x16x32_bf16 v[108:111], v[36:39], v[52:55], v[108:111]
    ds_read_b128 v[12:15], v4 offset:0
    v_mfma_f32_16x16x32_bf16 v[112:115], v[40:43], v[52:55], v[112:115]
    ds_read_b64_tr_b16 v[44:45], v8 offset:8192
    v_mfma_f32_16x16x32_bf16 v[116:119], v[28:31], v[56:59], v[116:119]
    ds_read_b64_tr_b16 v[46:47], v8 offset:8704
    v_mfma_f32_16x16x32_bf16 v[120:123], v[32:35], v[56:59], v[120:123]
    ds_read_b128 v[16:19], v4 offset:2048
    v_mfma_f32_16x16x32_bf16 v[124:127], v[36:39], v[56:59], v[124:127]
    ds_read_b128 v[20:23], v4 offset:4096
    v_mfma_f32_16x16x32_bf16 v[128:131], v[40:43], v[56:59], v[128:131]
    ds_read_b128 v[24:27], v4 offset:6144
    v_mfma_f32_16x16x32_bf16 v[132:135], v[28:31], v[60:63], v[132:135]
    ds_read_b64_tr_b16 v[48:49], v9 offset:8192
    v_mfma_f32_16x16x32_bf16 v[136:139], v[32:35], v[60:63], v[136:139]
    ds_read_b64_tr_b16 v[50:51], v9 offset:8704
    v_mfma_f32_16x16x32_bf16 v[140:143], v[36:39], v[60:63], v[140:143]
    ds_read_b64_tr_b16 v[52:53], v8 offset:16384
    v_mfma_f32_16x16x32_bf16 v[144:147], v[40:43], v[60:63], v[144:147]
    ds_read_b64_tr_b16 v[54:55], v8 offset:16896
    v_mfma_f32_16x16x32_bf16 v[148:151], v[28:31], v[64:67], v[148:151]
    ds_read_b64_tr_b16 v[56:57], v9 offset:16384
    v_mfma_f32_16x16x32_bf16 v[152:155], v[32:35], v[64:67], v[152:155]
    ds_read_b64_tr_b16 v[58:59], v9 offset:16896
    v_mfma_f32_16x16x32_bf16 v[156:159], v[36:39], v[64:67], v[156:159]
    v_mfma_f32_16x16x32_bf16 v[160:163], v[40:43], v[64:67], v[160:163]
    s_waitcnt lgkmcnt(9)
    v_mfma_f32_16x16x32_bf16 v[100:103], v[12:15], v[44:47], v[100:103]
    ds_read_b128 v[28:31], v5 offset:0
    s_waitcnt lgkmcnt(9)
    v_mfma_f32_16x16x32_bf16 v[104:107], v[16:19], v[44:47], v[104:107]
    ds_read_b64_tr_b16 v[60:61], v8 offset:12288
    s_waitcnt lgkmcnt(9)
    v_mfma_f32_16x16x32_bf16 v[108:111], v[20:23], v[44:47], v[108:111]
    ds_read_b64_tr_b16 v[62:63], v8 offset:12800
    s_waitcnt lgkmcnt(9)
    v_mfma_f32_16x16x32_bf16 v[112:115], v[24:27], v[44:47], v[112:115]
    ds_read_b128 v[32:35], v5 offset:2048
    s_waitcnt lgkmcnt(8)
    v_mfma_f32_16x16x32_bf16 v[116:119], v[12:15], v[48:51], v[116:119]
    ds_read_b128 v[36:39], v5 offset:4096
    v_mfma_f32_16x16x32_bf16 v[120:123], v[16:19], v[48:51], v[120:123]
    ds_read_b128 v[40:43], v5 offset:6144
    v_mfma_f32_16x16x32_bf16 v[124:127], v[20:23], v[48:51], v[124:127]
    ds_read_b64_tr_b16 v[64:65], v9 offset:12288
    v_mfma_f32_16x16x32_bf16 v[128:131], v[24:27], v[48:51], v[128:131]
    ds_read_b64_tr_b16 v[66:67], v9 offset:12800
    s_waitcnt lgkmcnt(10)
    v_mfma_f32_16x16x32_bf16 v[132:135], v[12:15], v[52:55], v[132:135]
    ds_read_b64_tr_b16 v[44:45], v8 offset:20480
    v_mfma_f32_16x16x32_bf16 v[136:139], v[16:19], v[52:55], v[136:139]
    ds_read_b64_tr_b16 v[46:47], v8 offset:20992
    v_mfma_f32_16x16x32_bf16 v[140:143], v[20:23], v[52:55], v[140:143]
    ds_read_b64_tr_b16 v[48:49], v9 offset:20480
    v_mfma_f32_16x16x32_bf16 v[144:147], v[24:27], v[52:55], v[144:147]
    ds_read_b64_tr_b16 v[50:51], v9 offset:20992
    s_waitcnt lgkmcnt(12)
    v_mfma_f32_16x16x32_bf16 v[148:151], v[12:15], v[56:59], v[148:151]
    v_mfma_f32_16x16x32_bf16 v[152:155], v[16:19], v[56:59], v[152:155]
    v_mfma_f32_16x16x32_bf16 v[156:159], v[20:23], v[56:59], v[156:159]
    v_mfma_f32_16x16x32_bf16 v[160:163], v[24:27], v[56:59], v[160:163]
    s_waitcnt lgkmcnt(9)
    v_mfma_f32_16x16x32_bf16 v[100:103], v[28:31], v[60:63], v[100:103]
    s_waitcnt lgkmcnt(8)
    v_mfma_f32_16x16x32_bf16 v[104:107], v[32:35], v[60:63], v[104:107]
    s_waitcnt lgkmcnt(0)
    s_barrier
    v_mfma_f32_16x16x32_bf16 v[108:111], v[36:39], v[60:63], v[108:111]
    ds_read_b128 v[12:15], v4 offset:16384
    v_mfma_f32_16x16x32_bf16 v[112:115], v[40:43], v[60:63], v[112:115]
    ds_read_b64_tr_b16 v[52:53], v8 offset:24576
    v_mfma_f32_16x16x32_bf16 v[116:119], v[28:31], v[64:67], v[116:119]
    ds_read_b64_tr_b16 v[54:55], v8 offset:25088
    v_mfma_f32_16x16x32_bf16 v[120:123], v[32:35], v[64:67], v[120:123]
    ds_read_b128 v[16:19], v4 offset:18432
    v_mfma_f32_16x16x32_bf16 v[124:127], v[36:39], v[64:67], v[124:127]
    ds_read_b128 v[20:23], v4 offset:20480
    v_mfma_f32_16x16x32_bf16 v[128:131], v[40:43], v[64:67], v[128:131]
    ds_read_b128 v[24:27], v4 offset:22528
    v_mfma_f32_16x16x32_bf16 v[132:135], v[28:31], v[44:47], v[132:135]
    ds_read_b64_tr_b16 v[56:57], v9 offset:24576
    v_mfma_f32_16x16x32_bf16 v[136:139], v[32:35], v[44:47], v[136:139]
    ds_read_b64_tr_b16 v[58:59], v9 offset:25088
    v_mfma_f32_16x16x32_bf16 v[140:143], v[36:39], v[44:47], v[140:143]
    ds_read_b64_tr_b16 v[60:61], v10 offset:0
    v_mfma_f32_16x16x32_bf16 v[144:147], v[40:43], v[44:47], v[144:147]
    ds_read_b64_tr_b16 v[62:63], v10 offset:512
    v_mfma_f32_16x16x32_bf16 v[148:151], v[28:31], v[48:51], v[148:151]
    ds_read_b64_tr_b16 v[64:65], v11 offset:0
    v_mfma_f32_16x16x32_bf16 v[152:155], v[32:35], v[48:51], v[152:155]
    ds_read_b64_tr_b16 v[66:67], v11 offset:512
    v_mfma_f32_16x16x32_bf16 v[156:159], v[36:39], v[48:51], v[156:159]
    v_mfma_f32_16x16x32_bf16 v[160:163], v[40:43], v[48:51], v[160:163]
    s_waitcnt lgkmcnt(9)
    v_mfma_f32_16x16x32_bf16 v[100:103], v[12:15], v[52:55], v[100:103]
    ds_read_b128 v[28:31], v5 offset:16384
    s_waitcnt lgkmcnt(9)
    v_mfma_f32_16x16x32_bf16 v[104:107], v[16:19], v[52:55], v[104:107]
    ds_read_b64_tr_b16 v[44:45], v8 offset:28672
    s_waitcnt lgkmcnt(9)
    v_mfma_f32_16x16x32_bf16 v[108:111], v[20:23], v[52:55], v[108:111]
    ds_read_b64_tr_b16 v[46:47], v8 offset:29184
    s_waitcnt lgkmcnt(9)
    v_mfma_f32_16x16x32_bf16 v[112:115], v[24:27], v[52:55], v[112:115]
    ds_read_b128 v[32:35], v5 offset:18432
    s_waitcnt lgkmcnt(8)
    v_mfma_f32_16x16x32_bf16 v[116:119], v[12:15], v[56:59], v[116:119]
    ds_read_b128 v[36:39], v5 offset:20480
    v_mfma_f32_16x16x32_bf16 v[120:123], v[16:19], v[56:59], v[120:123]
    ds_read_b128 v[40:43], v5 offset:22528
    v_mfma_f32_16x16x32_bf16 v[124:127], v[20:23], v[56:59], v[124:127]
    ds_read_b64_tr_b16 v[48:49], v9 offset:28672
    v_mfma_f32_16x16x32_bf16 v[128:131], v[24:27], v[56:59], v[128:131]
    ds_read_b64_tr_b16 v[50:51], v9 offset:29184
    s_waitcnt lgkmcnt(10)
    v_mfma_f32_16x16x32_bf16 v[132:135], v[12:15], v[60:63], v[132:135]
    ds_read_b64_tr_b16 v[52:53], v10 offset:4096
    v_mfma_f32_16x16x32_bf16 v[136:139], v[16:19], v[60:63], v[136:139]
    ds_read_b64_tr_b16 v[54:55], v10 offset:4608
    v_mfma_f32_16x16x32_bf16 v[140:143], v[20:23], v[60:63], v[140:143]
    ds_read_b64_tr_b16 v[56:57], v11 offset:4096
    v_mfma_f32_16x16x32_bf16 v[144:147], v[24:27], v[60:63], v[144:147]
    ds_read_b64_tr_b16 v[58:59], v11 offset:4608
    s_waitcnt lgkmcnt(12)
    v_mfma_f32_16x16x32_bf16 v[148:151], v[12:15], v[64:67], v[148:151]
    v_mfma_f32_16x16x32_bf16 v[152:155], v[16:19], v[64:67], v[152:155]
    v_mfma_f32_16x16x32_bf16 v[156:159], v[20:23], v[64:67], v[156:159]
    v_mfma_f32_16x16x32_bf16 v[160:163], v[24:27], v[64:67], v[160:163]
    s_waitcnt lgkmcnt(9)
    v_mfma_f32_16x16x32_bf16 v[100:103], v[28:31], v[44:47], v[100:103]
    s_waitcnt lgkmcnt(8)
    v_mfma_f32_16x16x32_bf16 v[104:107], v[32:35], v[44:47], v[104:107]
    s_waitcnt lgkmcnt(0)
    s_barrier
    v_mfma_f32_16x16x32_bf16 v[108:111], v[36:39], v[44:47], v[108:111]
    ds_read_b128 v[12:15], v4 offset:32768
    v_mfma_f32_16x16x32_bf16 v[112:115], v[40:43], v[44:47], v[112:115]
    ds_read_b64_tr_b16 v[60:61], v10 offset:8192
    v_mfma_f32_16x16x32_bf16 v[116:119], v[28:31], v[48:51], v[116:119]
    ds_read_b64_tr_b16 v[62:63], v10 offset:8704
    v_mfma_f32_16x16x32_bf16 v[120:123], v[32:35], v[48:51], v[120:123]
    ds_read_b128 v[16:19], v4 offset:34816
    v_mfma_f32_16x16x32_bf16 v[124:127], v[36:39], v[48:51], v[124:127]
    ds_read_b128 v[20:23], v4 offset:36864
    v_mfma_f32_16x16x32_bf16 v[128:131], v[40:43], v[48:51], v[128:131]
    ds_read_b128 v[24:27], v4 offset:38912
    v_mfma_f32_16x16x32_bf16 v[132:135], v[28:31], v[52:55], v[132:135]
    ds_read_b64_tr_b16 v[64:65], v11 offset:8192
    v_mfma_f32_16x16x32_bf16 v[136:139], v[32:35], v[52:55], v[136:139]
    ds_read_b64_tr_b16 v[66:67], v11 offset:8704
    v_mfma_f32_16x16x32_bf16 v[140:143], v[36:39], v[52:55], v[140:143]
    ds_read_b64_tr_b16 v[44:45], v10 offset:16384
    v_mfma_f32_16x16x32_bf16 v[144:147], v[40:43], v[52:55], v[144:147]
    ds_read_b64_tr_b16 v[46:47], v10 offset:16896
    v_mfma_f32_16x16x32_bf16 v[148:151], v[28:31], v[56:59], v[148:151]
    ds_read_b64_tr_b16 v[48:49], v11 offset:16384
    v_mfma_f32_16x16x32_bf16 v[152:155], v[32:35], v[56:59], v[152:155]
    ds_read_b64_tr_b16 v[50:51], v11 offset:16896
    v_mfma_f32_16x16x32_bf16 v[156:159], v[36:39], v[56:59], v[156:159]
    v_mfma_f32_16x16x32_bf16 v[160:163], v[40:43], v[56:59], v[160:163]
    s_waitcnt lgkmcnt(9)
    v_mfma_f32_16x16x32_bf16 v[100:103], v[12:15], v[60:63], v[100:103]
    ds_read_b128 v[28:31], v5 offset:32768
    s_waitcnt lgkmcnt(9)
    v_mfma_f32_16x16x32_bf16 v[104:107], v[16:19], v[60:63], v[104:107]
    ds_read_b64_tr_b16 v[52:53], v10 offset:12288
    s_waitcnt lgkmcnt(9)
    v_mfma_f32_16x16x32_bf16 v[108:111], v[20:23], v[60:63], v[108:111]
    ds_read_b64_tr_b16 v[54:55], v10 offset:12800
    s_waitcnt lgkmcnt(9)
    v_mfma_f32_16x16x32_bf16 v[112:115], v[24:27], v[60:63], v[112:115]
    ds_read_b128 v[32:35], v5 offset:34816
    s_waitcnt lgkmcnt(8)
    v_mfma_f32_16x16x32_bf16 v[116:119], v[12:15], v[64:67], v[116:119]
    ds_read_b128 v[36:39], v5 offset:36864
    v_mfma_f32_16x16x32_bf16 v[120:123], v[16:19], v[64:67], v[120:123]
    ds_read_b128 v[40:43], v5 offset:38912
    v_mfma_f32_16x16x32_bf16 v[124:127], v[20:23], v[64:67], v[124:127]
    ds_read_b64_tr_b16 v[56:57], v11 offset:12288
    v_mfma_f32_16x16x32_bf16 v[128:131], v[24:27], v[64:67], v[128:131]
    ds_read_b64_tr_b16 v[58:59], v11 offset:12800
    s_waitcnt lgkmcnt(10)
    v_mfma_f32_16x16x32_bf16 v[132:135], v[12:15], v[44:47], v[132:135]
    ds_read_b64_tr_b16 v[60:61], v10 offset:20480
    v_mfma_f32_16x16x32_bf16 v[136:139], v[16:19], v[44:47], v[136:139]
    ds_read_b64_tr_b16 v[62:63], v10 offset:20992
    v_mfma_f32_16x16x32_bf16 v[140:143], v[20:23], v[44:47], v[140:143]
    ds_read_b64_tr_b16 v[64:65], v11 offset:20480
    v_mfma_f32_16x16x32_bf16 v[144:147], v[24:27], v[44:47], v[144:147]
    ds_read_b64_tr_b16 v[66:67], v11 offset:20992
    s_waitcnt lgkmcnt(12)
    v_mfma_f32_16x16x32_bf16 v[148:151], v[12:15], v[48:51], v[148:151]
    v_mfma_f32_16x16x32_bf16 v[152:155], v[16:19], v[48:51], v[152:155]
    v_mfma_f32_16x16x32_bf16 v[156:159], v[20:23], v[48:51], v[156:159]
    v_mfma_f32_16x16x32_bf16 v[160:163], v[24:27], v[48:51], v[160:163]
    s_waitcnt lgkmcnt(9)
    v_mfma_f32_16x16x32_bf16 v[100:103], v[28:31], v[52:55], v[100:103]
    s_waitcnt lgkmcnt(8)
    v_mfma_f32_16x16x32_bf16 v[104:107], v[32:35], v[52:55], v[104:107]
    s_waitcnt lgkmcnt(0)
    s_barrier
    v_mfma_f32_16x16x32_bf16 v[108:111], v[36:39], v[52:55], v[108:111]
    ds_read_b128 v[12:15], v4 offset:49152
    v_mfma_f32_16x16x32_bf16 v[112:115], v[40:43], v[52:55], v[112:115]
    ds_read_b64_tr_b16 v[44:45], v8 offset:0
    v_mfma_f32_16x16x32_bf16 v[116:119], v[28:31], v[56:59], v[116:119]
    ds_read_b64_tr_b16 v[46:47], v8 offset:512
    v_mfma_f32_16x16x32_bf16 v[120:123], v[32:35], v[56:59], v[120:123]
    ds_read_b128 v[16:19], v4 offset:51200
    v_mfma_f32_16x16x32_bf16 v[124:127], v[36:39], v[56:59], v[124:127]
    ds_read_b128 v[20:23], v4 offset:53248
    v_mfma_f32_16x16x32_bf16 v[128:131], v[40:43], v[56:59], v[128:131]
    ds_read_b128 v[24:27], v4 offset:55296
    v_mfma_f32_16x16x32_bf16 v[132:135], v[28:31], v[60:63], v[132:135]
    ds_read_b64_tr_b16 v[48:49], v9 offset:0
    v_mfma_f32_16x16x32_bf16 v[136:139], v[32:35], v[60:63], v[136:139]
    ds_read_b64_tr_b16 v[50:51], v9 offset:512
    v_mfma_f32_16x16x32_bf16 v[140:143], v[36:39], v[60:63], v[140:143]
    ds_read_b64_tr_b16 v[52:53], v10 offset:24576
    v_mfma_f32_16x16x32_bf16 v[144:147], v[40:43], v[60:63], v[144:147]
    ds_read_b64_tr_b16 v[54:55], v10 offset:25088
    v_mfma_f32_16x16x32_bf16 v[148:151], v[28:31], v[64:67], v[148:151]
    ds_read_b64_tr_b16 v[56:57], v11 offset:24576
    v_mfma_f32_16x16x32_bf16 v[152:155], v[32:35], v[64:67], v[152:155]
    ds_read_b64_tr_b16 v[58:59], v11 offset:25088
    v_mfma_f32_16x16x32_bf16 v[156:159], v[36:39], v[64:67], v[156:159]
    v_mfma_f32_16x16x32_bf16 v[160:163], v[40:43], v[64:67], v[160:163]
    ds_read_b32 v68, v1 offset:48
    s_waitcnt lgkmcnt(10)
    v_mfma_f32_16x16x32_bf16 v[100:103], v[12:15], v[44:47], v[100:103]
    ds_read_b128 v[28:31], v5 offset:49152
    s_waitcnt lgkmcnt(10)
    v_mfma_f32_16x16x32_bf16 v[104:107], v[16:19], v[44:47], v[104:107]
    ds_read_b64_tr_b16 v[60:61], v8 offset:4096
    s_waitcnt lgkmcnt(10)
    v_mfma_f32_16x16x32_bf16 v[108:111], v[20:23], v[44:47], v[108:111]
    ds_read_b64_tr_b16 v[62:63], v8 offset:4608
    s_waitcnt lgkmcnt(10)
    v_mfma_f32_16x16x32_bf16 v[112:115], v[24:27], v[44:47], v[112:115]
    ds_read_b128 v[32:35], v5 offset:51200
    s_waitcnt lgkmcnt(9)
    v_mfma_f32_16x16x32_bf16 v[116:119], v[12:15], v[48:51], v[116:119]
    ds_read_b128 v[36:39], v5 offset:53248
    v_mfma_f32_16x16x32_bf16 v[120:123], v[16:19], v[48:51], v[120:123]
    ds_read_b128 v[40:43], v5 offset:55296
    v_mfma_f32_16x16x32_bf16 v[124:127], v[20:23], v[48:51], v[124:127]
    ds_read_b64_tr_b16 v[64:65], v9 offset:4096
    v_mfma_f32_16x16x32_bf16 v[128:131], v[24:27], v[48:51], v[128:131]
    ds_read_b64_tr_b16 v[66:67], v9 offset:4608
    s_waitcnt lgkmcnt(11)
    v_mfma_f32_16x16x32_bf16 v[132:135], v[12:15], v[52:55], v[132:135]
    ds_read_b64_tr_b16 v[44:45], v10 offset:28672
    v_mfma_f32_16x16x32_bf16 v[136:139], v[16:19], v[52:55], v[136:139]
    ds_read_b64_tr_b16 v[46:47], v10 offset:29184
    v_mfma_f32_16x16x32_bf16 v[140:143], v[20:23], v[52:55], v[140:143]
    ds_read_b64_tr_b16 v[48:49], v11 offset:28672
    v_mfma_f32_16x16x32_bf16 v[144:147], v[24:27], v[52:55], v[144:147]
    ds_read_b64_tr_b16 v[50:51], v11 offset:29184
    s_waitcnt lgkmcnt(13)
    v_mfma_f32_16x16x32_bf16 v[148:151], v[12:15], v[56:59], v[148:151]
    v_mfma_f32_16x16x32_bf16 v[152:155], v[16:19], v[56:59], v[152:155]
    v_mfma_f32_16x16x32_bf16 v[156:159], v[20:23], v[56:59], v[156:159]
    v_mfma_f32_16x16x32_bf16 v[160:163], v[24:27], v[56:59], v[160:163]
    s_waitcnt lgkmcnt(9)
    v_mfma_f32_16x16x32_bf16 v[100:103], v[28:31], v[60:63], v[100:103]
    v_lshlrev_b32 v18, 4, v0
    v_add_u32 v12, s52, v18
    s_waitcnt lgkmcnt(8)
    v_mfma_f32_16x16x32_bf16 v[104:107], v[32:35], v[60:63], v[104:107]
    v_xor_b32 v13, 4096, v12
    v_and_b32 v14, 0x30, v0
    s_waitcnt lgkmcnt(0)
    s_barrier
    v_cmp_gt_u32 vcc, 1, v68
    s_nop 0
    s_and_b32 vcc_lo, vcc_lo, 3
    s_cbranch_scc0 SCK_13
    v_and_b32 v69, 1, v0
    v_lshlrev_b32 v69, 2, v69
    v_add_u32 v69, 159088, v69
    ds_read_b32 v68, v69 offset:0
FW_14:
    s_waitcnt lgkmcnt(0)
    v_cmp_gt_u32 vcc, 1, v68
    s_cbranch_vccz FO_15
    ds_read_b32 v68, v69 offset:0
    s_branch FW_14
FO_15:
SCK_13:
    v_mfma_f32_16x16x32_bf16 v[108:111], v[36:39], v[60:63], v[108:111]
    ds_read_b128 v[68:71], v164 offset:0
    v_add_u32 v14, s53, v14
    v_mfma_f32_16x16x32_bf16 v[112:115], v[40:43], v[60:63], v[112:115]
    ds_read2_b32 v[52:53], v165 offset0:64 offset1:64
    v_xor_b32 v15, 64, v14
    v_mfma_f32_16x16x32_bf16 v[116:119], v[28:31], v[64:67], v[116:119]
    ds_read2_b32 v[54:55], v2 offset0:64 offset1:64
    v_lshlrev_b32 v19, 2, v0
    v_mfma_f32_16x16x32_bf16 v[120:123], v[32:35], v[64:67], v[120:123]
    ds_read2_b32 v[56:57], v165 offset0:128 offset1:128
    v_add_u32 v16, s53, v19
    v_mfma_f32_16x16x32_bf16 v[124:127], v[36:39], v[64:67], v[124:127]
    ds_read2_b32 v[58:59], v2 offset0:128 offset1:128
    v_xor_b32 v17, 256, v16
    v_mfma_f32_16x16x32_bf16 v[128:131], v[40:43], v[64:67], v[128:131]
    ds_read_b128 v[72:75], v164 offset:1024
    v_xor_b32 v18, 8, v3
    v_mfma_f32_16x16x32_bf16 v[132:135], v[28:31], v[44:47], v[132:135]
    ds_read_b128 v[76:79], v164 offset:64
    v_writelane_b32 v18, s50, 1
    v_mfma_f32_16x16x32_bf16 v[136:139], v[32:35], v[44:47], v[136:139]
    ds_read_b128 v[80:83], v164 offset:1088
    v_mov_b32 v20, 0x3f803f80
    v_mfma_f32_16x16x32_bf16 v[140:143], v[36:39], v[44:47], v[140:143]
    ds_read_b128 v[84:87], v164 offset:128
    v_mov_b32 v21, 0x3f803f80
    v_mfma_f32_16x16x32_bf16 v[144:147], v[40:43], v[44:47], v[144:147]
    ds_read_b128 v[88:91], v164 offset:1152
    v_mov_b32 v22, 0x3f803f80
    v_mfma_f32_16x16x32_bf16 v[148:151], v[28:31], v[48:51], v[148:151]
    ds_read_b128 v[92:95], v164 offset:192
    v_mov_b32 v23, 0x3f803f80
    v_mfma_f32_16x16x32_bf16 v[152:155], v[32:35], v[48:51], v[152:155]
    ds_read_b128 v[96:99], v164 offset:1216
    v_mov_b32 v24, 1
    v_and_b32 v4, 15, v0
    v_mfma_f32_16x16x32_bf16 v[156:159], v[36:39], v[48:51], v[156:159]
    v_bfe_u32 v5, v0, 4, 1
    v_lshlrev_b32 v5, 5, v5
    v_mfma_f32_16x16x32_bf16 v[160:163], v[40:43], v[48:51], v[160:163]
    v_lshrrev_b32 v6, 5, v0
    v_lshl_add_u32 v5, v6, 4, v5
    v_lshl_add_u32 v7, v4, 11, v5
    v_lshlrev_b32 v6, 4, v0
    v_and_b32 v8, 0x300, v6
    v_lshl_add_u32 v8, v4, 2, v8
    s_waitcnt lgkmcnt(10)
    v_pk_fma_f32 v[100:101], v[68:69], v[52:53], v[100:101]
    v_pk_fma_f32 v[102:103], v[70:71], v[52:53], v[102:103]
    s_waitcnt lgkmcnt(9)
    v_pk_fma_f32 v[116:117], v[68:69], v[54:55], v[116:117]
    v_pk_fma_f32 v[118:119], v[70:71], v[54:55], v[118:119]
    s_waitcnt lgkmcnt(8)
    v_pk_fma_f32 v[132:133], v[68:69], v[56:57], v[132:133]
    v_pk_fma_f32 v[134:135], v[70:71], v[56:57], v[134:135]
    s_waitcnt lgkmcnt(7)
    v_pk_fma_f32 v[148:149], v[68:69], v[58:59], v[148:149]
    v_pk_fma_f32 v[150:151], v[70:71], v[58:59], v[150:151]
    s_waitcnt lgkmcnt(6)
    v_pk_mul_f32 v[100:101], v[100:101], v[72:73]
    v_pk_mul_f32 v[102:103], v[102:103], v[74:75]
    v_pk_mul_f32 v[116:117], v[116:117], v[72:73]
    v_pk_mul_f32 v[118:119], v[118:119], v[74:75]
    v_pk_mul_f32 v[132:133], v[132:133], v[72:73]
    v_pk_mul_f32 v[134:135], v[134:135], v[74:75]
    v_pk_mul_f32 v[148:149], v[148:149], v[72:73]
    v_pk_mul_f32 v[150:151], v[150:151], v[74:75]
    v_exp_f32 v28, v100 clamp
    v_exp_f32 v29, v101 clamp
    v_exp_f32 v30, v102 clamp
    v_exp_f32 v31, v103 clamp
    v_exp_f32 v32, v116 clamp
    v_exp_f32 v33, v117 clamp
    v_exp_f32 v34, v118 clamp
    v_exp_f32 v35, v119 clamp
    v_cvt_pk_bf16_f32 v132, v132, v133
    v_cvt_pk_bf16_f32 v133, v134, v135
    v_cvt_pk_bf16_f32 v148, v148, v149
    v_cvt_pk_bf16_f32 v149, v150, v151
    v_pk_mul_f32 v[100:101], v[100:101], s[40:41] clamp
    v_pk_mul_f32 v[102:103], v[102:103], s[40:41] clamp
    v_pk_mul_f32 v[116:117], v[116:117], s[40:41] clamp
    v_pk_mul_f32 v[118:119], v[118:119], s[40:41] clamp
    v_pk_add_f32 v[28:29], v[28:29], s[74:75]
    v_pk_add_f32 v[30:31], v[30:31], s[74:75]
    v_pk_add_f32 v[32:33], v[32:33], s[74:75]
    v_pk_add_f32 v[34:35], v[34:35], s[74:75]
    v_pk_fma_f32 v[100:101], v[100:101], s[76:77], v[28:29]
    v_pk_fma_f32 v[102:103], v[102:103], s[76:77], v[30:31]
    v_pk_fma_f32 v[116:117], v[116:117], s[76:77], v[32:33]
    v_pk_fma_f32 v[118:119], v[118:119], s[76:77], v[34:35]
    v_cvt_pk_bf16_f32 v100, v100, v101
    v_cvt_pk_bf16_f32 v101, v102, v103
    v_cvt_pk_bf16_f32 v116, v116, v117
    v_cvt_pk_bf16_f32 v117, v118, v119
    s_waitcnt lgkmcnt(5)
    v_pk_fma_f32 v[104:105], v[76:77], v[52:53], v[104:105]
    v_pk_fma_f32 v[106:107], v[78:79], v[52:53], v[106:107]
    v_pk_fma_f32 v[120:121], v[76:77], v[54:55], v[120:121]
    v_pk_fma_f32 v[122:123], v[78:79], v[54:55], v[122:123]
    v_pk_fma_f32 v[136:137], v[76:77], v[56:57], v[136:137]
    v_pk_fma_f32 v[138:139], v[78:79], v[56:57], v[138:139]
    v_pk_fma_f32 v[152:153], v[76:77], v[58:59], v[152:153]
    v_pk_fma_f32 v[154:155], v[78:79], v[58:59], v[154:155]
    s_waitcnt lgkmcnt(4)
    v_pk_mul_f32 v[104:105], v[104:105], v[80:81]
    v_pk_mul_f32 v[106:107], v[106:107], v[82:83]
    v_pk_mul_f32 v[120:121], v[120:121], v[80:81]
    v_pk_mul_f32 v[122:123], v[122:123], v[82:83]
    v_pk_mul_f32 v[136:137], v[136:137], v[80:81]
    v_pk_mul_f32 v[138:139], v[138:139], v[82:83]
    v_pk_mul_f32 v[152:153], v[152:153], v[80:81]
    v_pk_mul_f32 v[154:155], v[154:155], v[82:83]
    v_exp_f32 v36, v104 clamp
    v_exp_f32 v37, v105 clamp
    v_exp_f32 v38, v106 clamp
    v_exp_f32 v39, v107 clamp
    v_exp_f32 v40, v120 clamp
    v_exp_f32 v41, v121 clamp
    v_exp_f32 v42, v122 clamp
    v_exp_f32 v43, v123 clamp
    v_cvt_pk_bf16_f32 v134, v136, v137
    v_cvt_pk_bf16_f32 v135, v138, v139
    v_cvt_pk_bf16_f32 v150, v152, v153
    v_cvt_pk_bf16_f32 v151, v154, v155
    v_pk_mul_f32 v[104:105], v[104:105], s[40:41] clamp
    v_pk_mul_f32 v[106:107], v[106:107], s[40:41] clamp
    v_pk_mul_f32 v[120:121], v[120:121], s[40:41] clamp
    v_pk_mul_f32 v[122:123], v[122:123], s[40:41] clamp
    v_pk_add_f32 v[36:37], v[36:37], s[74:75]
    v_pk_add_f32 v[38:39], v[38:39], s[74:75]
    v_pk_add_f32 v[40:41], v[40:41], s[74:75]
    v_pk_add_f32 v[42:43], v[42:43], s[74:75]
    v_pk_fma_f32 v[104:105], v[104:105], s[76:77], v[36:37]
    v_pk_fma_f32 v[106:107], v[106:107], s[76:77], v[38:39]
    v_pk_fma_f32 v[120:121], v[120:121], s[76:77], v[40:41]
    v_pk_fma_f32 v[122:123], v[122:123], s[76:77], v[42:43]
    v_cvt_pk_bf16_f32 v102, v104, v105
    v_cvt_pk_bf16_f32 v103, v106, v107
    v_cvt_pk_bf16_f32 v118, v120, v121
    v_cvt_pk_bf16_f32 v119, v122, v123
    s_waitcnt lgkmcnt(3)
    v_pk_fma_f32 v[108:109], v[84:85], v[52:53], v[108:109]
    v_pk_fma_f32 v[110:111], v[86:87], v[52:53], v[110:111]
    v_pk_fma_f32 v[124:125], v[84:85], v[54:55], v[124:125]
    v_pk_fma_f32 v[126:127], v[86:87], v[54:55], v[126:127]
    v_pk_fma_f32 v[140:141], v[84:85], v[56:57], v[140:141]
    v_pk_fma_f32 v[142:143], v[86:87], v[56:57], v[142:143]
    v_pk_fma_f32 v[156:157], v[84:85], v[58:59], v[156:157]
    v_pk_fma_f32 v[158:159], v[86:87], v[58:59], v[158:159]
    s_waitcnt lgkmcnt(2)
    v_pk_mul_f32 v[108:109], v[108:109], v[88:89]
    v_pk_mul_f32 v[110:111], v[110:111], v[90:91]
    v_pk_mul_f32 v[124:125], v[124:125], v[88:89]
    v_pk_mul_f32 v[126:127], v[126:127], v[90:91]
    v_pk_mul_f32 v[140:141], v[140:141], v[88:89]
    v_pk_mul_f32 v[142:143], v[142:143], v[90:91]
    v_pk_mul_f32 v[156:157], v[156:157], v[88:89]
    v_pk_mul_f32 v[158:159], v[158:159], v[90:91]
    v_mfma_f32_16x16x32_bf16 v[60:63], v[148:151], v[100:103], 0
    v_exp_f32 v28, v108 clamp
    v_exp_f32 v29, v109 clamp
    v_mfma_f32_16x16x32_bf16 v[64:67], v[148:151], v[116:119], 0
    v_exp_f32 v30, v110 clamp
    v_exp_f32 v31, v111 clamp
    v_mfma_f32_16x16x32_bf16 v[68:71], v[100:103], v[20:23], 0
    v_exp_f32 v32, v124 clamp
    v_exp_f32 v33, v125 clamp
    v_exp_f32 v34, v126 clamp
    v_exp_f32 v35, v127 clamp
    v_cvt_pk_bf16_f32 v136, v140, v141
    v_cvt_pk_bf16_f32 v137, v142, v143
    v_cvt_pk_bf16_f32 v152, v156, v157
    v_cvt_pk_bf16_f32 v153, v158, v159
    v_pk_mul_f32 v[108:109], v[108:109], s[40:41] clamp
    v_pk_mul_f32 v[110:111], v[110:111], s[40:41] clamp
    v_pk_mul_f32 v[124:125], v[124:125], s[40:41] clamp
    v_pk_mul_f32 v[126:127], v[126:127], s[40:41] clamp
    v_pk_add_f32 v[28:29], v[28:29], s[74:75]
    v_pk_add_f32 v[30:31], v[30:31], s[74:75]
    v_pk_add_f32 v[32:33], v[32:33], s[74:75]
    v_pk_add_f32 v[34:35], v[34:35], s[74:75]
    v_pk_fma_f32 v[108:109], v[108:109], s[76:77], v[28:29]
    v_pk_fma_f32 v[110:111], v[110:111], s[76:77], v[30:31]
    v_pk_fma_f32 v[124:125], v[124:125], s[76:77], v[32:33]
    v_pk_fma_f32 v[126:127], v[126:127], s[76:77], v[34:35]
    v_cvt_pk_bf16_f32 v104, v108, v109
    v_cvt_pk_bf16_f32 v105, v110, v111
    v_cvt_pk_bf16_f32 v120, v124, v125
    v_cvt_pk_bf16_f32 v121, v126, v127
    s_waitcnt lgkmcnt(1)
    v_pk_fma_f32 v[112:113], v[92:93], v[52:53], v[112:113]
    v_pk_fma_f32 v[114:115], v[94:95], v[52:53], v[114:115]
    v_pk_fma_f32 v[128:129], v[92:93], v[54:55], v[128:129]
    v_pk_fma_f32 v[130:131], v[94:95], v[54:55], v[130:131]
    v_pk_fma_f32 v[144:145], v[92:93], v[56:57], v[144:145]
    v_pk_fma_f32 v[146:147], v[94:95], v[56:57], v[146:147]
    v_pk_fma_f32 v[160:161], v[92:93], v[58:59], v[160:161]
    v_pk_fma_f32 v[162:163], v[94:95], v[58:59], v[162:163]
    s_waitcnt lgkmcnt(0)
    v_pk_mul_f32 v[112:113], v[112:113], v[96:97]
    v_pk_mul_f32 v[114:115], v[114:115], v[98:99]
    v_pk_mul_f32 v[128:129], v[128:129], v[96:97]
    v_pk_mul_f32 v[130:131], v[130:131], v[98:99]
    v_pk_mul_f32 v[144:145], v[144:145], v[96:97]
    v_pk_mul_f32 v[146:147], v[146:147], v[98:99]
    v_pk_mul_f32 v[160:161], v[160:161], v[96:97]
    v_pk_mul_f32 v[162:163], v[162:163], v[98:99]
    v_mfma_f32_16x16x32_bf16 v[72:75], v[116:119], v[20:23], 0
    v_exp_f32 v36, v112 clamp
    v_exp_f32 v37, v113 clamp
    v_mfma_f32_16x16x32_bf16 v[44:47], v[132:135], v[100:103], 0
    v_exp_f32 v38, v114 clamp
    v_exp_f32 v39, v115 clamp
    v_mfma_f32_16x16x32_bf16 v[48:51], v[132:135], v[116:119], 0
    v_exp_f32 v40, v128 clamp
    v_exp_f32 v41, v129 clamp
    v_exp_f32 v42, v130 clamp
    v_exp_f32 v43, v131 clamp
    v_cvt_pk_bf16_f32 v138, v144, v145
    s_branch IW_s5
IW_w5:
    s_branch IW_r5
IW_s5:
    v_cvt_pk_bf16_f32 v139, v146, v147
    v_cvt_pk_bf16_f32 v154, v160, v161
    v_cvt_pk_bf16_f32 v155, v162, v163
    v_pk_mul_f32 v[112:113], v[112:113], s[40:41] clamp
    v_pk_mul_f32 v[114:115], v[114:115], s[40:41] clamp
    v_pk_mul_f32 v[128:129], v[128:129], s[40:41] clamp
    v_pk_mul_f32 v[130:131], v[130:131], s[40:41] clamp
    v_pk_add_f32 v[36:37], v[36:37], s[74:75]
    v_pk_add_f32 v[38:39], v[38:39], s[74:75]
    v_pk_add_f32 v[40:41], v[40:41], s[74:75]
    v_pk_add_f32 v[42:43], v[42:43], s[74:75]
    v_pk_fma_f32 v[112:113], v[112:113], s[76:77], v[36:37]
    v_pk_fma_f32 v[114:115], v[114:115], s[76:77], v[38:39]
    v_pk_fma_f32 v[128:129], v[128:129], s[76:77], v[40:41]
    v_pk_fma_f32 v[130:131], v[130:131], s[76:77], v[42:43]
    v_cvt_pk_bf16_f32 v106, v112, v113
    v_cvt_pk_bf16_f32 v107, v114, v115
    v_cvt_pk_bf16_f32 v122, v128, v129
    v_cvt_pk_bf16_f32 v123, v130, v131
    v_mfma_f32_16x16x32_bf16 v[60:63], v[152:155], v[104:107], v[60:63]
    s_nop 0
    v_mfma_f32_16x16x32_bf16 v[64:67], v[152:155], v[120:123], v[64:67]
    v_mfma_f32_16x16x32_bf16 v[68:71], v[104:107], v[20:23], v[68:71]
    v_mfma_f32_16x16x32_bf16 v[72:75], v[120:123], v[20:23], v[72:75]
    v_mfma_f32_16x16x32_bf16 v[44:47], v[136:139], v[104:107], v[44:47]
    v_mfma_f32_16x16x32_bf16 v[48:51], v[136:139], v[120:123], v[48:51]
    buffer_load_dwordx4 v[140:143], v7, s[12:15], s42 offen offset:0
    buffer_load_dwordx4 v[144:147], v7, s[12:15], s42 offen offset:64
    buffer_load_dwordx4 v[156:159], v7, s[12:15], s43 offen offset:0
    buffer_load_dwordx4 v[160:163], v7, s[12:15], s43 offen offset:64
    ds_write_b128 v12, v[60:63] offset:0
    ds_write_b128 v12, v[64:67] offset:1024
    s_mov_b32 exec_lo, 0x10001
    s_mov_b32 exec_hi, 0x10001
    ds_write_b128 v14, v[68:71]
    ds_write_b128 v15, v[72:75]
    s_mov_b64 exec, 1
    ds_write_b32 v3, v24 offset:32
    s_mov_b64 exec, -1
F_xw:
    ds_read_b32 v25, v18 offset:32
    ds_read_b128 v[28:31], v13 offset:1024
    ds_read_b128 v[32:35], v13
    ds_read_b32 v26, v16
    ds_read_b32 v27, v17
    s_waitcnt lgkmcnt(4)
    v_cmp_eq_u32 vcc, 0, v25
    s_cbranch_vccz F_xx
    s_waitcnt lgkmcnt(0)
    s_branch F_xw
F_xx:
    s_waitcnt lgkmcnt(3)
    v_add_f32 v44, v44, v28
    v_add_f32 v45, v45, v29
    v_add_f32 v46, v46, v30
    v_add_f32 v47, v47, v31
    buffer_atomic_add_f32 v44, v8, s[24:27], s46 offen offset:0
    buffer_atomic_add_f32 v45, v8, s[24:27], s46 offen offset:64
    buffer_atomic_add_f32 v46, v8, s[24:27], s46 offen offset:128
    buffer_atomic_add_f32 v47, v8, s[24:27], s46 offen offset:192
    s_waitcnt lgkmcnt(2)
    v_add_f32 v48, v48, v32
    v_add_f32 v49, v49, v33
    v_add_f32 v50, v50, v34
    v_add_f32 v51, v51, v35
    buffer_atomic_add_f32 v48, v8, s[24:27], s47 offen offset:0
    buffer_atomic_add_f32 v49, v8, s[24:27], s47 offen offset:64
    buffer_atomic_add_f32 v50, v8, s[24:27], s47 offen offset:128
    buffer_atomic_add_f32 v51, v8, s[24:27], s47 offen offset:192
    s_waitcnt lgkmcnt(0)
    v_add_f32 v26, v26, v27
    s_mov_b64 exec, 0xffff
    buffer_atomic_add_f32 v26, v19, s[24:27], s48 offen
    s_mov_b64 exec, 1
    ds_add_u32 v3, v24 offset:32
    s_mov_b64 exec, -1
    s_setprio 2
    v_mov_b32 v2, v7
    s_lshl_b32 s47, s3, 7
    s_add_u32 s47, s47, 157184
    v_lshlrev_b32 v5, 2, v4
    v_add_u32 v5, s47, v5
    ds_read2_b32 v[76:77], v5 offset0:0 offset1:128
    ds_read2_b32 v[78:79], v5 offset0:16 offset1:144
    v_lshrrev_b32 v4, 3, v0
    v_and_b32 v5, 7, v0
    v_lshrrev_b32 v6, 1, v4
    v_lshlrev_b32 v7, 1, v6
    v_xor_b32 v7, v5, v7
    v_lshlrev_b32 v7, 4, v7
    v_lshl_add_u32 v40, v4, 11, v7
    v_and_b32 v6, 1, v6
    v_lshlrev_b32 v6, 1, v6
    v_xor_b32 v41, v5, v6
    v_xor_b32 v42, 4, v41
    v_lshlrev_b32 v41, 4, v41
    v_lshlrev_b32 v42, 4, v42
    v_mul_u32_u24 v7, 6144, v4
    v_add_u32 v41, v41, v7
    v_add_u32 v42, v42, v7
    v_add_u32 v42, 49152, v42
    s_mul_i32 s56, s3, 98304
    s_lshl_b32 s47, s10, 7
    s_add_u32 s56, s56, s47
    s_lshl_b32 s57, s29, 7
    s_lshl_b32 s47, s3, 15
    s_add_u32 s57, s57, s47
    s_and_b32 s81, s28, 3
    s_mul_i32 s81, s81, 4
    s_lshr_b32 s47, s28, 2
    s_mul_i32 s47, s47, 1
    s_add_u32 s81, s81, s47
    s_lshl_b32 s78, s3, 11
    s_lshl_b32 s44, s10, 1
    s_add_u32 s44, s44, s37
    s_mul_i32 s45, s44, 4224
    s_mov_b32 s52, s45
    s_add_u32 s53, s45, 4096
    s_lshl_b32 s51, s44, 3
    s_and_b32 s47, s32, 3
    s_add_u32 s51, s51, s47
    s_lshl_b32 s51, s51, 7
    v_xor_b32 v18, 8, v3
    v_mov_b32 v25, 0

    s_add_u32 s54, s51, 0x82d000
    s_add_u32 s54, s72, s54
    s_addc_u32 s55, s73, 0
    s_add_u32 s82, s49, 0x82d000
    s_add_u32 s82, s72, s82
    s_addc_u32 s83, s73, 0
    s_lshl_b32 s57, s29, 7
    s_and_b32 s47, s3, 1
    s_lshl_b32 s79, s47, 12
    s_lshl_b32 s47, s47, 16
    s_add_u32 s57, s57, s47

    s_setprio 2
    s_waitcnt lgkmcnt(0)
    v_mul_f32 v76, v76, v77
    v_add_f32 v77, 1.0, v77
    v_mul_f32 v78, v78, v79
    v_add_f32 v79, 1.0, v79
    s_waitcnt vmcnt(9)
    v_lshlrev_b32 v100, 16, v140
    v_and_b32 v101, 0xffff0000, v140
    v_lshlrev_b32 v102, 16, v141
    v_and_b32 v103, 0xffff0000, v141
    v_lshlrev_b32 v104, 16, v142
    v_and_b32 v105, 0xffff0000, v142
    v_lshlrev_b32 v106, 16, v143
    v_and_b32 v107, 0xffff0000, v143
    v_fma_f32 v100, v100, v77, v76
    v_fma_f32 v101, v101, v77, v76
    v_fma_f32 v102, v102, v77, v76
    v_fma_f32 v103, v103, v77, v76
    v_fma_f32 v104, v104, v77, v76
    v_fma_f32 v105, v105, v77, v76
    v_fma_f32 v106, v106, v77, v76
    v_fma_f32 v107, v107, v77, v76
    v_lshlrev_b32 v108, 16, v144
    v_and_b32 v109, 0xffff0000, v144
    v_lshlrev_b32 v110, 16, v145
    v_and_b32 v111, 0xffff0000, v145
    v_lshlrev_b32 v112, 16, v146
    v_and_b32 v113, 0xffff0000, v146
    v_lshlrev_b32 v114, 16, v147
    v_and_b32 v115, 0xffff0000, v147
    v_fma_f32 v108, v108, v77, v76
    v_fma_f32 v109, v109, v77, v76
    v_fma_f32 v110, v110, v77, v76
    v_fma_f32 v111, v111, v77, v76
    v_fma_f32 v112, v112, v77, v76
    v_fma_f32 v113, v113, v77, v76
    v_fma_f32 v114, v114, v77, v76
    v_fma_f32 v115, v115, v77, v76
    v_lshlrev_b32 v116, 16, v156
    v_and_b32 v117, 0xffff0000, v156
    v_lshlrev_b32 v118, 16, v157
    v_and_b32 v119, 0xffff0000, v157
    v_lshlrev_b32 v120, 16, v158
    v_and_b32 v121, 0xffff0000, v158
    v_lshlrev_b32 v122, 16, v159
    v_and_b32 v123, 0xffff0000, v159
    v_fma_f32 v116, v116, v79, v78
    v_fma_f32 v117, v117, v79, v78
    v_fma_f32 v118, v118, v79, v78
    v_fma_f32 v119, v119, v79, v78
    v_fma_f32 v120, v120, v79, v78
    v_fma_f32 v121, v121, v79, v78
    v_fma_f32 v122, v122, v79, v78
    v_fma_f32 v123, v123, v79, v78
    v_lshlrev_b32 v124, 16, v160
    v_and_b32 v125, 0xffff0000, v160
    v_lshlrev_b32 v126, 16, v161
    v_and_b32 v127, 0xffff0000, v161
    v_lshlrev_b32 v128, 16, v162
    v_and_b32 v129, 0xffff0000, v162
    v_lshlrev_b32 v130, 16, v163
    v_and_b32 v131, 0xffff0000, v163
    v_fma_f32 v124, v124, v79, v78
    v_fma_f32 v125, v125, v79, v78
    v_fma_f32 v126, v126, v79, v78
    v_fma_f32 v127, v127, v79, v78
    v_fma_f32 v128, v128, v79, v78
    v_fma_f32 v129, v129, v79, v78
    v_fma_f32 v130, v130, v79, v78
    v_fma_f32 v131, v131, v79, v78
    v_permlane16_swap_b32 v100, v104
    v_permlane16_swap_b32 v101, v105
    v_permlane16_swap_b32 v102, v106
    v_permlane16_swap_b32 v103, v107
    v_permlane16_swap_b32 v108, v112
    v_permlane16_swap_b32 v109, v113
    v_permlane16_swap_b32 v110, v114
    v_permlane16_swap_b32 v111, v115
    v_permlane16_swap_b32 v116, v120
    v_permlane16_swap_b32 v117, v121
    v_permlane16_swap_b32 v118, v122
    v_permlane16_swap_b32 v119, v123
    v_permlane16_swap_b32 v124, v128
    v_permlane16_swap_b32 v125, v129
    v_permlane16_swap_b32 v126, v130
    v_permlane16_swap_b32 v127, v131
    s_setprio 2
    s_cmp_lt_u32 s3, 2
    s_cbranch_scc1 F_w0
    v_cmp_gt_u32 vcc, 1, v25
    s_cbranch_vccz CW_16
    ds_read_b32 v25, v1 offset:0
FW_17:
    s_waitcnt lgkmcnt(0)
    v_cmp_gt_u32 vcc, 1, v25
    s_cbranch_vccz FO_18
    s_sleep 2
    ds_read_b32 v25, v1 offset:0
    s_branch FW_17
FO_18:
CW_16:
    s_add_u32 s47, s81, 0
    s_and_b32 s47, s47, 15
    s_lshl_b32 s47, s47, 17
    s_add_u32 m0, s79, 147456
    s_add_u32 s47, s47, s57
    buffer_load_dwordx4 v40, s[20:23], s47 offen lds
    s_add_u32 m0, m0, 1024
    s_add_u32 s47, s47, 16384
    buffer_load_dwordx4 v40, s[20:23], s47 offen lds
    s_add_u32 m0, m0, 1024
    s_add_u32 s47, s47, 16384
    buffer_load_dwordx4 v40, s[20:23], s47 offen lds
    s_add_u32 m0, m0, 1024
    s_add_u32 s47, s47, 16384
    buffer_load_dwordx4 v40, s[20:23], s47 offen lds
    v_cmp_gt_u32 vcc, 2, v25
    s_cbranch_vccz CW_19
    ds_read_b32 v25, v1 offset:0
FW_20:
    s_waitcnt lgkmcnt(0)
    v_cmp_gt_u32 vcc, 2, v25
    s_cbranch_vccz FO_21
    s_sleep 2
    ds_read_b32 v25, v1 offset:0
    s_branch FW_20
FO_21:
CW_19:
    s_add_u32 s47, s81, 1
    s_and_b32 s47, s47, 15
    s_lshl_b32 s47, s47, 17
    s_add_u32 m0, s79, 0
    s_add_u32 s47, s47, s57
    buffer_load_dwordx4 v40, s[20:23], s47 offen lds
    s_add_u32 m0, m0, 1024
    s_add_u32 s47, s47, 16384
    buffer_load_dwordx4 v40, s[20:23], s47 offen lds
    s_add_u32 m0, m0, 1024
    s_add_u32 s47, s47, 16384
    buffer_load_dwordx4 v40, s[20:23], s47 offen lds
    s_add_u32 m0, m0, 1024
    s_add_u32 s47, s47, 16384
    buffer_load_dwordx4 v40, s[20:23], s47 offen lds
    s_waitcnt vmcnt(8)
    s_branch F_w1
F_w0:
    s_waitcnt vmcnt(0)
F_w1:
    s_mov_b32 s49, 1
    s_atomic_add s49, s[82:83], 0x0
    s_atomic_add s49, s[82:83], 0x80
    s_atomic_add s49, s[82:83], 0x100
    s_atomic_add s49, s[82:83], 0x180
    v_mov_b32 v26, 3
    s_mov_b64 exec, 1
    ds_write_b32 v3, v26 offset:32
    s_mov_b64 exec, -1
    s_cmp_ge_u32 s3, 2
    s_cbranch_scc1 F_wo
    ds_read_b32 v26, v18 offset:32
FW_22:
    s_waitcnt lgkmcnt(0)
    v_cmp_gt_u32 vcc, 2, v26
    s_cbranch_vccz FO_23
    ds_read_b32 v26, v18 offset:32
    s_branch FW_22
FO_23:
    v_cmp_gt_u32 vcc, 4, v25
    s_cbranch_vccz CW_24
    ds_read_b32 v25, v1 offset:0
FW_25:
    s_waitcnt lgkmcnt(0)
    v_cmp_gt_u32 vcc, 4, v25
    s_cbranch_vccz FO_26
    s_sleep 2
    ds_read_b32 v25, v1 offset:0
    s_branch FW_25
FO_26:
CW_24:
    v_lshlrev_b32 v9, 4, v0
    s_lshl_b32 s50, s3, 7
    s_add_u32 s50, s50, 159232
    s_add_u32 m0, s78, 40960
SP_27:
    s_load_dword s58, s[54:55], 0 glc
    s_waitcnt lgkmcnt(0)
    s_cmp_ge_u32 s58, 32
    s_cbranch_scc1 SD_28
    s_sleep 1
    s_branch SP_27
SD_28:
    buffer_load_dwordx4 v9, s[24:27], s52 offen offset:0 sc1 lds
    buffer_load_dwordx4 v9, s[24:27], s52 offen offset:1024 sc1 lds
    s_add_u32 m0, m0, 2048
    s_nop 0
    buffer_load_dwordx4 v9, s[24:27], s52 offen offset:2048 sc1 lds
    buffer_load_dwordx4 v9, s[24:27], s52 offen offset:3072 sc1 lds
    s_mov_b32 m0, s50
    s_mov_b32 exec_hi, 0
    buffer_load_dword v19, s[24:27], s53 offen sc1 lds
    s_mov_b64 exec, 1
    s_lshl_b32 s50, s3, 2
    s_add_u32 m0, s50, 159168
    s_add_u32 s51, s51, 184320
    buffer_load_dword v19, s[24:27], s51 offen sc1 lds
    s_waitcnt vmcnt(0)
    s_mov_b64 exec, 1
    v_mov_b32 v26, 32
    ds_write_b32 v3, v26 offset:128
    s_mov_b64 exec, -1
    s_branch F_wj
F_wo:
    v_cmp_gt_u32 vcc, 2, v25
    s_cbranch_vccz CW_29
    ds_read_b32 v25, v1 offset:0
FW_30:
    s_waitcnt lgkmcnt(0)
    v_cmp_gt_u32 vcc, 2, v25
    s_cbranch_vccz FO_31
    s_sleep 2
    ds_read_b32 v25, v1 offset:0
    s_branch FW_30
FO_31:
CW_29:
    s_add_u32 s47, s81, 2
    s_and_b32 s47, s47, 15
    s_lshl_b32 s47, s47, 17
    s_add_u32 m0, s79, 8192
    s_add_u32 s47, s47, s57
    buffer_load_dwordx4 v40, s[20:23], s47 offen lds
    s_add_u32 m0, m0, 1024
    s_add_u32 s47, s47, 16384
    buffer_load_dwordx4 v40, s[20:23], s47 offen lds
    s_add_u32 m0, m0, 1024
    s_add_u32 s47, s47, 16384
    buffer_load_dwordx4 v40, s[20:23], s47 offen lds
    s_add_u32 m0, m0, 1024
    s_add_u32 s47, s47, 16384
    buffer_load_dwordx4 v40, s[20:23], s47 offen lds
    v_cmp_gt_u32 vcc, 2, v25
    s_cbranch_vccz CW_32
    ds_read_b32 v25, v1 offset:0
FW_33:
    s_waitcnt lgkmcnt(0)
    v_cmp_gt_u32 vcc, 2, v25
    s_cbranch_vccz FO_34
    s_sleep 2
    ds_read_b32 v25, v1 offset:0
    s_branch FW_33
FO_34:
CW_32:
    s_waitcnt vmcnt(8)
    s_add_u32 s47, s81, 3
    s_and_b32 s47, s47, 15
    s_lshl_b32 s47, s47, 17
    s_add_u32 m0, s79, 139264
    s_add_u32 s47, s47, s57
    buffer_load_dwordx4 v40, s[20:23], s47 offen lds
    s_add_u32 m0, m0, 1024
    s_add_u32 s47, s47, 16384
    buffer_load_dwordx4 v40, s[20:23], s47 offen lds
    s_add_u32 m0, m0, 1024
    s_add_u32 s47, s47, 16384
    buffer_load_dwordx4 v40, s[20:23], s47 offen lds
    s_add_u32 m0, m0, 1024
    s_add_u32 s47, s47, 16384
    buffer_load_dwordx4 v40, s[20:23], s47 offen lds
    v_cmp_gt_u32 vcc, 3, v25
    s_cbranch_vccz CW_35
    ds_read_b32 v25, v1 offset:0
FW_36:
    s_waitcnt lgkmcnt(0)
    v_cmp_gt_u32 vcc, 3, v25
    s_cbranch_vccz FO_37
    s_sleep 2
    ds_read_b32 v25, v1 offset:0
    s_branch FW_36
FO_37:
CW_35:
    s_waitcnt vmcnt(8)
    s_add_u32 s47, s81, 4
    s_and_b32 s47, s47, 15
    s_lshl_b32 s47, s47, 17
    s_add_u32 m0, s79, 16384
    s_add_u32 s47, s47, s57
    buffer_load_dwordx4 v40, s[20:23], s47 offen lds
    s_add_u32 m0, m0, 1024
    s_add_u32 s47, s47, 16384
    buffer_load_dwordx4 v40, s[20:23], s47 offen lds
    s_add_u32 m0, m0, 1024
    s_add_u32 s47, s47, 16384
    buffer_load_dwordx4 v40, s[20:23], s47 offen lds
    s_add_u32 m0, m0, 1024
    s_add_u32 s47, s47, 16384
    buffer_load_dwordx4 v40, s[20:23], s47 offen lds
    v_cmp_gt_u32 vcc, 3, v25
    s_cbranch_vccz CW_38
    ds_read_b32 v25, v1 offset:0
FW_39:
    s_waitcnt lgkmcnt(0)
    v_cmp_gt_u32 vcc, 3, v25
    s_cbranch_vccz FO_40
    s_sleep 2
    ds_read_b32 v25, v1 offset:0
    s_branch FW_39
FO_40:
CW_38:
    s_waitcnt vmcnt(8)
    s_add_u32 s47, s81, 5
    s_and_b32 s47, s47, 15
    s_lshl_b32 s47, s47, 17
    s_add_u32 m0, s79, 24576
    s_add_u32 s47, s47, s57
    buffer_load_dwordx4 v40, s[20:23], s47 offen lds
    s_add_u32 m0, m0, 1024
    s_add_u32 s47, s47, 16384
    buffer_load_dwordx4 v40, s[20:23], s47 offen lds
    s_add_u32 m0, m0, 1024
    s_add_u32 s47, s47, 16384
    buffer_load_dwordx4 v40, s[20:23], s47 offen lds
    s_add_u32 m0, m0, 1024
    s_add_u32 s47, s47, 16384
    buffer_load_dwordx4 v40, s[20:23], s47 offen lds
    v_cmp_gt_u32 vcc, 3, v25
    s_cbranch_vccz CW_41
    ds_read_b32 v25, v1 offset:0
FW_42:
    s_waitcnt lgkmcnt(0)
    v_cmp_gt_u32 vcc, 3, v25
    s_cbranch_vccz FO_43
    s_sleep 2
    ds_read_b32 v25, v1 offset:0
    s_branch FW_42
FO_43:
CW_41:
    s_waitcnt vmcnt(8)
    s_add_u32 s47, s81, 6
    s_and_b32 s47, s47, 15
    s_lshl_b32 s47, s47, 17
    s_add_u32 m0, s79, 131072
    s_add_u32 s47, s47, s57
    buffer_load_dwordx4 v40, s[20:23], s47 offen lds
    s_add_u32 m0, m0, 1024
    s_add_u32 s47, s47, 16384
    buffer_load_dwordx4 v40, s[20:23], s47 offen lds
    s_add_u32 m0, m0, 1024
    s_add_u32 s47, s47, 16384
    buffer_load_dwordx4 v40, s[20:23], s47 offen lds
    s_add_u32 m0, m0, 1024
    s_add_u32 s47, s47, 16384
    buffer_load_dwordx4 v40, s[20:23], s47 offen lds
    v_cmp_gt_u32 vcc, 4, v25
    s_cbranch_vccz CW_44
    ds_read_b32 v25, v1 offset:0
FW_45:
    s_waitcnt lgkmcnt(0)
    v_cmp_gt_u32 vcc, 4, v25
    s_cbranch_vccz FO_46
    s_sleep 2
    ds_read_b32 v25, v1 offset:0
    s_branch FW_45
FO_46:
CW_44:
    s_waitcnt vmcnt(8)
    s_add_u32 s47, s81, 7
    s_and_b32 s47, s47, 15
    s_lshl_b32 s47, s47, 17
    s_add_u32 m0, s79, 81920
    s_add_u32 s47, s47, s57
    buffer_load_dwordx4 v40, s[20:23], s47 offen lds
    s_add_u32 m0, m0, 1024
    s_add_u32 s47, s47, 16384
    buffer_load_dwordx4 v40, s[20:23], s47 offen lds
    s_add_u32 m0, m0, 1024
    s_add_u32 s47, s47, 16384
    buffer_load_dwordx4 v40, s[20:23], s47 offen lds
    s_add_u32 m0, m0, 1024
    s_add_u32 s47, s47, 16384
    buffer_load_dwordx4 v40, s[20:23], s47 offen lds
    v_cmp_gt_u32 vcc, 5, v25
    s_cbranch_vccz CW_47
    ds_read_b32 v25, v1 offset:0
FW_48:
    s_waitcnt lgkmcnt(0)
    v_cmp_gt_u32 vcc, 5, v25
    s_cbranch_vccz FO_49
    s_sleep 2
    ds_read_b32 v25, v1 offset:0
    s_branch FW_48
FO_49:
CW_47:
    s_waitcnt vmcnt(8)
    s_add_u32 s47, s81, 8
    s_and_b32 s47, s47, 15
    s_lshl_b32 s47, s47, 17
    s_add_u32 m0, s79, 49152
    s_add_u32 s47, s47, s57
    buffer_load_dwordx4 v40, s[20:23], s47 offen lds
    s_add_u32 m0, m0, 1024
    s_add_u32 s47, s47, 16384
    buffer_load_dwordx4 v40, s[20:23], s47 offen lds
    s_add_u32 m0, m0, 1024
    s_add_u32 s47, s47, 16384
    buffer_load_dwordx4 v40, s[20:23], s47 offen lds
    s_add_u32 m0, m0, 1024
    s_add_u32 s47, s47, 16384
    buffer_load_dwordx4 v40, s[20:23], s47 offen lds
    v_cmp_gt_u32 vcc, 5, v25
    s_cbranch_vccz CW_50
    ds_read_b32 v25, v1 offset:0
FW_51:
    s_waitcnt lgkmcnt(0)
    v_cmp_gt_u32 vcc, 5, v25
    s_cbranch_vccz FO_52
    s_sleep 2
    ds_read_b32 v25, v1 offset:0
    s_branch FW_51
FO_52:
CW_50:
    s_waitcnt vmcnt(8)
    s_add_u32 s47, s81, 9
    s_and_b32 s47, s47, 15
    s_lshl_b32 s47, s47, 17
    s_add_u32 m0, s79, 57344
    s_add_u32 s47, s47, s57
    buffer_load_dwordx4 v40, s[20:23], s47 offen lds
    s_add_u32 m0, m0, 1024
    s_add_u32 s47, s47, 16384
    buffer_load_dwordx4 v40, s[20:23], s47 offen lds
    s_add_u32 m0, m0, 1024
    s_add_u32 s47, s47, 16384
    buffer_load_dwordx4 v40, s[20:23], s47 offen lds
    s_add_u32 m0, m0, 1024
    s_add_u32 s47, s47, 16384
    buffer_load_dwordx4 v40, s[20:23], s47 offen lds
    v_cmp_gt_u32 vcc, 5, v25
    s_cbranch_vccz CW_53
    ds_read_b32 v25, v1 offset:0
FW_54:
    s_waitcnt lgkmcnt(0)
    v_cmp_gt_u32 vcc, 5, v25
    s_cbranch_vccz FO_55
    s_sleep 2
    ds_read_b32 v25, v1 offset:0
    s_branch FW_54
FO_55:
CW_53:
    s_waitcnt vmcnt(8)
    s_add_u32 s47, s81, 10
    s_and_b32 s47, s47, 15
    s_lshl_b32 s47, s47, 17
    s_add_u32 m0, s79, 73728
    s_add_u32 s47, s47, s57
    buffer_load_dwordx4 v40, s[20:23], s47 offen lds
    s_add_u32 m0, m0, 1024
    s_add_u32 s47, s47, 16384
    buffer_load_dwordx4 v40, s[20:23], s47 offen lds
    s_add_u32 m0, m0, 1024
    s_add_u32 s47, s47, 16384
    buffer_load_dwordx4 v40, s[20:23], s47 offen lds
    s_add_u32 m0, m0, 1024
    s_add_u32 s47, s47, 16384
    buffer_load_dwordx4 v40, s[20:23], s47 offen lds
    v_cmp_gt_u32 vcc, 6, v25
    s_cbranch_vccz CW_56
    ds_read_b32 v25, v1 offset:0
FW_57:
    s_waitcnt lgkmcnt(0)
    v_cmp_gt_u32 vcc, 6, v25
    s_cbranch_vccz FO_58
    s_sleep 2
    ds_read_b32 v25, v1 offset:0
    s_branch FW_57
FO_58:
CW_56:
    s_waitcnt vmcnt(8)
    s_add_u32 s47, s81, 11
    s_and_b32 s47, s47, 15
    s_lshl_b32 s47, s47, 17
    s_add_u32 m0, s79, 98304
    s_add_u32 s47, s47, s57
    buffer_load_dwordx4 v40, s[20:23], s47 offen lds
    s_add_u32 m0, m0, 1024
    s_add_u32 s47, s47, 16384
    buffer_load_dwordx4 v40, s[20:23], s47 offen lds
    s_add_u32 m0, m0, 1024
    s_add_u32 s47, s47, 16384
    buffer_load_dwordx4 v40, s[20:23], s47 offen lds
    s_add_u32 m0, m0, 1024
    s_add_u32 s47, s47, 16384
    buffer_load_dwordx4 v40, s[20:23], s47 offen lds
    v_cmp_gt_u32 vcc, 7, v25
    s_cbranch_vccz CW_59
    ds_read_b32 v25, v1 offset:0
FW_60:
    s_waitcnt lgkmcnt(0)
    v_cmp_gt_u32 vcc, 7, v25
    s_cbranch_vccz FO_61
    s_sleep 2
    ds_read_b32 v25, v1 offset:0
    s_branch FW_60
FO_61:
CW_59:
    s_waitcnt vmcnt(8)
    s_add_u32 s47, s81, 12
    s_and_b32 s47, s47, 15
    s_lshl_b32 s47, s47, 17
    s_add_u32 m0, s79, 90112
    s_add_u32 s47, s47, s57
    buffer_load_dwordx4 v40, s[20:23], s47 offen lds
    s_add_u32 m0, m0, 1024
    s_add_u32 s47, s47, 16384
    buffer_load_dwordx4 v40, s[20:23], s47 offen lds
    s_add_u32 m0, m0, 1024
    s_add_u32 s47, s47, 16384
    buffer_load_dwordx4 v40, s[20:23], s47 offen lds
    s_add_u32 m0, m0, 1024
    s_add_u32 s47, s47, 16384
    buffer_load_dwordx4 v40, s[20:23], s47 offen lds
    v_cmp_gt_u32 vcc, 8, v25
    s_cbranch_vccz CW_62
    ds_read_b32 v25, v1 offset:0
FW_63:
    s_waitcnt lgkmcnt(0)
    v_cmp_gt_u32 vcc, 8, v25
    s_cbranch_vccz FO_64
    s_sleep 2
    ds_read_b32 v25, v1 offset:0
    s_branch FW_63
FO_64:
CW_62:
    s_waitcnt vmcnt(8)
    s_add_u32 s47, s81, 13
    s_and_b32 s47, s47, 15
    s_lshl_b32 s47, s47, 17
    s_add_u32 m0, s79, 114688
    s_add_u32 s47, s47, s57
    buffer_load_dwordx4 v40, s[20:23], s47 offen lds
    s_add_u32 m0, m0, 1024
    s_add_u32 s47, s47, 16384
    buffer_load_dwordx4 v40, s[20:23], s47 offen lds
    s_add_u32 m0, m0, 1024
    s_add_u32 s47, s47, 16384
    buffer_load_dwordx4 v40, s[20:23], s47 offen lds
    s_add_u32 m0, m0, 1024
    s_add_u32 s47, s47, 16384
    buffer_load_dwordx4 v40, s[20:23], s47 offen lds
    v_cmp_gt_u32 vcc, 9, v25
    s_cbranch_vccz CW_65
    ds_read_b32 v25, v1 offset:0
FW_66:
    s_waitcnt lgkmcnt(0)
    v_cmp_gt_u32 vcc, 9, v25
    s_cbranch_vccz FO_67
    s_sleep 2
    ds_read_b32 v25, v1 offset:0
    s_branch FW_66
FO_67:
CW_65:
    s_waitcnt vmcnt(8)
    s_add_u32 s47, s81, 14
    s_and_b32 s47, s47, 15
    s_lshl_b32 s47, s47, 17
    s_add_u32 m0, s79, 106496
    s_add_u32 s47, s47, s57
    buffer_load_dwordx4 v40, s[20:23], s47 offen lds
    s_add_u32 m0, m0, 1024
    s_add_u32 s47, s47, 16384
    buffer_load_dwordx4 v40, s[20:23], s47 offen lds
    s_add_u32 m0, m0, 1024
    s_add_u32 s47, s47, 16384
    buffer_load_dwordx4 v40, s[20:23], s47 offen lds
    s_add_u32 m0, m0, 1024
    s_add_u32 s47, s47, 16384
    buffer_load_dwordx4 v40, s[20:23], s47 offen lds
    v_cmp_gt_u32 vcc, 10, v25
    s_cbranch_vccz CW_68
    ds_read_b32 v25, v1 offset:0
FW_69:
    s_waitcnt lgkmcnt(0)
    v_cmp_gt_u32 vcc, 10, v25
    s_cbranch_vccz FO_70
    s_sleep 2
    ds_read_b32 v25, v1 offset:0
    s_branch FW_69
FO_70:
CW_68:
    s_waitcnt vmcnt(8)
    s_add_u32 s47, s81, 15
    s_and_b32 s47, s47, 15
    s_lshl_b32 s47, s47, 17
    s_add_u32 m0, s79, 122880
    s_add_u32 s47, s47, s57
    buffer_load_dwordx4 v40, s[20:23], s47 offen lds
    s_add_u32 m0, m0, 1024
    s_add_u32 s47, s47, 16384
    buffer_load_dwordx4 v40, s[20:23], s47 offen lds
    s_add_u32 m0, m0, 1024
    s_add_u32 s47, s47, 16384
    buffer_load_dwordx4 v40, s[20:23], s47 offen lds
    s_add_u32 m0, m0, 1024
    s_add_u32 s47, s47, 16384
    buffer_load_dwordx4 v40, s[20:23], s47 offen lds
F_wj:
    v_mov_b32 v5, 159096
    ds_read_b32 v6, v5 offset:0
FW_71:
    s_branch IW_s6
IW_w6:
    s_branch IW_r6
IW_s6:
    s_waitcnt lgkmcnt(0)
    v_cmp_gt_u32 vcc, 1, v6
    s_cbranch_vccz FO_72
    s_sleep 1
    ds_read_b32 v6, v5 offset:0
    s_branch FW_71
FO_72:
    v_and_b32 v5, 7, v0
    v_lshlrev_b32 v5, 2, v5
    v_add_u32 v5, 158976, v5
    ds_read_b32 v5, v5
    s_lshr_b32 s47, s64, 5
    s_sub_u32 s47, 63, s47
    s_mov_b64 s[60:61], 0
    s_waitcnt lgkmcnt(0)
    v_bfe_u32 v5, v5, 5, 6
    v_cmp_eq_u32 vcc, s47, v5
    s_cbranch_vccz F_ns

    v_mov_b32 v5, 158976
    ds_read_b128 v[44:47], v5
    ds_read_b128 v[48:51], v5 offset:16
    v_and_b32 v6, 15, v0
    v_add_u32 v6, s64, v6
    v_sub_u32 v6, 2047, v6
    v_subrev_u32 v7, 16, v6
    v_mov_b32 v164, 0
    v_mov_b32 v165, 0
    s_waitcnt lgkmcnt(0)
    v_and_b32 v5, 0x7ff, v44
    v_or_b32 v44, 0x4000, v44
    v_cmp_eq_u32 vcc, v5, v6
    v_cmp_eq_u32 s[62:63], v5, v7
    s_nop 0
    v_cndmask_b32 v164, v164, v44, vcc
    v_cndmask_b32 v165, v165, v44, s[62:63]
    v_and_b32 v5, 0x7ff, v45
    v_or_b32 v45, 0x4800, v45
    v_cmp_eq_u32 vcc, v5, v6
    v_cmp_eq_u32 s[62:63], v5, v7
    s_nop 0
    v_cndmask_b32 v164, v164, v45, vcc
    v_cndmask_b32 v165, v165, v45, s[62:63]
    v_and_b32 v5, 0x7ff, v46
    v_or_b32 v46, 0x5000, v46
    v_cmp_eq_u32 vcc, v5, v6
    v_cmp_eq_u32 s[62:63], v5, v7
    s_nop 0
    v_cndmask_b32 v164, v164, v46, vcc
    v_cndmask_b32 v165, v165, v46, s[62:63]
    v_and_b32 v5, 0x7ff, v47
    v_or_b32 v47, 0x5800, v47
    v_cmp_eq_u32 vcc, v5, v6
    v_cmp_eq_u32 s[62:63], v5, v7
    s_nop 0
    v_cndmask_b32 v164, v164, v47, vcc
    v_cndmask_b32 v165, v165, v47, s[62:63]
    v_and_b32 v5, 0x7ff, v48
    v_or_b32 v48, 0x6000, v48
    v_cmp_eq_u32 vcc, v5, v6
    v_cmp_eq_u32 s[62:63], v5, v7
    s_nop 0
    v_cndmask_b32 v164, v164, v48, vcc
    v_cndmask_b32 v165, v165, v48, s[62:63]
    v_and_b32 v5, 0x7ff, v49
    v_or_b32 v49, 0x6800, v49
    v_cmp_eq_u32 vcc, v5, v6
    v_cmp_eq_u32 s[62:63], v5, v7
    s_nop 0
    v_cndmask_b32 v164, v164, v49, vcc
    v_cndmask_b32 v165, v165, v49, s[62:63]
    v_and_b32 v5, 0x7ff, v50
    v_or_b32 v50, 0x7000, v50
    v_cmp_eq_u32 vcc, v5, v6
    v_cmp_eq_u32 s[62:63], v5, v7
    s_nop 0
    v_cndmask_b32 v164, v164, v50, vcc
    v_cndmask_b32 v165, v165, v50, s[62:63]
    v_and_b32 v5, 0x7ff, v51
    v_or_b32 v51, 0x7800, v51
    v_cmp_eq_u32 vcc, v5, v6
    v_cmp_eq_u32 s[62:63], v5, v7
    s_nop 0
    v_cndmask_b32 v164, v164, v51, vcc
    v_cndmask_b32 v165, v165, v51, s[62:63]
    s_mov_b32 s47, 0xbfb8aa3b
    v_and_b32 v7, 0x30, v0
    v_add_u32 v7, 159744, v7
    v_cmp_ne_u32 s[74:75], 0, v164
    v_bfe_u32 v5, v164, 11, 3
    v_lshl_add_u32 v162, v5, 8, v7
    v_and_b32 v5, 0xffff0000, v164
    v_ashrrev_i32 v6, 31, v5
    v_not_b32 v6, v6
    v_or_b32 v6, 0x80000000, v6
    v_xor_b32 v5, v5, v6
    v_and_b32 v5, 0xffff0000, v5
    v_mul_f32 v5, s47, v5
    v_exp_f32 v5, v5
    s_nop 0
    v_add_f32 v5, 1.0, v5
    v_rcp_f32 v5, v5
    s_nop 0
    v_cvt_pk_bf16_f32 v5, v5, v5
    v_lshlrev_b32 v164, 16, v5
    v_cmp_ne_u32 s[76:77], 0, v165
    v_bfe_u32 v5, v165, 11, 3
    v_lshl_add_u32 v163, v5, 8, v7
    v_and_b32 v5, 0xffff0000, v165
    v_ashrrev_i32 v6, 31, v5
    v_not_b32 v6, v6
    v_or_b32 v6, 0x80000000, v6
    v_xor_b32 v5, v5, v6
    v_and_b32 v5, 0xffff0000, v5
    v_mul_f32 v5, s47, v5
    v_exp_f32 v5, v5
    s_nop 0
    v_add_f32 v5, 1.0, v5
    v_rcp_f32 v5, v5
    s_nop 0
    v_cvt_pk_bf16_f32 v5, v5, v5
    v_lshlrev_b32 v165, 16, v5
    v_mov_b32 v161, 159136
    s_mov_b64 s[60:61], 1
F_ns:
    s_lshl_b32 s51, s28, 2
    s_add_u32 s51, s51, s3
    s_lshl_b32 s51, s51, 3
    s_and_b32 s47, s29, 3
    s_add_u32 s51, s51, s47
    s_lshl_b32 s51, s51, 7

    s_add_u32 s54, s51, 0x835000
    s_add_u32 s54, s72, s54
    s_addc_u32 s55, s73, 0
    v_lshlrev_b32 v98, 4, v0
    v_lshrrev_b32 v16, 4, v0
    v_bfe_u32 v17, v0, 2, 2
    v_lshl_add_u32 v17, v16, 2, v17
    v_bfe_u32 v16, v17, 1, 2
    v_lshlrev_b32 v16, 5, v16
    v_lshl_add_u32 v16, v17, 7, v16
    v_and_b32 v17, 3, v0
    v_lshl_add_u32 v4, v17, 3, v16
    v_xor_b32 v5, 32, v4
    v_xor_b32 v6, 64, v4
    v_xor_b32 v7, 96, v4
    s_lshl_b32 s79, s28, 18
    s_lshl_b32 s80, s3, 16
    s_add_u32 s79, s79, s80
    s_lshl_b32 s81, s81, 11
    v_mov_b32 v99, 1

    v_add_u32 v8, 57344, v4
    v_add_u32 v9, 57344, v5
    v_add_u32 v10, 57344, v6
    v_add_u32 v11, 57344, v7
    v_add_u32 v12, 114688, v4
    v_add_u32 v13, 114688, v5
    v_add_u32 v14, 114688, v6
    v_add_u32 v15, 114688, v7
    s_add_u32 s16, s72, 0x400000
    s_addc_u32 s17, s73, 0
    s_mov_b32 s18, 0x400000
    s_mov_b32 s19, 0x00020000
    s_mov_b32 s12, s68
    s_mov_b32 s13, s69
    s_mov_b32 s14, 0x400000
    s_mov_b32 s15, 0x00020000
    s_add_u32 s80, s81, 0
    s_and_b32 s80, s80, 0x7fff
    s_add_u32 s4, s80, s79
    s_add_u32 s80, s81, 2048
    s_and_b32 s80, s80, 0x7fff
    s_add_u32 s5, s80, s79
    s_add_u32 s80, s81, 4096
    s_and_b32 s80, s80, 0x7fff
    s_add_u32 s6, s80, s79
    s_add_u32 s80, s81, 6144
    s_and_b32 s80, s80, 0x7fff
    s_add_u32 s7, s80, s79
    s_add_u32 s80, s81, 8192
    s_and_b32 s80, s80, 0x7fff
    s_add_u32 s8, s80, s79
    s_add_u32 s80, s81, 10240
    s_and_b32 s80, s80, 0x7fff
    s_add_u32 s9, s80, s79
    s_add_u32 s80, s81, 12288
    s_and_b32 s80, s80, 0x7fff
    s_add_u32 s10, s80, s79
    s_add_u32 s80, s81, 14336
    s_and_b32 s80, s80, 0x7fff
    s_add_u32 s11, s80, s79
    s_add_u32 s80, s81, 16384
    s_and_b32 s80, s80, 0x7fff
    s_add_u32 s30, s80, s79
    s_add_u32 s80, s81, 18432
    s_and_b32 s80, s80, 0x7fff
    s_add_u32 s31, s80, s79
    s_add_u32 s80, s81, 20480
    s_and_b32 s80, s80, 0x7fff
    s_add_u32 s32, s80, s79
    s_add_u32 s80, s81, 22528
    s_and_b32 s80, s80, 0x7fff
    s_add_u32 s33, s80, s79
    s_add_u32 s80, s81, 24576
    s_and_b32 s80, s80, 0x7fff
    s_add_u32 s34, s80, s79
    s_add_u32 s80, s81, 26624
    s_and_b32 s80, s80, 0x7fff
    s_add_u32 s35, s80, s79
    s_add_u32 s80, s81, 28672
    s_and_b32 s80, s80, 0x7fff
    s_add_u32 s36, s80, s79
    s_add_u32 s80, s81, 30720
    s_and_b32 s80, s80, 0x7fff
    s_add_u32 s37, s80, s79
    v_add_u32 v97, 0x8000, v98
    s_setprio 2
    s_mov_b32 s50, 0
F_op:
    s_load_dword s47, s[54:55], 0 glc
    s_getreg_b32 s51, hwreg(HW_REG_IB_STS)
    s_and_b32 s51, s51, 0xc0000f
    s_or_b32 s51, s51, s50
    s_cbranch_scc1 F_oq
    s_mov_b64 exec, 1
    ds_write_b32 v3, v99 offset:160
    s_mov_b64 exec, -1
    s_mov_b32 s50, 1
F_oq:
    s_waitcnt lgkmcnt(0)
    s_cmp_lt_u32 s47, 16
    s_cbranch_scc1 F_op
    buffer_load_dwordx4 v[48:51], v98, s[16:19], s4 offen offset:0 sc1
    buffer_load_dwordx4 v[52:55], v97, s[16:19], s4 offen offset:0 sc1
    buffer_load_dwordx4 v[56:59], v98, s[16:19], s4 offen offset:1024 sc1
    buffer_load_dwordx4 v[60:63], v97, s[16:19], s4 offen offset:1024 sc1
    buffer_load_dwordx4 v[64:67], v98, s[16:19], s5 offen offset:0 sc1
    buffer_load_dwordx4 v[68:71], v97, s[16:19], s5 offen offset:0 sc1
    buffer_load_dwordx4 v[72:75], v98, s[16:19], s5 offen offset:1024 sc1
    buffer_load_dwordx4 v[76:79], v97, s[16:19], s5 offen offset:1024 sc1
    buffer_load_dwordx4 v[80:83], v98, s[16:19], s6 offen offset:0 sc1
    buffer_load_dwordx4 v[84:87], v97, s[16:19], s6 offen offset:0 sc1
    buffer_load_dwordx4 v[88:91], v98, s[16:19], s6 offen offset:1024 sc1
    buffer_load_dwordx4 v[92:95], v97, s[16:19], s6 offen offset:1024 sc1
    s_cmp_lg_u32 s50, 0
    s_cbranch_scc1 F_or
    s_waitcnt vmcnt(12)
    s_mov_b64 exec, 1
    ds_write_b32 v3, v99 offset:160
    s_mov_b64 exec, -1
F_or:
    v_or_b32 v17, 8, v1
    ds_read_b32 v16, v17 offset:160
FW_73:
    s_waitcnt lgkmcnt(0)
    v_cmp_gt_u32 vcc, 1, v16
    s_cbranch_vccz FO_74
    ds_read_b32 v16, v17 offset:160
    s_branch FW_73
FO_74:
    v_and_b32 v1, 0x3fff, v2
    v_bfe_u32 v99, v0, 3, 1
    v_lshl_add_u32 v1, v99, 6, v1
    ds_read_b64_tr_b16 v[16:17], v12 offset:32768
    ds_read_b64_tr_b16 v[18:19], v12 offset:34816
    ds_read_b64_tr_b16 v[20:21], v13 offset:32768
    ds_read_b64_tr_b16 v[22:23], v13 offset:34816
    ds_read_b64_tr_b16 v[24:25], v14 offset:32768
    ds_read_b64_tr_b16 v[26:27], v14 offset:34816
    ds_read_b64_tr_b16 v[28:29], v15 offset:32768
    ds_read_b64_tr_b16 v[30:31], v15 offset:34816
    s_waitcnt vmcnt(10) lgkmcnt(0)
    v_mfma_f32_16x16x32_bf16 v[100:103], v[16:19], v[48:51], v[100:103]
    ds_read_b64_tr_b16 v[32:33], v12 offset:36864
    ds_read_b64_tr_b16 v[34:35], v12 offset:38912
    v_mfma_f32_16x16x32_bf16 v[116:119], v[16:19], v[52:55], v[116:119]
    ds_read_b64_tr_b16 v[36:37], v13 offset:36864
    ds_read_b64_tr_b16 v[38:39], v13 offset:38912
    v_mfma_f32_16x16x32_bf16 v[104:107], v[20:23], v[48:51], v[104:107]
    ds_read_b64_tr_b16 v[40:41], v14 offset:36864
    ds_read_b64_tr_b16 v[42:43], v14 offset:38912
    v_mfma_f32_16x16x32_bf16 v[120:123], v[20:23], v[52:55], v[120:123]
    ds_read_b64_tr_b16 v[44:45], v15 offset:36864
    ds_read_b64_tr_b16 v[46:47], v15 offset:38912
    v_mfma_f32_16x16x32_bf16 v[108:111], v[24:27], v[48:51], v[108:111]
    buffer_load_dwordx4 v[132:135], v98, s[16:19], s7 offen offset:0 sc1
    v_mfma_f32_16x16x32_bf16 v[124:127], v[24:27], v[52:55], v[124:127]
    v_mfma_f32_16x16x32_bf16 v[112:115], v[28:31], v[48:51], v[112:115]
    buffer_load_dwordx4 v[136:139], v97, s[16:19], s7 offen offset:0 sc1
    v_mfma_f32_16x16x32_bf16 v[128:131], v[28:31], v[52:55], v[128:131]
    s_waitcnt vmcnt(10) lgkmcnt(0)
    v_mfma_f32_16x16x32_bf16 v[100:103], v[32:35], v[56:59], v[100:103]
    ds_read_b64_tr_b16 v[16:17], v4 offset:0
    ds_read_b64_tr_b16 v[18:19], v4 offset:2048
    v_mfma_f32_16x16x32_bf16 v[116:119], v[32:35], v[60:63], v[116:119]
    ds_read_b64_tr_b16 v[20:21], v5 offset:0
    ds_read_b64_tr_b16 v[22:23], v5 offset:2048
    v_mfma_f32_16x16x32_bf16 v[104:107], v[36:39], v[56:59], v[104:107]
    ds_read_b64_tr_b16 v[24:25], v6 offset:0
    ds_read_b64_tr_b16 v[26:27], v6 offset:2048
    v_mfma_f32_16x16x32_bf16 v[120:123], v[36:39], v[60:63], v[120:123]
    ds_read_b64_tr_b16 v[28:29], v7 offset:0
    ds_read_b64_tr_b16 v[30:31], v7 offset:2048
    v_mfma_f32_16x16x32_bf16 v[108:111], v[40:43], v[56:59], v[108:111]
    buffer_load_dwordx4 v[48:51], v98, s[16:19], s7 offen offset:1024 sc1
    v_mfma_f32_16x16x32_bf16 v[124:127], v[40:43], v[60:63], v[124:127]
    v_mfma_f32_16x16x32_bf16 v[112:115], v[44:47], v[56:59], v[112:115]
    buffer_load_dwordx4 v[52:55], v97, s[16:19], s7 offen offset:1024 sc1
    v_mfma_f32_16x16x32_bf16 v[128:131], v[44:47], v[60:63], v[128:131]
    s_waitcnt vmcnt(10) lgkmcnt(0)
    v_mfma_f32_16x16x32_bf16 v[100:103], v[16:19], v[64:67], v[100:103]
    ds_read_b64_tr_b16 v[32:33], v4 offset:4096
    ds_read_b64_tr_b16 v[34:35], v4 offset:6144
    v_mfma_f32_16x16x32_bf16 v[116:119], v[16:19], v[68:71], v[116:119]
    ds_read_b64_tr_b16 v[36:37], v5 offset:4096
    ds_read_b64_tr_b16 v[38:39], v5 offset:6144
    v_mfma_f32_16x16x32_bf16 v[104:107], v[20:23], v[64:67], v[104:107]
    ds_read_b64_tr_b16 v[40:41], v6 offset:4096
    ds_read_b64_tr_b16 v[42:43], v6 offset:6144
    v_mfma_f32_16x16x32_bf16 v[120:123], v[20:23], v[68:71], v[120:123]
    ds_read_b64_tr_b16 v[44:45], v7 offset:4096
    ds_read_b64_tr_b16 v[46:47], v7 offset:6144
    v_mfma_f32_16x16x32_bf16 v[108:111], v[24:27], v[64:67], v[108:111]
    buffer_load_dwordx4 v[56:59], v98, s[16:19], s8 offen offset:0 sc1
    v_mfma_f32_16x16x32_bf16 v[124:127], v[24:27], v[68:71], v[124:127]
    v_mfma_f32_16x16x32_bf16 v[112:115], v[28:31], v[64:67], v[112:115]
    buffer_load_dwordx4 v[60:63], v97, s[16:19], s8 offen offset:0 sc1
    v_mfma_f32_16x16x32_bf16 v[128:131], v[28:31], v[68:71], v[128:131]
    s_waitcnt vmcnt(10) lgkmcnt(0)
    v_mfma_f32_16x16x32_bf16 v[100:103], v[32:35], v[72:75], v[100:103]
    ds_read_b64_tr_b16 v[16:17], v4 offset:8192
    ds_read_b64_tr_b16 v[18:19], v4 offset:10240
    v_mfma_f32_16x16x32_bf16 v[116:119], v[32:35], v[76:79], v[116:119]
    ds_read_b64_tr_b16 v[20:21], v5 offset:8192
    ds_read_b64_tr_b16 v[22:23], v5 offset:10240
    v_mfma_f32_16x16x32_bf16 v[104:107], v[36:39], v[72:75], v[104:107]
    ds_read_b64_tr_b16 v[24:25], v6 offset:8192
    ds_read_b64_tr_b16 v[26:27], v6 offset:10240
    v_mfma_f32_16x16x32_bf16 v[120:123], v[36:39], v[76:79], v[120:123]
    ds_read_b64_tr_b16 v[28:29], v7 offset:8192
    ds_read_b64_tr_b16 v[30:31], v7 offset:10240
    v_mfma_f32_16x16x32_bf16 v[108:111], v[40:43], v[72:75], v[108:111]
    buffer_load_dwordx4 v[64:67], v98, s[16:19], s8 offen offset:1024 sc1
    v_mfma_f32_16x16x32_bf16 v[124:127], v[40:43], v[76:79], v[124:127]
    v_mfma_f32_16x16x32_bf16 v[112:115], v[44:47], v[72:75], v[112:115]
    buffer_load_dwordx4 v[68:71], v97, s[16:19], s8 offen offset:1024 sc1
    v_mfma_f32_16x16x32_bf16 v[128:131], v[44:47], v[76:79], v[128:131]
    s_waitcnt vmcnt(10) lgkmcnt(0)
    v_mfma_f32_16x16x32_bf16 v[100:103], v[16:19], v[80:83], v[100:103]
    ds_read_b64_tr_b16 v[32:33], v4 offset:12288
    ds_read_b64_tr_b16 v[34:35], v4 offset:14336
    v_mfma_f32_16x16x32_bf16 v[116:119], v[16:19], v[84:87], v[116:119]
    ds_read_b64_tr_b16 v[36:37], v5 offset:12288
    ds_read_b64_tr_b16 v[38:39], v5 offset:14336
    v_mfma_f32_16x16x32_bf16 v[104:107], v[20:23], v[80:83], v[104:107]
    ds_read_b64_tr_b16 v[40:41], v6 offset:12288
    ds_read_b64_tr_b16 v[42:43], v6 offset:14336
    v_mfma_f32_16x16x32_bf16 v[120:123], v[20:23], v[84:87], v[120:123]
    ds_read_b64_tr_b16 v[44:45], v7 offset:12288
    ds_read_b64_tr_b16 v[46:47], v7 offset:14336
    v_mfma_f32_16x16x32_bf16 v[108:111], v[24:27], v[80:83], v[108:111]
    buffer_load_dwordx4 v[72:75], v98, s[16:19], s9 offen offset:0 sc1
    v_mfma_f32_16x16x32_bf16 v[124:127], v[24:27], v[84:87], v[124:127]
    v_mfma_f32_16x16x32_bf16 v[112:115], v[28:31], v[80:83], v[112:115]
    buffer_load_dwordx4 v[76:79], v97, s[16:19], s9 offen offset:0 sc1
    v_mfma_f32_16x16x32_bf16 v[128:131], v[28:31], v[84:87], v[128:131]
    s_waitcnt vmcnt(10) lgkmcnt(0)
    v_mfma_f32_16x16x32_bf16 v[100:103], v[32:35], v[88:91], v[100:103]
    ds_read_b64_tr_b16 v[16:17], v12 offset:24576
    ds_read_b64_tr_b16 v[18:19], v12 offset:26624
    v_mfma_f32_16x16x32_bf16 v[116:119], v[32:35], v[92:95], v[116:119]
    ds_read_b64_tr_b16 v[20:21], v13 offset:24576
    ds_read_b64_tr_b16 v[22:23], v13 offset:26624
    v_mfma_f32_16x16x32_bf16 v[104:107], v[36:39], v[88:91], v[104:107]
    ds_read_b64_tr_b16 v[24:25], v14 offset:24576
    ds_read_b64_tr_b16 v[26:27], v14 offset:26624
    v_mfma_f32_16x16x32_bf16 v[120:123], v[36:39], v[92:95], v[120:123]
    ds_read_b64_tr_b16 v[28:29], v15 offset:24576
    ds_read_b64_tr_b16 v[30:31], v15 offset:26624
    v_mfma_f32_16x16x32_bf16 v[108:111], v[40:43], v[88:91], v[108:111]
    buffer_load_dwordx4 v[80:83], v98, s[16:19], s9 offen offset:1024 sc1
    v_mfma_f32_16x16x32_bf16 v[124:127], v[40:43], v[92:95], v[124:127]
    v_mfma_f32_16x16x32_bf16 v[112:115], v[44:47], v[88:91], v[112:115]
    buffer_load_dwordx4 v[84:87], v97, s[16:19], s9 offen offset:1024 sc1
    v_mfma_f32_16x16x32_bf16 v[128:131], v[44:47], v[92:95], v[128:131]
    s_waitcnt vmcnt(10) lgkmcnt(0)
    v_mfma_f32_16x16x32_bf16 v[100:103], v[16:19], v[132:135], v[100:103]
    ds_read_b64_tr_b16 v[32:33], v12 offset:28672
    ds_read_b64_tr_b16 v[34:35], v12 offset:30720
    v_mfma_f32_16x16x32_bf16 v[116:119], v[16:19], v[136:139], v[116:119]
    ds_read_b64_tr_b16 v[36:37], v13 offset:28672
    ds_read_b64_tr_b16 v[38:39], v13 offset:30720
    v_mfma_f32_16x16x32_bf16 v[104:107], v[20:23], v[132:135], v[104:107]
    ds_read_b64_tr_b16 v[40:41], v14 offset:28672
    ds_read_b64_tr_b16 v[42:43], v14 offset:30720
    v_mfma_f32_16x16x32_bf16 v[120:123], v[20:23], v[136:139], v[120:123]
    ds_read_b64_tr_b16 v[44:45], v15 offset:28672
    ds_read_b64_tr_b16 v[46:47], v15 offset:30720
    v_mfma_f32_16x16x32_bf16 v[108:111], v[24:27], v[132:135], v[108:111]
    buffer_load_dwordx4 v[88:91], v98, s[16:19], s10 offen offset:0 sc1
    v_mfma_f32_16x16x32_bf16 v[124:127], v[24:27], v[136:139], v[124:127]
    v_mfma_f32_16x16x32_bf16 v[112:115], v[28:31], v[132:135], v[112:115]
    buffer_load_dwordx4 v[92:95], v97, s[16:19], s10 offen offset:0 sc1
    v_mfma_f32_16x16x32_bf16 v[128:131], v[28:31], v[136:139], v[128:131]
    s_waitcnt vmcnt(10) lgkmcnt(0)
    v_mfma_f32_16x16x32_bf16 v[100:103], v[32:35], v[48:51], v[100:103]
    ds_read_b64_tr_b16 v[16:17], v4 offset:16384
    ds_read_b64_tr_b16 v[18:19], v4 offset:18432
    v_mfma_f32_16x16x32_bf16 v[116:119], v[32:35], v[52:55], v[116:119]
    ds_read_b64_tr_b16 v[20:21], v5 offset:16384
    ds_read_b64_tr_b16 v[22:23], v5 offset:18432
    v_mfma_f32_16x16x32_bf16 v[104:107], v[36:39], v[48:51], v[104:107]
    ds_read_b64_tr_b16 v[24:25], v6 offset:16384
    ds_read_b64_tr_b16 v[26:27], v6 offset:18432
    v_mfma_f32_16x16x32_bf16 v[120:123], v[36:39], v[52:55], v[120:123]
    ds_read_b64_tr_b16 v[28:29], v7 offset:16384
    ds_read_b64_tr_b16 v[30:31], v7 offset:18432
    v_mfma_f32_16x16x32_bf16 v[108:111], v[40:43], v[48:51], v[108:111]
    buffer_load_dwordx4 v[132:135], v98, s[16:19], s10 offen offset:1024 sc1
    v_mfma_f32_16x16x32_bf16 v[124:127], v[40:43], v[52:55], v[124:127]
    v_mfma_f32_16x16x32_bf16 v[112:115], v[44:47], v[48:51], v[112:115]
    buffer_load_dwordx4 v[136:139], v97, s[16:19], s10 offen offset:1024 sc1
    v_mfma_f32_16x16x32_bf16 v[128:131], v[44:47], v[52:55], v[128:131]
    s_waitcnt vmcnt(10) lgkmcnt(0)
    v_mfma_f32_16x16x32_bf16 v[100:103], v[16:19], v[56:59], v[100:103]
    ds_read_b64_tr_b16 v[32:33], v4 offset:20480
    ds_read_b64_tr_b16 v[34:35], v4 offset:22528
    v_mfma_f32_16x16x32_bf16 v[116:119], v[16:19], v[60:63], v[116:119]
    ds_read_b64_tr_b16 v[36:37], v5 offset:20480
    ds_read_b64_tr_b16 v[38:39], v5 offset:22528
    v_mfma_f32_16x16x32_bf16 v[104:107], v[20:23], v[56:59], v[104:107]
    ds_read_b64_tr_b16 v[40:41], v6 offset:20480
    ds_read_b64_tr_b16 v[42:43], v6 offset:22528
    v_mfma_f32_16x16x32_bf16 v[120:123], v[20:23], v[60:63], v[120:123]
    ds_read_b64_tr_b16 v[44:45], v7 offset:20480
    ds_read_b64_tr_b16 v[46:47], v7 offset:22528
    v_mfma_f32_16x16x32_bf16 v[108:111], v[24:27], v[56:59], v[108:111]
    buffer_load_dwordx4 v[48:51], v98, s[16:19], s11 offen offset:0 sc1
    v_mfma_f32_16x16x32_bf16 v[124:127], v[24:27], v[60:63], v[124:127]
    v_mfma_f32_16x16x32_bf16 v[112:115], v[28:31], v[56:59], v[112:115]
    buffer_load_dwordx4 v[52:55], v97, s[16:19], s11 offen offset:0 sc1
    v_mfma_f32_16x16x32_bf16 v[128:131], v[28:31], v[60:63], v[128:131]
    s_waitcnt vmcnt(10) lgkmcnt(0)
    v_mfma_f32_16x16x32_bf16 v[100:103], v[32:35], v[64:67], v[100:103]
    ds_read_b64_tr_b16 v[16:17], v4 offset:24576
    ds_read_b64_tr_b16 v[18:19], v4 offset:26624
    v_mfma_f32_16x16x32_bf16 v[116:119], v[32:35], v[68:71], v[116:119]
    ds_read_b64_tr_b16 v[20:21], v5 offset:24576
    ds_read_b64_tr_b16 v[22:23], v5 offset:26624
    v_mfma_f32_16x16x32_bf16 v[104:107], v[36:39], v[64:67], v[104:107]
    ds_read_b64_tr_b16 v[24:25], v6 offset:24576
    ds_read_b64_tr_b16 v[26:27], v6 offset:26624
    v_mfma_f32_16x16x32_bf16 v[120:123], v[36:39], v[68:71], v[120:123]
    ds_read_b64_tr_b16 v[28:29], v7 offset:24576
    ds_read_b64_tr_b16 v[30:31], v7 offset:26624
    v_mfma_f32_16x16x32_bf16 v[108:111], v[40:43], v[64:67], v[108:111]
    buffer_load_dwordx4 v[56:59], v98, s[16:19], s11 offen offset:1024 sc1
    v_mfma_f32_16x16x32_bf16 v[124:127], v[40:43], v[68:71], v[124:127]
    v_mfma_f32_16x16x32_bf16 v[112:115], v[44:47], v[64:67], v[112:115]
    buffer_load_dwordx4 v[60:63], v97, s[16:19], s11 offen offset:1024 sc1
    v_mfma_f32_16x16x32_bf16 v[128:131], v[44:47], v[68:71], v[128:131]
    s_waitcnt vmcnt(10) lgkmcnt(0)
    v_mfma_f32_16x16x32_bf16 v[100:103], v[16:19], v[72:75], v[100:103]
    ds_read_b64_tr_b16 v[32:33], v4 offset:28672
    ds_read_b64_tr_b16 v[34:35], v4 offset:30720
    v_mfma_f32_16x16x32_bf16 v[116:119], v[16:19], v[76:79], v[116:119]
    ds_read_b64_tr_b16 v[36:37], v5 offset:28672
    ds_read_b64_tr_b16 v[38:39], v5 offset:30720
    v_mfma_f32_16x16x32_bf16 v[104:107], v[20:23], v[72:75], v[104:107]
    ds_read_b64_tr_b16 v[40:41], v6 offset:28672
    ds_read_b64_tr_b16 v[42:43], v6 offset:30720
    v_mfma_f32_16x16x32_bf16 v[120:123], v[20:23], v[76:79], v[120:123]
    ds_read_b64_tr_b16 v[44:45], v7 offset:28672
    ds_read_b64_tr_b16 v[46:47], v7 offset:30720
    v_mfma_f32_16x16x32_bf16 v[108:111], v[24:27], v[72:75], v[108:111]
    buffer_load_dwordx4 v[64:67], v98, s[16:19], s30 offen offset:0 sc1
    v_mfma_f32_16x16x32_bf16 v[124:127], v[24:27], v[76:79], v[124:127]
    v_mfma_f32_16x16x32_bf16 v[112:115], v[28:31], v[72:75], v[112:115]
    buffer_load_dwordx4 v[68:71], v97, s[16:19], s30 offen offset:0 sc1
    v_mfma_f32_16x16x32_bf16 v[128:131], v[28:31], v[76:79], v[128:131]
    s_waitcnt vmcnt(10) lgkmcnt(0)
    v_mfma_f32_16x16x32_bf16 v[100:103], v[32:35], v[80:83], v[100:103]
    ds_read_b64_tr_b16 v[16:17], v12 offset:16384
    ds_read_b64_tr_b16 v[18:19], v12 offset:18432
    v_mfma_f32_16x16x32_bf16 v[116:119], v[32:35], v[84:87], v[116:119]
    ds_read_b64_tr_b16 v[20:21], v13 offset:16384
    ds_read_b64_tr_b16 v[22:23], v13 offset:18432
    v_mfma_f32_16x16x32_bf16 v[104:107], v[36:39], v[80:83], v[104:107]
    ds_read_b64_tr_b16 v[24:25], v14 offset:16384
    ds_read_b64_tr_b16 v[26:27], v14 offset:18432
    v_mfma_f32_16x16x32_bf16 v[120:123], v[36:39], v[84:87], v[120:123]
    ds_read_b64_tr_b16 v[28:29], v15 offset:16384
    ds_read_b64_tr_b16 v[30:31], v15 offset:18432
    v_mfma_f32_16x16x32_bf16 v[108:111], v[40:43], v[80:83], v[108:111]
    buffer_load_dwordx4 v[72:75], v98, s[16:19], s30 offen offset:1024 sc1
    v_mfma_f32_16x16x32_bf16 v[124:127], v[40:43], v[84:87], v[124:127]
    v_mfma_f32_16x16x32_bf16 v[112:115], v[44:47], v[80:83], v[112:115]
    buffer_load_dwordx4 v[76:79], v97, s[16:19], s30 offen offset:1024 sc1
    v_mfma_f32_16x16x32_bf16 v[128:131], v[44:47], v[84:87], v[128:131]
    s_waitcnt vmcnt(10) lgkmcnt(0)
    v_mfma_f32_16x16x32_bf16 v[100:103], v[16:19], v[88:91], v[100:103]
    ds_read_b64_tr_b16 v[32:33], v12 offset:20480
    ds_read_b64_tr_b16 v[34:35], v12 offset:22528
    v_mfma_f32_16x16x32_bf16 v[116:119], v[16:19], v[92:95], v[116:119]
    ds_read_b64_tr_b16 v[36:37], v13 offset:20480
    ds_read_b64_tr_b16 v[38:39], v13 offset:22528
    v_mfma_f32_16x16x32_bf16 v[104:107], v[20:23], v[88:91], v[104:107]
    ds_read_b64_tr_b16 v[40:41], v14 offset:20480
    ds_read_b64_tr_b16 v[42:43], v14 offset:22528
    v_mfma_f32_16x16x32_bf16 v[120:123], v[20:23], v[92:95], v[120:123]
    ds_read_b64_tr_b16 v[44:45], v15 offset:20480
    ds_read_b64_tr_b16 v[46:47], v15 offset:22528
    v_mfma_f32_16x16x32_bf16 v[108:111], v[24:27], v[88:91], v[108:111]
    buffer_load_dwordx4 v[80:83], v98, s[16:19], s31 offen offset:0 sc1
    v_mfma_f32_16x16x32_bf16 v[124:127], v[24:27], v[92:95], v[124:127]
    v_mfma_f32_16x16x32_bf16 v[112:115], v[28:31], v[88:91], v[112:115]
    buffer_load_dwordx4 v[84:87], v97, s[16:19], s31 offen offset:0 sc1
    v_mfma_f32_16x16x32_bf16 v[128:131], v[28:31], v[92:95], v[128:131]
    s_waitcnt vmcnt(10) lgkmcnt(0)
    v_mfma_f32_16x16x32_bf16 v[100:103], v[32:35], v[132:135], v[100:103]
    ds_read_b64_tr_b16 v[16:17], v8 offset:24576
    ds_read_b64_tr_b16 v[18:19], v8 offset:26624
    v_mfma_f32_16x16x32_bf16 v[116:119], v[32:35], v[136:139], v[116:119]
    ds_read_b64_tr_b16 v[20:21], v9 offset:24576
    ds_read_b64_tr_b16 v[22:23], v9 offset:26624
    v_mfma_f32_16x16x32_bf16 v[104:107], v[36:39], v[132:135], v[104:107]
    ds_read_b64_tr_b16 v[24:25], v10 offset:24576
    ds_read_b64_tr_b16 v[26:27], v10 offset:26624
    v_mfma_f32_16x16x32_bf16 v[120:123], v[36:39], v[136:139], v[120:123]
    ds_read_b64_tr_b16 v[28:29], v11 offset:24576
    ds_read_b64_tr_b16 v[30:31], v11 offset:26624
    v_mfma_f32_16x16x32_bf16 v[108:111], v[40:43], v[132:135], v[108:111]
    buffer_load_dwordx4 v[88:91], v98, s[16:19], s31 offen offset:1024 sc1
    v_mfma_f32_16x16x32_bf16 v[124:127], v[40:43], v[136:139], v[124:127]
    v_mfma_f32_16x16x32_bf16 v[112:115], v[44:47], v[132:135], v[112:115]
    buffer_load_dwordx4 v[92:95], v97, s[16:19], s31 offen offset:1024 sc1
    v_mfma_f32_16x16x32_bf16 v[128:131], v[44:47], v[136:139], v[128:131]
    s_waitcnt vmcnt(10) lgkmcnt(0)
    v_mfma_f32_16x16x32_bf16 v[100:103], v[16:19], v[48:51], v[100:103]
    ds_read_b64_tr_b16 v[32:33], v8 offset:28672
    ds_read_b64_tr_b16 v[34:35], v8 offset:30720
    v_mfma_f32_16x16x32_bf16 v[116:119], v[16:19], v[52:55], v[116:119]
    ds_read_b64_tr_b16 v[36:37], v9 offset:28672
    ds_read_b64_tr_b16 v[38:39], v9 offset:30720
    v_mfma_f32_16x16x32_bf16 v[104:107], v[20:23], v[48:51], v[104:107]
    ds_read_b64_tr_b16 v[40:41], v10 offset:28672
    ds_read_b64_tr_b16 v[42:43], v10 offset:30720
    v_mfma_f32_16x16x32_bf16 v[120:123], v[20:23], v[52:55], v[120:123]
    ds_read_b64_tr_b16 v[44:45], v11 offset:28672
    ds_read_b64_tr_b16 v[46:47], v11 offset:30720
    v_mfma_f32_16x16x32_bf16 v[108:111], v[24:27], v[48:51], v[108:111]
    buffer_load_dwordx4 v[132:135], v98, s[16:19], s32 offen offset:0 sc1
    v_mfma_f32_16x16x32_bf16 v[124:127], v[24:27], v[52:55], v[124:127]
    v_mfma_f32_16x16x32_bf16 v[112:115], v[28:31], v[48:51], v[112:115]
    buffer_load_dwordx4 v[136:139], v97, s[16:19], s32 offen offset:0 sc1
    v_mfma_f32_16x16x32_bf16 v[128:131], v[28:31], v[52:55], v[128:131]
    s_waitcnt vmcnt(10) lgkmcnt(0)
    v_mfma_f32_16x16x32_bf16 v[100:103], v[32:35], v[56:59], v[100:103]
    ds_read_b64_tr_b16 v[16:17], v4 offset:49152
    ds_read_b64_tr_b16 v[18:19], v4 offset:51200
    v_mfma_f32_16x16x32_bf16 v[116:119], v[32:35], v[60:63], v[116:119]
    ds_read_b64_tr_b16 v[20:21], v5 offset:49152
    ds_read_b64_tr_b16 v[22:23], v5 offset:51200
    v_mfma_f32_16x16x32_bf16 v[104:107], v[36:39], v[56:59], v[104:107]
    ds_read_b64_tr_b16 v[24:25], v6 offset:49152
    ds_read_b64_tr_b16 v[26:27], v6 offset:51200
    v_mfma_f32_16x16x32_bf16 v[120:123], v[36:39], v[60:63], v[120:123]
    ds_read_b64_tr_b16 v[28:29], v7 offset:49152
    ds_read_b64_tr_b16 v[30:31], v7 offset:51200
    v_mfma_f32_16x16x32_bf16 v[108:111], v[40:43], v[56:59], v[108:111]
    buffer_load_dwordx4 v[48:51], v98, s[16:19], s32 offen offset:1024 sc1
    v_mfma_f32_16x16x32_bf16 v[124:127], v[40:43], v[60:63], v[124:127]
    v_mfma_f32_16x16x32_bf16 v[112:115], v[44:47], v[56:59], v[112:115]
    buffer_load_dwordx4 v[52:55], v97, s[16:19], s32 offen offset:1024 sc1
    v_mfma_f32_16x16x32_bf16 v[128:131], v[44:47], v[60:63], v[128:131]
    s_waitcnt vmcnt(10) lgkmcnt(0)
    v_mfma_f32_16x16x32_bf16 v[100:103], v[16:19], v[64:67], v[100:103]
    ds_read_b64_tr_b16 v[32:33], v4 offset:53248
    ds_read_b64_tr_b16 v[34:35], v4 offset:55296
    v_mfma_f32_16x16x32_bf16 v[116:119], v[16:19], v[68:71], v[116:119]
    ds_read_b64_tr_b16 v[36:37], v5 offset:53248
    ds_read_b64_tr_b16 v[38:39], v5 offset:55296
    v_mfma_f32_16x16x32_bf16 v[104:107], v[20:23], v[64:67], v[104:107]
    ds_read_b64_tr_b16 v[40:41], v6 offset:53248
    ds_read_b64_tr_b16 v[42:43], v6 offset:55296
    v_mfma_f32_16x16x32_bf16 v[120:123], v[20:23], v[68:71], v[120:123]
    ds_read_b64_tr_b16 v[44:45], v7 offset:53248
    ds_read_b64_tr_b16 v[46:47], v7 offset:55296
    v_mfma_f32_16x16x32_bf16 v[108:111], v[24:27], v[64:67], v[108:111]
    buffer_load_dwordx4 v[56:59], v98, s[16:19], s33 offen offset:0 sc1
    s_branch IW_s7
IW_w7:
    s_branch IW_r7
IW_s7:
    v_mfma_f32_16x16x32_bf16 v[124:127], v[24:27], v[68:71], v[124:127]
    v_mfma_f32_16x16x32_bf16 v[112:115], v[28:31], v[64:67], v[112:115]
    buffer_load_dwordx4 v[60:63], v97, s[16:19], s33 offen offset:0 sc1
    v_mfma_f32_16x16x32_bf16 v[128:131], v[28:31], v[68:71], v[128:131]
    s_waitcnt vmcnt(10) lgkmcnt(0)
    v_mfma_f32_16x16x32_bf16 v[100:103], v[32:35], v[72:75], v[100:103]
    ds_read_b64_tr_b16 v[16:17], v8 offset:0
    ds_read_b64_tr_b16 v[18:19], v8 offset:2048
    v_mfma_f32_16x16x32_bf16 v[116:119], v[32:35], v[76:79], v[116:119]
    ds_read_b64_tr_b16 v[20:21], v9 offset:0
    ds_read_b64_tr_b16 v[22:23], v9 offset:2048
    v_mfma_f32_16x16x32_bf16 v[104:107], v[36:39], v[72:75], v[104:107]
    ds_read_b64_tr_b16 v[24:25], v10 offset:0
    ds_read_b64_tr_b16 v[26:27], v10 offset:2048
    v_mfma_f32_16x16x32_bf16 v[120:123], v[36:39], v[76:79], v[120:123]
    ds_read_b64_tr_b16 v[28:29], v11 offset:0
    ds_read_b64_tr_b16 v[30:31], v11 offset:2048
    v_mfma_f32_16x16x32_bf16 v[108:111], v[40:43], v[72:75], v[108:111]
    buffer_load_dwordx4 v[64:67], v98, s[16:19], s33 offen offset:1024 sc1
    v_mfma_f32_16x16x32_bf16 v[124:127], v[40:43], v[76:79], v[124:127]
    v_mfma_f32_16x16x32_bf16 v[112:115], v[44:47], v[72:75], v[112:115]
    buffer_load_dwordx4 v[68:71], v97, s[16:19], s33 offen offset:1024 sc1
    v_mfma_f32_16x16x32_bf16 v[128:131], v[44:47], v[76:79], v[128:131]
    s_waitcnt vmcnt(10) lgkmcnt(0)
    v_mfma_f32_16x16x32_bf16 v[100:103], v[16:19], v[80:83], v[100:103]
    ds_read_b64_tr_b16 v[32:33], v8 offset:4096
    ds_read_b64_tr_b16 v[34:35], v8 offset:6144
    v_mfma_f32_16x16x32_bf16 v[116:119], v[16:19], v[84:87], v[116:119]
    ds_read_b64_tr_b16 v[36:37], v9 offset:4096
    ds_read_b64_tr_b16 v[38:39], v9 offset:6144
    v_mfma_f32_16x16x32_bf16 v[104:107], v[20:23], v[80:83], v[104:107]
    ds_read_b64_tr_b16 v[40:41], v10 offset:4096
    ds_read_b64_tr_b16 v[42:43], v10 offset:6144
    v_mfma_f32_16x16x32_bf16 v[120:123], v[20:23], v[84:87], v[120:123]
    ds_read_b64_tr_b16 v[44:45], v11 offset:4096
    ds_read_b64_tr_b16 v[46:47], v11 offset:6144
    v_mfma_f32_16x16x32_bf16 v[108:111], v[24:27], v[80:83], v[108:111]
    buffer_load_dwordx4 v[72:75], v98, s[16:19], s34 offen offset:0 sc1
    v_mfma_f32_16x16x32_bf16 v[124:127], v[24:27], v[84:87], v[124:127]
    v_mfma_f32_16x16x32_bf16 v[112:115], v[28:31], v[80:83], v[112:115]
    buffer_load_dwordx4 v[76:79], v97, s[16:19], s34 offen offset:0 sc1
    v_mfma_f32_16x16x32_bf16 v[128:131], v[28:31], v[84:87], v[128:131]
    s_waitcnt vmcnt(10) lgkmcnt(0)
    v_mfma_f32_16x16x32_bf16 v[100:103], v[32:35], v[88:91], v[100:103]
    ds_read_b64_tr_b16 v[16:17], v8 offset:16384
    ds_read_b64_tr_b16 v[18:19], v8 offset:18432
    v_mfma_f32_16x16x32_bf16 v[116:119], v[32:35], v[92:95], v[116:119]
    ds_read_b64_tr_b16 v[20:21], v9 offset:16384
    ds_read_b64_tr_b16 v[22:23], v9 offset:18432
    v_mfma_f32_16x16x32_bf16 v[104:107], v[36:39], v[88:91], v[104:107]
    ds_read_b64_tr_b16 v[24:25], v10 offset:16384
    ds_read_b64_tr_b16 v[26:27], v10 offset:18432
    v_mfma_f32_16x16x32_bf16 v[120:123], v[36:39], v[92:95], v[120:123]
    ds_read_b64_tr_b16 v[28:29], v11 offset:16384
    ds_read_b64_tr_b16 v[30:31], v11 offset:18432
    v_mfma_f32_16x16x32_bf16 v[108:111], v[40:43], v[88:91], v[108:111]
    buffer_load_dwordx4 v[80:83], v98, s[16:19], s34 offen offset:1024 sc1
    v_mfma_f32_16x16x32_bf16 v[124:127], v[40:43], v[92:95], v[124:127]
    v_mfma_f32_16x16x32_bf16 v[112:115], v[44:47], v[88:91], v[112:115]
    buffer_load_dwordx4 v[84:87], v97, s[16:19], s34 offen offset:1024 sc1
    v_mfma_f32_16x16x32_bf16 v[128:131], v[44:47], v[92:95], v[128:131]
    s_waitcnt vmcnt(10) lgkmcnt(0)
    v_mfma_f32_16x16x32_bf16 v[100:103], v[16:19], v[132:135], v[100:103]
    ds_read_b64_tr_b16 v[32:33], v8 offset:20480
    ds_read_b64_tr_b16 v[34:35], v8 offset:22528
    v_mfma_f32_16x16x32_bf16 v[116:119], v[16:19], v[136:139], v[116:119]
    ds_read_b64_tr_b16 v[36:37], v9 offset:20480
    ds_read_b64_tr_b16 v[38:39], v9 offset:22528
    v_mfma_f32_16x16x32_bf16 v[104:107], v[20:23], v[132:135], v[104:107]
    ds_read_b64_tr_b16 v[40:41], v10 offset:20480
    ds_read_b64_tr_b16 v[42:43], v10 offset:22528
    v_mfma_f32_16x16x32_bf16 v[120:123], v[20:23], v[136:139], v[120:123]
    ds_read_b64_tr_b16 v[44:45], v11 offset:20480
    ds_read_b64_tr_b16 v[46:47], v11 offset:22528
    v_mfma_f32_16x16x32_bf16 v[108:111], v[24:27], v[132:135], v[108:111]
    buffer_load_dwordx4 v[88:91], v98, s[16:19], s35 offen offset:0 sc1
    v_mfma_f32_16x16x32_bf16 v[124:127], v[24:27], v[136:139], v[124:127]
    v_mfma_f32_16x16x32_bf16 v[112:115], v[28:31], v[132:135], v[112:115]
    buffer_load_dwordx4 v[92:95], v97, s[16:19], s35 offen offset:0 sc1
    v_mfma_f32_16x16x32_bf16 v[128:131], v[28:31], v[136:139], v[128:131]
    s_waitcnt vmcnt(10) lgkmcnt(0)
    v_mfma_f32_16x16x32_bf16 v[100:103], v[32:35], v[48:51], v[100:103]
    ds_read_b64_tr_b16 v[16:17], v8 offset:40960
    ds_read_b64_tr_b16 v[18:19], v8 offset:43008
    v_mfma_f32_16x16x32_bf16 v[116:119], v[32:35], v[52:55], v[116:119]
    ds_read_b64_tr_b16 v[20:21], v9 offset:40960
    ds_read_b64_tr_b16 v[22:23], v9 offset:43008
    v_mfma_f32_16x16x32_bf16 v[104:107], v[36:39], v[48:51], v[104:107]
    ds_read_b64_tr_b16 v[24:25], v10 offset:40960
    ds_read_b64_tr_b16 v[26:27], v10 offset:43008
    v_mfma_f32_16x16x32_bf16 v[120:123], v[36:39], v[52:55], v[120:123]
    ds_read_b64_tr_b16 v[28:29], v11 offset:40960
    ds_read_b64_tr_b16 v[30:31], v11 offset:43008
    v_mfma_f32_16x16x32_bf16 v[108:111], v[40:43], v[48:51], v[108:111]
    buffer_load_dwordx4 v[132:135], v98, s[16:19], s35 offen offset:1024 sc1
    v_mfma_f32_16x16x32_bf16 v[124:127], v[40:43], v[52:55], v[124:127]
    v_mfma_f32_16x16x32_bf16 v[112:115], v[44:47], v[48:51], v[112:115]
    buffer_load_dwordx4 v[136:139], v97, s[16:19], s35 offen offset:1024 sc1
    v_mfma_f32_16x16x32_bf16 v[128:131], v[44:47], v[52:55], v[128:131]
    s_waitcnt vmcnt(10) lgkmcnt(0)
    v_mfma_f32_16x16x32_bf16 v[100:103], v[16:19], v[56:59], v[100:103]
    ds_read_b64_tr_b16 v[32:33], v8 offset:45056
    ds_read_b64_tr_b16 v[34:35], v8 offset:47104
    v_mfma_f32_16x16x32_bf16 v[116:119], v[16:19], v[60:63], v[116:119]
    ds_read_b64_tr_b16 v[36:37], v9 offset:45056
    ds_read_b64_tr_b16 v[38:39], v9 offset:47104
    v_mfma_f32_16x16x32_bf16 v[104:107], v[20:23], v[56:59], v[104:107]
    ds_read_b64_tr_b16 v[40:41], v10 offset:45056
    ds_read_b64_tr_b16 v[42:43], v10 offset:47104
    v_mfma_f32_16x16x32_bf16 v[120:123], v[20:23], v[60:63], v[120:123]
    ds_read_b64_tr_b16 v[44:45], v11 offset:45056
    ds_read_b64_tr_b16 v[46:47], v11 offset:47104
    v_mfma_f32_16x16x32_bf16 v[108:111], v[24:27], v[56:59], v[108:111]
    buffer_load_dwordx4 v[48:51], v98, s[16:19], s36 offen offset:0 sc1
    v_mfma_f32_16x16x32_bf16 v[124:127], v[24:27], v[60:63], v[124:127]
    v_mfma_f32_16x16x32_bf16 v[112:115], v[28:31], v[56:59], v[112:115]
    buffer_load_dwordx4 v[52:55], v97, s[16:19], s36 offen offset:0 sc1
    v_mfma_f32_16x16x32_bf16 v[128:131], v[28:31], v[60:63], v[128:131]
    s_waitcnt vmcnt(10) lgkmcnt(0)
    v_mfma_f32_16x16x32_bf16 v[100:103], v[32:35], v[64:67], v[100:103]
    ds_read_b64_tr_b16 v[16:17], v8 offset:32768
    ds_read_b64_tr_b16 v[18:19], v8 offset:34816
    v_mfma_f32_16x16x32_bf16 v[116:119], v[32:35], v[68:71], v[116:119]
    ds_read_b64_tr_b16 v[20:21], v9 offset:32768
    ds_read_b64_tr_b16 v[22:23], v9 offset:34816
    v_mfma_f32_16x16x32_bf16 v[104:107], v[36:39], v[64:67], v[104:107]
    ds_read_b64_tr_b16 v[24:25], v10 offset:32768
    ds_read_b64_tr_b16 v[26:27], v10 offset:34816
    v_mfma_f32_16x16x32_bf16 v[120:123], v[36:39], v[68:71], v[120:123]
    ds_read_b64_tr_b16 v[28:29], v11 offset:32768
    ds_read_b64_tr_b16 v[30:31], v11 offset:34816
    v_mfma_f32_16x16x32_bf16 v[108:111], v[40:43], v[64:67], v[108:111]
    buffer_load_dwordx4 v[56:59], v98, s[16:19], s36 offen offset:1024 sc1
    v_mfma_f32_16x16x32_bf16 v[124:127], v[40:43], v[68:71], v[124:127]
    v_mfma_f32_16x16x32_bf16 v[112:115], v[44:47], v[64:67], v[112:115]
    buffer_load_dwordx4 v[60:63], v97, s[16:19], s36 offen offset:1024 sc1
    v_mfma_f32_16x16x32_bf16 v[128:131], v[44:47], v[68:71], v[128:131]
    s_waitcnt vmcnt(10) lgkmcnt(0)
    v_mfma_f32_16x16x32_bf16 v[100:103], v[16:19], v[72:75], v[100:103]
    ds_read_b64_tr_b16 v[32:33], v8 offset:36864
    ds_read_b64_tr_b16 v[34:35], v8 offset:38912
    v_mfma_f32_16x16x32_bf16 v[116:119], v[16:19], v[76:79], v[116:119]
    ds_read_b64_tr_b16 v[36:37], v9 offset:36864
    ds_read_b64_tr_b16 v[38:39], v9 offset:38912
    v_mfma_f32_16x16x32_bf16 v[104:107], v[20:23], v[72:75], v[104:107]
    ds_read_b64_tr_b16 v[40:41], v10 offset:36864
    ds_read_b64_tr_b16 v[42:43], v10 offset:38912
    v_mfma_f32_16x16x32_bf16 v[120:123], v[20:23], v[76:79], v[120:123]
    ds_read_b64_tr_b16 v[44:45], v11 offset:36864
    ds_read_b64_tr_b16 v[46:47], v11 offset:38912
    v_mfma_f32_16x16x32_bf16 v[108:111], v[24:27], v[72:75], v[108:111]
    buffer_load_dwordx4 v[64:67], v98, s[16:19], s37 offen offset:0 sc1
    v_mfma_f32_16x16x32_bf16 v[124:127], v[24:27], v[76:79], v[124:127]
    v_mfma_f32_16x16x32_bf16 v[112:115], v[28:31], v[72:75], v[112:115]
    buffer_load_dwordx4 v[68:71], v97, s[16:19], s37 offen offset:0 sc1
    v_mfma_f32_16x16x32_bf16 v[128:131], v[28:31], v[76:79], v[128:131]
    s_waitcnt vmcnt(10) lgkmcnt(0)
    v_mfma_f32_16x16x32_bf16 v[100:103], v[32:35], v[80:83], v[100:103]
    ds_read_b64_tr_b16 v[16:17], v12 offset:0
    ds_read_b64_tr_b16 v[18:19], v12 offset:2048
    v_mfma_f32_16x16x32_bf16 v[116:119], v[32:35], v[84:87], v[116:119]
    ds_read_b64_tr_b16 v[20:21], v13 offset:0
    ds_read_b64_tr_b16 v[22:23], v13 offset:2048
    v_mfma_f32_16x16x32_bf16 v[104:107], v[36:39], v[80:83], v[104:107]
    ds_read_b64_tr_b16 v[24:25], v14 offset:0
    ds_read_b64_tr_b16 v[26:27], v14 offset:2048
    v_mfma_f32_16x16x32_bf16 v[120:123], v[36:39], v[84:87], v[120:123]
    ds_read_b64_tr_b16 v[28:29], v15 offset:0
    ds_read_b64_tr_b16 v[30:31], v15 offset:2048
    v_mfma_f32_16x16x32_bf16 v[108:111], v[40:43], v[80:83], v[108:111]
    buffer_load_dwordx4 v[72:75], v98, s[16:19], s37 offen offset:1024 sc1
    v_mfma_f32_16x16x32_bf16 v[124:127], v[40:43], v[84:87], v[124:127]
    v_mfma_f32_16x16x32_bf16 v[112:115], v[44:47], v[80:83], v[112:115]
    buffer_load_dwordx4 v[76:79], v97, s[16:19], s37 offen offset:1024 sc1
    v_mfma_f32_16x16x32_bf16 v[128:131], v[44:47], v[84:87], v[128:131]
    s_waitcnt vmcnt(10) lgkmcnt(0)
    v_mfma_f32_16x16x32_bf16 v[100:103], v[16:19], v[88:91], v[100:103]
    ds_read_b64_tr_b16 v[32:33], v12 offset:4096
    ds_read_b64_tr_b16 v[34:35], v12 offset:6144
    v_mfma_f32_16x16x32_bf16 v[116:119], v[16:19], v[92:95], v[116:119]
    ds_read_b64_tr_b16 v[36:37], v13 offset:4096
    ds_read_b64_tr_b16 v[38:39], v13 offset:6144
    v_mfma_f32_16x16x32_bf16 v[104:107], v[20:23], v[88:91], v[104:107]
    ds_read_b64_tr_b16 v[40:41], v14 offset:4096
    ds_read_b64_tr_b16 v[42:43], v14 offset:6144
    v_mfma_f32_16x16x32_bf16 v[120:123], v[20:23], v[92:95], v[120:123]
    ds_read_b64_tr_b16 v[44:45], v15 offset:4096
    ds_read_b64_tr_b16 v[46:47], v15 offset:6144
    v_mfma_f32_16x16x32_bf16 v[108:111], v[24:27], v[88:91], v[108:111]
    v_mfma_f32_16x16x32_bf16 v[124:127], v[24:27], v[92:95], v[124:127]
    v_mfma_f32_16x16x32_bf16 v[112:115], v[28:31], v[88:91], v[112:115]
    v_mfma_f32_16x16x32_bf16 v[128:131], v[28:31], v[92:95], v[128:131]
    s_waitcnt vmcnt(8) lgkmcnt(0)
    v_mfma_f32_16x16x32_bf16 v[100:103], v[32:35], v[132:135], v[100:103]
    ds_read_b64_tr_b16 v[16:17], v8 offset:49152
    ds_read_b64_tr_b16 v[18:19], v8 offset:51200
    v_mfma_f32_16x16x32_bf16 v[116:119], v[32:35], v[136:139], v[116:119]
    ds_read_b64_tr_b16 v[20:21], v9 offset:49152
    ds_read_b64_tr_b16 v[22:23], v9 offset:51200
    v_mfma_f32_16x16x32_bf16 v[104:107], v[36:39], v[132:135], v[104:107]
    ds_read_b64_tr_b16 v[24:25], v10 offset:49152
    ds_read_b64_tr_b16 v[26:27], v10 offset:51200
    v_mfma_f32_16x16x32_bf16 v[120:123], v[36:39], v[136:139], v[120:123]
    ds_read_b64_tr_b16 v[28:29], v11 offset:49152
    ds_read_b64_tr_b16 v[30:31], v11 offset:51200
    v_mfma_f32_16x16x32_bf16 v[108:111], v[40:43], v[132:135], v[108:111]
    v_mfma_f32_16x16x32_bf16 v[124:127], v[40:43], v[136:139], v[124:127]
    v_mfma_f32_16x16x32_bf16 v[112:115], v[44:47], v[132:135], v[112:115]
    v_mfma_f32_16x16x32_bf16 v[128:131], v[44:47], v[136:139], v[128:131]
    s_waitcnt vmcnt(6) lgkmcnt(0)
    v_mfma_f32_16x16x32_bf16 v[100:103], v[16:19], v[48:51], v[100:103]
    ds_read_b64_tr_b16 v[32:33], v8 offset:53248
    ds_read_b64_tr_b16 v[34:35], v8 offset:55296
    v_mfma_f32_16x16x32_bf16 v[116:119], v[16:19], v[52:55], v[116:119]
    ds_read_b64_tr_b16 v[36:37], v9 offset:53248
    ds_read_b64_tr_b16 v[38:39], v9 offset:55296
    v_mfma_f32_16x16x32_bf16 v[104:107], v[20:23], v[48:51], v[104:107]
    ds_read_b64_tr_b16 v[40:41], v10 offset:53248
    ds_read_b64_tr_b16 v[42:43], v10 offset:55296
    v_mfma_f32_16x16x32_bf16 v[120:123], v[20:23], v[52:55], v[120:123]
    ds_read_b64_tr_b16 v[44:45], v11 offset:53248
    ds_read_b64_tr_b16 v[46:47], v11 offset:55296
    v_mfma_f32_16x16x32_bf16 v[108:111], v[24:27], v[48:51], v[108:111]
    v_mfma_f32_16x16x32_bf16 v[124:127], v[24:27], v[52:55], v[124:127]
    v_mfma_f32_16x16x32_bf16 v[112:115], v[28:31], v[48:51], v[112:115]
    v_mfma_f32_16x16x32_bf16 v[128:131], v[28:31], v[52:55], v[128:131]
    s_waitcnt vmcnt(4) lgkmcnt(0)
    v_mfma_f32_16x16x32_bf16 v[100:103], v[32:35], v[56:59], v[100:103]
    ds_read_b64_tr_b16 v[16:17], v12 offset:8192
    ds_read_b64_tr_b16 v[18:19], v12 offset:10240
    v_mfma_f32_16x16x32_bf16 v[116:119], v[32:35], v[60:63], v[116:119]
    ds_read_b64_tr_b16 v[20:21], v13 offset:8192
    ds_read_b64_tr_b16 v[22:23], v13 offset:10240
    v_mfma_f32_16x16x32_bf16 v[104:107], v[36:39], v[56:59], v[104:107]
    ds_read_b64_tr_b16 v[24:25], v14 offset:8192
    ds_read_b64_tr_b16 v[26:27], v14 offset:10240
    v_mfma_f32_16x16x32_bf16 v[120:123], v[36:39], v[60:63], v[120:123]
    ds_read_b64_tr_b16 v[28:29], v15 offset:8192
    ds_read_b64_tr_b16 v[30:31], v15 offset:10240
    v_mfma_f32_16x16x32_bf16 v[108:111], v[40:43], v[56:59], v[108:111]
    v_mfma_f32_16x16x32_bf16 v[124:127], v[40:43], v[60:63], v[124:127]
    v_mfma_f32_16x16x32_bf16 v[112:115], v[44:47], v[56:59], v[112:115]
    v_mfma_f32_16x16x32_bf16 v[128:131], v[44:47], v[60:63], v[128:131]
    s_waitcnt vmcnt(2) lgkmcnt(0)
    v_mfma_f32_16x16x32_bf16 v[100:103], v[16:19], v[64:67], v[100:103]
    ds_read_b64_tr_b16 v[32:33], v12 offset:12288
    ds_read_b64_tr_b16 v[34:35], v12 offset:14336
    v_mfma_f32_16x16x32_bf16 v[116:119], v[16:19], v[68:71], v[116:119]
    ds_read_b64_tr_b16 v[36:37], v13 offset:12288
    ds_read_b64_tr_b16 v[38:39], v13 offset:14336
    v_mfma_f32_16x16x32_bf16 v[104:107], v[20:23], v[64:67], v[104:107]
    ds_read_b64_tr_b16 v[40:41], v14 offset:12288
    ds_read_b64_tr_b16 v[42:43], v14 offset:14336
    v_mfma_f32_16x16x32_bf16 v[120:123], v[20:23], v[68:71], v[120:123]
    ds_read_b64_tr_b16 v[44:45], v15 offset:12288
    ds_read_b64_tr_b16 v[46:47], v15 offset:14336
    v_mfma_f32_16x16x32_bf16 v[108:111], v[24:27], v[64:67], v[108:111]
    v_mfma_f32_16x16x32_bf16 v[124:127], v[24:27], v[68:71], v[124:127]
    v_mfma_f32_16x16x32_bf16 v[112:115], v[28:31], v[64:67], v[112:115]
    v_mfma_f32_16x16x32_bf16 v[128:131], v[28:31], v[68:71], v[128:131]
    s_waitcnt vmcnt(0) lgkmcnt(0)
    s_cmp_eq_u64 s[60:61], 0
    s_cbranch_scc1 F_y0
    ds_read_b32 v160, v161
    ds_read_b128 v[48:51], v162 offset:0
    ds_read_b128 v[52:55], v162 offset:64
    ds_read_b128 v[56:59], v162 offset:128
    ds_read_b128 v[60:63], v162 offset:192
    ds_read_b128 v[64:67], v163 offset:0
    ds_read_b128 v[68:71], v163 offset:64
    ds_read_b128 v[80:83], v163 offset:128
    ds_read_b128 v[84:87], v163 offset:192
F_y0:
    v_mfma_f32_16x16x32_bf16 v[100:103], v[32:35], v[72:75], v[100:103]
    v_mfma_f32_16x16x32_bf16 v[104:107], v[36:39], v[72:75], v[104:107]
    v_mfma_f32_16x16x32_bf16 v[108:111], v[40:43], v[72:75], v[108:111]
    v_mfma_f32_16x16x32_bf16 v[112:115], v[44:47], v[72:75], v[112:115]
    v_mfma_f32_16x16x32_bf16 v[116:119], v[32:35], v[76:79], v[116:119]
    v_mfma_f32_16x16x32_bf16 v[120:123], v[36:39], v[76:79], v[120:123]
    v_mfma_f32_16x16x32_bf16 v[124:127], v[40:43], v[76:79], v[124:127]
    v_mfma_f32_16x16x32_bf16 v[128:131], v[44:47], v[76:79], v[128:131]
    s_cmp_eq_u64 s[60:61], 0
    s_cbranch_scc1 F_fin
F_y1:
    s_waitcnt lgkmcnt(0)
    v_cmp_eq_u32 vcc, 0, v160
    s_cbranch_vccz F_y2
    ds_read_b32 v160, v161
    ds_read_b128 v[48:51], v162 offset:0
    ds_read_b128 v[52:55], v162 offset:64
    ds_read_b128 v[56:59], v162 offset:128
    ds_read_b128 v[60:63], v162 offset:192
    ds_read_b128 v[64:67], v163 offset:0
    ds_read_b128 v[68:71], v163 offset:64
    ds_read_b128 v[80:83], v163 offset:128
    ds_read_b128 v[84:87], v163 offset:192
    s_branch F_y1
F_y2:
    s_nop 4
    s_mov_b64 exec, s[74:75]
    s_cbranch_execz F_rb_75
    v_fmac_f32 v100, v48, v164
    v_fmac_f32 v101, v49, v164
    v_fmac_f32 v102, v50, v164
    v_fmac_f32 v103, v51, v164
    v_fmac_f32 v104, v52, v164
    v_fmac_f32 v105, v53, v164
    v_fmac_f32 v106, v54, v164
    v_fmac_f32 v107, v55, v164
    v_fmac_f32 v108, v56, v164
    v_fmac_f32 v109, v57, v164
    v_fmac_f32 v110, v58, v164
    v_fmac_f32 v111, v59, v164
    v_fmac_f32 v112, v60, v164
    v_fmac_f32 v113, v61, v164
    v_fmac_f32 v114, v62, v164
    v_fmac_f32 v115, v63, v164
F_rb_75:
    s_mov_b64 exec, s[76:77]
    s_cbranch_execz F_rb_76
    v_fmac_f32 v116, v64, v165
    v_fmac_f32 v117, v65, v165
    v_fmac_f32 v118, v66, v165
    v_fmac_f32 v119, v67, v165
    v_fmac_f32 v120, v68, v165
    v_fmac_f32 v121, v69, v165
    v_fmac_f32 v122, v70, v165
    v_fmac_f32 v123, v71, v165
    v_fmac_f32 v124, v80, v165
    v_fmac_f32 v125, v81, v165
    v_fmac_f32 v126, v82, v165
    v_fmac_f32 v127, v83, v165
    v_fmac_f32 v128, v84, v165
    v_fmac_f32 v129, v85, v165
    v_fmac_f32 v130, v86, v165
    v_fmac_f32 v131, v87, v165
F_rb_76:
    s_mov_b64 exec, -1
F_fin:
    v_cvt_pk_bf16_f32 v16, v100, v101
    v_cvt_pk_bf16_f32 v17, v102, v103
    v_cvt_pk_bf16_f32 v18, v104, v105
    v_cvt_pk_bf16_f32 v19, v106, v107
    v_cvt_pk_bf16_f32 v20, v108, v109
    v_cvt_pk_bf16_f32 v21, v110, v111
    v_cvt_pk_bf16_f32 v22, v112, v113
    v_cvt_pk_bf16_f32 v23, v114, v115
    v_permlane16_swap_b32 v16, v18
    v_permlane16_swap_b32 v17, v19
    v_permlane16_swap_b32 v20, v22
    v_permlane16_swap_b32 v21, v23
    v_mov_b32 v4, v16
    v_mov_b32 v5, v17
    v_mov_b32 v6, v18
    v_mov_b32 v7, v19
    v_mov_b32_dpp v16, v20 row_ror:8 row_mask:0xf bank_mask:0xc
    v_mov_b32_dpp v17, v21 row_ror:8 row_mask:0xf bank_mask:0xc
    v_mov_b32_dpp v18, v22 row_ror:8 row_mask:0xf bank_mask:0xc
    v_mov_b32_dpp v19, v23 row_ror:8 row_mask:0xf bank_mask:0xc
    v_mov_b32_dpp v20, v4 row_ror:8 row_mask:0xf bank_mask:0x3
    v_mov_b32_dpp v21, v5 row_ror:8 row_mask:0xf bank_mask:0x3
    v_mov_b32_dpp v22, v6 row_ror:8 row_mask:0xf bank_mask:0x3
    v_mov_b32_dpp v23, v7 row_ror:8 row_mask:0xf bank_mask:0x3
    s_add_u32 s44, s42, 0x4000
    buffer_store_dwordx4 v[16:19], v1, s[12:15], s42 offen sc1
    buffer_store_dwordx4 v[20:23], v1, s[12:15], s44 offen sc1
    v_cvt_pk_bf16_f32 v24, v116, v117
    v_cvt_pk_bf16_f32 v25, v118, v119
    v_cvt_pk_bf16_f32 v26, v120, v121
    v_cvt_pk_bf16_f32 v27, v122, v123
    v_cvt_pk_bf16_f32 v28, v124, v125
    v_cvt_pk_bf16_f32 v29, v126, v127
    v_cvt_pk_bf16_f32 v30, v128, v129
    v_cvt_pk_bf16_f32 v31, v130, v131
    v_permlane16_swap_b32 v24, v26
    v_permlane16_swap_b32 v25, v27
    v_permlane16_swap_b32 v28, v30
    v_permlane16_swap_b32 v29, v31
    v_mov_b32 v4, v24
    v_mov_b32 v5, v25
    v_mov_b32 v6, v26
    v_mov_b32 v7, v27
    v_mov_b32_dpp v24, v28 row_ror:8 row_mask:0xf bank_mask:0xc
    v_mov_b32_dpp v25, v29 row_ror:8 row_mask:0xf bank_mask:0xc
    v_mov_b32_dpp v26, v30 row_ror:8 row_mask:0xf bank_mask:0xc
    v_mov_b32_dpp v27, v31 row_ror:8 row_mask:0xf bank_mask:0xc
    v_mov_b32_dpp v28, v4 row_ror:8 row_mask:0xf bank_mask:0x3
    v_mov_b32_dpp v29, v5 row_ror:8 row_mask:0xf bank_mask:0x3
    v_mov_b32_dpp v30, v6 row_ror:8 row_mask:0xf bank_mask:0x3
    v_mov_b32_dpp v31, v7 row_ror:8 row_mask:0xf bank_mask:0x3
    s_add_u32 s44, s43, 0x4000
    buffer_store_dwordx4 v[24:27], v1, s[12:15], s43 offen sc1
    buffer_store_dwordx4 v[28:31], v1, s[12:15], s44 offen sc1
    s_endpgm
F_aux:
    s_setprio 3
    s_sub_u32 s3, s3, 8
    s_mov_b32 s88, s3
    v_lshrrev_b32 v5, 4, v0
    s_cmp_eq_u32 s3, 1
    s_mov_b32 s45, 73728
    s_cselect_b32 s45, 65536, s45
    s_cmp_eq_u32 s3, 2
    s_cselect_b32 s45, 147456, s45
    v_bfe_u32 v60, v0, 2, 2
    v_lshl_add_u32 v62, v5, 3, v60
    v_lshrrev_b32 v60, 1, v60
    v_and_b32 v63, 1, v5
    v_lshl_add_u32 v60, v63, 1, v60
    v_lshlrev_b32 v60, 5, v60
    v_lshl_add_u32 v60, v62, 7, v60
    v_and_b32 v63, 3, v0
    v_lshl_add_u32 v60, v63, 3, v60
    v_add_u32 v62, s45, v60
    v_xor_b32 v63, 32, v62
    v_xor_b32 v64, 64, v62
    v_xor_b32 v65, 96, v62
    v_lshlrev_b32 v2, 4, v0
    v_lshlrev_b32 v3, 2, v0
    v_and_b32 v7, 15, v0
    v_and_b32 v8, 7, v0
    v_lshlrev_b32 v8, 4, v8
    v_lshl_add_u32 v8, v5, 7, v8
    v_bfe_u32 v9, v0, 3, 1
    v_lshl_add_u32 v4, v9, 11, v8
    v_and_b32 v9, 1, v0
    v_lshlrev_b32 v59, 2, v7
    s_lshl_b32 s76, s32, 4
    s_add_u32 s76, s76, s33
    s_lshl_b32 s77, s76, 3
    s_lshl_b32 s44, s3, 1
    s_add_u32 s77, s77, s44
    v_mov_b32 v12, 0
    v_mov_b32 v13, 0
    v_mov_b32 v14, 0
    v_mov_b32 v15, 0
    s_lshl_b32 s75, s3, 4
    s_add_u32 s75, s75, s33
    s_lshl_b32 s44, s3, 2
    s_add_u32 s44, s44, 159040
    v_mov_b32 v10, s44

    v_mov_b32 v32, 0x3f803f80
    v_mov_b32 v33, 0x3f803f80
    v_mov_b32 v34, 0x3f803f80
    v_mov_b32 v35, 0x3f803f80
    v_mov_b32 v36, 0x3f803f80
    v_mov_b32 v37, 0x3f803f80
    v_mov_b32 v38, 0x3f803f80
    v_mov_b32 v39, 0x3f803f80
    v_mov_b32 v40, 0x3f803f80
    v_mov_b32 v41, 0x3f803f80
    v_mov_b32 v42, 0x3f803f80
    v_mov_b32 v43, 0x3f803f80
    v_mov_b32 v44, 0x3f803f80
    v_mov_b32 v45, 0x3f803f80
    v_mov_b32 v46, 0x3f803f80
    v_mov_b32 v47, 0x3f803f80
    s_waitcnt lgkmcnt(0)
    s_mov_b32 s20, s4
    s_mov_b32 s21, s5
    s_mov_b32 s22, 0x400000
    s_mov_b32 s23, 0x00020000
    s_mov_b32 s19, 0x20000
    s_add_u32 s40, s72, 0x850000
    s_addc_u32 s41, s73, 0
    s_mov_b32 s42, 0xd000
    s_mov_b32 s43, 0x00020000
    s_cmp_lg_u32 s3, 0
    s_cbranch_scc1 F_z0
    s_getpc_b64 s[46:47]
F_pc:
    s_sub_u32 s46, s46, F_pc-parallel_sum__linear_attn_block__moe_arch_mod__prompt_kernel
    s_subb_u32 s47, s47, 0
    s_and_b32 s44, s31, 7
    s_lshl_b32 s44, s44, 13
    v_lshlrev_b32 v67, 7, v0
    v_add_u32 v67, s44, v67
    v_min_u32 v67, F_codeend-parallel_sum__linear_attn_block__moe_arch_mod__prompt_kernel-4, v67
    global_load_dword v61, v67, s[46:47]
    s_cmp_lg_u32 s75, 0
    s_cbranch_scc1 F_z0
    s_lshl_b32 s44, s32, 9
    s_add_u32 s44, s44, 32768
    s_mov_b32 exec_hi, 0
    buffer_store_dwordx4 v[12:15], v2, s[40:43], s44 offen sc0 sc1
    s_mul_i32 s44, s32, 768
    s_add_u32 s44, s44, 40960
    s_mov_b32 exec_hi, 0xffff
    buffer_store_dwordx4 v[12:15], v2, s[40:43], s44 offen sc0 sc1
    s_mov_b64 exec, -1
F_z0:

    s_and_b32 s89, s2, 0xdd
    s_bfe_u32 s44, s2, 0x10005
    s_lshl_b32 s44, s44, 1
    s_or_b32 s89, s89, s44
    s_bfe_u32 s44, s2, 0x10001
    s_xor_b32 s44, s44, 1
    s_lshl_b32 s44, s44, 5
    s_or_b32 s89, s89, s44
    s_xor_b32 s89, s89, 0

    s_and_b32 s36, s89, 3
    s_bfe_u32 s37, s89, 0x10002
    s_lshr_b32 s38, s89, 3
    s_cmp_eq_u32 s37, 0
    s_cselect_b32 s16, s62, s64
    s_cselect_b32 s17, s63, s65
    s_cmp_lt_u32 s89, 224
    s_cselect_b32 s18, 7340032, 0
    v_mul_u32_u24 v6, 57344, v5
    v_lshl_add_u32 v6, v7, 4, v6
    s_lshl_b32 s44, s36, 2
    s_add_u32 s44, s44, s3
    s_mul_i32 s54, s44, 458752
    s_lshl_b32 s45, s38, 8
    s_add_u32 s54, s54, s45
    s_lshl_b32 s55, s44, 7

    s_add_u32 s39, s35, 2
    s_and_b32 s39, s39, 7
    s_lshl_b32 s10, s34, 3
    s_add_u32 s10, s10, s30

    s_mul_i32 s10, s10, 112
    s_mul_i32 s79, s3, 28
    s_add_u32 s10, s10, s79
    s_lshl_b32 s78, s10, 11
    s_lshl_b32 s79, s39, 8
    s_add_u32 s78, s78, s79
    v_mul_u32_u24 v160, 14336, v5
    v_lshl_add_u32 v160, v7, 4, v160

    s_mov_b32 s80, s66
    s_mov_b32 s81, s67
    s_mov_b32 s82, 0x700000
    s_mov_b32 s83, 0x00020000
    s_barrier
    s_bitcmp0_b32 s3, 0
    s_cbranch_scc1 F_cs1
    ds_read_b64_tr_b16 v[72:73], v62 offset:0
    ds_read_b64_tr_b16 v[74:75], v62 offset:512
    ds_read_b64_tr_b16 v[76:77], v62 offset:4096
    ds_read_b64_tr_b16 v[78:79], v62 offset:4608
    ds_read_b64_tr_b16 v[80:81], v63 offset:0
    ds_read_b64_tr_b16 v[82:83], v63 offset:512
    ds_read_b64_tr_b16 v[84:85], v63 offset:4096
    ds_read_b64_tr_b16 v[86:87], v63 offset:4608
    s_waitcnt lgkmcnt(4)
    ds_read_b64_tr_b16 v[88:89], v64 offset:0
    ds_read_b64_tr_b16 v[90:91], v64 offset:512
    ds_read_b64_tr_b16 v[92:93], v64 offset:4096
    ds_read_b64_tr_b16 v[94:95], v64 offset:4608
    ds_read_b64_tr_b16 v[96:97], v65 offset:0
    ds_read_b64_tr_b16 v[98:99], v65 offset:512
    ds_read_b64_tr_b16 v[100:101], v65 offset:4096
    ds_read_b64_tr_b16 v[102:103], v65 offset:4608
    s_branch F_cs2
F_cs1:
    v_add_u32 v60, 159040, v3
    s_mov_b32 exec_hi, 0xffff
    ds_write_b32 v60, v12
    s_mov_b64 exec, -1
F_cs2:
    s_add_u32 s24, s72, 0x800000
    s_addc_u32 s25, s73, 0
    s_mov_b32 s26, 0x48000
    s_mov_b32 s27, 0x00020000
    s_mov_b32 s48, s70
    s_mov_b32 s49, s71
    s_mov_b32 s50, 0x100
    s_mov_b32 s51, 0x00020000
    s_lshl_b32 s47, s32, 9
    s_add_u32 s56, s47, 0x858000
    s_add_u32 s56, s72, s56
    s_addc_u32 s57, s73, 0
    s_lshl_b32 s47, s33, 9
    s_add_u32 s58, s47, 0x858100
    s_add_u32 s58, s72, s58
    s_addc_u32 s59, s73, 0
    v_mov_b32 v68, 0x3f803f80
    v_mov_b32 v69, 0x3f803f80
    v_mov_b32 v70, 0x3f803f80
    v_mov_b32 v71, 0x3f803f80
    s_waitcnt lgkmcnt(0)
    s_cmp_lg_u32 s75, 0
    s_cbranch_scc1 F_z4
    s_lshl_b32 s45, s32, 2
    s_add_u32 s44, s70, s45
    s_addc_u32 s45, s71, 0
    s_mov_b32 s46, 1
    s_waitcnt vmcnt(0)
    s_atomic_add s46, s[44:45], 0
F_z4:

    s_bitcmp0_b32 s3, 0
    s_cbranch_scc1 F_c2a
    v_mfma_f32_16x16x32_bf16 v[104:107], v[68:71], v[72:75], 0
    v_mfma_f32_16x16x32_bf16 v[108:111], v[68:71], v[80:83], 0
    v_mfma_f32_16x16x32_bf16 v[112:115], v[68:71], v[88:91], 0
    v_mfma_f32_16x16x32_bf16 v[116:119], v[68:71], v[96:99], 0
    v_mfma_f32_16x16x32_bf16 v[104:107], v[68:71], v[76:79], v[104:107]
    v_mfma_f32_16x16x32_bf16 v[108:111], v[68:71], v[84:87], v[108:111]
    v_mfma_f32_16x16x32_bf16 v[112:115], v[68:71], v[92:95], v[112:115]
    v_mfma_f32_16x16x32_bf16 v[116:119], v[68:71], v[100:103], v[116:119]
    v_cmp_eq_u32 vcc, 1, v5
    s_nop 4
    v_cndmask_b32 v66, v104, v108, vcc
    v_cmp_eq_u32 vcc, 2, v5
    s_nop 1
    v_cndmask_b32 v66, v66, v112, vcc
    v_cmp_eq_u32 vcc, 3, v5
    s_nop 1
    v_cndmask_b32 v66, v66, v116, vcc

F_c2a:
    s_barrier
    s_cmp_lg_u32 s3, 2
    s_cbranch_scc1 F_cs3
    ds_read_b64_tr_b16 v[72:73], v62 offset:0
    ds_read_b64_tr_b16 v[74:75], v62 offset:512
    ds_read_b64_tr_b16 v[76:77], v62 offset:4096
    ds_read_b64_tr_b16 v[78:79], v62 offset:4608
    ds_read_b64_tr_b16 v[80:81], v63 offset:0
    ds_read_b64_tr_b16 v[82:83], v63 offset:512
    ds_read_b64_tr_b16 v[84:85], v63 offset:4096
    ds_read_b64_tr_b16 v[86:87], v63 offset:4608
    s_branch IW_s8
IW_w8:
    s_branch IW_r8
IW_s8:
    s_waitcnt lgkmcnt(4)
    ds_read_b64_tr_b16 v[88:89], v64 offset:0
    ds_read_b64_tr_b16 v[90:91], v64 offset:512
    ds_read_b64_tr_b16 v[92:93], v64 offset:4096
    ds_read_b64_tr_b16 v[94:95], v64 offset:4608
    ds_read_b64_tr_b16 v[96:97], v65 offset:0
    ds_read_b64_tr_b16 v[98:99], v65 offset:512
    ds_read_b64_tr_b16 v[100:101], v65 offset:4096
    ds_read_b64_tr_b16 v[102:103], v65 offset:4608
    s_waitcnt lgkmcnt(0)
F_cs3:
    s_cmp_lg_u32 s3, 0
    s_cbranch_scc1 EV_78
    s_branch IW_w8
IW_r8:
EV_78:
    s_cmp_lg_u32 s3, 1
    s_cbranch_scc1 EV_79
    s_branch IW_w0
IW_r0:
EV_79:
    s_cmp_lg_u32 s3, 2
    s_cbranch_scc1 EV_80
    s_branch IW_w1
IW_r1:
EV_80:
    s_cmp_lg_u32 s3, 3
    s_cbranch_scc1 EV_81
    s_branch IW_w3
IW_r3:
EV_81:
    s_barrier
    s_cmp_lt_u32 s3, 2
    s_mov_b32 s44, 98304
    s_cselect_b32 s44, 98304, s44
    s_lshl_b32 s45, s3, 12
    s_add_u32 s44, s44, s45
    v_add_u32 v4, s44, v4
    v_add_u32 v8, 161792, v8
    ds_read_b128 v[16:19], v4 offset:0
    ds_read_b128 v[20:23], v4 offset:512
    ds_read_b128 v[24:27], v4 offset:1024
    ds_read_b128 v[28:31], v4 offset:1536
    s_mov_b32 exec_lo, 0x00ff00ff
    s_mov_b32 exec_hi, 0x00ff00ff
    ds_read_b128 v[32:35], v8 offset:0
    ds_read_b128 v[36:39], v8 offset:512
    ds_read_b128 v[40:43], v8 offset:1024
    ds_read_b128 v[44:47], v8 offset:1536
    s_mov_b64 exec, -1
    s_waitcnt lgkmcnt(0)
    v_mfma_f32_16x16x32_bf16 v[120:123], v[16:19], v[16:19], 0
    v_mfma_f32_16x16x32_bf16 v[124:127], v[16:19], v[32:35], 0
    v_mfma_f32_16x16x32_bf16 v[128:131], v[32:35], v[32:35], 0
    v_mfma_f32_16x16x32_bf16 v[120:123], v[20:23], v[20:23], v[120:123]
    v_mfma_f32_16x16x32_bf16 v[124:127], v[20:23], v[36:39], v[124:127]
    v_mfma_f32_16x16x32_bf16 v[128:131], v[36:39], v[36:39], v[128:131]
    v_mfma_f32_16x16x32_bf16 v[120:123], v[24:27], v[24:27], v[120:123]
    v_mfma_f32_16x16x32_bf16 v[124:127], v[24:27], v[40:43], v[124:127]
    v_mfma_f32_16x16x32_bf16 v[128:131], v[40:43], v[40:43], v[128:131]
    v_mfma_f32_16x16x32_bf16 v[120:123], v[28:31], v[28:31], v[120:123]
    v_mfma_f32_16x16x32_bf16 v[124:127], v[28:31], v[44:47], v[124:127]
    v_mfma_f32_16x16x32_bf16 v[128:131], v[44:47], v[44:47], v[128:131]
    s_cmp_lg_u32 s3, 2
    s_cbranch_scc1 F_c2b
    v_mfma_f32_16x16x32_bf16 v[104:107], v[68:71], v[72:75], 0
    v_mfma_f32_16x16x32_bf16 v[108:111], v[68:71], v[80:83], 0
    v_mfma_f32_16x16x32_bf16 v[112:115], v[68:71], v[88:91], 0
    v_mfma_f32_16x16x32_bf16 v[116:119], v[68:71], v[96:99], 0
    v_mfma_f32_16x16x32_bf16 v[104:107], v[68:71], v[76:79], v[104:107]
    v_mfma_f32_16x16x32_bf16 v[108:111], v[68:71], v[84:87], v[108:111]
    v_mfma_f32_16x16x32_bf16 v[112:115], v[68:71], v[92:95], v[112:115]
    v_mfma_f32_16x16x32_bf16 v[116:119], v[68:71], v[100:103], v[116:119]
    v_cmp_eq_u32 vcc, 1, v5
    s_nop 4
    v_cndmask_b32 v66, v104, v108, vcc
    v_cmp_eq_u32 vcc, 2, v5
    s_nop 1
    v_cndmask_b32 v66, v66, v112, vcc
    v_cmp_eq_u32 vcc, 3, v5
    s_nop 1
    v_cndmask_b32 v66, v66, v116, vcc

F_c2b:
    s_cmp_lg_u32 s3, 0
    s_cbranch_scc1 F_r1
    buffer_load_dword v11, v59, s[48:51], 0 offen sc0 sc1
F_r1:
    s_cmp_lg_u32 s3, 0
    s_cbranch_scc1 EV_83
    s_branch IW_w4
IW_r4:
EV_83:
    s_cmp_lg_u32 s3, 1
    s_cbranch_scc1 EV_84
    s_branch IW_w9
IW_r9:
EV_84:
    s_cmp_lg_u32 s3, 2
    s_cbranch_scc1 EV_85
    s_branch IW_w10
IW_r10:
EV_85:
    s_cmp_lg_u32 s3, 3
    s_cbranch_scc1 EV_86
    s_nop 0
EV_86:
    s_barrier
    v_and_b32 v52, 3, v0
    v_cmp_eq_u32 vcc, 1, v52
    s_nop 1
    v_cndmask_b32 v120, v120, v121, vcc
    v_cndmask_b32 v124, v124, v125, vcc
    v_cndmask_b32 v128, v128, v129, vcc
    v_cmp_eq_u32 vcc, 2, v52
    s_nop 1
    v_cndmask_b32 v120, v120, v122, vcc
    v_cndmask_b32 v124, v124, v126, vcc
    v_cndmask_b32 v128, v128, v130, vcc
    v_cmp_eq_u32 vcc, 3, v52
    s_nop 1
    v_cndmask_b32 v120, v120, v123, vcc
    v_cndmask_b32 v124, v124, v127, vcc
    v_cndmask_b32 v128, v128, v131, vcc
    v_add_f32_dpp v120, v120, v120 quad_perm:[1,0,3,2] row_mask:0xf bank_mask:0xf
    v_add_f32_dpp v124, v124, v124 quad_perm:[1,0,3,2] row_mask:0xf bank_mask:0xf
    v_add_f32_dpp v128, v128, v128 quad_perm:[1,0,3,2] row_mask:0xf bank_mask:0xf
    v_add_f32_dpp v120, v120, v120 quad_perm:[2,3,0,1] row_mask:0xf bank_mask:0xf
    v_add_f32_dpp v124, v124, v124 quad_perm:[2,3,0,1] row_mask:0xf bank_mask:0xf
    v_add_f32_dpp v128, v128, v128 quad_perm:[2,3,0,1] row_mask:0xf bank_mask:0xf
    v_readlane_b32 s44, v124, 8
    v_readlane_b32 s45, v124, 24
    v_readlane_b32 s46, v124, 40
    v_readlane_b32 s47, v124, 56
    v_mov_b32 v48, s44
    v_mov_b32 v52, s45
    s_nop 0
    v_writelane_b32 v48, s46, 1
    v_writelane_b32 v52, s47, 1
    v_readlane_b32 s44, v120, 0
    v_readlane_b32 s45, v120, 20
    v_readlane_b32 s46, v120, 40
    v_readlane_b32 s47, v120, 60
    v_mov_b32 v49, s44
    v_mov_b32 v53, s45
    s_nop 0
    v_writelane_b32 v49, s46, 1
    v_writelane_b32 v53, s47, 1
    v_readlane_b32 s44, v124, 0
    v_readlane_b32 s45, v124, 20
    v_readlane_b32 s46, v124, 32
    v_readlane_b32 s47, v124, 52
    v_mov_b32 v50, s44
    v_mov_b32 v54, s45
    s_nop 0
    v_writelane_b32 v50, s46, 1
    v_writelane_b32 v54, s47, 1
    v_readlane_b32 s44, v128, 8
    v_readlane_b32 s45, v128, 24
    v_readlane_b32 s46, v128, 8
    v_readlane_b32 s47, v128, 24
    v_mov_b32 v51, s44
    v_mov_b32 v55, s45
    s_nop 0
    v_writelane_b32 v51, s46, 1
    v_writelane_b32 v55, s47, 1
    v_add_f32 v48, v48, v52
    v_add_f32 v49, v49, v53
    v_add_f32 v50, v50, v54
    v_add_f32 v51, v51, v55
    v_mul_f32 v48, 0x3a800000, v48
    v_mul_f32 v49, 0x3a800000, v49
    v_fma_f32 v49, -v48, v48, v49
    v_max_f32 v49, 0, v49
    v_cvt_pk_bf16_f32 v52, v48, v49
    v_lshlrev_b32 v48, 16, v52
    v_and_b32 v49, 0xffff0000, v52
    v_add_f32 v49, 0x3727c5ac, v49
    v_cvt_pk_bf16_f32 v49, v49, v49
    v_lshlrev_b32 v49, 16, v49
    v_sqrt_f32 v49, v49
    s_nop 0
    v_cvt_pk_bf16_f32 v49, v49, v49
    v_lshlrev_b32 v49, 16, v49
    v_rcp_f32 v49, v49
    v_xor_b32 v48, 0x80000000, v48
    v_fma_f32 v50, v48, v51, v50
    v_mul_f32 v50, v50, v49
    v_cvt_pk_bf16_f32 v50, v50, v50
    v_and_b32 v50, 0xffff0000, v50
    v_ashrrev_i32 v51, 31, v50
    v_or_b32 v51, 0x80000000, v51
    v_xor_b32 v50, v50, v51
    v_and_b32 v50, 0xffff0000, v50
    s_sub_u32 s44, 2047, s77
    v_sub_u32 v51, s44, v9
    v_or_b32 v50, v50, v51
    s_lshl_b32 s44, s3, 1
    v_add_u32 v52, s44, v9
    v_lshlrev_b32 v53, 3, v52
    v_lshlrev_b32 v52, 2, v52
    v_add_u32 v53, 159744, v53
    v_add_u32 v52, 159808, v52
    s_mov_b64 exec, 3
    ds_write_b64 v53, v[48:49]
    ds_write_b32 v52, v50
    s_mov_b64 exec, -1
    s_waitcnt lgkmcnt(0)

    s_cmp_lg_u32 s3, 0
    s_cbranch_scc1 F_a0r
F_a0p:
    s_waitcnt vmcnt(0)
    v_cmp_eq_u32 vcc, 0, v11
    s_cbranch_vccz F_a0r
    s_sleep 4
    buffer_load_dword v11, v59, s[48:51], 0 offen sc0 sc1
    s_branch F_a0p
F_a0r:
    s_barrier
    s_cmp_eq_u32 s3, 0
    s_cbranch_scc1 F_ax0
    s_mul_i32 s44, s33, 768
    s_add_u32 s44, s44, 40960
    s_add_u32 s45, s3, 1
    s_lshr_b32 s45, s45, 1
    s_cmp_eq_u32 s3, 2
    s_cselect_b32 s45, 0, s45
    s_lshl_b32 s45, s45, 8
    s_add_u32 s44, s44, s45
    buffer_atomic_add_f32 v66, v3, s[40:43], s44 offen
    s_mul_i32 s44, s2, 1152
    s_mul_i32 s45, s3, 384
    s_add_u32 s44, s44, s45
    s_sub_u32 s44, s44, 384
    s_mov_b64 exec, 0xffffff
    buffer_store_dwordx4 v[12:15], v2, s[24:27], s44 offen sc0 sc1
    s_mov_b64 exec, -1
    s_branch F_s1
F_ax0:
    v_add_u32 v60, 159744, v3
    ds_read_b32 v60, v60
    s_lshl_b32 s44, s76, 7
    s_mov_b32 exec_hi, 0
    s_waitcnt lgkmcnt(0)
    buffer_store_dword v60, v3, s[40:43], s44 offen sc0 sc1
    s_mov_b64 exec, -1
F_s1:

    s_barrier
    v_mov_b32 v4, 159144
    v_mov_b32 v8, 1
    s_lshr_b32 s47, s32, 2
    s_lshl_b32 s47, s47, 11
    s_add_u32 s86, s47, 0x858180
    s_add_u32 s86, s72, s86
    s_addc_u32 s87, s73, 0
    s_waitcnt vmcnt(0)
    s_mov_b64 exec, 1
    ds_add_rtn_u32 v9, v4, v8
    s_waitcnt lgkmcnt(0)
    v_readfirstlane_b32 s44, v9
    s_mov_b64 exec, -1
    s_cmp_lg_u32 s44, 3
    s_cbranch_scc1 F_a0s
    s_mov_b32 s74, 1
    s_atomic_add s74, s[86:87], 0
    s_atomic_add s74, s[56:57], 0
    s_atomic_add s74, s[58:59], 0
F_a0s:

    s_barrier
    s_mul_i32 s53, s2, 37
    s_and_b32 s53, s53, 255
    s_mul_i32 s53, s53, 4
    s_lshr_b32 s53, s53, 8
    s_branch F_swx
F_sw0:
    s_add_u32 s91, s54, 0
    buffer_load_dwordx4 v[72:75], v6, s[16:19], s91 offen nt
    s_add_u32 s91, s54, 7168
    buffer_load_dwordx4 v[76:79], v6, s[16:19], s91 offen nt
    s_add_u32 s91, s54, 14336
    buffer_load_dwordx4 v[80:83], v6, s[16:19], s91 offen nt
    s_add_u32 s91, s54, 21504
    buffer_load_dwordx4 v[84:87], v6, s[16:19], s91 offen nt
    s_add_u32 s91, s54, 28672
    buffer_load_dwordx4 v[88:91], v6, s[16:19], s91 offen nt
    s_add_u32 s91, s54, 35840
    buffer_load_dwordx4 v[92:95], v6, s[16:19], s91 offen nt
    s_add_u32 s91, s54, 43008
    buffer_load_dwordx4 v[96:99], v6, s[16:19], s91 offen nt
    s_add_u32 s91, s54, 50176
    buffer_load_dwordx4 v[100:103], v6, s[16:19], s91 offen nt
    s_setpc_b64 s[34:35]
F_swx:
    s_cmp_eq_u32 s3, 2
    s_cbranch_scc1 F_ax2
    s_cmp_eq_u32 s3, 1
    s_cbranch_scc1 F_ax1
    s_cmp_eq_u32 s3, 0
    s_cbranch_scc1 F_ax0b
    s_barrier
    s_cmp_lg_u32 s53, 0
    s_cbranch_scc1 SW_87
    s_call_b64 s[34:35], F_sw0
SW_87:
    s_branch IW_w5
IW_r5:
    s_barrier
    s_cmp_lg_u32 s53, 1
    s_cbranch_scc1 SW_88
    s_call_b64 s[34:35], F_sw0
SW_88:
    s_branch IW_w7
IW_r7:
    s_barrier
    s_cmp_lg_u32 s53, 2
    s_cbranch_scc1 SW_89
    s_call_b64 s[34:35], F_sw0
SW_89:
    s_nop 0
    s_barrier
    s_cmp_lg_u32 s53, 3
    s_cbranch_scc1 SW_90
    s_call_b64 s[34:35], F_sw0
SW_90:
    s_nop 0
    s_barrier
    s_nop 0
    s_barrier
    s_nop 0
    s_barrier
    s_add_u32 s91, s54, 229376
    buffer_load_dwordx4 v[104:107], v6, s[16:19], s91 offen nt
    s_add_u32 s91, s54, 236544
    buffer_load_dwordx4 v[108:111], v6, s[16:19], s91 offen nt
    s_add_u32 s91, s54, 243712
    buffer_load_dwordx4 v[112:115], v6, s[16:19], s91 offen nt
    s_add_u32 s91, s54, 250880
    buffer_load_dwordx4 v[116:119], v6, s[16:19], s91 offen nt
    s_nop 0
    s_load_dword s76, s[56:57], 0 glc
    s_barrier
    s_add_u32 s91, s54, 258048
    buffer_load_dwordx4 v[120:123], v6, s[16:19], s91 offen nt
    s_add_u32 s91, s54, 265216
    buffer_load_dwordx4 v[124:127], v6, s[16:19], s91 offen nt
    s_add_u32 s91, s54, 272384
    buffer_load_dwordx4 v[128:131], v6, s[16:19], s91 offen nt
    s_add_u32 s91, s54, 279552
    buffer_load_dwordx4 v[132:135], v6, s[16:19], s91 offen nt
    s_waitcnt lgkmcnt(0)
    s_cmp_lt_u32 s76, 1000
    s_cbranch_scc1 F_g3
    v_mov_b32 v4, 1
    s_mov_b64 exec, 1
    ds_write_b32 v10, v4 offset:48
    s_mov_b64 exec, -1
    s_mov_b32 s88, 0
F_g3:
    s_barrier
    s_branch F_aj
F_ax1:
    s_barrier
    s_cmp_lg_u32 s53, 0
    s_cbranch_scc1 SW_91
    s_call_b64 s[34:35], F_sw0
SW_91:
    s_branch IW_w6
IW_r6:
    s_barrier
    s_cmp_lg_u32 s53, 1
    s_cbranch_scc1 SW_92
    s_call_b64 s[34:35], F_sw0
SW_92:
    s_nop 0
    s_barrier
    s_cmp_lg_u32 s53, 2
    s_cbranch_scc1 SW_93
    s_call_b64 s[34:35], F_sw0
SW_93:
    s_nop 0
    s_mul_i32 s44, s33, 768
    s_add_u32 s44, s44, 40960
    s_barrier
    s_cmp_lg_u32 s53, 3
    s_cbranch_scc1 SW_94
    s_call_b64 s[34:35], F_sw0
SW_94:
    s_load_dword s76, s[58:59], 0 glc
    s_barrier
    s_waitcnt lgkmcnt(0)
    s_cmp_ge_u32 s76, 16
    s_cbranch_scc1 GC_95
SP_96:
    s_load_dword s76, s[58:59], 0 glc
    s_waitcnt lgkmcnt(0)
    s_cmp_ge_u32 s76, 16
    s_cbranch_scc1 SD_97
    s_sleep 3
    s_branch SP_96
SD_97:
GC_95:
    s_barrier
    s_sleep 4
    s_mov_b32 m0, 158208
    s_mov_b32 exec_hi, 0xffff
    buffer_load_dwordx4 v2, s[40:43], s44 offen sc0 sc1 lds
    s_mov_b64 exec, -1
    s_barrier
    s_add_u32 s91, s54, 229376
    buffer_load_dwordx4 v[104:107], v6, s[16:19], s91 offen nt
    s_add_u32 s91, s54, 236544
    buffer_load_dwordx4 v[108:111], v6, s[16:19], s91 offen nt
    s_add_u32 s91, s54, 243712
    buffer_load_dwordx4 v[112:115], v6, s[16:19], s91 offen nt
    s_add_u32 s91, s54, 250880
    buffer_load_dwordx4 v[116:119], v6, s[16:19], s91 offen nt
    s_barrier
    s_add_u32 s91, s54, 258048
    buffer_load_dwordx4 v[120:123], v6, s[16:19], s91 offen nt
    s_add_u32 s91, s54, 265216
    buffer_load_dwordx4 v[124:127], v6, s[16:19], s91 offen nt
    s_add_u32 s91, s54, 272384
    buffer_load_dwordx4 v[128:131], v6, s[16:19], s91 offen nt
    s_add_u32 s91, s54, 279552
    buffer_load_dwordx4 v[132:135], v6, s[16:19], s91 offen nt
    s_waitcnt vmcnt(8)
    v_mov_b32 v4, 1
    s_mov_b64 exec, 1
    ds_write_b32 v10, v4 offset:48
    s_mov_b64 exec, -1
    s_barrier
    s_branch F_aj
IW_w9:
    s_branch IW_r9
F_ax0b:
    s_barrier
    s_cmp_lg_u32 s53, 0
    s_cbranch_scc1 SW_98
    s_call_b64 s[34:35], F_sw0
SW_98:
    s_branch IW_w2
IW_r2:
    s_barrier
    s_cmp_lg_u32 s53, 1
    s_cbranch_scc1 SW_99
    s_call_b64 s[34:35], F_sw0
SW_99:
    s_nop 0
    s_barrier
    s_cmp_lg_u32 s53, 2
    s_cbranch_scc1 SW_100
    s_call_b64 s[34:35], F_sw0
SW_100:
    s_nop 0
    s_lshl_b32 s47, s28, 9
    s_waitcnt lgkmcnt(0)
    s_add_u32 s58, s47, 0x858000
    s_add_u32 s58, s72, s58
    s_addc_u32 s59, s73, 0
    s_lshl_b32 s44, s32, 11
    s_lshl_b32 s45, s28, 11
    v_lshrrev_b32 v11, 2, v0
    v_and_b32 v9, 3, v0
    v_lshlrev_b32 v9, 4, v9
    v_lshl_add_u32 v11, v11, 7, v9

    s_barrier
    s_cmp_lg_u32 s53, 3
    s_cbranch_scc1 SW_101
    s_call_b64 s[34:35], F_sw0
SW_101:
    s_load_dword s76, s[56:57], 0 glc
    s_load_dword s77, s[58:59], 0 glc
    s_barrier
    s_waitcnt lgkmcnt(0)
    s_cmp_ge_u32 s76, 16
    s_cbranch_scc1 GC_102
SP_103:
    s_load_dword s76, s[56:57], 0 glc
    s_waitcnt lgkmcnt(0)
    s_cmp_ge_u32 s76, 16
    s_cbranch_scc1 SD_104
    s_sleep 3
    s_branch SP_103
SD_104:
GC_102:
    s_cmp_ge_u32 s77, 16
    s_cbranch_scc1 GC_105
SP_106:
    s_load_dword s77, s[58:59], 0 glc
    s_waitcnt lgkmcnt(0)
    s_cmp_ge_u32 s77, 16
    s_cbranch_scc1 SD_107
    s_sleep 3
    s_branch SP_106
SD_107:
GC_105:
    s_barrier
    s_sleep 4
    buffer_load_dwordx4 v[32:35], v11, s[40:43], s44 offen sc0 sc1
    buffer_load_dwordx4 v[36:39], v11, s[40:43], s45 offen sc0 sc1
    v_lshlrev_b32 v9, 3, v0
    v_add_u32 v9, 155648, v9
    s_mov_b32 s44, 0x3fb8aa3b

    s_barrier
    s_add_u32 s91, s54, 229376
    buffer_load_dwordx4 v[104:107], v6, s[16:19], s91 offen nt
    s_add_u32 s91, s54, 236544
    buffer_load_dwordx4 v[108:111], v6, s[16:19], s91 offen nt
    s_add_u32 s91, s54, 243712
    buffer_load_dwordx4 v[112:115], v6, s[16:19], s91 offen nt
    s_add_u32 s91, s54, 250880
    buffer_load_dwordx4 v[116:119], v6, s[16:19], s91 offen nt
    s_barrier
    s_add_u32 s91, s54, 258048
    buffer_load_dwordx4 v[120:123], v6, s[16:19], s91 offen nt
    s_add_u32 s91, s54, 265216
    buffer_load_dwordx4 v[124:127], v6, s[16:19], s91 offen nt
    s_add_u32 s91, s54, 272384
    buffer_load_dwordx4 v[128:131], v6, s[16:19], s91 offen nt
    s_add_u32 s91, s54, 279552
    buffer_load_dwordx4 v[132:135], v6, s[16:19], s91 offen nt
    s_waitcnt vmcnt(8)
    v_swap_b32 v33, v34
    v_swap_b32 v37, v38
    v_mul_f32 v40, s44, v34
    v_mul_f32 v41, s44, v35
    ds_write_b64 v9, v[32:33]
    ds_write_b64 v9, v[40:41] offset:1024
    ds_write_b64 v9, v[36:37] offset:1536
    ds_write_b64 v9, v[38:39] offset:2048

    v_mov_b32 v4, 1
    s_mov_b64 exec, 1
    ds_write_b32 v10, v4 offset:48
    s_mov_b64 exec, -1
    s_barrier
    s_branch F_aj
F_ax2:
    s_cmp_lg_u32 s2, 248
    s_cbranch_scc1 F_a2n
    s_waitcnt lgkmcnt(0)
    s_mov_b32 s74, 7
    v_lshrrev_b32 v11, 1, v0
    v_and_b32 v9, 1, v0
    v_lshlrev_b32 v9, 4, v9
    v_lshl_add_u32 v11, v11, 7, v9
    v_lshlrev_b32 v9, 9, v0
    v_mov_b32 v8, 1000
F_a2l:

    s_load_dword s60, s[40:41], 0x8180 glc
    s_load_dword s61, s[40:41], 0x8980 glc
    s_load_dword s62, s[40:41], 0x9180 glc
    s_load_dword s63, s[40:41], 0x9980 glc
    s_waitcnt lgkmcnt(0)
    s_add_u32 s60, s60, s61
    s_add_u32 s62, s62, s63
    s_add_u32 s60, s60, s62
    s_cmp_ge_u32 s60, 256
    s_cbranch_scc1 F_a2t

    s_cmp_ge_u32 s74, 17
    s_cbranch_scc1 DB_108
    s_barrier
    s_add_u32 s74, s74, 1
DB_108:
    s_branch F_a2l
F_a2t:
    s_movk_i32 s44, 0
    buffer_load_dwordx4 v[16:19], v11, s[40:43], s44 offen offset:64 sc0 sc1
    s_movk_i32 s44, 4096
    buffer_load_dwordx4 v[20:23], v11, s[40:43], s44 offen offset:64 sc0 sc1
    s_movk_i32 s44, 8192
    buffer_load_dwordx4 v[24:27], v11, s[40:43], s44 offen offset:64 sc0 sc1
    s_movk_i32 s44, 12288
    buffer_load_dwordx4 v[28:31], v11, s[40:43], s44 offen offset:64 sc0 sc1
    s_movk_i32 s44, 16384
    buffer_load_dwordx4 v[32:35], v11, s[40:43], s44 offen offset:64 sc0 sc1
    s_movk_i32 s44, 20480
    buffer_load_dwordx4 v[36:39], v11, s[40:43], s44 offen offset:64 sc0 sc1
    s_movk_i32 s44, 24576
    buffer_load_dwordx4 v[40:43], v11, s[40:43], s44 offen offset:64 sc0 sc1
    s_movk_i32 s44, 28672
    buffer_load_dwordx4 v[44:47], v11, s[40:43], s44 offen offset:64 sc0 sc1
    s_mov_b32 s44, 32768
    s_mov_b64 exec, 0xffff
    buffer_atomic_add v8, v9, s[40:43], s44 offen
    s_mov_b64 exec, -1

    s_cmp_ge_u32 s74, 17
    s_cbranch_scc1 DB_109
    s_barrier
    s_add_u32 s74, s74, 1
DB_109:
    s_waitcnt vmcnt(1)
    v_max3_u32 v48, v16, v17, v18
    v_med3_u32 v49, v16, v17, v18
    v_min3_u32 v50, v16, v17, v18
    v_med3_u32 v50, v49, v50, v19
    v_med3_u32 v49, v48, v49, v19
    v_max_u32 v48, v48, v19
    v_med3_u32 v50, v49, v50, v20
    v_med3_u32 v49, v48, v49, v20
    v_max_u32 v48, v48, v20
    v_med3_u32 v50, v49, v50, v21
    v_med3_u32 v49, v48, v49, v21
    v_max_u32 v48, v48, v21
    v_med3_u32 v50, v49, v50, v22
    v_med3_u32 v49, v48, v49, v22
    v_max_u32 v48, v48, v22
    v_med3_u32 v50, v49, v50, v23
    v_med3_u32 v49, v48, v49, v23
    v_max_u32 v48, v48, v23
    v_med3_u32 v50, v49, v50, v24
    v_med3_u32 v49, v48, v49, v24
    v_max_u32 v48, v48, v24
    v_med3_u32 v50, v49, v50, v25
    v_med3_u32 v49, v48, v49, v25
    v_max_u32 v48, v48, v25
    v_med3_u32 v50, v49, v50, v26
    v_med3_u32 v49, v48, v49, v26
    v_max_u32 v48, v48, v26
    v_med3_u32 v50, v49, v50, v27
    v_med3_u32 v49, v48, v49, v27
    v_max_u32 v48, v48, v27
    v_med3_u32 v50, v49, v50, v28
    v_med3_u32 v49, v48, v49, v28
    v_max_u32 v48, v48, v28
    v_med3_u32 v50, v49, v50, v29
    v_med3_u32 v49, v48, v49, v29
    v_max_u32 v48, v48, v29
    v_med3_u32 v50, v49, v50, v30
    v_med3_u32 v49, v48, v49, v30
    v_max_u32 v48, v48, v30
    v_med3_u32 v50, v49, v50, v31
    v_med3_u32 v49, v48, v49, v31
    v_max_u32 v48, v48, v31
    v_med3_u32 v50, v49, v50, v32
    v_med3_u32 v49, v48, v49, v32
    v_max_u32 v48, v48, v32
    v_med3_u32 v50, v49, v50, v33
    v_med3_u32 v49, v48, v49, v33
    v_max_u32 v48, v48, v33
    v_med3_u32 v50, v49, v50, v34
    v_med3_u32 v49, v48, v49, v34
    v_max_u32 v48, v48, v34
    v_med3_u32 v50, v49, v50, v35
    v_med3_u32 v49, v48, v49, v35
    v_max_u32 v48, v48, v35
    v_med3_u32 v50, v49, v50, v36
    v_med3_u32 v49, v48, v49, v36
    v_max_u32 v48, v48, v36
    v_med3_u32 v50, v49, v50, v37
    v_med3_u32 v49, v48, v49, v37
    v_max_u32 v48, v48, v37
    v_med3_u32 v50, v49, v50, v38
    v_med3_u32 v49, v48, v49, v38
    v_max_u32 v48, v48, v38
    v_med3_u32 v50, v49, v50, v39
    v_med3_u32 v49, v48, v49, v39
    v_max_u32 v48, v48, v39
    v_med3_u32 v50, v49, v50, v40
    v_med3_u32 v49, v48, v49, v40
    v_max_u32 v48, v48, v40
    v_med3_u32 v50, v49, v50, v41
    v_med3_u32 v49, v48, v49, v41
    v_max_u32 v48, v48, v41
    v_med3_u32 v50, v49, v50, v42
    v_med3_u32 v49, v48, v49, v42
    v_max_u32 v48, v48, v42
    v_med3_u32 v50, v49, v50, v43
    v_med3_u32 v49, v48, v49, v43
    v_max_u32 v48, v48, v43
    v_med3_u32 v50, v49, v50, v44
    v_med3_u32 v49, v48, v49, v44
    v_max_u32 v48, v48, v44
    v_med3_u32 v50, v49, v50, v45
    v_med3_u32 v49, v48, v49, v45
    v_max_u32 v48, v48, v45
    v_med3_u32 v50, v49, v50, v46
    v_med3_u32 v49, v48, v49, v46
    v_max_u32 v48, v48, v46
    v_med3_u32 v50, v49, v50, v47
    v_med3_u32 v49, v48, v49, v47
    v_max_u32 v48, v48, v47
    s_mov_b32 s53, 0
    v_max_u32 v4, v48, v49
    s_nop 1
    v_max_u32_dpp v4, v4, v4 row_shr:1 row_mask:0xf bank_mask:0xf bound_ctrl:0
    s_nop 1
    v_max_u32_dpp v4, v4, v4 row_shr:2 row_mask:0xf bank_mask:0xf bound_ctrl:0
    s_nop 1
    v_max_u32_dpp v4, v4, v4 row_shr:4 row_mask:0xf bank_mask:0xf bound_ctrl:0
    s_nop 1
    v_max_u32_dpp v4, v4, v4 row_shr:8 row_mask:0xf bank_mask:0xf bound_ctrl:0
    s_nop 1
    v_max_u32_dpp v4, v4, v4 row_bcast:15 row_mask:0xa bank_mask:0xf
    s_nop 1
    v_max_u32_dpp v4, v4, v4 row_bcast:31 row_mask:0xc bank_mask:0xf
    s_nop 0
    v_readlane_b32 s52, v4, 63
    s_nop 0
    s_add_u32 s53, s53, s52
    v_writelane_b32 v13, s53, 0
    v_subrev_u32 v48, s52, v48
    v_subrev_u32 v49, s52, v49
    v_max_u32 v4, v48, v49
    s_nop 1
    v_max_u32_dpp v4, v4, v4 row_shr:1 row_mask:0xf bank_mask:0xf bound_ctrl:0
    s_nop 1
    v_max_u32_dpp v4, v4, v4 row_shr:2 row_mask:0xf bank_mask:0xf bound_ctrl:0
    s_nop 1
    v_max_u32_dpp v4, v4, v4 row_shr:4 row_mask:0xf bank_mask:0xf bound_ctrl:0
    s_nop 1
    v_max_u32_dpp v4, v4, v4 row_shr:8 row_mask:0xf bank_mask:0xf bound_ctrl:0
    s_nop 1
    v_max_u32_dpp v4, v4, v4 row_bcast:15 row_mask:0xa bank_mask:0xf
    s_nop 1
    v_max_u32_dpp v4, v4, v4 row_bcast:31 row_mask:0xc bank_mask:0xf
    s_nop 0
    v_readlane_b32 s52, v4, 63
    s_nop 0
    s_add_u32 s53, s53, s52
    v_writelane_b32 v13, s53, 1
    v_subrev_u32 v48, s52, v48
    v_subrev_u32 v49, s52, v49
    v_max_u32 v4, v48, v49
    s_nop 1
    v_max_u32_dpp v4, v4, v4 row_shr:1 row_mask:0xf bank_mask:0xf bound_ctrl:0
    s_nop 1
    v_max_u32_dpp v4, v4, v4 row_shr:2 row_mask:0xf bank_mask:0xf bound_ctrl:0
    s_nop 1
    v_max_u32_dpp v4, v4, v4 row_shr:4 row_mask:0xf bank_mask:0xf bound_ctrl:0
    s_nop 1
    v_max_u32_dpp v4, v4, v4 row_shr:8 row_mask:0xf bank_mask:0xf bound_ctrl:0
    s_nop 1
    v_max_u32_dpp v4, v4, v4 row_bcast:15 row_mask:0xa bank_mask:0xf
    s_nop 1
    v_max_u32_dpp v4, v4, v4 row_bcast:31 row_mask:0xc bank_mask:0xf
    s_nop 0
    v_readlane_b32 s52, v4, 63
    s_nop 0
    s_add_u32 s53, s53, s52
    v_writelane_b32 v13, s53, 2
    v_subrev_u32 v48, s52, v48
    v_subrev_u32 v49, s52, v49
    v_max_u32 v4, v48, v49
    s_nop 1
    v_max_u32_dpp v4, v4, v4 row_shr:1 row_mask:0xf bank_mask:0xf bound_ctrl:0
    s_nop 1
    v_max_u32_dpp v4, v4, v4 row_shr:2 row_mask:0xf bank_mask:0xf bound_ctrl:0
    s_nop 1
    v_max_u32_dpp v4, v4, v4 row_shr:4 row_mask:0xf bank_mask:0xf bound_ctrl:0
    s_nop 1
    v_max_u32_dpp v4, v4, v4 row_shr:8 row_mask:0xf bank_mask:0xf bound_ctrl:0
    s_nop 1
    v_max_u32_dpp v4, v4, v4 row_bcast:15 row_mask:0xa bank_mask:0xf
    s_nop 1
    v_max_u32_dpp v4, v4, v4 row_bcast:31 row_mask:0xc bank_mask:0xf
    s_nop 0
    v_readlane_b32 s52, v4, 63
    s_nop 0
    s_add_u32 s53, s53, s52
    v_writelane_b32 v13, s53, 3
    v_subrev_u32 v48, s52, v48
    v_subrev_u32 v49, s52, v49
    v_max_u32 v4, v48, v49
    s_nop 1
    v_max_u32_dpp v4, v4, v4 row_shr:1 row_mask:0xf bank_mask:0xf bound_ctrl:0
    s_nop 1
    v_max_u32_dpp v4, v4, v4 row_shr:2 row_mask:0xf bank_mask:0xf bound_ctrl:0
    s_nop 1
    v_max_u32_dpp v4, v4, v4 row_shr:4 row_mask:0xf bank_mask:0xf bound_ctrl:0
    s_nop 1
    v_max_u32_dpp v4, v4, v4 row_shr:8 row_mask:0xf bank_mask:0xf bound_ctrl:0
    s_nop 1
    v_max_u32_dpp v4, v4, v4 row_bcast:15 row_mask:0xa bank_mask:0xf
    s_nop 1
    v_max_u32_dpp v4, v4, v4 row_bcast:31 row_mask:0xc bank_mask:0xf
    s_nop 0
    v_readlane_b32 s52, v4, 63
    s_nop 0
    s_add_u32 s53, s53, s52
    v_writelane_b32 v13, s53, 4
    v_subrev_u32 v48, s52, v48
    v_subrev_u32 v49, s52, v49
    v_max_u32 v4, v48, v49
    s_nop 1
    v_max_u32_dpp v4, v4, v4 row_shr:1 row_mask:0xf bank_mask:0xf bound_ctrl:0
    s_nop 1
    v_max_u32_dpp v4, v4, v4 row_shr:2 row_mask:0xf bank_mask:0xf bound_ctrl:0
    s_nop 1
    v_max_u32_dpp v4, v4, v4 row_shr:4 row_mask:0xf bank_mask:0xf bound_ctrl:0
    s_nop 1
    v_max_u32_dpp v4, v4, v4 row_shr:8 row_mask:0xf bank_mask:0xf bound_ctrl:0
    s_nop 1
    v_max_u32_dpp v4, v4, v4 row_bcast:15 row_mask:0xa bank_mask:0xf
    s_nop 1
    v_max_u32_dpp v4, v4, v4 row_bcast:31 row_mask:0xc bank_mask:0xf
    s_nop 0
    v_readlane_b32 s52, v4, 63
    s_nop 0
    s_add_u32 s53, s53, s52
    v_writelane_b32 v13, s53, 5
    v_subrev_u32 v48, s52, v48
    v_subrev_u32 v49, s52, v49
    v_max_u32 v4, v48, v49
    s_nop 1
    v_max_u32_dpp v4, v4, v4 row_shr:1 row_mask:0xf bank_mask:0xf bound_ctrl:0
    s_nop 1
    v_max_u32_dpp v4, v4, v4 row_shr:2 row_mask:0xf bank_mask:0xf bound_ctrl:0
    s_nop 1
    v_max_u32_dpp v4, v4, v4 row_shr:4 row_mask:0xf bank_mask:0xf bound_ctrl:0
    s_nop 1
    v_max_u32_dpp v4, v4, v4 row_shr:8 row_mask:0xf bank_mask:0xf bound_ctrl:0
    s_nop 1
    v_max_u32_dpp v4, v4, v4 row_bcast:15 row_mask:0xa bank_mask:0xf
    s_nop 1
    v_max_u32_dpp v4, v4, v4 row_bcast:31 row_mask:0xc bank_mask:0xf
    s_nop 0
    v_readlane_b32 s52, v4, 63
    s_nop 0
    s_add_u32 s53, s53, s52
    v_writelane_b32 v13, s53, 6
    v_subrev_u32 v48, s52, v48
    v_subrev_u32 v49, s52, v49
    v_max_u32 v4, v48, v49
    s_nop 1
    v_max_u32_dpp v4, v4, v4 row_shr:1 row_mask:0xf bank_mask:0xf bound_ctrl:0
    s_nop 1
    v_max_u32_dpp v4, v4, v4 row_shr:2 row_mask:0xf bank_mask:0xf bound_ctrl:0
    s_nop 1
    v_max_u32_dpp v4, v4, v4 row_shr:4 row_mask:0xf bank_mask:0xf bound_ctrl:0
    s_nop 1
    v_max_u32_dpp v4, v4, v4 row_shr:8 row_mask:0xf bank_mask:0xf bound_ctrl:0
    s_nop 1
    v_max_u32_dpp v4, v4, v4 row_bcast:15 row_mask:0xa bank_mask:0xf
    s_nop 1
    v_max_u32_dpp v4, v4, v4 row_bcast:31 row_mask:0xc bank_mask:0xf
    s_nop 0
    v_readlane_b32 s52, v4, 63
    s_nop 0
    s_add_u32 s53, s53, s52
    v_writelane_b32 v13, s53, 7
    v_cmp_lt_u32 vcc, s53, v50
    s_cbranch_vccz F_a2k
    s_mov_b32 s53, 0
    s_mov_b32 s52, 0
    s_mov_b32 s64, 0
F_a2f:
    v_subrev_u32 v16, s52, v16
    v_subrev_u32 v17, s52, v17
    v_subrev_u32 v18, s52, v18
    v_subrev_u32 v19, s52, v19
    v_subrev_u32 v20, s52, v20
    v_subrev_u32 v21, s52, v21
    v_subrev_u32 v22, s52, v22
    v_subrev_u32 v23, s52, v23
    v_subrev_u32 v24, s52, v24
    v_subrev_u32 v25, s52, v25
    v_subrev_u32 v26, s52, v26
    v_subrev_u32 v27, s52, v27
    v_subrev_u32 v28, s52, v28
    v_subrev_u32 v29, s52, v29
    v_subrev_u32 v30, s52, v30
    v_subrev_u32 v31, s52, v31
    v_subrev_u32 v32, s52, v32
    v_subrev_u32 v33, s52, v33
    v_subrev_u32 v34, s52, v34
    v_subrev_u32 v35, s52, v35
    v_subrev_u32 v36, s52, v36
    v_subrev_u32 v37, s52, v37
    v_subrev_u32 v38, s52, v38
    v_subrev_u32 v39, s52, v39
    v_subrev_u32 v40, s52, v40
    v_subrev_u32 v41, s52, v41
    v_subrev_u32 v42, s52, v42
    v_subrev_u32 v43, s52, v43
    v_subrev_u32 v44, s52, v44
    v_subrev_u32 v45, s52, v45
    v_subrev_u32 v46, s52, v46
    v_subrev_u32 v47, s52, v47
    v_max3_u32 v4, v16, v17, v18
    v_max3_u32 v12, v19, v20, v21
    v_max3_u32 v4, v4, v22, v23
    v_max3_u32 v12, v12, v24, v25
    v_max3_u32 v4, v4, v26, v27
    v_max3_u32 v12, v12, v28, v29
    v_max3_u32 v4, v4, v30, v31
    v_max3_u32 v12, v12, v32, v33
    v_max3_u32 v4, v4, v34, v35
    v_max3_u32 v12, v12, v36, v37
    v_max3_u32 v4, v4, v38, v39
    v_max3_u32 v12, v12, v40, v41
    v_max3_u32 v4, v4, v42, v43
    v_max3_u32 v12, v12, v44, v45
    v_max3_u32 v4, v4, v46, v47
    v_max_u32 v4, v4, v12
    s_nop 1
    v_max_u32_dpp v4, v4, v4 row_shr:1 row_mask:0xf bank_mask:0xf bound_ctrl:0
    s_nop 1
    v_max_u32_dpp v4, v4, v4 row_shr:2 row_mask:0xf bank_mask:0xf bound_ctrl:0
    s_nop 1
    v_max_u32_dpp v4, v4, v4 row_shr:4 row_mask:0xf bank_mask:0xf bound_ctrl:0
    s_nop 1
    v_max_u32_dpp v4, v4, v4 row_shr:8 row_mask:0xf bank_mask:0xf bound_ctrl:0
    s_nop 1
    v_max_u32_dpp v4, v4, v4 row_bcast:15 row_mask:0xa bank_mask:0xf
    s_nop 1
    v_max_u32_dpp v4, v4, v4 row_bcast:31 row_mask:0xc bank_mask:0xf
    s_nop 0
    v_readlane_b32 s52, v4, 63
    s_nop 0
    s_add_u32 s53, s53, s52
    s_mov_b32 m0, s64
    v_writelane_b32 v13, s53, m0
    s_cmp_ge_u32 s74, 17
    s_cbranch_scc1 DB_110
    s_barrier
    s_add_u32 s74, s74, 1
DB_110:
    s_add_u32 s64, s64, 1
    s_cmp_lt_u32 s64, 8
    s_cbranch_scc1 F_a2f
F_a2k:
    v_and_b32 v4, 7, v0
    v_lshlrev_b32 v4, 2, v4
    ds_bpermute_b32 v12, v4, v13
    v_lshrrev_b32 v9, 3, v0
    v_lshl_add_u32 v4, v9, 9, v4
    s_mov_b32 s44, 32896
    s_mov_b32 s45, 36992
    s_waitcnt lgkmcnt(0)
    v_or_b32 v12, 0x8000, v12
    buffer_store_dword v12, v4, s[40:43], s44 offen sc0 sc1
    buffer_store_dword v12, v4, s[40:43], s45 offen sc0 sc1

F_a2m:
    s_cmp_ge_u32 s74, 17
    s_cbranch_scc1 DB_111
    s_barrier
    s_add_u32 s74, s74, 1
DB_111:
    s_cmp_lt_u32 s74, 17
    s_cbranch_scc1 F_a2m
    s_add_u32 s91, s54, 0
    buffer_load_dwordx4 v[72:75], v6, s[16:19], s91 offen nt
    s_add_u32 s91, s54, 7168
    buffer_load_dwordx4 v[76:79], v6, s[16:19], s91 offen nt
    s_add_u32 s91, s54, 14336
    buffer_load_dwordx4 v[80:83], v6, s[16:19], s91 offen nt
    s_add_u32 s91, s54, 21504
    buffer_load_dwordx4 v[84:87], v6, s[16:19], s91 offen nt
    s_add_u32 s91, s54, 28672
    buffer_load_dwordx4 v[88:91], v6, s[16:19], s91 offen nt
    s_add_u32 s91, s54, 35840
    buffer_load_dwordx4 v[92:95], v6, s[16:19], s91 offen nt
    s_add_u32 s91, s54, 43008
    buffer_load_dwordx4 v[96:99], v6, s[16:19], s91 offen nt
    s_add_u32 s91, s54, 50176
    buffer_load_dwordx4 v[100:103], v6, s[16:19], s91 offen nt
    s_add_u32 s91, s54, 229376
    buffer_load_dwordx4 v[104:107], v6, s[16:19], s91 offen nt
    s_add_u32 s91, s54, 236544
    buffer_load_dwordx4 v[108:111], v6, s[16:19], s91 offen nt
    s_add_u32 s91, s54, 243712
    buffer_load_dwordx4 v[112:115], v6, s[16:19], s91 offen nt
    s_add_u32 s91, s54, 250880
    buffer_load_dwordx4 v[116:119], v6, s[16:19], s91 offen nt
    s_add_u32 s91, s54, 258048
    buffer_load_dwordx4 v[120:123], v6, s[16:19], s91 offen nt
    s_add_u32 s91, s54, 265216
    buffer_load_dwordx4 v[124:127], v6, s[16:19], s91 offen nt
    s_add_u32 s91, s54, 272384
    buffer_load_dwordx4 v[128:131], v6, s[16:19], s91 offen nt
    s_add_u32 s91, s54, 279552
    buffer_load_dwordx4 v[132:135], v6, s[16:19], s91 offen nt
    s_branch F_aj2
IW_w10:
    s_branch IW_r10
F_a2n:
    s_barrier
    s_cmp_lg_u32 s53, 0
    s_cbranch_scc1 SW_112
    s_call_b64 s[34:35], F_sw0
SW_112:
    s_branch IW_w11
IW_r11:
    s_barrier
    s_cmp_lg_u32 s53, 1
    s_cbranch_scc1 SW_113
    s_call_b64 s[34:35], F_sw0
SW_113:
    s_nop 0
    s_barrier
    s_cmp_lg_u32 s53, 2
    s_cbranch_scc1 SW_114
    s_call_b64 s[34:35], F_sw0
SW_114:
    s_nop 0
    s_barrier
    s_cmp_lg_u32 s53, 3
    s_cbranch_scc1 SW_115
    s_call_b64 s[34:35], F_sw0
SW_115:
    s_nop 0
    s_barrier
    s_nop 0
    s_barrier
    s_nop 0
    s_barrier
    s_add_u32 s91, s54, 229376
    buffer_load_dwordx4 v[104:107], v6, s[16:19], s91 offen nt
    s_add_u32 s91, s54, 236544
    buffer_load_dwordx4 v[108:111], v6, s[16:19], s91 offen nt
    s_add_u32 s91, s54, 243712
    buffer_load_dwordx4 v[112:115], v6, s[16:19], s91 offen nt
    s_add_u32 s91, s54, 250880
    buffer_load_dwordx4 v[116:119], v6, s[16:19], s91 offen nt
    s_nop 0
    s_load_dwordx8 s[60:67], s[56:57], 128 glc
    s_barrier
    s_add_u32 s91, s54, 258048
    buffer_load_dwordx4 v[120:123], v6, s[16:19], s91 offen nt
    s_add_u32 s91, s54, 265216
    buffer_load_dwordx4 v[124:127], v6, s[16:19], s91 offen nt
    s_add_u32 s91, s54, 272384
    buffer_load_dwordx4 v[128:131], v6, s[16:19], s91 offen nt
    s_add_u32 s91, s54, 279552
    buffer_load_dwordx4 v[132:135], v6, s[16:19], s91 offen nt
    s_waitcnt lgkmcnt(0)
    s_and_b64 s[44:45], s[60:61], s[62:63]
    s_and_b64 s[44:45], s[44:45], s[64:65]
    s_and_b64 s[44:45], s[44:45], s[66:67]
    s_and_b32 s44, s44, s45
    s_bitcmp1_b32 s44, 15
    s_cbranch_scc0 F_a2q
    s_andn2_b32 s60, s60, 0x8000
    v_writelane_b32 v12, s60, 0
    s_andn2_b32 s61, s61, 0x8000
    v_writelane_b32 v12, s61, 1
    s_andn2_b32 s62, s62, 0x8000
    v_writelane_b32 v12, s62, 2
    s_andn2_b32 s63, s63, 0x8000
    v_writelane_b32 v12, s63, 3
    s_andn2_b32 s64, s64, 0x8000
    v_writelane_b32 v12, s64, 4
    s_andn2_b32 s65, s65, 0x8000
    v_writelane_b32 v12, s65, 5
    s_andn2_b32 s66, s66, 0x8000
    v_writelane_b32 v12, s66, 6
    s_andn2_b32 s67, s67, 0x8000
    v_writelane_b32 v12, s67, 7
    v_add_u32 v4, 158976, v3
    s_mov_b64 exec, 0xff
    ds_write_b32 v4, v12
    s_mov_b64 exec, -1
    v_mov_b32 v4, 1
    s_mov_b64 exec, 1
    ds_write_b32 v10, v4 offset:48
    s_mov_b64 exec, -1
    s_waitcnt lgkmcnt(0)
    s_mov_b32 s88, 1
    s_branch F_a2r
F_a2q:
    s_load_dwordx8 s[60:67], s[56:57], 128 glc
F_a2r:
    s_barrier
    s_cmp_lg_u32 s88, 2
    s_cbranch_scc1 F_aj
    s_waitcnt lgkmcnt(0)
    s_and_b64 s[44:45], s[60:61], s[62:63]
    s_and_b64 s[44:45], s[44:45], s[64:65]
    s_and_b64 s[44:45], s[44:45], s[66:67]
    s_and_b32 s44, s44, s45
    s_bitcmp1_b32 s44, 15
    s_cbranch_scc0 F_a2s
    s_andn2_b32 s60, s60, 0x8000
    v_writelane_b32 v12, s60, 0
    s_andn2_b32 s61, s61, 0x8000
    v_writelane_b32 v12, s61, 1
    s_andn2_b32 s62, s62, 0x8000
    v_writelane_b32 v12, s62, 2
    s_andn2_b32 s63, s63, 0x8000
    v_writelane_b32 v12, s63, 3
    s_andn2_b32 s64, s64, 0x8000
    v_writelane_b32 v12, s64, 4
    s_andn2_b32 s65, s65, 0x8000
    v_writelane_b32 v12, s65, 5
    s_andn2_b32 s66, s66, 0x8000
    v_writelane_b32 v12, s66, 6
    s_andn2_b32 s67, s67, 0x8000
    v_writelane_b32 v12, s67, 7
    v_add_u32 v4, 158976, v3
    s_mov_b64 exec, 0xff
    ds_write_b32 v4, v12
    s_mov_b64 exec, -1
    v_mov_b32 v4, 1
    s_mov_b64 exec, 1
    ds_write_b32 v10, v4 offset:48
    s_mov_b64 exec, -1
    s_mov_b32 s88, 1
F_a2s:
    v_mov_b32 v4, 1
    s_mov_b64 exec, 1
    ds_write_b32 v10, v4 offset:176
    s_mov_b64 exec, -1
F_aj:
    s_mov_b32 s74, 0
F_aj2:
    v_and_b32 v13, 3, v0
    v_lshlrev_b32 v13, 2, v13
    v_add_u32 v13, 159040, v13

    s_cmp_lt_u32 s3, 2
    s_mov_b32 s75, 65536
    s_cselect_b32 s75, 32768, s75
    s_and_b32 s44, s3, 1
    s_lshl_b32 s44, s44, 12
    s_add_u32 s75, s75, s44
    s_add_u32 s12, s72, 0x900000
    s_addc_u32 s13, s73, 0
    s_mov_b32 s14, 0xe0000
    s_mov_b32 s15, 0x00020000
    s_mov_b32 s47, s10
    v_mov_b32 v4, 159096
    ds_read_b32 v9, v4
    s_waitcnt lgkmcnt(0)
    v_readfirstlane_b32 s79, v9
    s_nop 0
    s_cmp_lg_u32 s79, 0
    s_cbranch_scc1 F_xf
    s_cmp_eq_u32 s2, 248
    s_cbranch_scc1 F_xe
    ds_read_b32 v9, v4 offset:128
FW_116:
    s_waitcnt lgkmcnt(0)
    v_cmp_gt_u32 vcc, 1, v9
    s_cbranch_vccz FO_117
    ds_read_b32 v9, v4 offset:128
    s_branch FW_116
FO_117:
    ds_read_b32 v9, v4
    s_waitcnt lgkmcnt(0)
    v_readfirstlane_b32 s79, v9
    s_nop 0
    s_cmp_eq_u32 s79, 0
    s_cbranch_scc1 F_xe
F_xf:
    v_and_b32 v4, 7, v0
    v_lshlrev_b32 v4, 2, v4
    v_add_u32 v4, 158976, v4
    ds_read_b32 v4, v4
    s_waitcnt lgkmcnt(0)
    v_and_b32 v4, 0x7ff, v4
    v_sub_u32 v4, 2047, v4
    v_and_b32 v11, 7, v4
    v_lshrrev_b32 v9, 3, v4
    v_lshlrev_b32 v9, 7, v9
    v_lshl_add_u32 v9, v11, 3, v9
    v_lshlrev_b32 v4, 11, v4
    v_lshl_add_u32 v4, v5, 4, v4
    buffer_load_dwordx4 v[64:67], v4, s[20:23], s55 offen
    buffer_load_dwordx4 v[68:71], v4, s[20:23], s55 offen offset:64
    buffer_load_dwordx2 v[14:15], v9, s[40:43], 0 offen sc0 sc1

F_xe:
    s_cmp_lg_u32 s74, 0
    s_cbranch_scc1 JB_118
    s_barrier
JB_118:
    s_cmp_lg_u32 s88, 3
    s_cbranch_scc1 F_g4
SP_119:
    s_load_dword s76, s[56:57], 0 glc
    s_waitcnt lgkmcnt(0)
    s_cmp_ge_u32 s76, 1000
    s_cbranch_scc1 SD_120
    s_sleep 3
    s_branch SP_119
SD_120:
    v_mov_b32 v4, 1
    s_mov_b64 exec, 1
    ds_write_b32 v10, v4 offset:48
    s_mov_b64 exec, -1
F_g4:
    s_setprio 1
    s_cmp_lg_u32 s79, 0
    s_cbranch_scc1 F_xd
    s_cmp_lg_u32 s88, 2
    s_cbranch_scc1 F_se
F_sc:
    s_load_dwordx8 s[60:67], s[56:57], 128 glc
    s_waitcnt lgkmcnt(0)
    s_and_b64 s[44:45], s[60:61], s[62:63]
    s_and_b64 s[44:45], s[44:45], s[64:65]
    s_and_b64 s[44:45], s[44:45], s[66:67]
    s_and_b32 s44, s44, s45
    s_bitcmp1_b32 s44, 15
    s_cbranch_scc1 F_sd
    s_sleep 4
    s_branch F_sc
F_sd:
    s_andn2_b32 s60, s60, 0x8000
    v_writelane_b32 v12, s60, 0
    s_andn2_b32 s61, s61, 0x8000
    v_writelane_b32 v12, s61, 1
    s_andn2_b32 s62, s62, 0x8000
    v_writelane_b32 v12, s62, 2
    s_andn2_b32 s63, s63, 0x8000
    v_writelane_b32 v12, s63, 3
    s_andn2_b32 s64, s64, 0x8000
    v_writelane_b32 v12, s64, 4
    s_andn2_b32 s65, s65, 0x8000
    v_writelane_b32 v12, s65, 5
    s_andn2_b32 s66, s66, 0x8000
    v_writelane_b32 v12, s66, 6
    s_andn2_b32 s67, s67, 0x8000
    v_writelane_b32 v12, s67, 7
    v_add_u32 v4, 158976, v3
    s_mov_b64 exec, 0xff
    ds_write_b32 v4, v12
    s_mov_b64 exec, -1
    v_mov_b32 v4, 1
    s_mov_b64 exec, 1
    ds_write_b32 v10, v4 offset:48
    s_mov_b64 exec, -1
F_se:
    v_mov_b32 v4, 159096
    ds_read_b32 v9, v4 offset:0
FW_121:
    s_waitcnt lgkmcnt(0)
    v_cmp_gt_u32 vcc, 1, v9
    s_cbranch_vccz FO_122
    s_sleep 1
    ds_read_b32 v9, v4 offset:0
    s_branch FW_121
FO_122:
    v_and_b32 v4, 7, v0
    v_lshlrev_b32 v4, 2, v4
    v_add_u32 v4, 158976, v4
    ds_read_b32 v4, v4
    s_waitcnt lgkmcnt(0)
    v_and_b32 v4, 0x7ff, v4
    v_sub_u32 v4, 2047, v4
    v_and_b32 v11, 7, v4
    v_lshrrev_b32 v9, 3, v4
    v_lshlrev_b32 v9, 7, v9
    v_lshl_add_u32 v9, v11, 3, v9
    v_lshlrev_b32 v4, 11, v4
    v_lshl_add_u32 v4, v5, 4, v4
    buffer_load_dwordx4 v[64:67], v4, s[20:23], s55 offen
    buffer_load_dwordx4 v[68:71], v4, s[20:23], s55 offen offset:64
    buffer_load_dwordx2 v[14:15], v9, s[40:43], 0 offen sc0 sc1

F_xd:
    s_mov_b32 s52, 0x05040100
    s_mov_b32 s53, 0x07060302
    s_setprio 1
    s_cmp_ge_u32 s89, 224
    s_cbranch_scc1 F_adown
    s_waitcnt vmcnt(0)
    v_lshlrev_b32 v34, 16, v64
    v_and_b32 v35, 0xffff0000, v64
    v_lshlrev_b32 v36, 16, v65
    v_and_b32 v37, 0xffff0000, v65
    v_lshlrev_b32 v38, 16, v66
    v_and_b32 v39, 0xffff0000, v66
    v_lshlrev_b32 v40, 16, v67
    v_and_b32 v41, 0xffff0000, v67
    v_lshlrev_b32 v42, 16, v68
    v_and_b32 v43, 0xffff0000, v68
    v_lshlrev_b32 v44, 16, v69
    v_and_b32 v45, 0xffff0000, v69
    v_lshlrev_b32 v46, 16, v70
    v_and_b32 v47, 0xffff0000, v70
    v_lshlrev_b32 v48, 16, v71
    v_and_b32 v49, 0xffff0000, v71
    v_add_f32 v34, v34, v14
    v_add_f32 v35, v35, v14
    v_add_f32 v36, v36, v14
    v_add_f32 v37, v37, v14
    v_add_f32 v38, v38, v14
    v_add_f32 v39, v39, v14
    v_add_f32 v40, v40, v14
    v_add_f32 v41, v41, v14
    v_add_f32 v42, v42, v14
    v_add_f32 v43, v43, v14
    v_add_f32 v44, v44, v14
    v_add_f32 v45, v45, v14
    v_add_f32 v46, v46, v14
    v_add_f32 v47, v47, v14
    v_add_f32 v48, v48, v14
    v_add_f32 v49, v49, v14
    v_cvt_pk_bf16_f32 v64, v34, v35
    v_cvt_pk_bf16_f32 v65, v36, v37
    v_cvt_pk_bf16_f32 v66, v38, v39
    v_cvt_pk_bf16_f32 v67, v40, v41
    v_cvt_pk_bf16_f32 v68, v42, v43
    v_cvt_pk_bf16_f32 v69, v44, v45
    v_cvt_pk_bf16_f32 v70, v46, v47
    v_cvt_pk_bf16_f32 v71, v48, v49
    v_lshlrev_b32 v34, 16, v64
    v_and_b32 v35, 0xffff0000, v64
    v_lshlrev_b32 v36, 16, v65
    v_and_b32 v37, 0xffff0000, v65
    v_lshlrev_b32 v38, 16, v66
    v_and_b32 v39, 0xffff0000, v66
    v_lshlrev_b32 v40, 16, v67
    v_and_b32 v41, 0xffff0000, v67
    v_lshlrev_b32 v42, 16, v68
    v_and_b32 v43, 0xffff0000, v68
    v_lshlrev_b32 v44, 16, v69
    v_and_b32 v45, 0xffff0000, v69
    v_lshlrev_b32 v46, 16, v70
    v_and_b32 v47, 0xffff0000, v70
    v_lshlrev_b32 v48, 16, v71
    v_and_b32 v49, 0xffff0000, v71
    v_mul_f32 v34, v34, v15
    v_mul_f32 v35, v35, v15
    v_mul_f32 v36, v36, v15
    v_mul_f32 v37, v37, v15
    v_mul_f32 v38, v38, v15
    v_mul_f32 v39, v39, v15
    v_mul_f32 v40, v40, v15
    v_mul_f32 v41, v41, v15
    v_mul_f32 v42, v42, v15
    v_mul_f32 v43, v43, v15
    v_mul_f32 v44, v44, v15
    v_mul_f32 v45, v45, v15
    v_mul_f32 v46, v46, v15
    v_mul_f32 v47, v47, v15
    v_mul_f32 v48, v48, v15
    v_mul_f32 v49, v49, v15
    v_cvt_pk_bf16_f32 v64, v34, v35
    v_cvt_pk_bf16_f32 v65, v36, v37
    v_cvt_pk_bf16_f32 v66, v38, v39
    v_cvt_pk_bf16_f32 v67, v40, v41
    v_cvt_pk_bf16_f32 v68, v42, v43
    v_cvt_pk_bf16_f32 v69, v44, v45
    v_cvt_pk_bf16_f32 v70, v46, v47
    v_cvt_pk_bf16_f32 v71, v48, v49
    s_waitcnt vmcnt(0)
    v_perm_b32 v136, v76, v72, s52
    v_perm_b32 v137, v84, v80, s52
    v_perm_b32 v138, v92, v88, s52
    v_perm_b32 v139, v100, v96, s52
    s_nop 1
    v_mfma_f32_16x16x32_bf16 v[32:35], v[64:67], v[136:139], 0
    v_perm_b32 v140, v76, v72, s53
    v_perm_b32 v141, v84, v80, s53
    v_perm_b32 v142, v92, v88, s53
    v_perm_b32 v143, v100, v96, s53
    s_nop 1
    v_mfma_f32_16x16x32_bf16 v[36:39], v[64:67], v[140:143], 0
    v_perm_b32 v136, v77, v73, s52
    v_perm_b32 v137, v85, v81, s52
    v_perm_b32 v138, v93, v89, s52
    v_perm_b32 v139, v101, v97, s52
    s_nop 1
    v_mfma_f32_16x16x32_bf16 v[40:43], v[64:67], v[136:139], 0
    v_perm_b32 v140, v77, v73, s53
    v_perm_b32 v141, v85, v81, s53
    v_perm_b32 v142, v93, v89, s53
    v_perm_b32 v143, v101, v97, s53
    s_nop 1
    v_mfma_f32_16x16x32_bf16 v[44:47], v[64:67], v[140:143], 0
    v_perm_b32 v136, v78, v74, s52
    v_perm_b32 v137, v86, v82, s52
    v_perm_b32 v138, v94, v90, s52
    v_perm_b32 v139, v102, v98, s52
    s_nop 1
    v_mfma_f32_16x16x32_bf16 v[48:51], v[64:67], v[136:139], 0
    v_perm_b32 v140, v78, v74, s53
    v_perm_b32 v141, v86, v82, s53
    v_perm_b32 v142, v94, v90, s53
    v_perm_b32 v143, v102, v98, s53
    s_nop 1
    v_mfma_f32_16x16x32_bf16 v[52:55], v[64:67], v[140:143], 0
    v_perm_b32 v136, v79, v75, s52
    v_perm_b32 v137, v87, v83, s52
    v_perm_b32 v138, v95, v91, s52
    v_perm_b32 v139, v103, v99, s52
    s_nop 1
    v_mfma_f32_16x16x32_bf16 v[56:59], v[64:67], v[136:139], 0
    v_perm_b32 v140, v79, v75, s53
    v_perm_b32 v141, v87, v83, s53
    v_perm_b32 v142, v95, v91, s53
    v_perm_b32 v143, v103, v99, s53
    s_nop 1
    v_mfma_f32_16x16x32_bf16 v[60:63], v[64:67], v[140:143], 0
    s_waitcnt vmcnt(0)
    v_perm_b32 v136, v108, v104, s52
    v_perm_b32 v137, v116, v112, s52
    v_perm_b32 v138, v124, v120, s52
    v_perm_b32 v139, v132, v128, s52
    s_nop 1
    v_mfma_f32_16x16x32_bf16 v[32:35], v[68:71], v[136:139], v[32:35]
    v_perm_b32 v140, v108, v104, s53
    v_perm_b32 v141, v116, v112, s53
    v_perm_b32 v142, v124, v120, s53
    v_perm_b32 v143, v132, v128, s53
    s_nop 1
    v_mfma_f32_16x16x32_bf16 v[36:39], v[68:71], v[140:143], v[36:39]
    v_perm_b32 v136, v109, v105, s52
    v_perm_b32 v137, v117, v113, s52
    v_perm_b32 v138, v125, v121, s52
    v_perm_b32 v139, v133, v129, s52
    s_nop 1
    v_mfma_f32_16x16x32_bf16 v[40:43], v[68:71], v[136:139], v[40:43]
    v_perm_b32 v140, v109, v105, s53
    v_perm_b32 v141, v117, v113, s53
    v_perm_b32 v142, v125, v121, s53
    v_perm_b32 v143, v133, v129, s53
    s_nop 1
    v_mfma_f32_16x16x32_bf16 v[44:47], v[68:71], v[140:143], v[44:47]
    v_perm_b32 v136, v110, v106, s52
    v_perm_b32 v137, v118, v114, s52
    v_perm_b32 v138, v126, v122, s52
    v_perm_b32 v139, v134, v130, s52
    s_nop 1
    v_mfma_f32_16x16x32_bf16 v[48:51], v[68:71], v[136:139], v[48:51]
    v_perm_b32 v140, v110, v106, s53
    v_perm_b32 v141, v118, v114, s53
    v_perm_b32 v142, v126, v122, s53
    v_perm_b32 v143, v134, v130, s53
    s_nop 1
    v_mfma_f32_16x16x32_bf16 v[52:55], v[68:71], v[140:143], v[52:55]
    v_perm_b32 v136, v111, v107, s52
    v_perm_b32 v137, v119, v115, s52
    v_perm_b32 v138, v127, v123, s52
    v_perm_b32 v139, v135, v131, s52
    s_nop 1
    v_mfma_f32_16x16x32_bf16 v[56:59], v[68:71], v[136:139], v[56:59]
    v_perm_b32 v140, v111, v107, s53
    v_perm_b32 v141, v119, v115, s53
    v_perm_b32 v142, v127, v123, s53
    v_perm_b32 v143, v135, v131, s53
    s_nop 1
    v_mfma_f32_16x16x32_bf16 v[60:63], v[68:71], v[140:143], v[60:63]
    v_cmp_gt_u32 vcc, 32, v0
    s_nop 1
    v_cndmask_b32 v32, v48, v32, vcc
    v_cndmask_b32 v33, v49, v33, vcc
    v_cndmask_b32 v34, v50, v34, vcc
    v_cndmask_b32 v35, v51, v35, vcc
    v_cndmask_b32 v36, v52, v36, vcc
    v_cndmask_b32 v37, v53, v37, vcc
    v_cndmask_b32 v38, v54, v38, vcc
    v_cndmask_b32 v39, v55, v39, vcc
    v_cndmask_b32 v40, v56, v40, vcc
    v_cndmask_b32 v41, v57, v41, vcc
    v_cndmask_b32 v42, v58, v42, vcc
    v_cndmask_b32 v43, v59, v43, vcc
    v_cndmask_b32 v44, v60, v44, vcc
    v_cndmask_b32 v45, v61, v45, vcc
    v_cndmask_b32 v46, v62, v46, vcc
    v_cndmask_b32 v47, v63, v47, vcc
    s_and_b32 s44, s3, 1
    s_lshl_b32 s44, s44, 12
    s_add_u32 s44, s44, 65536
    v_and_b32 v8, 1, v5
    v_lshrrev_b32 v9, 1, v5
    v_lshl_add_u32 v4, v9, 3, v8
    v_lshlrev_b32 v9, 8, v4
    v_xor_b32 v4, v7, v4
    v_lshl_add_u32 v4, v4, 4, v9
    v_add_u32 v72, s44, v4
    v_xor_b32 v73, 32, v72
    v_xor_b32 v74, 64, v72
    v_xor_b32 v75, 96, v72
    v_add_u32 v8, 8, v10
    s_lshl_b32 s44, s3, 2
    v_add_u32 v76, s44, v5
    v_xor_b32 v76, v76, v7
    v_lshlrev_b32 v76, 4, v76
    v_lshl_add_u32 v76, v7, 8, v76
    v_add_u32 v76, 65536, v76
    s_lshl_b32 s44, s3, 10
    s_lshl_b32 s77, s36, 1
    s_add_u32 s77, s77, s37
    s_mul_i32 s77, s77, 114688
    s_lshl_b32 s46, s38, 12
    s_add_u32 s77, s77, s46
    s_add_u32 s77, s77, s44
    s_lshl_b32 s46, s38, 9
    v_mov_b32 v9, 159148
    v_mov_b32 v11, 1
    v_and_b32 v77, 0xfffffff7, v13

    s_add_u32 s56, s46, 0x829000
    s_add_u32 s56, s72, s56
    s_addc_u32 s57, s73, 0
    s_setprio 3
    ds_read_b32 v12, v13 offset:32
FW_123:
    s_waitcnt lgkmcnt(0)
    v_cmp_gt_u32 vcc, 2, v12
    s_cbranch_vccz FO_124
    s_sleep 1
    ds_read_b32 v12, v13 offset:32
    s_branch IW_s11
IW_w11:
    s_branch IW_r11
IW_s11:
    s_branch FW_123
FO_124:
    s_cmp_lt_u32 s3, 2
    s_cbranch_scc1 F_t1
    ds_write_b128 v72, v[32:35] offset:0
    ds_write_b128 v73, v[36:39] offset:512
    ds_write_b128 v74, v[40:43] offset:1024
    ds_write_b128 v75, v[44:47] offset:1536
    s_mov_b64 exec, 1
    ds_write_b32 v10, v11 offset:64
    s_mov_b64 exec, -1
    s_add_u32 s45, s78, 0
    buffer_load_dwordx4 v[16:19], v160, s[80:83], s45 offen nt
    s_add_u32 s45, s78, 2048
    buffer_load_dwordx4 v[20:23], v160, s[80:83], s45 offen nt
    s_add_u32 s45, s78, 4096
    buffer_load_dwordx4 v[24:27], v160, s[80:83], s45 offen nt
    s_add_u32 s45, s78, 6144
    buffer_load_dwordx4 v[28:31], v160, s[80:83], s45 offen nt
    s_add_u32 s45, s78, 8192
    buffer_load_dwordx4 v[144:147], v160, s[80:83], s45 offen nt
    s_add_u32 s45, s78, 10240
    buffer_load_dwordx4 v[148:151], v160, s[80:83], s45 offen nt
    s_add_u32 s45, s78, 12288
    buffer_load_dwordx4 v[152:155], v160, s[80:83], s45 offen nt
    s_branch F_t2
F_t1:
    s_add_u32 s45, s78, 0
    buffer_load_dwordx4 v[16:19], v160, s[80:83], s45 offen nt
    s_add_u32 s45, s78, 2048
    buffer_load_dwordx4 v[20:23], v160, s[80:83], s45 offen nt
    s_add_u32 s45, s78, 4096
    buffer_load_dwordx4 v[24:27], v160, s[80:83], s45 offen nt
    s_add_u32 s45, s78, 6144
    buffer_load_dwordx4 v[28:31], v160, s[80:83], s45 offen nt
    s_add_u32 s45, s78, 8192
    buffer_load_dwordx4 v[144:147], v160, s[80:83], s45 offen nt
    s_add_u32 s45, s78, 10240
    buffer_load_dwordx4 v[148:151], v160, s[80:83], s45 offen nt
    s_add_u32 s45, s78, 12288
    buffer_load_dwordx4 v[152:155], v160, s[80:83], s45 offen nt
F_t3:
    ds_read_b32 v12, v8 offset:64
    ds_read_b128 v[80:83], v72 offset:0
    ds_read_b128 v[84:87], v73 offset:512
    ds_read_b128 v[88:91], v74 offset:1024
    ds_read_b128 v[92:95], v75 offset:1536
    s_waitcnt lgkmcnt(0)
    v_cmp_eq_u32 vcc, 0, v12
    s_cbranch_vccnz F_t3
    v_add_f32 v32, v32, v80
    v_add_f32 v33, v33, v81
    v_add_f32 v34, v34, v82
    v_add_f32 v35, v35, v83
    v_add_f32 v36, v36, v84
    v_add_f32 v37, v37, v85
    v_add_f32 v38, v38, v86
    v_add_f32 v39, v39, v87
    v_add_f32 v40, v40, v88
    v_add_f32 v41, v41, v89
    v_add_f32 v42, v42, v90
    v_add_f32 v43, v43, v91
    v_add_f32 v44, v44, v92
    v_add_f32 v45, v45, v93
    v_add_f32 v46, v46, v94
    v_add_f32 v47, v47, v95
    ds_write_b128 v72, v[32:35] offset:0
    ds_write_b128 v73, v[36:39] offset:512
    ds_write_b128 v74, v[40:43] offset:1024
    ds_write_b128 v75, v[44:47] offset:1536
    s_mov_b64 exec, 1
    ds_write_b32 v10, v11 offset:64
    s_mov_b64 exec, -1
F_t2:
F_t4:
    ds_read_b32 v12, v77 offset:64
    ds_read_b128 v[80:83], v76
    ds_read_b128 v[84:87], v76 offset:4096
    s_waitcnt lgkmcnt(0)
    v_cmp_eq_u32 vcc, 0, v12
    s_cbranch_vccnz F_t4
    v_add_f32 v72, v80, v84
    v_add_f32 v73, v81, v85
    v_add_f32 v74, v82, v86
    v_add_f32 v75, v83, v87
    buffer_store_dwordx4 v[72:75], v2, s[12:15], s77 offen sc0 sc1
    v_mov_b32 v4, 2
    s_mov_b64 exec, 1
    ds_write_b32 v10, v4 offset:64
    s_mov_b64 exec, -1
    s_waitcnt vmcnt(0)
    s_mov_b64 exec, 1
    ds_add_rtn_u32 v9, v9, v11
    s_waitcnt lgkmcnt(0)
    v_readfirstlane_b32 s44, v9
    s_mov_b64 exec, -1
    s_cmp_lg_u32 s44, 3
    s_cbranch_scc1 F_ad2

    s_mov_b32 s74, 1
    s_atomic_add s74, s[56:57], 0x0
    s_atomic_add s74, s[56:57], 0x80
    s_atomic_add s74, s[56:57], 0x100
    s_atomic_add s74, s[56:57], 0x180
    s_branch F_ad2
F_adown:
    s_add_u32 s45, s78, 0
    buffer_load_dwordx4 v[16:19], v160, s[80:83], s45 offen nt
    s_add_u32 s45, s78, 2048
    buffer_load_dwordx4 v[20:23], v160, s[80:83], s45 offen nt
    s_add_u32 s45, s78, 4096
    buffer_load_dwordx4 v[24:27], v160, s[80:83], s45 offen nt
    s_add_u32 s45, s78, 6144
    buffer_load_dwordx4 v[28:31], v160, s[80:83], s45 offen nt
    s_add_u32 s45, s78, 8192
    buffer_load_dwordx4 v[144:147], v160, s[80:83], s45 offen nt
    s_add_u32 s45, s78, 10240
    buffer_load_dwordx4 v[148:151], v160, s[80:83], s45 offen nt
    s_add_u32 s45, s78, 12288
    buffer_load_dwordx4 v[152:155], v160, s[80:83], s45 offen nt
    v_mov_b32 v4, 2
    s_mov_b64 exec, 1
    ds_write_b32 v10, v4 offset:64
    s_mov_b64 exec, -1
F_ad2:
    v_min_u32 v4, 55, v0
    v_lshlrev_b32 v4, 4, v4
    s_lshl_b32 s38, s47, 5
    s_and_b32 s46, s39, 3
    s_lshr_b32 s44, s47, 7
    s_lshl_b32 s44, s44, 2
    s_add_u32 s44, s44, s46
    s_lshl_b32 s44, s44, 7
    s_add_u32 s45, s47, 111
    s_lshr_b32 s45, s45, 7
    s_lshl_b32 s45, s45, 2
    s_add_u32 s45, s45, s46
    s_lshl_b32 s45, s45, 7
    s_waitcnt lgkmcnt(0)

    s_add_u32 s56, s44, 0x829000
    s_add_u32 s56, s72, s56
    s_addc_u32 s57, s73, 0
    s_add_u32 s58, s45, 0x829000
    s_add_u32 s58, s72, s58
    s_addc_u32 s59, s73, 0
    v_mov_b32 v156, 0
    v_mov_b32 v157, 0
    v_mov_b32 v158, 0
    v_mov_b32 v159, 0
    s_mov_b32 s48, 0xbfb8aa3b
    ds_read_b32 v12, v13 offset:0
FW_125:
    s_waitcnt lgkmcnt(0)
    v_cmp_gt_u32 vcc, 4, v12
    s_cbranch_vccz FO_126
    s_sleep 1
    ds_read_b32 v12, v13 offset:0
    s_branch FW_125
FO_126:
    ds_read_b32 v12, v13 offset:64
FW_127:
    s_waitcnt lgkmcnt(0)
    v_cmp_gt_u32 vcc, 2, v12
    s_cbranch_vccz FO_128
    s_sleep 1
    ds_read_b32 v12, v13 offset:64
    s_branch FW_127
FO_128:
    ds_read_b32 v12, v13 offset:32
FW_129:
    s_waitcnt lgkmcnt(0)
    v_cmp_gt_u32 vcc, 2, v12
    s_cbranch_vccz FO_130
    s_sleep 1
    ds_read_b32 v12, v13 offset:32
    s_branch FW_129
FO_130:
    s_mov_b32 s44, s75
    v_lshlrev_b32 v9, 3, v0
    v_add_u32 v9, s44, v9
    ds_write_b64 v9, v[156:157]
    v_lshrrev_b32 v11, 1, v0
    v_mul_u32_u24 v9, 37, v11
    v_lshrrev_b32 v9, 8, v9
    v_add_u32 v11, v11, v9
    v_lshlrev_b32 v11, 1, v11
    v_and_b32 v9, 1, v0
    v_lshl_add_u32 v11, v9, 8, v11
    v_add_u32 v11, s44, v11
    v_and_b32 v9, 7, v0
    v_lshlrev_b32 v9, 6, v9
    v_lshl_add_u32 v9, v5, 4, v9
    v_add_u32 v9, s44, v9

    s_setprio 1
    s_waitcnt vmcnt(0)
    v_perm_b32 v72, v20, v16, s52
    v_perm_b32 v73, v28, v24, s52
    v_perm_b32 v74, v148, v144, s52
    v_perm_b32 v75, v156, v152, s52
    v_perm_b32 v76, v20, v16, s53
    v_perm_b32 v77, v28, v24, s53
    v_perm_b32 v78, v148, v144, s53
    v_perm_b32 v79, v156, v152, s53
    v_perm_b32 v80, v21, v17, s52
    v_perm_b32 v81, v29, v25, s52
    v_perm_b32 v82, v149, v145, s52
    v_perm_b32 v83, v157, v153, s52
    v_perm_b32 v84, v21, v17, s53
    v_perm_b32 v85, v29, v25, s53
    v_perm_b32 v86, v149, v145, s53
    v_perm_b32 v87, v157, v153, s53
    v_perm_b32 v88, v22, v18, s52
    v_perm_b32 v89, v30, v26, s52
    v_perm_b32 v90, v150, v146, s52
    v_perm_b32 v91, v158, v154, s52
    v_perm_b32 v92, v22, v18, s53
    v_perm_b32 v93, v30, v26, s53
    v_perm_b32 v94, v150, v146, s53
    v_perm_b32 v95, v158, v154, s53
    v_perm_b32 v96, v23, v19, s52
    v_perm_b32 v97, v31, v27, s52
    v_perm_b32 v98, v151, v147, s52
    v_perm_b32 v99, v159, v155, s52
    v_perm_b32 v100, v23, v19, s53
    v_perm_b32 v101, v31, v27, s53
    v_perm_b32 v102, v151, v147, s53
    v_perm_b32 v103, v159, v155, s53
    v_and_b32 v16, 1, v5
    v_lshlrev_b32 v16, 11, v16
    v_lshl_add_u32 v16, v7, 5, v16
    v_lshrrev_b32 v8, 1, v5
    v_lshl_add_u32 v16, v8, 4, v16
    v_add_u32 v16, s75, v16
    s_lshl_b32 s44, s3, 10
    s_add_u32 s44, s44, 32768
    v_add_u32 v17, s44, v3
    v_add_u32 v18, 32768, v17
    v_mov_b32 v19, 1
    s_lshl_b32 s60, s3, 13
    s_lshl_b32 s45, s39, 9
    s_add_u32 s60, s60, s45
    s_add_u32 s60, s60, 135168
    s_add_u32 s61, s60, 4096

    s_add_u32 s62, s45, 0x845000
    s_add_u32 s62, s72, s62
    s_addc_u32 s63, s73, 0
    s_setprio 3
    s_cmp_lg_u32 s3, 0
    s_cbranch_scc1 F_pp
F_p1:
    s_load_dword s76, s[56:57], 0 glc
    s_load_dword s77, s[58:59], 0 glc
    s_waitcnt lgkmcnt(0)
    s_min_u32 s76, s76, s77
    s_cmp_ge_u32 s76, 8
    s_cbranch_scc1 F_p2
    s_sleep 2
    s_branch F_p1
F_p2:
    v_mov_b32 v12, 3
    s_mov_b64 exec, 1
    ds_write_b32 v10, v12 offset:64
    s_mov_b64 exec, -1
F_pp:
    v_mov_b32 v8, 159104
    ds_read_b32 v12, v8 offset:0
FW_131:
    s_waitcnt lgkmcnt(0)
    v_cmp_gt_u32 vcc, 3, v12
    s_cbranch_vccz FO_132
    s_sleep 1
    ds_read_b32 v12, v8 offset:0
    s_branch FW_131
FO_132:
    s_add_u32 s45, s38, 0
    buffer_load_dwordx4 v[32:35], v4, s[12:15], s45 offen sc0 sc1
    s_add_u32 s45, s38, 114688
    buffer_load_dwordx4 v[36:39], v4, s[12:15], s45 offen sc0 sc1
    s_add_u32 s45, s38, 229376
    buffer_load_dwordx4 v[40:43], v4, s[12:15], s45 offen sc0 sc1
    s_add_u32 s45, s38, 344064
    buffer_load_dwordx4 v[44:47], v4, s[12:15], s45 offen sc0 sc1
    s_add_u32 s45, s38, 458752
    buffer_load_dwordx4 v[48:51], v4, s[12:15], s45 offen sc0 sc1
    s_add_u32 s45, s38, 573440
    buffer_load_dwordx4 v[52:55], v4, s[12:15], s45 offen sc0 sc1
    s_add_u32 s45, s38, 688128
    buffer_load_dwordx4 v[56:59], v4, s[12:15], s45 offen sc0 sc1
    s_add_u32 s45, s38, 802816
    buffer_load_dwordx4 v[60:63], v4, s[12:15], s45 offen sc0 sc1
    s_waitcnt vmcnt(0)
    v_add_f32 v32, v32, v40
    v_add_f32 v48, v48, v56
    v_add_f32 v33, v33, v41
    v_add_f32 v49, v49, v57
    v_add_f32 v34, v34, v42
    v_add_f32 v50, v50, v58
    v_add_f32 v35, v35, v43
    v_add_f32 v51, v51, v59
    v_add_f32 v32, v32, v48
    v_add_f32 v33, v33, v49
    v_add_f32 v34, v34, v50
    v_add_f32 v35, v35, v51
    v_add_f32 v36, v36, v44
    v_add_f32 v52, v52, v60
    v_add_f32 v37, v37, v45
    v_add_f32 v53, v53, v61
    v_add_f32 v38, v38, v46
    v_add_f32 v54, v54, v62
    v_add_f32 v39, v39, v47
    v_add_f32 v55, v55, v63
    v_add_f32 v36, v36, v52
    v_add_f32 v37, v37, v53
    v_add_f32 v38, v38, v54
    v_add_f32 v39, v39, v55
    v_cvt_pk_bf16_f32 v40, v32, v36
    v_cvt_pk_bf16_f32 v41, v33, v37
    v_cvt_pk_bf16_f32 v42, v34, v38
    v_cvt_pk_bf16_f32 v43, v35, v39
    v_lshlrev_b32 v32, 16, v40
    v_and_b32 v36, 0xffff0000, v40
    v_lshlrev_b32 v33, 16, v41
    v_and_b32 v37, 0xffff0000, v41
    v_lshlrev_b32 v34, 16, v42
    v_and_b32 v38, 0xffff0000, v42
    v_lshlrev_b32 v35, 16, v43
    v_and_b32 v39, 0xffff0000, v43
    v_mul_f32 v40, s48, v32
    v_mul_f32 v41, s48, v33
    v_mul_f32 v42, s48, v34
    v_mul_f32 v43, s48, v35
    v_exp_f32 v40, v40
    v_exp_f32 v41, v41
    v_exp_f32 v42, v42
    v_exp_f32 v43, v43
    v_add_f32 v40, 1.0, v40
    v_add_f32 v41, 1.0, v41
    v_add_f32 v42, 1.0, v42
    v_add_f32 v43, 1.0, v43
    v_rcp_f32 v40, v40
    v_rcp_f32 v41, v41
    v_rcp_f32 v42, v42
    v_rcp_f32 v43, v43
    v_mul_f32 v32, v32, v40
    v_mul_f32 v33, v33, v41
    v_mul_f32 v34, v34, v42
    v_mul_f32 v35, v35, v43
    v_cvt_pk_bf16_f32 v32, v32, v32
    v_cvt_pk_bf16_f32 v33, v33, v33
    v_cvt_pk_bf16_f32 v34, v34, v34
    v_cvt_pk_bf16_f32 v35, v35, v35
    v_lshlrev_b32 v32, 16, v32
    v_lshlrev_b32 v33, 16, v33
    v_lshlrev_b32 v34, 16, v34
    v_lshlrev_b32 v35, 16, v35
    v_mul_f32 v32, v32, v36
    v_mul_f32 v33, v33, v37
    v_mul_f32 v34, v34, v38
    v_mul_f32 v35, v35, v39
    v_cvt_pk_bf16_f32 v32, v32, v32
    v_cvt_pk_bf16_f32 v33, v33, v33
    v_cvt_pk_bf16_f32 v34, v34, v34
    v_cvt_pk_bf16_f32 v35, v35, v35
    s_mov_b32 exec_hi, 0xffffff
    ds_write_b16 v11, v32 offset:0
    ds_write_b16 v11, v33 offset:64
    ds_write_b16 v11, v34 offset:128
    ds_write_b16 v11, v35 offset:192
    s_mov_b64 exec, -1
    ds_read_b128 v[64:67], v9
    v_cmp_gt_u32 vcc, 32, v0
    s_waitcnt lgkmcnt(0)
    v_mfma_f32_16x16x32_bf16 v[104:107], v[64:67], v[72:75], 0
    v_mfma_f32_16x16x32_bf16 v[120:123], v[64:67], v[88:91], 0
    v_mfma_f32_16x16x32_bf16 v[108:111], v[64:67], v[76:79], 0
    v_mfma_f32_16x16x32_bf16 v[124:127], v[64:67], v[92:95], 0
    v_mfma_f32_16x16x32_bf16 v[112:115], v[64:67], v[80:83], 0
    v_mfma_f32_16x16x32_bf16 v[128:131], v[64:67], v[96:99], 0
    v_mfma_f32_16x16x32_bf16 v[116:119], v[64:67], v[84:87], 0
    v_mfma_f32_16x16x32_bf16 v[132:135], v[64:67], v[100:103], 0
    s_nop 1
    v_cndmask_b32 v136, v120, v104, vcc
    v_cndmask_b32 v140, v121, v105, vcc
    v_cndmask_b32 v144, v122, v106, vcc
    v_cndmask_b32 v148, v123, v107, vcc
    v_cndmask_b32 v137, v124, v108, vcc
    v_cndmask_b32 v141, v125, v109, vcc
    v_cndmask_b32 v145, v126, v110, vcc
    v_cndmask_b32 v149, v127, v111, vcc
    v_cndmask_b32 v138, v128, v112, vcc
    v_cndmask_b32 v142, v129, v113, vcc
    v_cndmask_b32 v146, v130, v114, vcc
    v_cndmask_b32 v150, v131, v115, vcc
    v_cndmask_b32 v139, v132, v116, vcc
    v_cndmask_b32 v143, v133, v117, vcc
    v_cndmask_b32 v147, v134, v118, vcc
    v_cndmask_b32 v151, v135, v119, vcc
    ds_write_b128 v16, v[136:139] offset:0
    ds_write_b128 v16, v[140:143] offset:512
    ds_write_b128 v16, v[144:147] offset:1024
    ds_write_b128 v16, v[148:151] offset:1536
    s_mov_b64 exec, 1
    ds_write_b32 v10, v19 offset:80
    s_mov_b64 exec, -1
F_d1:
    ds_read_b32 v12, v13 offset:80
    ds_read2st64_b32 v[32:33], v17 offset0:0 offset1:1
    ds_read2st64_b32 v[34:35], v17 offset0:2 offset1:3
    ds_read2st64_b32 v[36:37], v17 offset0:16 offset1:17
    ds_read2st64_b32 v[38:39], v17 offset0:18 offset1:19
    ds_read2st64_b32 v[40:41], v18 offset0:0 offset1:1
    ds_read2st64_b32 v[42:43], v18 offset0:2 offset1:3
    ds_read2st64_b32 v[44:45], v18 offset0:16 offset1:17
    ds_read2st64_b32 v[46:47], v18 offset0:18 offset1:19
    s_waitcnt lgkmcnt(0)
    v_cmp_eq_u32 vcc, 0, v12
    s_cbranch_vccnz F_d1
    v_add_f32 v32, v32, v36
    v_add_f32 v40, v40, v44
    v_add_f32 v33, v33, v37
    v_add_f32 v41, v41, v45
    v_add_f32 v34, v34, v38
    v_add_f32 v42, v42, v46
    v_add_f32 v35, v35, v39
    v_add_f32 v43, v43, v47
    v_add_f32 v32, v32, v40
    buffer_atomic_add_f32 v32, v3, s[24:27], s60 offen offset:0
    v_add_f32 v33, v33, v41
    buffer_atomic_add_f32 v33, v3, s[24:27], s60 offen offset:256
    v_add_f32 v34, v34, v42
    buffer_atomic_add_f32 v34, v3, s[24:27], s61 offen offset:0
    v_add_f32 v35, v35, v43
    buffer_atomic_add_f32 v35, v3, s[24:27], s61 offen offset:256
    v_mov_b32 v4, 159140
    v_mov_b32 v8, 1
    s_waitcnt vmcnt(0)
    s_mov_b64 exec, 1
    ds_add_rtn_u32 v9, v4, v8
    s_waitcnt lgkmcnt(0)
    v_readfirstlane_b32 s44, v9
    s_mov_b64 exec, -1
    s_cmp_lg_u32 s44, 3
    s_cbranch_scc1 F_ye
    s_mov_b32 s44, 1
    s_atomic_add s44, s[62:63], 0
    s_atomic_add s44, s[62:63], 0x80
    s_atomic_add s44, s[62:63], 0x100
    s_atomic_add s44, s[62:63], 0x180
F_ye:

    s_endpgm
F_codeend:
.section .rodata,"a"
.p2align 6
.amdhsa_kernel parallel_sum__linear_attn_block__moe_arch_mod__prompt_kernel
  .amdhsa_next_free_vgpr 168
  .amdhsa_next_free_sgpr 98
  .amdhsa_accum_offset 168
  .amdhsa_group_segment_fixed_size 0
  .amdhsa_kernarg_size 88
  .amdhsa_user_sgpr_count 2
  .amdhsa_user_sgpr_kernarg_segment_ptr 1
  .amdhsa_system_sgpr_workgroup_id_x 1
  .amdhsa_float_denorm_mode_32 3
  .amdhsa_float_denorm_mode_16_64 3
.end_amdhsa_kernel
```

```asm
; @launch grid=(256,1,1) block=(768,1,1) lds=163840
.amdgcn_target "amdgcn-amd-amdhsa--gfx950"
.text
.globl parallel_sum__linear_attn_block__moe_arch_mod__prompt_kernel
.p2align 12
.p2align 8
.type parallel_sum__linear_attn_block__moe_arch_mod__prompt_kernel,@function
parallel_sum__linear_attn_block__moe_arch_mod__prompt_kernel:
    s_load_dwordx4 s[4:7], s[0:1], 0
    s_load_dwordx2 s[8:9], s[0:1], 16
    s_load_dwordx8 s[60:67], s[0:1], 32
    s_load_dwordx4 s[68:71], s[0:1], 64
    s_load_dwordx2 s[72:73], s[0:1], 80
    s_cmp_ge_u32 s2, 256
    s_cbranch_scc1 F_end
    v_lshrrev_b32 v1, 6, v0
    v_and_b32 v0, 63, v0
    s_and_b32 s30, s2, 7
    v_readfirstlane_b32 s3, v1
    s_lshr_b32 s31, s2, 3
    s_and_b32 s36, s30, 1
    s_lshl_b32 s32, s36, 3
    s_and_b32 s35, s31, 7
    s_add_u32 s32, s32, s35
    s_lshr_b32 s37, s30, 1
    s_lshl_b32 s33, s37, 2
    s_lshr_b32 s34, s31, 3
    s_add_u32 s33, s33, s34
    s_add_u32 s10, s33, 0
    s_and_b32 s10, s10, 15
    s_add_u32 s11, s35, s34
    s_and_b32 s11, s11, 3
    s_and_b32 s28, s32, 11
    s_and_b32 s29, s37, 1
    s_lshl_b32 s29, s29, 2
    s_add_u32 s28, s28, s29
    s_lshr_b32 s29, s37, 1
    s_lshl_b32 s29, s29, 3
    s_and_b32 s38, s35, 4
    s_add_u32 s29, s29, s38
    s_add_u32 s38, s34, 1
    s_and_b32 s38, s38, 3
    s_add_u32 s29, s29, s38

    s_lshl_b32 s11, s34, 1
    s_add_u32 s11, s11, s35
    s_and_b32 s11, s11, 7
    s_mul_i32 s89, s36, 8
    s_mul_i32 s38, s37, 2
    s_add_u32 s89, s89, s38

    s_mov_b32 s94, 0x73156420
    s_mov_b32 s95, 0xfb9dea8c
    s_cmp_eq_u32 s11, 1
    s_cselect_b32 s94, 0x62047531, s94
    s_cselect_b32 s95, 0xea8cfb9d, s95
    s_cmp_eq_u32 s11, 2
    s_cselect_b32 s94, 0x53710642, s94
    s_cselect_b32 s95, 0xdbf9cae8, s95
    s_cmp_eq_u32 s11, 3
    s_cselect_b32 s94, 0x42601753, s94
    s_cselect_b32 s95, 0xcae8dbf9, s95
    s_cmp_eq_u32 s11, 4
    s_cselect_b32 s94, 0x58320164, s94
    s_cselect_b32 s95, 0xfdbec9a7, s95
    s_cmp_eq_u32 s11, 5
    s_cselect_b32 s94, 0x49231075, s94
    s_cselect_b32 s95, 0xecafd8b6, s95
    s_cmp_eq_u32 s11, 6
    s_cselect_b32 s94, 0xa5143206, s94
    s_cselect_b32 s95, 0xfd9ebc87, s95
    s_cmp_eq_u32 s11, 7
    s_cselect_b32 s94, 0xb4052317, s94
    s_cselect_b32 s95, 0xec8fad96, s95
    s_cmp_ge_u32 s3, 8
    s_cbranch_scc1 F_aux
    s_cmp_ge_u32 s3, 4
    s_cbranch_scc1 F_nl
    v_lshrrev_b32 v2, 3, v0
    v_and_b32 v3, 7, v0
    v_lshrrev_b32 v4, 1, v2
    v_xor_b32 v5, v3, v4
    v_xor_b32 v6, 4, v5
    v_lshlrev_b32 v5, 4, v5
    v_lshlrev_b32 v6, 4, v6
    v_lshlrev_b32 v7, 11, v2
    v_add_u32 v5, v5, v7
    v_add_u32 v6, v6, v7
    v_and_b32 v4, 1, v4
    v_lshlrev_b32 v4, 1, v4
    v_xor_b32 v8, v3, v4
    v_xor_b32 v9, 4, v8
    v_lshlrev_b32 v8, 4, v8
    v_lshlrev_b32 v9, 4, v9
    v_mul_u32_u24 v7, 6144, v2
    v_add_u32 v8, v8, v7
    v_add_u32 v9, v9, v7
    v_add_u32 v9, 49152, v9
    s_lshl_b32 s36, s32, 18
    s_lshl_b32 s37, s3, 16
    s_add_u32 s36, s36, s37
    s_lshl_b32 s38, s33, 7
    s_mul_i32 s37, s3, 98304
    s_add_u32 s38, s38, s37
    s_lshl_b32 s47, s10, 7
    s_add_u32 s47, s47, s37
    s_lshl_b32 s44, s3, 12
    s_lshl_b32 s45, s3, 11
    s_add_u32 s43, s45, 1024
    s_mov_b32 s14, 4194304
    s_mov_b32 s15, 0x20000
    s_mov_b32 s18, 6291456
    s_mov_b32 s19, 0x20000
    s_waitcnt lgkmcnt(0)
    s_mov_b32 s12, s4
    s_mov_b32 s13, s5
    s_mov_b32 s16, s6
    s_mov_b32 s17, s7

    s_setprio 3
    s_bfe_u32 s40, s94, 0x40000
    s_add_u32 s40, s89, s40
    s_and_b32 s40, s40, 15
    s_mul_i32 s41, s40, 393216
    s_lshl_b32 s40, s40, 7
    s_add_u32 s40, s40, s36
    s_add_u32 s42, s41, s47
    s_add_u32 s41, s41, s38
    s_add_u32 m0, s44, 0
    s_add_u32 s46, s40, 0
    buffer_load_dwordx4 v5, s[12:15], s46 offen lds
    s_add_u32 m0, s44, 1024
    s_add_u32 s46, s40, 16384
    buffer_load_dwordx4 v6, s[12:15], s46 offen lds
    s_add_u32 m0, s44, 2048
    s_add_u32 s46, s40, 32768
    buffer_load_dwordx4 v5, s[12:15], s46 offen lds
    s_add_u32 m0, s44, 3072
    s_add_u32 s46, s40, 49152
    buffer_load_dwordx4 v6, s[12:15], s46 offen lds
    s_add_u32 m0, s45, 65536
    s_add_u32 s46, s41, 2048
    buffer_load_dwordx4 v8, s[16:19], s46 offen lds
    s_add_u32 m0, s43, 65536
    s_add_u32 s46, s41, 2048
    buffer_load_dwordx4 v9, s[16:19], s46 offen lds
    s_add_u32 m0, s45, 73728
    s_add_u32 s46, s41, 4096
    buffer_load_dwordx4 v8, s[16:19], s46 offen lds
    s_add_u32 m0, s43, 73728
    s_add_u32 s46, s41, 4096
    buffer_load_dwordx4 v9, s[16:19], s46 offen lds
    s_add_u32 m0, s45, 147456
    s_nop 0
    buffer_load_dwordx4 v8, s[16:19], s42 offen lds
    s_add_u32 m0, s43, 147456
    s_nop 0
    buffer_load_dwordx4 v9, s[16:19], s42 offen lds
    s_bfe_u32 s40, s94, 0x40004
    s_add_u32 s40, s89, s40
    s_and_b32 s40, s40, 15
    s_mul_i32 s41, s40, 393216
    s_lshl_b32 s40, s40, 7
    s_add_u32 s40, s40, s36
    s_add_u32 s42, s41, s47
    s_add_u32 s41, s41, s38
    s_add_u32 m0, s44, 16384
    s_add_u32 s46, s40, 0
    buffer_load_dwordx4 v5, s[12:15], s46 offen lds
    s_add_u32 m0, s44, 17408
    s_add_u32 s46, s40, 16384
    buffer_load_dwordx4 v6, s[12:15], s46 offen lds
    s_add_u32 m0, s44, 18432
    s_add_u32 s46, s40, 32768
    buffer_load_dwordx4 v5, s[12:15], s46 offen lds
    s_add_u32 m0, s44, 19456
    s_add_u32 s46, s40, 49152
    buffer_load_dwordx4 v6, s[12:15], s46 offen lds
    s_add_u32 m0, s45, 81920
    s_add_u32 s46, s41, 2048
    buffer_load_dwordx4 v8, s[16:19], s46 offen lds
    s_add_u32 m0, s43, 81920
    s_add_u32 s46, s41, 2048
    buffer_load_dwordx4 v9, s[16:19], s46 offen lds
    v_and_b32 v1, 15, v0
    v_lshrrev_b32 v7, 4, v0
    v_lshrrev_b32 v3, 1, v1
    v_xor_b32 v3, v3, v7
    v_lshlrev_b32 v3, 4, v3
    v_lshlrev_b32 v1, 7, v1
    v_add3_u32 v2, v1, v3, s44
    v_xor_b32 v3, 64, v2
    v_add_u32 v14, 0x10000, v2
    v_add_u32 v15, 0x10000, v3
    v_bfe_u32 v1, v0, 2, 2
    v_lshl_add_u32 v4, v7, 3, v1
    v_lshrrev_b32 v1, 1, v1
    v_and_b32 v7, 1, v7
    v_lshl_add_u32 v1, v7, 1, v1
    v_lshlrev_b32 v1, 5, v1
    v_lshl_add_u32 v1, v4, 7, v1
    v_and_b32 v7, 3, v0
    v_lshl_add_u32 v1, v7, 3, v1
    v_add_u32 v10, 90112, v1
    v_xor_b32 v11, 32, v10
    v_xor_b32 v12, 64, v10
    v_xor_b32 v13, 96, v10
    v_lshlrev_b32 v1, 2, v7
    v_add_u32 v1, 159040, v1
    s_lshl_b32 s50, s3, 2
    s_add_u32 s50, s50, 159040
    v_mov_b32 v4, s50
    v_mov_b32 v164, 1

    s_waitcnt vmcnt(8)
    s_barrier
    s_add_u32 m0, s45, 90112
    s_add_u32 s46, s41, 4096
    buffer_load_dwordx4 v8, s[16:19], s46 offen lds
    ds_read_b128 v[48:51], v2 offset:0
    s_add_u32 m0, s43, 90112
    s_add_u32 s46, s41, 4096
    buffer_load_dwordx4 v9, s[16:19], s46 offen lds
    ds_read_b128 v[52:55], v2 offset:2048
    s_lshl_b32 s51, s32, 4
    s_add_u32 s51, s51, s33
    s_lshl_b32 s51, s51, 14
    s_add_u32 s51, s51, s45
    v_lshlrev_b32 v165, 4, v0
    s_mov_b32 s20, s60
    s_mov_b32 s21, s61
    s_mov_b32 s22, 0x800
    s_mov_b32 s23, 0x00020000
    s_add_u32 m0, s45, 98304
    s_add_u32 s46, s51, 0
    buffer_load_dwordx4 v165, s[12:15], s46 offen lds
    ds_read_b128 v[56:59], v3 offset:0
    s_add_u32 m0, s45, 99328
    s_add_u32 s46, s51, 1024
    buffer_load_dwordx4 v165, s[12:15], s46 offen lds
    ds_read_b128 v[60:63], v3 offset:2048
    s_and_b32 s46, s3, 1
    s_lshl_b32 s46, s46, 10
    s_add_u32 m0, s46, 161792
    s_nop 0
    buffer_load_dwordx4 v165, s[20:23], s46 offen lds
    s_add_u32 m0, s45, 106496
    s_add_u32 s46, s51, 8192
    buffer_load_dwordx4 v165, s[12:15], s46 offen lds
    s_add_u32 m0, s45, 107520
    s_add_u32 s46, s51, 9216
    buffer_load_dwordx4 v165, s[12:15], s46 offen lds
    s_bfe_u32 s40, s94, 0x40008
    s_add_u32 s40, s89, s40
    s_and_b32 s40, s40, 15
    s_mul_i32 s41, s40, 393216
    s_lshl_b32 s40, s40, 7
    s_add_u32 s40, s40, s36
    s_add_u32 s42, s41, s47
    s_add_u32 s41, s41, s38
    s_add_u32 m0, s44, 32768
    s_add_u32 s46, s40, 0
    buffer_load_dwordx4 v5, s[12:15], s46 offen lds
    s_add_u32 m0, s44, 33792
    s_add_u32 s46, s40, 16384
    buffer_load_dwordx4 v6, s[12:15], s46 offen lds
    s_add_u32 m0, s44, 34816
    s_add_u32 s46, s40, 32768
    buffer_load_dwordx4 v5, s[12:15], s46 offen lds
    s_add_u32 m0, s44, 35840
    s_add_u32 s46, s40, 49152
    buffer_load_dwordx4 v6, s[12:15], s46 offen lds
    s_waitcnt vmcnt(9) lgkmcnt(0)
    s_barrier
    s_add_u32 m0, s45, 114688
    s_add_u32 s46, s41, 2048
    buffer_load_dwordx4 v8, s[16:19], s46 offen lds
    ds_read_b64_tr_b16 v[64:65], v10 offset:57344
    ds_read_b64_tr_b16 v[66:67], v10 offset:57856
    s_add_u32 m0, s43, 114688
    s_add_u32 s46, s41, 2048
    buffer_load_dwordx4 v9, s[16:19], s46 offen lds
    ds_read_b128 v[68:71], v2 offset:16384
    s_add_u32 m0, s45, 122880
    s_add_u32 s46, s41, 4096
    buffer_load_dwordx4 v8, s[16:19], s46 offen lds
    ds_read_b64_tr_b16 v[72:73], v11 offset:57344
    ds_read_b64_tr_b16 v[74:75], v11 offset:57856
    s_add_u32 m0, s43, 122880
    s_add_u32 s46, s41, 4096
    buffer_load_dwordx4 v9, s[16:19], s46 offen lds
    ds_read_b128 v[76:79], v2 offset:18432
    s_bfe_u32 s40, s94, 0x40004
    s_add_u32 s40, s89, s40
    s_and_b32 s40, s40, 15
    s_mul_i32 s41, s40, 393216
    s_lshl_b32 s40, s40, 7
    s_add_u32 s40, s40, s36
    s_add_u32 s42, s41, s47
    s_add_u32 s41, s41, s38
    s_add_u32 m0, s45, 139264
    s_nop 0
    buffer_load_dwordx4 v8, s[16:19], s42 offen lds
    ds_read_b64_tr_b16 v[80:81], v12 offset:57344
    ds_read_b64_tr_b16 v[82:83], v12 offset:57856
    s_add_u32 m0, s43, 139264
    s_nop 0
    buffer_load_dwordx4 v9, s[16:19], s42 offen lds
    ds_read_b128 v[84:87], v3 offset:16384
    s_bfe_u32 s40, s94, 0x4000c
    s_add_u32 s40, s89, s40
    s_and_b32 s40, s40, 15
    s_mul_i32 s41, s40, 393216
    s_lshl_b32 s40, s40, 7
    s_add_u32 s40, s40, s36
    s_add_u32 s42, s41, s47
    s_add_u32 s41, s41, s38
    s_add_u32 m0, s44, 49152
    s_add_u32 s46, s40, 0
    buffer_load_dwordx4 v5, s[12:15], s46 offen lds
    ds_read_b64_tr_b16 v[88:89], v13 offset:57344
    ds_read_b64_tr_b16 v[90:91], v13 offset:57856
    s_add_u32 m0, s44, 50176
    s_add_u32 s46, s40, 16384
    buffer_load_dwordx4 v6, s[12:15], s46 offen lds
    ds_read_b128 v[92:95], v3 offset:18432
    s_add_u32 m0, s44, 51200
    s_add_u32 s46, s40, 32768
    buffer_load_dwordx4 v5, s[12:15], s46 offen lds
    s_add_u32 m0, s44, 52224
    s_add_u32 s46, s40, 49152
    buffer_load_dwordx4 v6, s[12:15], s46 offen lds
    s_add_u32 m0, s45, 131072
    s_add_u32 s46, s41, 2048
    buffer_load_dwordx4 v8, s[16:19], s46 offen lds
    s_waitcnt vmcnt(5) lgkmcnt(0)
    s_barrier
    s_add_u32 m0, s43, 131072
    s_add_u32 s46, s41, 2048
    buffer_load_dwordx4 v9, s[16:19], s46 offen lds
    v_mfma_f32_16x16x32_bf16 v[16:19], v[64:67], v[48:51], 0
    ds_read_b64_tr_b16 v[96:97], v10 offset:61440
    ds_read_b64_tr_b16 v[98:99], v10 offset:61952
    s_add_u32 m0, s45, 65536
    s_add_u32 s46, s41, 4096
    buffer_load_dwordx4 v8, s[16:19], s46 offen lds
    v_mfma_f32_16x16x32_bf16 v[32:35], v[64:67], v[52:55], 0
    ds_read_b128 v[100:103], v2 offset:32768
    s_add_u32 m0, s43, 65536
    s_add_u32 s46, s41, 4096
    buffer_load_dwordx4 v9, s[16:19], s46 offen lds
    v_mfma_f32_16x16x32_bf16 v[20:23], v[72:75], v[48:51], 0
    ds_read_b64_tr_b16 v[104:105], v11 offset:61440
    ds_read_b64_tr_b16 v[106:107], v11 offset:61952
    s_bfe_u32 s40, s94, 0x40008
    s_add_u32 s40, s89, s40
    s_and_b32 s40, s40, 15
    s_mul_i32 s41, s40, 393216
    s_lshl_b32 s40, s40, 7
    s_add_u32 s40, s40, s36
    s_add_u32 s42, s41, s47
    s_add_u32 s41, s41, s38
    s_add_u32 m0, s45, 90112
    s_nop 0
    buffer_load_dwordx4 v8, s[16:19], s42 offen lds
    v_mfma_f32_16x16x32_bf16 v[36:39], v[72:75], v[52:55], 0
    ds_read_b128 v[108:111], v2 offset:34816
    s_add_u32 m0, s43, 90112
    s_nop 0
    buffer_load_dwordx4 v9, s[16:19], s42 offen lds
    v_mfma_f32_16x16x32_bf16 v[24:27], v[80:83], v[48:51], 0
    ds_read_b64_tr_b16 v[112:113], v12 offset:61440
    ds_read_b64_tr_b16 v[114:115], v12 offset:61952
    s_bfe_u32 s40, s94, 0x40010
    s_add_u32 s40, s89, s40
    s_and_b32 s40, s40, 15
    s_mul_i32 s41, s40, 393216
    s_lshl_b32 s40, s40, 7
    s_add_u32 s40, s40, s36
    s_add_u32 s42, s41, s47
    s_add_u32 s41, s41, s38
    s_add_u32 m0, s44, 0
    s_add_u32 s46, s40, 0
    buffer_load_dwordx4 v5, s[12:15], s46 offen lds
    v_mfma_f32_16x16x32_bf16 v[40:43], v[80:83], v[52:55], 0
    ds_read_b128 v[116:119], v3 offset:32768
    s_add_u32 m0, s44, 1024
    s_add_u32 s46, s40, 16384
    buffer_load_dwordx4 v6, s[12:15], s46 offen lds
    v_mfma_f32_16x16x32_bf16 v[28:31], v[88:91], v[48:51], 0
    ds_read_b64_tr_b16 v[120:121], v13 offset:61440
    ds_read_b64_tr_b16 v[122:123], v13 offset:61952
    s_add_u32 m0, s44, 2048
    s_add_u32 s46, s40, 32768
    buffer_load_dwordx4 v5, s[12:15], s46 offen lds
    v_mfma_f32_16x16x32_bf16 v[44:47], v[88:91], v[52:55], 0
    ds_read_b128 v[124:127], v3 offset:34816
    s_add_u32 m0, s44, 3072
    s_add_u32 s46, s40, 49152
    buffer_load_dwordx4 v6, s[12:15], s46 offen lds
    ds_read_b64_tr_b16 v[128:129], v10 offset:49152
    ds_read_b64_tr_b16 v[130:131], v10 offset:49664
    s_add_u32 m0, s45, 73728
    s_add_u32 s46, s41, 2048
    buffer_load_dwordx4 v8, s[16:19], s46 offen lds
    ds_read_b64_tr_b16 v[132:133], v11 offset:49152
    s_waitcnt lgkmcnt(8)
    ds_read_b64_tr_b16 v[134:135], v11 offset:49664
    s_add_u32 m0, s43, 73728
    s_add_u32 s46, s41, 2048
    buffer_load_dwordx4 v9, s[16:19], s46 offen lds
    ds_read_b64_tr_b16 v[136:137], v12 offset:49152
    ds_read_b64_tr_b16 v[138:139], v12 offset:49664
    ds_read_b64_tr_b16 v[140:141], v13 offset:49152
    ds_read_b64_tr_b16 v[142:143], v13 offset:49664
    s_waitcnt vmcnt(6) lgkmcnt(0)
    s_barrier
    s_add_u32 m0, s45, 81920
    s_add_u32 s46, s41, 4096
    buffer_load_dwordx4 v8, s[16:19], s46 offen lds
    v_mfma_f32_16x16x32_bf16 v[16:19], v[96:99], v[56:59], v[16:19]
    ds_read_b64_tr_b16 v[144:145], v10 offset:53248
    ds_read_b64_tr_b16 v[146:147], v10 offset:53760
    s_add_u32 m0, s43, 81920
    s_add_u32 s46, s41, 4096
    buffer_load_dwordx4 v9, s[16:19], s46 offen lds
    v_mfma_f32_16x16x32_bf16 v[32:35], v[96:99], v[60:63], v[32:35]
    ds_read_b128 v[148:151], v2 offset:49152
    s_bfe_u32 s40, s94, 0x40014
    s_add_u32 s40, s89, s40
    s_and_b32 s40, s40, 15
    s_mul_i32 s41, s40, 393216
    s_lshl_b32 s40, s40, 7
    s_add_u32 s40, s40, s36
    s_add_u32 s42, s41, s47
    s_add_u32 s41, s41, s38
    s_add_u32 m0, s44, 16384
    s_add_u32 s46, s40, 0
    buffer_load_dwordx4 v5, s[12:15], s46 offen lds
    v_mfma_f32_16x16x32_bf16 v[20:23], v[104:107], v[56:59], v[20:23]
    ds_read_b64_tr_b16 v[152:153], v11 offset:53248
    ds_read_b64_tr_b16 v[154:155], v11 offset:53760
    s_add_u32 m0, s44, 17408
    s_add_u32 s46, s40, 16384
    buffer_load_dwordx4 v6, s[12:15], s46 offen lds
    v_mfma_f32_16x16x32_bf16 v[36:39], v[104:107], v[60:63], v[36:39]
    ds_read_b128 v[156:159], v2 offset:51200
    s_add_u32 m0, s44, 18432
    s_add_u32 s46, s40, 32768
    buffer_load_dwordx4 v5, s[12:15], s46 offen lds
    v_mfma_f32_16x16x32_bf16 v[24:27], v[112:115], v[56:59], v[24:27]
    ds_read_b64_tr_b16 v[160:161], v12 offset:53248
    ds_read_b64_tr_b16 v[162:163], v12 offset:53760
    s_add_u32 m0, s44, 19456
    s_add_u32 s46, s40, 49152
    buffer_load_dwordx4 v6, s[12:15], s46 offen lds
    v_mfma_f32_16x16x32_bf16 v[40:43], v[112:115], v[60:63], v[40:43]
    ds_read_b128 v[64:67], v3 offset:49152
    s_add_u32 m0, s45, 98304
    s_add_u32 s46, s41, 2048
    buffer_load_dwordx4 v8, s[16:19], s46 offen lds
    v_mfma_f32_16x16x32_bf16 v[28:31], v[120:123], v[56:59], v[28:31]
    ds_read_b64_tr_b16 v[72:73], v13 offset:53248
    ds_read_b64_tr_b16 v[74:75], v13 offset:53760
    s_add_u32 m0, s43, 98304
    s_add_u32 s46, s41, 2048
    buffer_load_dwordx4 v9, s[16:19], s46 offen lds
    v_mfma_f32_16x16x32_bf16 v[44:47], v[120:123], v[60:63], v[44:47]
    ds_read_b128 v[80:83], v3 offset:51200
    s_add_u32 m0, s45, 106496
    s_add_u32 s46, s41, 4096
    buffer_load_dwordx4 v8, s[16:19], s46 offen lds
    v_mfma_f32_16x16x32_bf16 v[16:19], v[128:131], v[68:71], v[16:19]
    ds_read_b64_tr_b16 v[48:49], v10 offset:0
    ds_read_b64_tr_b16 v[50:51], v10 offset:512
    s_add_u32 m0, s43, 106496
    s_add_u32 s46, s41, 4096
    buffer_load_dwordx4 v9, s[16:19], s46 offen lds
    v_mfma_f32_16x16x32_bf16 v[32:35], v[128:131], v[76:79], v[32:35]
    ds_read_b64_tr_b16 v[88:89], v11 offset:0
    s_waitcnt lgkmcnt(8)
    ds_read_b64_tr_b16 v[90:91], v11 offset:512
    s_bfe_u32 s40, s94, 0x4000c
    s_add_u32 s40, s89, s40
    s_and_b32 s40, s40, 15
    s_mul_i32 s41, s40, 393216
    s_lshl_b32 s40, s40, 7
    s_add_u32 s40, s40, s36
    s_add_u32 s42, s41, s47
    s_add_u32 s41, s41, s38
    s_add_u32 m0, s45, 147456
    s_nop 0
    buffer_load_dwordx4 v8, s[16:19], s42 offen lds
    v_mfma_f32_16x16x32_bf16 v[20:23], v[132:135], v[68:71], v[20:23]
    ds_read_b64_tr_b16 v[52:53], v12 offset:0
    ds_read_b64_tr_b16 v[54:55], v12 offset:512
    v_mfma_f32_16x16x32_bf16 v[36:39], v[132:135], v[76:79], v[36:39]
    ds_read_b64_tr_b16 v[96:97], v13 offset:0
    ds_read_b64_tr_b16 v[98:99], v13 offset:512
    v_mfma_f32_16x16x32_bf16 v[24:27], v[136:139], v[68:71], v[24:27]
    v_mfma_f32_16x16x32_bf16 v[40:43], v[136:139], v[76:79], v[40:43]
    v_mfma_f32_16x16x32_bf16 v[28:31], v[140:143], v[68:71], v[28:31]
    v_mfma_f32_16x16x32_bf16 v[44:47], v[140:143], v[76:79], v[44:47]
    s_waitcnt vmcnt(9) lgkmcnt(0)
    s_barrier
    s_add_u32 m0, s43, 147456
    s_nop 0
    buffer_load_dwordx4 v9, s[16:19], s42 offen lds
    v_mfma_f32_16x16x32_bf16 v[16:19], v[144:147], v[84:87], v[16:19]
    ds_read_b64_tr_b16 v[104:105], v10 offset:4096
    ds_read_b64_tr_b16 v[106:107], v10 offset:4608
    s_bfe_u32 s40, s94, 0x40018
    s_add_u32 s40, s89, s40
    s_and_b32 s40, s40, 15
    s_mul_i32 s41, s40, 393216
    s_lshl_b32 s40, s40, 7
    s_add_u32 s40, s40, s36
    s_add_u32 s42, s41, s47
    s_add_u32 s41, s41, s38
    s_add_u32 m0, s44, 32768
    s_add_u32 s46, s40, 0
    buffer_load_dwordx4 v5, s[12:15], s46 offen lds
    v_mfma_f32_16x16x32_bf16 v[32:35], v[144:147], v[92:95], v[32:35]
    ds_read_b128 v[112:115], v2 offset:0
    s_add_u32 m0, s44, 33792
    s_add_u32 s46, s40, 16384
    s_branch IW_s0
IW_w0:
    s_branch IW_r0
IW_s0:
    buffer_load_dwordx4 v6, s[12:15], s46 offen lds
    v_mfma_f32_16x16x32_bf16 v[20:23], v[152:155], v[84:87], v[20:23]
    ds_read_b64_tr_b16 v[56:57], v11 offset:4096
    ds_read_b64_tr_b16 v[58:59], v11 offset:4608
    s_add_u32 m0, s44, 34816
    s_add_u32 s46, s40, 32768
    buffer_load_dwordx4 v5, s[12:15], s46 offen lds
    v_mfma_f32_16x16x32_bf16 v[36:39], v[152:155], v[92:95], v[36:39]
    ds_read_b128 v[120:123], v2 offset:2048
    s_add_u32 m0, s44, 35840
    s_add_u32 s46, s40, 49152
    buffer_load_dwordx4 v6, s[12:15], s46 offen lds
    v_mfma_f32_16x16x32_bf16 v[24:27], v[160:163], v[84:87], v[24:27]
    ds_read_b64_tr_b16 v[60:61], v12 offset:4096
    ds_read_b64_tr_b16 v[62:63], v12 offset:4608
    s_add_u32 m0, s45, 114688
    s_add_u32 s46, s41, 2048
    buffer_load_dwordx4 v8, s[16:19], s46 offen lds
    v_mfma_f32_16x16x32_bf16 v[40:43], v[160:163], v[92:95], v[40:43]
    ds_read_b128 v[128:131], v3 offset:0
    s_add_u32 m0, s43, 114688
    s_add_u32 s46, s41, 2048
    buffer_load_dwordx4 v9, s[16:19], s46 offen lds
    v_mfma_f32_16x16x32_bf16 v[28:31], v[72:75], v[84:87], v[28:31]
    ds_read_b64_tr_b16 v[132:133], v13 offset:4096
    ds_read_b64_tr_b16 v[134:135], v13 offset:4608
    s_add_u32 m0, s45, 122880
    s_add_u32 s46, s41, 4096
    buffer_load_dwordx4 v8, s[16:19], s46 offen lds
    v_mfma_f32_16x16x32_bf16 v[44:47], v[72:75], v[92:95], v[44:47]
    ds_read_b128 v[136:139], v3 offset:2048
    s_add_u32 m0, s43, 122880
    s_add_u32 s46, s41, 4096
    buffer_load_dwordx4 v9, s[16:19], s46 offen lds
    v_mfma_f32_16x16x32_bf16 v[16:19], v[48:51], v[100:103], v[16:19]
    s_bfe_u32 s40, s94, 0x4001c
    s_add_u32 s40, s89, s40
    s_and_b32 s40, s40, 15
    s_mul_i32 s41, s40, 393216
    s_lshl_b32 s40, s40, 7
    s_add_u32 s40, s40, s36
    s_add_u32 s42, s41, s47
    s_add_u32 s41, s41, s38
    s_add_u32 m0, s44, 49152
    s_add_u32 s46, s40, 0
    buffer_load_dwordx4 v5, s[12:15], s46 offen lds
    v_mfma_f32_16x16x32_bf16 v[32:35], v[48:51], v[108:111], v[32:35]
    s_add_u32 m0, s44, 50176
    s_add_u32 s46, s40, 16384
    buffer_load_dwordx4 v6, s[12:15], s46 offen lds
    v_mfma_f32_16x16x32_bf16 v[20:23], v[88:91], v[100:103], v[20:23]
    v_mfma_f32_16x16x32_bf16 v[36:39], v[88:91], v[108:111], v[36:39]
    v_mfma_f32_16x16x32_bf16 v[24:27], v[52:55], v[100:103], v[24:27]
    v_mfma_f32_16x16x32_bf16 v[40:43], v[52:55], v[108:111], v[40:43]
    v_mfma_f32_16x16x32_bf16 v[28:31], v[96:99], v[100:103], v[28:31]
    v_mfma_f32_16x16x32_bf16 v[44:47], v[96:99], v[108:111], v[44:47]
    s_waitcnt vmcnt(10) lgkmcnt(0)
    s_barrier
    s_add_u32 m0, s44, 51200
    s_add_u32 s46, s40, 32768
    buffer_load_dwordx4 v5, s[12:15], s46 offen lds
    v_mfma_f32_16x16x32_bf16 v[16:19], v[104:107], v[116:119], v[16:19]
    ds_read_b64_tr_b16 v[68:69], v10 offset:57344
    ds_read_b64_tr_b16 v[70:71], v10 offset:57856
    s_add_u32 m0, s44, 52224
    s_add_u32 s46, s40, 49152
    buffer_load_dwordx4 v6, s[12:15], s46 offen lds
    v_mfma_f32_16x16x32_bf16 v[32:35], v[104:107], v[124:127], v[32:35]
    ds_read_b128 v[140:143], v2 offset:16384
    s_add_u32 m0, s45, 65536
    s_add_u32 s46, s41, 2048
    buffer_load_dwordx4 v8, s[16:19], s46 offen lds
    v_mfma_f32_16x16x32_bf16 v[20:23], v[56:59], v[116:119], v[20:23]
    ds_read_b64_tr_b16 v[76:77], v11 offset:57344
    ds_read_b64_tr_b16 v[78:79], v11 offset:57856
    s_add_u32 m0, s43, 65536
    s_add_u32 s46, s41, 2048
    buffer_load_dwordx4 v9, s[16:19], s46 offen lds
    v_mfma_f32_16x16x32_bf16 v[36:39], v[56:59], v[124:127], v[36:39]
    ds_read_b128 v[144:147], v2 offset:18432
    s_add_u32 m0, s45, 131072
    s_add_u32 s46, s41, 4096
    buffer_load_dwordx4 v8, s[16:19], s46 offen lds
    v_mfma_f32_16x16x32_bf16 v[24:27], v[60:63], v[116:119], v[24:27]
    ds_read_b64_tr_b16 v[152:153], v12 offset:57344
    ds_read_b64_tr_b16 v[154:155], v12 offset:57856
    s_add_u32 m0, s43, 131072
    s_add_u32 s46, s41, 4096
    buffer_load_dwordx4 v9, s[16:19], s46 offen lds
    v_mfma_f32_16x16x32_bf16 v[40:43], v[60:63], v[124:127], v[40:43]
    ds_read_b128 v[160:163], v3 offset:16384
    s_bfe_u32 s40, s94, 0x40010
    s_add_u32 s40, s89, s40
    s_and_b32 s40, s40, 15
    s_mul_i32 s41, s40, 393216
    s_lshl_b32 s40, s40, 7
    s_add_u32 s40, s40, s36
    s_add_u32 s42, s41, s47
    s_add_u32 s41, s41, s38
    s_add_u32 m0, s45, 139264
    s_nop 0
    buffer_load_dwordx4 v8, s[16:19], s42 offen lds
    v_mfma_f32_16x16x32_bf16 v[28:31], v[132:135], v[116:119], v[28:31]
    ds_read_b64_tr_b16 v[84:85], v13 offset:57344
    ds_read_b64_tr_b16 v[86:87], v13 offset:57856
    s_add_u32 m0, s43, 139264
    s_nop 0
    buffer_load_dwordx4 v9, s[16:19], s42 offen lds
    v_mfma_f32_16x16x32_bf16 v[44:47], v[132:135], v[124:127], v[44:47]
    ds_read_b128 v[72:75], v3 offset:18432
    s_bfe_u32 s40, s95, 0x40000
    s_add_u32 s40, s89, s40
    s_and_b32 s40, s40, 15
    s_mul_i32 s41, s40, 393216
    s_lshl_b32 s40, s40, 7
    s_add_u32 s40, s40, s36
    s_add_u32 s42, s41, s47
    s_add_u32 s41, s41, s38
    s_add_u32 m0, s44, 0
    s_add_u32 s46, s40, 0
    buffer_load_dwordx4 v5, s[12:15], s46 offen lds
    s_add_u32 m0, s44, 1024
    s_add_u32 s46, s40, 16384
    buffer_load_dwordx4 v6, s[12:15], s46 offen lds
    s_add_u32 m0, s44, 2048
    s_add_u32 s46, s40, 32768
    buffer_load_dwordx4 v5, s[12:15], s46 offen lds
    s_waitcnt vmcnt(13) lgkmcnt(0)
    s_barrier
    s_add_u32 m0, s44, 3072
    s_add_u32 s46, s40, 49152
    buffer_load_dwordx4 v6, s[12:15], s46 offen lds
    v_mfma_f32_16x16x32_bf16 v[16:19], v[68:71], v[148:151], v[16:19]
    ds_read_b64_tr_b16 v[92:93], v10 offset:61440
    ds_read_b64_tr_b16 v[94:95], v10 offset:61952
    s_add_u32 m0, s45, 73728
    s_add_u32 s46, s41, 2048
    buffer_load_dwordx4 v8, s[16:19], s46 offen lds
    v_mfma_f32_16x16x32_bf16 v[32:35], v[68:71], v[156:159], v[32:35]
    ds_read_b128 v[48:51], v2 offset:32768
    s_add_u32 m0, s43, 73728
    s_add_u32 s46, s41, 2048
    buffer_load_dwordx4 v9, s[16:19], s46 offen lds
    v_mfma_f32_16x16x32_bf16 v[20:23], v[76:79], v[148:151], v[20:23]
    ds_read_b64_tr_b16 v[88:89], v11 offset:61440
    ds_read_b64_tr_b16 v[90:91], v11 offset:61952
    s_add_u32 m0, s45, 81920
    s_add_u32 s46, s41, 4096
    buffer_load_dwordx4 v8, s[16:19], s46 offen lds
    v_mfma_f32_16x16x32_bf16 v[36:39], v[76:79], v[156:159], v[36:39]
    ds_read_b128 v[52:55], v2 offset:34816
    s_add_u32 m0, s43, 81920
    s_add_u32 s46, s41, 4096
    buffer_load_dwordx4 v9, s[16:19], s46 offen lds
    v_mfma_f32_16x16x32_bf16 v[24:27], v[152:155], v[148:151], v[24:27]
    ds_read_b64_tr_b16 v[100:101], v12 offset:61440
    ds_read_b64_tr_b16 v[102:103], v12 offset:61952
    s_bfe_u32 s40, s95, 0x40004
    s_add_u32 s40, s89, s40
    s_and_b32 s40, s40, 15
    s_mul_i32 s41, s40, 393216
    s_lshl_b32 s40, s40, 7
    s_add_u32 s40, s40, s36
    s_add_u32 s42, s41, s47
    s_add_u32 s41, s41, s38
    s_add_u32 m0, s44, 16384
    s_add_u32 s46, s40, 0
    buffer_load_dwordx4 v5, s[12:15], s46 offen lds
    v_mfma_f32_16x16x32_bf16 v[40:43], v[152:155], v[156:159], v[40:43]
    ds_read_b128 v[96:99], v3 offset:32768
    s_add_u32 m0, s44, 17408
    s_add_u32 s46, s40, 16384
    buffer_load_dwordx4 v6, s[12:15], s46 offen lds
    v_mfma_f32_16x16x32_bf16 v[28:31], v[84:87], v[148:151], v[28:31]
    ds_read_b64_tr_b16 v[108:109], v13 offset:61440
    ds_read_b64_tr_b16 v[110:111], v13 offset:61952
    s_add_u32 m0, s44, 18432
    s_add_u32 s46, s40, 32768
    buffer_load_dwordx4 v5, s[12:15], s46 offen lds
    v_mfma_f32_16x16x32_bf16 v[44:47], v[84:87], v[156:159], v[44:47]
    ds_read_b128 v[104:107], v3 offset:34816
    s_add_u32 m0, s44, 19456
    s_add_u32 s46, s40, 49152
    buffer_load_dwordx4 v6, s[12:15], s46 offen lds
    s_add_u32 m0, s45, 90112
    s_add_u32 s46, s41, 2048
    buffer_load_dwordx4 v8, s[16:19], s46 offen lds
    s_add_u32 m0, s43, 90112
    s_add_u32 s46, s41, 2048
    buffer_load_dwordx4 v9, s[16:19], s46 offen lds
    s_waitcnt vmcnt(14) lgkmcnt(0)
    s_barrier
    s_add_u32 m0, s45, 98304
    s_add_u32 s46, s41, 4096
    buffer_load_dwordx4 v8, s[16:19], s46 offen lds
    v_mfma_f32_16x16x32_bf16 v[16:19], v[92:95], v[64:67], v[16:19]
    ds_read_b64_tr_b16 v[56:57], v10 offset:49152
    ds_read_b64_tr_b16 v[58:59], v10 offset:49664
    s_add_u32 m0, s43, 98304
    s_add_u32 s46, s41, 4096
    buffer_load_dwordx4 v9, s[16:19], s46 offen lds
    v_mfma_f32_16x16x32_bf16 v[32:35], v[92:95], v[80:83], v[32:35]
    ds_read_b128 v[60:63], v2 offset:49152
    s_bfe_u32 s40, s94, 0x40014
    s_add_u32 s40, s89, s40
    s_and_b32 s40, s40, 15
    s_mul_i32 s41, s40, 393216
    s_lshl_b32 s40, s40, 7
    s_add_u32 s40, s40, s36
    s_add_u32 s42, s41, s47
    s_add_u32 s41, s41, s38
    s_add_u32 m0, s45, 106496
    s_nop 0
    buffer_load_dwordx4 v8, s[16:19], s42 offen lds
    v_mfma_f32_16x16x32_bf16 v[20:23], v[88:91], v[64:67], v[20:23]
    ds_read_b64_tr_b16 v[116:117], v11 offset:49152
    ds_read_b64_tr_b16 v[118:119], v11 offset:49664
    s_add_u32 m0, s43, 106496
    s_nop 0
    buffer_load_dwordx4 v9, s[16:19], s42 offen lds
    v_mfma_f32_16x16x32_bf16 v[36:39], v[88:91], v[80:83], v[36:39]
    ds_read_b128 v[132:135], v2 offset:51200
    s_bfe_u32 s40, s95, 0x40008
    s_add_u32 s40, s89, s40
    s_and_b32 s40, s40, 15
    s_mul_i32 s41, s40, 393216
    s_lshl_b32 s40, s40, 7
    s_add_u32 s40, s40, s36
    s_add_u32 s42, s41, s47
    s_add_u32 s41, s41, s38
    s_add_u32 m0, s44, 32768
    s_add_u32 s46, s40, 0
    buffer_load_dwordx4 v5, s[12:15], s46 offen lds
    v_mfma_f32_16x16x32_bf16 v[24:27], v[100:103], v[64:67], v[24:27]
    ds_read_b64_tr_b16 v[124:125], v12 offset:49152
    ds_read_b64_tr_b16 v[126:127], v12 offset:49664
    s_add_u32 m0, s44, 33792
    s_add_u32 s46, s40, 16384
    buffer_load_dwordx4 v6, s[12:15], s46 offen lds
    v_mfma_f32_16x16x32_bf16 v[40:43], v[100:103], v[80:83], v[40:43]
    ds_read_b128 v[68:71], v3 offset:49152
    s_add_u32 m0, s44, 34816
    s_add_u32 s46, s40, 32768
    buffer_load_dwordx4 v5, s[12:15], s46 offen lds
    v_mfma_f32_16x16x32_bf16 v[28:31], v[108:111], v[64:67], v[28:31]
    ds_read_b64_tr_b16 v[76:77], v13 offset:49152
    ds_read_b64_tr_b16 v[78:79], v13 offset:49664
    s_add_u32 m0, s44, 35840
    s_add_u32 s46, s40, 49152
    buffer_load_dwordx4 v6, s[12:15], s46 offen lds
    v_mfma_f32_16x16x32_bf16 v[44:47], v[108:111], v[80:83], v[44:47]
    ds_read_b128 v[152:155], v3 offset:51200
    s_add_u32 m0, s45, 114688
    s_add_u32 s46, s41, 2048
    buffer_load_dwordx4 v8, s[16:19], s46 offen lds
    s_add_u32 m0, s43, 114688
    s_add_u32 s46, s41, 2048
    buffer_load_dwordx4 v9, s[16:19], s46 offen lds
    s_add_u32 m0, s45, 122880
    s_add_u32 s46, s41, 4096
    buffer_load_dwordx4 v8, s[16:19], s46 offen lds
    s_waitcnt vmcnt(17) lgkmcnt(0)
    s_barrier
    s_add_u32 m0, s43, 122880
    s_add_u32 s46, s41, 4096
    buffer_load_dwordx4 v9, s[16:19], s46 offen lds
    v_mfma_f32_16x16x32_bf16 v[16:19], v[56:59], v[112:115], v[16:19]
    ds_read_b64_tr_b16 v[148:149], v10 offset:53248
    ds_read_b64_tr_b16 v[150:151], v10 offset:53760
    s_bfe_u32 s40, s95, 0x4000c
    s_add_u32 s40, s89, s40
    s_and_b32 s40, s40, 15
    s_mul_i32 s41, s40, 393216
    s_lshl_b32 s40, s40, 7
    s_add_u32 s40, s40, s36
    s_add_u32 s42, s41, s47
    s_add_u32 s41, s41, s38
    s_add_u32 m0, s44, 49152
    s_add_u32 s46, s40, 0
    buffer_load_dwordx4 v5, s[12:15], s46 offen lds
    v_mfma_f32_16x16x32_bf16 v[32:35], v[56:59], v[120:123], v[32:35]
    ds_read_b128 v[84:87], v2 offset:0
    s_add_u32 m0, s44, 50176
    s_add_u32 s46, s40, 16384
    buffer_load_dwordx4 v6, s[12:15], s46 offen lds
    v_mfma_f32_16x16x32_bf16 v[20:23], v[116:119], v[112:115], v[20:23]
    ds_read_b64_tr_b16 v[156:157], v11 offset:53248
    ds_read_b64_tr_b16 v[158:159], v11 offset:53760
    s_add_u32 m0, s44, 51200
    s_add_u32 s46, s40, 32768
    buffer_load_dwordx4 v5, s[12:15], s46 offen lds
    v_mfma_f32_16x16x32_bf16 v[36:39], v[116:119], v[120:123], v[36:39]
    ds_read_b128 v[92:95], v2 offset:2048
    s_add_u32 m0, s44, 52224
    s_add_u32 s46, s40, 49152
    buffer_load_dwordx4 v6, s[12:15], s46 offen lds
    v_mfma_f32_16x16x32_bf16 v[24:27], v[124:127], v[112:115], v[24:27]
    ds_read_b64_tr_b16 v[88:89], v12 offset:53248
    ds_read_b64_tr_b16 v[90:91], v12 offset:53760
    s_add_u32 m0, s45, 65536
    s_add_u32 s46, s41, 2048
    buffer_load_dwordx4 v8, s[16:19], s46 offen lds
    v_mfma_f32_16x16x32_bf16 v[40:43], v[124:127], v[120:123], v[40:43]
    ds_read_b128 v[100:103], v3 offset:0
    s_add_u32 m0, s43, 65536
    s_add_u32 s46, s41, 2048
    buffer_load_dwordx4 v9, s[16:19], s46 offen lds
    v_mfma_f32_16x16x32_bf16 v[28:31], v[76:79], v[112:115], v[28:31]
    ds_read_b64_tr_b16 v[64:65], v13 offset:53248
    ds_read_b64_tr_b16 v[66:67], v13 offset:53760
    s_add_u32 m0, s45, 131072
    s_add_u32 s46, s41, 4096
    buffer_load_dwordx4 v8, s[16:19], s46 offen lds
    v_mfma_f32_16x16x32_bf16 v[44:47], v[76:79], v[120:123], v[44:47]
    ds_read_b128 v[108:111], v3 offset:2048
    s_add_u32 m0, s43, 131072
    s_add_u32 s46, s41, 4096
    buffer_load_dwordx4 v9, s[16:19], s46 offen lds
    s_waitcnt vmcnt(16) lgkmcnt(0)
    s_barrier
    s_bfe_u32 s40, s95, 0x40010
    s_add_u32 s40, s89, s40
    s_and_b32 s40, s40, 15
    s_mul_i32 s41, s40, 393216
    s_lshl_b32 s40, s40, 7
    s_add_u32 s40, s40, s36
    s_add_u32 s42, s41, s47
    s_add_u32 s41, s41, s38
    s_add_u32 m0, s44, 0
    s_add_u32 s46, s40, 0
    buffer_load_dwordx4 v5, s[12:15], s46 offen lds
    v_mfma_f32_16x16x32_bf16 v[16:19], v[148:151], v[128:131], v[16:19]
    ds_read_b64_tr_b16 v[80:81], v10 offset:16384
    ds_read_b64_tr_b16 v[82:83], v10 offset:16896
    s_add_u32 m0, s44, 1024
    s_add_u32 s46, s40, 16384
    buffer_load_dwordx4 v6, s[12:15], s46 offen lds
    v_mfma_f32_16x16x32_bf16 v[32:35], v[148:151], v[136:139], v[32:35]
    ds_read_b128 v[56:59], v2 offset:16384
    s_add_u32 m0, s44, 2048
    s_add_u32 s46, s40, 32768
    buffer_load_dwordx4 v5, s[12:15], s46 offen lds
    v_mfma_f32_16x16x32_bf16 v[20:23], v[156:159], v[128:131], v[20:23]
    ds_read_b64_tr_b16 v[116:117], v11 offset:16384
    ds_read_b64_tr_b16 v[118:119], v11 offset:16896
    s_add_u32 m0, s44, 3072
    s_add_u32 s46, s40, 49152
    buffer_load_dwordx4 v6, s[12:15], s46 offen lds
    v_mfma_f32_16x16x32_bf16 v[36:39], v[156:159], v[136:139], v[36:39]
    ds_read_b128 v[124:127], v2 offset:18432
    s_add_u32 m0, s45, 73728
    s_add_u32 s46, s41, 2048
    buffer_load_dwordx4 v8, s[16:19], s46 offen lds
    v_mfma_f32_16x16x32_bf16 v[24:27], v[88:91], v[128:131], v[24:27]
    ds_read_b64_tr_b16 v[112:113], v12 offset:16384
    ds_read_b64_tr_b16 v[114:115], v12 offset:16896
    s_add_u32 m0, s43, 73728
    s_add_u32 s46, s41, 2048
    buffer_load_dwordx4 v9, s[16:19], s46 offen lds
    v_mfma_f32_16x16x32_bf16 v[40:43], v[88:91], v[136:139], v[40:43]
    ds_read_b128 v[76:79], v3 offset:16384
    s_add_u32 m0, s45, 81920
    s_add_u32 s46, s41, 4096
    buffer_load_dwordx4 v8, s[16:19], s46 offen lds
    v_mfma_f32_16x16x32_bf16 v[28:31], v[64:67], v[128:131], v[28:31]
    ds_read_b64_tr_b16 v[120:121], v13 offset:16384
    ds_read_b64_tr_b16 v[122:123], v13 offset:16896
    s_add_u32 m0, s43, 81920
    s_add_u32 s46, s41, 4096
    buffer_load_dwordx4 v9, s[16:19], s46 offen lds
    v_mfma_f32_16x16x32_bf16 v[44:47], v[64:67], v[136:139], v[44:47]
    ds_read_b128 v[148:151], v3 offset:18432
    s_waitcnt vmcnt(16) lgkmcnt(0)
    s_barrier
    s_bfe_u32 s40, s95, 0x40014
    s_add_u32 s40, s89, s40
    s_and_b32 s40, s40, 15
    s_mul_i32 s41, s40, 393216
    s_lshl_b32 s40, s40, 7
    s_add_u32 s40, s40, s36
    s_add_u32 s42, s41, s47
    s_add_u32 s41, s41, s38
    s_add_u32 m0, s44, 16384
    s_add_u32 s46, s40, 0
    buffer_load_dwordx4 v5, s[12:15], s46 offen lds
    v_mfma_f32_16x16x32_bf16 v[16:19], v[80:83], v[140:143], v[16:19]
    ds_read_b64_tr_b16 v[156:157], v10 offset:20480
    ds_read_b64_tr_b16 v[158:159], v10 offset:20992
    s_add_u32 m0, s44, 17408
    s_add_u32 s46, s40, 16384
    buffer_load_dwordx4 v6, s[12:15], s46 offen lds
    v_mfma_f32_16x16x32_bf16 v[32:35], v[80:83], v[144:147], v[32:35]
    ds_read_b128 v[88:91], v2 offset:32768
    s_add_u32 m0, s44, 18432
    s_add_u32 s46, s40, 32768
    buffer_load_dwordx4 v5, s[12:15], s46 offen lds
    v_mfma_f32_16x16x32_bf16 v[20:23], v[116:119], v[140:143], v[20:23]
    ds_read_b64_tr_b16 v[128:129], v11 offset:20480
    ds_read_b64_tr_b16 v[130:131], v11 offset:20992
    s_add_u32 m0, s44, 19456
    s_add_u32 s46, s40, 49152
    buffer_load_dwordx4 v6, s[12:15], s46 offen lds
    v_mfma_f32_16x16x32_bf16 v[36:39], v[116:119], v[144:147], v[36:39]
    ds_read_b128 v[64:67], v2 offset:34816
    s_add_u32 m0, s45, 90112
    s_add_u32 s46, s41, 2048
    buffer_load_dwordx4 v8, s[16:19], s46 offen lds
    v_mfma_f32_16x16x32_bf16 v[24:27], v[112:115], v[140:143], v[24:27]
    ds_read_b64_tr_b16 v[136:137], v12 offset:20480
    ds_read_b64_tr_b16 v[138:139], v12 offset:20992
    s_add_u32 m0, s43, 90112
    s_add_u32 s46, s41, 2048
    buffer_load_dwordx4 v9, s[16:19], s46 offen lds
    v_mfma_f32_16x16x32_bf16 v[40:43], v[112:115], v[144:147], v[40:43]
    ds_read_b128 v[80:83], v3 offset:32768
    s_add_u32 m0, s45, 98304
    s_add_u32 s46, s41, 4096
    buffer_load_dwordx4 v8, s[16:19], s46 offen lds
    v_mfma_f32_16x16x32_bf16 v[28:31], v[120:123], v[140:143], v[28:31]
    ds_read_b64_tr_b16 v[116:117], v13 offset:20480
    ds_read_b64_tr_b16 v[118:119], v13 offset:20992
    s_add_u32 m0, s43, 98304
    s_add_u32 s46, s41, 4096
    buffer_load_dwordx4 v9, s[16:19], s46 offen lds
    v_mfma_f32_16x16x32_bf16 v[44:47], v[120:123], v[144:147], v[44:47]
    ds_read_b128 v[112:115], v3 offset:34816
    s_waitcnt vmcnt(16) lgkmcnt(0)
    s_barrier
    s_bfe_u32 s40, s95, 0x40018
    s_add_u32 s40, s89, s40
    s_and_b32 s40, s40, 15
    s_mul_i32 s41, s40, 393216
    s_lshl_b32 s40, s40, 7
    s_add_u32 s40, s40, s36
    s_add_u32 s42, s41, s47
    s_add_u32 s41, s41, s38
    s_add_u32 m0, s44, 32768
    s_add_u32 s46, s40, 0
    buffer_load_dwordx4 v5, s[12:15], s46 offen lds
    v_mfma_f32_16x16x32_bf16 v[16:19], v[156:159], v[160:163], v[16:19]
    ds_read_b128 v[140:143], v2 offset:49152
    s_add_u32 m0, s44, 33792
    s_add_u32 s46, s40, 16384
    buffer_load_dwordx4 v6, s[12:15], s46 offen lds
    v_mfma_f32_16x16x32_bf16 v[32:35], v[156:159], v[72:75], v[32:35]
    ds_read_b128 v[120:123], v2 offset:51200
    s_add_u32 m0, s44, 34816
    s_add_u32 s46, s40, 32768
    buffer_load_dwordx4 v5, s[12:15], s46 offen lds
    v_mfma_f32_16x16x32_bf16 v[20:23], v[128:131], v[160:163], v[20:23]
    ds_read_b128 v[144:147], v3 offset:49152
    s_add_u32 m0, s44, 35840
    s_add_u32 s46, s40, 49152
    buffer_load_dwordx4 v6, s[12:15], s46 offen lds
    v_mfma_f32_16x16x32_bf16 v[36:39], v[128:131], v[72:75], v[36:39]
    ds_read_b128 v[156:159], v3 offset:51200
    s_add_u32 m0, s45, 106496
    s_add_u32 s46, s41, 2048
    buffer_load_dwordx4 v8, s[16:19], s46 offen lds
    v_mfma_f32_16x16x32_bf16 v[24:27], v[136:139], v[160:163], v[24:27]
    s_add_u32 m0, s43, 106496
    s_add_u32 s46, s41, 2048
    buffer_load_dwordx4 v9, s[16:19], s46 offen lds
    v_mfma_f32_16x16x32_bf16 v[40:43], v[136:139], v[72:75], v[40:43]
    s_add_u32 m0, s45, 114688
    s_add_u32 s46, s41, 4096
    buffer_load_dwordx4 v8, s[16:19], s46 offen lds
    v_mfma_f32_16x16x32_bf16 v[28:31], v[116:119], v[160:163], v[28:31]
    s_add_u32 m0, s43, 114688
    s_add_u32 s46, s41, 4096
    buffer_load_dwordx4 v9, s[16:19], s46 offen lds
    v_mfma_f32_16x16x32_bf16 v[44:47], v[116:119], v[72:75], v[44:47]
    s_waitcnt vmcnt(16) lgkmcnt(0)
    s_barrier
    s_bfe_u32 s40, s95, 0x4001c
    s_add_u32 s40, s89, s40
    s_and_b32 s40, s40, 15
    s_mul_i32 s41, s40, 393216
    s_lshl_b32 s40, s40, 7
    s_add_u32 s40, s40, s36
    s_add_u32 s42, s41, s47
    s_add_u32 s41, s41, s38
    s_add_u32 m0, s44, 49152
    s_add_u32 s46, s40, 0
    buffer_load_dwordx4 v5, s[12:15], s46 offen lds
    s_add_u32 m0, s44, 50176
    s_add_u32 s46, s40, 16384
    buffer_load_dwordx4 v6, s[12:15], s46 offen lds
    s_add_u32 m0, s44, 51200
    s_add_u32 s46, s40, 32768
    buffer_load_dwordx4 v5, s[12:15], s46 offen lds
    s_add_u32 m0, s44, 52224
    s_add_u32 s46, s40, 49152
    buffer_load_dwordx4 v6, s[12:15], s46 offen lds
    s_add_u32 m0, s45, 65536
    s_add_u32 s46, s41, 2048
    buffer_load_dwordx4 v8, s[16:19], s46 offen lds
    s_add_u32 m0, s43, 65536
    s_add_u32 s46, s41, 2048
    buffer_load_dwordx4 v9, s[16:19], s46 offen lds
    s_add_u32 m0, s45, 122880
    s_add_u32 s46, s41, 4096
    buffer_load_dwordx4 v8, s[16:19], s46 offen lds
    s_add_u32 m0, s43, 122880
    s_add_u32 s46, s41, 4096
    buffer_load_dwordx4 v9, s[16:19], s46 offen lds
    s_waitcnt vmcnt(16)
    s_barrier
    s_bfe_u32 s40, s94, 0x40018
    s_add_u32 s40, s89, s40
    s_and_b32 s40, s40, 15
    s_mul_i32 s41, s40, 393216
    s_lshl_b32 s40, s40, 7
    s_add_u32 s40, s40, s36
    s_add_u32 s42, s41, s47
    s_add_u32 s41, s41, s38
    s_add_u32 m0, s45, 147456
    s_nop 0
    buffer_load_dwordx4 v8, s[16:19], s42 offen lds
    s_add_u32 m0, s43, 147456
    s_nop 0
    buffer_load_dwordx4 v9, s[16:19], s42 offen lds
    s_waitcnt vmcnt(10)
    s_barrier
    s_bfe_u32 s40, s95, 0x40010
    s_add_u32 s40, s89, s40
    s_and_b32 s40, s40, 15
    s_mul_i32 s41, s40, 393216
    s_lshl_b32 s40, s40, 7
    s_add_u32 s40, s40, s36
    s_add_u32 s42, s41, s47
    s_add_u32 s41, s41, s38
    s_add_u32 m0, s45, 139264
    s_nop 0
    buffer_load_dwordx4 v8, s[16:19], s42 offen lds
    s_add_u32 m0, s43, 139264
    s_nop 0
    buffer_load_dwordx4 v9, s[16:19], s42 offen lds
    s_waitcnt vmcnt(4)
    s_barrier
    s_bfe_u32 s40, s95, 0x40014
    s_add_u32 s40, s89, s40
    s_and_b32 s40, s40, 15
    s_mul_i32 s41, s40, 393216
    s_lshl_b32 s40, s40, 7
    s_add_u32 s40, s40, s36
    s_add_u32 s42, s41, s47
    s_add_u32 s41, s41, s38
    s_add_u32 m0, s45, 131072
    s_nop 0
    buffer_load_dwordx4 v8, s[16:19], s42 offen lds
    s_add_u32 m0, s43, 131072
    s_nop 0
    buffer_load_dwordx4 v9, s[16:19], s42 offen lds
    s_setprio 1
    v_and_b32 v14, 15, v0
    v_lshlrev_b32 v14, 2, v14
    s_lshl_b32 s50, s3, 7
    s_add_u32 s50, s50, 155648
    v_add_u32 v14, s50, v14
    v_and_b32 v15, 0x30, v0
    v_add_u32 v15, 158208, v15
    v_and_b32 v165, 0xfffffff7, v1

    ds_read_b32 v7, v165 offset:48
FW_1:
    s_waitcnt lgkmcnt(0)
    v_cmp_gt_u32 vcc, 1, v7
    s_cbranch_vccz FO_2
    s_sleep 1
    ds_read_b32 v7, v165 offset:48
    s_branch FW_1
FO_2:
    ds_read2_b32 v[72:73], v14 offset0:0 offset1:0
    ds_read2_b32 v[74:75], v14 offset0:16 offset1:16
    ds_read_b128 v[128:131], v15 offset:0
    ds_read_b128 v[136:139], v15 offset:64
    ds_read_b128 v[160:163], v15 offset:128
    ds_read_b128 v[116:119], v15 offset:192
    v_add_u32 v14, 1024, v14
    s_waitcnt lgkmcnt(3)
    v_fmac_f32 v16, v128, v72
    v_fmac_f32 v17, v129, v72
    v_fmac_f32 v18, v130, v72
    v_fmac_f32 v19, v131, v72
    v_fmac_f32 v32, v128, v74
    s_branch IW_s1
IW_w1:
    s_branch IW_r1
IW_s1:
    v_fmac_f32 v33, v129, v74
    v_fmac_f32 v34, v130, v74
    v_fmac_f32 v35, v131, v74
    s_waitcnt lgkmcnt(2)
    v_fmac_f32 v20, v136, v72
    v_fmac_f32 v21, v137, v72
    v_fmac_f32 v22, v138, v72
    v_fmac_f32 v23, v139, v72
    v_fmac_f32 v36, v136, v74
    v_fmac_f32 v37, v137, v74
    v_fmac_f32 v38, v138, v74
    v_fmac_f32 v39, v139, v74
    s_waitcnt lgkmcnt(1)
    v_fmac_f32 v24, v160, v72
    v_fmac_f32 v25, v161, v72
    v_fmac_f32 v26, v162, v72
    v_fmac_f32 v27, v163, v72
    v_fmac_f32 v40, v160, v74
    v_fmac_f32 v41, v161, v74
    v_fmac_f32 v42, v162, v74
    v_fmac_f32 v43, v163, v74
    s_waitcnt lgkmcnt(0)
    v_fmac_f32 v28, v116, v72
    v_fmac_f32 v29, v117, v72
    v_fmac_f32 v30, v118, v72
    v_fmac_f32 v31, v119, v72
    v_fmac_f32 v44, v116, v74
    v_fmac_f32 v45, v117, v74
    v_fmac_f32 v46, v118, v74
    v_fmac_f32 v47, v119, v74
    s_setprio 3
    s_waitcnt vmcnt(6)
    s_barrier
    s_bfe_u32 s40, s95, 0x40018
    s_add_u32 s40, s89, s40
    s_and_b32 s40, s40, 15
    s_mul_i32 s41, s40, 393216
    s_lshl_b32 s40, s40, 7
    s_add_u32 s40, s40, s36
    s_add_u32 s42, s41, s47
    s_add_u32 s41, s41, s38
    s_add_u32 m0, s45, 81920
    s_nop 0
    buffer_load_dwordx4 v8, s[16:19], s42 offen lds
    s_add_u32 m0, s43, 81920
    s_nop 0
    buffer_load_dwordx4 v9, s[16:19], s42 offen lds
    s_bfe_u32 s40, s95, 0x4001c
    s_add_u32 s40, s89, s40
    s_and_b32 s40, s40, 15
    s_mul_i32 s41, s40, 393216
    s_lshl_b32 s40, s40, 7
    s_add_u32 s40, s40, s36
    s_add_u32 s42, s41, s47
    s_add_u32 s41, s41, s38
    s_add_u32 m0, s45, 73728
    s_nop 0
    buffer_load_dwordx4 v8, s[16:19], s42 offen lds
    s_add_u32 m0, s43, 73728
    s_nop 0
    buffer_load_dwordx4 v9, s[16:19], s42 offen lds
    s_bfe_u32 s40, s94, 0x4001c
    s_add_u32 s40, s89, s40
    s_and_b32 s40, s40, 15
    s_mul_i32 s41, s40, 393216
    s_lshl_b32 s40, s40, 7
    s_add_u32 s40, s40, s36
    s_add_u32 s42, s41, s47
    s_add_u32 s41, s41, s38
    s_add_u32 m0, s45, 98304
    s_nop 0
    buffer_load_dwordx4 v8, s[16:19], s42 offen lds
    s_add_u32 m0, s43, 98304
    s_nop 0
    buffer_load_dwordx4 v9, s[16:19], s42 offen lds
    s_bfe_u32 s40, s95, 0x40000
    s_add_u32 s40, s89, s40
    s_and_b32 s40, s40, 15
    s_mul_i32 s41, s40, 393216
    s_lshl_b32 s40, s40, 7
    s_add_u32 s40, s40, s36
    s_add_u32 s42, s41, s47
    s_add_u32 s41, s41, s38
    s_add_u32 m0, s45, 90112
    s_nop 0
    buffer_load_dwordx4 v8, s[16:19], s42 offen lds
    s_add_u32 m0, s43, 90112
    s_nop 0
    buffer_load_dwordx4 v9, s[16:19], s42 offen lds
    s_bfe_u32 s40, s95, 0x40004
    s_add_u32 s40, s89, s40
    s_and_b32 s40, s40, 15
    s_mul_i32 s41, s40, 393216
    s_lshl_b32 s40, s40, 7
    s_add_u32 s40, s40, s36
    s_add_u32 s42, s41, s47
    s_add_u32 s41, s41, s38
    s_add_u32 m0, s45, 114688
    s_nop 0
    buffer_load_dwordx4 v8, s[16:19], s42 offen lds
    s_add_u32 m0, s43, 114688
    s_nop 0
    buffer_load_dwordx4 v9, s[16:19], s42 offen lds
    s_bfe_u32 s40, s95, 0x40008
    s_add_u32 s40, s89, s40
    s_and_b32 s40, s40, 15
    s_mul_i32 s41, s40, 393216
    s_lshl_b32 s40, s40, 7
    s_add_u32 s40, s40, s36
    s_add_u32 s42, s41, s47
    s_add_u32 s41, s41, s38
    s_add_u32 m0, s45, 106496
    s_nop 0
    buffer_load_dwordx4 v8, s[16:19], s42 offen lds
    s_add_u32 m0, s43, 106496
    s_nop 0
    buffer_load_dwordx4 v9, s[16:19], s42 offen lds
    s_bfe_u32 s40, s95, 0x4000c
    s_add_u32 s40, s89, s40
    s_and_b32 s40, s40, 15
    s_mul_i32 s41, s40, 393216
    s_lshl_b32 s40, s40, 7
    s_add_u32 s40, s40, s36
    s_add_u32 s42, s41, s47
    s_add_u32 s41, s41, s38
    s_add_u32 m0, s45, 122880
    s_nop 0
    buffer_load_dwordx4 v8, s[16:19], s42 offen lds
    s_add_u32 m0, s43, 122880
    s_nop 0
    buffer_load_dwordx4 v9, s[16:19], s42 offen lds
    s_setprio 2
    v_subrev_u32 v5, 24576, v10
    v_subrev_u32 v6, 24576, v11
    v_subrev_u32 v8, 24576, v12
    v_subrev_u32 v9, 24576, v13
    s_add_u32 s16, s72, 0x400000
    s_addc_u32 s17, s73, 0
    s_mov_b32 s18, 0x400000
    s_mov_b32 s19, 0x00020000
    s_add_u32 s24, s72, 0x800000
    s_addc_u32 s25, s73, 0
    s_mov_b32 s26, 0x48000
    s_mov_b32 s27, 0x00020000
    s_mov_b32 s40, 0x21317218
    s_mov_b32 s41, s40
    s_mov_b32 s74, 0x358637bd
    s_mov_b32 s75, s74
    s_mov_b32 s76, 0x5d800000
    s_mov_b32 s77, s76
    s_lshl_b32 s79, s32, 18
    s_lshl_b32 s80, s3, 16
    s_add_u32 s79, s79, s80
    s_lshl_b32 s80, s10, 11
    s_add_u32 s79, s79, s80
    s_add_u32 s80, s79, 0x8000
    s_lshl_b32 s45, s32, 2
    s_add_u32 s45, s45, s3
    s_lshl_b32 s45, s45, 10
    s_mov_b32 s46, 0x3fb8aa3b

    s_add_u32 s54, s45, 0x835000
    s_add_u32 s54, s72, s54
    s_addc_u32 s55, s73, 0
    s_waitcnt vmcnt(8)
    s_mov_b64 exec, 1
    ds_add_u32 v4, v164 offset:112
    s_mov_b64 exec, -1
    ds_read_b32 v7, v1 offset:32
FW_3:
    s_waitcnt lgkmcnt(0)
    v_cmp_gt_u32 vcc, 1, v7
    s_cbranch_vccz FO_4
    s_sleep 2
    ds_read_b32 v7, v1 offset:32
    s_branch FW_3
FO_4:
    ds_read_b32 v7, v1 offset:112
FW_5:
    s_waitcnt lgkmcnt(0)
    v_cmp_gt_u32 vcc, 1, v7
    s_cbranch_vccz FO_6
    ds_read_b32 v7, v1 offset:112
    s_branch FW_5
FO_6:
    ds_read_b64_tr_b16 v[128:129], v10 offset:57344
    ds_read_b64_tr_b16 v[130:131], v10 offset:57856
    ds_read_b64_tr_b16 v[136:137], v11 offset:57344
    ds_read_b64_tr_b16 v[138:139], v11 offset:57856
    ds_read_b64_tr_b16 v[160:161], v12 offset:57344
    ds_read_b64_tr_b16 v[162:163], v12 offset:57856
    ds_read_b64_tr_b16 v[116:117], v13 offset:57344
    ds_read_b64_tr_b16 v[118:119], v13 offset:57856
    ds_read_b64_tr_b16 v[72:73], v10 offset:61440
    ds_read_b64_tr_b16 v[74:75], v10 offset:61952
    s_waitcnt lgkmcnt(8)
    v_mfma_f32_16x16x32_bf16 v[16:19], v[128:131], v[48:51], v[16:19]
    v_mfma_f32_16x16x32_bf16 v[32:35], v[128:131], v[52:55], v[32:35]
    ds_read_b64_tr_b16 v[128:129], v11 offset:61440
    ds_read_b64_tr_b16 v[130:131], v11 offset:61952
    s_waitcnt lgkmcnt(8)
    v_mfma_f32_16x16x32_bf16 v[20:23], v[136:139], v[48:51], v[20:23]
    v_mfma_f32_16x16x32_bf16 v[36:39], v[136:139], v[52:55], v[36:39]
    ds_read_b64_tr_b16 v[136:137], v12 offset:61440
    ds_read_b64_tr_b16 v[138:139], v12 offset:61952
    s_waitcnt lgkmcnt(8)
    v_mfma_f32_16x16x32_bf16 v[24:27], v[160:163], v[48:51], v[24:27]
    v_mfma_f32_16x16x32_bf16 v[40:43], v[160:163], v[52:55], v[40:43]
    ds_read_b64_tr_b16 v[160:161], v13 offset:61440
    ds_read_b64_tr_b16 v[162:163], v13 offset:61952
    s_waitcnt lgkmcnt(8)
    v_mfma_f32_16x16x32_bf16 v[28:31], v[116:119], v[48:51], v[28:31]
    ds_read_b128 v[48:51], v2 offset:0
    v_mfma_f32_16x16x32_bf16 v[44:47], v[116:119], v[52:55], v[44:47]
    ds_read_b64_tr_b16 v[116:117], v10 offset:49152
    ds_read_b64_tr_b16 v[118:119], v10 offset:49664
    s_waitcnt lgkmcnt(9)
    v_mfma_f32_16x16x32_bf16 v[16:19], v[72:75], v[96:99], v[16:19]
    ds_read_b128 v[52:55], v2 offset:2048
    v_mfma_f32_16x16x32_bf16 v[32:35], v[72:75], v[104:107], v[32:35]
    ds_read_b64_tr_b16 v[72:73], v11 offset:49152
    ds_read_b64_tr_b16 v[74:75], v11 offset:49664
    s_waitcnt lgkmcnt(10)
    v_mfma_f32_16x16x32_bf16 v[20:23], v[128:131], v[96:99], v[20:23]
    v_mfma_f32_16x16x32_bf16 v[36:39], v[128:131], v[104:107], v[36:39]
    ds_read_b64_tr_b16 v[128:129], v12 offset:49152
    ds_read_b64_tr_b16 v[130:131], v12 offset:49664
    s_waitcnt lgkmcnt(10)
    v_mfma_f32_16x16x32_bf16 v[24:27], v[136:139], v[96:99], v[24:27]
    v_mfma_f32_16x16x32_bf16 v[40:43], v[136:139], v[104:107], v[40:43]
    ds_read_b64_tr_b16 v[136:137], v13 offset:49152
    ds_read_b64_tr_b16 v[138:139], v13 offset:49664
    s_waitcnt lgkmcnt(10)
    v_mfma_f32_16x16x32_bf16 v[28:31], v[160:163], v[96:99], v[28:31]
    ds_read_b128 v[96:99], v3 offset:0
    v_mfma_f32_16x16x32_bf16 v[44:47], v[160:163], v[104:107], v[44:47]
    ds_read_b64_tr_b16 v[160:161], v10 offset:53248
    ds_read_b64_tr_b16 v[162:163], v10 offset:53760
    s_waitcnt lgkmcnt(10)
    v_mfma_f32_16x16x32_bf16 v[16:19], v[116:119], v[48:51], v[16:19]
    ds_read_b128 v[104:107], v3 offset:2048
    s_waitcnt lgkmcnt(10)
    v_mfma_f32_16x16x32_bf16 v[32:35], v[116:119], v[52:55], v[32:35]
    ds_read_b64_tr_b16 v[116:117], v11 offset:53248
    ds_read_b64_tr_b16 v[118:119], v11 offset:53760
    s_waitcnt lgkmcnt(10)
    v_mfma_f32_16x16x32_bf16 v[20:23], v[72:75], v[48:51], v[20:23]
    v_mfma_f32_16x16x32_bf16 v[36:39], v[72:75], v[52:55], v[36:39]
    ds_read_b64_tr_b16 v[72:73], v12 offset:53248
    ds_read_b64_tr_b16 v[74:75], v12 offset:53760
    s_waitcnt lgkmcnt(10)
    v_mfma_f32_16x16x32_bf16 v[24:27], v[128:131], v[48:51], v[24:27]
    v_mfma_f32_16x16x32_bf16 v[40:43], v[128:131], v[52:55], v[40:43]
    ds_read_b64_tr_b16 v[128:129], v13 offset:53248
    ds_read_b64_tr_b16 v[130:131], v13 offset:53760
    s_waitcnt lgkmcnt(10)
    v_mfma_f32_16x16x32_bf16 v[28:31], v[136:139], v[48:51], v[28:31]
    ds_read_b128 v[48:51], v2 offset:16384
    v_mfma_f32_16x16x32_bf16 v[44:47], v[136:139], v[52:55], v[44:47]
    ds_read_b64_tr_b16 v[136:137], v10 offset:40960
    ds_read_b64_tr_b16 v[138:139], v10 offset:41472
    s_waitcnt lgkmcnt(10)
    v_mfma_f32_16x16x32_bf16 v[16:19], v[160:163], v[96:99], v[16:19]
    ds_read_b128 v[52:55], v2 offset:18432
    s_waitcnt lgkmcnt(10)
    v_mfma_f32_16x16x32_bf16 v[32:35], v[160:163], v[104:107], v[32:35]
    ds_read_b64_tr_b16 v[160:161], v11 offset:40960
    ds_read_b64_tr_b16 v[162:163], v11 offset:41472
    s_waitcnt lgkmcnt(10)
    v_mfma_f32_16x16x32_bf16 v[20:23], v[116:119], v[96:99], v[20:23]
    v_mfma_f32_16x16x32_bf16 v[36:39], v[116:119], v[104:107], v[36:39]
    ds_read_b64_tr_b16 v[116:117], v12 offset:40960
    ds_read_b64_tr_b16 v[118:119], v12 offset:41472
    s_waitcnt lgkmcnt(8)
    v_mov_b32 v165, 2
    s_mov_b64 exec, 1
    ds_write_b32 v4, v165 offset:0
    s_mov_b64 exec, -1
    v_mfma_f32_16x16x32_bf16 v[24:27], v[72:75], v[96:99], v[24:27]
    v_mfma_f32_16x16x32_bf16 v[40:43], v[72:75], v[104:107], v[40:43]
    ds_read_b64_tr_b16 v[72:73], v13 offset:40960
    ds_read_b64_tr_b16 v[74:75], v13 offset:41472
    v_mfma_f32_16x16x32_bf16 v[28:31], v[128:131], v[96:99], v[28:31]
    ds_read_b128 v[96:99], v3 offset:16384
    v_mfma_f32_16x16x32_bf16 v[44:47], v[128:131], v[104:107], v[44:47]
    ds_read_b64_tr_b16 v[128:129], v10 offset:45056
    ds_read_b64_tr_b16 v[130:131], v10 offset:45568
    s_waitcnt lgkmcnt(11)
    v_mfma_f32_16x16x32_bf16 v[16:19], v[136:139], v[48:51], v[16:19]
    ds_read_b128 v[104:107], v3 offset:18432
    s_waitcnt lgkmcnt(11)
    v_mfma_f32_16x16x32_bf16 v[32:35], v[136:139], v[52:55], v[32:35]
    ds_read_b64_tr_b16 v[136:137], v11 offset:45056
    ds_read_b64_tr_b16 v[138:139], v11 offset:45568
    s_waitcnt lgkmcnt(11)
    v_mfma_f32_16x16x32_bf16 v[20:23], v[160:163], v[48:51], v[20:23]
    v_mfma_f32_16x16x32_bf16 v[36:39], v[160:163], v[52:55], v[36:39]
    ds_read_b64_tr_b16 v[160:161], v12 offset:45056
    ds_read_b64_tr_b16 v[162:163], v12 offset:45568
    s_waitcnt lgkmcnt(11)
    v_mfma_f32_16x16x32_bf16 v[24:27], v[116:119], v[48:51], v[24:27]
    v_mfma_f32_16x16x32_bf16 v[40:43], v[116:119], v[52:55], v[40:43]
    ds_read_b64_tr_b16 v[116:117], v13 offset:45056
    ds_read_b64_tr_b16 v[118:119], v13 offset:45568
    s_waitcnt lgkmcnt(10)
    v_mfma_f32_16x16x32_bf16 v[28:31], v[72:75], v[48:51], v[28:31]
    ds_read_b128 v[48:51], v2 offset:32768
    v_mfma_f32_16x16x32_bf16 v[44:47], v[72:75], v[52:55], v[44:47]
    ds_read_b64_tr_b16 v[72:73], v5 offset:16384
    ds_read_b64_tr_b16 v[74:75], v5 offset:16896
    s_waitcnt lgkmcnt(10)
    v_mfma_f32_16x16x32_bf16 v[16:19], v[128:131], v[96:99], v[16:19]
    ds_read_b128 v[52:55], v2 offset:34816
    s_waitcnt lgkmcnt(10)
    v_mfma_f32_16x16x32_bf16 v[32:35], v[128:131], v[104:107], v[32:35]
    ds_read_b64_tr_b16 v[128:129], v6 offset:16384
    ds_read_b64_tr_b16 v[130:131], v6 offset:16896
    s_waitcnt lgkmcnt(10)
    v_mfma_f32_16x16x32_bf16 v[20:23], v[136:139], v[96:99], v[20:23]
    v_mfma_f32_16x16x32_bf16 v[36:39], v[136:139], v[104:107], v[36:39]
    ds_read_b64_tr_b16 v[136:137], v8 offset:16384
    ds_read_b64_tr_b16 v[138:139], v8 offset:16896
    s_waitcnt lgkmcnt(10)
    v_mfma_f32_16x16x32_bf16 v[24:27], v[160:163], v[96:99], v[24:27]
    v_mfma_f32_16x16x32_bf16 v[40:43], v[160:163], v[104:107], v[40:43]
    ds_read_b64_tr_b16 v[160:161], v9 offset:16384
    ds_read_b64_tr_b16 v[162:163], v9 offset:16896
    s_waitcnt lgkmcnt(10)
    v_mfma_f32_16x16x32_bf16 v[28:31], v[116:119], v[96:99], v[28:31]
    ds_read_b128 v[96:99], v3 offset:32768
    v_mfma_f32_16x16x32_bf16 v[44:47], v[116:119], v[104:107], v[44:47]
    ds_read_b64_tr_b16 v[116:117], v5 offset:20480
    ds_read_b64_tr_b16 v[118:119], v5 offset:20992
    s_waitcnt lgkmcnt(10)
    v_mfma_f32_16x16x32_bf16 v[16:19], v[72:75], v[48:51], v[16:19]
    ds_read_b128 v[104:107], v3 offset:34816
    s_waitcnt lgkmcnt(10)
    v_mfma_f32_16x16x32_bf16 v[32:35], v[72:75], v[52:55], v[32:35]
    ds_read_b64_tr_b16 v[72:73], v6 offset:20480
    ds_read_b64_tr_b16 v[74:75], v6 offset:20992
    s_waitcnt lgkmcnt(10)
    v_mfma_f32_16x16x32_bf16 v[20:23], v[128:131], v[48:51], v[20:23]
    v_mfma_f32_16x16x32_bf16 v[36:39], v[128:131], v[52:55], v[36:39]
    ds_read_b64_tr_b16 v[128:129], v8 offset:20480
    ds_read_b64_tr_b16 v[130:131], v8 offset:20992
    s_waitcnt lgkmcnt(10)
    v_mfma_f32_16x16x32_bf16 v[24:27], v[136:139], v[48:51], v[24:27]
    v_mfma_f32_16x16x32_bf16 v[40:43], v[136:139], v[52:55], v[40:43]
    ds_read_b64_tr_b16 v[136:137], v9 offset:20480
    ds_read_b64_tr_b16 v[138:139], v9 offset:20992
    s_waitcnt lgkmcnt(10)
    v_mfma_f32_16x16x32_bf16 v[28:31], v[160:163], v[48:51], v[28:31]
    s_waitcnt vmcnt(0)
    s_mov_b64 exec, 1
    ds_add_u32 v4, v164 offset:112
    s_mov_b64 exec, -1
    ds_read_b128 v[48:51], v2 offset:49152
    v_mfma_f32_16x16x32_bf16 v[44:47], v[160:163], v[52:55], v[44:47]
    ds_read_b64_tr_b16 v[160:161], v5 offset:8192
    ds_read_b64_tr_b16 v[162:163], v5 offset:8704
    s_waitcnt lgkmcnt(11)
    v_mfma_f32_16x16x32_bf16 v[16:19], v[116:119], v[96:99], v[16:19]
    ds_read_b128 v[52:55], v2 offset:51200
    s_waitcnt lgkmcnt(11)
    v_mfma_f32_16x16x32_bf16 v[32:35], v[116:119], v[104:107], v[32:35]
    ds_read_b64_tr_b16 v[116:117], v6 offset:8192
    ds_read_b64_tr_b16 v[118:119], v6 offset:8704
    s_waitcnt lgkmcnt(11)
    v_mfma_f32_16x16x32_bf16 v[20:23], v[72:75], v[96:99], v[20:23]
    v_mfma_f32_16x16x32_bf16 v[36:39], v[72:75], v[104:107], v[36:39]
    ds_read_b64_tr_b16 v[72:73], v8 offset:8192
    ds_read_b64_tr_b16 v[74:75], v8 offset:8704
    s_waitcnt lgkmcnt(9)
    v_mov_b32 v165, 4
    s_mov_b64 exec, 1
    ds_write_b32 v4, v165 offset:0
    s_mov_b64 exec, -1
    v_mfma_f32_16x16x32_bf16 v[24:27], v[128:131], v[96:99], v[24:27]
    v_mfma_f32_16x16x32_bf16 v[40:43], v[128:131], v[104:107], v[40:43]
    ds_read_b64_tr_b16 v[128:129], v9 offset:8192
    ds_read_b64_tr_b16 v[130:131], v9 offset:8704
    v_mfma_f32_16x16x32_bf16 v[28:31], v[136:139], v[96:99], v[28:31]
    ds_read_b128 v[96:99], v3 offset:49152
    v_mfma_f32_16x16x32_bf16 v[44:47], v[136:139], v[104:107], v[44:47]
    ds_read_b64_tr_b16 v[136:137], v5 offset:12288
    ds_read_b64_tr_b16 v[138:139], v5 offset:12800
    s_waitcnt lgkmcnt(11)
    v_mfma_f32_16x16x32_bf16 v[16:19], v[160:163], v[48:51], v[16:19]
    ds_read_b128 v[104:107], v3 offset:51200
    s_waitcnt lgkmcnt(11)
    v_mfma_f32_16x16x32_bf16 v[32:35], v[160:163], v[52:55], v[32:35]
    ds_read_b64_tr_b16 v[160:161], v6 offset:12288
    ds_read_b64_tr_b16 v[162:163], v6 offset:12800
    s_waitcnt lgkmcnt(11)
    v_mfma_f32_16x16x32_bf16 v[20:23], v[116:119], v[48:51], v[20:23]
    v_mfma_f32_16x16x32_bf16 v[36:39], v[116:119], v[52:55], v[36:39]
    ds_read_b64_tr_b16 v[116:117], v8 offset:12288
    ds_read_b64_tr_b16 v[118:119], v8 offset:12800
    s_waitcnt lgkmcnt(11)
    v_mfma_f32_16x16x32_bf16 v[24:27], v[72:75], v[48:51], v[24:27]
    v_mfma_f32_16x16x32_bf16 v[40:43], v[72:75], v[52:55], v[40:43]
    ds_read_b64_tr_b16 v[72:73], v9 offset:12288
    ds_read_b64_tr_b16 v[74:75], v9 offset:12800
    s_waitcnt lgkmcnt(10)
    v_mfma_f32_16x16x32_bf16 v[28:31], v[128:131], v[48:51], v[28:31]
    ds_read_b64_tr_b16 v[48:49], v10 offset:8192
    v_mfma_f32_16x16x32_bf16 v[44:47], v[128:131], v[52:55], v[44:47]
    ds_read_b64_tr_b16 v[50:51], v10 offset:8704
    ds_read_b64_tr_b16 v[128:129], v11 offset:8192
    s_waitcnt lgkmcnt(10)
    v_mfma_f32_16x16x32_bf16 v[16:19], v[136:139], v[96:99], v[16:19]
    ds_read_b64_tr_b16 v[130:131], v11 offset:8704
    s_waitcnt lgkmcnt(10)
    v_mfma_f32_16x16x32_bf16 v[32:35], v[136:139], v[104:107], v[32:35]
    ds_read_b64_tr_b16 v[52:53], v12 offset:8192
    ds_read_b64_tr_b16 v[54:55], v12 offset:8704
    s_waitcnt lgkmcnt(10)
    v_mfma_f32_16x16x32_bf16 v[20:23], v[160:163], v[96:99], v[20:23]
    ds_read_b64_tr_b16 v[136:137], v13 offset:8192
    v_mfma_f32_16x16x32_bf16 v[36:39], v[160:163], v[104:107], v[36:39]
    ds_read_b64_tr_b16 v[138:139], v13 offset:8704
    ds_read_b64_tr_b16 v[160:161], v10 offset:12288
    s_waitcnt lgkmcnt(9)
    v_mov_b32 v165, 5
    s_mov_b64 exec, 1
    ds_write_b32 v4, v165 offset:0
    s_mov_b64 exec, -1
    v_mfma_f32_16x16x32_bf16 v[24:27], v[116:119], v[96:99], v[24:27]
    ds_read_b64_tr_b16 v[162:163], v10 offset:12800
    v_mfma_f32_16x16x32_bf16 v[40:43], v[116:119], v[104:107], v[40:43]
    ds_read_b64_tr_b16 v[116:117], v11 offset:12288
    ds_read_b64_tr_b16 v[118:119], v11 offset:12800
    v_mfma_f32_16x16x32_bf16 v[28:31], v[72:75], v[96:99], v[28:31]
    ds_read_b64_tr_b16 v[96:97], v12 offset:12288
    v_mfma_f32_16x16x32_bf16 v[44:47], v[72:75], v[104:107], v[44:47]
    ds_read_b64_tr_b16 v[98:99], v12 offset:12800
    s_waitcnt lgkmcnt(8)
    ds_read_b64_tr_b16 v[72:73], v13 offset:12288
    s_waitcnt lgkmcnt(14)
    v_mfma_f32_16x16x32_bf16 v[16:19], v[48:51], v[60:63], v[16:19]
    ds_read_b64_tr_b16 v[74:75], v13 offset:12800
    v_mfma_f32_16x16x32_bf16 v[32:35], v[48:51], v[132:135], v[32:35]
    ds_read_b32 v7, v1 offset:112
FW_7:
    s_waitcnt lgkmcnt(0)
    v_cmp_gt_u32 vcc, 2, v7
    s_cbranch_vccz FO_8
    ds_read_b32 v7, v1 offset:112
    s_branch FW_7
FO_8:
    ds_read_b64_tr_b16 v[104:105], v10 offset:0
    ds_read_b64_tr_b16 v[106:107], v10 offset:512
    v_mfma_f32_16x16x32_bf16 v[20:23], v[128:131], v[60:63], v[20:23]
    ds_read_b64_tr_b16 v[48:49], v11 offset:0
    v_mfma_f32_16x16x32_bf16 v[36:39], v[128:131], v[132:135], v[36:39]
    ds_read_b64_tr_b16 v[50:51], v11 offset:512
    ds_read_b64_tr_b16 v[128:129], v12 offset:0
    v_mfma_f32_16x16x32_bf16 v[24:27], v[52:55], v[60:63], v[24:27]
    ds_read_b64_tr_b16 v[130:131], v12 offset:512
    v_mfma_f32_16x16x32_bf16 v[40:43], v[52:55], v[132:135], v[40:43]
    ds_read_b64_tr_b16 v[52:53], v13 offset:0
    ds_read_b64_tr_b16 v[54:55], v13 offset:512
    v_mfma_f32_16x16x32_bf16 v[28:31], v[136:139], v[60:63], v[28:31]
    v_mfma_f32_16x16x32_bf16 v[44:47], v[136:139], v[132:135], v[44:47]
    v_mfma_f32_16x16x32_bf16 v[16:19], v[160:163], v[68:71], v[16:19]
    ds_read_b64_tr_b16 v[60:61], v10 offset:4096
    v_mfma_f32_16x16x32_bf16 v[32:35], v[160:163], v[152:155], v[32:35]
    ds_read_b64_tr_b16 v[62:63], v10 offset:4608
    ds_read_b64_tr_b16 v[136:137], v11 offset:4096
    v_mfma_f32_16x16x32_bf16 v[20:23], v[116:119], v[68:71], v[20:23]
    ds_read_b64_tr_b16 v[138:139], v11 offset:4608
    v_mfma_f32_16x16x32_bf16 v[36:39], v[116:119], v[152:155], v[36:39]
    ds_read_b64_tr_b16 v[132:133], v12 offset:4096
    ds_read_b64_tr_b16 v[134:135], v12 offset:4608
    v_mfma_f32_16x16x32_bf16 v[24:27], v[96:99], v[68:71], v[24:27]
    ds_read_b64_tr_b16 v[160:161], v13 offset:4096
    v_mfma_f32_16x16x32_bf16 v[40:43], v[96:99], v[152:155], v[40:43]
    s_waitcnt lgkmcnt(8)
    ds_read_b64_tr_b16 v[162:163], v13 offset:4608
    v_mfma_f32_16x16x32_bf16 v[28:31], v[72:75], v[68:71], v[28:31]
    v_mfma_f32_16x16x32_bf16 v[44:47], v[72:75], v[152:155], v[44:47]
    s_waitcnt lgkmcnt(14)
    v_mfma_f32_16x16x32_bf16 v[16:19], v[104:107], v[84:87], v[16:19]
    ds_read_b64_tr_b16 v[116:117], v10 offset:24576
    v_mfma_f32_16x16x32_bf16 v[32:35], v[104:107], v[92:95], v[32:35]
    ds_read_b64_tr_b16 v[118:119], v10 offset:25088
    ds_read_b64_tr_b16 v[96:97], v11 offset:24576
    s_waitcnt lgkmcnt(15)
    v_mfma_f32_16x16x32_bf16 v[20:23], v[48:51], v[84:87], v[20:23]
    ds_read_b64_tr_b16 v[98:99], v11 offset:25088
    s_waitcnt lgkmcnt(4)
    v_mov_b32 v165, 7
    s_mov_b64 exec, 1
    ds_write_b32 v4, v165 offset:0
    s_mov_b64 exec, -1
    v_mfma_f32_16x16x32_bf16 v[36:39], v[48:51], v[92:95], v[36:39]
    ds_read_b64_tr_b16 v[68:69], v12 offset:24576
    ds_read_b64_tr_b16 v[70:71], v12 offset:25088
    v_mfma_f32_16x16x32_bf16 v[24:27], v[128:131], v[84:87], v[24:27]
    ds_read_b64_tr_b16 v[72:73], v13 offset:24576
    v_mfma_f32_16x16x32_bf16 v[40:43], v[128:131], v[92:95], v[40:43]
    ds_read_b64_tr_b16 v[74:75], v13 offset:25088
    v_mfma_f32_16x16x32_bf16 v[28:31], v[52:55], v[84:87], v[28:31]
    v_mfma_f32_16x16x32_bf16 v[44:47], v[52:55], v[92:95], v[44:47]
    v_mfma_f32_16x16x32_bf16 v[16:19], v[60:63], v[100:103], v[16:19]
    ds_read_b64_tr_b16 v[152:153], v10 offset:28672
    v_mfma_f32_16x16x32_bf16 v[32:35], v[60:63], v[108:111], v[32:35]
    ds_read_b64_tr_b16 v[154:155], v10 offset:29184
    ds_read_b64_tr_b16 v[104:105], v11 offset:28672
    v_mfma_f32_16x16x32_bf16 v[20:23], v[136:139], v[100:103], v[20:23]
    ds_read_b64_tr_b16 v[106:107], v11 offset:29184
    v_mfma_f32_16x16x32_bf16 v[36:39], v[136:139], v[108:111], v[36:39]
    ds_read_b64_tr_b16 v[48:49], v12 offset:28672
    ds_read_b64_tr_b16 v[50:51], v12 offset:29184
    v_mfma_f32_16x16x32_bf16 v[24:27], v[132:135], v[100:103], v[24:27]
    s_waitcnt lgkmcnt(8)
    ds_read_b64_tr_b16 v[128:129], v13 offset:28672
    v_mfma_f32_16x16x32_bf16 v[40:43], v[132:135], v[108:111], v[40:43]
    ds_read_b64_tr_b16 v[130:131], v13 offset:29184
    v_mfma_f32_16x16x32_bf16 v[28:31], v[160:163], v[100:103], v[28:31]
    v_mfma_f32_16x16x32_bf16 v[44:47], v[160:163], v[108:111], v[44:47]
    s_waitcnt lgkmcnt(15)
    v_mfma_f32_16x16x32_bf16 v[16:19], v[116:119], v[56:59], v[16:19]
    ds_read_b64_tr_b16 v[84:85], v10 offset:16384
    v_mfma_f32_16x16x32_bf16 v[32:35], v[116:119], v[124:127], v[32:35]
    ds_read_b64_tr_b16 v[86:87], v10 offset:16896
    ds_read_b64_tr_b16 v[52:53], v11 offset:16384
    s_waitcnt lgkmcnt(15)
    v_mfma_f32_16x16x32_bf16 v[20:23], v[96:99], v[56:59], v[20:23]
    ds_read_b64_tr_b16 v[54:55], v11 offset:16896
    v_mfma_f32_16x16x32_bf16 v[36:39], v[96:99], v[124:127], v[36:39]
    ds_read_b64_tr_b16 v[92:93], v12 offset:16384
    s_waitcnt lgkmcnt(8)
    ds_read_b64_tr_b16 v[94:95], v12 offset:16896
    s_waitcnt lgkmcnt(15)
    v_mfma_f32_16x16x32_bf16 v[24:27], v[68:71], v[56:59], v[24:27]
    ds_read_b64_tr_b16 v[60:61], v13 offset:16384
    v_mfma_f32_16x16x32_bf16 v[40:43], v[68:71], v[124:127], v[40:43]
    ds_read_b64_tr_b16 v[62:63], v13 offset:16896
    s_waitcnt lgkmcnt(15)
    v_mfma_f32_16x16x32_bf16 v[28:31], v[72:75], v[56:59], v[28:31]
    v_mfma_f32_16x16x32_bf16 v[44:47], v[72:75], v[124:127], v[44:47]
    s_waitcnt lgkmcnt(14)
    v_mfma_f32_16x16x32_bf16 v[16:19], v[152:155], v[76:79], v[16:19]
    ds_read_b64_tr_b16 v[136:137], v10 offset:20480
    v_mfma_f32_16x16x32_bf16 v[32:35], v[152:155], v[148:151], v[32:35]
    ds_read_b64_tr_b16 v[138:139], v10 offset:20992
    ds_read_b64_tr_b16 v[132:133], v11 offset:20480
    s_waitcnt lgkmcnt(15)
    v_mfma_f32_16x16x32_bf16 v[20:23], v[104:107], v[76:79], v[20:23]
    ds_read_b64_tr_b16 v[134:135], v11 offset:20992
    v_mfma_f32_16x16x32_bf16 v[36:39], v[104:107], v[148:151], v[36:39]
    s_waitcnt lgkmcnt(8)
    ds_read_b64_tr_b16 v[100:101], v12 offset:20480
    ds_read_b64_tr_b16 v[102:103], v12 offset:20992
    s_waitcnt lgkmcnt(15)
    v_mfma_f32_16x16x32_bf16 v[24:27], v[48:51], v[76:79], v[24:27]
    ds_read_b64_tr_b16 v[160:161], v13 offset:20480
    v_mfma_f32_16x16x32_bf16 v[40:43], v[48:51], v[148:151], v[40:43]
    ds_read_b64_tr_b16 v[162:163], v13 offset:20992
    s_waitcnt lgkmcnt(15)
    v_mfma_f32_16x16x32_bf16 v[28:31], v[128:131], v[76:79], v[28:31]
    v_mfma_f32_16x16x32_bf16 v[44:47], v[128:131], v[148:151], v[44:47]
    s_waitcnt lgkmcnt(14)
    v_mfma_f32_16x16x32_bf16 v[16:19], v[84:87], v[88:91], v[16:19]
    ds_read_b64_tr_b16 v[108:109], v10 offset:32768
    v_mfma_f32_16x16x32_bf16 v[32:35], v[84:87], v[64:67], v[32:35]
    ds_read_b64_tr_b16 v[110:111], v10 offset:33280
    ds_read_b64_tr_b16 v[116:117], v11 offset:32768
    s_waitcnt lgkmcnt(15)
    v_mfma_f32_16x16x32_bf16 v[20:23], v[52:55], v[88:91], v[20:23]
    s_waitcnt lgkmcnt(8)
    ds_read_b64_tr_b16 v[118:119], v11 offset:33280
    v_mfma_f32_16x16x32_bf16 v[36:39], v[52:55], v[64:67], v[36:39]
    ds_read_b64_tr_b16 v[96:97], v12 offset:32768
    ds_read_b64_tr_b16 v[98:99], v12 offset:33280
    s_waitcnt lgkmcnt(15)
    v_mfma_f32_16x16x32_bf16 v[24:27], v[92:95], v[88:91], v[24:27]
    ds_read_b64_tr_b16 v[68:69], v13 offset:32768
    v_mfma_f32_16x16x32_bf16 v[40:43], v[92:95], v[64:67], v[40:43]
    ds_read_b64_tr_b16 v[70:71], v13 offset:33280
    s_waitcnt lgkmcnt(15)
    v_mfma_f32_16x16x32_bf16 v[28:31], v[60:63], v[88:91], v[28:31]
    v_mfma_f32_16x16x32_bf16 v[44:47], v[60:63], v[64:67], v[44:47]
    s_waitcnt lgkmcnt(14)
    v_mfma_f32_16x16x32_bf16 v[16:19], v[136:139], v[80:83], v[16:19]
    ds_read_b64_tr_b16 v[56:57], v10 offset:36864
    v_mfma_f32_16x16x32_bf16 v[32:35], v[136:139], v[112:115], v[32:35]
    ds_read_b64_tr_b16 v[58:59], v10 offset:37376
    s_waitcnt lgkmcnt(8)
    ds_read_b64_tr_b16 v[72:73], v11 offset:36864
    s_waitcnt lgkmcnt(15)
    v_mfma_f32_16x16x32_bf16 v[20:23], v[132:135], v[80:83], v[20:23]
    ds_read_b64_tr_b16 v[74:75], v11 offset:37376
    v_mfma_f32_16x16x32_bf16 v[36:39], v[132:135], v[112:115], v[36:39]
    ds_read_b64_tr_b16 v[124:125], v12 offset:36864
    ds_read_b64_tr_b16 v[126:127], v12 offset:37376
    s_waitcnt lgkmcnt(15)
    v_mfma_f32_16x16x32_bf16 v[24:27], v[100:103], v[80:83], v[24:27]
    ds_read_b64_tr_b16 v[152:153], v13 offset:36864
    v_mfma_f32_16x16x32_bf16 v[40:43], v[100:103], v[112:115], v[40:43]
    ds_read_b64_tr_b16 v[154:155], v13 offset:37376
    s_waitcnt lgkmcnt(15)
    v_mfma_f32_16x16x32_bf16 v[28:31], v[160:163], v[80:83], v[28:31]
    v_mfma_f32_16x16x32_bf16 v[44:47], v[160:163], v[112:115], v[44:47]
    s_waitcnt lgkmcnt(14)
    v_mfma_f32_16x16x32_bf16 v[16:19], v[108:111], v[140:143], v[16:19]
    ds_read2_b32 v[112:113], v14 offset0:0 offset1:0
    s_waitcnt lgkmcnt(8)
    ds_read2_b32 v[114:115], v14 offset0:16 offset1:16
    v_mfma_f32_16x16x32_bf16 v[32:35], v[108:111], v[120:123], v[32:35]
    s_waitcnt lgkmcnt(14)
    v_mfma_f32_16x16x32_bf16 v[20:23], v[116:119], v[140:143], v[20:23]
    s_waitcnt lgkmcnt(2)
    v_mov_b32 v165, 10
    s_mov_b64 exec, 1
    ds_write_b32 v4, v165 offset:0
    s_mov_b64 exec, -1
    v_mfma_f32_16x16x32_bf16 v[36:39], v[116:119], v[120:123], v[36:39]
    v_mfma_f32_16x16x32_bf16 v[24:27], v[96:99], v[140:143], v[24:27]
    v_mfma_f32_16x16x32_bf16 v[40:43], v[96:99], v[120:123], v[40:43]
    v_mfma_f32_16x16x32_bf16 v[28:31], v[68:71], v[140:143], v[28:31]
    v_mfma_f32_16x16x32_bf16 v[44:47], v[68:71], v[120:123], v[44:47]
    v_mfma_f32_16x16x32_bf16 v[16:19], v[56:59], v[144:147], v[16:19]
    v_mfma_f32_16x16x32_bf16 v[32:35], v[56:59], v[156:159], v[32:35]
    v_mfma_f32_16x16x32_bf16 v[20:23], v[72:75], v[144:147], v[20:23]
    s_branch IW_s2
IW_w2:
    s_branch IW_r2
IW_s2:
    v_mfma_f32_16x16x32_bf16 v[36:39], v[72:75], v[156:159], v[36:39]
    v_mfma_f32_16x16x32_bf16 v[24:27], v[124:127], v[144:147], v[24:27]
    v_mfma_f32_16x16x32_bf16 v[40:43], v[124:127], v[156:159], v[40:43]
    v_mfma_f32_16x16x32_bf16 v[28:31], v[152:155], v[144:147], v[28:31]
    v_mfma_f32_16x16x32_bf16 v[44:47], v[152:155], v[156:159], v[44:47]
    s_setprio 3
    v_lshlrev_b32 v6, 4, v0
    v_lshlrev_b32 v8, 2, v0
    v_add_u32 v8, 40960, v8
    v_mov_b32 v11, 0x35c1a2a0

    s_waitcnt lgkmcnt(2)
    v_pk_mul_f32 v[16:17], v[16:17], v[112:113]
    v_pk_mul_f32 v[18:19], v[18:19], v[112:113]
    v_pk_mul_f32 v[20:21], v[20:21], v[112:113]
    v_pk_mul_f32 v[22:23], v[22:23], v[112:113]
    v_pk_mul_f32 v[24:25], v[24:25], v[112:113]
    v_pk_mul_f32 v[26:27], v[26:27], v[112:113]
    v_pk_mul_f32 v[28:29], v[28:29], v[112:113]
    v_pk_mul_f32 v[30:31], v[30:31], v[112:113]
    s_waitcnt lgkmcnt(1)
    v_pk_mul_f32 v[32:33], v[32:33], v[114:115]
    v_pk_mul_f32 v[34:35], v[34:35], v[114:115]
    v_pk_mul_f32 v[36:37], v[36:37], v[114:115]
    v_pk_mul_f32 v[38:39], v[38:39], v[114:115]
    v_pk_mul_f32 v[40:41], v[40:41], v[114:115]
    v_pk_mul_f32 v[42:43], v[42:43], v[114:115]
    v_pk_mul_f32 v[44:45], v[44:45], v[114:115]
    v_pk_mul_f32 v[46:47], v[46:47], v[114:115]
    v_exp_f32 v80, v16 clamp
    v_exp_f32 v81, v17 clamp
    v_exp_f32 v82, v18 clamp
    v_exp_f32 v83, v19 clamp
    v_exp_f32 v84, v20 clamp
    v_exp_f32 v85, v21 clamp
    v_exp_f32 v86, v22 clamp
    v_exp_f32 v87, v23 clamp
    v_exp_f32 v88, v24 clamp
    v_exp_f32 v89, v25 clamp
    v_exp_f32 v90, v26 clamp
    v_exp_f32 v91, v27 clamp
    v_exp_f32 v92, v28 clamp
    v_exp_f32 v93, v29 clamp
    v_exp_f32 v94, v30 clamp
    v_exp_f32 v95, v31 clamp
    v_exp_f32 v96, v32 clamp
    v_exp_f32 v97, v33 clamp
    v_exp_f32 v98, v34 clamp
    v_exp_f32 v99, v35 clamp
    v_exp_f32 v100, v36 clamp
    v_exp_f32 v101, v37 clamp
    v_exp_f32 v102, v38 clamp
    v_exp_f32 v103, v39 clamp
    v_exp_f32 v104, v40 clamp
    v_exp_f32 v105, v41 clamp
    v_exp_f32 v106, v42 clamp
    v_exp_f32 v107, v43 clamp
    v_exp_f32 v108, v44 clamp
    v_exp_f32 v109, v45 clamp
    v_exp_f32 v110, v46 clamp
    v_exp_f32 v111, v47 clamp
    v_pk_mul_f32 v[16:17], v[16:17], s[40:41] clamp
    v_pk_mul_f32 v[18:19], v[18:19], s[40:41] clamp
    v_pk_mul_f32 v[20:21], v[20:21], s[40:41] clamp
    v_pk_mul_f32 v[22:23], v[22:23], s[40:41] clamp
    v_pk_mul_f32 v[24:25], v[24:25], s[40:41] clamp
    v_pk_mul_f32 v[26:27], v[26:27], s[40:41] clamp
    v_pk_mul_f32 v[28:29], v[28:29], s[40:41] clamp
    v_pk_mul_f32 v[30:31], v[30:31], s[40:41] clamp
    v_pk_mul_f32 v[32:33], v[32:33], s[40:41] clamp
    v_pk_mul_f32 v[34:35], v[34:35], s[40:41] clamp
    v_pk_mul_f32 v[36:37], v[36:37], s[40:41] clamp
    v_pk_mul_f32 v[38:39], v[38:39], s[40:41] clamp
    v_pk_mul_f32 v[40:41], v[40:41], s[40:41] clamp
    v_pk_mul_f32 v[42:43], v[42:43], s[40:41] clamp
    v_pk_mul_f32 v[44:45], v[44:45], s[40:41] clamp
    v_pk_mul_f32 v[46:47], v[46:47], s[40:41] clamp
    v_pk_add_f32 v[80:81], v[80:81], s[74:75]
    v_pk_add_f32 v[82:83], v[82:83], s[74:75]
    v_pk_add_f32 v[84:85], v[84:85], s[74:75]
    v_pk_add_f32 v[86:87], v[86:87], s[74:75]
    v_pk_add_f32 v[88:89], v[88:89], s[74:75]
    v_pk_add_f32 v[90:91], v[90:91], s[74:75]
    v_pk_add_f32 v[92:93], v[92:93], s[74:75]
    v_pk_add_f32 v[94:95], v[94:95], s[74:75]
    v_pk_add_f32 v[96:97], v[96:97], s[74:75]
    v_pk_add_f32 v[98:99], v[98:99], s[74:75]
    v_pk_add_f32 v[100:101], v[100:101], s[74:75]
    v_pk_add_f32 v[102:103], v[102:103], s[74:75]
    v_pk_add_f32 v[104:105], v[104:105], s[74:75]
    v_pk_add_f32 v[106:107], v[106:107], s[74:75]
    v_pk_add_f32 v[108:109], v[108:109], s[74:75]
    v_pk_add_f32 v[110:111], v[110:111], s[74:75]
    v_pk_fma_f32 v[16:17], v[16:17], s[76:77], v[80:81]
    v_pk_fma_f32 v[18:19], v[18:19], s[76:77], v[82:83]
    v_pk_fma_f32 v[20:21], v[20:21], s[76:77], v[84:85]
    v_pk_fma_f32 v[22:23], v[22:23], s[76:77], v[86:87]
    v_pk_fma_f32 v[24:25], v[24:25], s[76:77], v[88:89]
    v_pk_fma_f32 v[26:27], v[26:27], s[76:77], v[90:91]
    v_pk_fma_f32 v[28:29], v[28:29], s[76:77], v[92:93]
    v_pk_fma_f32 v[30:31], v[30:31], s[76:77], v[94:95]
    v_pk_fma_f32 v[32:33], v[32:33], s[76:77], v[96:97]
    v_pk_fma_f32 v[34:35], v[34:35], s[76:77], v[98:99]
    v_pk_fma_f32 v[36:37], v[36:37], s[76:77], v[100:101]
    v_pk_fma_f32 v[38:39], v[38:39], s[76:77], v[102:103]
    v_pk_fma_f32 v[40:41], v[40:41], s[76:77], v[104:105]
    v_pk_fma_f32 v[42:43], v[42:43], s[76:77], v[106:107]
    v_pk_fma_f32 v[44:45], v[44:45], s[76:77], v[108:109]
    v_pk_fma_f32 v[46:47], v[46:47], s[76:77], v[110:111]
    v_cvt_pk_bf16_f32 v112, v16, v17
    v_cvt_pk_bf16_f32 v113, v18, v19
    v_cvt_pk_bf16_f32 v114, v20, v21
    v_cvt_pk_bf16_f32 v115, v22, v23
    v_cvt_pk_bf16_f32 v116, v24, v25
    v_cvt_pk_bf16_f32 v117, v26, v27
    v_cvt_pk_bf16_f32 v118, v28, v29
    v_cvt_pk_bf16_f32 v119, v30, v31
    v_cvt_pk_bf16_f32 v120, v32, v33
    v_cvt_pk_bf16_f32 v121, v34, v35
    v_cvt_pk_bf16_f32 v122, v36, v37
    v_cvt_pk_bf16_f32 v123, v38, v39
    v_cvt_pk_bf16_f32 v124, v40, v41
    v_cvt_pk_bf16_f32 v125, v42, v43
    v_cvt_pk_bf16_f32 v126, v44, v45
    v_cvt_pk_bf16_f32 v127, v46, v47
    s_waitcnt lgkmcnt(0)
    v_and_b32 v9, 0xfffffff7, v1
    v_and_b32 v5, 0x30, v0
    v_add_u32 v5, 159232, v5
    v_and_b32 v8, 15, v0
    v_lshlrev_b32 v8, 6, v8
    v_and_b32 v10, 0x30, v0
    v_add_u32 v8, v8, v10
    v_add_u32 v8, 40960, v8
F_kw:
    ds_read_b32 v7, v9 offset:128
    ds_read_b128 v[32:35], v5 offset:0
    ds_read_b128 v[36:39], v5 offset:64
    ds_read_b128 v[16:19], v8 offset:0
    ds_read_b128 v[20:23], v8 offset:1024
    ds_read_b128 v[24:27], v8 offset:4096
    ds_read_b128 v[28:31], v8 offset:5120
    ds_read_b128 v[56:59], v5 offset:128
    ds_read_b128 v[60:63], v5 offset:192
    ds_read_b128 v[40:43], v8 offset:2048
    ds_read_b128 v[44:47], v8 offset:3072
    ds_read_b128 v[48:51], v8 offset:6144
    ds_read_b128 v[52:55], v8 offset:7168
    s_waitcnt lgkmcnt(12)
    v_cmp_gt_u32 vcc, 2, v7
    s_cbranch_vccz F_kx
    s_waitcnt lgkmcnt(0)
    s_branch F_kw
F_kx:
    s_waitcnt lgkmcnt(10)
    v_cvt_pk_bf16_f32 v136, v32, v33
    v_cvt_pk_bf16_f32 v137, v34, v35
    v_cvt_pk_bf16_f32 v138, v36, v37
    v_cvt_pk_bf16_f32 v139, v38, v39
    s_nop 1
    v_mfma_f32_16x16x32_bf16 v[72:75], v[136:139], v[112:115], 0
    v_mfma_f32_16x16x32_bf16 v[84:87], v[136:139], v[120:123], 0
    s_waitcnt lgkmcnt(8)
    v_cvt_pk_bf16_f32 v128, v16, v17
    v_cvt_pk_bf16_f32 v129, v18, v19
    v_cvt_pk_bf16_f32 v130, v20, v21
    v_cvt_pk_bf16_f32 v131, v22, v23
    s_nop 1
    v_mfma_f32_16x16x32_bf16 v[64:67], v[128:131], v[112:115], 0
    v_mfma_f32_16x16x32_bf16 v[76:79], v[128:131], v[120:123], 0
    s_waitcnt lgkmcnt(6)
    v_cvt_pk_bf16_f32 v132, v24, v25
    v_cvt_pk_bf16_f32 v133, v26, v27
    v_cvt_pk_bf16_f32 v134, v28, v29
    v_cvt_pk_bf16_f32 v135, v30, v31
    s_nop 1
    v_mfma_f32_16x16x32_bf16 v[68:71], v[132:135], v[112:115], 0
    v_mfma_f32_16x16x32_bf16 v[80:83], v[132:135], v[120:123], 0
    s_waitcnt lgkmcnt(4)
    v_cvt_pk_bf16_f32 v148, v56, v57
    v_cvt_pk_bf16_f32 v149, v58, v59
    v_cvt_pk_bf16_f32 v150, v60, v61
    v_cvt_pk_bf16_f32 v151, v62, v63
    v_fma_f32 v72, v72, s46, v11
    v_rcp_f32 v72, v72
    v_fma_f32 v84, v84, s46, v11
    v_rcp_f32 v84, v84
    v_mfma_f32_16x16x32_bf16 v[96:99], v[148:151], v[116:119], 0
    v_mfma_f32_16x16x32_bf16 v[108:111], v[148:151], v[124:127], 0
    s_waitcnt lgkmcnt(2)
    v_cvt_pk_bf16_f32 v140, v40, v41
    v_cvt_pk_bf16_f32 v141, v42, v43
    v_cvt_pk_bf16_f32 v142, v44, v45
    v_cvt_pk_bf16_f32 v143, v46, v47
    s_nop 1
    v_mfma_f32_16x16x32_bf16 v[88:91], v[140:143], v[116:119], 0
    v_mfma_f32_16x16x32_bf16 v[100:103], v[140:143], v[124:127], 0
    s_waitcnt lgkmcnt(0)
    v_cvt_pk_bf16_f32 v144, v48, v49
    v_cvt_pk_bf16_f32 v145, v50, v51
    v_cvt_pk_bf16_f32 v146, v52, v53
    v_cvt_pk_bf16_f32 v147, v54, v55
    s_nop 1
    v_mfma_f32_16x16x32_bf16 v[92:95], v[144:147], v[116:119], 0
    v_mfma_f32_16x16x32_bf16 v[104:107], v[144:147], v[124:127], 0
    v_mul_f32 v64, v64, v72
    v_mul_f32 v65, v65, v72
    v_mul_f32 v66, v66, v72
    v_mul_f32 v67, v67, v72
    v_mul_f32 v68, v68, v72
    v_mul_f32 v69, v69, v72
    v_mul_f32 v70, v70, v72
    v_mul_f32 v71, v71, v72
    v_cvt_pk_bf16_f32 v152, v64, v65
    v_cvt_pk_bf16_f32 v153, v66, v67
    v_cvt_pk_bf16_f32 v154, v68, v69
    v_cvt_pk_bf16_f32 v155, v70, v71
    buffer_store_dwordx4 v[152:155], v6, s[16:19], s79 offen offset:0 sc0 sc1
    v_fma_f32 v96, v96, s46, v11
    v_rcp_f32 v96, v96
    v_fma_f32 v108, v108, s46, v11
    v_rcp_f32 v108, v108
    v_mov_b32 v85, v84
    v_pk_mul_f32 v[76:77], v[76:77], v[84:85]
    v_pk_mul_f32 v[78:79], v[78:79], v[84:85]
    v_pk_mul_f32 v[80:81], v[80:81], v[84:85]
    v_pk_mul_f32 v[82:83], v[82:83], v[84:85]
    v_cvt_pk_bf16_f32 v156, v76, v77
    v_cvt_pk_bf16_f32 v157, v78, v79
    v_cvt_pk_bf16_f32 v158, v80, v81
    v_cvt_pk_bf16_f32 v159, v82, v83
    buffer_store_dwordx4 v[156:159], v6, s[16:19], s80 offen offset:0 sc0 sc1
    v_mov_b32 v97, v96
    v_pk_mul_f32 v[88:89], v[88:89], v[96:97]
    v_pk_mul_f32 v[90:91], v[90:91], v[96:97]
    v_pk_mul_f32 v[92:93], v[92:93], v[96:97]
    v_pk_mul_f32 v[94:95], v[94:95], v[96:97]
    v_cvt_pk_bf16_f32 v160, v88, v89
    v_cvt_pk_bf16_f32 v161, v90, v91
    v_cvt_pk_bf16_f32 v162, v92, v93
    v_cvt_pk_bf16_f32 v163, v94, v95
    buffer_store_dwordx4 v[160:163], v6, s[16:19], s79 offen offset:1024 sc0 sc1
    v_mov_b32 v109, v108
    v_pk_mul_f32 v[100:101], v[100:101], v[108:109]
    v_pk_mul_f32 v[102:103], v[102:103], v[108:109]
    v_pk_mul_f32 v[104:105], v[104:105], v[108:109]
    v_pk_mul_f32 v[106:107], v[106:107], v[108:109]
    v_cvt_pk_bf16_f32 v16, v100, v101
    v_cvt_pk_bf16_f32 v17, v102, v103
    v_cvt_pk_bf16_f32 v18, v104, v105
    v_cvt_pk_bf16_f32 v19, v106, v107
    buffer_store_dwordx4 v[16:19], v6, s[16:19], s80 offen offset:1024 sc0 sc1
    s_mov_b64 exec, 1
    ds_write_b32 v4, v164 offset:144
    s_waitcnt vmcnt(0)
    s_mov_b32 s45, 1
    s_atomic_add s45, s[54:55], 0x0
    s_atomic_add s45, s[54:55], 0x80
    s_atomic_add s45, s[54:55], 0x100
    s_atomic_add s45, s[54:55], 0x180
    ds_add_u32 v4, v164 offset:144
    s_mov_b64 exec, -1
    s_cmp_lg_u32 s3, 0
    s_cbranch_scc1 F_end
    s_setprio 3
    s_lshr_b32 s50, s29, 1
    s_lshl_b32 s50, s50, 2
    s_and_b32 s51, s28, 3
    s_add_u32 s50, s50, s51
    s_lshl_b32 s50, s50, 7
    s_add_u32 s56, s50, 0x845000
    s_add_u32 s56, s72, s56
    s_addc_u32 s57, s73, 0
    v_mov_b32 v2, 159096
    ds_read_b32 v7, v2 offset:0
FW_9:
    s_waitcnt lgkmcnt(0)
    v_cmp_gt_u32 vcc, 1, v7
    s_cbranch_vccz FO_10
    s_sleep 2
    ds_read_b32 v7, v2 offset:0
    s_branch FW_9
FO_10:
    v_and_b32 v2, 7, v0
    v_lshlrev_b32 v2, 2, v2
    v_add_u32 v2, 158976, v2
    ds_read_b32 v2, v2
    s_sub_u32 s51, 15, s28
    s_waitcnt lgkmcnt(0)
    v_bfe_u32 v2, v2, 7, 4
    v_cmp_eq_u32 vcc, s51, v2
    s_cbranch_vccz F_ny

    v_lshrrev_b32 v2, 4, v0
    v_and_b32 v6, 15, v0
    v_lshlrev_b32 v6, 4, v6
    v_lshl_add_u32 v2, v2, 12, v6
    s_lshl_b32 s50, s29, 8
    s_add_u32 s50, s50, 135168

SP_11:
    s_load_dword s58, s[56:57], 0 glc
    s_waitcnt lgkmcnt(0)
    s_cmp_ge_u32 s58, 32
    s_cbranch_scc1 SD_12
    s_sleep 2
    s_branch SP_11
SD_12:
    s_mov_b32 m0, 159744
    s_nop 0
    buffer_load_dwordx4 v2, s[24:27], s50 offen sc0 sc1 lds
    s_add_u32 s50, s50, 16384
    s_add_u32 m0, m0, 1024
    s_nop 0
    buffer_load_dwordx4 v2, s[24:27], s50 offen sc0 sc1 lds
    s_waitcnt vmcnt(0)
    v_mov_b32 v7, 1
    s_mov_b64 exec, 1
    ds_write_b32 v4, v7 offset:96
    s_mov_b64 exec, -1
F_ny:
F_end:
    s_endpgm
F_nl:
    s_sub_u32 s3, s3, 4
    s_setprio 2
    s_lshr_b32 s36, s3, 1
    s_and_b32 s37, s3, 1
    v_and_b32 v1, 15, v0
    v_lshrrev_b32 v2, 4, v0
    v_lshrrev_b32 v3, 1, v1
    v_xor_b32 v3, v3, v2
    v_lshlrev_b32 v3, 4, v3
    v_lshlrev_b32 v1, 7, v1
    s_lshl_b32 s38, s36, 13
    v_add3_u32 v4, v1, v3, s38
    v_xor_b32 v5, 64, v4
    v_add_u32 v6, 0x10000, v4
    v_add_u32 v7, 0x10000, v5
    v_bfe_u32 v1, v0, 2, 2
    v_lshl_add_u32 v3, v2, 3, v1
    v_lshrrev_b32 v1, 1, v1
    v_and_b32 v2, 1, v2
    v_lshl_add_u32 v1, v2, 1, v1
    s_lshl_b32 s38, s37, 1
    s_add_u32 s38, s38, s36
    v_xor_b32 v1, s38, v1
    v_lshlrev_b32 v1, 5, v1
    v_lshl_add_u32 v1, v3, 7, v1
    v_and_b32 v2, 3, v0
    v_lshl_add_u32 v1, v2, 3, v1
    v_add_u32 v8, 0x10000, v1
    v_xor_b32 v9, 32, v8
    v_add_u32 v10, 0x8000, v8
    v_add_u32 v11, 0x8000, v9
    s_mov_b32 s40, 0x21317218
    s_mov_b32 s41, s40
    s_mov_b32 s74, 0x358637bd
    s_mov_b32 s75, s74
    s_mov_b32 s76, 0x5d800000
    s_mov_b32 s77, s76
    v_and_b32 v164, 0x30, v0
    s_lshl_b32 s42, s36, 8
    s_add_u32 s42, s42, 155648
    v_add_u32 v164, s42, v164
    v_and_b32 v165, 15, v0
    v_lshlrev_b32 v165, 2, v165
    s_lshl_b32 s42, s38, 6
    s_add_u32 s42, s42, 158208
    v_add_u32 v165, s42, v165
    s_lshl_b32 s42, s3, 2
    s_add_u32 s42, s42, 159040
    v_mov_b32 v3, s42
    v_lshlrev_b32 v1, 2, v2
    v_add_u32 v1, 159040, v1
    v_xor_b32 v2, 64, v165
    s_lshl_b32 s44, s33, 1
    s_add_u32 s44, s44, s37
    s_mul_i32 s45, s44, 4224
    s_mul_i32 s46, s36, 3072
    s_add_u32 s46, s46, s45
    s_lshl_b32 s47, s36, 10
    s_add_u32 s47, s47, 1024
    s_add_u32 s47, s47, s45
    s_lshl_b32 s48, s36, 6
    s_add_u32 s48, s48, 4096
    s_add_u32 s48, s48, s45
    s_lshl_b32 s49, s44, 10
    s_lshl_b32 s52, s3, 11
    s_add_u32 s52, s52, 65536
    s_lshl_b32 s53, s3, 7
    s_lshl_b32 s43, s36, 6
    s_add_u32 s53, s53, s43
    s_add_u32 s53, s53, 159232
    s_mov_b32 s50, 159068
    s_waitcnt lgkmcnt(0)
    s_lshl_b32 s64, s28, 7
    s_lshl_b32 s65, s3, 5
    s_add_u32 s64, s64, s65
    s_lshl_b32 s42, s64, 11
    s_lshl_b32 s65, s29, 7
    s_add_u32 s42, s42, s65
    s_add_u32 s43, s42, 0x8000
    s_lshl_b32 s66, s44, 1
    s_add_u32 s66, s66, s36
    s_lshl_b32 s66, s66, 4
    s_add_u32 s66, s66, s32
    s_lshl_b32 s66, s66, 10

    s_mov_b32 s12, s4
    s_mov_b32 s13, s5
    s_mov_b32 s14, 0x400000
    s_mov_b32 s15, 0x00020000
    s_mov_b32 s16, s6
    s_mov_b32 s17, s7
    s_mov_b32 s18, 0x600000
    s_mov_b32 s19, 0x00020000
    s_mov_b32 s20, s8
    s_mov_b32 s21, s9
    s_mov_b32 s22, 0x200000
    s_mov_b32 s23, 0x00020000
    s_add_u32 s24, s72, 0x800000
    s_addc_u32 s25, s73, 0
    s_mov_b32 s26, 0x48000
    s_mov_b32 s27, 0x00020000
    s_add_u32 s84, s72, 0xa00000
    s_addc_u32 s85, s73, 0
    s_mov_b32 s86, 0x100000
    s_mov_b32 s87, 0x00020000
    s_barrier
    ds_read_b128 v[12:15], v4 offset:0
    ds_read_b64_tr_b16 v[44:45], v8 offset:0
    ds_read_b64_tr_b16 v[46:47], v8 offset:512
    ds_read_b128 v[16:19], v4 offset:2048
    ds_read_b128 v[20:23], v4 offset:4096
    ds_read_b128 v[24:27], v4 offset:6144
    ds_read_b64_tr_b16 v[48:49], v9 offset:0
    ds_read_b64_tr_b16 v[50:51], v9 offset:512
    ds_read_b64_tr_b16 v[52:53], v8 offset:8192
    ds_read_b64_tr_b16 v[54:55], v8 offset:8704
    ds_read_b64_tr_b16 v[56:57], v9 offset:8192
    ds_read_b64_tr_b16 v[58:59], v9 offset:8704
    s_waitcnt lgkmcnt(9)
    v_mfma_f32_16x16x32_bf16 v[100:103], v[12:15], v[44:47], 0
    ds_read_b128 v[28:31], v5 offset:0
    s_waitcnt lgkmcnt(9)
    v_mfma_f32_16x16x32_bf16 v[104:107], v[16:19], v[44:47], 0
    ds_read_b64_tr_b16 v[60:61], v8 offset:4096
    s_waitcnt lgkmcnt(9)
    v_mfma_f32_16x16x32_bf16 v[108:111], v[20:23], v[44:47], 0
    ds_read_b64_tr_b16 v[62:63], v8 offset:4608
    s_waitcnt lgkmcnt(9)
    v_mfma_f32_16x16x32_bf16 v[112:115], v[24:27], v[44:47], 0
    ds_read_b128 v[32:35], v5 offset:2048
    s_waitcnt lgkmcnt(8)
    v_mfma_f32_16x16x32_bf16 v[116:119], v[12:15], v[48:51], 0
    ds_read_b128 v[36:39], v5 offset:4096
    v_mfma_f32_16x16x32_bf16 v[120:123], v[16:19], v[48:51], 0
    ds_read_b128 v[40:43], v5 offset:6144
    v_mfma_f32_16x16x32_bf16 v[124:127], v[20:23], v[48:51], 0
    ds_read_b64_tr_b16 v[64:65], v9 offset:4096
    v_mfma_f32_16x16x32_bf16 v[128:131], v[24:27], v[48:51], 0
    ds_read_b64_tr_b16 v[66:67], v9 offset:4608
    s_waitcnt lgkmcnt(10)
    v_mfma_f32_16x16x32_bf16 v[132:135], v[12:15], v[52:55], 0
    ds_read_b64_tr_b16 v[44:45], v8 offset:12288
    v_mfma_f32_16x16x32_bf16 v[136:139], v[16:19], v[52:55], 0
    ds_read_b64_tr_b16 v[46:47], v8 offset:12800
    v_mfma_f32_16x16x32_bf16 v[140:143], v[20:23], v[52:55], 0
    ds_read_b64_tr_b16 v[48:49], v9 offset:12288
    v_mfma_f32_16x16x32_bf16 v[144:147], v[24:27], v[52:55], 0
    ds_read_b64_tr_b16 v[50:51], v9 offset:12800
    s_waitcnt lgkmcnt(12)
    v_mfma_f32_16x16x32_bf16 v[148:151], v[12:15], v[56:59], 0
    v_mfma_f32_16x16x32_bf16 v[152:155], v[16:19], v[56:59], 0
    v_mfma_f32_16x16x32_bf16 v[156:159], v[20:23], v[56:59], 0
    v_mfma_f32_16x16x32_bf16 v[160:163], v[24:27], v[56:59], 0
    s_waitcnt lgkmcnt(9)
    v_mfma_f32_16x16x32_bf16 v[100:103], v[28:31], v[60:63], v[100:103]
    s_waitcnt lgkmcnt(8)
    v_mfma_f32_16x16x32_bf16 v[104:107], v[32:35], v[60:63], v[104:107]
    s_waitcnt lgkmcnt(0)
    s_barrier
    v_mfma_f32_16x16x32_bf16 v[108:111], v[36:39], v[60:63], v[108:111]
    ds_read_b128 v[12:15], v4 offset:16384
    v_mfma_f32_16x16x32_bf16 v[112:115], v[40:43], v[60:63], v[112:115]
    ds_read_b64_tr_b16 v[52:53], v8 offset:16384
    v_mfma_f32_16x16x32_bf16 v[116:119], v[28:31], v[64:67], v[116:119]
    ds_read_b64_tr_b16 v[54:55], v8 offset:16896
    v_mfma_f32_16x16x32_bf16 v[120:123], v[32:35], v[64:67], v[120:123]
    ds_read_b128 v[16:19], v4 offset:18432
    v_mfma_f32_16x16x32_bf16 v[124:127], v[36:39], v[64:67], v[124:127]
    ds_read_b128 v[20:23], v4 offset:20480
    v_mfma_f32_16x16x32_bf16 v[128:131], v[40:43], v[64:67], v[128:131]
    ds_read_b128 v[24:27], v4 offset:22528
    v_mfma_f32_16x16x32_bf16 v[132:135], v[28:31], v[44:47], v[132:135]
    ds_read_b64_tr_b16 v[56:57], v9 offset:16384
    v_mfma_f32_16x16x32_bf16 v[136:139], v[32:35], v[44:47], v[136:139]
    ds_read_b64_tr_b16 v[58:59], v9 offset:16896
    v_mfma_f32_16x16x32_bf16 v[140:143], v[36:39], v[44:47], v[140:143]
    ds_read_b64_tr_b16 v[60:61], v8 offset:24576
    v_mfma_f32_16x16x32_bf16 v[144:147], v[40:43], v[44:47], v[144:147]
    ds_read_b64_tr_b16 v[62:63], v8 offset:25088
    v_mfma_f32_16x16x32_bf16 v[148:151], v[28:31], v[48:51], v[148:151]
    ds_read_b64_tr_b16 v[64:65], v9 offset:24576
    v_mfma_f32_16x16x32_bf16 v[152:155], v[32:35], v[48:51], v[152:155]
    ds_read_b64_tr_b16 v[66:67], v9 offset:25088
    v_mfma_f32_16x16x32_bf16 v[156:159], v[36:39], v[48:51], v[156:159]
    v_mfma_f32_16x16x32_bf16 v[160:163], v[40:43], v[48:51], v[160:163]
    s_waitcnt lgkmcnt(9)
    v_mfma_f32_16x16x32_bf16 v[100:103], v[12:15], v[52:55], v[100:103]
    ds_read_b128 v[28:31], v5 offset:16384
    s_waitcnt lgkmcnt(9)
    v_mfma_f32_16x16x32_bf16 v[104:107], v[16:19], v[52:55], v[104:107]
    ds_read_b64_tr_b16 v[44:45], v8 offset:20480
    s_waitcnt lgkmcnt(9)
    v_mfma_f32_16x16x32_bf16 v[108:111], v[20:23], v[52:55], v[108:111]
    ds_read_b64_tr_b16 v[46:47], v8 offset:20992
    s_waitcnt lgkmcnt(9)
    v_mfma_f32_16x16x32_bf16 v[112:115], v[24:27], v[52:55], v[112:115]
    ds_read_b128 v[32:35], v5 offset:18432
    s_waitcnt lgkmcnt(8)
    v_mfma_f32_16x16x32_bf16 v[116:119], v[12:15], v[56:59], v[116:119]
    ds_read_b128 v[36:39], v5 offset:20480
    v_mfma_f32_16x16x32_bf16 v[120:123], v[16:19], v[56:59], v[120:123]
    ds_read_b128 v[40:43], v5 offset:22528
    v_mfma_f32_16x16x32_bf16 v[124:127], v[20:23], v[56:59], v[124:127]
    ds_read_b64_tr_b16 v[48:49], v9 offset:20480
    v_mfma_f32_16x16x32_bf16 v[128:131], v[24:27], v[56:59], v[128:131]
    ds_read_b64_tr_b16 v[50:51], v9 offset:20992
    s_waitcnt lgkmcnt(10)
    v_mfma_f32_16x16x32_bf16 v[132:135], v[12:15], v[60:63], v[132:135]
    ds_read_b64_tr_b16 v[52:53], v8 offset:28672
    v_mfma_f32_16x16x32_bf16 v[136:139], v[16:19], v[60:63], v[136:139]
    ds_read_b64_tr_b16 v[54:55], v8 offset:29184
    v_mfma_f32_16x16x32_bf16 v[140:143], v[20:23], v[60:63], v[140:143]
    ds_read_b64_tr_b16 v[56:57], v9 offset:28672
    v_mfma_f32_16x16x32_bf16 v[144:147], v[24:27], v[60:63], v[144:147]
    ds_read_b64_tr_b16 v[58:59], v9 offset:29184
    s_waitcnt lgkmcnt(12)
    v_mfma_f32_16x16x32_bf16 v[148:151], v[12:15], v[64:67], v[148:151]
    v_mfma_f32_16x16x32_bf16 v[152:155], v[16:19], v[64:67], v[152:155]
    v_mfma_f32_16x16x32_bf16 v[156:159], v[20:23], v[64:67], v[156:159]
    v_mfma_f32_16x16x32_bf16 v[160:163], v[24:27], v[64:67], v[160:163]
    s_waitcnt lgkmcnt(9)
    v_mfma_f32_16x16x32_bf16 v[100:103], v[28:31], v[44:47], v[100:103]
    s_waitcnt lgkmcnt(8)
    v_mfma_f32_16x16x32_bf16 v[104:107], v[32:35], v[44:47], v[104:107]
    s_waitcnt lgkmcnt(0)
    s_barrier
    v_mfma_f32_16x16x32_bf16 v[108:111], v[36:39], v[44:47], v[108:111]
    ds_read_b128 v[12:15], v4 offset:32768
    v_mfma_f32_16x16x32_bf16 v[112:115], v[40:43], v[44:47], v[112:115]
    ds_read_b64_tr_b16 v[60:61], v10 offset:16384
    v_mfma_f32_16x16x32_bf16 v[116:119], v[28:31], v[48:51], v[116:119]
    ds_read_b64_tr_b16 v[62:63], v10 offset:16896
    v_mfma_f32_16x16x32_bf16 v[120:123], v[32:35], v[48:51], v[120:123]
    ds_read_b128 v[16:19], v4 offset:34816
    v_mfma_f32_16x16x32_bf16 v[124:127], v[36:39], v[48:51], v[124:127]
    ds_read_b128 v[20:23], v4 offset:36864
    v_mfma_f32_16x16x32_bf16 v[128:131], v[40:43], v[48:51], v[128:131]
    ds_read_b128 v[24:27], v4 offset:38912
    v_mfma_f32_16x16x32_bf16 v[132:135], v[28:31], v[52:55], v[132:135]
    ds_read_b64_tr_b16 v[64:65], v11 offset:16384
    v_mfma_f32_16x16x32_bf16 v[136:139], v[32:35], v[52:55], v[136:139]
    ds_read_b64_tr_b16 v[66:67], v11 offset:16896
    v_mfma_f32_16x16x32_bf16 v[140:143], v[36:39], v[52:55], v[140:143]
    ds_read_b64_tr_b16 v[44:45], v10 offset:24576
    v_mfma_f32_16x16x32_bf16 v[144:147], v[40:43], v[52:55], v[144:147]
    ds_read_b64_tr_b16 v[46:47], v10 offset:25088
    v_mfma_f32_16x16x32_bf16 v[148:151], v[28:31], v[56:59], v[148:151]
    ds_read_b64_tr_b16 v[48:49], v11 offset:24576
    v_mfma_f32_16x16x32_bf16 v[152:155], v[32:35], v[56:59], v[152:155]
    ds_read_b64_tr_b16 v[50:51], v11 offset:25088
    v_mfma_f32_16x16x32_bf16 v[156:159], v[36:39], v[56:59], v[156:159]
    v_mfma_f32_16x16x32_bf16 v[160:163], v[40:43], v[56:59], v[160:163]
    s_waitcnt lgkmcnt(9)
    v_mfma_f32_16x16x32_bf16 v[100:103], v[12:15], v[60:63], v[100:103]
    ds_read_b128 v[28:31], v5 offset:32768
    s_waitcnt lgkmcnt(9)
    v_mfma_f32_16x16x32_bf16 v[104:107], v[16:19], v[60:63], v[104:107]
    ds_read_b64_tr_b16 v[52:53], v10 offset:20480
    s_waitcnt lgkmcnt(9)
    v_mfma_f32_16x16x32_bf16 v[108:111], v[20:23], v[60:63], v[108:111]
    ds_read_b64_tr_b16 v[54:55], v10 offset:20992
    s_waitcnt lgkmcnt(9)
    v_mfma_f32_16x16x32_bf16 v[112:115], v[24:27], v[60:63], v[112:115]
    ds_read_b128 v[32:35], v5 offset:34816
    s_waitcnt lgkmcnt(8)
    v_mfma_f32_16x16x32_bf16 v[116:119], v[12:15], v[64:67], v[116:119]
    ds_read_b128 v[36:39], v5 offset:36864
    v_mfma_f32_16x16x32_bf16 v[120:123], v[16:19], v[64:67], v[120:123]
    ds_read_b128 v[40:43], v5 offset:38912
    v_mfma_f32_16x16x32_bf16 v[124:127], v[20:23], v[64:67], v[124:127]
    ds_read_b64_tr_b16 v[56:57], v11 offset:20480
    v_mfma_f32_16x16x32_bf16 v[128:131], v[24:27], v[64:67], v[128:131]
    ds_read_b64_tr_b16 v[58:59], v11 offset:20992
    s_waitcnt lgkmcnt(10)
    v_mfma_f32_16x16x32_bf16 v[132:135], v[12:15], v[44:47], v[132:135]
    ds_read_b64_tr_b16 v[60:61], v10 offset:28672
    v_mfma_f32_16x16x32_bf16 v[136:139], v[16:19], v[44:47], v[136:139]
    ds_read_b64_tr_b16 v[62:63], v10 offset:29184
    v_mfma_f32_16x16x32_bf16 v[140:143], v[20:23], v[44:47], v[140:143]
    ds_read_b64_tr_b16 v[64:65], v11 offset:28672
    v_mfma_f32_16x16x32_bf16 v[144:147], v[24:27], v[44:47], v[144:147]
    ds_read_b64_tr_b16 v[66:67], v11 offset:29184
    s_waitcnt lgkmcnt(12)
    v_mfma_f32_16x16x32_bf16 v[148:151], v[12:15], v[48:51], v[148:151]
    v_mfma_f32_16x16x32_bf16 v[152:155], v[16:19], v[48:51], v[152:155]
    v_mfma_f32_16x16x32_bf16 v[156:159], v[20:23], v[48:51], v[156:159]
    v_mfma_f32_16x16x32_bf16 v[160:163], v[24:27], v[48:51], v[160:163]
    s_waitcnt lgkmcnt(9)
    v_mfma_f32_16x16x32_bf16 v[100:103], v[28:31], v[52:55], v[100:103]
    s_waitcnt lgkmcnt(8)
    v_mfma_f32_16x16x32_bf16 v[104:107], v[32:35], v[52:55], v[104:107]
    s_branch IW_s3
IW_w3:
    s_branch IW_r3
IW_s3:
    s_waitcnt lgkmcnt(0)
    s_barrier
    v_mfma_f32_16x16x32_bf16 v[108:111], v[36:39], v[52:55], v[108:111]
    ds_read_b128 v[12:15], v4 offset:49152
    v_mfma_f32_16x16x32_bf16 v[112:115], v[40:43], v[52:55], v[112:115]
    ds_read_b64_tr_b16 v[44:45], v10 offset:32768
    v_mfma_f32_16x16x32_bf16 v[116:119], v[28:31], v[56:59], v[116:119]
    ds_read_b64_tr_b16 v[46:47], v10 offset:33280
    v_mfma_f32_16x16x32_bf16 v[120:123], v[32:35], v[56:59], v[120:123]
    ds_read_b128 v[16:19], v4 offset:51200
    v_mfma_f32_16x16x32_bf16 v[124:127], v[36:39], v[56:59], v[124:127]
    ds_read_b128 v[20:23], v4 offset:53248
    v_mfma_f32_16x16x32_bf16 v[128:131], v[40:43], v[56:59], v[128:131]
    ds_read_b128 v[24:27], v4 offset:55296
    v_mfma_f32_16x16x32_bf16 v[132:135], v[28:31], v[60:63], v[132:135]
    ds_read_b64_tr_b16 v[48:49], v11 offset:32768
    v_mfma_f32_16x16x32_bf16 v[136:139], v[32:35], v[60:63], v[136:139]
    ds_read_b64_tr_b16 v[50:51], v11 offset:33280
    v_mfma_f32_16x16x32_bf16 v[140:143], v[36:39], v[60:63], v[140:143]
    ds_read_b64_tr_b16 v[52:53], v8 offset:0
    v_mfma_f32_16x16x32_bf16 v[144:147], v[40:43], v[60:63], v[144:147]
    ds_read_b64_tr_b16 v[54:55], v8 offset:512
    v_mfma_f32_16x16x32_bf16 v[148:151], v[28:31], v[64:67], v[148:151]
    ds_read_b64_tr_b16 v[56:57], v9 offset:0
    v_mfma_f32_16x16x32_bf16 v[152:155], v[32:35], v[64:67], v[152:155]
    ds_read_b64_tr_b16 v[58:59], v9 offset:512
    v_mfma_f32_16x16x32_bf16 v[156:159], v[36:39], v[64:67], v[156:159]
    v_mfma_f32_16x16x32_bf16 v[160:163], v[40:43], v[64:67], v[160:163]
    s_waitcnt lgkmcnt(9)
    v_mfma_f32_16x16x32_bf16 v[100:103], v[12:15], v[44:47], v[100:103]
    ds_read_b128 v[28:31], v5 offset:49152
    s_waitcnt lgkmcnt(9)
    v_mfma_f32_16x16x32_bf16 v[104:107], v[16:19], v[44:47], v[104:107]
    ds_read_b64_tr_b16 v[60:61], v10 offset:36864
    s_waitcnt lgkmcnt(9)
    v_mfma_f32_16x16x32_bf16 v[108:111], v[20:23], v[44:47], v[108:111]
    ds_read_b64_tr_b16 v[62:63], v10 offset:37376
    s_waitcnt lgkmcnt(9)
    v_mfma_f32_16x16x32_bf16 v[112:115], v[24:27], v[44:47], v[112:115]
    ds_read_b128 v[32:35], v5 offset:51200
    s_waitcnt lgkmcnt(8)
    v_mfma_f32_16x16x32_bf16 v[116:119], v[12:15], v[48:51], v[116:119]
    ds_read_b128 v[36:39], v5 offset:53248
    v_mfma_f32_16x16x32_bf16 v[120:123], v[16:19], v[48:51], v[120:123]
    ds_read_b128 v[40:43], v5 offset:55296
    v_mfma_f32_16x16x32_bf16 v[124:127], v[20:23], v[48:51], v[124:127]
    ds_read_b64_tr_b16 v[64:65], v11 offset:36864
    v_mfma_f32_16x16x32_bf16 v[128:131], v[24:27], v[48:51], v[128:131]
    ds_read_b64_tr_b16 v[66:67], v11 offset:37376
    s_waitcnt lgkmcnt(10)
    v_mfma_f32_16x16x32_bf16 v[132:135], v[12:15], v[52:55], v[132:135]
    ds_read_b64_tr_b16 v[44:45], v8 offset:4096
    v_mfma_f32_16x16x32_bf16 v[136:139], v[16:19], v[52:55], v[136:139]
    ds_read_b64_tr_b16 v[46:47], v8 offset:4608
    v_mfma_f32_16x16x32_bf16 v[140:143], v[20:23], v[52:55], v[140:143]
    ds_read_b64_tr_b16 v[48:49], v9 offset:4096
    v_mfma_f32_16x16x32_bf16 v[144:147], v[24:27], v[52:55], v[144:147]
    ds_read_b64_tr_b16 v[50:51], v9 offset:4608
    s_waitcnt lgkmcnt(12)
    v_mfma_f32_16x16x32_bf16 v[148:151], v[12:15], v[56:59], v[148:151]
    v_mfma_f32_16x16x32_bf16 v[152:155], v[16:19], v[56:59], v[152:155]
    v_mfma_f32_16x16x32_bf16 v[156:159], v[20:23], v[56:59], v[156:159]
    v_mfma_f32_16x16x32_bf16 v[160:163], v[24:27], v[56:59], v[160:163]
    s_waitcnt lgkmcnt(9)
    v_mfma_f32_16x16x32_bf16 v[100:103], v[28:31], v[60:63], v[100:103]
    s_waitcnt lgkmcnt(8)
    v_mfma_f32_16x16x32_bf16 v[104:107], v[32:35], v[60:63], v[104:107]
    s_waitcnt lgkmcnt(0)
    s_barrier
    v_mfma_f32_16x16x32_bf16 v[108:111], v[36:39], v[60:63], v[108:111]
    ds_read_b128 v[12:15], v4 offset:0
    v_mfma_f32_16x16x32_bf16 v[112:115], v[40:43], v[60:63], v[112:115]
    ds_read_b64_tr_b16 v[52:53], v8 offset:8192
    v_mfma_f32_16x16x32_bf16 v[116:119], v[28:31], v[64:67], v[116:119]
    ds_read_b64_tr_b16 v[54:55], v8 offset:8704
    v_mfma_f32_16x16x32_bf16 v[120:123], v[32:35], v[64:67], v[120:123]
    ds_read_b128 v[16:19], v4 offset:2048
    v_mfma_f32_16x16x32_bf16 v[124:127], v[36:39], v[64:67], v[124:127]
    ds_read_b128 v[20:23], v4 offset:4096
    v_mfma_f32_16x16x32_bf16 v[128:131], v[40:43], v[64:67], v[128:131]
    ds_read_b128 v[24:27], v4 offset:6144
    v_mfma_f32_16x16x32_bf16 v[132:135], v[28:31], v[44:47], v[132:135]
    ds_read_b64_tr_b16 v[56:57], v9 offset:8192
    v_mfma_f32_16x16x32_bf16 v[136:139], v[32:35], v[44:47], v[136:139]
    ds_read_b64_tr_b16 v[58:59], v9 offset:8704
    v_mfma_f32_16x16x32_bf16 v[140:143], v[36:39], v[44:47], v[140:143]
    ds_read_b64_tr_b16 v[60:61], v8 offset:16384
    v_mfma_f32_16x16x32_bf16 v[144:147], v[40:43], v[44:47], v[144:147]
    ds_read_b64_tr_b16 v[62:63], v8 offset:16896
    v_mfma_f32_16x16x32_bf16 v[148:151], v[28:31], v[48:51], v[148:151]
    ds_read_b64_tr_b16 v[64:65], v9 offset:16384
    v_mfma_f32_16x16x32_bf16 v[152:155], v[32:35], v[48:51], v[152:155]
    ds_read_b64_tr_b16 v[66:67], v9 offset:16896
    v_mfma_f32_16x16x32_bf16 v[156:159], v[36:39], v[48:51], v[156:159]
    v_mfma_f32_16x16x32_bf16 v[160:163], v[40:43], v[48:51], v[160:163]
    s_waitcnt lgkmcnt(9)
    v_mfma_f32_16x16x32_bf16 v[100:103], v[12:15], v[52:55], v[100:103]
    ds_read_b128 v[28:31], v5 offset:0
    s_waitcnt lgkmcnt(9)
    v_mfma_f32_16x16x32_bf16 v[104:107], v[16:19], v[52:55], v[104:107]
    ds_read_b64_tr_b16 v[44:45], v8 offset:12288
    s_waitcnt lgkmcnt(9)
    v_mfma_f32_16x16x32_bf16 v[108:111], v[20:23], v[52:55], v[108:111]
    ds_read_b64_tr_b16 v[46:47], v8 offset:12800
    s_waitcnt lgkmcnt(9)
    v_mfma_f32_16x16x32_bf16 v[112:115], v[24:27], v[52:55], v[112:115]
    ds_read_b128 v[32:35], v5 offset:2048
    s_waitcnt lgkmcnt(8)
    v_mfma_f32_16x16x32_bf16 v[116:119], v[12:15], v[56:59], v[116:119]
    ds_read_b128 v[36:39], v5 offset:4096
    v_mfma_f32_16x16x32_bf16 v[120:123], v[16:19], v[56:59], v[120:123]
    ds_read_b128 v[40:43], v5 offset:6144
    v_mfma_f32_16x16x32_bf16 v[124:127], v[20:23], v[56:59], v[124:127]
    ds_read_b64_tr_b16 v[48:49], v9 offset:12288
    v_mfma_f32_16x16x32_bf16 v[128:131], v[24:27], v[56:59], v[128:131]
    ds_read_b64_tr_b16 v[50:51], v9 offset:12800
    s_waitcnt lgkmcnt(10)
    v_mfma_f32_16x16x32_bf16 v[132:135], v[12:15], v[60:63], v[132:135]
    ds_read_b64_tr_b16 v[52:53], v8 offset:20480
    v_mfma_f32_16x16x32_bf16 v[136:139], v[16:19], v[60:63], v[136:139]
    ds_read_b64_tr_b16 v[54:55], v8 offset:20992
    v_mfma_f32_16x16x32_bf16 v[140:143], v[20:23], v[60:63], v[140:143]
    ds_read_b64_tr_b16 v[56:57], v9 offset:20480
    v_mfma_f32_16x16x32_bf16 v[144:147], v[24:27], v[60:63], v[144:147]
    ds_read_b64_tr_b16 v[58:59], v9 offset:20992
    s_waitcnt lgkmcnt(12)
    v_mfma_f32_16x16x32_bf16 v[148:151], v[12:15], v[64:67], v[148:151]
    v_mfma_f32_16x16x32_bf16 v[152:155], v[16:19], v[64:67], v[152:155]
    v_mfma_f32_16x16x32_bf16 v[156:159], v[20:23], v[64:67], v[156:159]
    v_mfma_f32_16x16x32_bf16 v[160:163], v[24:27], v[64:67], v[160:163]
    s_waitcnt lgkmcnt(9)
    v_mfma_f32_16x16x32_bf16 v[100:103], v[28:31], v[44:47], v[100:103]
    s_waitcnt lgkmcnt(8)
    v_mfma_f32_16x16x32_bf16 v[104:107], v[32:35], v[44:47], v[104:107]
    s_waitcnt lgkmcnt(0)
    s_barrier
    v_mfma_f32_16x16x32_bf16 v[108:111], v[36:39], v[44:47], v[108:111]
    ds_read_b128 v[12:15], v4 offset:16384
    v_mfma_f32_16x16x32_bf16 v[112:115], v[40:43], v[44:47], v[112:115]
    ds_read_b64_tr_b16 v[60:61], v10 offset:0
    v_mfma_f32_16x16x32_bf16 v[116:119], v[28:31], v[48:51], v[116:119]
    ds_read_b64_tr_b16 v[62:63], v10 offset:512
    v_mfma_f32_16x16x32_bf16 v[120:123], v[32:35], v[48:51], v[120:123]
    ds_read_b128 v[16:19], v4 offset:18432
    v_mfma_f32_16x16x32_bf16 v[124:127], v[36:39], v[48:51], v[124:127]
    ds_read_b128 v[20:23], v4 offset:20480
    v_mfma_f32_16x16x32_bf16 v[128:131], v[40:43], v[48:51], v[128:131]
    ds_read_b128 v[24:27], v4 offset:22528
    v_mfma_f32_16x16x32_bf16 v[132:135], v[28:31], v[52:55], v[132:135]
    ds_read_b64_tr_b16 v[64:65], v11 offset:0
    v_mfma_f32_16x16x32_bf16 v[136:139], v[32:35], v[52:55], v[136:139]
    ds_read_b64_tr_b16 v[66:67], v11 offset:512
    v_mfma_f32_16x16x32_bf16 v[140:143], v[36:39], v[52:55], v[140:143]
    ds_read_b64_tr_b16 v[44:45], v10 offset:8192
    v_mfma_f32_16x16x32_bf16 v[144:147], v[40:43], v[52:55], v[144:147]
    ds_read_b64_tr_b16 v[46:47], v10 offset:8704
    v_mfma_f32_16x16x32_bf16 v[148:151], v[28:31], v[56:59], v[148:151]
    ds_read_b64_tr_b16 v[48:49], v11 offset:8192
    v_mfma_f32_16x16x32_bf16 v[152:155], v[32:35], v[56:59], v[152:155]
    ds_read_b64_tr_b16 v[50:51], v11 offset:8704
    v_mfma_f32_16x16x32_bf16 v[156:159], v[36:39], v[56:59], v[156:159]
    v_mfma_f32_16x16x32_bf16 v[160:163], v[40:43], v[56:59], v[160:163]
    s_waitcnt lgkmcnt(9)
    v_mfma_f32_16x16x32_bf16 v[100:103], v[12:15], v[60:63], v[100:103]
    ds_read_b128 v[28:31], v5 offset:16384
    s_waitcnt lgkmcnt(9)
    v_mfma_f32_16x16x32_bf16 v[104:107], v[16:19], v[60:63], v[104:107]
    ds_read_b64_tr_b16 v[52:53], v10 offset:4096
    s_waitcnt lgkmcnt(9)
    v_mfma_f32_16x16x32_bf16 v[108:111], v[20:23], v[60:63], v[108:111]
    ds_read_b64_tr_b16 v[54:55], v10 offset:4608
    s_waitcnt lgkmcnt(9)
    v_mfma_f32_16x16x32_bf16 v[112:115], v[24:27], v[60:63], v[112:115]
    ds_read_b128 v[32:35], v5 offset:18432
    s_waitcnt lgkmcnt(8)
    v_mfma_f32_16x16x32_bf16 v[116:119], v[12:15], v[64:67], v[116:119]
    ds_read_b128 v[36:39], v5 offset:20480
    v_mfma_f32_16x16x32_bf16 v[120:123], v[16:19], v[64:67], v[120:123]
    ds_read_b128 v[40:43], v5 offset:22528
    v_mfma_f32_16x16x32_bf16 v[124:127], v[20:23], v[64:67], v[124:127]
    ds_read_b64_tr_b16 v[56:57], v11 offset:4096
    v_mfma_f32_16x16x32_bf16 v[128:131], v[24:27], v[64:67], v[128:131]
    ds_read_b64_tr_b16 v[58:59], v11 offset:4608
    s_waitcnt lgkmcnt(10)
    v_mfma_f32_16x16x32_bf16 v[132:135], v[12:15], v[44:47], v[132:135]
    ds_read_b64_tr_b16 v[60:61], v10 offset:12288
    v_mfma_f32_16x16x32_bf16 v[136:139], v[16:19], v[44:47], v[136:139]
    ds_read_b64_tr_b16 v[62:63], v10 offset:12800
    v_mfma_f32_16x16x32_bf16 v[140:143], v[20:23], v[44:47], v[140:143]
    ds_read_b64_tr_b16 v[64:65], v11 offset:12288
    v_mfma_f32_16x16x32_bf16 v[144:147], v[24:27], v[44:47], v[144:147]
    ds_read_b64_tr_b16 v[66:67], v11 offset:12800
    s_waitcnt lgkmcnt(12)
    v_mfma_f32_16x16x32_bf16 v[148:151], v[12:15], v[48:51], v[148:151]
    v_mfma_f32_16x16x32_bf16 v[152:155], v[16:19], v[48:51], v[152:155]
    v_mfma_f32_16x16x32_bf16 v[156:159], v[20:23], v[48:51], v[156:159]
    v_mfma_f32_16x16x32_bf16 v[160:163], v[24:27], v[48:51], v[160:163]
    s_waitcnt lgkmcnt(9)
    v_mfma_f32_16x16x32_bf16 v[100:103], v[28:31], v[52:55], v[100:103]
    s_waitcnt lgkmcnt(8)
    v_mfma_f32_16x16x32_bf16 v[104:107], v[32:35], v[52:55], v[104:107]
    s_waitcnt lgkmcnt(0)
    s_barrier
    v_mfma_f32_16x16x32_bf16 v[108:111], v[36:39], v[52:55], v[108:111]
    ds_read_b128 v[12:15], v4 offset:32768
    v_mfma_f32_16x16x32_bf16 v[112:115], v[40:43], v[52:55], v[112:115]
    ds_read_b64_tr_b16 v[44:45], v10 offset:16384
    v_mfma_f32_16x16x32_bf16 v[116:119], v[28:31], v[56:59], v[116:119]
    ds_read_b64_tr_b16 v[46:47], v10 offset:16896
    v_mfma_f32_16x16x32_bf16 v[120:123], v[32:35], v[56:59], v[120:123]
    ds_read_b128 v[16:19], v4 offset:34816
    v_mfma_f32_16x16x32_bf16 v[124:127], v[36:39], v[56:59], v[124:127]
    ds_read_b128 v[20:23], v4 offset:36864
    v_mfma_f32_16x16x32_bf16 v[128:131], v[40:43], v[56:59], v[128:131]
    ds_read_b128 v[24:27], v4 offset:38912
    v_mfma_f32_16x16x32_bf16 v[132:135], v[28:31], v[60:63], v[132:135]
    ds_read_b64_tr_b16 v[48:49], v11 offset:16384
    v_mfma_f32_16x16x32_bf16 v[136:139], v[32:35], v[60:63], v[136:139]
    ds_read_b64_tr_b16 v[50:51], v11 offset:16896
    v_mfma_f32_16x16x32_bf16 v[140:143], v[36:39], v[60:63], v[140:143]
    ds_read_b64_tr_b16 v[52:53], v10 offset:24576
    v_mfma_f32_16x16x32_bf16 v[144:147], v[40:43], v[60:63], v[144:147]
    ds_read_b64_tr_b16 v[54:55], v10 offset:25088
    v_mfma_f32_16x16x32_bf16 v[148:151], v[28:31], v[64:67], v[148:151]
    ds_read_b64_tr_b16 v[56:57], v11 offset:24576
    v_mfma_f32_16x16x32_bf16 v[152:155], v[32:35], v[64:67], v[152:155]
    ds_read_b64_tr_b16 v[58:59], v11 offset:25088
    v_mfma_f32_16x16x32_bf16 v[156:159], v[36:39], v[64:67], v[156:159]
    v_mfma_f32_16x16x32_bf16 v[160:163], v[40:43], v[64:67], v[160:163]
    s_waitcnt lgkmcnt(9)
    v_mfma_f32_16x16x32_bf16 v[100:103], v[12:15], v[44:47], v[100:103]
    ds_read_b128 v[28:31], v5 offset:32768
    s_waitcnt lgkmcnt(9)
    v_mfma_f32_16x16x32_bf16 v[104:107], v[16:19], v[44:47], v[104:107]
    ds_read_b64_tr_b16 v[60:61], v10 offset:20480
    s_waitcnt lgkmcnt(9)
    v_mfma_f32_16x16x32_bf16 v[108:111], v[20:23], v[44:47], v[108:111]
    ds_read_b64_tr_b16 v[62:63], v10 offset:20992
    s_waitcnt lgkmcnt(9)
    v_mfma_f32_16x16x32_bf16 v[112:115], v[24:27], v[44:47], v[112:115]
    ds_read_b128 v[32:35], v5 offset:34816
    s_waitcnt lgkmcnt(8)
    v_mfma_f32_16x16x32_bf16 v[116:119], v[12:15], v[48:51], v[116:119]
    ds_read_b128 v[36:39], v5 offset:36864
    v_mfma_f32_16x16x32_bf16 v[120:123], v[16:19], v[48:51], v[120:123]
    ds_read_b128 v[40:43], v5 offset:38912
    v_mfma_f32_16x16x32_bf16 v[124:127], v[20:23], v[48:51], v[124:127]
    ds_read_b64_tr_b16 v[64:65], v11 offset:20480
    v_mfma_f32_16x16x32_bf16 v[128:131], v[24:27], v[48:51], v[128:131]
    ds_read_b64_tr_b16 v[66:67], v11 offset:20992
    s_waitcnt lgkmcnt(10)
    v_mfma_f32_16x16x32_bf16 v[132:135], v[12:15], v[52:55], v[132:135]
    ds_read_b64_tr_b16 v[44:45], v10 offset:28672
    v_mfma_f32_16x16x32_bf16 v[136:139], v[16:19], v[52:55], v[136:139]
    ds_read_b64_tr_b16 v[46:47], v10 offset:29184
    v_mfma_f32_16x16x32_bf16 v[140:143], v[20:23], v[52:55], v[140:143]
    ds_read_b64_tr_b16 v[48:49], v11 offset:28672
    v_mfma_f32_16x16x32_bf16 v[144:147], v[24:27], v[52:55], v[144:147]
    ds_read_b64_tr_b16 v[50:51], v11 offset:29184
    s_waitcnt lgkmcnt(12)
    v_mfma_f32_16x16x32_bf16 v[148:151], v[12:15], v[56:59], v[148:151]
    v_mfma_f32_16x16x32_bf16 v[152:155], v[16:19], v[56:59], v[152:155]
    v_mfma_f32_16x16x32_bf16 v[156:159], v[20:23], v[56:59], v[156:159]
    v_mfma_f32_16x16x32_bf16 v[160:163], v[24:27], v[56:59], v[160:163]
    s_waitcnt lgkmcnt(9)
    v_mfma_f32_16x16x32_bf16 v[100:103], v[28:31], v[60:63], v[100:103]
    s_waitcnt lgkmcnt(8)
    v_mfma_f32_16x16x32_bf16 v[104:107], v[32:35], v[60:63], v[104:107]
    s_waitcnt lgkmcnt(0)
    s_barrier
    v_mfma_f32_16x16x32_bf16 v[108:111], v[36:39], v[60:63], v[108:111]
    ds_read_b128 v[12:15], v4 offset:49152
    v_mfma_f32_16x16x32_bf16 v[112:115], v[40:43], v[60:63], v[112:115]
    ds_read_b64_tr_b16 v[52:53], v8 offset:0
    v_mfma_f32_16x16x32_bf16 v[116:119], v[28:31], v[64:67], v[116:119]
    ds_read_b64_tr_b16 v[54:55], v8 offset:512
    v_mfma_f32_16x16x32_bf16 v[120:123], v[32:35], v[64:67], v[120:123]
    ds_read_b128 v[16:19], v4 offset:51200
    v_mfma_f32_16x16x32_bf16 v[124:127], v[36:39], v[64:67], v[124:127]
    ds_read_b128 v[20:23], v4 offset:53248
    v_mfma_f32_16x16x32_bf16 v[128:131], v[40:43], v[64:67], v[128:131]
    ds_read_b128 v[24:27], v4 offset:55296
    v_mfma_f32_16x16x32_bf16 v[132:135], v[28:31], v[44:47], v[132:135]
    ds_read_b64_tr_b16 v[56:57], v9 offset:0
    v_mfma_f32_16x16x32_bf16 v[136:139], v[32:35], v[44:47], v[136:139]
    ds_read_b64_tr_b16 v[58:59], v9 offset:512
    v_mfma_f32_16x16x32_bf16 v[140:143], v[36:39], v[44:47], v[140:143]
    ds_read_b64_tr_b16 v[60:61], v10 offset:32768
    v_mfma_f32_16x16x32_bf16 v[144:147], v[40:43], v[44:47], v[144:147]
    ds_read_b64_tr_b16 v[62:63], v10 offset:33280
    v_mfma_f32_16x16x32_bf16 v[148:151], v[28:31], v[48:51], v[148:151]
    ds_read_b64_tr_b16 v[64:65], v11 offset:32768
    v_mfma_f32_16x16x32_bf16 v[152:155], v[32:35], v[48:51], v[152:155]
    ds_read_b64_tr_b16 v[66:67], v11 offset:33280
    v_mfma_f32_16x16x32_bf16 v[156:159], v[36:39], v[48:51], v[156:159]
    v_mfma_f32_16x16x32_bf16 v[160:163], v[40:43], v[48:51], v[160:163]
    s_waitcnt lgkmcnt(9)
    v_mfma_f32_16x16x32_bf16 v[100:103], v[12:15], v[52:55], v[100:103]
    ds_read_b128 v[28:31], v5 offset:49152
    s_waitcnt lgkmcnt(9)
    v_mfma_f32_16x16x32_bf16 v[104:107], v[16:19], v[52:55], v[104:107]
    ds_read_b64_tr_b16 v[44:45], v8 offset:4096
    s_waitcnt lgkmcnt(9)
    v_mfma_f32_16x16x32_bf16 v[108:111], v[20:23], v[52:55], v[108:111]
    ds_read_b64_tr_b16 v[46:47], v8 offset:4608
    s_waitcnt lgkmcnt(9)
    v_mfma_f32_16x16x32_bf16 v[112:115], v[24:27], v[52:55], v[112:115]
    ds_read_b128 v[32:35], v5 offset:51200
    s_waitcnt lgkmcnt(8)
    v_mfma_f32_16x16x32_bf16 v[116:119], v[12:15], v[56:59], v[116:119]
    ds_read_b128 v[36:39], v5 offset:53248
    v_mfma_f32_16x16x32_bf16 v[120:123], v[16:19], v[56:59], v[120:123]
    ds_read_b128 v[40:43], v5 offset:55296
    v_mfma_f32_16x16x32_bf16 v[124:127], v[20:23], v[56:59], v[124:127]
    ds_read_b64_tr_b16 v[48:49], v9 offset:4096
    v_mfma_f32_16x16x32_bf16 v[128:131], v[24:27], v[56:59], v[128:131]
    ds_read_b64_tr_b16 v[50:51], v9 offset:4608
    s_waitcnt lgkmcnt(10)
    v_mfma_f32_16x16x32_bf16 v[132:135], v[12:15], v[60:63], v[132:135]
    ds_read_b64_tr_b16 v[52:53], v10 offset:36864
    v_mfma_f32_16x16x32_bf16 v[136:139], v[16:19], v[60:63], v[136:139]
    ds_read_b64_tr_b16 v[54:55], v10 offset:37376
    v_mfma_f32_16x16x32_bf16 v[140:143], v[20:23], v[60:63], v[140:143]
    ds_read_b64_tr_b16 v[56:57], v11 offset:36864
    v_mfma_f32_16x16x32_bf16 v[144:147], v[24:27], v[60:63], v[144:147]
    ds_read_b64_tr_b16 v[58:59], v11 offset:37376
    s_waitcnt lgkmcnt(12)
    v_mfma_f32_16x16x32_bf16 v[148:151], v[12:15], v[64:67], v[148:151]
    v_mfma_f32_16x16x32_bf16 v[152:155], v[16:19], v[64:67], v[152:155]
    v_mfma_f32_16x16x32_bf16 v[156:159], v[20:23], v[64:67], v[156:159]
    v_mfma_f32_16x16x32_bf16 v[160:163], v[24:27], v[64:67], v[160:163]
    s_waitcnt lgkmcnt(9)
    v_mfma_f32_16x16x32_bf16 v[100:103], v[28:31], v[44:47], v[100:103]
    s_waitcnt lgkmcnt(8)
    v_mfma_f32_16x16x32_bf16 v[104:107], v[32:35], v[44:47], v[104:107]
    s_waitcnt lgkmcnt(0)
    s_barrier
    v_mfma_f32_16x16x32_bf16 v[108:111], v[36:39], v[44:47], v[108:111]
    ds_read_b128 v[12:15], v4 offset:0
    v_mfma_f32_16x16x32_bf16 v[112:115], v[40:43], v[44:47], v[112:115]
    ds_read_b64_tr_b16 v[60:61], v8 offset:8192
    v_mfma_f32_16x16x32_bf16 v[116:119], v[28:31], v[48:51], v[116:119]
    ds_read_b64_tr_b16 v[62:63], v8 offset:8704
    v_mfma_f32_16x16x32_bf16 v[120:123], v[32:35], v[48:51], v[120:123]
    ds_read_b128 v[16:19], v4 offset:2048
    v_mfma_f32_16x16x32_bf16 v[124:127], v[36:39], v[48:51], v[124:127]
    ds_read_b128 v[20:23], v4 offset:4096
    v_mfma_f32_16x16x32_bf16 v[128:131], v[40:43], v[48:51], v[128:131]
    ds_read_b128 v[24:27], v4 offset:6144
    v_mfma_f32_16x16x32_bf16 v[132:135], v[28:31], v[52:55], v[132:135]
    ds_read_b64_tr_b16 v[64:65], v9 offset:8192
    v_mfma_f32_16x16x32_bf16 v[136:139], v[32:35], v[52:55], v[136:139]
    ds_read_b64_tr_b16 v[66:67], v9 offset:8704
    v_mfma_f32_16x16x32_bf16 v[140:143], v[36:39], v[52:55], v[140:143]
    ds_read_b64_tr_b16 v[44:45], v8 offset:16384
    v_mfma_f32_16x16x32_bf16 v[144:147], v[40:43], v[52:55], v[144:147]
    ds_read_b64_tr_b16 v[46:47], v8 offset:16896
    v_mfma_f32_16x16x32_bf16 v[148:151], v[28:31], v[56:59], v[148:151]
    ds_read_b64_tr_b16 v[48:49], v9 offset:16384
    v_mfma_f32_16x16x32_bf16 v[152:155], v[32:35], v[56:59], v[152:155]
    ds_read_b64_tr_b16 v[50:51], v9 offset:16896
    v_mfma_f32_16x16x32_bf16 v[156:159], v[36:39], v[56:59], v[156:159]
    v_mfma_f32_16x16x32_bf16 v[160:163], v[40:43], v[56:59], v[160:163]
    s_waitcnt lgkmcnt(9)
    v_mfma_f32_16x16x32_bf16 v[100:103], v[12:15], v[60:63], v[100:103]
    ds_read_b128 v[28:31], v5 offset:0
    s_waitcnt lgkmcnt(9)
    v_mfma_f32_16x16x32_bf16 v[104:107], v[16:19], v[60:63], v[104:107]
    ds_read_b64_tr_b16 v[52:53], v8 offset:12288
    s_waitcnt lgkmcnt(9)
    v_mfma_f32_16x16x32_bf16 v[108:111], v[20:23], v[60:63], v[108:111]
    ds_read_b64_tr_b16 v[54:55], v8 offset:12800
    s_waitcnt lgkmcnt(9)
    v_mfma_f32_16x16x32_bf16 v[112:115], v[24:27], v[60:63], v[112:115]
    ds_read_b128 v[32:35], v5 offset:2048
    s_waitcnt lgkmcnt(8)
    v_mfma_f32_16x16x32_bf16 v[116:119], v[12:15], v[64:67], v[116:119]
    ds_read_b128 v[36:39], v5 offset:4096
    v_mfma_f32_16x16x32_bf16 v[120:123], v[16:19], v[64:67], v[120:123]
    ds_read_b128 v[40:43], v5 offset:6144
    v_mfma_f32_16x16x32_bf16 v[124:127], v[20:23], v[64:67], v[124:127]
    ds_read_b64_tr_b16 v[56:57], v9 offset:12288
    v_mfma_f32_16x16x32_bf16 v[128:131], v[24:27], v[64:67], v[128:131]
    ds_read_b64_tr_b16 v[58:59], v9 offset:12800
    s_waitcnt lgkmcnt(10)
    v_mfma_f32_16x16x32_bf16 v[132:135], v[12:15], v[44:47], v[132:135]
    ds_read_b64_tr_b16 v[60:61], v8 offset:20480
    v_mfma_f32_16x16x32_bf16 v[136:139], v[16:19], v[44:47], v[136:139]
    ds_read_b64_tr_b16 v[62:63], v8 offset:20992
    v_mfma_f32_16x16x32_bf16 v[140:143], v[20:23], v[44:47], v[140:143]
    ds_read_b64_tr_b16 v[64:65], v9 offset:20480
    v_mfma_f32_16x16x32_bf16 v[144:147], v[24:27], v[44:47], v[144:147]
    ds_read_b64_tr_b16 v[66:67], v9 offset:20992
    s_waitcnt lgkmcnt(12)
    v_mfma_f32_16x16x32_bf16 v[148:151], v[12:15], v[48:51], v[148:151]
    v_mfma_f32_16x16x32_bf16 v[152:155], v[16:19], v[48:51], v[152:155]
    v_mfma_f32_16x16x32_bf16 v[156:159], v[20:23], v[48:51], v[156:159]
    v_mfma_f32_16x16x32_bf16 v[160:163], v[24:27], v[48:51], v[160:163]
    s_waitcnt lgkmcnt(9)
    v_mfma_f32_16x16x32_bf16 v[100:103], v[28:31], v[52:55], v[100:103]
    s_waitcnt lgkmcnt(8)
    v_mfma_f32_16x16x32_bf16 v[104:107], v[32:35], v[52:55], v[104:107]
    s_waitcnt lgkmcnt(0)
    s_barrier
    v_mfma_f32_16x16x32_bf16 v[108:111], v[36:39], v[52:55], v[108:111]
    ds_read_b128 v[12:15], v4 offset:16384
    v_mfma_f32_16x16x32_bf16 v[112:115], v[40:43], v[52:55], v[112:115]
    ds_read_b64_tr_b16 v[44:45], v8 offset:24576
    v_mfma_f32_16x16x32_bf16 v[116:119], v[28:31], v[56:59], v[116:119]
    ds_read_b64_tr_b16 v[46:47], v8 offset:25088
    v_mfma_f32_16x16x32_bf16 v[120:123], v[32:35], v[56:59], v[120:123]
    ds_read_b128 v[16:19], v4 offset:18432
    v_mfma_f32_16x16x32_bf16 v[124:127], v[36:39], v[56:59], v[124:127]
    ds_read_b128 v[20:23], v4 offset:20480
    v_mfma_f32_16x16x32_bf16 v[128:131], v[40:43], v[56:59], v[128:131]
    ds_read_b128 v[24:27], v4 offset:22528
    v_mfma_f32_16x16x32_bf16 v[132:135], v[28:31], v[60:63], v[132:135]
    ds_read_b64_tr_b16 v[48:49], v9 offset:24576
    v_mfma_f32_16x16x32_bf16 v[136:139], v[32:35], v[60:63], v[136:139]
    ds_read_b64_tr_b16 v[50:51], v9 offset:25088
    v_mfma_f32_16x16x32_bf16 v[140:143], v[36:39], v[60:63], v[140:143]
    ds_read_b64_tr_b16 v[52:53], v10 offset:0
    v_mfma_f32_16x16x32_bf16 v[144:147], v[40:43], v[60:63], v[144:147]
    ds_read_b64_tr_b16 v[54:55], v10 offset:512
    v_mfma_f32_16x16x32_bf16 v[148:151], v[28:31], v[64:67], v[148:151]
    ds_read_b64_tr_b16 v[56:57], v11 offset:0
    v_mfma_f32_16x16x32_bf16 v[152:155], v[32:35], v[64:67], v[152:155]
    ds_read_b64_tr_b16 v[58:59], v11 offset:512
    v_mfma_f32_16x16x32_bf16 v[156:159], v[36:39], v[64:67], v[156:159]
    v_mfma_f32_16x16x32_bf16 v[160:163], v[40:43], v[64:67], v[160:163]
    s_waitcnt lgkmcnt(9)
    v_mfma_f32_16x16x32_bf16 v[100:103], v[12:15], v[44:47], v[100:103]
    ds_read_b128 v[28:31], v5 offset:16384
    s_waitcnt lgkmcnt(9)
    v_mfma_f32_16x16x32_bf16 v[104:107], v[16:19], v[44:47], v[104:107]
    ds_read_b64_tr_b16 v[60:61], v8 offset:28672
    s_waitcnt lgkmcnt(9)
    v_mfma_f32_16x16x32_bf16 v[108:111], v[20:23], v[44:47], v[108:111]
    ds_read_b64_tr_b16 v[62:63], v8 offset:29184
    s_waitcnt lgkmcnt(9)
    v_mfma_f32_16x16x32_bf16 v[112:115], v[24:27], v[44:47], v[112:115]
    ds_read_b128 v[32:35], v5 offset:18432
    s_waitcnt lgkmcnt(8)
    v_mfma_f32_16x16x32_bf16 v[116:119], v[12:15], v[48:51], v[116:119]
    ds_read_b128 v[36:39], v5 offset:20480
    v_mfma_f32_16x16x32_bf16 v[120:123], v[16:19], v[48:51], v[120:123]
    ds_read_b128 v[40:43], v5 offset:22528
    v_mfma_f32_16x16x32_bf16 v[124:127], v[20:23], v[48:51], v[124:127]
    ds_read_b64_tr_b16 v[64:65], v9 offset:28672
    v_mfma_f32_16x16x32_bf16 v[128:131], v[24:27], v[48:51], v[128:131]
    ds_read_b64_tr_b16 v[66:67], v9 offset:29184
    s_waitcnt lgkmcnt(10)
    v_mfma_f32_16x16x32_bf16 v[132:135], v[12:15], v[52:55], v[132:135]
    ds_read_b64_tr_b16 v[44:45], v10 offset:4096
    v_mfma_f32_16x16x32_bf16 v[136:139], v[16:19], v[52:55], v[136:139]
    ds_read_b64_tr_b16 v[46:47], v10 offset:4608
    v_mfma_f32_16x16x32_bf16 v[140:143], v[20:23], v[52:55], v[140:143]
    ds_read_b64_tr_b16 v[48:49], v11 offset:4096
    v_mfma_f32_16x16x32_bf16 v[144:147], v[24:27], v[52:55], v[144:147]
    ds_read_b64_tr_b16 v[50:51], v11 offset:4608
    s_waitcnt lgkmcnt(12)
    v_mfma_f32_16x16x32_bf16 v[148:151], v[12:15], v[56:59], v[148:151]
    v_mfma_f32_16x16x32_bf16 v[152:155], v[16:19], v[56:59], v[152:155]
    v_mfma_f32_16x16x32_bf16 v[156:159], v[20:23], v[56:59], v[156:159]
    v_mfma_f32_16x16x32_bf16 v[160:163], v[24:27], v[56:59], v[160:163]
    s_waitcnt lgkmcnt(9)
    v_mfma_f32_16x16x32_bf16 v[100:103], v[28:31], v[60:63], v[100:103]
    s_waitcnt lgkmcnt(8)
    v_mfma_f32_16x16x32_bf16 v[104:107], v[32:35], v[60:63], v[104:107]
    s_waitcnt lgkmcnt(0)
    s_barrier
    v_mfma_f32_16x16x32_bf16 v[108:111], v[36:39], v[60:63], v[108:111]
    ds_read_b128 v[12:15], v4 offset:32768
    v_mfma_f32_16x16x32_bf16 v[112:115], v[40:43], v[60:63], v[112:115]
    ds_read_b64_tr_b16 v[52:53], v10 offset:16384
    v_mfma_f32_16x16x32_bf16 v[116:119], v[28:31], v[64:67], v[116:119]
    ds_read_b64_tr_b16 v[54:55], v10 offset:16896
    v_mfma_f32_16x16x32_bf16 v[120:123], v[32:35], v[64:67], v[120:123]
    ds_read_b128 v[16:19], v4 offset:34816
    v_mfma_f32_16x16x32_bf16 v[124:127], v[36:39], v[64:67], v[124:127]
    ds_read_b128 v[20:23], v4 offset:36864
    v_mfma_f32_16x16x32_bf16 v[128:131], v[40:43], v[64:67], v[128:131]
    ds_read_b128 v[24:27], v4 offset:38912
    v_mfma_f32_16x16x32_bf16 v[132:135], v[28:31], v[44:47], v[132:135]
    ds_read_b64_tr_b16 v[56:57], v11 offset:16384
    v_mfma_f32_16x16x32_bf16 v[136:139], v[32:35], v[44:47], v[136:139]
    ds_read_b64_tr_b16 v[58:59], v11 offset:16896
    v_mfma_f32_16x16x32_bf16 v[140:143], v[36:39], v[44:47], v[140:143]
    ds_read_b64_tr_b16 v[60:61], v10 offset:24576
    v_mfma_f32_16x16x32_bf16 v[144:147], v[40:43], v[44:47], v[144:147]
    ds_read_b64_tr_b16 v[62:63], v10 offset:25088
    v_mfma_f32_16x16x32_bf16 v[148:151], v[28:31], v[48:51], v[148:151]
    ds_read_b64_tr_b16 v[64:65], v11 offset:24576
    v_mfma_f32_16x16x32_bf16 v[152:155], v[32:35], v[48:51], v[152:155]
    ds_read_b64_tr_b16 v[66:67], v11 offset:25088
    v_mfma_f32_16x16x32_bf16 v[156:159], v[36:39], v[48:51], v[156:159]
    v_mfma_f32_16x16x32_bf16 v[160:163], v[40:43], v[48:51], v[160:163]
    s_waitcnt lgkmcnt(9)
    v_mfma_f32_16x16x32_bf16 v[100:103], v[12:15], v[52:55], v[100:103]
    ds_read_b128 v[28:31], v5 offset:32768
    s_waitcnt lgkmcnt(9)
    v_mfma_f32_16x16x32_bf16 v[104:107], v[16:19], v[52:55], v[104:107]
    ds_read_b64_tr_b16 v[44:45], v10 offset:20480
    s_waitcnt lgkmcnt(9)
    v_mfma_f32_16x16x32_bf16 v[108:111], v[20:23], v[52:55], v[108:111]
    ds_read_b64_tr_b16 v[46:47], v10 offset:20992
    s_waitcnt lgkmcnt(9)
    v_mfma_f32_16x16x32_bf16 v[112:115], v[24:27], v[52:55], v[112:115]
    ds_read_b128 v[32:35], v5 offset:34816
    s_waitcnt lgkmcnt(8)
    v_mfma_f32_16x16x32_bf16 v[116:119], v[12:15], v[56:59], v[116:119]
    ds_read_b128 v[36:39], v5 offset:36864
    v_mfma_f32_16x16x32_bf16 v[120:123], v[16:19], v[56:59], v[120:123]
    ds_read_b128 v[40:43], v5 offset:38912
    v_mfma_f32_16x16x32_bf16 v[124:127], v[20:23], v[56:59], v[124:127]
    ds_read_b64_tr_b16 v[48:49], v11 offset:20480
    v_mfma_f32_16x16x32_bf16 v[128:131], v[24:27], v[56:59], v[128:131]
    ds_read_b64_tr_b16 v[50:51], v11 offset:20992
    s_waitcnt lgkmcnt(10)
    v_mfma_f32_16x16x32_bf16 v[132:135], v[12:15], v[60:63], v[132:135]
    ds_read_b64_tr_b16 v[52:53], v10 offset:28672
    v_mfma_f32_16x16x32_bf16 v[136:139], v[16:19], v[60:63], v[136:139]
    ds_read_b64_tr_b16 v[54:55], v10 offset:29184
    v_mfma_f32_16x16x32_bf16 v[140:143], v[20:23], v[60:63], v[140:143]
    ds_read_b64_tr_b16 v[56:57], v11 offset:28672
    v_mfma_f32_16x16x32_bf16 v[144:147], v[24:27], v[60:63], v[144:147]
    ds_read_b64_tr_b16 v[58:59], v11 offset:29184
    s_waitcnt lgkmcnt(12)
    v_mfma_f32_16x16x32_bf16 v[148:151], v[12:15], v[64:67], v[148:151]
    v_mfma_f32_16x16x32_bf16 v[152:155], v[16:19], v[64:67], v[152:155]
    v_mfma_f32_16x16x32_bf16 v[156:159], v[20:23], v[64:67], v[156:159]
    v_mfma_f32_16x16x32_bf16 v[160:163], v[24:27], v[64:67], v[160:163]
    s_waitcnt lgkmcnt(9)
    v_mfma_f32_16x16x32_bf16 v[100:103], v[28:31], v[44:47], v[100:103]
    s_waitcnt lgkmcnt(8)
    v_mfma_f32_16x16x32_bf16 v[104:107], v[32:35], v[44:47], v[104:107]
    s_waitcnt lgkmcnt(0)
    s_barrier
    v_mfma_f32_16x16x32_bf16 v[108:111], v[36:39], v[44:47], v[108:111]
    ds_read_b128 v[12:15], v4 offset:49152
    v_mfma_f32_16x16x32_bf16 v[112:115], v[40:43], v[44:47], v[112:115]
    ds_read_b64_tr_b16 v[60:61], v8 offset:0
    v_mfma_f32_16x16x32_bf16 v[116:119], v[28:31], v[48:51], v[116:119]
    ds_read_b64_tr_b16 v[62:63], v8 offset:512
    v_mfma_f32_16x16x32_bf16 v[120:123], v[32:35], v[48:51], v[120:123]
    ds_read_b128 v[16:19], v4 offset:51200
    v_mfma_f32_16x16x32_bf16 v[124:127], v[36:39], v[48:51], v[124:127]
    ds_read_b128 v[20:23], v4 offset:53248
    v_mfma_f32_16x16x32_bf16 v[128:131], v[40:43], v[48:51], v[128:131]
    ds_read_b128 v[24:27], v4 offset:55296
    v_mfma_f32_16x16x32_bf16 v[132:135], v[28:31], v[52:55], v[132:135]
    ds_read_b64_tr_b16 v[64:65], v9 offset:0
    v_mfma_f32_16x16x32_bf16 v[136:139], v[32:35], v[52:55], v[136:139]
    ds_read_b64_tr_b16 v[66:67], v9 offset:512
    v_mfma_f32_16x16x32_bf16 v[140:143], v[36:39], v[52:55], v[140:143]
    ds_read_b64_tr_b16 v[44:45], v10 offset:32768
    s_branch IW_s4
IW_w4:
    s_branch IW_r4
IW_s4:
    v_mfma_f32_16x16x32_bf16 v[144:147], v[40:43], v[52:55], v[144:147]
    ds_read_b64_tr_b16 v[46:47], v10 offset:33280
    v_mfma_f32_16x16x32_bf16 v[148:151], v[28:31], v[56:59], v[148:151]
    ds_read_b64_tr_b16 v[48:49], v11 offset:32768
    v_mfma_f32_16x16x32_bf16 v[152:155], v[32:35], v[56:59], v[152:155]
    ds_read_b64_tr_b16 v[50:51], v11 offset:33280
    v_mfma_f32_16x16x32_bf16 v[156:159], v[36:39], v[56:59], v[156:159]
    v_mfma_f32_16x16x32_bf16 v[160:163], v[40:43], v[56:59], v[160:163]
    s_waitcnt lgkmcnt(9)
    v_mfma_f32_16x16x32_bf16 v[100:103], v[12:15], v[60:63], v[100:103]
    ds_read_b128 v[28:31], v5 offset:49152
    s_waitcnt lgkmcnt(9)
    v_mfma_f32_16x16x32_bf16 v[104:107], v[16:19], v[60:63], v[104:107]
    ds_read_b64_tr_b16 v[52:53], v8 offset:4096
    s_waitcnt lgkmcnt(9)
    v_mfma_f32_16x16x32_bf16 v[108:111], v[20:23], v[60:63], v[108:111]
    ds_read_b64_tr_b16 v[54:55], v8 offset:4608
    s_waitcnt lgkmcnt(9)
    v_mfma_f32_16x16x32_bf16 v[112:115], v[24:27], v[60:63], v[112:115]
    ds_read_b128 v[32:35], v5 offset:51200
    s_waitcnt lgkmcnt(8)
    v_mfma_f32_16x16x32_bf16 v[116:119], v[12:15], v[64:67], v[116:119]
    ds_read_b128 v[36:39], v5 offset:53248
    v_mfma_f32_16x16x32_bf16 v[120:123], v[16:19], v[64:67], v[120:123]
    ds_read_b128 v[40:43], v5 offset:55296
    v_mfma_f32_16x16x32_bf16 v[124:127], v[20:23], v[64:67], v[124:127]
    ds_read_b64_tr_b16 v[56:57], v9 offset:4096
    v_mfma_f32_16x16x32_bf16 v[128:131], v[24:27], v[64:67], v[128:131]
    ds_read_b64_tr_b16 v[58:59], v9 offset:4608
    s_waitcnt lgkmcnt(10)
    v_mfma_f32_16x16x32_bf16 v[132:135], v[12:15], v[44:47], v[132:135]
    ds_read_b64_tr_b16 v[60:61], v10 offset:36864
    v_mfma_f32_16x16x32_bf16 v[136:139], v[16:19], v[44:47], v[136:139]
    ds_read_b64_tr_b16 v[62:63], v10 offset:37376
    v_mfma_f32_16x16x32_bf16 v[140:143], v[20:23], v[44:47], v[140:143]
    ds_read_b64_tr_b16 v[64:65], v11 offset:36864
    v_mfma_f32_16x16x32_bf16 v[144:147], v[24:27], v[44:47], v[144:147]
    ds_read_b64_tr_b16 v[66:67], v11 offset:37376
    s_waitcnt lgkmcnt(12)
    v_mfma_f32_16x16x32_bf16 v[148:151], v[12:15], v[48:51], v[148:151]
    v_mfma_f32_16x16x32_bf16 v[152:155], v[16:19], v[48:51], v[152:155]
    v_mfma_f32_16x16x32_bf16 v[156:159], v[20:23], v[48:51], v[156:159]
    v_mfma_f32_16x16x32_bf16 v[160:163], v[24:27], v[48:51], v[160:163]
    s_waitcnt lgkmcnt(9)
    v_mfma_f32_16x16x32_bf16 v[100:103], v[28:31], v[52:55], v[100:103]
    s_waitcnt lgkmcnt(8)
    v_mfma_f32_16x16x32_bf16 v[104:107], v[32:35], v[52:55], v[104:107]
    s_waitcnt lgkmcnt(0)
    s_barrier
    v_mfma_f32_16x16x32_bf16 v[108:111], v[36:39], v[52:55], v[108:111]
    ds_read_b128 v[12:15], v4 offset:0
    v_mfma_f32_16x16x32_bf16 v[112:115], v[40:43], v[52:55], v[112:115]
    ds_read_b64_tr_b16 v[44:45], v8 offset:8192
    v_mfma_f32_16x16x32_bf16 v[116:119], v[28:31], v[56:59], v[116:119]
    ds_read_b64_tr_b16 v[46:47], v8 offset:8704
    v_mfma_f32_16x16x32_bf16 v[120:123], v[32:35], v[56:59], v[120:123]
    ds_read_b128 v[16:19], v4 offset:2048
    v_mfma_f32_16x16x32_bf16 v[124:127], v[36:39], v[56:59], v[124:127]
    ds_read_b128 v[20:23], v4 offset:4096
    v_mfma_f32_16x16x32_bf16 v[128:131], v[40:43], v[56:59], v[128:131]
    ds_read_b128 v[24:27], v4 offset:6144
    v_mfma_f32_16x16x32_bf16 v[132:135], v[28:31], v[60:63], v[132:135]
    ds_read_b64_tr_b16 v[48:49], v9 offset:8192
    v_mfma_f32_16x16x32_bf16 v[136:139], v[32:35], v[60:63], v[136:139]
    ds_read_b64_tr_b16 v[50:51], v9 offset:8704
    v_mfma_f32_16x16x32_bf16 v[140:143], v[36:39], v[60:63], v[140:143]
    ds_read_b64_tr_b16 v[52:53], v8 offset:16384
    v_mfma_f32_16x16x32_bf16 v[144:147], v[40:43], v[60:63], v[144:147]
    ds_read_b64_tr_b16 v[54:55], v8 offset:16896
    v_mfma_f32_16x16x32_bf16 v[148:151], v[28:31], v[64:67], v[148:151]
    ds_read_b64_tr_b16 v[56:57], v9 offset:16384
    v_mfma_f32_16x16x32_bf16 v[152:155], v[32:35], v[64:67], v[152:155]
    ds_read_b64_tr_b16 v[58:59], v9 offset:16896
    v_mfma_f32_16x16x32_bf16 v[156:159], v[36:39], v[64:67], v[156:159]
    v_mfma_f32_16x16x32_bf16 v[160:163], v[40:43], v[64:67], v[160:163]
    s_waitcnt lgkmcnt(9)
    v_mfma_f32_16x16x32_bf16 v[100:103], v[12:15], v[44:47], v[100:103]
    ds_read_b128 v[28:31], v5 offset:0
    s_waitcnt lgkmcnt(9)
    v_mfma_f32_16x16x32_bf16 v[104:107], v[16:19], v[44:47], v[104:107]
    ds_read_b64_tr_b16 v[60:61], v8 offset:12288
    s_waitcnt lgkmcnt(9)
    v_mfma_f32_16x16x32_bf16 v[108:111], v[20:23], v[44:47], v[108:111]
    ds_read_b64_tr_b16 v[62:63], v8 offset:12800
    s_waitcnt lgkmcnt(9)
    v_mfma_f32_16x16x32_bf16 v[112:115], v[24:27], v[44:47], v[112:115]
    ds_read_b128 v[32:35], v5 offset:2048
    s_waitcnt lgkmcnt(8)
    v_mfma_f32_16x16x32_bf16 v[116:119], v[12:15], v[48:51], v[116:119]
    ds_read_b128 v[36:39], v5 offset:4096
    v_mfma_f32_16x16x32_bf16 v[120:123], v[16:19], v[48:51], v[120:123]
    ds_read_b128 v[40:43], v5 offset:6144
    v_mfma_f32_16x16x32_bf16 v[124:127], v[20:23], v[48:51], v[124:127]
    ds_read_b64_tr_b16 v[64:65], v9 offset:12288
    v_mfma_f32_16x16x32_bf16 v[128:131], v[24:27], v[48:51], v[128:131]
    ds_read_b64_tr_b16 v[66:67], v9 offset:12800
    s_waitcnt lgkmcnt(10)
    v_mfma_f32_16x16x32_bf16 v[132:135], v[12:15], v[52:55], v[132:135]
    ds_read_b64_tr_b16 v[44:45], v8 offset:20480
    v_mfma_f32_16x16x32_bf16 v[136:139], v[16:19], v[52:55], v[136:139]
    ds_read_b64_tr_b16 v[46:47], v8 offset:20992
    v_mfma_f32_16x16x32_bf16 v[140:143], v[20:23], v[52:55], v[140:143]
    ds_read_b64_tr_b16 v[48:49], v9 offset:20480
    v_mfma_f32_16x16x32_bf16 v[144:147], v[24:27], v[52:55], v[144:147]
    ds_read_b64_tr_b16 v[50:51], v9 offset:20992
    s_waitcnt lgkmcnt(12)
    v_mfma_f32_16x16x32_bf16 v[148:151], v[12:15], v[56:59], v[148:151]
    v_mfma_f32_16x16x32_bf16 v[152:155], v[16:19], v[56:59], v[152:155]
    v_mfma_f32_16x16x32_bf16 v[156:159], v[20:23], v[56:59], v[156:159]
    v_mfma_f32_16x16x32_bf16 v[160:163], v[24:27], v[56:59], v[160:163]
    s_waitcnt lgkmcnt(9)
    v_mfma_f32_16x16x32_bf16 v[100:103], v[28:31], v[60:63], v[100:103]
    s_waitcnt lgkmcnt(8)
    v_mfma_f32_16x16x32_bf16 v[104:107], v[32:35], v[60:63], v[104:107]
    s_waitcnt lgkmcnt(0)
    s_barrier
    v_mfma_f32_16x16x32_bf16 v[108:111], v[36:39], v[60:63], v[108:111]
    ds_read_b128 v[12:15], v4 offset:16384
    v_mfma_f32_16x16x32_bf16 v[112:115], v[40:43], v[60:63], v[112:115]
    ds_read_b64_tr_b16 v[52:53], v8 offset:24576
    v_mfma_f32_16x16x32_bf16 v[116:119], v[28:31], v[64:67], v[116:119]
    ds_read_b64_tr_b16 v[54:55], v8 offset:25088
    v_mfma_f32_16x16x32_bf16 v[120:123], v[32:35], v[64:67], v[120:123]
    ds_read_b128 v[16:19], v4 offset:18432
    v_mfma_f32_16x16x32_bf16 v[124:127], v[36:39], v[64:67], v[124:127]
    ds_read_b128 v[20:23], v4 offset:20480
    v_mfma_f32_16x16x32_bf16 v[128:131], v[40:43], v[64:67], v[128:131]
    ds_read_b128 v[24:27], v4 offset:22528
    v_mfma_f32_16x16x32_bf16 v[132:135], v[28:31], v[44:47], v[132:135]
    ds_read_b64_tr_b16 v[56:57], v9 offset:24576
    v_mfma_f32_16x16x32_bf16 v[136:139], v[32:35], v[44:47], v[136:139]
    ds_read_b64_tr_b16 v[58:59], v9 offset:25088
    v_mfma_f32_16x16x32_bf16 v[140:143], v[36:39], v[44:47], v[140:143]
    ds_read_b64_tr_b16 v[60:61], v10 offset:0
    v_mfma_f32_16x16x32_bf16 v[144:147], v[40:43], v[44:47], v[144:147]
    ds_read_b64_tr_b16 v[62:63], v10 offset:512
    v_mfma_f32_16x16x32_bf16 v[148:151], v[28:31], v[48:51], v[148:151]
    ds_read_b64_tr_b16 v[64:65], v11 offset:0
    v_mfma_f32_16x16x32_bf16 v[152:155], v[32:35], v[48:51], v[152:155]
    ds_read_b64_tr_b16 v[66:67], v11 offset:512
    v_mfma_f32_16x16x32_bf16 v[156:159], v[36:39], v[48:51], v[156:159]
    v_mfma_f32_16x16x32_bf16 v[160:163], v[40:43], v[48:51], v[160:163]
    s_waitcnt lgkmcnt(9)
    v_mfma_f32_16x16x32_bf16 v[100:103], v[12:15], v[52:55], v[100:103]
    ds_read_b128 v[28:31], v5 offset:16384
    s_waitcnt lgkmcnt(9)
    v_mfma_f32_16x16x32_bf16 v[104:107], v[16:19], v[52:55], v[104:107]
    ds_read_b64_tr_b16 v[44:45], v8 offset:28672
    s_waitcnt lgkmcnt(9)
    v_mfma_f32_16x16x32_bf16 v[108:111], v[20:23], v[52:55], v[108:111]
    ds_read_b64_tr_b16 v[46:47], v8 offset:29184
    s_waitcnt lgkmcnt(9)
    v_mfma_f32_16x16x32_bf16 v[112:115], v[24:27], v[52:55], v[112:115]
    ds_read_b128 v[32:35], v5 offset:18432
    s_waitcnt lgkmcnt(8)
    v_mfma_f32_16x16x32_bf16 v[116:119], v[12:15], v[56:59], v[116:119]
    ds_read_b128 v[36:39], v5 offset:20480
    v_mfma_f32_16x16x32_bf16 v[120:123], v[16:19], v[56:59], v[120:123]
    ds_read_b128 v[40:43], v5 offset:22528
    v_mfma_f32_16x16x32_bf16 v[124:127], v[20:23], v[56:59], v[124:127]
    ds_read_b64_tr_b16 v[48:49], v9 offset:28672
    v_mfma_f32_16x16x32_bf16 v[128:131], v[24:27], v[56:59], v[128:131]
    ds_read_b64_tr_b16 v[50:51], v9 offset:29184
    s_waitcnt lgkmcnt(10)
    v_mfma_f32_16x16x32_bf16 v[132:135], v[12:15], v[60:63], v[132:135]
    ds_read_b64_tr_b16 v[52:53], v10 offset:4096
    v_mfma_f32_16x16x32_bf16 v[136:139], v[16:19], v[60:63], v[136:139]
    ds_read_b64_tr_b16 v[54:55], v10 offset:4608
    v_mfma_f32_16x16x32_bf16 v[140:143], v[20:23], v[60:63], v[140:143]
    ds_read_b64_tr_b16 v[56:57], v11 offset:4096
    v_mfma_f32_16x16x32_bf16 v[144:147], v[24:27], v[60:63], v[144:147]
    ds_read_b64_tr_b16 v[58:59], v11 offset:4608
    s_waitcnt lgkmcnt(12)
    v_mfma_f32_16x16x32_bf16 v[148:151], v[12:15], v[64:67], v[148:151]
    v_mfma_f32_16x16x32_bf16 v[152:155], v[16:19], v[64:67], v[152:155]
    v_mfma_f32_16x16x32_bf16 v[156:159], v[20:23], v[64:67], v[156:159]
    v_mfma_f32_16x16x32_bf16 v[160:163], v[24:27], v[64:67], v[160:163]
    s_waitcnt lgkmcnt(9)
    v_mfma_f32_16x16x32_bf16 v[100:103], v[28:31], v[44:47], v[100:103]
    s_waitcnt lgkmcnt(8)
    v_mfma_f32_16x16x32_bf16 v[104:107], v[32:35], v[44:47], v[104:107]
    s_waitcnt lgkmcnt(0)
    s_barrier
    v_mfma_f32_16x16x32_bf16 v[108:111], v[36:39], v[44:47], v[108:111]
    ds_read_b128 v[12:15], v4 offset:32768
    v_mfma_f32_16x16x32_bf16 v[112:115], v[40:43], v[44:47], v[112:115]
    ds_read_b64_tr_b16 v[60:61], v10 offset:8192
    v_mfma_f32_16x16x32_bf16 v[116:119], v[28:31], v[48:51], v[116:119]
    ds_read_b64_tr_b16 v[62:63], v10 offset:8704
    v_mfma_f32_16x16x32_bf16 v[120:123], v[32:35], v[48:51], v[120:123]
    ds_read_b128 v[16:19], v4 offset:34816
    v_mfma_f32_16x16x32_bf16 v[124:127], v[36:39], v[48:51], v[124:127]
    ds_read_b128 v[20:23], v4 offset:36864
    v_mfma_f32_16x16x32_bf16 v[128:131], v[40:43], v[48:51], v[128:131]
    ds_read_b128 v[24:27], v4 offset:38912
    v_mfma_f32_16x16x32_bf16 v[132:135], v[28:31], v[52:55], v[132:135]
    ds_read_b64_tr_b16 v[64:65], v11 offset:8192
    v_mfma_f32_16x16x32_bf16 v[136:139], v[32:35], v[52:55], v[136:139]
    ds_read_b64_tr_b16 v[66:67], v11 offset:8704
    v_mfma_f32_16x16x32_bf16 v[140:143], v[36:39], v[52:55], v[140:143]
    ds_read_b64_tr_b16 v[44:45], v10 offset:16384
    v_mfma_f32_16x16x32_bf16 v[144:147], v[40:43], v[52:55], v[144:147]
    ds_read_b64_tr_b16 v[46:47], v10 offset:16896
    v_mfma_f32_16x16x32_bf16 v[148:151], v[28:31], v[56:59], v[148:151]
    ds_read_b64_tr_b16 v[48:49], v11 offset:16384
    v_mfma_f32_16x16x32_bf16 v[152:155], v[32:35], v[56:59], v[152:155]
    ds_read_b64_tr_b16 v[50:51], v11 offset:16896
    v_mfma_f32_16x16x32_bf16 v[156:159], v[36:39], v[56:59], v[156:159]
    v_mfma_f32_16x16x32_bf16 v[160:163], v[40:43], v[56:59], v[160:163]
    s_waitcnt lgkmcnt(9)
    v_mfma_f32_16x16x32_bf16 v[100:103], v[12:15], v[60:63], v[100:103]
    ds_read_b128 v[28:31], v5 offset:32768
    s_waitcnt lgkmcnt(9)
    v_mfma_f32_16x16x32_bf16 v[104:107], v[16:19], v[60:63], v[104:107]
    ds_read_b64_tr_b16 v[52:53], v10 offset:12288
    s_waitcnt lgkmcnt(9)
    v_mfma_f32_16x16x32_bf16 v[108:111], v[20:23], v[60:63], v[108:111]
    ds_read_b64_tr_b16 v[54:55], v10 offset:12800
    s_waitcnt lgkmcnt(9)
    v_mfma_f32_16x16x32_bf16 v[112:115], v[24:27], v[60:63], v[112:115]
    ds_read_b128 v[32:35], v5 offset:34816
    s_waitcnt lgkmcnt(8)
    v_mfma_f32_16x16x32_bf16 v[116:119], v[12:15], v[64:67], v[116:119]
    ds_read_b128 v[36:39], v5 offset:36864
    v_mfma_f32_16x16x32_bf16 v[120:123], v[16:19], v[64:67], v[120:123]
    ds_read_b128 v[40:43], v5 offset:38912
    v_mfma_f32_16x16x32_bf16 v[124:127], v[20:23], v[64:67], v[124:127]
    ds_read_b64_tr_b16 v[56:57], v11 offset:12288
    v_mfma_f32_16x16x32_bf16 v[128:131], v[24:27], v[64:67], v[128:131]
    ds_read_b64_tr_b16 v[58:59], v11 offset:12800
    s_waitcnt lgkmcnt(10)
    v_mfma_f32_16x16x32_bf16 v[132:135], v[12:15], v[44:47], v[132:135]
    ds_read_b64_tr_b16 v[60:61], v10 offset:20480
    v_mfma_f32_16x16x32_bf16 v[136:139], v[16:19], v[44:47], v[136:139]
    ds_read_b64_tr_b16 v[62:63], v10 offset:20992
    v_mfma_f32_16x16x32_bf16 v[140:143], v[20:23], v[44:47], v[140:143]
    ds_read_b64_tr_b16 v[64:65], v11 offset:20480
    v_mfma_f32_16x16x32_bf16 v[144:147], v[24:27], v[44:47], v[144:147]
    ds_read_b64_tr_b16 v[66:67], v11 offset:20992
    s_waitcnt lgkmcnt(12)
    v_mfma_f32_16x16x32_bf16 v[148:151], v[12:15], v[48:51], v[148:151]
    v_mfma_f32_16x16x32_bf16 v[152:155], v[16:19], v[48:51], v[152:155]
    v_mfma_f32_16x16x32_bf16 v[156:159], v[20:23], v[48:51], v[156:159]
    v_mfma_f32_16x16x32_bf16 v[160:163], v[24:27], v[48:51], v[160:163]
    s_waitcnt lgkmcnt(9)
    v_mfma_f32_16x16x32_bf16 v[100:103], v[28:31], v[52:55], v[100:103]
    s_waitcnt lgkmcnt(8)
    v_mfma_f32_16x16x32_bf16 v[104:107], v[32:35], v[52:55], v[104:107]
    s_waitcnt lgkmcnt(0)
    s_barrier
    v_mfma_f32_16x16x32_bf16 v[108:111], v[36:39], v[52:55], v[108:111]
    ds_read_b128 v[12:15], v4 offset:49152
    v_mfma_f32_16x16x32_bf16 v[112:115], v[40:43], v[52:55], v[112:115]
    ds_read_b64_tr_b16 v[44:45], v8 offset:0
    v_mfma_f32_16x16x32_bf16 v[116:119], v[28:31], v[56:59], v[116:119]
    ds_read_b64_tr_b16 v[46:47], v8 offset:512
    v_mfma_f32_16x16x32_bf16 v[120:123], v[32:35], v[56:59], v[120:123]
    ds_read_b128 v[16:19], v4 offset:51200
    v_mfma_f32_16x16x32_bf16 v[124:127], v[36:39], v[56:59], v[124:127]
    ds_read_b128 v[20:23], v4 offset:53248
    v_mfma_f32_16x16x32_bf16 v[128:131], v[40:43], v[56:59], v[128:131]
    ds_read_b128 v[24:27], v4 offset:55296
    v_mfma_f32_16x16x32_bf16 v[132:135], v[28:31], v[60:63], v[132:135]
    ds_read_b64_tr_b16 v[48:49], v9 offset:0
    v_mfma_f32_16x16x32_bf16 v[136:139], v[32:35], v[60:63], v[136:139]
    ds_read_b64_tr_b16 v[50:51], v9 offset:512
    v_mfma_f32_16x16x32_bf16 v[140:143], v[36:39], v[60:63], v[140:143]
    ds_read_b64_tr_b16 v[52:53], v10 offset:24576
    v_mfma_f32_16x16x32_bf16 v[144:147], v[40:43], v[60:63], v[144:147]
    ds_read_b64_tr_b16 v[54:55], v10 offset:25088
    v_mfma_f32_16x16x32_bf16 v[148:151], v[28:31], v[64:67], v[148:151]
    ds_read_b64_tr_b16 v[56:57], v11 offset:24576
    v_mfma_f32_16x16x32_bf16 v[152:155], v[32:35], v[64:67], v[152:155]
    ds_read_b64_tr_b16 v[58:59], v11 offset:25088
    v_mfma_f32_16x16x32_bf16 v[156:159], v[36:39], v[64:67], v[156:159]
    v_mfma_f32_16x16x32_bf16 v[160:163], v[40:43], v[64:67], v[160:163]
    ds_read_b32 v68, v1 offset:48
    s_waitcnt lgkmcnt(10)
    v_mfma_f32_16x16x32_bf16 v[100:103], v[12:15], v[44:47], v[100:103]
    ds_read_b128 v[28:31], v5 offset:49152
    s_waitcnt lgkmcnt(10)
    v_mfma_f32_16x16x32_bf16 v[104:107], v[16:19], v[44:47], v[104:107]
    ds_read_b64_tr_b16 v[60:61], v8 offset:4096
    s_waitcnt lgkmcnt(10)
    v_mfma_f32_16x16x32_bf16 v[108:111], v[20:23], v[44:47], v[108:111]
    ds_read_b64_tr_b16 v[62:63], v8 offset:4608
    s_waitcnt lgkmcnt(10)
    v_mfma_f32_16x16x32_bf16 v[112:115], v[24:27], v[44:47], v[112:115]
    ds_read_b128 v[32:35], v5 offset:51200
    s_waitcnt lgkmcnt(9)
    v_mfma_f32_16x16x32_bf16 v[116:119], v[12:15], v[48:51], v[116:119]
    ds_read_b128 v[36:39], v5 offset:53248
    v_mfma_f32_16x16x32_bf16 v[120:123], v[16:19], v[48:51], v[120:123]
    ds_read_b128 v[40:43], v5 offset:55296
    v_mfma_f32_16x16x32_bf16 v[124:127], v[20:23], v[48:51], v[124:127]
    ds_read_b64_tr_b16 v[64:65], v9 offset:4096
    v_mfma_f32_16x16x32_bf16 v[128:131], v[24:27], v[48:51], v[128:131]
    ds_read_b64_tr_b16 v[66:67], v9 offset:4608
    s_waitcnt lgkmcnt(11)
    v_mfma_f32_16x16x32_bf16 v[132:135], v[12:15], v[52:55], v[132:135]
    ds_read_b64_tr_b16 v[44:45], v10 offset:28672
    v_mfma_f32_16x16x32_bf16 v[136:139], v[16:19], v[52:55], v[136:139]
    ds_read_b64_tr_b16 v[46:47], v10 offset:29184
    v_mfma_f32_16x16x32_bf16 v[140:143], v[20:23], v[52:55], v[140:143]
    ds_read_b64_tr_b16 v[48:49], v11 offset:28672
    v_mfma_f32_16x16x32_bf16 v[144:147], v[24:27], v[52:55], v[144:147]
    ds_read_b64_tr_b16 v[50:51], v11 offset:29184
    s_waitcnt lgkmcnt(13)
    v_mfma_f32_16x16x32_bf16 v[148:151], v[12:15], v[56:59], v[148:151]
    v_mfma_f32_16x16x32_bf16 v[152:155], v[16:19], v[56:59], v[152:155]
    v_mfma_f32_16x16x32_bf16 v[156:159], v[20:23], v[56:59], v[156:159]
    v_mfma_f32_16x16x32_bf16 v[160:163], v[24:27], v[56:59], v[160:163]
    s_waitcnt lgkmcnt(9)
    v_mfma_f32_16x16x32_bf16 v[100:103], v[28:31], v[60:63], v[100:103]
    v_lshlrev_b32 v18, 4, v0
    v_add_u32 v12, s52, v18
    s_waitcnt lgkmcnt(8)
    v_mfma_f32_16x16x32_bf16 v[104:107], v[32:35], v[60:63], v[104:107]
    v_xor_b32 v13, 4096, v12
    v_and_b32 v14, 0x30, v0
    s_waitcnt lgkmcnt(0)
    s_barrier
    v_cmp_gt_u32 vcc, 1, v68
    s_nop 0
    s_and_b32 vcc_lo, vcc_lo, 3
    s_cbranch_scc0 SCK_13
    v_and_b32 v69, 1, v0
    v_lshlrev_b32 v69, 2, v69
    v_add_u32 v69, 159088, v69
    ds_read_b32 v68, v69 offset:0
FW_14:
    s_waitcnt lgkmcnt(0)
    v_cmp_gt_u32 vcc, 1, v68
    s_cbranch_vccz FO_15
    ds_read_b32 v68, v69 offset:0
    s_branch FW_14
FO_15:
SCK_13:
    v_mfma_f32_16x16x32_bf16 v[108:111], v[36:39], v[60:63], v[108:111]
    ds_read_b128 v[68:71], v164 offset:0
    v_add_u32 v14, s53, v14
    v_mfma_f32_16x16x32_bf16 v[112:115], v[40:43], v[60:63], v[112:115]
    ds_read2_b32 v[52:53], v165 offset0:64 offset1:64
    v_xor_b32 v15, 64, v14
    v_mfma_f32_16x16x32_bf16 v[116:119], v[28:31], v[64:67], v[116:119]
    ds_read2_b32 v[54:55], v2 offset0:64 offset1:64
    v_lshlrev_b32 v19, 2, v0
    v_mfma_f32_16x16x32_bf16 v[120:123], v[32:35], v[64:67], v[120:123]
    ds_read2_b32 v[56:57], v165 offset0:128 offset1:128
    v_add_u32 v16, s53, v19
    v_mfma_f32_16x16x32_bf16 v[124:127], v[36:39], v[64:67], v[124:127]
    ds_read2_b32 v[58:59], v2 offset0:128 offset1:128
    v_xor_b32 v17, 256, v16
    v_mfma_f32_16x16x32_bf16 v[128:131], v[40:43], v[64:67], v[128:131]
    ds_read_b128 v[72:75], v164 offset:1024
    v_xor_b32 v18, 8, v3
    v_mfma_f32_16x16x32_bf16 v[132:135], v[28:31], v[44:47], v[132:135]
    ds_read_b128 v[76:79], v164 offset:64
    v_writelane_b32 v18, s50, 1
    v_mfma_f32_16x16x32_bf16 v[136:139], v[32:35], v[44:47], v[136:139]
    ds_read_b128 v[80:83], v164 offset:1088
    v_mov_b32 v20, 0x3f803f80
    v_mfma_f32_16x16x32_bf16 v[140:143], v[36:39], v[44:47], v[140:143]
    ds_read_b128 v[84:87], v164 offset:128
    v_mov_b32 v21, 0x3f803f80
    v_mfma_f32_16x16x32_bf16 v[144:147], v[40:43], v[44:47], v[144:147]
    ds_read_b128 v[88:91], v164 offset:1152
    v_mov_b32 v22, 0x3f803f80
    v_mfma_f32_16x16x32_bf16 v[148:151], v[28:31], v[48:51], v[148:151]
    ds_read_b128 v[92:95], v164 offset:192
    v_mov_b32 v23, 0x3f803f80
    v_mfma_f32_16x16x32_bf16 v[152:155], v[32:35], v[48:51], v[152:155]
    ds_read_b128 v[96:99], v164 offset:1216
    v_mov_b32 v24, 1
    v_and_b32 v4, 15, v0
    v_mfma_f32_16x16x32_bf16 v[156:159], v[36:39], v[48:51], v[156:159]
    v_bfe_u32 v5, v0, 4, 1
    v_lshlrev_b32 v5, 5, v5
    v_mfma_f32_16x16x32_bf16 v[160:163], v[40:43], v[48:51], v[160:163]
    v_lshrrev_b32 v6, 5, v0
    v_lshl_add_u32 v5, v6, 4, v5
    v_lshl_add_u32 v7, v4, 11, v5
    v_lshlrev_b32 v6, 4, v0
    v_and_b32 v8, 0x300, v6
    v_lshl_add_u32 v8, v4, 2, v8
    s_waitcnt lgkmcnt(10)
    v_pk_fma_f32 v[100:101], v[68:69], v[52:53], v[100:101]
    v_pk_fma_f32 v[102:103], v[70:71], v[52:53], v[102:103]
    s_waitcnt lgkmcnt(9)
    v_pk_fma_f32 v[116:117], v[68:69], v[54:55], v[116:117]
    v_pk_fma_f32 v[118:119], v[70:71], v[54:55], v[118:119]
    s_waitcnt lgkmcnt(8)
    v_pk_fma_f32 v[132:133], v[68:69], v[56:57], v[132:133]
    v_pk_fma_f32 v[134:135], v[70:71], v[56:57], v[134:135]
    s_waitcnt lgkmcnt(7)
    v_pk_fma_f32 v[148:149], v[68:69], v[58:59], v[148:149]
    v_pk_fma_f32 v[150:151], v[70:71], v[58:59], v[150:151]
    s_waitcnt lgkmcnt(6)
    v_pk_mul_f32 v[100:101], v[100:101], v[72:73]
    v_pk_mul_f32 v[102:103], v[102:103], v[74:75]
    v_pk_mul_f32 v[116:117], v[116:117], v[72:73]
    v_pk_mul_f32 v[118:119], v[118:119], v[74:75]
    v_pk_mul_f32 v[132:133], v[132:133], v[72:73]
    v_pk_mul_f32 v[134:135], v[134:135], v[74:75]
    v_pk_mul_f32 v[148:149], v[148:149], v[72:73]
    v_pk_mul_f32 v[150:151], v[150:151], v[74:75]
    v_exp_f32 v28, v100 clamp
    v_exp_f32 v29, v101 clamp
    v_exp_f32 v30, v102 clamp
    v_exp_f32 v31, v103 clamp
    v_exp_f32 v32, v116 clamp
    v_exp_f32 v33, v117 clamp
    v_exp_f32 v34, v118 clamp
    v_exp_f32 v35, v119 clamp
    v_cvt_pk_bf16_f32 v132, v132, v133
    v_cvt_pk_bf16_f32 v133, v134, v135
    v_cvt_pk_bf16_f32 v148, v148, v149
    v_cvt_pk_bf16_f32 v149, v150, v151
    v_pk_mul_f32 v[100:101], v[100:101], s[40:41] clamp
    v_pk_mul_f32 v[102:103], v[102:103], s[40:41] clamp
    v_pk_mul_f32 v[116:117], v[116:117], s[40:41] clamp
    v_pk_mul_f32 v[118:119], v[118:119], s[40:41] clamp
    v_pk_add_f32 v[28:29], v[28:29], s[74:75]
    v_pk_add_f32 v[30:31], v[30:31], s[74:75]
    v_pk_add_f32 v[32:33], v[32:33], s[74:75]
    v_pk_add_f32 v[34:35], v[34:35], s[74:75]
    v_pk_fma_f32 v[100:101], v[100:101], s[76:77], v[28:29]
    v_pk_fma_f32 v[102:103], v[102:103], s[76:77], v[30:31]
    v_pk_fma_f32 v[116:117], v[116:117], s[76:77], v[32:33]
    v_pk_fma_f32 v[118:119], v[118:119], s[76:77], v[34:35]
    v_cvt_pk_bf16_f32 v100, v100, v101
    v_cvt_pk_bf16_f32 v101, v102, v103
    v_cvt_pk_bf16_f32 v116, v116, v117
    v_cvt_pk_bf16_f32 v117, v118, v119
    s_waitcnt lgkmcnt(5)
    v_pk_fma_f32 v[104:105], v[76:77], v[52:53], v[104:105]
    v_pk_fma_f32 v[106:107], v[78:79], v[52:53], v[106:107]
    v_pk_fma_f32 v[120:121], v[76:77], v[54:55], v[120:121]
    v_pk_fma_f32 v[122:123], v[78:79], v[54:55], v[122:123]
    v_pk_fma_f32 v[136:137], v[76:77], v[56:57], v[136:137]
    v_pk_fma_f32 v[138:139], v[78:79], v[56:57], v[138:139]
    v_pk_fma_f32 v[152:153], v[76:77], v[58:59], v[152:153]
    v_pk_fma_f32 v[154:155], v[78:79], v[58:59], v[154:155]
    s_waitcnt lgkmcnt(4)
    v_pk_mul_f32 v[104:105], v[104:105], v[80:81]
    v_pk_mul_f32 v[106:107], v[106:107], v[82:83]
    v_pk_mul_f32 v[120:121], v[120:121], v[80:81]
    v_pk_mul_f32 v[122:123], v[122:123], v[82:83]
    v_pk_mul_f32 v[136:137], v[136:137], v[80:81]
    v_pk_mul_f32 v[138:139], v[138:139], v[82:83]
    v_pk_mul_f32 v[152:153], v[152:153], v[80:81]
    v_pk_mul_f32 v[154:155], v[154:155], v[82:83]
    v_exp_f32 v36, v104 clamp
    v_exp_f32 v37, v105 clamp
    v_exp_f32 v38, v106 clamp
    v_exp_f32 v39, v107 clamp
    v_exp_f32 v40, v120 clamp
    v_exp_f32 v41, v121 clamp
    v_exp_f32 v42, v122 clamp
    v_exp_f32 v43, v123 clamp
    v_cvt_pk_bf16_f32 v134, v136, v137
    v_cvt_pk_bf16_f32 v135, v138, v139
    v_cvt_pk_bf16_f32 v150, v152, v153
    v_cvt_pk_bf16_f32 v151, v154, v155
    v_pk_mul_f32 v[104:105], v[104:105], s[40:41] clamp
    v_pk_mul_f32 v[106:107], v[106:107], s[40:41] clamp
    v_pk_mul_f32 v[120:121], v[120:121], s[40:41] clamp
    v_pk_mul_f32 v[122:123], v[122:123], s[40:41] clamp
    v_pk_add_f32 v[36:37], v[36:37], s[74:75]
    v_pk_add_f32 v[38:39], v[38:39], s[74:75]
    v_pk_add_f32 v[40:41], v[40:41], s[74:75]
    v_pk_add_f32 v[42:43], v[42:43], s[74:75]
    v_pk_fma_f32 v[104:105], v[104:105], s[76:77], v[36:37]
    v_pk_fma_f32 v[106:107], v[106:107], s[76:77], v[38:39]
    v_pk_fma_f32 v[120:121], v[120:121], s[76:77], v[40:41]
    v_pk_fma_f32 v[122:123], v[122:123], s[76:77], v[42:43]
    v_cvt_pk_bf16_f32 v102, v104, v105
    v_cvt_pk_bf16_f32 v103, v106, v107
    v_cvt_pk_bf16_f32 v118, v120, v121
    v_cvt_pk_bf16_f32 v119, v122, v123
    s_waitcnt lgkmcnt(3)
    v_pk_fma_f32 v[108:109], v[84:85], v[52:53], v[108:109]
    v_pk_fma_f32 v[110:111], v[86:87], v[52:53], v[110:111]
    v_pk_fma_f32 v[124:125], v[84:85], v[54:55], v[124:125]
    v_pk_fma_f32 v[126:127], v[86:87], v[54:55], v[126:127]
    v_pk_fma_f32 v[140:141], v[84:85], v[56:57], v[140:141]
    v_pk_fma_f32 v[142:143], v[86:87], v[56:57], v[142:143]
    v_pk_fma_f32 v[156:157], v[84:85], v[58:59], v[156:157]
    v_pk_fma_f32 v[158:159], v[86:87], v[58:59], v[158:159]
    s_waitcnt lgkmcnt(2)
    v_pk_mul_f32 v[108:109], v[108:109], v[88:89]
    v_pk_mul_f32 v[110:111], v[110:111], v[90:91]
    v_pk_mul_f32 v[124:125], v[124:125], v[88:89]
    v_pk_mul_f32 v[126:127], v[126:127], v[90:91]
    v_pk_mul_f32 v[140:141], v[140:141], v[88:89]
    v_pk_mul_f32 v[142:143], v[142:143], v[90:91]
    v_pk_mul_f32 v[156:157], v[156:157], v[88:89]
    v_pk_mul_f32 v[158:159], v[158:159], v[90:91]
    v_mfma_f32_16x16x32_bf16 v[60:63], v[148:151], v[100:103], 0
    v_exp_f32 v28, v108 clamp
    v_exp_f32 v29, v109 clamp
    v_mfma_f32_16x16x32_bf16 v[64:67], v[148:151], v[116:119], 0
    v_exp_f32 v30, v110 clamp
    v_exp_f32 v31, v111 clamp
    v_mfma_f32_16x16x32_bf16 v[68:71], v[100:103], v[20:23], 0
    v_exp_f32 v32, v124 clamp
    v_exp_f32 v33, v125 clamp
    v_exp_f32 v34, v126 clamp
    v_exp_f32 v35, v127 clamp
    v_cvt_pk_bf16_f32 v136, v140, v141
    v_cvt_pk_bf16_f32 v137, v142, v143
    v_cvt_pk_bf16_f32 v152, v156, v157
    v_cvt_pk_bf16_f32 v153, v158, v159
    v_pk_mul_f32 v[108:109], v[108:109], s[40:41] clamp
    v_pk_mul_f32 v[110:111], v[110:111], s[40:41] clamp
    v_pk_mul_f32 v[124:125], v[124:125], s[40:41] clamp
    v_pk_mul_f32 v[126:127], v[126:127], s[40:41] clamp
    v_pk_add_f32 v[28:29], v[28:29], s[74:75]
    v_pk_add_f32 v[30:31], v[30:31], s[74:75]
    v_pk_add_f32 v[32:33], v[32:33], s[74:75]
    v_pk_add_f32 v[34:35], v[34:35], s[74:75]
    v_pk_fma_f32 v[108:109], v[108:109], s[76:77], v[28:29]
    v_pk_fma_f32 v[110:111], v[110:111], s[76:77], v[30:31]
    v_pk_fma_f32 v[124:125], v[124:125], s[76:77], v[32:33]
    v_pk_fma_f32 v[126:127], v[126:127], s[76:77], v[34:35]
    v_cvt_pk_bf16_f32 v104, v108, v109
    v_cvt_pk_bf16_f32 v105, v110, v111
    v_cvt_pk_bf16_f32 v120, v124, v125
    v_cvt_pk_bf16_f32 v121, v126, v127
    s_waitcnt lgkmcnt(1)
    v_pk_fma_f32 v[112:113], v[92:93], v[52:53], v[112:113]
    v_pk_fma_f32 v[114:115], v[94:95], v[52:53], v[114:115]
    v_pk_fma_f32 v[128:129], v[92:93], v[54:55], v[128:129]
    v_pk_fma_f32 v[130:131], v[94:95], v[54:55], v[130:131]
    v_pk_fma_f32 v[144:145], v[92:93], v[56:57], v[144:145]
    v_pk_fma_f32 v[146:147], v[94:95], v[56:57], v[146:147]
    v_pk_fma_f32 v[160:161], v[92:93], v[58:59], v[160:161]
    v_pk_fma_f32 v[162:163], v[94:95], v[58:59], v[162:163]
    s_waitcnt lgkmcnt(0)
    v_pk_mul_f32 v[112:113], v[112:113], v[96:97]
    v_pk_mul_f32 v[114:115], v[114:115], v[98:99]
    v_pk_mul_f32 v[128:129], v[128:129], v[96:97]
    v_pk_mul_f32 v[130:131], v[130:131], v[98:99]
    v_pk_mul_f32 v[144:145], v[144:145], v[96:97]
    v_pk_mul_f32 v[146:147], v[146:147], v[98:99]
    v_pk_mul_f32 v[160:161], v[160:161], v[96:97]
    v_pk_mul_f32 v[162:163], v[162:163], v[98:99]
    v_mfma_f32_16x16x32_bf16 v[72:75], v[116:119], v[20:23], 0
    v_exp_f32 v36, v112 clamp
    v_exp_f32 v37, v113 clamp
    v_mfma_f32_16x16x32_bf16 v[44:47], v[132:135], v[100:103], 0
    v_exp_f32 v38, v114 clamp
    v_exp_f32 v39, v115 clamp
    v_mfma_f32_16x16x32_bf16 v[48:51], v[132:135], v[116:119], 0
    v_exp_f32 v40, v128 clamp
    v_exp_f32 v41, v129 clamp
    v_exp_f32 v42, v130 clamp
    v_exp_f32 v43, v131 clamp
    s_branch IW_s5
IW_w5:
    s_branch IW_r5
IW_s5:
    v_cvt_pk_bf16_f32 v138, v144, v145
    v_cvt_pk_bf16_f32 v139, v146, v147
    v_cvt_pk_bf16_f32 v154, v160, v161
    v_cvt_pk_bf16_f32 v155, v162, v163
    v_pk_mul_f32 v[112:113], v[112:113], s[40:41] clamp
    v_pk_mul_f32 v[114:115], v[114:115], s[40:41] clamp
    v_pk_mul_f32 v[128:129], v[128:129], s[40:41] clamp
    v_pk_mul_f32 v[130:131], v[130:131], s[40:41] clamp
    v_pk_add_f32 v[36:37], v[36:37], s[74:75]
    v_pk_add_f32 v[38:39], v[38:39], s[74:75]
    v_pk_add_f32 v[40:41], v[40:41], s[74:75]
    v_pk_add_f32 v[42:43], v[42:43], s[74:75]
    v_pk_fma_f32 v[112:113], v[112:113], s[76:77], v[36:37]
    v_pk_fma_f32 v[114:115], v[114:115], s[76:77], v[38:39]
    v_pk_fma_f32 v[128:129], v[128:129], s[76:77], v[40:41]
    v_pk_fma_f32 v[130:131], v[130:131], s[76:77], v[42:43]
    v_cvt_pk_bf16_f32 v106, v112, v113
    v_cvt_pk_bf16_f32 v107, v114, v115
    v_cvt_pk_bf16_f32 v122, v128, v129
    v_cvt_pk_bf16_f32 v123, v130, v131
    v_mfma_f32_16x16x32_bf16 v[60:63], v[152:155], v[104:107], v[60:63]
    s_nop 0
    v_mfma_f32_16x16x32_bf16 v[64:67], v[152:155], v[120:123], v[64:67]
    v_mfma_f32_16x16x32_bf16 v[68:71], v[104:107], v[20:23], v[68:71]
    v_mfma_f32_16x16x32_bf16 v[72:75], v[120:123], v[20:23], v[72:75]
    v_mfma_f32_16x16x32_bf16 v[44:47], v[136:139], v[104:107], v[44:47]
    v_mfma_f32_16x16x32_bf16 v[48:51], v[136:139], v[120:123], v[48:51]
    buffer_load_dwordx4 v[140:143], v7, s[12:15], s42 offen offset:0
    buffer_load_dwordx4 v[144:147], v7, s[12:15], s42 offen offset:64
    buffer_load_dwordx4 v[156:159], v7, s[12:15], s43 offen offset:0
    buffer_load_dwordx4 v[160:163], v7, s[12:15], s43 offen offset:64
    ds_write_b128 v12, v[60:63] offset:0
    ds_write_b128 v12, v[64:67] offset:1024
    s_mov_b32 exec_lo, 0x10001
    s_mov_b32 exec_hi, 0x10001
    ds_write_b128 v14, v[68:71]
    ds_write_b128 v15, v[72:75]
    s_mov_b64 exec, 1
    ds_write_b32 v3, v24 offset:32
    s_mov_b64 exec, -1
F_xw:
    ds_read_b32 v25, v18 offset:32
    ds_read_b128 v[28:31], v13 offset:1024
    ds_read_b128 v[32:35], v13
    ds_read_b32 v26, v16
    ds_read_b32 v27, v17
    s_waitcnt lgkmcnt(4)
    v_cmp_eq_u32 vcc, 0, v25
    s_cbranch_vccz F_xx
    s_waitcnt lgkmcnt(0)
    s_branch F_xw
F_xx:
    s_waitcnt lgkmcnt(3)
    v_add_f32 v44, v44, v28
    v_add_f32 v45, v45, v29
    v_add_f32 v46, v46, v30
    v_add_f32 v47, v47, v31
    buffer_atomic_add_f32 v44, v8, s[24:27], s46 offen offset:0
    buffer_atomic_add_f32 v45, v8, s[24:27], s46 offen offset:64
    buffer_atomic_add_f32 v46, v8, s[24:27], s46 offen offset:128
    buffer_atomic_add_f32 v47, v8, s[24:27], s46 offen offset:192
    s_waitcnt lgkmcnt(2)
    v_add_f32 v48, v48, v32
    v_add_f32 v49, v49, v33
    v_add_f32 v50, v50, v34
    v_add_f32 v51, v51, v35
    buffer_atomic_add_f32 v48, v8, s[24:27], s47 offen offset:0
    buffer_atomic_add_f32 v49, v8, s[24:27], s47 offen offset:64
    buffer_atomic_add_f32 v50, v8, s[24:27], s47 offen offset:128
    buffer_atomic_add_f32 v51, v8, s[24:27], s47 offen offset:192
    s_waitcnt lgkmcnt(0)
    v_add_f32 v26, v26, v27
    s_mov_b64 exec, 0xffff
    buffer_atomic_add_f32 v26, v19, s[24:27], s48 offen
    s_mov_b64 exec, 1
    ds_add_u32 v3, v24 offset:32
    s_mov_b64 exec, -1
    s_setprio 2
    v_mov_b32 v2, v7
    s_lshl_b32 s47, s3, 7
    s_add_u32 s47, s47, 157184
    v_lshlrev_b32 v5, 2, v4
    v_add_u32 v5, s47, v5
    ds_read2_b32 v[76:77], v5 offset0:0 offset1:128
    ds_read2_b32 v[78:79], v5 offset0:16 offset1:144
    v_lshrrev_b32 v4, 3, v0
    v_and_b32 v5, 7, v0
    v_lshrrev_b32 v6, 1, v4
    v_lshlrev_b32 v7, 1, v6
    v_xor_b32 v7, v5, v7
    v_lshlrev_b32 v7, 4, v7
    v_lshl_add_u32 v40, v4, 11, v7
    v_and_b32 v6, 1, v6
    v_lshlrev_b32 v6, 1, v6
    v_xor_b32 v41, v5, v6
    v_xor_b32 v42, 4, v41
    v_lshlrev_b32 v41, 4, v41
    v_lshlrev_b32 v42, 4, v42
    v_mul_u32_u24 v7, 6144, v4
    v_add_u32 v41, v41, v7
    v_add_u32 v42, v42, v7
    v_add_u32 v42, 49152, v42
    s_mul_i32 s56, s3, 98304
    s_lshl_b32 s47, s10, 7
    s_add_u32 s56, s56, s47
    s_lshl_b32 s57, s29, 7
    s_lshl_b32 s47, s3, 15
    s_add_u32 s57, s57, s47
    s_and_b32 s81, s28, 3
    s_mul_i32 s81, s81, 4
    s_lshr_b32 s47, s28, 2
    s_mul_i32 s47, s47, 1
    s_add_u32 s81, s81, s47
    s_lshl_b32 s78, s3, 11
    s_lshl_b32 s44, s10, 1
    s_add_u32 s44, s44, s37
    s_mul_i32 s45, s44, 4224
    s_mov_b32 s52, s45
    s_add_u32 s53, s45, 4096
    s_lshl_b32 s51, s44, 3
    s_and_b32 s47, s32, 3
    s_add_u32 s51, s51, s47
    s_lshl_b32 s51, s51, 7
    v_xor_b32 v18, 8, v3
    v_mov_b32 v25, 0

    s_add_u32 s54, s51, 0x82d000
    s_add_u32 s54, s72, s54
    s_addc_u32 s55, s73, 0
    s_add_u32 s82, s49, 0x82d000
    s_add_u32 s82, s72, s82
    s_addc_u32 s83, s73, 0
    s_lshl_b32 s57, s29, 7
    s_and_b32 s47, s3, 1
    s_lshl_b32 s79, s47, 12
    s_lshl_b32 s47, s47, 16
    s_add_u32 s57, s57, s47

    s_setprio 2
    s_waitcnt lgkmcnt(0)
    v_mul_f32 v76, v76, v77
    v_add_f32 v77, 1.0, v77
    v_mul_f32 v78, v78, v79
    v_add_f32 v79, 1.0, v79
    s_waitcnt vmcnt(9)
    v_lshlrev_b32 v100, 16, v140
    v_and_b32 v101, 0xffff0000, v140
    v_lshlrev_b32 v102, 16, v141
    v_and_b32 v103, 0xffff0000, v141
    v_lshlrev_b32 v104, 16, v142
    v_and_b32 v105, 0xffff0000, v142
    v_lshlrev_b32 v106, 16, v143
    v_and_b32 v107, 0xffff0000, v143
    v_fma_f32 v100, v100, v77, v76
    v_fma_f32 v101, v101, v77, v76
    v_fma_f32 v102, v102, v77, v76
    v_fma_f32 v103, v103, v77, v76
    v_fma_f32 v104, v104, v77, v76
    v_fma_f32 v105, v105, v77, v76
    v_fma_f32 v106, v106, v77, v76
    v_fma_f32 v107, v107, v77, v76
    v_lshlrev_b32 v108, 16, v144
    v_and_b32 v109, 0xffff0000, v144
    v_lshlrev_b32 v110, 16, v145
    v_and_b32 v111, 0xffff0000, v145
    v_lshlrev_b32 v112, 16, v146
    v_and_b32 v113, 0xffff0000, v146
    v_lshlrev_b32 v114, 16, v147
    v_and_b32 v115, 0xffff0000, v147
    v_fma_f32 v108, v108, v77, v76
    v_fma_f32 v109, v109, v77, v76
    v_fma_f32 v110, v110, v77, v76
    v_fma_f32 v111, v111, v77, v76
    v_fma_f32 v112, v112, v77, v76
    v_fma_f32 v113, v113, v77, v76
    v_fma_f32 v114, v114, v77, v76
    v_fma_f32 v115, v115, v77, v76
    v_lshlrev_b32 v116, 16, v156
    v_and_b32 v117, 0xffff0000, v156
    v_lshlrev_b32 v118, 16, v157
    v_and_b32 v119, 0xffff0000, v157
    v_lshlrev_b32 v120, 16, v158
    v_and_b32 v121, 0xffff0000, v158
    v_lshlrev_b32 v122, 16, v159
    v_and_b32 v123, 0xffff0000, v159
    v_fma_f32 v116, v116, v79, v78
    v_fma_f32 v117, v117, v79, v78
    v_fma_f32 v118, v118, v79, v78
    v_fma_f32 v119, v119, v79, v78
    v_fma_f32 v120, v120, v79, v78
    v_fma_f32 v121, v121, v79, v78
    v_fma_f32 v122, v122, v79, v78
    v_fma_f32 v123, v123, v79, v78
    v_lshlrev_b32 v124, 16, v160
    v_and_b32 v125, 0xffff0000, v160
    v_lshlrev_b32 v126, 16, v161
    v_and_b32 v127, 0xffff0000, v161
    v_lshlrev_b32 v128, 16, v162
    v_and_b32 v129, 0xffff0000, v162
    v_lshlrev_b32 v130, 16, v163
    v_and_b32 v131, 0xffff0000, v163
    v_fma_f32 v124, v124, v79, v78
    v_fma_f32 v125, v125, v79, v78
    v_fma_f32 v126, v126, v79, v78
    v_fma_f32 v127, v127, v79, v78
    v_fma_f32 v128, v128, v79, v78
    v_fma_f32 v129, v129, v79, v78
    v_fma_f32 v130, v130, v79, v78
    v_fma_f32 v131, v131, v79, v78
    v_permlane16_swap_b32 v100, v104
    v_permlane16_swap_b32 v101, v105
    v_permlane16_swap_b32 v102, v106
    v_permlane16_swap_b32 v103, v107
    v_permlane16_swap_b32 v108, v112
    v_permlane16_swap_b32 v109, v113
    v_permlane16_swap_b32 v110, v114
    v_permlane16_swap_b32 v111, v115
    v_permlane16_swap_b32 v116, v120
    v_permlane16_swap_b32 v117, v121
    v_permlane16_swap_b32 v118, v122
    v_permlane16_swap_b32 v119, v123
    v_permlane16_swap_b32 v124, v128
    v_permlane16_swap_b32 v125, v129
    v_permlane16_swap_b32 v126, v130
    v_permlane16_swap_b32 v127, v131
    s_setprio 2
    s_cmp_lt_u32 s3, 2
    s_cbranch_scc1 F_w0
    v_cmp_gt_u32 vcc, 1, v25
    s_cbranch_vccz CW_16
    ds_read_b32 v25, v1 offset:0
FW_17:
    s_waitcnt lgkmcnt(0)
    v_cmp_gt_u32 vcc, 1, v25
    s_cbranch_vccz FO_18
    s_sleep 2
    ds_read_b32 v25, v1 offset:0
    s_branch FW_17
FO_18:
CW_16:
    s_add_u32 s47, s81, 0
    s_and_b32 s47, s47, 15
    s_lshl_b32 s47, s47, 17
    s_add_u32 m0, s79, 147456
    s_add_u32 s47, s47, s57
    buffer_load_dwordx4 v40, s[20:23], s47 offen lds
    s_add_u32 m0, m0, 1024
    s_add_u32 s47, s47, 16384
    buffer_load_dwordx4 v40, s[20:23], s47 offen lds
    s_add_u32 m0, m0, 1024
    s_add_u32 s47, s47, 16384
    buffer_load_dwordx4 v40, s[20:23], s47 offen lds
    s_add_u32 m0, m0, 1024
    s_add_u32 s47, s47, 16384
    buffer_load_dwordx4 v40, s[20:23], s47 offen lds
    v_cmp_gt_u32 vcc, 2, v25
    s_cbranch_vccz CW_19
    ds_read_b32 v25, v1 offset:0
FW_20:
    s_waitcnt lgkmcnt(0)
    v_cmp_gt_u32 vcc, 2, v25
    s_cbranch_vccz FO_21
    s_sleep 2
    ds_read_b32 v25, v1 offset:0
    s_branch FW_20
FO_21:
CW_19:
    s_add_u32 s47, s81, 1
    s_and_b32 s47, s47, 15
    s_lshl_b32 s47, s47, 17
    s_add_u32 m0, s79, 0
    s_add_u32 s47, s47, s57
    buffer_load_dwordx4 v40, s[20:23], s47 offen lds
    s_add_u32 m0, m0, 1024
    s_add_u32 s47, s47, 16384
    buffer_load_dwordx4 v40, s[20:23], s47 offen lds
    s_add_u32 m0, m0, 1024
    s_add_u32 s47, s47, 16384
    buffer_load_dwordx4 v40, s[20:23], s47 offen lds
    s_add_u32 m0, m0, 1024
    s_add_u32 s47, s47, 16384
    buffer_load_dwordx4 v40, s[20:23], s47 offen lds
    s_waitcnt vmcnt(8)
    s_branch F_w1
F_w0:
    s_waitcnt vmcnt(0)
F_w1:
    s_mov_b32 s49, 1
    s_atomic_add s49, s[82:83], 0x0
    s_atomic_add s49, s[82:83], 0x80
    s_atomic_add s49, s[82:83], 0x100
    s_atomic_add s49, s[82:83], 0x180
    v_mov_b32 v26, 3
    s_mov_b64 exec, 1
    ds_write_b32 v3, v26 offset:32
    s_mov_b64 exec, -1
    s_cmp_ge_u32 s3, 2
    s_cbranch_scc1 F_wo
    ds_read_b32 v26, v18 offset:32
FW_22:
    s_waitcnt lgkmcnt(0)
    v_cmp_gt_u32 vcc, 2, v26
    s_cbranch_vccz FO_23
    ds_read_b32 v26, v18 offset:32
    s_branch FW_22
FO_23:
    v_cmp_gt_u32 vcc, 4, v25
    s_cbranch_vccz CW_24
    ds_read_b32 v25, v1 offset:0
FW_25:
    s_waitcnt lgkmcnt(0)
    v_cmp_gt_u32 vcc, 4, v25
    s_cbranch_vccz FO_26
    s_sleep 2
    ds_read_b32 v25, v1 offset:0
    s_branch FW_25
FO_26:
CW_24:
    v_lshlrev_b32 v9, 4, v0
    s_lshl_b32 s50, s3, 7
    s_add_u32 s50, s50, 159232
    s_add_u32 m0, s78, 40960
SP_27:
    s_load_dword s58, s[54:55], 0 glc
    s_waitcnt lgkmcnt(0)
    s_cmp_ge_u32 s58, 32
    s_cbranch_scc1 SD_28
    s_sleep 1
    s_branch SP_27
SD_28:
    buffer_load_dwordx4 v9, s[24:27], s52 offen offset:0 sc1 lds
    buffer_load_dwordx4 v9, s[24:27], s52 offen offset:1024 sc1 lds
    s_add_u32 m0, m0, 2048
    s_nop 0
    buffer_load_dwordx4 v9, s[24:27], s52 offen offset:2048 sc1 lds
    buffer_load_dwordx4 v9, s[24:27], s52 offen offset:3072 sc1 lds
    s_mov_b32 m0, s50
    s_mov_b32 exec_hi, 0
    buffer_load_dword v19, s[24:27], s53 offen sc1 lds
    s_mov_b64 exec, 1
    s_lshl_b32 s50, s3, 2
    s_add_u32 m0, s50, 159168
    s_add_u32 s51, s51, 184320
    buffer_load_dword v19, s[24:27], s51 offen sc1 lds
    s_waitcnt vmcnt(0)
    s_mov_b64 exec, 1
    v_mov_b32 v26, 32
    ds_write_b32 v3, v26 offset:128
    s_mov_b64 exec, -1
    s_branch F_wj
F_wo:
    v_cmp_gt_u32 vcc, 2, v25
    s_cbranch_vccz CW_29
    ds_read_b32 v25, v1 offset:0
FW_30:
    s_waitcnt lgkmcnt(0)
    v_cmp_gt_u32 vcc, 2, v25
    s_cbranch_vccz FO_31
    s_sleep 2
    ds_read_b32 v25, v1 offset:0
    s_branch FW_30
FO_31:
CW_29:
    s_add_u32 s47, s81, 2
    s_and_b32 s47, s47, 15
    s_lshl_b32 s47, s47, 17
    s_add_u32 m0, s79, 8192
    s_add_u32 s47, s47, s57
    buffer_load_dwordx4 v40, s[20:23], s47 offen lds
    s_add_u32 m0, m0, 1024
    s_add_u32 s47, s47, 16384
    buffer_load_dwordx4 v40, s[20:23], s47 offen lds
    s_add_u32 m0, m0, 1024
    s_add_u32 s47, s47, 16384
    buffer_load_dwordx4 v40, s[20:23], s47 offen lds
    s_add_u32 m0, m0, 1024
    s_add_u32 s47, s47, 16384
    buffer_load_dwordx4 v40, s[20:23], s47 offen lds
    v_cmp_gt_u32 vcc, 2, v25
    s_cbranch_vccz CW_32
    ds_read_b32 v25, v1 offset:0
FW_33:
    s_waitcnt lgkmcnt(0)
    v_cmp_gt_u32 vcc, 2, v25
    s_cbranch_vccz FO_34
    s_sleep 2
    ds_read_b32 v25, v1 offset:0
    s_branch FW_33
FO_34:
CW_32:
    s_waitcnt vmcnt(8)
    s_add_u32 s47, s81, 3
    s_and_b32 s47, s47, 15
    s_lshl_b32 s47, s47, 17
    s_add_u32 m0, s79, 139264
    s_add_u32 s47, s47, s57
    buffer_load_dwordx4 v40, s[20:23], s47 offen lds
    s_add_u32 m0, m0, 1024
    s_add_u32 s47, s47, 16384
    buffer_load_dwordx4 v40, s[20:23], s47 offen lds
    s_add_u32 m0, m0, 1024
    s_add_u32 s47, s47, 16384
    buffer_load_dwordx4 v40, s[20:23], s47 offen lds
    s_add_u32 m0, m0, 1024
    s_add_u32 s47, s47, 16384
    buffer_load_dwordx4 v40, s[20:23], s47 offen lds
    v_cmp_gt_u32 vcc, 3, v25
    s_cbranch_vccz CW_35
    ds_read_b32 v25, v1 offset:0
FW_36:
    s_waitcnt lgkmcnt(0)
    v_cmp_gt_u32 vcc, 3, v25
    s_cbranch_vccz FO_37
    s_sleep 2
    ds_read_b32 v25, v1 offset:0
    s_branch FW_36
FO_37:
CW_35:
    s_waitcnt vmcnt(8)
    s_add_u32 s47, s81, 4
    s_and_b32 s47, s47, 15
    s_lshl_b32 s47, s47, 17
    s_add_u32 m0, s79, 16384
    s_add_u32 s47, s47, s57
    buffer_load_dwordx4 v40, s[20:23], s47 offen lds
    s_add_u32 m0, m0, 1024
    s_add_u32 s47, s47, 16384
    buffer_load_dwordx4 v40, s[20:23], s47 offen lds
    s_add_u32 m0, m0, 1024
    s_add_u32 s47, s47, 16384
    buffer_load_dwordx4 v40, s[20:23], s47 offen lds
    s_add_u32 m0, m0, 1024
    s_add_u32 s47, s47, 16384
    buffer_load_dwordx4 v40, s[20:23], s47 offen lds
    v_cmp_gt_u32 vcc, 3, v25
    s_cbranch_vccz CW_38
    ds_read_b32 v25, v1 offset:0
FW_39:
    s_waitcnt lgkmcnt(0)
    v_cmp_gt_u32 vcc, 3, v25
    s_cbranch_vccz FO_40
    s_sleep 2
    ds_read_b32 v25, v1 offset:0
    s_branch FW_39
FO_40:
CW_38:
    s_waitcnt vmcnt(8)
    s_add_u32 s47, s81, 5
    s_and_b32 s47, s47, 15
    s_lshl_b32 s47, s47, 17
    s_add_u32 m0, s79, 24576
    s_add_u32 s47, s47, s57
    buffer_load_dwordx4 v40, s[20:23], s47 offen lds
    s_add_u32 m0, m0, 1024
    s_add_u32 s47, s47, 16384
    buffer_load_dwordx4 v40, s[20:23], s47 offen lds
    s_add_u32 m0, m0, 1024
    s_add_u32 s47, s47, 16384
    buffer_load_dwordx4 v40, s[20:23], s47 offen lds
    s_add_u32 m0, m0, 1024
    s_add_u32 s47, s47, 16384
    buffer_load_dwordx4 v40, s[20:23], s47 offen lds
    v_cmp_gt_u32 vcc, 3, v25
    s_cbranch_vccz CW_41
    ds_read_b32 v25, v1 offset:0
FW_42:
    s_waitcnt lgkmcnt(0)
    v_cmp_gt_u32 vcc, 3, v25
    s_cbranch_vccz FO_43
    s_sleep 2
    ds_read_b32 v25, v1 offset:0
    s_branch FW_42
FO_43:
CW_41:
    s_waitcnt vmcnt(8)
    s_add_u32 s47, s81, 6
    s_and_b32 s47, s47, 15
    s_lshl_b32 s47, s47, 17
    s_add_u32 m0, s79, 131072
    s_add_u32 s47, s47, s57
    buffer_load_dwordx4 v40, s[20:23], s47 offen lds
    s_add_u32 m0, m0, 1024
    s_add_u32 s47, s47, 16384
    buffer_load_dwordx4 v40, s[20:23], s47 offen lds
    s_add_u32 m0, m0, 1024
    s_add_u32 s47, s47, 16384
    buffer_load_dwordx4 v40, s[20:23], s47 offen lds
    s_add_u32 m0, m0, 1024
    s_add_u32 s47, s47, 16384
    buffer_load_dwordx4 v40, s[20:23], s47 offen lds
    v_cmp_gt_u32 vcc, 4, v25
    s_cbranch_vccz CW_44
    ds_read_b32 v25, v1 offset:0
FW_45:
    s_waitcnt lgkmcnt(0)
    v_cmp_gt_u32 vcc, 4, v25
    s_cbranch_vccz FO_46
    s_sleep 2
    ds_read_b32 v25, v1 offset:0
    s_branch FW_45
FO_46:
CW_44:
    s_waitcnt vmcnt(8)
    s_add_u32 s47, s81, 7
    s_and_b32 s47, s47, 15
    s_lshl_b32 s47, s47, 17
    s_add_u32 m0, s79, 81920
    s_add_u32 s47, s47, s57
    buffer_load_dwordx4 v40, s[20:23], s47 offen lds
    s_add_u32 m0, m0, 1024
    s_add_u32 s47, s47, 16384
    buffer_load_dwordx4 v40, s[20:23], s47 offen lds
    s_add_u32 m0, m0, 1024
    s_add_u32 s47, s47, 16384
    buffer_load_dwordx4 v40, s[20:23], s47 offen lds
    s_add_u32 m0, m0, 1024
    s_add_u32 s47, s47, 16384
    buffer_load_dwordx4 v40, s[20:23], s47 offen lds
    v_cmp_gt_u32 vcc, 5, v25
    s_cbranch_vccz CW_47
    ds_read_b32 v25, v1 offset:0
FW_48:
    s_waitcnt lgkmcnt(0)
    v_cmp_gt_u32 vcc, 5, v25
    s_cbranch_vccz FO_49
    s_sleep 2
    ds_read_b32 v25, v1 offset:0
    s_branch FW_48
FO_49:
CW_47:
    s_waitcnt vmcnt(8)
    s_add_u32 s47, s81, 8
    s_and_b32 s47, s47, 15
    s_lshl_b32 s47, s47, 17
    s_add_u32 m0, s79, 49152
    s_add_u32 s47, s47, s57
    buffer_load_dwordx4 v40, s[20:23], s47 offen lds
    s_add_u32 m0, m0, 1024
    s_add_u32 s47, s47, 16384
    buffer_load_dwordx4 v40, s[20:23], s47 offen lds
    s_add_u32 m0, m0, 1024
    s_add_u32 s47, s47, 16384
    buffer_load_dwordx4 v40, s[20:23], s47 offen lds
    s_add_u32 m0, m0, 1024
    s_add_u32 s47, s47, 16384
    buffer_load_dwordx4 v40, s[20:23], s47 offen lds
    v_cmp_gt_u32 vcc, 5, v25
    s_cbranch_vccz CW_50
    ds_read_b32 v25, v1 offset:0
FW_51:
    s_waitcnt lgkmcnt(0)
    v_cmp_gt_u32 vcc, 5, v25
    s_cbranch_vccz FO_52
    s_sleep 2
    ds_read_b32 v25, v1 offset:0
    s_branch FW_51
FO_52:
CW_50:
    s_waitcnt vmcnt(8)
    s_add_u32 s47, s81, 9
    s_and_b32 s47, s47, 15
    s_lshl_b32 s47, s47, 17
    s_add_u32 m0, s79, 57344
    s_add_u32 s47, s47, s57
    buffer_load_dwordx4 v40, s[20:23], s47 offen lds
    s_add_u32 m0, m0, 1024
    s_add_u32 s47, s47, 16384
    buffer_load_dwordx4 v40, s[20:23], s47 offen lds
    s_add_u32 m0, m0, 1024
    s_add_u32 s47, s47, 16384
    buffer_load_dwordx4 v40, s[20:23], s47 offen lds
    s_add_u32 m0, m0, 1024
    s_add_u32 s47, s47, 16384
    buffer_load_dwordx4 v40, s[20:23], s47 offen lds
    v_cmp_gt_u32 vcc, 5, v25
    s_cbranch_vccz CW_53
    ds_read_b32 v25, v1 offset:0
FW_54:
    s_waitcnt lgkmcnt(0)
    v_cmp_gt_u32 vcc, 5, v25
    s_cbranch_vccz FO_55
    s_sleep 2
    ds_read_b32 v25, v1 offset:0
    s_branch FW_54
FO_55:
CW_53:
    s_waitcnt vmcnt(8)
    s_add_u32 s47, s81, 10
    s_and_b32 s47, s47, 15
    s_lshl_b32 s47, s47, 17
    s_add_u32 m0, s79, 73728
    s_add_u32 s47, s47, s57
    buffer_load_dwordx4 v40, s[20:23], s47 offen lds
    s_add_u32 m0, m0, 1024
    s_add_u32 s47, s47, 16384
    buffer_load_dwordx4 v40, s[20:23], s47 offen lds
    s_add_u32 m0, m0, 1024
    s_add_u32 s47, s47, 16384
    buffer_load_dwordx4 v40, s[20:23], s47 offen lds
    s_add_u32 m0, m0, 1024
    s_add_u32 s47, s47, 16384
    buffer_load_dwordx4 v40, s[20:23], s47 offen lds
    v_cmp_gt_u32 vcc, 6, v25
    s_cbranch_vccz CW_56
    ds_read_b32 v25, v1 offset:0
FW_57:
    s_waitcnt lgkmcnt(0)
    v_cmp_gt_u32 vcc, 6, v25
    s_cbranch_vccz FO_58
    s_sleep 2
    ds_read_b32 v25, v1 offset:0
    s_branch FW_57
FO_58:
CW_56:
    s_waitcnt vmcnt(8)
    s_add_u32 s47, s81, 11
    s_and_b32 s47, s47, 15
    s_lshl_b32 s47, s47, 17
    s_add_u32 m0, s79, 98304
    s_add_u32 s47, s47, s57
    buffer_load_dwordx4 v40, s[20:23], s47 offen lds
    s_add_u32 m0, m0, 1024
    s_add_u32 s47, s47, 16384
    buffer_load_dwordx4 v40, s[20:23], s47 offen lds
    s_add_u32 m0, m0, 1024
    s_add_u32 s47, s47, 16384
    buffer_load_dwordx4 v40, s[20:23], s47 offen lds
    s_add_u32 m0, m0, 1024
    s_add_u32 s47, s47, 16384
    buffer_load_dwordx4 v40, s[20:23], s47 offen lds
    v_cmp_gt_u32 vcc, 7, v25
    s_cbranch_vccz CW_59
    ds_read_b32 v25, v1 offset:0
FW_60:
    s_waitcnt lgkmcnt(0)
    v_cmp_gt_u32 vcc, 7, v25
    s_cbranch_vccz FO_61
    s_sleep 2
    ds_read_b32 v25, v1 offset:0
    s_branch FW_60
FO_61:
CW_59:
    s_waitcnt vmcnt(8)
    s_add_u32 s47, s81, 12
    s_and_b32 s47, s47, 15
    s_lshl_b32 s47, s47, 17
    s_add_u32 m0, s79, 90112
    s_add_u32 s47, s47, s57
    buffer_load_dwordx4 v40, s[20:23], s47 offen lds
    s_add_u32 m0, m0, 1024
    s_add_u32 s47, s47, 16384
    buffer_load_dwordx4 v40, s[20:23], s47 offen lds
    s_add_u32 m0, m0, 1024
    s_add_u32 s47, s47, 16384
    buffer_load_dwordx4 v40, s[20:23], s47 offen lds
    s_add_u32 m0, m0, 1024
    s_add_u32 s47, s47, 16384
    buffer_load_dwordx4 v40, s[20:23], s47 offen lds
    v_cmp_gt_u32 vcc, 8, v25
    s_cbranch_vccz CW_62
    ds_read_b32 v25, v1 offset:0
FW_63:
    s_waitcnt lgkmcnt(0)
    v_cmp_gt_u32 vcc, 8, v25
    s_cbranch_vccz FO_64
    s_sleep 2
    ds_read_b32 v25, v1 offset:0
    s_branch FW_63
FO_64:
CW_62:
    s_waitcnt vmcnt(8)
    s_add_u32 s47, s81, 13
    s_and_b32 s47, s47, 15
    s_lshl_b32 s47, s47, 17
    s_add_u32 m0, s79, 114688
    s_add_u32 s47, s47, s57
    buffer_load_dwordx4 v40, s[20:23], s47 offen lds
    s_add_u32 m0, m0, 1024
    s_add_u32 s47, s47, 16384
    buffer_load_dwordx4 v40, s[20:23], s47 offen lds
    s_add_u32 m0, m0, 1024
    s_add_u32 s47, s47, 16384
    buffer_load_dwordx4 v40, s[20:23], s47 offen lds
    s_add_u32 m0, m0, 1024
    s_add_u32 s47, s47, 16384
    buffer_load_dwordx4 v40, s[20:23], s47 offen lds
    v_cmp_gt_u32 vcc, 9, v25
    s_cbranch_vccz CW_65
    ds_read_b32 v25, v1 offset:0
FW_66:
    s_waitcnt lgkmcnt(0)
    v_cmp_gt_u32 vcc, 9, v25
    s_cbranch_vccz FO_67
    s_sleep 2
    ds_read_b32 v25, v1 offset:0
    s_branch FW_66
FO_67:
CW_65:
    s_waitcnt vmcnt(8)
    s_add_u32 s47, s81, 14
    s_and_b32 s47, s47, 15
    s_lshl_b32 s47, s47, 17
    s_add_u32 m0, s79, 106496
    s_add_u32 s47, s47, s57
    buffer_load_dwordx4 v40, s[20:23], s47 offen lds
    s_add_u32 m0, m0, 1024
    s_add_u32 s47, s47, 16384
    buffer_load_dwordx4 v40, s[20:23], s47 offen lds
    s_add_u32 m0, m0, 1024
    s_add_u32 s47, s47, 16384
    buffer_load_dwordx4 v40, s[20:23], s47 offen lds
    s_add_u32 m0, m0, 1024
    s_add_u32 s47, s47, 16384
    buffer_load_dwordx4 v40, s[20:23], s47 offen lds
    v_cmp_gt_u32 vcc, 10, v25
    s_cbranch_vccz CW_68
    ds_read_b32 v25, v1 offset:0
FW_69:
    s_waitcnt lgkmcnt(0)
    v_cmp_gt_u32 vcc, 10, v25
    s_cbranch_vccz FO_70
    s_sleep 2
    ds_read_b32 v25, v1 offset:0
    s_branch FW_69
FO_70:
CW_68:
    s_waitcnt vmcnt(8)
    s_add_u32 s47, s81, 15
    s_and_b32 s47, s47, 15
    s_lshl_b32 s47, s47, 17
    s_add_u32 m0, s79, 122880
    s_add_u32 s47, s47, s57
    buffer_load_dwordx4 v40, s[20:23], s47 offen lds
    s_add_u32 m0, m0, 1024
    s_add_u32 s47, s47, 16384
    buffer_load_dwordx4 v40, s[20:23], s47 offen lds
    s_add_u32 m0, m0, 1024
    s_add_u32 s47, s47, 16384
    buffer_load_dwordx4 v40, s[20:23], s47 offen lds
    s_add_u32 m0, m0, 1024
    s_add_u32 s47, s47, 16384
    buffer_load_dwordx4 v40, s[20:23], s47 offen lds
F_wj:
    v_mov_b32 v5, 159096
    s_branch IW_s6
IW_w6:
    s_branch IW_r6
IW_s6:
    ds_read_b32 v6, v5 offset:0
FW_71:
    s_waitcnt lgkmcnt(0)
    v_cmp_gt_u32 vcc, 1, v6
    s_cbranch_vccz FO_72
    s_sleep 1
    ds_read_b32 v6, v5 offset:0
    s_branch FW_71
FO_72:
    v_and_b32 v5, 7, v0
    v_lshlrev_b32 v5, 2, v5
    v_add_u32 v5, 158976, v5
    ds_read_b32 v5, v5
    s_lshr_b32 s47, s64, 5
    s_sub_u32 s47, 63, s47
    s_mov_b64 s[60:61], 0
    s_waitcnt lgkmcnt(0)
    v_bfe_u32 v5, v5, 5, 6
    v_cmp_eq_u32 vcc, s47, v5
    s_cbranch_vccz F_ns

    v_mov_b32 v5, 158976
    ds_read_b128 v[44:47], v5
    ds_read_b128 v[48:51], v5 offset:16
    v_and_b32 v6, 15, v0
    v_add_u32 v6, s64, v6
    v_sub_u32 v6, 2047, v6
    v_subrev_u32 v7, 16, v6
    v_mov_b32 v164, 0
    v_mov_b32 v165, 0
    s_waitcnt lgkmcnt(0)
    v_and_b32 v5, 0x7ff, v44
    v_or_b32 v44, 0x4000, v44
    v_cmp_eq_u32 vcc, v5, v6
    v_cmp_eq_u32 s[62:63], v5, v7
    s_nop 0
    v_cndmask_b32 v164, v164, v44, vcc
    v_cndmask_b32 v165, v165, v44, s[62:63]
    v_and_b32 v5, 0x7ff, v45
    v_or_b32 v45, 0x4800, v45
    v_cmp_eq_u32 vcc, v5, v6
    v_cmp_eq_u32 s[62:63], v5, v7
    s_nop 0
    v_cndmask_b32 v164, v164, v45, vcc
    v_cndmask_b32 v165, v165, v45, s[62:63]
    v_and_b32 v5, 0x7ff, v46
    v_or_b32 v46, 0x5000, v46
    v_cmp_eq_u32 vcc, v5, v6
    v_cmp_eq_u32 s[62:63], v5, v7
    s_nop 0
    v_cndmask_b32 v164, v164, v46, vcc
    v_cndmask_b32 v165, v165, v46, s[62:63]
    v_and_b32 v5, 0x7ff, v47
    v_or_b32 v47, 0x5800, v47
    v_cmp_eq_u32 vcc, v5, v6
    v_cmp_eq_u32 s[62:63], v5, v7
    s_nop 0
    v_cndmask_b32 v164, v164, v47, vcc
    v_cndmask_b32 v165, v165, v47, s[62:63]
    v_and_b32 v5, 0x7ff, v48
    v_or_b32 v48, 0x6000, v48
    v_cmp_eq_u32 vcc, v5, v6
    v_cmp_eq_u32 s[62:63], v5, v7
    s_nop 0
    v_cndmask_b32 v164, v164, v48, vcc
    v_cndmask_b32 v165, v165, v48, s[62:63]
    v_and_b32 v5, 0x7ff, v49
    v_or_b32 v49, 0x6800, v49
    v_cmp_eq_u32 vcc, v5, v6
    v_cmp_eq_u32 s[62:63], v5, v7
    s_nop 0
    v_cndmask_b32 v164, v164, v49, vcc
    v_cndmask_b32 v165, v165, v49, s[62:63]
    v_and_b32 v5, 0x7ff, v50
    v_or_b32 v50, 0x7000, v50
    v_cmp_eq_u32 vcc, v5, v6
    v_cmp_eq_u32 s[62:63], v5, v7
    s_nop 0
    v_cndmask_b32 v164, v164, v50, vcc
    v_cndmask_b32 v165, v165, v50, s[62:63]
    v_and_b32 v5, 0x7ff, v51
    v_or_b32 v51, 0x7800, v51
    v_cmp_eq_u32 vcc, v5, v6
    v_cmp_eq_u32 s[62:63], v5, v7
    s_nop 0
    v_cndmask_b32 v164, v164, v51, vcc
    v_cndmask_b32 v165, v165, v51, s[62:63]
    s_mov_b32 s47, 0xbfb8aa3b
    v_and_b32 v7, 0x30, v0
    v_add_u32 v7, 159744, v7
    v_cmp_ne_u32 s[74:75], 0, v164
    v_bfe_u32 v5, v164, 11, 3
    v_lshl_add_u32 v162, v5, 8, v7
    v_and_b32 v5, 0xffff0000, v164
    v_ashrrev_i32 v6, 31, v5
    v_not_b32 v6, v6
    v_or_b32 v6, 0x80000000, v6
    v_xor_b32 v5, v5, v6
    v_and_b32 v5, 0xffff0000, v5
    v_mul_f32 v5, s47, v5
    v_exp_f32 v5, v5
    s_nop 0
    v_add_f32 v5, 1.0, v5
    v_rcp_f32 v5, v5
    s_nop 0
    v_cvt_pk_bf16_f32 v5, v5, v5
    v_lshlrev_b32 v164, 16, v5
    v_cmp_ne_u32 s[76:77], 0, v165
    v_bfe_u32 v5, v165, 11, 3
    v_lshl_add_u32 v163, v5, 8, v7
    v_and_b32 v5, 0xffff0000, v165
    v_ashrrev_i32 v6, 31, v5
    v_not_b32 v6, v6
    v_or_b32 v6, 0x80000000, v6
    v_xor_b32 v5, v5, v6
    v_and_b32 v5, 0xffff0000, v5
    v_mul_f32 v5, s47, v5
    v_exp_f32 v5, v5
    s_nop 0
    v_add_f32 v5, 1.0, v5
    v_rcp_f32 v5, v5
    s_nop 0
    v_cvt_pk_bf16_f32 v5, v5, v5
    v_lshlrev_b32 v165, 16, v5
    v_mov_b32 v161, 159136
    s_mov_b64 s[60:61], 1
F_ns:
    s_lshl_b32 s51, s28, 2
    s_add_u32 s51, s51, s3
    s_lshl_b32 s51, s51, 3
    s_and_b32 s47, s29, 3
    s_add_u32 s51, s51, s47
    s_lshl_b32 s51, s51, 7

    s_add_u32 s54, s51, 0x835000
    s_add_u32 s54, s72, s54
    s_addc_u32 s55, s73, 0
    v_lshlrev_b32 v98, 4, v0
    v_lshrrev_b32 v16, 4, v0
    v_bfe_u32 v17, v0, 2, 2
    v_lshl_add_u32 v17, v16, 2, v17
    v_bfe_u32 v16, v17, 1, 2
    v_lshlrev_b32 v16, 5, v16
    v_lshl_add_u32 v16, v17, 7, v16
    v_and_b32 v17, 3, v0
    v_lshl_add_u32 v4, v17, 3, v16
    v_xor_b32 v5, 32, v4
    v_xor_b32 v6, 64, v4
    v_xor_b32 v7, 96, v4
    s_lshl_b32 s79, s28, 18
    s_lshl_b32 s80, s3, 16
    s_add_u32 s79, s79, s80
    s_lshl_b32 s81, s81, 11
    v_mov_b32 v99, 1

    v_add_u32 v8, 57344, v4
    v_add_u32 v9, 57344, v5
    v_add_u32 v10, 57344, v6
    v_add_u32 v11, 57344, v7
    v_add_u32 v12, 114688, v4
    v_add_u32 v13, 114688, v5
    v_add_u32 v14, 114688, v6
    v_add_u32 v15, 114688, v7
    s_add_u32 s16, s72, 0x400000
    s_addc_u32 s17, s73, 0
    s_mov_b32 s18, 0x400000
    s_mov_b32 s19, 0x00020000
    s_mov_b32 s12, s68
    s_mov_b32 s13, s69
    s_mov_b32 s14, 0x400000
    s_mov_b32 s15, 0x00020000
    s_add_u32 s80, s81, 0
    s_and_b32 s80, s80, 0x7fff
    s_add_u32 s4, s80, s79
    s_add_u32 s80, s81, 2048
    s_and_b32 s80, s80, 0x7fff
    s_add_u32 s5, s80, s79
    s_add_u32 s80, s81, 4096
    s_and_b32 s80, s80, 0x7fff
    s_add_u32 s6, s80, s79
    s_add_u32 s80, s81, 6144
    s_and_b32 s80, s80, 0x7fff
    s_add_u32 s7, s80, s79
    s_add_u32 s80, s81, 8192
    s_and_b32 s80, s80, 0x7fff
    s_add_u32 s8, s80, s79
    s_add_u32 s80, s81, 10240
    s_and_b32 s80, s80, 0x7fff
    s_add_u32 s9, s80, s79
    s_add_u32 s80, s81, 12288
    s_and_b32 s80, s80, 0x7fff
    s_add_u32 s10, s80, s79
    s_add_u32 s80, s81, 14336
    s_and_b32 s80, s80, 0x7fff
    s_add_u32 s11, s80, s79
    s_add_u32 s80, s81, 16384
    s_and_b32 s80, s80, 0x7fff
    s_add_u32 s30, s80, s79
    s_add_u32 s80, s81, 18432
    s_and_b32 s80, s80, 0x7fff
    s_add_u32 s31, s80, s79
    s_add_u32 s80, s81, 20480
    s_and_b32 s80, s80, 0x7fff
    s_add_u32 s32, s80, s79
    s_add_u32 s80, s81, 22528
    s_and_b32 s80, s80, 0x7fff
    s_add_u32 s33, s80, s79
    s_add_u32 s80, s81, 24576
    s_and_b32 s80, s80, 0x7fff
    s_add_u32 s34, s80, s79
    s_add_u32 s80, s81, 26624
    s_and_b32 s80, s80, 0x7fff
    s_add_u32 s35, s80, s79
    s_add_u32 s80, s81, 28672
    s_and_b32 s80, s80, 0x7fff
    s_add_u32 s36, s80, s79
    s_add_u32 s80, s81, 30720
    s_and_b32 s80, s80, 0x7fff
    s_add_u32 s37, s80, s79
    v_add_u32 v97, 0x8000, v98
    s_setprio 2
    s_mov_b32 s50, 0
F_op:
    s_load_dword s47, s[54:55], 0 glc
    s_getreg_b32 s51, hwreg(HW_REG_IB_STS)
    s_and_b32 s51, s51, 0xc0000f
    s_or_b32 s51, s51, s50
    s_cbranch_scc1 F_oq
    s_mov_b64 exec, 1
    ds_write_b32 v3, v99 offset:160
    s_mov_b64 exec, -1
    s_mov_b32 s50, 1
F_oq:
    s_waitcnt lgkmcnt(0)
    s_cmp_lt_u32 s47, 16
    s_cbranch_scc1 F_op
    buffer_load_dwordx4 v[48:51], v98, s[16:19], s4 offen offset:0 sc1
    buffer_load_dwordx4 v[52:55], v97, s[16:19], s4 offen offset:0 sc1
    buffer_load_dwordx4 v[56:59], v98, s[16:19], s4 offen offset:1024 sc1
    buffer_load_dwordx4 v[60:63], v97, s[16:19], s4 offen offset:1024 sc1
    buffer_load_dwordx4 v[64:67], v98, s[16:19], s5 offen offset:0 sc1
    buffer_load_dwordx4 v[68:71], v97, s[16:19], s5 offen offset:0 sc1
    buffer_load_dwordx4 v[72:75], v98, s[16:19], s5 offen offset:1024 sc1
    buffer_load_dwordx4 v[76:79], v97, s[16:19], s5 offen offset:1024 sc1
    buffer_load_dwordx4 v[80:83], v98, s[16:19], s6 offen offset:0 sc1
    buffer_load_dwordx4 v[84:87], v97, s[16:19], s6 offen offset:0 sc1
    buffer_load_dwordx4 v[88:91], v98, s[16:19], s6 offen offset:1024 sc1
    buffer_load_dwordx4 v[92:95], v97, s[16:19], s6 offen offset:1024 sc1
    s_cmp_lg_u32 s50, 0
    s_cbranch_scc1 F_or
    s_waitcnt vmcnt(12)
    s_mov_b64 exec, 1
    ds_write_b32 v3, v99 offset:160
    s_mov_b64 exec, -1
F_or:
    v_or_b32 v17, 8, v1
    ds_read_b32 v16, v17 offset:160
FW_73:
    s_waitcnt lgkmcnt(0)
    v_cmp_gt_u32 vcc, 1, v16
    s_cbranch_vccz FO_74
    ds_read_b32 v16, v17 offset:160
    s_branch FW_73
FO_74:
    v_and_b32 v1, 0x3fff, v2
    v_bfe_u32 v99, v0, 3, 1
    v_lshl_add_u32 v1, v99, 6, v1
    ds_read_b64_tr_b16 v[16:17], v12 offset:32768
    ds_read_b64_tr_b16 v[18:19], v12 offset:34816
    ds_read_b64_tr_b16 v[20:21], v13 offset:32768
    ds_read_b64_tr_b16 v[22:23], v13 offset:34816
    ds_read_b64_tr_b16 v[24:25], v14 offset:32768
    ds_read_b64_tr_b16 v[26:27], v14 offset:34816
    ds_read_b64_tr_b16 v[28:29], v15 offset:32768
    ds_read_b64_tr_b16 v[30:31], v15 offset:34816
    s_waitcnt vmcnt(10) lgkmcnt(0)
    v_mfma_f32_16x16x32_bf16 v[100:103], v[16:19], v[48:51], v[100:103]
    ds_read_b64_tr_b16 v[32:33], v12 offset:36864
    ds_read_b64_tr_b16 v[34:35], v12 offset:38912
    v_mfma_f32_16x16x32_bf16 v[116:119], v[16:19], v[52:55], v[116:119]
    ds_read_b64_tr_b16 v[36:37], v13 offset:36864
    ds_read_b64_tr_b16 v[38:39], v13 offset:38912
    v_mfma_f32_16x16x32_bf16 v[104:107], v[20:23], v[48:51], v[104:107]
    ds_read_b64_tr_b16 v[40:41], v14 offset:36864
    ds_read_b64_tr_b16 v[42:43], v14 offset:38912
    v_mfma_f32_16x16x32_bf16 v[120:123], v[20:23], v[52:55], v[120:123]
    ds_read_b64_tr_b16 v[44:45], v15 offset:36864
    ds_read_b64_tr_b16 v[46:47], v15 offset:38912
    v_mfma_f32_16x16x32_bf16 v[108:111], v[24:27], v[48:51], v[108:111]
    buffer_load_dwordx4 v[132:135], v98, s[16:19], s7 offen offset:0 sc1
    v_mfma_f32_16x16x32_bf16 v[124:127], v[24:27], v[52:55], v[124:127]
    v_mfma_f32_16x16x32_bf16 v[112:115], v[28:31], v[48:51], v[112:115]
    buffer_load_dwordx4 v[136:139], v97, s[16:19], s7 offen offset:0 sc1
    v_mfma_f32_16x16x32_bf16 v[128:131], v[28:31], v[52:55], v[128:131]
    s_waitcnt vmcnt(10) lgkmcnt(0)
    v_mfma_f32_16x16x32_bf16 v[100:103], v[32:35], v[56:59], v[100:103]
    ds_read_b64_tr_b16 v[16:17], v4 offset:0
    ds_read_b64_tr_b16 v[18:19], v4 offset:2048
    v_mfma_f32_16x16x32_bf16 v[116:119], v[32:35], v[60:63], v[116:119]
    ds_read_b64_tr_b16 v[20:21], v5 offset:0
    ds_read_b64_tr_b16 v[22:23], v5 offset:2048
    v_mfma_f32_16x16x32_bf16 v[104:107], v[36:39], v[56:59], v[104:107]
    ds_read_b64_tr_b16 v[24:25], v6 offset:0
    ds_read_b64_tr_b16 v[26:27], v6 offset:2048
    v_mfma_f32_16x16x32_bf16 v[120:123], v[36:39], v[60:63], v[120:123]
    ds_read_b64_tr_b16 v[28:29], v7 offset:0
    ds_read_b64_tr_b16 v[30:31], v7 offset:2048
    v_mfma_f32_16x16x32_bf16 v[108:111], v[40:43], v[56:59], v[108:111]
    buffer_load_dwordx4 v[48:51], v98, s[16:19], s7 offen offset:1024 sc1
    v_mfma_f32_16x16x32_bf16 v[124:127], v[40:43], v[60:63], v[124:127]
    v_mfma_f32_16x16x32_bf16 v[112:115], v[44:47], v[56:59], v[112:115]
    buffer_load_dwordx4 v[52:55], v97, s[16:19], s7 offen offset:1024 sc1
    v_mfma_f32_16x16x32_bf16 v[128:131], v[44:47], v[60:63], v[128:131]
    s_waitcnt vmcnt(10) lgkmcnt(0)
    v_mfma_f32_16x16x32_bf16 v[100:103], v[16:19], v[64:67], v[100:103]
    ds_read_b64_tr_b16 v[32:33], v4 offset:4096
    ds_read_b64_tr_b16 v[34:35], v4 offset:6144
    v_mfma_f32_16x16x32_bf16 v[116:119], v[16:19], v[68:71], v[116:119]
    ds_read_b64_tr_b16 v[36:37], v5 offset:4096
    ds_read_b64_tr_b16 v[38:39], v5 offset:6144
    v_mfma_f32_16x16x32_bf16 v[104:107], v[20:23], v[64:67], v[104:107]
    ds_read_b64_tr_b16 v[40:41], v6 offset:4096
    ds_read_b64_tr_b16 v[42:43], v6 offset:6144
    v_mfma_f32_16x16x32_bf16 v[120:123], v[20:23], v[68:71], v[120:123]
    ds_read_b64_tr_b16 v[44:45], v7 offset:4096
    ds_read_b64_tr_b16 v[46:47], v7 offset:6144
    v_mfma_f32_16x16x32_bf16 v[108:111], v[24:27], v[64:67], v[108:111]
    buffer_load_dwordx4 v[56:59], v98, s[16:19], s8 offen offset:0 sc1
    v_mfma_f32_16x16x32_bf16 v[124:127], v[24:27], v[68:71], v[124:127]
    v_mfma_f32_16x16x32_bf16 v[112:115], v[28:31], v[64:67], v[112:115]
    buffer_load_dwordx4 v[60:63], v97, s[16:19], s8 offen offset:0 sc1
    v_mfma_f32_16x16x32_bf16 v[128:131], v[28:31], v[68:71], v[128:131]
    s_waitcnt vmcnt(10) lgkmcnt(0)
    v_mfma_f32_16x16x32_bf16 v[100:103], v[32:35], v[72:75], v[100:103]
    ds_read_b64_tr_b16 v[16:17], v4 offset:8192
    ds_read_b64_tr_b16 v[18:19], v4 offset:10240
    v_mfma_f32_16x16x32_bf16 v[116:119], v[32:35], v[76:79], v[116:119]
    ds_read_b64_tr_b16 v[20:21], v5 offset:8192
    ds_read_b64_tr_b16 v[22:23], v5 offset:10240
    v_mfma_f32_16x16x32_bf16 v[104:107], v[36:39], v[72:75], v[104:107]
    ds_read_b64_tr_b16 v[24:25], v6 offset:8192
    ds_read_b64_tr_b16 v[26:27], v6 offset:10240
    v_mfma_f32_16x16x32_bf16 v[120:123], v[36:39], v[76:79], v[120:123]
    ds_read_b64_tr_b16 v[28:29], v7 offset:8192
    ds_read_b64_tr_b16 v[30:31], v7 offset:10240
    v_mfma_f32_16x16x32_bf16 v[108:111], v[40:43], v[72:75], v[108:111]
    buffer_load_dwordx4 v[64:67], v98, s[16:19], s8 offen offset:1024 sc1
    v_mfma_f32_16x16x32_bf16 v[124:127], v[40:43], v[76:79], v[124:127]
    v_mfma_f32_16x16x32_bf16 v[112:115], v[44:47], v[72:75], v[112:115]
    buffer_load_dwordx4 v[68:71], v97, s[16:19], s8 offen offset:1024 sc1
    v_mfma_f32_16x16x32_bf16 v[128:131], v[44:47], v[76:79], v[128:131]
    s_waitcnt vmcnt(10) lgkmcnt(0)
    v_mfma_f32_16x16x32_bf16 v[100:103], v[16:19], v[80:83], v[100:103]
    ds_read_b64_tr_b16 v[32:33], v4 offset:12288
    ds_read_b64_tr_b16 v[34:35], v4 offset:14336
    v_mfma_f32_16x16x32_bf16 v[116:119], v[16:19], v[84:87], v[116:119]
    ds_read_b64_tr_b16 v[36:37], v5 offset:12288
    ds_read_b64_tr_b16 v[38:39], v5 offset:14336
    v_mfma_f32_16x16x32_bf16 v[104:107], v[20:23], v[80:83], v[104:107]
    ds_read_b64_tr_b16 v[40:41], v6 offset:12288
    ds_read_b64_tr_b16 v[42:43], v6 offset:14336
    v_mfma_f32_16x16x32_bf16 v[120:123], v[20:23], v[84:87], v[120:123]
    ds_read_b64_tr_b16 v[44:45], v7 offset:12288
    ds_read_b64_tr_b16 v[46:47], v7 offset:14336
    v_mfma_f32_16x16x32_bf16 v[108:111], v[24:27], v[80:83], v[108:111]
    buffer_load_dwordx4 v[72:75], v98, s[16:19], s9 offen offset:0 sc1
    v_mfma_f32_16x16x32_bf16 v[124:127], v[24:27], v[84:87], v[124:127]
    v_mfma_f32_16x16x32_bf16 v[112:115], v[28:31], v[80:83], v[112:115]
    buffer_load_dwordx4 v[76:79], v97, s[16:19], s9 offen offset:0 sc1
    v_mfma_f32_16x16x32_bf16 v[128:131], v[28:31], v[84:87], v[128:131]
    s_waitcnt vmcnt(10) lgkmcnt(0)
    v_mfma_f32_16x16x32_bf16 v[100:103], v[32:35], v[88:91], v[100:103]
    ds_read_b64_tr_b16 v[16:17], v12 offset:24576
    ds_read_b64_tr_b16 v[18:19], v12 offset:26624
    v_mfma_f32_16x16x32_bf16 v[116:119], v[32:35], v[92:95], v[116:119]
    ds_read_b64_tr_b16 v[20:21], v13 offset:24576
    ds_read_b64_tr_b16 v[22:23], v13 offset:26624
    v_mfma_f32_16x16x32_bf16 v[104:107], v[36:39], v[88:91], v[104:107]
    ds_read_b64_tr_b16 v[24:25], v14 offset:24576
    ds_read_b64_tr_b16 v[26:27], v14 offset:26624
    v_mfma_f32_16x16x32_bf16 v[120:123], v[36:39], v[92:95], v[120:123]
    ds_read_b64_tr_b16 v[28:29], v15 offset:24576
    ds_read_b64_tr_b16 v[30:31], v15 offset:26624
    v_mfma_f32_16x16x32_bf16 v[108:111], v[40:43], v[88:91], v[108:111]
    buffer_load_dwordx4 v[80:83], v98, s[16:19], s9 offen offset:1024 sc1
    v_mfma_f32_16x16x32_bf16 v[124:127], v[40:43], v[92:95], v[124:127]
    v_mfma_f32_16x16x32_bf16 v[112:115], v[44:47], v[88:91], v[112:115]
    buffer_load_dwordx4 v[84:87], v97, s[16:19], s9 offen offset:1024 sc1
    v_mfma_f32_16x16x32_bf16 v[128:131], v[44:47], v[92:95], v[128:131]
    s_waitcnt vmcnt(10) lgkmcnt(0)
    v_mfma_f32_16x16x32_bf16 v[100:103], v[16:19], v[132:135], v[100:103]
    ds_read_b64_tr_b16 v[32:33], v12 offset:28672
    ds_read_b64_tr_b16 v[34:35], v12 offset:30720
    v_mfma_f32_16x16x32_bf16 v[116:119], v[16:19], v[136:139], v[116:119]
    ds_read_b64_tr_b16 v[36:37], v13 offset:28672
    ds_read_b64_tr_b16 v[38:39], v13 offset:30720
    v_mfma_f32_16x16x32_bf16 v[104:107], v[20:23], v[132:135], v[104:107]
    ds_read_b64_tr_b16 v[40:41], v14 offset:28672
    ds_read_b64_tr_b16 v[42:43], v14 offset:30720
    v_mfma_f32_16x16x32_bf16 v[120:123], v[20:23], v[136:139], v[120:123]
    ds_read_b64_tr_b16 v[44:45], v15 offset:28672
    ds_read_b64_tr_b16 v[46:47], v15 offset:30720
    v_mfma_f32_16x16x32_bf16 v[108:111], v[24:27], v[132:135], v[108:111]
    buffer_load_dwordx4 v[88:91], v98, s[16:19], s10 offen offset:0 sc1
    v_mfma_f32_16x16x32_bf16 v[124:127], v[24:27], v[136:139], v[124:127]
    v_mfma_f32_16x16x32_bf16 v[112:115], v[28:31], v[132:135], v[112:115]
    buffer_load_dwordx4 v[92:95], v97, s[16:19], s10 offen offset:0 sc1
    v_mfma_f32_16x16x32_bf16 v[128:131], v[28:31], v[136:139], v[128:131]
    s_waitcnt vmcnt(10) lgkmcnt(0)
    v_mfma_f32_16x16x32_bf16 v[100:103], v[32:35], v[48:51], v[100:103]
    ds_read_b64_tr_b16 v[16:17], v4 offset:16384
    ds_read_b64_tr_b16 v[18:19], v4 offset:18432
    v_mfma_f32_16x16x32_bf16 v[116:119], v[32:35], v[52:55], v[116:119]
    ds_read_b64_tr_b16 v[20:21], v5 offset:16384
    ds_read_b64_tr_b16 v[22:23], v5 offset:18432
    v_mfma_f32_16x16x32_bf16 v[104:107], v[36:39], v[48:51], v[104:107]
    ds_read_b64_tr_b16 v[24:25], v6 offset:16384
    ds_read_b64_tr_b16 v[26:27], v6 offset:18432
    v_mfma_f32_16x16x32_bf16 v[120:123], v[36:39], v[52:55], v[120:123]
    ds_read_b64_tr_b16 v[28:29], v7 offset:16384
    ds_read_b64_tr_b16 v[30:31], v7 offset:18432
    v_mfma_f32_16x16x32_bf16 v[108:111], v[40:43], v[48:51], v[108:111]
    buffer_load_dwordx4 v[132:135], v98, s[16:19], s10 offen offset:1024 sc1
    v_mfma_f32_16x16x32_bf16 v[124:127], v[40:43], v[52:55], v[124:127]
    v_mfma_f32_16x16x32_bf16 v[112:115], v[44:47], v[48:51], v[112:115]
    buffer_load_dwordx4 v[136:139], v97, s[16:19], s10 offen offset:1024 sc1
    v_mfma_f32_16x16x32_bf16 v[128:131], v[44:47], v[52:55], v[128:131]
    s_waitcnt vmcnt(10) lgkmcnt(0)
    v_mfma_f32_16x16x32_bf16 v[100:103], v[16:19], v[56:59], v[100:103]
    ds_read_b64_tr_b16 v[32:33], v4 offset:20480
    ds_read_b64_tr_b16 v[34:35], v4 offset:22528
    v_mfma_f32_16x16x32_bf16 v[116:119], v[16:19], v[60:63], v[116:119]
    ds_read_b64_tr_b16 v[36:37], v5 offset:20480
    ds_read_b64_tr_b16 v[38:39], v5 offset:22528
    v_mfma_f32_16x16x32_bf16 v[104:107], v[20:23], v[56:59], v[104:107]
    ds_read_b64_tr_b16 v[40:41], v6 offset:20480
    ds_read_b64_tr_b16 v[42:43], v6 offset:22528
    v_mfma_f32_16x16x32_bf16 v[120:123], v[20:23], v[60:63], v[120:123]
    ds_read_b64_tr_b16 v[44:45], v7 offset:20480
    ds_read_b64_tr_b16 v[46:47], v7 offset:22528
    v_mfma_f32_16x16x32_bf16 v[108:111], v[24:27], v[56:59], v[108:111]
    buffer_load_dwordx4 v[48:51], v98, s[16:19], s11 offen offset:0 sc1
    v_mfma_f32_16x16x32_bf16 v[124:127], v[24:27], v[60:63], v[124:127]
    v_mfma_f32_16x16x32_bf16 v[112:115], v[28:31], v[56:59], v[112:115]
    buffer_load_dwordx4 v[52:55], v97, s[16:19], s11 offen offset:0 sc1
    v_mfma_f32_16x16x32_bf16 v[128:131], v[28:31], v[60:63], v[128:131]
    s_waitcnt vmcnt(10) lgkmcnt(0)
    v_mfma_f32_16x16x32_bf16 v[100:103], v[32:35], v[64:67], v[100:103]
    ds_read_b64_tr_b16 v[16:17], v4 offset:24576
    ds_read_b64_tr_b16 v[18:19], v4 offset:26624
    v_mfma_f32_16x16x32_bf16 v[116:119], v[32:35], v[68:71], v[116:119]
    ds_read_b64_tr_b16 v[20:21], v5 offset:24576
    ds_read_b64_tr_b16 v[22:23], v5 offset:26624
    v_mfma_f32_16x16x32_bf16 v[104:107], v[36:39], v[64:67], v[104:107]
    ds_read_b64_tr_b16 v[24:25], v6 offset:24576
    ds_read_b64_tr_b16 v[26:27], v6 offset:26624
    v_mfma_f32_16x16x32_bf16 v[120:123], v[36:39], v[68:71], v[120:123]
    ds_read_b64_tr_b16 v[28:29], v7 offset:24576
    ds_read_b64_tr_b16 v[30:31], v7 offset:26624
    v_mfma_f32_16x16x32_bf16 v[108:111], v[40:43], v[64:67], v[108:111]
    buffer_load_dwordx4 v[56:59], v98, s[16:19], s11 offen offset:1024 sc1
    v_mfma_f32_16x16x32_bf16 v[124:127], v[40:43], v[68:71], v[124:127]
    v_mfma_f32_16x16x32_bf16 v[112:115], v[44:47], v[64:67], v[112:115]
    buffer_load_dwordx4 v[60:63], v97, s[16:19], s11 offen offset:1024 sc1
    v_mfma_f32_16x16x32_bf16 v[128:131], v[44:47], v[68:71], v[128:131]
    s_waitcnt vmcnt(10) lgkmcnt(0)
    v_mfma_f32_16x16x32_bf16 v[100:103], v[16:19], v[72:75], v[100:103]
    ds_read_b64_tr_b16 v[32:33], v4 offset:28672
    ds_read_b64_tr_b16 v[34:35], v4 offset:30720
    v_mfma_f32_16x16x32_bf16 v[116:119], v[16:19], v[76:79], v[116:119]
    ds_read_b64_tr_b16 v[36:37], v5 offset:28672
    ds_read_b64_tr_b16 v[38:39], v5 offset:30720
    v_mfma_f32_16x16x32_bf16 v[104:107], v[20:23], v[72:75], v[104:107]
    ds_read_b64_tr_b16 v[40:41], v6 offset:28672
    ds_read_b64_tr_b16 v[42:43], v6 offset:30720
    v_mfma_f32_16x16x32_bf16 v[120:123], v[20:23], v[76:79], v[120:123]
    ds_read_b64_tr_b16 v[44:45], v7 offset:28672
    ds_read_b64_tr_b16 v[46:47], v7 offset:30720
    v_mfma_f32_16x16x32_bf16 v[108:111], v[24:27], v[72:75], v[108:111]
    buffer_load_dwordx4 v[64:67], v98, s[16:19], s30 offen offset:0 sc1
    v_mfma_f32_16x16x32_bf16 v[124:127], v[24:27], v[76:79], v[124:127]
    v_mfma_f32_16x16x32_bf16 v[112:115], v[28:31], v[72:75], v[112:115]
    buffer_load_dwordx4 v[68:71], v97, s[16:19], s30 offen offset:0 sc1
    v_mfma_f32_16x16x32_bf16 v[128:131], v[28:31], v[76:79], v[128:131]
    s_waitcnt vmcnt(10) lgkmcnt(0)
    v_mfma_f32_16x16x32_bf16 v[100:103], v[32:35], v[80:83], v[100:103]
    ds_read_b64_tr_b16 v[16:17], v12 offset:16384
    ds_read_b64_tr_b16 v[18:19], v12 offset:18432
    v_mfma_f32_16x16x32_bf16 v[116:119], v[32:35], v[84:87], v[116:119]
    ds_read_b64_tr_b16 v[20:21], v13 offset:16384
    ds_read_b64_tr_b16 v[22:23], v13 offset:18432
    v_mfma_f32_16x16x32_bf16 v[104:107], v[36:39], v[80:83], v[104:107]
    ds_read_b64_tr_b16 v[24:25], v14 offset:16384
    ds_read_b64_tr_b16 v[26:27], v14 offset:18432
    v_mfma_f32_16x16x32_bf16 v[120:123], v[36:39], v[84:87], v[120:123]
    ds_read_b64_tr_b16 v[28:29], v15 offset:16384
    ds_read_b64_tr_b16 v[30:31], v15 offset:18432
    v_mfma_f32_16x16x32_bf16 v[108:111], v[40:43], v[80:83], v[108:111]
    buffer_load_dwordx4 v[72:75], v98, s[16:19], s30 offen offset:1024 sc1
    v_mfma_f32_16x16x32_bf16 v[124:127], v[40:43], v[84:87], v[124:127]
    v_mfma_f32_16x16x32_bf16 v[112:115], v[44:47], v[80:83], v[112:115]
    buffer_load_dwordx4 v[76:79], v97, s[16:19], s30 offen offset:1024 sc1
    v_mfma_f32_16x16x32_bf16 v[128:131], v[44:47], v[84:87], v[128:131]
    s_waitcnt vmcnt(10) lgkmcnt(0)
    v_mfma_f32_16x16x32_bf16 v[100:103], v[16:19], v[88:91], v[100:103]
    ds_read_b64_tr_b16 v[32:33], v12 offset:20480
    ds_read_b64_tr_b16 v[34:35], v12 offset:22528
    v_mfma_f32_16x16x32_bf16 v[116:119], v[16:19], v[92:95], v[116:119]
    ds_read_b64_tr_b16 v[36:37], v13 offset:20480
    ds_read_b64_tr_b16 v[38:39], v13 offset:22528
    v_mfma_f32_16x16x32_bf16 v[104:107], v[20:23], v[88:91], v[104:107]
    ds_read_b64_tr_b16 v[40:41], v14 offset:20480
    ds_read_b64_tr_b16 v[42:43], v14 offset:22528
    v_mfma_f32_16x16x32_bf16 v[120:123], v[20:23], v[92:95], v[120:123]
    ds_read_b64_tr_b16 v[44:45], v15 offset:20480
    ds_read_b64_tr_b16 v[46:47], v15 offset:22528
    v_mfma_f32_16x16x32_bf16 v[108:111], v[24:27], v[88:91], v[108:111]
    buffer_load_dwordx4 v[80:83], v98, s[16:19], s31 offen offset:0 sc1
    v_mfma_f32_16x16x32_bf16 v[124:127], v[24:27], v[92:95], v[124:127]
    v_mfma_f32_16x16x32_bf16 v[112:115], v[28:31], v[88:91], v[112:115]
    buffer_load_dwordx4 v[84:87], v97, s[16:19], s31 offen offset:0 sc1
    v_mfma_f32_16x16x32_bf16 v[128:131], v[28:31], v[92:95], v[128:131]
    s_waitcnt vmcnt(10) lgkmcnt(0)
    v_mfma_f32_16x16x32_bf16 v[100:103], v[32:35], v[132:135], v[100:103]
    ds_read_b64_tr_b16 v[16:17], v8 offset:24576
    ds_read_b64_tr_b16 v[18:19], v8 offset:26624
    v_mfma_f32_16x16x32_bf16 v[116:119], v[32:35], v[136:139], v[116:119]
    ds_read_b64_tr_b16 v[20:21], v9 offset:24576
    ds_read_b64_tr_b16 v[22:23], v9 offset:26624
    v_mfma_f32_16x16x32_bf16 v[104:107], v[36:39], v[132:135], v[104:107]
    ds_read_b64_tr_b16 v[24:25], v10 offset:24576
    ds_read_b64_tr_b16 v[26:27], v10 offset:26624
    v_mfma_f32_16x16x32_bf16 v[120:123], v[36:39], v[136:139], v[120:123]
    ds_read_b64_tr_b16 v[28:29], v11 offset:24576
    ds_read_b64_tr_b16 v[30:31], v11 offset:26624
    v_mfma_f32_16x16x32_bf16 v[108:111], v[40:43], v[132:135], v[108:111]
    buffer_load_dwordx4 v[88:91], v98, s[16:19], s31 offen offset:1024 sc1
    v_mfma_f32_16x16x32_bf16 v[124:127], v[40:43], v[136:139], v[124:127]
    v_mfma_f32_16x16x32_bf16 v[112:115], v[44:47], v[132:135], v[112:115]
    buffer_load_dwordx4 v[92:95], v97, s[16:19], s31 offen offset:1024 sc1
    v_mfma_f32_16x16x32_bf16 v[128:131], v[44:47], v[136:139], v[128:131]
    s_waitcnt vmcnt(10) lgkmcnt(0)
    v_mfma_f32_16x16x32_bf16 v[100:103], v[16:19], v[48:51], v[100:103]
    ds_read_b64_tr_b16 v[32:33], v8 offset:28672
    ds_read_b64_tr_b16 v[34:35], v8 offset:30720
    v_mfma_f32_16x16x32_bf16 v[116:119], v[16:19], v[52:55], v[116:119]
    ds_read_b64_tr_b16 v[36:37], v9 offset:28672
    ds_read_b64_tr_b16 v[38:39], v9 offset:30720
    v_mfma_f32_16x16x32_bf16 v[104:107], v[20:23], v[48:51], v[104:107]
    ds_read_b64_tr_b16 v[40:41], v10 offset:28672
    ds_read_b64_tr_b16 v[42:43], v10 offset:30720
    v_mfma_f32_16x16x32_bf16 v[120:123], v[20:23], v[52:55], v[120:123]
    ds_read_b64_tr_b16 v[44:45], v11 offset:28672
    ds_read_b64_tr_b16 v[46:47], v11 offset:30720
    v_mfma_f32_16x16x32_bf16 v[108:111], v[24:27], v[48:51], v[108:111]
    buffer_load_dwordx4 v[132:135], v98, s[16:19], s32 offen offset:0 sc1
    v_mfma_f32_16x16x32_bf16 v[124:127], v[24:27], v[52:55], v[124:127]
    v_mfma_f32_16x16x32_bf16 v[112:115], v[28:31], v[48:51], v[112:115]
    buffer_load_dwordx4 v[136:139], v97, s[16:19], s32 offen offset:0 sc1
    v_mfma_f32_16x16x32_bf16 v[128:131], v[28:31], v[52:55], v[128:131]
    s_waitcnt vmcnt(10) lgkmcnt(0)
    v_mfma_f32_16x16x32_bf16 v[100:103], v[32:35], v[56:59], v[100:103]
    ds_read_b64_tr_b16 v[16:17], v4 offset:49152
    ds_read_b64_tr_b16 v[18:19], v4 offset:51200
    v_mfma_f32_16x16x32_bf16 v[116:119], v[32:35], v[60:63], v[116:119]
    ds_read_b64_tr_b16 v[20:21], v5 offset:49152
    ds_read_b64_tr_b16 v[22:23], v5 offset:51200
    v_mfma_f32_16x16x32_bf16 v[104:107], v[36:39], v[56:59], v[104:107]
    ds_read_b64_tr_b16 v[24:25], v6 offset:49152
    ds_read_b64_tr_b16 v[26:27], v6 offset:51200
    v_mfma_f32_16x16x32_bf16 v[120:123], v[36:39], v[60:63], v[120:123]
    ds_read_b64_tr_b16 v[28:29], v7 offset:49152
    ds_read_b64_tr_b16 v[30:31], v7 offset:51200
    v_mfma_f32_16x16x32_bf16 v[108:111], v[40:43], v[56:59], v[108:111]
    buffer_load_dwordx4 v[48:51], v98, s[16:19], s32 offen offset:1024 sc1
    v_mfma_f32_16x16x32_bf16 v[124:127], v[40:43], v[60:63], v[124:127]
    v_mfma_f32_16x16x32_bf16 v[112:115], v[44:47], v[56:59], v[112:115]
    buffer_load_dwordx4 v[52:55], v97, s[16:19], s32 offen offset:1024 sc1
    v_mfma_f32_16x16x32_bf16 v[128:131], v[44:47], v[60:63], v[128:131]
    s_waitcnt vmcnt(10) lgkmcnt(0)
    v_mfma_f32_16x16x32_bf16 v[100:103], v[16:19], v[64:67], v[100:103]
    ds_read_b64_tr_b16 v[32:33], v4 offset:53248
    ds_read_b64_tr_b16 v[34:35], v4 offset:55296
    v_mfma_f32_16x16x32_bf16 v[116:119], v[16:19], v[68:71], v[116:119]
    ds_read_b64_tr_b16 v[36:37], v5 offset:53248
    ds_read_b64_tr_b16 v[38:39], v5 offset:55296
    v_mfma_f32_16x16x32_bf16 v[104:107], v[20:23], v[64:67], v[104:107]
    ds_read_b64_tr_b16 v[40:41], v6 offset:53248
    ds_read_b64_tr_b16 v[42:43], v6 offset:55296
    v_mfma_f32_16x16x32_bf16 v[120:123], v[20:23], v[68:71], v[120:123]
    ds_read_b64_tr_b16 v[44:45], v7 offset:53248
    ds_read_b64_tr_b16 v[46:47], v7 offset:55296
    v_mfma_f32_16x16x32_bf16 v[108:111], v[24:27], v[64:67], v[108:111]
    s_branch IW_s7
IW_w7:
    s_branch IW_r7
IW_s7:
    buffer_load_dwordx4 v[56:59], v98, s[16:19], s33 offen offset:0 sc1
    v_mfma_f32_16x16x32_bf16 v[124:127], v[24:27], v[68:71], v[124:127]
    v_mfma_f32_16x16x32_bf16 v[112:115], v[28:31], v[64:67], v[112:115]
    buffer_load_dwordx4 v[60:63], v97, s[16:19], s33 offen offset:0 sc1
    v_mfma_f32_16x16x32_bf16 v[128:131], v[28:31], v[68:71], v[128:131]
    s_waitcnt vmcnt(10) lgkmcnt(0)
    v_mfma_f32_16x16x32_bf16 v[100:103], v[32:35], v[72:75], v[100:103]
    ds_read_b64_tr_b16 v[16:17], v8 offset:0
    ds_read_b64_tr_b16 v[18:19], v8 offset:2048
    v_mfma_f32_16x16x32_bf16 v[116:119], v[32:35], v[76:79], v[116:119]
    ds_read_b64_tr_b16 v[20:21], v9 offset:0
    ds_read_b64_tr_b16 v[22:23], v9 offset:2048
    v_mfma_f32_16x16x32_bf16 v[104:107], v[36:39], v[72:75], v[104:107]
    ds_read_b64_tr_b16 v[24:25], v10 offset:0
    ds_read_b64_tr_b16 v[26:27], v10 offset:2048
    v_mfma_f32_16x16x32_bf16 v[120:123], v[36:39], v[76:79], v[120:123]
    ds_read_b64_tr_b16 v[28:29], v11 offset:0
    ds_read_b64_tr_b16 v[30:31], v11 offset:2048
    v_mfma_f32_16x16x32_bf16 v[108:111], v[40:43], v[72:75], v[108:111]
    buffer_load_dwordx4 v[64:67], v98, s[16:19], s33 offen offset:1024 sc1
    v_mfma_f32_16x16x32_bf16 v[124:127], v[40:43], v[76:79], v[124:127]
    v_mfma_f32_16x16x32_bf16 v[112:115], v[44:47], v[72:75], v[112:115]
    buffer_load_dwordx4 v[68:71], v97, s[16:19], s33 offen offset:1024 sc1
    v_mfma_f32_16x16x32_bf16 v[128:131], v[44:47], v[76:79], v[128:131]
    s_waitcnt vmcnt(10) lgkmcnt(0)
    v_mfma_f32_16x16x32_bf16 v[100:103], v[16:19], v[80:83], v[100:103]
    ds_read_b64_tr_b16 v[32:33], v8 offset:4096
    ds_read_b64_tr_b16 v[34:35], v8 offset:6144
    v_mfma_f32_16x16x32_bf16 v[116:119], v[16:19], v[84:87], v[116:119]
    ds_read_b64_tr_b16 v[36:37], v9 offset:4096
    ds_read_b64_tr_b16 v[38:39], v9 offset:6144
    v_mfma_f32_16x16x32_bf16 v[104:107], v[20:23], v[80:83], v[104:107]
    ds_read_b64_tr_b16 v[40:41], v10 offset:4096
    ds_read_b64_tr_b16 v[42:43], v10 offset:6144
    v_mfma_f32_16x16x32_bf16 v[120:123], v[20:23], v[84:87], v[120:123]
    ds_read_b64_tr_b16 v[44:45], v11 offset:4096
    ds_read_b64_tr_b16 v[46:47], v11 offset:6144
    v_mfma_f32_16x16x32_bf16 v[108:111], v[24:27], v[80:83], v[108:111]
    buffer_load_dwordx4 v[72:75], v98, s[16:19], s34 offen offset:0 sc1
    v_mfma_f32_16x16x32_bf16 v[124:127], v[24:27], v[84:87], v[124:127]
    v_mfma_f32_16x16x32_bf16 v[112:115], v[28:31], v[80:83], v[112:115]
    buffer_load_dwordx4 v[76:79], v97, s[16:19], s34 offen offset:0 sc1
    v_mfma_f32_16x16x32_bf16 v[128:131], v[28:31], v[84:87], v[128:131]
    s_waitcnt vmcnt(10) lgkmcnt(0)
    v_mfma_f32_16x16x32_bf16 v[100:103], v[32:35], v[88:91], v[100:103]
    ds_read_b64_tr_b16 v[16:17], v8 offset:16384
    ds_read_b64_tr_b16 v[18:19], v8 offset:18432
    v_mfma_f32_16x16x32_bf16 v[116:119], v[32:35], v[92:95], v[116:119]
    ds_read_b64_tr_b16 v[20:21], v9 offset:16384
    ds_read_b64_tr_b16 v[22:23], v9 offset:18432
    v_mfma_f32_16x16x32_bf16 v[104:107], v[36:39], v[88:91], v[104:107]
    ds_read_b64_tr_b16 v[24:25], v10 offset:16384
    ds_read_b64_tr_b16 v[26:27], v10 offset:18432
    v_mfma_f32_16x16x32_bf16 v[120:123], v[36:39], v[92:95], v[120:123]
    ds_read_b64_tr_b16 v[28:29], v11 offset:16384
    ds_read_b64_tr_b16 v[30:31], v11 offset:18432
    v_mfma_f32_16x16x32_bf16 v[108:111], v[40:43], v[88:91], v[108:111]
    buffer_load_dwordx4 v[80:83], v98, s[16:19], s34 offen offset:1024 sc1
    v_mfma_f32_16x16x32_bf16 v[124:127], v[40:43], v[92:95], v[124:127]
    v_mfma_f32_16x16x32_bf16 v[112:115], v[44:47], v[88:91], v[112:115]
    buffer_load_dwordx4 v[84:87], v97, s[16:19], s34 offen offset:1024 sc1
    v_mfma_f32_16x16x32_bf16 v[128:131], v[44:47], v[92:95], v[128:131]
    s_waitcnt vmcnt(10) lgkmcnt(0)
    v_mfma_f32_16x16x32_bf16 v[100:103], v[16:19], v[132:135], v[100:103]
    ds_read_b64_tr_b16 v[32:33], v8 offset:20480
    ds_read_b64_tr_b16 v[34:35], v8 offset:22528
    v_mfma_f32_16x16x32_bf16 v[116:119], v[16:19], v[136:139], v[116:119]
    ds_read_b64_tr_b16 v[36:37], v9 offset:20480
    ds_read_b64_tr_b16 v[38:39], v9 offset:22528
    v_mfma_f32_16x16x32_bf16 v[104:107], v[20:23], v[132:135], v[104:107]
    ds_read_b64_tr_b16 v[40:41], v10 offset:20480
    ds_read_b64_tr_b16 v[42:43], v10 offset:22528
    v_mfma_f32_16x16x32_bf16 v[120:123], v[20:23], v[136:139], v[120:123]
    ds_read_b64_tr_b16 v[44:45], v11 offset:20480
    ds_read_b64_tr_b16 v[46:47], v11 offset:22528
    v_mfma_f32_16x16x32_bf16 v[108:111], v[24:27], v[132:135], v[108:111]
    buffer_load_dwordx4 v[88:91], v98, s[16:19], s35 offen offset:0 sc1
    v_mfma_f32_16x16x32_bf16 v[124:127], v[24:27], v[136:139], v[124:127]
    v_mfma_f32_16x16x32_bf16 v[112:115], v[28:31], v[132:135], v[112:115]
    buffer_load_dwordx4 v[92:95], v97, s[16:19], s35 offen offset:0 sc1
    v_mfma_f32_16x16x32_bf16 v[128:131], v[28:31], v[136:139], v[128:131]
    s_waitcnt vmcnt(10) lgkmcnt(0)
    v_mfma_f32_16x16x32_bf16 v[100:103], v[32:35], v[48:51], v[100:103]
    ds_read_b64_tr_b16 v[16:17], v8 offset:40960
    ds_read_b64_tr_b16 v[18:19], v8 offset:43008
    v_mfma_f32_16x16x32_bf16 v[116:119], v[32:35], v[52:55], v[116:119]
    ds_read_b64_tr_b16 v[20:21], v9 offset:40960
    ds_read_b64_tr_b16 v[22:23], v9 offset:43008
    v_mfma_f32_16x16x32_bf16 v[104:107], v[36:39], v[48:51], v[104:107]
    ds_read_b64_tr_b16 v[24:25], v10 offset:40960
    ds_read_b64_tr_b16 v[26:27], v10 offset:43008
    v_mfma_f32_16x16x32_bf16 v[120:123], v[36:39], v[52:55], v[120:123]
    ds_read_b64_tr_b16 v[28:29], v11 offset:40960
    ds_read_b64_tr_b16 v[30:31], v11 offset:43008
    v_mfma_f32_16x16x32_bf16 v[108:111], v[40:43], v[48:51], v[108:111]
    buffer_load_dwordx4 v[132:135], v98, s[16:19], s35 offen offset:1024 sc1
    v_mfma_f32_16x16x32_bf16 v[124:127], v[40:43], v[52:55], v[124:127]
    v_mfma_f32_16x16x32_bf16 v[112:115], v[44:47], v[48:51], v[112:115]
    buffer_load_dwordx4 v[136:139], v97, s[16:19], s35 offen offset:1024 sc1
    v_mfma_f32_16x16x32_bf16 v[128:131], v[44:47], v[52:55], v[128:131]
    s_waitcnt vmcnt(10) lgkmcnt(0)
    v_mfma_f32_16x16x32_bf16 v[100:103], v[16:19], v[56:59], v[100:103]
    ds_read_b64_tr_b16 v[32:33], v8 offset:45056
    ds_read_b64_tr_b16 v[34:35], v8 offset:47104
    v_mfma_f32_16x16x32_bf16 v[116:119], v[16:19], v[60:63], v[116:119]
    ds_read_b64_tr_b16 v[36:37], v9 offset:45056
    ds_read_b64_tr_b16 v[38:39], v9 offset:47104
    v_mfma_f32_16x16x32_bf16 v[104:107], v[20:23], v[56:59], v[104:107]
    ds_read_b64_tr_b16 v[40:41], v10 offset:45056
    ds_read_b64_tr_b16 v[42:43], v10 offset:47104
    v_mfma_f32_16x16x32_bf16 v[120:123], v[20:23], v[60:63], v[120:123]
    ds_read_b64_tr_b16 v[44:45], v11 offset:45056
    ds_read_b64_tr_b16 v[46:47], v11 offset:47104
    v_mfma_f32_16x16x32_bf16 v[108:111], v[24:27], v[56:59], v[108:111]
    buffer_load_dwordx4 v[48:51], v98, s[16:19], s36 offen offset:0 sc1
    v_mfma_f32_16x16x32_bf16 v[124:127], v[24:27], v[60:63], v[124:127]
    v_mfma_f32_16x16x32_bf16 v[112:115], v[28:31], v[56:59], v[112:115]
    buffer_load_dwordx4 v[52:55], v97, s[16:19], s36 offen offset:0 sc1
    v_mfma_f32_16x16x32_bf16 v[128:131], v[28:31], v[60:63], v[128:131]
    s_waitcnt vmcnt(10) lgkmcnt(0)
    v_mfma_f32_16x16x32_bf16 v[100:103], v[32:35], v[64:67], v[100:103]
    ds_read_b64_tr_b16 v[16:17], v8 offset:32768
    ds_read_b64_tr_b16 v[18:19], v8 offset:34816
    v_mfma_f32_16x16x32_bf16 v[116:119], v[32:35], v[68:71], v[116:119]
    ds_read_b64_tr_b16 v[20:21], v9 offset:32768
    ds_read_b64_tr_b16 v[22:23], v9 offset:34816
    v_mfma_f32_16x16x32_bf16 v[104:107], v[36:39], v[64:67], v[104:107]
    ds_read_b64_tr_b16 v[24:25], v10 offset:32768
    ds_read_b64_tr_b16 v[26:27], v10 offset:34816
    v_mfma_f32_16x16x32_bf16 v[120:123], v[36:39], v[68:71], v[120:123]
    ds_read_b64_tr_b16 v[28:29], v11 offset:32768
    ds_read_b64_tr_b16 v[30:31], v11 offset:34816
    v_mfma_f32_16x16x32_bf16 v[108:111], v[40:43], v[64:67], v[108:111]
    buffer_load_dwordx4 v[56:59], v98, s[16:19], s36 offen offset:1024 sc1
    v_mfma_f32_16x16x32_bf16 v[124:127], v[40:43], v[68:71], v[124:127]
    v_mfma_f32_16x16x32_bf16 v[112:115], v[44:47], v[64:67], v[112:115]
    buffer_load_dwordx4 v[60:63], v97, s[16:19], s36 offen offset:1024 sc1
    v_mfma_f32_16x16x32_bf16 v[128:131], v[44:47], v[68:71], v[128:131]
    s_waitcnt vmcnt(10) lgkmcnt(0)
    v_mfma_f32_16x16x32_bf16 v[100:103], v[16:19], v[72:75], v[100:103]
    ds_read_b64_tr_b16 v[32:33], v8 offset:36864
    ds_read_b64_tr_b16 v[34:35], v8 offset:38912
    v_mfma_f32_16x16x32_bf16 v[116:119], v[16:19], v[76:79], v[116:119]
    ds_read_b64_tr_b16 v[36:37], v9 offset:36864
    ds_read_b64_tr_b16 v[38:39], v9 offset:38912
    v_mfma_f32_16x16x32_bf16 v[104:107], v[20:23], v[72:75], v[104:107]
    ds_read_b64_tr_b16 v[40:41], v10 offset:36864
    ds_read_b64_tr_b16 v[42:43], v10 offset:38912
    v_mfma_f32_16x16x32_bf16 v[120:123], v[20:23], v[76:79], v[120:123]
    ds_read_b64_tr_b16 v[44:45], v11 offset:36864
    ds_read_b64_tr_b16 v[46:47], v11 offset:38912
    v_mfma_f32_16x16x32_bf16 v[108:111], v[24:27], v[72:75], v[108:111]
    buffer_load_dwordx4 v[64:67], v98, s[16:19], s37 offen offset:0 sc1
    v_mfma_f32_16x16x32_bf16 v[124:127], v[24:27], v[76:79], v[124:127]
    v_mfma_f32_16x16x32_bf16 v[112:115], v[28:31], v[72:75], v[112:115]
    buffer_load_dwordx4 v[68:71], v97, s[16:19], s37 offen offset:0 sc1
    v_mfma_f32_16x16x32_bf16 v[128:131], v[28:31], v[76:79], v[128:131]
    s_waitcnt vmcnt(10) lgkmcnt(0)
    v_mfma_f32_16x16x32_bf16 v[100:103], v[32:35], v[80:83], v[100:103]
    ds_read_b64_tr_b16 v[16:17], v12 offset:0
    ds_read_b64_tr_b16 v[18:19], v12 offset:2048
    v_mfma_f32_16x16x32_bf16 v[116:119], v[32:35], v[84:87], v[116:119]
    ds_read_b64_tr_b16 v[20:21], v13 offset:0
    ds_read_b64_tr_b16 v[22:23], v13 offset:2048
    v_mfma_f32_16x16x32_bf16 v[104:107], v[36:39], v[80:83], v[104:107]
    ds_read_b64_tr_b16 v[24:25], v14 offset:0
    ds_read_b64_tr_b16 v[26:27], v14 offset:2048
    v_mfma_f32_16x16x32_bf16 v[120:123], v[36:39], v[84:87], v[120:123]
    ds_read_b64_tr_b16 v[28:29], v15 offset:0
    ds_read_b64_tr_b16 v[30:31], v15 offset:2048
    v_mfma_f32_16x16x32_bf16 v[108:111], v[40:43], v[80:83], v[108:111]
    buffer_load_dwordx4 v[72:75], v98, s[16:19], s37 offen offset:1024 sc1
    v_mfma_f32_16x16x32_bf16 v[124:127], v[40:43], v[84:87], v[124:127]
    v_mfma_f32_16x16x32_bf16 v[112:115], v[44:47], v[80:83], v[112:115]
    buffer_load_dwordx4 v[76:79], v97, s[16:19], s37 offen offset:1024 sc1
    v_mfma_f32_16x16x32_bf16 v[128:131], v[44:47], v[84:87], v[128:131]
    s_waitcnt vmcnt(10) lgkmcnt(0)
    v_mfma_f32_16x16x32_bf16 v[100:103], v[16:19], v[88:91], v[100:103]
    ds_read_b64_tr_b16 v[32:33], v12 offset:4096
    ds_read_b64_tr_b16 v[34:35], v12 offset:6144
    v_mfma_f32_16x16x32_bf16 v[116:119], v[16:19], v[92:95], v[116:119]
    ds_read_b64_tr_b16 v[36:37], v13 offset:4096
    ds_read_b64_tr_b16 v[38:39], v13 offset:6144
    v_mfma_f32_16x16x32_bf16 v[104:107], v[20:23], v[88:91], v[104:107]
    ds_read_b64_tr_b16 v[40:41], v14 offset:4096
    ds_read_b64_tr_b16 v[42:43], v14 offset:6144
    v_mfma_f32_16x16x32_bf16 v[120:123], v[20:23], v[92:95], v[120:123]
    ds_read_b64_tr_b16 v[44:45], v15 offset:4096
    ds_read_b64_tr_b16 v[46:47], v15 offset:6144
    v_mfma_f32_16x16x32_bf16 v[108:111], v[24:27], v[88:91], v[108:111]
    v_mfma_f32_16x16x32_bf16 v[124:127], v[24:27], v[92:95], v[124:127]
    v_mfma_f32_16x16x32_bf16 v[112:115], v[28:31], v[88:91], v[112:115]
    v_mfma_f32_16x16x32_bf16 v[128:131], v[28:31], v[92:95], v[128:131]
    s_waitcnt vmcnt(8) lgkmcnt(0)
    v_mfma_f32_16x16x32_bf16 v[100:103], v[32:35], v[132:135], v[100:103]
    ds_read_b64_tr_b16 v[16:17], v8 offset:49152
    ds_read_b64_tr_b16 v[18:19], v8 offset:51200
    v_mfma_f32_16x16x32_bf16 v[116:119], v[32:35], v[136:139], v[116:119]
    ds_read_b64_tr_b16 v[20:21], v9 offset:49152
    ds_read_b64_tr_b16 v[22:23], v9 offset:51200
    v_mfma_f32_16x16x32_bf16 v[104:107], v[36:39], v[132:135], v[104:107]
    ds_read_b64_tr_b16 v[24:25], v10 offset:49152
    ds_read_b64_tr_b16 v[26:27], v10 offset:51200
    v_mfma_f32_16x16x32_bf16 v[120:123], v[36:39], v[136:139], v[120:123]
    ds_read_b64_tr_b16 v[28:29], v11 offset:49152
    ds_read_b64_tr_b16 v[30:31], v11 offset:51200
    v_mfma_f32_16x16x32_bf16 v[108:111], v[40:43], v[132:135], v[108:111]
    v_mfma_f32_16x16x32_bf16 v[124:127], v[40:43], v[136:139], v[124:127]
    v_mfma_f32_16x16x32_bf16 v[112:115], v[44:47], v[132:135], v[112:115]
    v_mfma_f32_16x16x32_bf16 v[128:131], v[44:47], v[136:139], v[128:131]
    s_waitcnt vmcnt(6) lgkmcnt(0)
    v_mfma_f32_16x16x32_bf16 v[100:103], v[16:19], v[48:51], v[100:103]
    ds_read_b64_tr_b16 v[32:33], v8 offset:53248
    ds_read_b64_tr_b16 v[34:35], v8 offset:55296
    v_mfma_f32_16x16x32_bf16 v[116:119], v[16:19], v[52:55], v[116:119]
    ds_read_b64_tr_b16 v[36:37], v9 offset:53248
    ds_read_b64_tr_b16 v[38:39], v9 offset:55296
    v_mfma_f32_16x16x32_bf16 v[104:107], v[20:23], v[48:51], v[104:107]
    ds_read_b64_tr_b16 v[40:41], v10 offset:53248
    ds_read_b64_tr_b16 v[42:43], v10 offset:55296
    v_mfma_f32_16x16x32_bf16 v[120:123], v[20:23], v[52:55], v[120:123]
    ds_read_b64_tr_b16 v[44:45], v11 offset:53248
    ds_read_b64_tr_b16 v[46:47], v11 offset:55296
    v_mfma_f32_16x16x32_bf16 v[108:111], v[24:27], v[48:51], v[108:111]
    v_mfma_f32_16x16x32_bf16 v[124:127], v[24:27], v[52:55], v[124:127]
    v_mfma_f32_16x16x32_bf16 v[112:115], v[28:31], v[48:51], v[112:115]
    v_mfma_f32_16x16x32_bf16 v[128:131], v[28:31], v[52:55], v[128:131]
    s_waitcnt vmcnt(4) lgkmcnt(0)
    v_mfma_f32_16x16x32_bf16 v[100:103], v[32:35], v[56:59], v[100:103]
    ds_read_b64_tr_b16 v[16:17], v12 offset:8192
    ds_read_b64_tr_b16 v[18:19], v12 offset:10240
    v_mfma_f32_16x16x32_bf16 v[116:119], v[32:35], v[60:63], v[116:119]
    ds_read_b64_tr_b16 v[20:21], v13 offset:8192
    ds_read_b64_tr_b16 v[22:23], v13 offset:10240
    v_mfma_f32_16x16x32_bf16 v[104:107], v[36:39], v[56:59], v[104:107]
    ds_read_b64_tr_b16 v[24:25], v14 offset:8192
    ds_read_b64_tr_b16 v[26:27], v14 offset:10240
    v_mfma_f32_16x16x32_bf16 v[120:123], v[36:39], v[60:63], v[120:123]
    ds_read_b64_tr_b16 v[28:29], v15 offset:8192
    ds_read_b64_tr_b16 v[30:31], v15 offset:10240
    v_mfma_f32_16x16x32_bf16 v[108:111], v[40:43], v[56:59], v[108:111]
    v_mfma_f32_16x16x32_bf16 v[124:127], v[40:43], v[60:63], v[124:127]
    v_mfma_f32_16x16x32_bf16 v[112:115], v[44:47], v[56:59], v[112:115]
    v_mfma_f32_16x16x32_bf16 v[128:131], v[44:47], v[60:63], v[128:131]
    s_waitcnt vmcnt(2) lgkmcnt(0)
    v_mfma_f32_16x16x32_bf16 v[100:103], v[16:19], v[64:67], v[100:103]
    ds_read_b64_tr_b16 v[32:33], v12 offset:12288
    ds_read_b64_tr_b16 v[34:35], v12 offset:14336
    v_mfma_f32_16x16x32_bf16 v[116:119], v[16:19], v[68:71], v[116:119]
    ds_read_b64_tr_b16 v[36:37], v13 offset:12288
    ds_read_b64_tr_b16 v[38:39], v13 offset:14336
    v_mfma_f32_16x16x32_bf16 v[104:107], v[20:23], v[64:67], v[104:107]
    ds_read_b64_tr_b16 v[40:41], v14 offset:12288
    ds_read_b64_tr_b16 v[42:43], v14 offset:14336
    v_mfma_f32_16x16x32_bf16 v[120:123], v[20:23], v[68:71], v[120:123]
    ds_read_b64_tr_b16 v[44:45], v15 offset:12288
    ds_read_b64_tr_b16 v[46:47], v15 offset:14336
    v_mfma_f32_16x16x32_bf16 v[108:111], v[24:27], v[64:67], v[108:111]
    v_mfma_f32_16x16x32_bf16 v[124:127], v[24:27], v[68:71], v[124:127]
    v_mfma_f32_16x16x32_bf16 v[112:115], v[28:31], v[64:67], v[112:115]
    v_mfma_f32_16x16x32_bf16 v[128:131], v[28:31], v[68:71], v[128:131]
    s_waitcnt vmcnt(0) lgkmcnt(0)
    s_cmp_eq_u64 s[60:61], 0
    s_cbranch_scc1 F_y0
    ds_read_b32 v160, v161
    ds_read_b128 v[48:51], v162 offset:0
    ds_read_b128 v[52:55], v162 offset:64
    ds_read_b128 v[56:59], v162 offset:128
    ds_read_b128 v[60:63], v162 offset:192
    ds_read_b128 v[64:67], v163 offset:0
    ds_read_b128 v[68:71], v163 offset:64
    ds_read_b128 v[80:83], v163 offset:128
    ds_read_b128 v[84:87], v163 offset:192
F_y0:
    v_mfma_f32_16x16x32_bf16 v[100:103], v[32:35], v[72:75], v[100:103]
    v_mfma_f32_16x16x32_bf16 v[104:107], v[36:39], v[72:75], v[104:107]
    v_mfma_f32_16x16x32_bf16 v[108:111], v[40:43], v[72:75], v[108:111]
    v_mfma_f32_16x16x32_bf16 v[112:115], v[44:47], v[72:75], v[112:115]
    v_mfma_f32_16x16x32_bf16 v[116:119], v[32:35], v[76:79], v[116:119]
    v_mfma_f32_16x16x32_bf16 v[120:123], v[36:39], v[76:79], v[120:123]
    v_mfma_f32_16x16x32_bf16 v[124:127], v[40:43], v[76:79], v[124:127]
    v_mfma_f32_16x16x32_bf16 v[128:131], v[44:47], v[76:79], v[128:131]
    s_cmp_eq_u64 s[60:61], 0
    s_cbranch_scc1 F_fin
F_y1:
    s_waitcnt lgkmcnt(0)
    v_cmp_eq_u32 vcc, 0, v160
    s_cbranch_vccz F_y2
    ds_read_b32 v160, v161
    ds_read_b128 v[48:51], v162 offset:0
    ds_read_b128 v[52:55], v162 offset:64
    ds_read_b128 v[56:59], v162 offset:128
    ds_read_b128 v[60:63], v162 offset:192
    ds_read_b128 v[64:67], v163 offset:0
    ds_read_b128 v[68:71], v163 offset:64
    ds_read_b128 v[80:83], v163 offset:128
    ds_read_b128 v[84:87], v163 offset:192
    s_branch F_y1
F_y2:
    s_nop 4
    s_mov_b64 exec, s[74:75]
    s_cbranch_execz F_rb_75
    v_fmac_f32 v100, v48, v164
    v_fmac_f32 v101, v49, v164
    v_fmac_f32 v102, v50, v164
    v_fmac_f32 v103, v51, v164
    v_fmac_f32 v104, v52, v164
    v_fmac_f32 v105, v53, v164
    v_fmac_f32 v106, v54, v164
    v_fmac_f32 v107, v55, v164
    v_fmac_f32 v108, v56, v164
    v_fmac_f32 v109, v57, v164
    v_fmac_f32 v110, v58, v164
    v_fmac_f32 v111, v59, v164
    v_fmac_f32 v112, v60, v164
    v_fmac_f32 v113, v61, v164
    v_fmac_f32 v114, v62, v164
    v_fmac_f32 v115, v63, v164
F_rb_75:
    s_mov_b64 exec, s[76:77]
    s_cbranch_execz F_rb_76
    v_fmac_f32 v116, v64, v165
    v_fmac_f32 v117, v65, v165
    v_fmac_f32 v118, v66, v165
    v_fmac_f32 v119, v67, v165
    v_fmac_f32 v120, v68, v165
    v_fmac_f32 v121, v69, v165
    v_fmac_f32 v122, v70, v165
    v_fmac_f32 v123, v71, v165
    v_fmac_f32 v124, v80, v165
    v_fmac_f32 v125, v81, v165
    v_fmac_f32 v126, v82, v165
    v_fmac_f32 v127, v83, v165
    v_fmac_f32 v128, v84, v165
    v_fmac_f32 v129, v85, v165
    v_fmac_f32 v130, v86, v165
    v_fmac_f32 v131, v87, v165
F_rb_76:
    s_mov_b64 exec, -1
F_fin:
    v_cvt_pk_bf16_f32 v16, v100, v101
    v_cvt_pk_bf16_f32 v17, v102, v103
    v_cvt_pk_bf16_f32 v18, v104, v105
    v_cvt_pk_bf16_f32 v19, v106, v107
    v_cvt_pk_bf16_f32 v20, v108, v109
    v_cvt_pk_bf16_f32 v21, v110, v111
    v_cvt_pk_bf16_f32 v22, v112, v113
    v_cvt_pk_bf16_f32 v23, v114, v115
    v_permlane16_swap_b32 v16, v18
    v_permlane16_swap_b32 v17, v19
    v_permlane16_swap_b32 v20, v22
    v_permlane16_swap_b32 v21, v23
    v_mov_b32 v4, v16
    v_mov_b32 v5, v17
    v_mov_b32 v6, v18
    v_mov_b32 v7, v19
    v_mov_b32_dpp v16, v20 row_ror:8 row_mask:0xf bank_mask:0xc
    v_mov_b32_dpp v17, v21 row_ror:8 row_mask:0xf bank_mask:0xc
    v_mov_b32_dpp v18, v22 row_ror:8 row_mask:0xf bank_mask:0xc
    v_mov_b32_dpp v19, v23 row_ror:8 row_mask:0xf bank_mask:0xc
    v_mov_b32_dpp v20, v4 row_ror:8 row_mask:0xf bank_mask:0x3
    v_mov_b32_dpp v21, v5 row_ror:8 row_mask:0xf bank_mask:0x3
    v_mov_b32_dpp v22, v6 row_ror:8 row_mask:0xf bank_mask:0x3
    v_mov_b32_dpp v23, v7 row_ror:8 row_mask:0xf bank_mask:0x3
    s_add_u32 s44, s42, 0x4000
    buffer_store_dwordx4 v[16:19], v1, s[12:15], s42 offen sc1
    buffer_store_dwordx4 v[20:23], v1, s[12:15], s44 offen sc1
    v_cvt_pk_bf16_f32 v24, v116, v117
    v_cvt_pk_bf16_f32 v25, v118, v119
    v_cvt_pk_bf16_f32 v26, v120, v121
    v_cvt_pk_bf16_f32 v27, v122, v123
    v_cvt_pk_bf16_f32 v28, v124, v125
    v_cvt_pk_bf16_f32 v29, v126, v127
    v_cvt_pk_bf16_f32 v30, v128, v129
    v_cvt_pk_bf16_f32 v31, v130, v131
    v_permlane16_swap_b32 v24, v26
    v_permlane16_swap_b32 v25, v27
    v_permlane16_swap_b32 v28, v30
    v_permlane16_swap_b32 v29, v31
    v_mov_b32 v4, v24
    v_mov_b32 v5, v25
    v_mov_b32 v6, v26
    v_mov_b32 v7, v27
    v_mov_b32_dpp v24, v28 row_ror:8 row_mask:0xf bank_mask:0xc
    v_mov_b32_dpp v25, v29 row_ror:8 row_mask:0xf bank_mask:0xc
    v_mov_b32_dpp v26, v30 row_ror:8 row_mask:0xf bank_mask:0xc
    v_mov_b32_dpp v27, v31 row_ror:8 row_mask:0xf bank_mask:0xc
    v_mov_b32_dpp v28, v4 row_ror:8 row_mask:0xf bank_mask:0x3
    v_mov_b32_dpp v29, v5 row_ror:8 row_mask:0xf bank_mask:0x3
    v_mov_b32_dpp v30, v6 row_ror:8 row_mask:0xf bank_mask:0x3
    v_mov_b32_dpp v31, v7 row_ror:8 row_mask:0xf bank_mask:0x3
    s_add_u32 s44, s43, 0x4000
    buffer_store_dwordx4 v[24:27], v1, s[12:15], s43 offen sc1
    buffer_store_dwordx4 v[28:31], v1, s[12:15], s44 offen sc1
    s_endpgm
F_aux:
    s_setprio 3
    s_sub_u32 s3, s3, 8
    s_mov_b32 s88, s3
    v_lshrrev_b32 v5, 4, v0
    s_cmp_eq_u32 s3, 1
    s_mov_b32 s45, 73728
    s_cselect_b32 s45, 65536, s45
    s_cmp_eq_u32 s3, 2
    s_cselect_b32 s45, 147456, s45
    v_bfe_u32 v60, v0, 2, 2
    v_lshl_add_u32 v62, v5, 3, v60
    v_lshrrev_b32 v60, 1, v60
    v_and_b32 v63, 1, v5
    v_lshl_add_u32 v60, v63, 1, v60
    v_lshlrev_b32 v60, 5, v60
    v_lshl_add_u32 v60, v62, 7, v60
    v_and_b32 v63, 3, v0
    v_lshl_add_u32 v60, v63, 3, v60
    v_add_u32 v62, s45, v60
    v_xor_b32 v63, 32, v62
    v_xor_b32 v64, 64, v62
    v_xor_b32 v65, 96, v62
    v_lshlrev_b32 v2, 4, v0
    v_lshlrev_b32 v3, 2, v0
    v_and_b32 v7, 15, v0
    v_and_b32 v8, 7, v0
    v_lshlrev_b32 v8, 4, v8
    v_lshl_add_u32 v8, v5, 7, v8
    v_bfe_u32 v9, v0, 3, 1
    v_lshl_add_u32 v4, v9, 11, v8
    v_and_b32 v9, 1, v0
    v_lshlrev_b32 v59, 2, v7
    s_lshl_b32 s76, s32, 4
    s_add_u32 s76, s76, s33
    s_lshl_b32 s77, s76, 3
    s_lshl_b32 s44, s3, 1
    s_add_u32 s77, s77, s44
    v_mov_b32 v12, 0
    v_mov_b32 v13, 0
    v_mov_b32 v14, 0
    v_mov_b32 v15, 0
    s_lshl_b32 s75, s3, 4
    s_add_u32 s75, s75, s33
    s_lshl_b32 s44, s3, 2
    s_add_u32 s44, s44, 159040
    v_mov_b32 v10, s44

    v_mov_b32 v32, 0x3f803f80
    v_mov_b32 v33, 0x3f803f80
    v_mov_b32 v34, 0x3f803f80
    v_mov_b32 v35, 0x3f803f80
    v_mov_b32 v36, 0x3f803f80
    v_mov_b32 v37, 0x3f803f80
    v_mov_b32 v38, 0x3f803f80
    v_mov_b32 v39, 0x3f803f80
    v_mov_b32 v40, 0x3f803f80
    v_mov_b32 v41, 0x3f803f80
    v_mov_b32 v42, 0x3f803f80
    v_mov_b32 v43, 0x3f803f80
    v_mov_b32 v44, 0x3f803f80
    v_mov_b32 v45, 0x3f803f80
    v_mov_b32 v46, 0x3f803f80
    v_mov_b32 v47, 0x3f803f80
    s_waitcnt lgkmcnt(0)
    s_mov_b32 s20, s4
    s_mov_b32 s21, s5
    s_mov_b32 s22, 0x400000
    s_mov_b32 s23, 0x00020000
    s_mov_b32 s19, 0x20000
    s_add_u32 s40, s72, 0x850000
    s_addc_u32 s41, s73, 0
    s_mov_b32 s42, 0xd000
    s_mov_b32 s43, 0x00020000
    s_cmp_lg_u32 s3, 0
    s_cbranch_scc1 F_z0
    s_getpc_b64 s[46:47]
F_pc:
    s_sub_u32 s46, s46, F_pc-parallel_sum__linear_attn_block__moe_arch_mod__prompt_kernel
    s_subb_u32 s47, s47, 0
    s_and_b32 s44, s31, 7
    s_lshl_b32 s44, s44, 13
    v_lshlrev_b32 v67, 7, v0
    v_add_u32 v67, s44, v67
    v_min_u32 v67, F_codeend-parallel_sum__linear_attn_block__moe_arch_mod__prompt_kernel-4, v67
    global_load_dword v61, v67, s[46:47]
    s_cmp_lg_u32 s75, 0
    s_cbranch_scc1 F_z0
    s_lshl_b32 s44, s32, 9
    s_add_u32 s44, s44, 32768
    s_mov_b32 exec_hi, 0
    buffer_store_dwordx4 v[12:15], v2, s[40:43], s44 offen sc0 sc1
    s_mul_i32 s44, s32, 768
    s_add_u32 s44, s44, 40960
    s_mov_b32 exec_hi, 0xffff
    buffer_store_dwordx4 v[12:15], v2, s[40:43], s44 offen sc0 sc1
    s_mov_b64 exec, -1
F_z0:

    s_and_b32 s89, s2, 0xdd
    s_bfe_u32 s44, s2, 0x10005
    s_lshl_b32 s44, s44, 1
    s_or_b32 s89, s89, s44
    s_bfe_u32 s44, s2, 0x10001
    s_xor_b32 s44, s44, 1
    s_lshl_b32 s44, s44, 5
    s_or_b32 s89, s89, s44
    s_xor_b32 s89, s89, 0

    s_and_b32 s36, s89, 3
    s_bfe_u32 s37, s89, 0x10002
    s_lshr_b32 s38, s89, 3
    s_cmp_eq_u32 s37, 0
    s_cselect_b32 s16, s62, s64
    s_cselect_b32 s17, s63, s65
    s_cmp_lt_u32 s89, 224
    s_cselect_b32 s18, 7340032, 0
    v_mul_u32_u24 v6, 57344, v5
    v_lshl_add_u32 v6, v7, 4, v6
    s_lshl_b32 s44, s36, 2
    s_add_u32 s44, s44, s3
    s_mul_i32 s54, s44, 458752
    s_lshl_b32 s45, s38, 8
    s_add_u32 s54, s54, s45
    s_lshl_b32 s55, s44, 7

    s_add_u32 s39, s35, 2
    s_and_b32 s39, s39, 7
    s_lshl_b32 s10, s34, 3
    s_add_u32 s10, s10, s30

    s_mul_i32 s10, s10, 112
    s_mul_i32 s79, s3, 28
    s_add_u32 s10, s10, s79
    s_lshl_b32 s78, s10, 11
    s_lshl_b32 s79, s39, 8
    s_add_u32 s78, s78, s79
    v_mul_u32_u24 v160, 14336, v5
    v_lshl_add_u32 v160, v7, 4, v160

    s_mov_b32 s80, s66
    s_mov_b32 s81, s67
    s_mov_b32 s82, 0x700000
    s_mov_b32 s83, 0x00020000
    s_barrier
    s_bitcmp0_b32 s3, 0
    s_cbranch_scc1 F_cs1
    ds_read_b64_tr_b16 v[72:73], v62 offset:0
    ds_read_b64_tr_b16 v[74:75], v62 offset:512
    ds_read_b64_tr_b16 v[76:77], v62 offset:4096
    ds_read_b64_tr_b16 v[78:79], v62 offset:4608
    ds_read_b64_tr_b16 v[80:81], v63 offset:0
    ds_read_b64_tr_b16 v[82:83], v63 offset:512
    ds_read_b64_tr_b16 v[84:85], v63 offset:4096
    ds_read_b64_tr_b16 v[86:87], v63 offset:4608
    s_waitcnt lgkmcnt(4)
    ds_read_b64_tr_b16 v[88:89], v64 offset:0
    ds_read_b64_tr_b16 v[90:91], v64 offset:512
    ds_read_b64_tr_b16 v[92:93], v64 offset:4096
    ds_read_b64_tr_b16 v[94:95], v64 offset:4608
    ds_read_b64_tr_b16 v[96:97], v65 offset:0
    ds_read_b64_tr_b16 v[98:99], v65 offset:512
    ds_read_b64_tr_b16 v[100:101], v65 offset:4096
    ds_read_b64_tr_b16 v[102:103], v65 offset:4608
    s_branch F_cs2
F_cs1:
    v_add_u32 v60, 159040, v3
    s_mov_b32 exec_hi, 0xffff
    ds_write_b32 v60, v12
    s_mov_b64 exec, -1
F_cs2:
    s_add_u32 s24, s72, 0x800000
    s_addc_u32 s25, s73, 0
    s_mov_b32 s26, 0x48000
    s_mov_b32 s27, 0x00020000
    s_mov_b32 s48, s70
    s_mov_b32 s49, s71
    s_mov_b32 s50, 0x100
    s_mov_b32 s51, 0x00020000
    s_lshl_b32 s47, s32, 9
    s_add_u32 s56, s47, 0x858000
    s_add_u32 s56, s72, s56
    s_addc_u32 s57, s73, 0
    s_lshl_b32 s47, s33, 9
    s_add_u32 s58, s47, 0x858100
    s_add_u32 s58, s72, s58
    s_addc_u32 s59, s73, 0
    v_mov_b32 v68, 0x3f803f80
    v_mov_b32 v69, 0x3f803f80
    v_mov_b32 v70, 0x3f803f80
    v_mov_b32 v71, 0x3f803f80
    s_waitcnt lgkmcnt(0)
    s_cmp_lg_u32 s75, 0
    s_cbranch_scc1 F_z4
    s_lshl_b32 s45, s32, 2
    s_add_u32 s44, s70, s45
    s_addc_u32 s45, s71, 0
    s_mov_b32 s46, 1
    s_waitcnt vmcnt(0)
    s_atomic_add s46, s[44:45], 0
F_z4:

    s_bitcmp0_b32 s3, 0
    s_cbranch_scc1 F_c2a
    v_mfma_f32_16x16x32_bf16 v[104:107], v[68:71], v[72:75], 0
    v_mfma_f32_16x16x32_bf16 v[108:111], v[68:71], v[80:83], 0
    v_mfma_f32_16x16x32_bf16 v[112:115], v[68:71], v[88:91], 0
    v_mfma_f32_16x16x32_bf16 v[116:119], v[68:71], v[96:99], 0
    v_mfma_f32_16x16x32_bf16 v[104:107], v[68:71], v[76:79], v[104:107]
    v_mfma_f32_16x16x32_bf16 v[108:111], v[68:71], v[84:87], v[108:111]
    v_mfma_f32_16x16x32_bf16 v[112:115], v[68:71], v[92:95], v[112:115]
    v_mfma_f32_16x16x32_bf16 v[116:119], v[68:71], v[100:103], v[116:119]
    v_cmp_eq_u32 vcc, 1, v5
    s_nop 4
    v_cndmask_b32 v66, v104, v108, vcc
    v_cmp_eq_u32 vcc, 2, v5
    s_nop 1
    v_cndmask_b32 v66, v66, v112, vcc
    v_cmp_eq_u32 vcc, 3, v5
    s_nop 1
    v_cndmask_b32 v66, v66, v116, vcc

F_c2a:
    s_barrier
    s_cmp_lg_u32 s3, 2
    s_cbranch_scc1 F_cs3
    ds_read_b64_tr_b16 v[72:73], v62 offset:0
    ds_read_b64_tr_b16 v[74:75], v62 offset:512
    ds_read_b64_tr_b16 v[76:77], v62 offset:4096
    ds_read_b64_tr_b16 v[78:79], v62 offset:4608
    ds_read_b64_tr_b16 v[80:81], v63 offset:0
    ds_read_b64_tr_b16 v[82:83], v63 offset:512
    ds_read_b64_tr_b16 v[84:85], v63 offset:4096
    s_branch IW_s8
IW_w8:
    s_branch IW_r8
IW_s8:
    ds_read_b64_tr_b16 v[86:87], v63 offset:4608
    s_waitcnt lgkmcnt(4)
    ds_read_b64_tr_b16 v[88:89], v64 offset:0
    ds_read_b64_tr_b16 v[90:91], v64 offset:512
    ds_read_b64_tr_b16 v[92:93], v64 offset:4096
    ds_read_b64_tr_b16 v[94:95], v64 offset:4608
    ds_read_b64_tr_b16 v[96:97], v65 offset:0
    ds_read_b64_tr_b16 v[98:99], v65 offset:512
    ds_read_b64_tr_b16 v[100:101], v65 offset:4096
    ds_read_b64_tr_b16 v[102:103], v65 offset:4608
    s_waitcnt lgkmcnt(0)
F_cs3:
    s_cmp_lg_u32 s3, 0
    s_cbranch_scc1 EV_78
    s_branch IW_w8
IW_r8:
EV_78:
    s_cmp_lg_u32 s3, 1
    s_cbranch_scc1 EV_79
    s_branch IW_w0
IW_r0:
EV_79:
    s_cmp_lg_u32 s3, 2
    s_cbranch_scc1 EV_80
    s_branch IW_w1
IW_r1:
EV_80:
    s_cmp_lg_u32 s3, 3
    s_cbranch_scc1 EV_81
    s_branch IW_w3
IW_r3:
EV_81:
    s_barrier
    s_cmp_lt_u32 s3, 2
    s_mov_b32 s44, 98304
    s_cselect_b32 s44, 98304, s44
    s_lshl_b32 s45, s3, 12
    s_add_u32 s44, s44, s45
    v_add_u32 v4, s44, v4
    v_add_u32 v8, 161792, v8
    ds_read_b128 v[16:19], v4 offset:0
    ds_read_b128 v[20:23], v4 offset:512
    ds_read_b128 v[24:27], v4 offset:1024
    ds_read_b128 v[28:31], v4 offset:1536
    s_mov_b32 exec_lo, 0x00ff00ff
    s_mov_b32 exec_hi, 0x00ff00ff
    ds_read_b128 v[32:35], v8 offset:0
    ds_read_b128 v[36:39], v8 offset:512
    ds_read_b128 v[40:43], v8 offset:1024
    ds_read_b128 v[44:47], v8 offset:1536
    s_mov_b64 exec, -1
    s_waitcnt lgkmcnt(0)
    v_mfma_f32_16x16x32_bf16 v[120:123], v[16:19], v[16:19], 0
    v_mfma_f32_16x16x32_bf16 v[124:127], v[16:19], v[32:35], 0
    v_mfma_f32_16x16x32_bf16 v[128:131], v[32:35], v[32:35], 0
    v_mfma_f32_16x16x32_bf16 v[120:123], v[20:23], v[20:23], v[120:123]
    v_mfma_f32_16x16x32_bf16 v[124:127], v[20:23], v[36:39], v[124:127]
    v_mfma_f32_16x16x32_bf16 v[128:131], v[36:39], v[36:39], v[128:131]
    v_mfma_f32_16x16x32_bf16 v[120:123], v[24:27], v[24:27], v[120:123]
    v_mfma_f32_16x16x32_bf16 v[124:127], v[24:27], v[40:43], v[124:127]
    v_mfma_f32_16x16x32_bf16 v[128:131], v[40:43], v[40:43], v[128:131]
    v_mfma_f32_16x16x32_bf16 v[120:123], v[28:31], v[28:31], v[120:123]
    v_mfma_f32_16x16x32_bf16 v[124:127], v[28:31], v[44:47], v[124:127]
    v_mfma_f32_16x16x32_bf16 v[128:131], v[44:47], v[44:47], v[128:131]
    s_cmp_lg_u32 s3, 2
    s_cbranch_scc1 F_c2b
    v_mfma_f32_16x16x32_bf16 v[104:107], v[68:71], v[72:75], 0
    v_mfma_f32_16x16x32_bf16 v[108:111], v[68:71], v[80:83], 0
    v_mfma_f32_16x16x32_bf16 v[112:115], v[68:71], v[88:91], 0
    v_mfma_f32_16x16x32_bf16 v[116:119], v[68:71], v[96:99], 0
    v_mfma_f32_16x16x32_bf16 v[104:107], v[68:71], v[76:79], v[104:107]
    v_mfma_f32_16x16x32_bf16 v[108:111], v[68:71], v[84:87], v[108:111]
    v_mfma_f32_16x16x32_bf16 v[112:115], v[68:71], v[92:95], v[112:115]
    v_mfma_f32_16x16x32_bf16 v[116:119], v[68:71], v[100:103], v[116:119]
    v_cmp_eq_u32 vcc, 1, v5
    s_nop 4
    v_cndmask_b32 v66, v104, v108, vcc
    v_cmp_eq_u32 vcc, 2, v5
    s_nop 1
    v_cndmask_b32 v66, v66, v112, vcc
    v_cmp_eq_u32 vcc, 3, v5
    s_nop 1
    v_cndmask_b32 v66, v66, v116, vcc

F_c2b:
    s_cmp_lg_u32 s3, 0
    s_cbranch_scc1 F_r1
    buffer_load_dword v11, v59, s[48:51], 0 offen sc0 sc1
F_r1:
    s_cmp_lg_u32 s3, 0
    s_cbranch_scc1 EV_83
    s_branch IW_w4
IW_r4:
EV_83:
    s_cmp_lg_u32 s3, 1
    s_cbranch_scc1 EV_84
    s_branch IW_w9
IW_r9:
EV_84:
    s_cmp_lg_u32 s3, 2
    s_cbranch_scc1 EV_85
    s_branch IW_w10
IW_r10:
EV_85:
    s_cmp_lg_u32 s3, 3
    s_cbranch_scc1 EV_86
    s_nop 0
EV_86:
    s_barrier
    v_and_b32 v52, 3, v0
    v_cmp_eq_u32 vcc, 1, v52
    s_nop 1
    v_cndmask_b32 v120, v120, v121, vcc
    v_cndmask_b32 v124, v124, v125, vcc
    v_cndmask_b32 v128, v128, v129, vcc
    v_cmp_eq_u32 vcc, 2, v52
    s_nop 1
    v_cndmask_b32 v120, v120, v122, vcc
    v_cndmask_b32 v124, v124, v126, vcc
    v_cndmask_b32 v128, v128, v130, vcc
    v_cmp_eq_u32 vcc, 3, v52
    s_nop 1
    v_cndmask_b32 v120, v120, v123, vcc
    v_cndmask_b32 v124, v124, v127, vcc
    v_cndmask_b32 v128, v128, v131, vcc
    v_add_f32_dpp v120, v120, v120 quad_perm:[1,0,3,2] row_mask:0xf bank_mask:0xf
    v_add_f32_dpp v124, v124, v124 quad_perm:[1,0,3,2] row_mask:0xf bank_mask:0xf
    v_add_f32_dpp v128, v128, v128 quad_perm:[1,0,3,2] row_mask:0xf bank_mask:0xf
    v_add_f32_dpp v120, v120, v120 quad_perm:[2,3,0,1] row_mask:0xf bank_mask:0xf
    v_add_f32_dpp v124, v124, v124 quad_perm:[2,3,0,1] row_mask:0xf bank_mask:0xf
    v_add_f32_dpp v128, v128, v128 quad_perm:[2,3,0,1] row_mask:0xf bank_mask:0xf
    v_readlane_b32 s44, v124, 8
    v_readlane_b32 s45, v124, 24
    v_readlane_b32 s46, v124, 40
    v_readlane_b32 s47, v124, 56
    v_mov_b32 v48, s44
    v_mov_b32 v52, s45
    s_nop 0
    v_writelane_b32 v48, s46, 1
    v_writelane_b32 v52, s47, 1
    v_readlane_b32 s44, v120, 0
    v_readlane_b32 s45, v120, 20
    v_readlane_b32 s46, v120, 40
    v_readlane_b32 s47, v120, 60
    v_mov_b32 v49, s44
    v_mov_b32 v53, s45
    s_nop 0
    v_writelane_b32 v49, s46, 1
    v_writelane_b32 v53, s47, 1
    v_readlane_b32 s44, v124, 0
    v_readlane_b32 s45, v124, 20
    v_readlane_b32 s46, v124, 32
    v_readlane_b32 s47, v124, 52
    v_mov_b32 v50, s44
    v_mov_b32 v54, s45
    s_nop 0
    v_writelane_b32 v50, s46, 1
    v_writelane_b32 v54, s47, 1
    v_readlane_b32 s44, v128, 8
    v_readlane_b32 s45, v128, 24
    v_readlane_b32 s46, v128, 8
    v_readlane_b32 s47, v128, 24
    v_mov_b32 v51, s44
    v_mov_b32 v55, s45
    s_nop 0
    v_writelane_b32 v51, s46, 1
    v_writelane_b32 v55, s47, 1
    v_add_f32 v48, v48, v52
    v_add_f32 v49, v49, v53
    v_add_f32 v50, v50, v54
    v_add_f32 v51, v51, v55
    v_mul_f32 v48, 0x3a800000, v48
    v_mul_f32 v49, 0x3a800000, v49
    v_fma_f32 v49, -v48, v48, v49
    v_max_f32 v49, 0, v49
    v_cvt_pk_bf16_f32 v52, v48, v49
    v_lshlrev_b32 v48, 16, v52
    v_and_b32 v49, 0xffff0000, v52
    v_add_f32 v49, 0x3727c5ac, v49
    v_cvt_pk_bf16_f32 v49, v49, v49
    v_lshlrev_b32 v49, 16, v49
    v_sqrt_f32 v49, v49
    s_nop 0
    v_cvt_pk_bf16_f32 v49, v49, v49
    v_lshlrev_b32 v49, 16, v49
    v_rcp_f32 v49, v49
    v_xor_b32 v48, 0x80000000, v48
    v_fma_f32 v50, v48, v51, v50
    v_mul_f32 v50, v50, v49
    v_cvt_pk_bf16_f32 v50, v50, v50
    v_and_b32 v50, 0xffff0000, v50
    v_ashrrev_i32 v51, 31, v50
    v_or_b32 v51, 0x80000000, v51
    v_xor_b32 v50, v50, v51
    v_and_b32 v50, 0xffff0000, v50
    s_sub_u32 s44, 2047, s77
    v_sub_u32 v51, s44, v9
    v_or_b32 v50, v50, v51
    s_lshl_b32 s44, s3, 1
    v_add_u32 v52, s44, v9
    v_lshlrev_b32 v53, 3, v52
    v_lshlrev_b32 v52, 2, v52
    v_add_u32 v53, 159744, v53
    v_add_u32 v52, 159808, v52
    s_mov_b64 exec, 3
    ds_write_b64 v53, v[48:49]
    ds_write_b32 v52, v50
    s_mov_b64 exec, -1
    s_waitcnt lgkmcnt(0)

    s_cmp_lg_u32 s3, 0
    s_cbranch_scc1 F_a0r
F_a0p:
    s_waitcnt vmcnt(0)
    v_cmp_eq_u32 vcc, 0, v11
    s_cbranch_vccz F_a0r
    s_sleep 4
    buffer_load_dword v11, v59, s[48:51], 0 offen sc0 sc1
    s_branch F_a0p
F_a0r:
    s_barrier
    s_cmp_eq_u32 s3, 0
    s_cbranch_scc1 F_ax0
    s_mul_i32 s44, s33, 768
    s_add_u32 s44, s44, 40960
    s_add_u32 s45, s3, 1
    s_lshr_b32 s45, s45, 1
    s_cmp_eq_u32 s3, 2
    s_cselect_b32 s45, 0, s45
    s_lshl_b32 s45, s45, 8
    s_add_u32 s44, s44, s45
    buffer_atomic_add_f32 v66, v3, s[40:43], s44 offen
    s_mul_i32 s44, s2, 1152
    s_mul_i32 s45, s3, 384
    s_add_u32 s44, s44, s45
    s_sub_u32 s44, s44, 384
    s_mov_b64 exec, 0xffffff
    buffer_store_dwordx4 v[12:15], v2, s[24:27], s44 offen sc0 sc1
    s_mov_b64 exec, -1
    s_branch F_s1
F_ax0:
    v_add_u32 v60, 159744, v3
    ds_read_b32 v60, v60
    s_lshl_b32 s44, s76, 7
    s_mov_b32 exec_hi, 0
    s_waitcnt lgkmcnt(0)
    buffer_store_dword v60, v3, s[40:43], s44 offen sc0 sc1
    s_mov_b64 exec, -1
F_s1:

    s_barrier
    v_mov_b32 v4, 159144
    v_mov_b32 v8, 1
    s_lshr_b32 s47, s32, 2
    s_lshl_b32 s47, s47, 11
    s_add_u32 s86, s47, 0x858180
    s_add_u32 s86, s72, s86
    s_addc_u32 s87, s73, 0
    s_waitcnt vmcnt(0)
    s_mov_b64 exec, 1
    ds_add_rtn_u32 v9, v4, v8
    s_waitcnt lgkmcnt(0)
    v_readfirstlane_b32 s44, v9
    s_mov_b64 exec, -1
    s_cmp_lg_u32 s44, 3
    s_cbranch_scc1 F_a0s
    s_mov_b32 s74, 1
    s_atomic_add s74, s[86:87], 0
    s_atomic_add s74, s[56:57], 0
    s_atomic_add s74, s[58:59], 0
F_a0s:

    s_barrier
    s_mul_i32 s53, s2, 37
    s_and_b32 s53, s53, 255
    s_mul_i32 s53, s53, 4
    s_lshr_b32 s53, s53, 8
    s_branch F_swx
F_sw0:
    s_add_u32 s91, s54, 0
    buffer_load_dwordx4 v[72:75], v6, s[16:19], s91 offen nt
    s_add_u32 s91, s54, 7168
    buffer_load_dwordx4 v[76:79], v6, s[16:19], s91 offen nt
    s_add_u32 s91, s54, 14336
    buffer_load_dwordx4 v[80:83], v6, s[16:19], s91 offen nt
    s_add_u32 s91, s54, 21504
    buffer_load_dwordx4 v[84:87], v6, s[16:19], s91 offen nt
    s_add_u32 s91, s54, 28672
    buffer_load_dwordx4 v[88:91], v6, s[16:19], s91 offen nt
    s_add_u32 s91, s54, 35840
    buffer_load_dwordx4 v[92:95], v6, s[16:19], s91 offen nt
    s_add_u32 s91, s54, 43008
    buffer_load_dwordx4 v[96:99], v6, s[16:19], s91 offen nt
    s_add_u32 s91, s54, 50176
    buffer_load_dwordx4 v[100:103], v6, s[16:19], s91 offen nt
    s_setpc_b64 s[34:35]
F_swx:
    s_cmp_eq_u32 s3, 2
    s_cbranch_scc1 F_ax2
    s_cmp_eq_u32 s3, 1
    s_cbranch_scc1 F_ax1
    s_cmp_eq_u32 s3, 0
    s_cbranch_scc1 F_ax0b
    s_barrier
    s_cmp_lg_u32 s53, 0
    s_cbranch_scc1 SW_87
    s_call_b64 s[34:35], F_sw0
SW_87:
    s_branch IW_w5
IW_r5:
    s_barrier
    s_cmp_lg_u32 s53, 1
    s_cbranch_scc1 SW_88
    s_call_b64 s[34:35], F_sw0
SW_88:
    s_branch IW_w7
IW_r7:
    s_barrier
    s_cmp_lg_u32 s53, 2
    s_cbranch_scc1 SW_89
    s_call_b64 s[34:35], F_sw0
SW_89:
    s_nop 0
    s_barrier
    s_cmp_lg_u32 s53, 3
    s_cbranch_scc1 SW_90
    s_call_b64 s[34:35], F_sw0
SW_90:
    s_nop 0
    s_barrier
    s_nop 0
    s_barrier
    s_nop 0
    s_barrier
    s_add_u32 s91, s54, 229376
    buffer_load_dwordx4 v[104:107], v6, s[16:19], s91 offen nt
    s_add_u32 s91, s54, 236544
    buffer_load_dwordx4 v[108:111], v6, s[16:19], s91 offen nt
    s_add_u32 s91, s54, 243712
    buffer_load_dwordx4 v[112:115], v6, s[16:19], s91 offen nt
    s_add_u32 s91, s54, 250880
    buffer_load_dwordx4 v[116:119], v6, s[16:19], s91 offen nt
    s_nop 0
    s_load_dword s76, s[56:57], 0 glc
    s_barrier
    s_add_u32 s91, s54, 258048
    buffer_load_dwordx4 v[120:123], v6, s[16:19], s91 offen nt
    s_add_u32 s91, s54, 265216
    buffer_load_dwordx4 v[124:127], v6, s[16:19], s91 offen nt
    s_add_u32 s91, s54, 272384
    buffer_load_dwordx4 v[128:131], v6, s[16:19], s91 offen nt
    s_add_u32 s91, s54, 279552
    buffer_load_dwordx4 v[132:135], v6, s[16:19], s91 offen nt
    s_waitcnt lgkmcnt(0)
    s_cmp_lt_u32 s76, 1000
    s_cbranch_scc1 F_g3
    v_mov_b32 v4, 1
    s_mov_b64 exec, 1
    ds_write_b32 v10, v4 offset:48
    s_mov_b64 exec, -1
    s_mov_b32 s88, 0
F_g3:
    s_barrier
    s_branch F_aj
F_ax1:
    s_barrier
    s_cmp_lg_u32 s53, 0
    s_cbranch_scc1 SW_91
    s_call_b64 s[34:35], F_sw0
SW_91:
    s_branch IW_w6
IW_r6:
    s_barrier
    s_cmp_lg_u32 s53, 1
    s_cbranch_scc1 SW_92
    s_call_b64 s[34:35], F_sw0
SW_92:
    s_nop 0
    s_barrier
    s_cmp_lg_u32 s53, 2
    s_cbranch_scc1 SW_93
    s_call_b64 s[34:35], F_sw0
SW_93:
    s_nop 0
    s_mul_i32 s44, s33, 768
    s_add_u32 s44, s44, 40960
    s_barrier
    s_cmp_lg_u32 s53, 3
    s_cbranch_scc1 SW_94
    s_call_b64 s[34:35], F_sw0
SW_94:
    s_load_dword s76, s[58:59], 0 glc
    s_barrier
    s_waitcnt lgkmcnt(0)
    s_cmp_ge_u32 s76, 16
    s_cbranch_scc1 GC_95
SP_96:
    s_load_dword s76, s[58:59], 0 glc
    s_waitcnt lgkmcnt(0)
    s_cmp_ge_u32 s76, 16
    s_cbranch_scc1 SD_97
    s_sleep 3
    s_branch SP_96
SD_97:
GC_95:
    s_barrier
    s_sleep 4
    s_mov_b32 m0, 158208
    s_mov_b32 exec_hi, 0xffff
    buffer_load_dwordx4 v2, s[40:43], s44 offen sc0 sc1 lds
    s_mov_b64 exec, -1
    s_barrier
    s_add_u32 s91, s54, 229376
    buffer_load_dwordx4 v[104:107], v6, s[16:19], s91 offen nt
    s_add_u32 s91, s54, 236544
    buffer_load_dwordx4 v[108:111], v6, s[16:19], s91 offen nt
    s_add_u32 s91, s54, 243712
    buffer_load_dwordx4 v[112:115], v6, s[16:19], s91 offen nt
    s_add_u32 s91, s54, 250880
    buffer_load_dwordx4 v[116:119], v6, s[16:19], s91 offen nt
    s_barrier
    s_add_u32 s91, s54, 258048
    buffer_load_dwordx4 v[120:123], v6, s[16:19], s91 offen nt
    s_add_u32 s91, s54, 265216
    buffer_load_dwordx4 v[124:127], v6, s[16:19], s91 offen nt
    s_add_u32 s91, s54, 272384
    buffer_load_dwordx4 v[128:131], v6, s[16:19], s91 offen nt
    s_add_u32 s91, s54, 279552
    buffer_load_dwordx4 v[132:135], v6, s[16:19], s91 offen nt
    s_waitcnt vmcnt(8)
    v_mov_b32 v4, 1
    s_mov_b64 exec, 1
    ds_write_b32 v10, v4 offset:48
    s_mov_b64 exec, -1
    s_barrier
    s_branch F_aj
IW_w9:
    s_branch IW_r9
F_ax0b:
    s_barrier
    s_cmp_lg_u32 s53, 0
    s_cbranch_scc1 SW_98
    s_call_b64 s[34:35], F_sw0
SW_98:
    s_branch IW_w2
IW_r2:
    s_barrier
    s_cmp_lg_u32 s53, 1
    s_cbranch_scc1 SW_99
    s_call_b64 s[34:35], F_sw0
SW_99:
    s_nop 0
    s_barrier
    s_cmp_lg_u32 s53, 2
    s_cbranch_scc1 SW_100
    s_call_b64 s[34:35], F_sw0
SW_100:
    s_nop 0
    s_lshl_b32 s47, s28, 9
    s_waitcnt lgkmcnt(0)
    s_add_u32 s58, s47, 0x858000
    s_add_u32 s58, s72, s58
    s_addc_u32 s59, s73, 0
    s_lshl_b32 s44, s32, 11
    s_lshl_b32 s45, s28, 11
    v_lshrrev_b32 v11, 2, v0
    v_and_b32 v9, 3, v0
    v_lshlrev_b32 v9, 4, v9
    v_lshl_add_u32 v11, v11, 7, v9

    s_barrier
    s_cmp_lg_u32 s53, 3
    s_cbranch_scc1 SW_101
    s_call_b64 s[34:35], F_sw0
SW_101:
    s_load_dword s76, s[56:57], 0 glc
    s_load_dword s77, s[58:59], 0 glc
    s_barrier
    s_waitcnt lgkmcnt(0)
    s_cmp_ge_u32 s76, 16
    s_cbranch_scc1 GC_102
SP_103:
    s_load_dword s76, s[56:57], 0 glc
    s_waitcnt lgkmcnt(0)
    s_cmp_ge_u32 s76, 16
    s_cbranch_scc1 SD_104
    s_sleep 3
    s_branch SP_103
SD_104:
GC_102:
    s_cmp_ge_u32 s77, 16
    s_cbranch_scc1 GC_105
SP_106:
    s_load_dword s77, s[58:59], 0 glc
    s_waitcnt lgkmcnt(0)
    s_cmp_ge_u32 s77, 16
    s_cbranch_scc1 SD_107
    s_sleep 3
    s_branch SP_106
SD_107:
GC_105:
    s_barrier
    s_sleep 4
    buffer_load_dwordx4 v[32:35], v11, s[40:43], s44 offen sc0 sc1
    buffer_load_dwordx4 v[36:39], v11, s[40:43], s45 offen sc0 sc1
    v_lshlrev_b32 v9, 3, v0
    v_add_u32 v9, 155648, v9
    s_mov_b32 s44, 0x3fb8aa3b

    s_barrier
    s_add_u32 s91, s54, 229376
    buffer_load_dwordx4 v[104:107], v6, s[16:19], s91 offen nt
    s_add_u32 s91, s54, 236544
    buffer_load_dwordx4 v[108:111], v6, s[16:19], s91 offen nt
    s_add_u32 s91, s54, 243712
    buffer_load_dwordx4 v[112:115], v6, s[16:19], s91 offen nt
    s_add_u32 s91, s54, 250880
    buffer_load_dwordx4 v[116:119], v6, s[16:19], s91 offen nt
    s_barrier
    s_add_u32 s91, s54, 258048
    buffer_load_dwordx4 v[120:123], v6, s[16:19], s91 offen nt
    s_add_u32 s91, s54, 265216
    buffer_load_dwordx4 v[124:127], v6, s[16:19], s91 offen nt
    s_add_u32 s91, s54, 272384
    buffer_load_dwordx4 v[128:131], v6, s[16:19], s91 offen nt
    s_add_u32 s91, s54, 279552
    buffer_load_dwordx4 v[132:135], v6, s[16:19], s91 offen nt
    s_waitcnt vmcnt(8)
    v_swap_b32 v33, v34
    v_swap_b32 v37, v38
    v_mul_f32 v40, s44, v34
    v_mul_f32 v41, s44, v35
    ds_write_b64 v9, v[32:33]
    ds_write_b64 v9, v[40:41] offset:1024
    ds_write_b64 v9, v[36:37] offset:1536
    ds_write_b64 v9, v[38:39] offset:2048

    v_mov_b32 v4, 1
    s_mov_b64 exec, 1
    ds_write_b32 v10, v4 offset:48
    s_mov_b64 exec, -1
    s_barrier
    s_branch F_aj
F_ax2:
    s_cmp_lg_u32 s2, 248
    s_cbranch_scc1 F_a2n
    s_waitcnt lgkmcnt(0)
    s_mov_b32 s74, 7
    v_lshrrev_b32 v11, 1, v0
    v_and_b32 v9, 1, v0
    v_lshlrev_b32 v9, 4, v9
    v_lshl_add_u32 v11, v11, 7, v9
    v_lshlrev_b32 v9, 9, v0
    v_mov_b32 v8, 1000
F_a2l:

    s_load_dword s60, s[40:41], 0x8180 glc
    s_load_dword s61, s[40:41], 0x8980 glc
    s_load_dword s62, s[40:41], 0x9180 glc
    s_load_dword s63, s[40:41], 0x9980 glc
    s_waitcnt lgkmcnt(0)
    s_add_u32 s60, s60, s61
    s_add_u32 s62, s62, s63
    s_add_u32 s60, s60, s62
    s_cmp_ge_u32 s60, 256
    s_cbranch_scc1 F_a2t

    s_cmp_ge_u32 s74, 17
    s_cbranch_scc1 DB_108
    s_barrier
    s_add_u32 s74, s74, 1
DB_108:
    s_branch F_a2l
F_a2t:
    s_movk_i32 s44, 0
    buffer_load_dwordx4 v[16:19], v11, s[40:43], s44 offen offset:64 sc0 sc1
    s_movk_i32 s44, 4096
    buffer_load_dwordx4 v[20:23], v11, s[40:43], s44 offen offset:64 sc0 sc1
    s_movk_i32 s44, 8192
    buffer_load_dwordx4 v[24:27], v11, s[40:43], s44 offen offset:64 sc0 sc1
    s_movk_i32 s44, 12288
    buffer_load_dwordx4 v[28:31], v11, s[40:43], s44 offen offset:64 sc0 sc1
    s_movk_i32 s44, 16384
    buffer_load_dwordx4 v[32:35], v11, s[40:43], s44 offen offset:64 sc0 sc1
    s_movk_i32 s44, 20480
    buffer_load_dwordx4 v[36:39], v11, s[40:43], s44 offen offset:64 sc0 sc1
    s_movk_i32 s44, 24576
    buffer_load_dwordx4 v[40:43], v11, s[40:43], s44 offen offset:64 sc0 sc1
    s_movk_i32 s44, 28672
    buffer_load_dwordx4 v[44:47], v11, s[40:43], s44 offen offset:64 sc0 sc1
    s_mov_b32 s44, 32768
    s_mov_b64 exec, 0xffff
    buffer_atomic_add v8, v9, s[40:43], s44 offen
    s_mov_b64 exec, -1

    s_cmp_ge_u32 s74, 17
    s_cbranch_scc1 DB_109
    s_barrier
    s_add_u32 s74, s74, 1
DB_109:
    s_waitcnt vmcnt(1)
    v_max3_u32 v48, v16, v17, v18
    v_med3_u32 v49, v16, v17, v18
    v_min3_u32 v50, v16, v17, v18
    v_med3_u32 v50, v49, v50, v19
    v_med3_u32 v49, v48, v49, v19
    v_max_u32 v48, v48, v19
    v_med3_u32 v50, v49, v50, v20
    v_med3_u32 v49, v48, v49, v20
    v_max_u32 v48, v48, v20
    v_med3_u32 v50, v49, v50, v21
    v_med3_u32 v49, v48, v49, v21
    v_max_u32 v48, v48, v21
    v_med3_u32 v50, v49, v50, v22
    v_med3_u32 v49, v48, v49, v22
    v_max_u32 v48, v48, v22
    v_med3_u32 v50, v49, v50, v23
    v_med3_u32 v49, v48, v49, v23
    v_max_u32 v48, v48, v23
    v_med3_u32 v50, v49, v50, v24
    v_med3_u32 v49, v48, v49, v24
    v_max_u32 v48, v48, v24
    v_med3_u32 v50, v49, v50, v25
    v_med3_u32 v49, v48, v49, v25
    v_max_u32 v48, v48, v25
    v_med3_u32 v50, v49, v50, v26
    v_med3_u32 v49, v48, v49, v26
    v_max_u32 v48, v48, v26
    v_med3_u32 v50, v49, v50, v27
    v_med3_u32 v49, v48, v49, v27
    v_max_u32 v48, v48, v27
    v_med3_u32 v50, v49, v50, v28
    v_med3_u32 v49, v48, v49, v28
    v_max_u32 v48, v48, v28
    v_med3_u32 v50, v49, v50, v29
    v_med3_u32 v49, v48, v49, v29
    v_max_u32 v48, v48, v29
    v_med3_u32 v50, v49, v50, v30
    v_med3_u32 v49, v48, v49, v30
    v_max_u32 v48, v48, v30
    v_med3_u32 v50, v49, v50, v31
    v_med3_u32 v49, v48, v49, v31
    v_max_u32 v48, v48, v31
    v_med3_u32 v50, v49, v50, v32
    v_med3_u32 v49, v48, v49, v32
    v_max_u32 v48, v48, v32
    v_med3_u32 v50, v49, v50, v33
    v_med3_u32 v49, v48, v49, v33
    v_max_u32 v48, v48, v33
    v_med3_u32 v50, v49, v50, v34
    v_med3_u32 v49, v48, v49, v34
    v_max_u32 v48, v48, v34
    v_med3_u32 v50, v49, v50, v35
    v_med3_u32 v49, v48, v49, v35
    v_max_u32 v48, v48, v35
    v_med3_u32 v50, v49, v50, v36
    v_med3_u32 v49, v48, v49, v36
    v_max_u32 v48, v48, v36
    v_med3_u32 v50, v49, v50, v37
    v_med3_u32 v49, v48, v49, v37
    v_max_u32 v48, v48, v37
    v_med3_u32 v50, v49, v50, v38
    v_med3_u32 v49, v48, v49, v38
    v_max_u32 v48, v48, v38
    v_med3_u32 v50, v49, v50, v39
    v_med3_u32 v49, v48, v49, v39
    v_max_u32 v48, v48, v39
    v_med3_u32 v50, v49, v50, v40
    v_med3_u32 v49, v48, v49, v40
    v_max_u32 v48, v48, v40
    v_med3_u32 v50, v49, v50, v41
    v_med3_u32 v49, v48, v49, v41
    v_max_u32 v48, v48, v41
    v_med3_u32 v50, v49, v50, v42
    v_med3_u32 v49, v48, v49, v42
    v_max_u32 v48, v48, v42
    v_med3_u32 v50, v49, v50, v43
    v_med3_u32 v49, v48, v49, v43
    v_max_u32 v48, v48, v43
    v_med3_u32 v50, v49, v50, v44
    v_med3_u32 v49, v48, v49, v44
    v_max_u32 v48, v48, v44
    v_med3_u32 v50, v49, v50, v45
    v_med3_u32 v49, v48, v49, v45
    v_max_u32 v48, v48, v45
    v_med3_u32 v50, v49, v50, v46
    v_med3_u32 v49, v48, v49, v46
    v_max_u32 v48, v48, v46
    v_med3_u32 v50, v49, v50, v47
    v_med3_u32 v49, v48, v49, v47
    v_max_u32 v48, v48, v47
    s_mov_b32 s53, 0
    v_max_u32 v4, v48, v49
    s_nop 1
    v_max_u32_dpp v4, v4, v4 row_shr:1 row_mask:0xf bank_mask:0xf bound_ctrl:0
    s_nop 1
    v_max_u32_dpp v4, v4, v4 row_shr:2 row_mask:0xf bank_mask:0xf bound_ctrl:0
    s_nop 1
    v_max_u32_dpp v4, v4, v4 row_shr:4 row_mask:0xf bank_mask:0xf bound_ctrl:0
    s_nop 1
    v_max_u32_dpp v4, v4, v4 row_shr:8 row_mask:0xf bank_mask:0xf bound_ctrl:0
    s_nop 1
    v_max_u32_dpp v4, v4, v4 row_bcast:15 row_mask:0xa bank_mask:0xf
    s_nop 1
    v_max_u32_dpp v4, v4, v4 row_bcast:31 row_mask:0xc bank_mask:0xf
    s_nop 0
    v_readlane_b32 s52, v4, 63
    s_nop 0
    s_add_u32 s53, s53, s52
    v_writelane_b32 v13, s53, 0
    v_subrev_u32 v48, s52, v48
    v_subrev_u32 v49, s52, v49
    v_max_u32 v4, v48, v49
    s_nop 1
    v_max_u32_dpp v4, v4, v4 row_shr:1 row_mask:0xf bank_mask:0xf bound_ctrl:0
    s_nop 1
    v_max_u32_dpp v4, v4, v4 row_shr:2 row_mask:0xf bank_mask:0xf bound_ctrl:0
    s_nop 1
    v_max_u32_dpp v4, v4, v4 row_shr:4 row_mask:0xf bank_mask:0xf bound_ctrl:0
    s_nop 1
    v_max_u32_dpp v4, v4, v4 row_shr:8 row_mask:0xf bank_mask:0xf bound_ctrl:0
    s_nop 1
    v_max_u32_dpp v4, v4, v4 row_bcast:15 row_mask:0xa bank_mask:0xf
    s_nop 1
    v_max_u32_dpp v4, v4, v4 row_bcast:31 row_mask:0xc bank_mask:0xf
    s_nop 0
    v_readlane_b32 s52, v4, 63
    s_nop 0
    s_add_u32 s53, s53, s52
    v_writelane_b32 v13, s53, 1
    v_subrev_u32 v48, s52, v48
    v_subrev_u32 v49, s52, v49
    v_max_u32 v4, v48, v49
    s_nop 1
    v_max_u32_dpp v4, v4, v4 row_shr:1 row_mask:0xf bank_mask:0xf bound_ctrl:0
    s_nop 1
    v_max_u32_dpp v4, v4, v4 row_shr:2 row_mask:0xf bank_mask:0xf bound_ctrl:0
    s_nop 1
    v_max_u32_dpp v4, v4, v4 row_shr:4 row_mask:0xf bank_mask:0xf bound_ctrl:0
    s_nop 1
    v_max_u32_dpp v4, v4, v4 row_shr:8 row_mask:0xf bank_mask:0xf bound_ctrl:0
    s_nop 1
    v_max_u32_dpp v4, v4, v4 row_bcast:15 row_mask:0xa bank_mask:0xf
    s_nop 1
    v_max_u32_dpp v4, v4, v4 row_bcast:31 row_mask:0xc bank_mask:0xf
    s_nop 0
    v_readlane_b32 s52, v4, 63
    s_nop 0
    s_add_u32 s53, s53, s52
    v_writelane_b32 v13, s53, 2
    v_subrev_u32 v48, s52, v48
    v_subrev_u32 v49, s52, v49
    v_max_u32 v4, v48, v49
    s_nop 1
    v_max_u32_dpp v4, v4, v4 row_shr:1 row_mask:0xf bank_mask:0xf bound_ctrl:0
    s_nop 1
    v_max_u32_dpp v4, v4, v4 row_shr:2 row_mask:0xf bank_mask:0xf bound_ctrl:0
    s_nop 1
    v_max_u32_dpp v4, v4, v4 row_shr:4 row_mask:0xf bank_mask:0xf bound_ctrl:0
    s_nop 1
    v_max_u32_dpp v4, v4, v4 row_shr:8 row_mask:0xf bank_mask:0xf bound_ctrl:0
    s_nop 1
    v_max_u32_dpp v4, v4, v4 row_bcast:15 row_mask:0xa bank_mask:0xf
    s_nop 1
    v_max_u32_dpp v4, v4, v4 row_bcast:31 row_mask:0xc bank_mask:0xf
    s_nop 0
    v_readlane_b32 s52, v4, 63
    s_nop 0
    s_add_u32 s53, s53, s52
    v_writelane_b32 v13, s53, 3
    v_subrev_u32 v48, s52, v48
    v_subrev_u32 v49, s52, v49
    v_max_u32 v4, v48, v49
    s_nop 1
    v_max_u32_dpp v4, v4, v4 row_shr:1 row_mask:0xf bank_mask:0xf bound_ctrl:0
    s_nop 1
    v_max_u32_dpp v4, v4, v4 row_shr:2 row_mask:0xf bank_mask:0xf bound_ctrl:0
    s_nop 1
    v_max_u32_dpp v4, v4, v4 row_shr:4 row_mask:0xf bank_mask:0xf bound_ctrl:0
    s_nop 1
    v_max_u32_dpp v4, v4, v4 row_shr:8 row_mask:0xf bank_mask:0xf bound_ctrl:0
    s_nop 1
    v_max_u32_dpp v4, v4, v4 row_bcast:15 row_mask:0xa bank_mask:0xf
    s_nop 1
    v_max_u32_dpp v4, v4, v4 row_bcast:31 row_mask:0xc bank_mask:0xf
    s_nop 0
    v_readlane_b32 s52, v4, 63
    s_nop 0
    s_add_u32 s53, s53, s52
    v_writelane_b32 v13, s53, 4
    v_subrev_u32 v48, s52, v48
    v_subrev_u32 v49, s52, v49
    v_max_u32 v4, v48, v49
    s_nop 1
    v_max_u32_dpp v4, v4, v4 row_shr:1 row_mask:0xf bank_mask:0xf bound_ctrl:0
    s_nop 1
    v_max_u32_dpp v4, v4, v4 row_shr:2 row_mask:0xf bank_mask:0xf bound_ctrl:0
    s_nop 1
    v_max_u32_dpp v4, v4, v4 row_shr:4 row_mask:0xf bank_mask:0xf bound_ctrl:0
    s_nop 1
    v_max_u32_dpp v4, v4, v4 row_shr:8 row_mask:0xf bank_mask:0xf bound_ctrl:0
    s_nop 1
    v_max_u32_dpp v4, v4, v4 row_bcast:15 row_mask:0xa bank_mask:0xf
    s_nop 1
    v_max_u32_dpp v4, v4, v4 row_bcast:31 row_mask:0xc bank_mask:0xf
    s_nop 0
    v_readlane_b32 s52, v4, 63
    s_nop 0
    s_add_u32 s53, s53, s52
    v_writelane_b32 v13, s53, 5
    v_subrev_u32 v48, s52, v48
    v_subrev_u32 v49, s52, v49
    v_max_u32 v4, v48, v49
    s_nop 1
    v_max_u32_dpp v4, v4, v4 row_shr:1 row_mask:0xf bank_mask:0xf bound_ctrl:0
    s_nop 1
    v_max_u32_dpp v4, v4, v4 row_shr:2 row_mask:0xf bank_mask:0xf bound_ctrl:0
    s_nop 1
    v_max_u32_dpp v4, v4, v4 row_shr:4 row_mask:0xf bank_mask:0xf bound_ctrl:0
    s_nop 1
    v_max_u32_dpp v4, v4, v4 row_shr:8 row_mask:0xf bank_mask:0xf bound_ctrl:0
    s_nop 1
    v_max_u32_dpp v4, v4, v4 row_bcast:15 row_mask:0xa bank_mask:0xf
    s_nop 1
    v_max_u32_dpp v4, v4, v4 row_bcast:31 row_mask:0xc bank_mask:0xf
    s_nop 0
    v_readlane_b32 s52, v4, 63
    s_nop 0
    s_add_u32 s53, s53, s52
    v_writelane_b32 v13, s53, 6
    v_subrev_u32 v48, s52, v48
    v_subrev_u32 v49, s52, v49
    v_max_u32 v4, v48, v49
    s_nop 1
    v_max_u32_dpp v4, v4, v4 row_shr:1 row_mask:0xf bank_mask:0xf bound_ctrl:0
    s_nop 1
    v_max_u32_dpp v4, v4, v4 row_shr:2 row_mask:0xf bank_mask:0xf bound_ctrl:0
    s_nop 1
    v_max_u32_dpp v4, v4, v4 row_shr:4 row_mask:0xf bank_mask:0xf bound_ctrl:0
    s_nop 1
    v_max_u32_dpp v4, v4, v4 row_shr:8 row_mask:0xf bank_mask:0xf bound_ctrl:0
    s_nop 1
    v_max_u32_dpp v4, v4, v4 row_bcast:15 row_mask:0xa bank_mask:0xf
    s_nop 1
    v_max_u32_dpp v4, v4, v4 row_bcast:31 row_mask:0xc bank_mask:0xf
    s_nop 0
    v_readlane_b32 s52, v4, 63
    s_nop 0
    s_add_u32 s53, s53, s52
    v_writelane_b32 v13, s53, 7
    v_cmp_lt_u32 vcc, s53, v50
    s_cbranch_vccz F_a2k
    s_mov_b32 s53, 0
    s_mov_b32 s52, 0
    s_mov_b32 s64, 0
F_a2f:
    v_subrev_u32 v16, s52, v16
    v_subrev_u32 v17, s52, v17
    v_subrev_u32 v18, s52, v18
    v_subrev_u32 v19, s52, v19
    v_subrev_u32 v20, s52, v20
    v_subrev_u32 v21, s52, v21
    v_subrev_u32 v22, s52, v22
    v_subrev_u32 v23, s52, v23
    v_subrev_u32 v24, s52, v24
    v_subrev_u32 v25, s52, v25
    v_subrev_u32 v26, s52, v26
    v_subrev_u32 v27, s52, v27
    v_subrev_u32 v28, s52, v28
    v_subrev_u32 v29, s52, v29
    v_subrev_u32 v30, s52, v30
    v_subrev_u32 v31, s52, v31
    v_subrev_u32 v32, s52, v32
    v_subrev_u32 v33, s52, v33
    v_subrev_u32 v34, s52, v34
    v_subrev_u32 v35, s52, v35
    v_subrev_u32 v36, s52, v36
    v_subrev_u32 v37, s52, v37
    v_subrev_u32 v38, s52, v38
    v_subrev_u32 v39, s52, v39
    v_subrev_u32 v40, s52, v40
    v_subrev_u32 v41, s52, v41
    v_subrev_u32 v42, s52, v42
    v_subrev_u32 v43, s52, v43
    v_subrev_u32 v44, s52, v44
    v_subrev_u32 v45, s52, v45
    v_subrev_u32 v46, s52, v46
    v_subrev_u32 v47, s52, v47
    v_max3_u32 v4, v16, v17, v18
    v_max3_u32 v12, v19, v20, v21
    v_max3_u32 v4, v4, v22, v23
    v_max3_u32 v12, v12, v24, v25
    v_max3_u32 v4, v4, v26, v27
    v_max3_u32 v12, v12, v28, v29
    v_max3_u32 v4, v4, v30, v31
    v_max3_u32 v12, v12, v32, v33
    v_max3_u32 v4, v4, v34, v35
    v_max3_u32 v12, v12, v36, v37
    v_max3_u32 v4, v4, v38, v39
    v_max3_u32 v12, v12, v40, v41
    v_max3_u32 v4, v4, v42, v43
    v_max3_u32 v12, v12, v44, v45
    v_max3_u32 v4, v4, v46, v47
    v_max_u32 v4, v4, v12
    s_nop 1
    v_max_u32_dpp v4, v4, v4 row_shr:1 row_mask:0xf bank_mask:0xf bound_ctrl:0
    s_nop 1
    v_max_u32_dpp v4, v4, v4 row_shr:2 row_mask:0xf bank_mask:0xf bound_ctrl:0
    s_nop 1
    v_max_u32_dpp v4, v4, v4 row_shr:4 row_mask:0xf bank_mask:0xf bound_ctrl:0
    s_nop 1
    v_max_u32_dpp v4, v4, v4 row_shr:8 row_mask:0xf bank_mask:0xf bound_ctrl:0
    s_nop 1
    v_max_u32_dpp v4, v4, v4 row_bcast:15 row_mask:0xa bank_mask:0xf
    s_nop 1
    v_max_u32_dpp v4, v4, v4 row_bcast:31 row_mask:0xc bank_mask:0xf
    s_nop 0
    v_readlane_b32 s52, v4, 63
    s_nop 0
    s_add_u32 s53, s53, s52
    s_mov_b32 m0, s64
    v_writelane_b32 v13, s53, m0
    s_cmp_ge_u32 s74, 17
    s_cbranch_scc1 DB_110
    s_barrier
    s_add_u32 s74, s74, 1
DB_110:
    s_add_u32 s64, s64, 1
    s_cmp_lt_u32 s64, 8
    s_cbranch_scc1 F_a2f
F_a2k:
    v_and_b32 v4, 7, v0
    v_lshlrev_b32 v4, 2, v4
    ds_bpermute_b32 v12, v4, v13
    v_lshrrev_b32 v9, 3, v0
    v_lshl_add_u32 v4, v9, 9, v4
    s_mov_b32 s44, 32896
    s_mov_b32 s45, 36992
    s_waitcnt lgkmcnt(0)
    v_or_b32 v12, 0x8000, v12
    buffer_store_dword v12, v4, s[40:43], s44 offen sc0 sc1
    buffer_store_dword v12, v4, s[40:43], s45 offen sc0 sc1

F_a2m:
    s_cmp_ge_u32 s74, 17
    s_cbranch_scc1 DB_111
    s_barrier
    s_add_u32 s74, s74, 1
DB_111:
    s_cmp_lt_u32 s74, 17
    s_cbranch_scc1 F_a2m
    s_add_u32 s91, s54, 0
    buffer_load_dwordx4 v[72:75], v6, s[16:19], s91 offen nt
    s_add_u32 s91, s54, 7168
    buffer_load_dwordx4 v[76:79], v6, s[16:19], s91 offen nt
    s_add_u32 s91, s54, 14336
    buffer_load_dwordx4 v[80:83], v6, s[16:19], s91 offen nt
    s_add_u32 s91, s54, 21504
    buffer_load_dwordx4 v[84:87], v6, s[16:19], s91 offen nt
    s_add_u32 s91, s54, 28672
    buffer_load_dwordx4 v[88:91], v6, s[16:19], s91 offen nt
    s_add_u32 s91, s54, 35840
    buffer_load_dwordx4 v[92:95], v6, s[16:19], s91 offen nt
    s_add_u32 s91, s54, 43008
    buffer_load_dwordx4 v[96:99], v6, s[16:19], s91 offen nt
    s_add_u32 s91, s54, 50176
    buffer_load_dwordx4 v[100:103], v6, s[16:19], s91 offen nt
    s_add_u32 s91, s54, 229376
    buffer_load_dwordx4 v[104:107], v6, s[16:19], s91 offen nt
    s_add_u32 s91, s54, 236544
    buffer_load_dwordx4 v[108:111], v6, s[16:19], s91 offen nt
    s_add_u32 s91, s54, 243712
    buffer_load_dwordx4 v[112:115], v6, s[16:19], s91 offen nt
    s_add_u32 s91, s54, 250880
    buffer_load_dwordx4 v[116:119], v6, s[16:19], s91 offen nt
    s_add_u32 s91, s54, 258048
    buffer_load_dwordx4 v[120:123], v6, s[16:19], s91 offen nt
    s_add_u32 s91, s54, 265216
    buffer_load_dwordx4 v[124:127], v6, s[16:19], s91 offen nt
    s_add_u32 s91, s54, 272384
    buffer_load_dwordx4 v[128:131], v6, s[16:19], s91 offen nt
    s_add_u32 s91, s54, 279552
    buffer_load_dwordx4 v[132:135], v6, s[16:19], s91 offen nt
    s_branch F_aj2
IW_w10:
    s_branch IW_r10
F_a2n:
    s_barrier
    s_cmp_lg_u32 s53, 0
    s_cbranch_scc1 SW_112
    s_call_b64 s[34:35], F_sw0
SW_112:
    s_branch IW_w11
IW_r11:
    s_barrier
    s_cmp_lg_u32 s53, 1
    s_cbranch_scc1 SW_113
    s_call_b64 s[34:35], F_sw0
SW_113:
    s_nop 0
    s_barrier
    s_cmp_lg_u32 s53, 2
    s_cbranch_scc1 SW_114
    s_call_b64 s[34:35], F_sw0
SW_114:
    s_nop 0
    s_barrier
    s_cmp_lg_u32 s53, 3
    s_cbranch_scc1 SW_115
    s_call_b64 s[34:35], F_sw0
SW_115:
    s_nop 0
    s_barrier
    s_nop 0
    s_barrier
    s_nop 0
    s_barrier
    s_add_u32 s91, s54, 229376
    buffer_load_dwordx4 v[104:107], v6, s[16:19], s91 offen nt
    s_add_u32 s91, s54, 236544
    buffer_load_dwordx4 v[108:111], v6, s[16:19], s91 offen nt
    s_add_u32 s91, s54, 243712
    buffer_load_dwordx4 v[112:115], v6, s[16:19], s91 offen nt
    s_add_u32 s91, s54, 250880
    buffer_load_dwordx4 v[116:119], v6, s[16:19], s91 offen nt
    s_nop 0
    s_load_dwordx8 s[60:67], s[56:57], 128 glc
    s_barrier
    s_add_u32 s91, s54, 258048
    buffer_load_dwordx4 v[120:123], v6, s[16:19], s91 offen nt
    s_add_u32 s91, s54, 265216
    buffer_load_dwordx4 v[124:127], v6, s[16:19], s91 offen nt
    s_add_u32 s91, s54, 272384
    buffer_load_dwordx4 v[128:131], v6, s[16:19], s91 offen nt
    s_add_u32 s91, s54, 279552
    buffer_load_dwordx4 v[132:135], v6, s[16:19], s91 offen nt
    s_waitcnt lgkmcnt(0)
    s_and_b64 s[44:45], s[60:61], s[62:63]
    s_and_b64 s[44:45], s[44:45], s[64:65]
    s_and_b64 s[44:45], s[44:45], s[66:67]
    s_and_b32 s44, s44, s45
    s_bitcmp1_b32 s44, 15
    s_cbranch_scc0 F_a2q
    s_andn2_b32 s60, s60, 0x8000
    v_writelane_b32 v12, s60, 0
    s_andn2_b32 s61, s61, 0x8000
    v_writelane_b32 v12, s61, 1
    s_andn2_b32 s62, s62, 0x8000
    v_writelane_b32 v12, s62, 2
    s_andn2_b32 s63, s63, 0x8000
    v_writelane_b32 v12, s63, 3
    s_andn2_b32 s64, s64, 0x8000
    v_writelane_b32 v12, s64, 4
    s_andn2_b32 s65, s65, 0x8000
    v_writelane_b32 v12, s65, 5
    s_andn2_b32 s66, s66, 0x8000
    v_writelane_b32 v12, s66, 6
    s_andn2_b32 s67, s67, 0x8000
    v_writelane_b32 v12, s67, 7
    v_add_u32 v4, 158976, v3
    s_mov_b64 exec, 0xff
    ds_write_b32 v4, v12
    s_mov_b64 exec, -1
    v_mov_b32 v4, 1
    s_mov_b64 exec, 1
    ds_write_b32 v10, v4 offset:48
    s_mov_b64 exec, -1
    s_waitcnt lgkmcnt(0)
    s_mov_b32 s88, 1
    s_branch F_a2r
F_a2q:
    s_load_dwordx8 s[60:67], s[56:57], 128 glc
F_a2r:
    s_barrier
    s_cmp_lg_u32 s88, 2
    s_cbranch_scc1 F_aj
    s_waitcnt lgkmcnt(0)
    s_and_b64 s[44:45], s[60:61], s[62:63]
    s_and_b64 s[44:45], s[44:45], s[64:65]
    s_and_b64 s[44:45], s[44:45], s[66:67]
    s_and_b32 s44, s44, s45
    s_bitcmp1_b32 s44, 15
    s_cbranch_scc0 F_a2s
    s_andn2_b32 s60, s60, 0x8000
    v_writelane_b32 v12, s60, 0
    s_andn2_b32 s61, s61, 0x8000
    v_writelane_b32 v12, s61, 1
    s_andn2_b32 s62, s62, 0x8000
    v_writelane_b32 v12, s62, 2
    s_andn2_b32 s63, s63, 0x8000
    v_writelane_b32 v12, s63, 3
    s_andn2_b32 s64, s64, 0x8000
    v_writelane_b32 v12, s64, 4
    s_andn2_b32 s65, s65, 0x8000
    v_writelane_b32 v12, s65, 5
    s_andn2_b32 s66, s66, 0x8000
    v_writelane_b32 v12, s66, 6
    s_andn2_b32 s67, s67, 0x8000
    v_writelane_b32 v12, s67, 7
    v_add_u32 v4, 158976, v3
    s_mov_b64 exec, 0xff
    ds_write_b32 v4, v12
    s_mov_b64 exec, -1
    v_mov_b32 v4, 1
    s_mov_b64 exec, 1
    ds_write_b32 v10, v4 offset:48
    s_mov_b64 exec, -1
    s_mov_b32 s88, 1
F_a2s:
    v_mov_b32 v4, 1
    s_mov_b64 exec, 1
    ds_write_b32 v10, v4 offset:176
    s_mov_b64 exec, -1
F_aj:
    s_mov_b32 s74, 0
F_aj2:
    v_and_b32 v13, 3, v0
    v_lshlrev_b32 v13, 2, v13
    v_add_u32 v13, 159040, v13

    s_cmp_lt_u32 s3, 2
    s_mov_b32 s75, 65536
    s_cselect_b32 s75, 32768, s75
    s_and_b32 s44, s3, 1
    s_lshl_b32 s44, s44, 12
    s_add_u32 s75, s75, s44
    s_add_u32 s12, s72, 0x900000
    s_addc_u32 s13, s73, 0
    s_mov_b32 s14, 0xe0000
    s_mov_b32 s15, 0x00020000
    s_mov_b32 s47, s10
    v_mov_b32 v4, 159096
    ds_read_b32 v9, v4
    s_waitcnt lgkmcnt(0)
    v_readfirstlane_b32 s79, v9
    s_nop 0
    s_cmp_lg_u32 s79, 0
    s_cbranch_scc1 F_xf
    s_cmp_eq_u32 s2, 248
    s_cbranch_scc1 F_xe
    ds_read_b32 v9, v4 offset:128
FW_116:
    s_waitcnt lgkmcnt(0)
    v_cmp_gt_u32 vcc, 1, v9
    s_cbranch_vccz FO_117
    ds_read_b32 v9, v4 offset:128
    s_branch FW_116
FO_117:
    ds_read_b32 v9, v4
    s_waitcnt lgkmcnt(0)
    v_readfirstlane_b32 s79, v9
    s_nop 0
    s_cmp_eq_u32 s79, 0
    s_cbranch_scc1 F_xe
F_xf:
    v_and_b32 v4, 7, v0
    v_lshlrev_b32 v4, 2, v4
    v_add_u32 v4, 158976, v4
    ds_read_b32 v4, v4
    s_waitcnt lgkmcnt(0)
    v_and_b32 v4, 0x7ff, v4
    v_sub_u32 v4, 2047, v4
    v_and_b32 v11, 7, v4
    v_lshrrev_b32 v9, 3, v4
    v_lshlrev_b32 v9, 7, v9
    v_lshl_add_u32 v9, v11, 3, v9
    v_lshlrev_b32 v4, 11, v4
    v_lshl_add_u32 v4, v5, 4, v4
    buffer_load_dwordx4 v[64:67], v4, s[20:23], s55 offen
    buffer_load_dwordx4 v[68:71], v4, s[20:23], s55 offen offset:64
    buffer_load_dwordx2 v[14:15], v9, s[40:43], 0 offen sc0 sc1

F_xe:
    s_cmp_lg_u32 s74, 0
    s_cbranch_scc1 JB_118
    s_barrier
JB_118:
    s_cmp_lg_u32 s88, 3
    s_cbranch_scc1 F_g4
SP_119:
    s_load_dword s76, s[56:57], 0 glc
    s_waitcnt lgkmcnt(0)
    s_cmp_ge_u32 s76, 1000
    s_cbranch_scc1 SD_120
    s_sleep 3
    s_branch SP_119
SD_120:
    v_mov_b32 v4, 1
    s_mov_b64 exec, 1
    ds_write_b32 v10, v4 offset:48
    s_mov_b64 exec, -1
F_g4:
    s_setprio 1
    s_cmp_lg_u32 s79, 0
    s_cbranch_scc1 F_xd
    s_cmp_lg_u32 s88, 2
    s_cbranch_scc1 F_se
F_sc:
    s_load_dwordx8 s[60:67], s[56:57], 128 glc
    s_waitcnt lgkmcnt(0)
    s_and_b64 s[44:45], s[60:61], s[62:63]
    s_and_b64 s[44:45], s[44:45], s[64:65]
    s_and_b64 s[44:45], s[44:45], s[66:67]
    s_and_b32 s44, s44, s45
    s_bitcmp1_b32 s44, 15
    s_cbranch_scc1 F_sd
    s_sleep 4
    s_branch F_sc
F_sd:
    s_andn2_b32 s60, s60, 0x8000
    v_writelane_b32 v12, s60, 0
    s_andn2_b32 s61, s61, 0x8000
    v_writelane_b32 v12, s61, 1
    s_andn2_b32 s62, s62, 0x8000
    v_writelane_b32 v12, s62, 2
    s_andn2_b32 s63, s63, 0x8000
    v_writelane_b32 v12, s63, 3
    s_andn2_b32 s64, s64, 0x8000
    v_writelane_b32 v12, s64, 4
    s_andn2_b32 s65, s65, 0x8000
    v_writelane_b32 v12, s65, 5
    s_andn2_b32 s66, s66, 0x8000
    v_writelane_b32 v12, s66, 6
    s_andn2_b32 s67, s67, 0x8000
    v_writelane_b32 v12, s67, 7
    v_add_u32 v4, 158976, v3
    s_mov_b64 exec, 0xff
    ds_write_b32 v4, v12
    s_mov_b64 exec, -1
    v_mov_b32 v4, 1
    s_mov_b64 exec, 1
    ds_write_b32 v10, v4 offset:48
    s_mov_b64 exec, -1
F_se:
    v_mov_b32 v4, 159096
    ds_read_b32 v9, v4 offset:0
FW_121:
    s_waitcnt lgkmcnt(0)
    v_cmp_gt_u32 vcc, 1, v9
    s_cbranch_vccz FO_122
    s_sleep 1
    ds_read_b32 v9, v4 offset:0
    s_branch FW_121
FO_122:
    v_and_b32 v4, 7, v0
    v_lshlrev_b32 v4, 2, v4
    v_add_u32 v4, 158976, v4
    ds_read_b32 v4, v4
    s_waitcnt lgkmcnt(0)
    v_and_b32 v4, 0x7ff, v4
    v_sub_u32 v4, 2047, v4
    v_and_b32 v11, 7, v4
    v_lshrrev_b32 v9, 3, v4
    v_lshlrev_b32 v9, 7, v9
    v_lshl_add_u32 v9, v11, 3, v9
    v_lshlrev_b32 v4, 11, v4
    v_lshl_add_u32 v4, v5, 4, v4
    buffer_load_dwordx4 v[64:67], v4, s[20:23], s55 offen
    buffer_load_dwordx4 v[68:71], v4, s[20:23], s55 offen offset:64
    buffer_load_dwordx2 v[14:15], v9, s[40:43], 0 offen sc0 sc1

F_xd:
    s_mov_b32 s52, 0x05040100
    s_mov_b32 s53, 0x07060302
    s_setprio 1
    s_cmp_ge_u32 s89, 224
    s_cbranch_scc1 F_adown
    s_waitcnt vmcnt(0)
    v_lshlrev_b32 v34, 16, v64
    v_and_b32 v35, 0xffff0000, v64
    v_lshlrev_b32 v36, 16, v65
    v_and_b32 v37, 0xffff0000, v65
    v_lshlrev_b32 v38, 16, v66
    v_and_b32 v39, 0xffff0000, v66
    v_lshlrev_b32 v40, 16, v67
    v_and_b32 v41, 0xffff0000, v67
    v_lshlrev_b32 v42, 16, v68
    v_and_b32 v43, 0xffff0000, v68
    v_lshlrev_b32 v44, 16, v69
    v_and_b32 v45, 0xffff0000, v69
    v_lshlrev_b32 v46, 16, v70
    v_and_b32 v47, 0xffff0000, v70
    v_lshlrev_b32 v48, 16, v71
    v_and_b32 v49, 0xffff0000, v71
    v_add_f32 v34, v34, v14
    v_add_f32 v35, v35, v14
    v_add_f32 v36, v36, v14
    v_add_f32 v37, v37, v14
    v_add_f32 v38, v38, v14
    v_add_f32 v39, v39, v14
    v_add_f32 v40, v40, v14
    v_add_f32 v41, v41, v14
    v_add_f32 v42, v42, v14
    v_add_f32 v43, v43, v14
    v_add_f32 v44, v44, v14
    v_add_f32 v45, v45, v14
    v_add_f32 v46, v46, v14
    v_add_f32 v47, v47, v14
    v_add_f32 v48, v48, v14
    v_add_f32 v49, v49, v14
    v_cvt_pk_bf16_f32 v64, v34, v35
    v_cvt_pk_bf16_f32 v65, v36, v37
    v_cvt_pk_bf16_f32 v66, v38, v39
    v_cvt_pk_bf16_f32 v67, v40, v41
    v_cvt_pk_bf16_f32 v68, v42, v43
    v_cvt_pk_bf16_f32 v69, v44, v45
    v_cvt_pk_bf16_f32 v70, v46, v47
    v_cvt_pk_bf16_f32 v71, v48, v49
    v_lshlrev_b32 v34, 16, v64
    v_and_b32 v35, 0xffff0000, v64
    v_lshlrev_b32 v36, 16, v65
    v_and_b32 v37, 0xffff0000, v65
    v_lshlrev_b32 v38, 16, v66
    v_and_b32 v39, 0xffff0000, v66
    v_lshlrev_b32 v40, 16, v67
    v_and_b32 v41, 0xffff0000, v67
    v_lshlrev_b32 v42, 16, v68
    v_and_b32 v43, 0xffff0000, v68
    v_lshlrev_b32 v44, 16, v69
    v_and_b32 v45, 0xffff0000, v69
    v_lshlrev_b32 v46, 16, v70
    v_and_b32 v47, 0xffff0000, v70
    v_lshlrev_b32 v48, 16, v71
    v_and_b32 v49, 0xffff0000, v71
    v_mul_f32 v34, v34, v15
    v_mul_f32 v35, v35, v15
    v_mul_f32 v36, v36, v15
    v_mul_f32 v37, v37, v15
    v_mul_f32 v38, v38, v15
    v_mul_f32 v39, v39, v15
    v_mul_f32 v40, v40, v15
    v_mul_f32 v41, v41, v15
    v_mul_f32 v42, v42, v15
    v_mul_f32 v43, v43, v15
    v_mul_f32 v44, v44, v15
    v_mul_f32 v45, v45, v15
    v_mul_f32 v46, v46, v15
    v_mul_f32 v47, v47, v15
    v_mul_f32 v48, v48, v15
    v_mul_f32 v49, v49, v15
    v_cvt_pk_bf16_f32 v64, v34, v35
    v_cvt_pk_bf16_f32 v65, v36, v37
    v_cvt_pk_bf16_f32 v66, v38, v39
    v_cvt_pk_bf16_f32 v67, v40, v41
    v_cvt_pk_bf16_f32 v68, v42, v43
    v_cvt_pk_bf16_f32 v69, v44, v45
    v_cvt_pk_bf16_f32 v70, v46, v47
    v_cvt_pk_bf16_f32 v71, v48, v49
    s_waitcnt vmcnt(0)
    v_perm_b32 v136, v76, v72, s52
    v_perm_b32 v137, v84, v80, s52
    v_perm_b32 v138, v92, v88, s52
    v_perm_b32 v139, v100, v96, s52
    s_nop 1
    v_mfma_f32_16x16x32_bf16 v[32:35], v[64:67], v[136:139], 0
    v_perm_b32 v140, v76, v72, s53
    v_perm_b32 v141, v84, v80, s53
    v_perm_b32 v142, v92, v88, s53
    v_perm_b32 v143, v100, v96, s53
    s_nop 1
    v_mfma_f32_16x16x32_bf16 v[36:39], v[64:67], v[140:143], 0
    v_perm_b32 v136, v77, v73, s52
    v_perm_b32 v137, v85, v81, s52
    v_perm_b32 v138, v93, v89, s52
    v_perm_b32 v139, v101, v97, s52
    s_nop 1
    v_mfma_f32_16x16x32_bf16 v[40:43], v[64:67], v[136:139], 0
    v_perm_b32 v140, v77, v73, s53
    v_perm_b32 v141, v85, v81, s53
    v_perm_b32 v142, v93, v89, s53
    v_perm_b32 v143, v101, v97, s53
    s_nop 1
    v_mfma_f32_16x16x32_bf16 v[44:47], v[64:67], v[140:143], 0
    v_perm_b32 v136, v78, v74, s52
    v_perm_b32 v137, v86, v82, s52
    v_perm_b32 v138, v94, v90, s52
    v_perm_b32 v139, v102, v98, s52
    s_nop 1
    v_mfma_f32_16x16x32_bf16 v[48:51], v[64:67], v[136:139], 0
    v_perm_b32 v140, v78, v74, s53
    v_perm_b32 v141, v86, v82, s53
    v_perm_b32 v142, v94, v90, s53
    v_perm_b32 v143, v102, v98, s53
    s_nop 1
    v_mfma_f32_16x16x32_bf16 v[52:55], v[64:67], v[140:143], 0
    v_perm_b32 v136, v79, v75, s52
    v_perm_b32 v137, v87, v83, s52
    v_perm_b32 v138, v95, v91, s52
    v_perm_b32 v139, v103, v99, s52
    s_nop 1
    v_mfma_f32_16x16x32_bf16 v[56:59], v[64:67], v[136:139], 0
    v_perm_b32 v140, v79, v75, s53
    v_perm_b32 v141, v87, v83, s53
    v_perm_b32 v142, v95, v91, s53
    v_perm_b32 v143, v103, v99, s53
    s_nop 1
    v_mfma_f32_16x16x32_bf16 v[60:63], v[64:67], v[140:143], 0
    s_waitcnt vmcnt(0)
    v_perm_b32 v136, v108, v104, s52
    v_perm_b32 v137, v116, v112, s52
    v_perm_b32 v138, v124, v120, s52
    v_perm_b32 v139, v132, v128, s52
    s_nop 1
    v_mfma_f32_16x16x32_bf16 v[32:35], v[68:71], v[136:139], v[32:35]
    v_perm_b32 v140, v108, v104, s53
    v_perm_b32 v141, v116, v112, s53
    v_perm_b32 v142, v124, v120, s53
    v_perm_b32 v143, v132, v128, s53
    s_nop 1
    v_mfma_f32_16x16x32_bf16 v[36:39], v[68:71], v[140:143], v[36:39]
    v_perm_b32 v136, v109, v105, s52
    v_perm_b32 v137, v117, v113, s52
    v_perm_b32 v138, v125, v121, s52
    v_perm_b32 v139, v133, v129, s52
    s_nop 1
    v_mfma_f32_16x16x32_bf16 v[40:43], v[68:71], v[136:139], v[40:43]
    v_perm_b32 v140, v109, v105, s53
    v_perm_b32 v141, v117, v113, s53
    v_perm_b32 v142, v125, v121, s53
    v_perm_b32 v143, v133, v129, s53
    s_nop 1
    v_mfma_f32_16x16x32_bf16 v[44:47], v[68:71], v[140:143], v[44:47]
    v_perm_b32 v136, v110, v106, s52
    v_perm_b32 v137, v118, v114, s52
    v_perm_b32 v138, v126, v122, s52
    v_perm_b32 v139, v134, v130, s52
    s_nop 1
    v_mfma_f32_16x16x32_bf16 v[48:51], v[68:71], v[136:139], v[48:51]
    v_perm_b32 v140, v110, v106, s53
    v_perm_b32 v141, v118, v114, s53
    v_perm_b32 v142, v126, v122, s53
    v_perm_b32 v143, v134, v130, s53
    s_nop 1
    v_mfma_f32_16x16x32_bf16 v[52:55], v[68:71], v[140:143], v[52:55]
    v_perm_b32 v136, v111, v107, s52
    v_perm_b32 v137, v119, v115, s52
    v_perm_b32 v138, v127, v123, s52
    v_perm_b32 v139, v135, v131, s52
    s_nop 1
    v_mfma_f32_16x16x32_bf16 v[56:59], v[68:71], v[136:139], v[56:59]
    v_perm_b32 v140, v111, v107, s53
    v_perm_b32 v141, v119, v115, s53
    v_perm_b32 v142, v127, v123, s53
    v_perm_b32 v143, v135, v131, s53
    s_nop 1
    v_mfma_f32_16x16x32_bf16 v[60:63], v[68:71], v[140:143], v[60:63]
    v_cmp_gt_u32 vcc, 32, v0
    s_nop 1
    v_cndmask_b32 v32, v48, v32, vcc
    v_cndmask_b32 v33, v49, v33, vcc
    v_cndmask_b32 v34, v50, v34, vcc
    v_cndmask_b32 v35, v51, v35, vcc
    v_cndmask_b32 v36, v52, v36, vcc
    v_cndmask_b32 v37, v53, v37, vcc
    v_cndmask_b32 v38, v54, v38, vcc
    v_cndmask_b32 v39, v55, v39, vcc
    v_cndmask_b32 v40, v56, v40, vcc
    v_cndmask_b32 v41, v57, v41, vcc
    v_cndmask_b32 v42, v58, v42, vcc
    v_cndmask_b32 v43, v59, v43, vcc
    v_cndmask_b32 v44, v60, v44, vcc
    v_cndmask_b32 v45, v61, v45, vcc
    v_cndmask_b32 v46, v62, v46, vcc
    v_cndmask_b32 v47, v63, v47, vcc
    s_and_b32 s44, s3, 1
    s_lshl_b32 s44, s44, 12
    s_add_u32 s44, s44, 65536
    v_and_b32 v8, 1, v5
    v_lshrrev_b32 v9, 1, v5
    v_lshl_add_u32 v4, v9, 3, v8
    v_lshlrev_b32 v9, 8, v4
    v_xor_b32 v4, v7, v4
    v_lshl_add_u32 v4, v4, 4, v9
    v_add_u32 v72, s44, v4
    v_xor_b32 v73, 32, v72
    v_xor_b32 v74, 64, v72
    v_xor_b32 v75, 96, v72
    v_add_u32 v8, 8, v10
    s_lshl_b32 s44, s3, 2
    v_add_u32 v76, s44, v5
    v_xor_b32 v76, v76, v7
    v_lshlrev_b32 v76, 4, v76
    v_lshl_add_u32 v76, v7, 8, v76
    v_add_u32 v76, 65536, v76
    s_lshl_b32 s44, s3, 10
    s_lshl_b32 s77, s36, 1
    s_add_u32 s77, s77, s37
    s_mul_i32 s77, s77, 114688
    s_lshl_b32 s46, s38, 12
    s_add_u32 s77, s77, s46
    s_add_u32 s77, s77, s44
    s_lshl_b32 s46, s38, 9
    v_mov_b32 v9, 159148
    v_mov_b32 v11, 1
    v_and_b32 v77, 0xfffffff7, v13

    s_add_u32 s56, s46, 0x829000
    s_add_u32 s56, s72, s56
    s_addc_u32 s57, s73, 0
    s_setprio 3
    ds_read_b32 v12, v13 offset:32
FW_123:
    s_waitcnt lgkmcnt(0)
    v_cmp_gt_u32 vcc, 2, v12
    s_cbranch_vccz FO_124
    s_branch IW_s11
IW_w11:
    s_branch IW_r11
IW_s11:
    s_sleep 1
    ds_read_b32 v12, v13 offset:32
    s_branch FW_123
FO_124:
    s_cmp_lt_u32 s3, 2
    s_cbranch_scc1 F_t1
    ds_write_b128 v72, v[32:35] offset:0
    ds_write_b128 v73, v[36:39] offset:512
    ds_write_b128 v74, v[40:43] offset:1024
    ds_write_b128 v75, v[44:47] offset:1536
    s_mov_b64 exec, 1
    ds_write_b32 v10, v11 offset:64
    s_mov_b64 exec, -1
    s_add_u32 s45, s78, 0
    buffer_load_dwordx4 v[16:19], v160, s[80:83], s45 offen nt
    s_add_u32 s45, s78, 2048
    buffer_load_dwordx4 v[20:23], v160, s[80:83], s45 offen nt
    s_add_u32 s45, s78, 4096
    buffer_load_dwordx4 v[24:27], v160, s[80:83], s45 offen nt
    s_add_u32 s45, s78, 6144
    buffer_load_dwordx4 v[28:31], v160, s[80:83], s45 offen nt
    s_add_u32 s45, s78, 8192
    buffer_load_dwordx4 v[144:147], v160, s[80:83], s45 offen nt
    s_add_u32 s45, s78, 10240
    buffer_load_dwordx4 v[148:151], v160, s[80:83], s45 offen nt
    s_add_u32 s45, s78, 12288
    buffer_load_dwordx4 v[152:155], v160, s[80:83], s45 offen nt
    s_branch F_t2
F_t1:
    s_add_u32 s45, s78, 0
    buffer_load_dwordx4 v[16:19], v160, s[80:83], s45 offen nt
    s_add_u32 s45, s78, 2048
    buffer_load_dwordx4 v[20:23], v160, s[80:83], s45 offen nt
    s_add_u32 s45, s78, 4096
    buffer_load_dwordx4 v[24:27], v160, s[80:83], s45 offen nt
    s_add_u32 s45, s78, 6144
    buffer_load_dwordx4 v[28:31], v160, s[80:83], s45 offen nt
    s_add_u32 s45, s78, 8192
    buffer_load_dwordx4 v[144:147], v160, s[80:83], s45 offen nt
    s_add_u32 s45, s78, 10240
    buffer_load_dwordx4 v[148:151], v160, s[80:83], s45 offen nt
    s_add_u32 s45, s78, 12288
    buffer_load_dwordx4 v[152:155], v160, s[80:83], s45 offen nt
F_t3:
    ds_read_b32 v12, v8 offset:64
    ds_read_b128 v[80:83], v72 offset:0
    ds_read_b128 v[84:87], v73 offset:512
    ds_read_b128 v[88:91], v74 offset:1024
    ds_read_b128 v[92:95], v75 offset:1536
    s_waitcnt lgkmcnt(0)
    v_cmp_eq_u32 vcc, 0, v12
    s_cbranch_vccnz F_t3
    v_add_f32 v32, v32, v80
    v_add_f32 v33, v33, v81
    v_add_f32 v34, v34, v82
    v_add_f32 v35, v35, v83
    v_add_f32 v36, v36, v84
    v_add_f32 v37, v37, v85
    v_add_f32 v38, v38, v86
    v_add_f32 v39, v39, v87
    v_add_f32 v40, v40, v88
    v_add_f32 v41, v41, v89
    v_add_f32 v42, v42, v90
    v_add_f32 v43, v43, v91
    v_add_f32 v44, v44, v92
    v_add_f32 v45, v45, v93
    v_add_f32 v46, v46, v94
    v_add_f32 v47, v47, v95
    ds_write_b128 v72, v[32:35] offset:0
    ds_write_b128 v73, v[36:39] offset:512
    ds_write_b128 v74, v[40:43] offset:1024
    ds_write_b128 v75, v[44:47] offset:1536
    s_mov_b64 exec, 1
    ds_write_b32 v10, v11 offset:64
    s_mov_b64 exec, -1
F_t2:
F_t4:
    ds_read_b32 v12, v77 offset:64
    ds_read_b128 v[80:83], v76
    ds_read_b128 v[84:87], v76 offset:4096
    s_waitcnt lgkmcnt(0)
    v_cmp_eq_u32 vcc, 0, v12
    s_cbranch_vccnz F_t4
    v_add_f32 v72, v80, v84
    v_add_f32 v73, v81, v85
    v_add_f32 v74, v82, v86
    v_add_f32 v75, v83, v87
    buffer_store_dwordx4 v[72:75], v2, s[12:15], s77 offen sc0 sc1
    v_mov_b32 v4, 2
    s_mov_b64 exec, 1
    ds_write_b32 v10, v4 offset:64
    s_mov_b64 exec, -1
    s_waitcnt vmcnt(0)
    s_mov_b64 exec, 1
    ds_add_rtn_u32 v9, v9, v11
    s_waitcnt lgkmcnt(0)
    v_readfirstlane_b32 s44, v9
    s_mov_b64 exec, -1
    s_cmp_lg_u32 s44, 3
    s_cbranch_scc1 F_ad2

    s_mov_b32 s74, 1
    s_atomic_add s74, s[56:57], 0x0
    s_atomic_add s74, s[56:57], 0x80
    s_atomic_add s74, s[56:57], 0x100
    s_atomic_add s74, s[56:57], 0x180
    s_branch F_ad2
F_adown:
    s_add_u32 s45, s78, 0
    buffer_load_dwordx4 v[16:19], v160, s[80:83], s45 offen nt
    s_add_u32 s45, s78, 2048
    buffer_load_dwordx4 v[20:23], v160, s[80:83], s45 offen nt
    s_add_u32 s45, s78, 4096
    buffer_load_dwordx4 v[24:27], v160, s[80:83], s45 offen nt
    s_add_u32 s45, s78, 6144
    buffer_load_dwordx4 v[28:31], v160, s[80:83], s45 offen nt
    s_add_u32 s45, s78, 8192
    buffer_load_dwordx4 v[144:147], v160, s[80:83], s45 offen nt
    s_add_u32 s45, s78, 10240
    buffer_load_dwordx4 v[148:151], v160, s[80:83], s45 offen nt
    s_add_u32 s45, s78, 12288
    buffer_load_dwordx4 v[152:155], v160, s[80:83], s45 offen nt
    v_mov_b32 v4, 2
    s_mov_b64 exec, 1
    ds_write_b32 v10, v4 offset:64
    s_mov_b64 exec, -1
F_ad2:
    v_min_u32 v4, 55, v0
    v_lshlrev_b32 v4, 4, v4
    s_lshl_b32 s38, s47, 5
    s_and_b32 s46, s39, 3
    s_lshr_b32 s44, s47, 7
    s_lshl_b32 s44, s44, 2
    s_add_u32 s44, s44, s46
    s_lshl_b32 s44, s44, 7
    s_add_u32 s45, s47, 111
    s_lshr_b32 s45, s45, 7
    s_lshl_b32 s45, s45, 2
    s_add_u32 s45, s45, s46
    s_lshl_b32 s45, s45, 7
    s_waitcnt lgkmcnt(0)

    s_add_u32 s56, s44, 0x829000
    s_add_u32 s56, s72, s56
    s_addc_u32 s57, s73, 0
    s_add_u32 s58, s45, 0x829000
    s_add_u32 s58, s72, s58
    s_addc_u32 s59, s73, 0
    v_mov_b32 v156, 0
    v_mov_b32 v157, 0
    v_mov_b32 v158, 0
    v_mov_b32 v159, 0
    s_mov_b32 s48, 0xbfb8aa3b
    ds_read_b32 v12, v13 offset:0
FW_125:
    s_waitcnt lgkmcnt(0)
    v_cmp_gt_u32 vcc, 4, v12
    s_cbranch_vccz FO_126
    s_sleep 1
    ds_read_b32 v12, v13 offset:0
    s_branch FW_125
FO_126:
    ds_read_b32 v12, v13 offset:64
FW_127:
    s_waitcnt lgkmcnt(0)
    v_cmp_gt_u32 vcc, 2, v12
    s_cbranch_vccz FO_128
    s_sleep 1
    ds_read_b32 v12, v13 offset:64
    s_branch FW_127
FO_128:
    ds_read_b32 v12, v13 offset:32
FW_129:
    s_waitcnt lgkmcnt(0)
    v_cmp_gt_u32 vcc, 2, v12
    s_cbranch_vccz FO_130
    s_sleep 1
    ds_read_b32 v12, v13 offset:32
    s_branch FW_129
FO_130:
    s_mov_b32 s44, s75
    v_lshlrev_b32 v9, 3, v0
    v_add_u32 v9, s44, v9
    ds_write_b64 v9, v[156:157]
    v_lshrrev_b32 v11, 1, v0
    v_mul_u32_u24 v9, 37, v11
    v_lshrrev_b32 v9, 8, v9
    v_add_u32 v11, v11, v9
    v_lshlrev_b32 v11, 1, v11
    v_and_b32 v9, 1, v0
    v_lshl_add_u32 v11, v9, 8, v11
    v_add_u32 v11, s44, v11
    v_and_b32 v9, 7, v0
    v_lshlrev_b32 v9, 6, v9
    v_lshl_add_u32 v9, v5, 4, v9
    v_add_u32 v9, s44, v9

    s_setprio 1
    s_waitcnt vmcnt(0)
    v_perm_b32 v72, v20, v16, s52
    v_perm_b32 v73, v28, v24, s52
    v_perm_b32 v74, v148, v144, s52
    v_perm_b32 v75, v156, v152, s52
    v_perm_b32 v76, v20, v16, s53
    v_perm_b32 v77, v28, v24, s53
    v_perm_b32 v78, v148, v144, s53
    v_perm_b32 v79, v156, v152, s53
    v_perm_b32 v80, v21, v17, s52
    v_perm_b32 v81, v29, v25, s52
    v_perm_b32 v82, v149, v145, s52
    v_perm_b32 v83, v157, v153, s52
    v_perm_b32 v84, v21, v17, s53
    v_perm_b32 v85, v29, v25, s53
    v_perm_b32 v86, v149, v145, s53
    v_perm_b32 v87, v157, v153, s53
    v_perm_b32 v88, v22, v18, s52
    v_perm_b32 v89, v30, v26, s52
    v_perm_b32 v90, v150, v146, s52
    v_perm_b32 v91, v158, v154, s52
    v_perm_b32 v92, v22, v18, s53
    v_perm_b32 v93, v30, v26, s53
    v_perm_b32 v94, v150, v146, s53
    v_perm_b32 v95, v158, v154, s53
    v_perm_b32 v96, v23, v19, s52
    v_perm_b32 v97, v31, v27, s52
    v_perm_b32 v98, v151, v147, s52
    v_perm_b32 v99, v159, v155, s52
    v_perm_b32 v100, v23, v19, s53
    v_perm_b32 v101, v31, v27, s53
    v_perm_b32 v102, v151, v147, s53
    v_perm_b32 v103, v159, v155, s53
    v_and_b32 v16, 1, v5
    v_lshlrev_b32 v16, 11, v16
    v_lshl_add_u32 v16, v7, 5, v16
    v_lshrrev_b32 v8, 1, v5
    v_lshl_add_u32 v16, v8, 4, v16
    v_add_u32 v16, s75, v16
    s_lshl_b32 s44, s3, 10
    s_add_u32 s44, s44, 32768
    v_add_u32 v17, s44, v3
    v_add_u32 v18, 32768, v17
    v_mov_b32 v19, 1
    s_lshl_b32 s60, s3, 13
    s_lshl_b32 s45, s39, 9
    s_add_u32 s60, s60, s45
    s_add_u32 s60, s60, 135168
    s_add_u32 s61, s60, 4096

    s_add_u32 s62, s45, 0x845000
    s_add_u32 s62, s72, s62
    s_addc_u32 s63, s73, 0
    s_setprio 3
    s_cmp_lg_u32 s3, 0
    s_cbranch_scc1 F_pp
F_p1:
    s_load_dword s76, s[56:57], 0 glc
    s_load_dword s77, s[58:59], 0 glc
    s_waitcnt lgkmcnt(0)
    s_min_u32 s76, s76, s77
    s_cmp_ge_u32 s76, 8
    s_cbranch_scc1 F_p2
    s_sleep 2
    s_branch F_p1
F_p2:
    v_mov_b32 v12, 3
    s_mov_b64 exec, 1
    ds_write_b32 v10, v12 offset:64
    s_mov_b64 exec, -1
F_pp:
    v_mov_b32 v8, 159104
    ds_read_b32 v12, v8 offset:0
FW_131:
    s_waitcnt lgkmcnt(0)
    v_cmp_gt_u32 vcc, 3, v12
    s_cbranch_vccz FO_132
    s_sleep 1
    ds_read_b32 v12, v8 offset:0
    s_branch FW_131
FO_132:
    s_add_u32 s45, s38, 0
    buffer_load_dwordx4 v[32:35], v4, s[12:15], s45 offen sc0 sc1
    s_add_u32 s45, s38, 114688
    buffer_load_dwordx4 v[36:39], v4, s[12:15], s45 offen sc0 sc1
    s_add_u32 s45, s38, 229376
    buffer_load_dwordx4 v[40:43], v4, s[12:15], s45 offen sc0 sc1
    s_add_u32 s45, s38, 344064
    buffer_load_dwordx4 v[44:47], v4, s[12:15], s45 offen sc0 sc1
    s_add_u32 s45, s38, 458752
    buffer_load_dwordx4 v[48:51], v4, s[12:15], s45 offen sc0 sc1
    s_add_u32 s45, s38, 573440
    buffer_load_dwordx4 v[52:55], v4, s[12:15], s45 offen sc0 sc1
    s_add_u32 s45, s38, 688128
    buffer_load_dwordx4 v[56:59], v4, s[12:15], s45 offen sc0 sc1
    s_add_u32 s45, s38, 802816
    buffer_load_dwordx4 v[60:63], v4, s[12:15], s45 offen sc0 sc1
    s_waitcnt vmcnt(0)
    v_add_f32 v32, v32, v40
    v_add_f32 v48, v48, v56
    v_add_f32 v33, v33, v41
    v_add_f32 v49, v49, v57
    v_add_f32 v34, v34, v42
    v_add_f32 v50, v50, v58
    v_add_f32 v35, v35, v43
    v_add_f32 v51, v51, v59
    v_add_f32 v32, v32, v48
    v_add_f32 v33, v33, v49
    v_add_f32 v34, v34, v50
    v_add_f32 v35, v35, v51
    v_add_f32 v36, v36, v44
    v_add_f32 v52, v52, v60
    v_add_f32 v37, v37, v45
    v_add_f32 v53, v53, v61
    v_add_f32 v38, v38, v46
    v_add_f32 v54, v54, v62
    v_add_f32 v39, v39, v47
    v_add_f32 v55, v55, v63
    v_add_f32 v36, v36, v52
    v_add_f32 v37, v37, v53
    v_add_f32 v38, v38, v54
    v_add_f32 v39, v39, v55
    v_cvt_pk_bf16_f32 v40, v32, v36
    v_cvt_pk_bf16_f32 v41, v33, v37
    v_cvt_pk_bf16_f32 v42, v34, v38
    v_cvt_pk_bf16_f32 v43, v35, v39
    v_lshlrev_b32 v32, 16, v40
    v_and_b32 v36, 0xffff0000, v40
    v_lshlrev_b32 v33, 16, v41
    v_and_b32 v37, 0xffff0000, v41
    v_lshlrev_b32 v34, 16, v42
    v_and_b32 v38, 0xffff0000, v42
    v_lshlrev_b32 v35, 16, v43
    v_and_b32 v39, 0xffff0000, v43
    v_mul_f32 v40, s48, v32
    v_mul_f32 v41, s48, v33
    v_mul_f32 v42, s48, v34
    v_mul_f32 v43, s48, v35
    v_exp_f32 v40, v40
    v_exp_f32 v41, v41
    v_exp_f32 v42, v42
    v_exp_f32 v43, v43
    v_add_f32 v40, 1.0, v40
    v_add_f32 v41, 1.0, v41
    v_add_f32 v42, 1.0, v42
    v_add_f32 v43, 1.0, v43
    v_rcp_f32 v40, v40
    v_rcp_f32 v41, v41
    v_rcp_f32 v42, v42
    v_rcp_f32 v43, v43
    v_mul_f32 v32, v32, v40
    v_mul_f32 v33, v33, v41
    v_mul_f32 v34, v34, v42
    v_mul_f32 v35, v35, v43
    v_cvt_pk_bf16_f32 v32, v32, v32
    v_cvt_pk_bf16_f32 v33, v33, v33
    v_cvt_pk_bf16_f32 v34, v34, v34
    v_cvt_pk_bf16_f32 v35, v35, v35
    v_lshlrev_b32 v32, 16, v32
    v_lshlrev_b32 v33, 16, v33
    v_lshlrev_b32 v34, 16, v34
    v_lshlrev_b32 v35, 16, v35
    v_mul_f32 v32, v32, v36
    v_mul_f32 v33, v33, v37
    v_mul_f32 v34, v34, v38
    v_mul_f32 v35, v35, v39
    v_cvt_pk_bf16_f32 v32, v32, v32
    v_cvt_pk_bf16_f32 v33, v33, v33
    v_cvt_pk_bf16_f32 v34, v34, v34
    v_cvt_pk_bf16_f32 v35, v35, v35
    s_mov_b32 exec_hi, 0xffffff
    ds_write_b16 v11, v32 offset:0
    ds_write_b16 v11, v33 offset:64
    ds_write_b16 v11, v34 offset:128
    ds_write_b16 v11, v35 offset:192
    s_mov_b64 exec, -1
    ds_read_b128 v[64:67], v9
    v_cmp_gt_u32 vcc, 32, v0
    s_waitcnt lgkmcnt(0)
    v_mfma_f32_16x16x32_bf16 v[104:107], v[64:67], v[72:75], 0
    v_mfma_f32_16x16x32_bf16 v[120:123], v[64:67], v[88:91], 0
    v_mfma_f32_16x16x32_bf16 v[108:111], v[64:67], v[76:79], 0
    v_mfma_f32_16x16x32_bf16 v[124:127], v[64:67], v[92:95], 0
    v_mfma_f32_16x16x32_bf16 v[112:115], v[64:67], v[80:83], 0
    v_mfma_f32_16x16x32_bf16 v[128:131], v[64:67], v[96:99], 0
    v_mfma_f32_16x16x32_bf16 v[116:119], v[64:67], v[84:87], 0
    v_mfma_f32_16x16x32_bf16 v[132:135], v[64:67], v[100:103], 0
    s_nop 1
    v_cndmask_b32 v136, v120, v104, vcc
    v_cndmask_b32 v140, v121, v105, vcc
    v_cndmask_b32 v144, v122, v106, vcc
    v_cndmask_b32 v148, v123, v107, vcc
    v_cndmask_b32 v137, v124, v108, vcc
    v_cndmask_b32 v141, v125, v109, vcc
    v_cndmask_b32 v145, v126, v110, vcc
    v_cndmask_b32 v149, v127, v111, vcc
    v_cndmask_b32 v138, v128, v112, vcc
    v_cndmask_b32 v142, v129, v113, vcc
    v_cndmask_b32 v146, v130, v114, vcc
    v_cndmask_b32 v150, v131, v115, vcc
    v_cndmask_b32 v139, v132, v116, vcc
    v_cndmask_b32 v143, v133, v117, vcc
    v_cndmask_b32 v147, v134, v118, vcc
    v_cndmask_b32 v151, v135, v119, vcc
    ds_write_b128 v16, v[136:139] offset:0
    ds_write_b128 v16, v[140:143] offset:512
    ds_write_b128 v16, v[144:147] offset:1024
    ds_write_b128 v16, v[148:151] offset:1536
    s_mov_b64 exec, 1
    ds_write_b32 v10, v19 offset:80
    s_mov_b64 exec, -1
F_d1:
    ds_read_b32 v12, v13 offset:80
    ds_read2st64_b32 v[32:33], v17 offset0:0 offset1:1
    ds_read2st64_b32 v[34:35], v17 offset0:2 offset1:3
    ds_read2st64_b32 v[36:37], v17 offset0:16 offset1:17
    ds_read2st64_b32 v[38:39], v17 offset0:18 offset1:19
    ds_read2st64_b32 v[40:41], v18 offset0:0 offset1:1
    ds_read2st64_b32 v[42:43], v18 offset0:2 offset1:3
    ds_read2st64_b32 v[44:45], v18 offset0:16 offset1:17
    ds_read2st64_b32 v[46:47], v18 offset0:18 offset1:19
    s_waitcnt lgkmcnt(0)
    v_cmp_eq_u32 vcc, 0, v12
    s_cbranch_vccnz F_d1
    v_add_f32 v32, v32, v36
    v_add_f32 v40, v40, v44
    v_add_f32 v33, v33, v37
    v_add_f32 v41, v41, v45
    v_add_f32 v34, v34, v38
    v_add_f32 v42, v42, v46
    v_add_f32 v35, v35, v39
    v_add_f32 v43, v43, v47
    v_add_f32 v32, v32, v40
    buffer_atomic_add_f32 v32, v3, s[24:27], s60 offen offset:0
    v_add_f32 v33, v33, v41
    buffer_atomic_add_f32 v33, v3, s[24:27], s60 offen offset:256
    v_add_f32 v34, v34, v42
    buffer_atomic_add_f32 v34, v3, s[24:27], s61 offen offset:0
    v_add_f32 v35, v35, v43
    buffer_atomic_add_f32 v35, v3, s[24:27], s61 offen offset:256
    v_mov_b32 v4, 159140
    v_mov_b32 v8, 1
    s_waitcnt vmcnt(0)
    s_mov_b64 exec, 1
    ds_add_rtn_u32 v9, v4, v8
    s_waitcnt lgkmcnt(0)
    v_readfirstlane_b32 s44, v9
    s_mov_b64 exec, -1
    s_cmp_lg_u32 s44, 3
    s_cbranch_scc1 F_ye
    s_mov_b32 s44, 1
    s_atomic_add s44, s[62:63], 0
    s_atomic_add s44, s[62:63], 0x80
    s_atomic_add s44, s[62:63], 0x100
    s_atomic_add s44, s[62:63], 0x180
F_ye:

    s_endpgm
F_codeend:
.section .rodata,"a"
.p2align 6
.amdhsa_kernel parallel_sum__linear_attn_block__moe_arch_mod__prompt_kernel
  .amdhsa_next_free_vgpr 168
  .amdhsa_next_free_sgpr 98
  .amdhsa_accum_offset 168
  .amdhsa_group_segment_fixed_size 0
  .amdhsa_kernarg_size 88
  .amdhsa_user_sgpr_count 2
  .amdhsa_user_sgpr_kernarg_segment_ptr 1
  .amdhsa_system_sgpr_workgroup_id_x 1
  .amdhsa_float_denorm_mode_32 3
  .amdhsa_float_denorm_mode_16_64 3
.end_amdhsa_kernel
```

```asm
; @launch grid=(256,1,1) block=(768,1,1) lds=163840
.amdgcn_target "amdgcn-amd-amdhsa--gfx950"
.text
.globl parallel_sum__linear_attn_block__moe_arch_mod__prompt_kernel
.p2align 12
.p2align 8
.type parallel_sum__linear_attn_block__moe_arch_mod__prompt_kernel,@function
parallel_sum__linear_attn_block__moe_arch_mod__prompt_kernel:
    s_load_dwordx4 s[4:7], s[0:1], 0
    s_load_dwordx2 s[8:9], s[0:1], 16
    s_load_dwordx8 s[60:67], s[0:1], 32
    s_load_dwordx4 s[68:71], s[0:1], 64
    s_load_dwordx2 s[72:73], s[0:1], 80
    s_cmp_ge_u32 s2, 256
    s_cbranch_scc1 F_end
    v_lshrrev_b32 v1, 6, v0
    v_and_b32 v0, 63, v0
    s_and_b32 s30, s2, 7
    v_readfirstlane_b32 s3, v1
    s_lshr_b32 s31, s2, 3
    s_and_b32 s36, s30, 1
    s_lshl_b32 s32, s36, 3
    s_and_b32 s35, s31, 7
    s_add_u32 s32, s32, s35
    s_lshr_b32 s37, s30, 1
    s_lshl_b32 s33, s37, 2
    s_lshr_b32 s34, s31, 3
    s_add_u32 s33, s33, s34
    s_add_u32 s10, s33, 0
    s_and_b32 s10, s10, 15
    s_add_u32 s11, s35, s34
    s_and_b32 s11, s11, 3
    s_and_b32 s28, s32, 11
    s_and_b32 s29, s37, 1
    s_lshl_b32 s29, s29, 2
    s_add_u32 s28, s28, s29
    s_lshr_b32 s29, s37, 1
    s_lshl_b32 s29, s29, 3
    s_and_b32 s38, s35, 4
    s_add_u32 s29, s29, s38
    s_add_u32 s38, s34, 1
    s_and_b32 s38, s38, 3
    s_add_u32 s29, s29, s38

    s_lshl_b32 s11, s34, 1
    s_add_u32 s11, s11, s35
    s_and_b32 s11, s11, 7
    s_mul_i32 s89, s36, 8
    s_mul_i32 s38, s37, 2
    s_add_u32 s89, s89, s38

    s_mov_b32 s94, 0x73156420
    s_mov_b32 s95, 0xfb9dea8c
    s_cmp_eq_u32 s11, 1
    s_cselect_b32 s94, 0x62047531, s94
    s_cselect_b32 s95, 0xea8cfb9d, s95
    s_cmp_eq_u32 s11, 2
    s_cselect_b32 s94, 0x53710642, s94
    s_cselect_b32 s95, 0xdbf9cae8, s95
    s_cmp_eq_u32 s11, 3
    s_cselect_b32 s94, 0x42601753, s94
    s_cselect_b32 s95, 0xcae8dbf9, s95
    s_cmp_eq_u32 s11, 4
    s_cselect_b32 s94, 0x58320164, s94
    s_cselect_b32 s95, 0xfdbec9a7, s95
    s_cmp_eq_u32 s11, 5
    s_cselect_b32 s94, 0x49231075, s94
    s_cselect_b32 s95, 0xecafd8b6, s95
    s_cmp_eq_u32 s11, 6
    s_cselect_b32 s94, 0xa5143206, s94
    s_cselect_b32 s95, 0xfd9ebc87, s95
    s_cmp_eq_u32 s11, 7
    s_cselect_b32 s94, 0xb4052317, s94
    s_cselect_b32 s95, 0xec8fad96, s95
    s_cmp_ge_u32 s3, 8
    s_cbranch_scc1 F_aux
    s_cmp_ge_u32 s3, 4
    s_cbranch_scc1 F_nl
    v_lshrrev_b32 v2, 3, v0
    v_and_b32 v3, 7, v0
    v_lshrrev_b32 v4, 1, v2
    v_xor_b32 v5, v3, v4
    v_xor_b32 v6, 4, v5
    v_lshlrev_b32 v5, 4, v5
    v_lshlrev_b32 v6, 4, v6
    v_lshlrev_b32 v7, 11, v2
    v_add_u32 v5, v5, v7
    v_add_u32 v6, v6, v7
    v_and_b32 v4, 1, v4
    v_lshlrev_b32 v4, 1, v4
    v_xor_b32 v8, v3, v4
    v_xor_b32 v9, 4, v8
    v_lshlrev_b32 v8, 4, v8
    v_lshlrev_b32 v9, 4, v9
    v_mul_u32_u24 v7, 6144, v2
    v_add_u32 v8, v8, v7
    v_add_u32 v9, v9, v7
    v_add_u32 v9, 49152, v9
    s_lshl_b32 s36, s32, 18
    s_lshl_b32 s37, s3, 16
    s_add_u32 s36, s36, s37
    s_lshl_b32 s38, s33, 7
    s_mul_i32 s37, s3, 98304
    s_add_u32 s38, s38, s37
    s_lshl_b32 s47, s10, 7
    s_add_u32 s47, s47, s37
    s_lshl_b32 s44, s3, 12
    s_lshl_b32 s45, s3, 11
    s_add_u32 s43, s45, 1024
    s_mov_b32 s14, 4194304
    s_mov_b32 s15, 0x20000
    s_mov_b32 s18, 6291456
    s_mov_b32 s19, 0x20000
    s_waitcnt lgkmcnt(0)
    s_mov_b32 s12, s4
    s_mov_b32 s13, s5
    s_mov_b32 s16, s6
    s_mov_b32 s17, s7

    s_setprio 3
    s_bfe_u32 s40, s94, 0x40000
    s_add_u32 s40, s89, s40
    s_and_b32 s40, s40, 15
    s_mul_i32 s41, s40, 393216
    s_lshl_b32 s40, s40, 7
    s_add_u32 s40, s40, s36
    s_add_u32 s42, s41, s47
    s_add_u32 s41, s41, s38
    s_add_u32 m0, s44, 0
    s_add_u32 s46, s40, 0
    buffer_load_dwordx4 v5, s[12:15], s46 offen lds
    s_add_u32 m0, s44, 1024
    s_add_u32 s46, s40, 16384
    buffer_load_dwordx4 v6, s[12:15], s46 offen lds
    s_add_u32 m0, s44, 2048
    s_add_u32 s46, s40, 32768
    buffer_load_dwordx4 v5, s[12:15], s46 offen lds
    s_add_u32 m0, s44, 3072
    s_add_u32 s46, s40, 49152
    buffer_load_dwordx4 v6, s[12:15], s46 offen lds
    s_add_u32 m0, s45, 65536
    s_add_u32 s46, s41, 2048
    buffer_load_dwordx4 v8, s[16:19], s46 offen lds
    s_add_u32 m0, s43, 65536
    s_add_u32 s46, s41, 2048
    buffer_load_dwordx4 v9, s[16:19], s46 offen lds
    s_add_u32 m0, s45, 73728
    s_add_u32 s46, s41, 4096
    buffer_load_dwordx4 v8, s[16:19], s46 offen lds
    s_add_u32 m0, s43, 73728
    s_add_u32 s46, s41, 4096
    buffer_load_dwordx4 v9, s[16:19], s46 offen lds
    s_add_u32 m0, s45, 147456
    s_nop 0
    buffer_load_dwordx4 v8, s[16:19], s42 offen lds
    s_add_u32 m0, s43, 147456
    s_nop 0
    buffer_load_dwordx4 v9, s[16:19], s42 offen lds
    s_bfe_u32 s40, s94, 0x40004
    s_add_u32 s40, s89, s40
    s_and_b32 s40, s40, 15
    s_mul_i32 s41, s40, 393216
    s_lshl_b32 s40, s40, 7
    s_add_u32 s40, s40, s36
    s_add_u32 s42, s41, s47
    s_add_u32 s41, s41, s38
    s_add_u32 m0, s44, 16384
    s_add_u32 s46, s40, 0
    buffer_load_dwordx4 v5, s[12:15], s46 offen lds
    s_add_u32 m0, s44, 17408
    s_add_u32 s46, s40, 16384
    buffer_load_dwordx4 v6, s[12:15], s46 offen lds
    s_add_u32 m0, s44, 18432
    s_add_u32 s46, s40, 32768
    buffer_load_dwordx4 v5, s[12:15], s46 offen lds
    s_add_u32 m0, s44, 19456
    s_add_u32 s46, s40, 49152
    buffer_load_dwordx4 v6, s[12:15], s46 offen lds
    s_add_u32 m0, s45, 81920
    s_add_u32 s46, s41, 2048
    buffer_load_dwordx4 v8, s[16:19], s46 offen lds
    s_add_u32 m0, s43, 81920
    s_add_u32 s46, s41, 2048
    buffer_load_dwordx4 v9, s[16:19], s46 offen lds
    v_and_b32 v1, 15, v0
    v_lshrrev_b32 v7, 4, v0
    v_lshrrev_b32 v3, 1, v1
    v_xor_b32 v3, v3, v7
    v_lshlrev_b32 v3, 4, v3
    v_lshlrev_b32 v1, 7, v1
    v_add3_u32 v2, v1, v3, s44
    v_xor_b32 v3, 64, v2
    v_add_u32 v14, 0x10000, v2
    v_add_u32 v15, 0x10000, v3
    v_bfe_u32 v1, v0, 2, 2
    v_lshl_add_u32 v4, v7, 3, v1
    v_lshrrev_b32 v1, 1, v1
    v_and_b32 v7, 1, v7
    v_lshl_add_u32 v1, v7, 1, v1
    v_lshlrev_b32 v1, 5, v1
    v_lshl_add_u32 v1, v4, 7, v1
    v_and_b32 v7, 3, v0
    v_lshl_add_u32 v1, v7, 3, v1
    v_add_u32 v10, 90112, v1
    v_xor_b32 v11, 32, v10
    v_xor_b32 v12, 64, v10
    v_xor_b32 v13, 96, v10
    v_lshlrev_b32 v1, 2, v7
    v_add_u32 v1, 159040, v1
    s_lshl_b32 s50, s3, 2
    s_add_u32 s50, s50, 159040
    v_mov_b32 v4, s50
    v_mov_b32 v164, 1

    s_waitcnt vmcnt(8)
    s_barrier
    s_add_u32 m0, s45, 90112
    s_add_u32 s46, s41, 4096
    buffer_load_dwordx4 v8, s[16:19], s46 offen lds
    ds_read_b128 v[48:51], v2 offset:0
    s_add_u32 m0, s43, 90112
    s_add_u32 s46, s41, 4096
    buffer_load_dwordx4 v9, s[16:19], s46 offen lds
    ds_read_b128 v[52:55], v2 offset:2048
    s_lshl_b32 s51, s32, 4
    s_add_u32 s51, s51, s33
    s_lshl_b32 s51, s51, 14
    s_add_u32 s51, s51, s45
    v_lshlrev_b32 v165, 4, v0
    s_mov_b32 s20, s60
    s_mov_b32 s21, s61
    s_mov_b32 s22, 0x800
    s_mov_b32 s23, 0x00020000
    s_add_u32 m0, s45, 98304
    s_add_u32 s46, s51, 0
    buffer_load_dwordx4 v165, s[12:15], s46 offen lds
    ds_read_b128 v[56:59], v3 offset:0
    s_add_u32 m0, s45, 99328
    s_add_u32 s46, s51, 1024
    buffer_load_dwordx4 v165, s[12:15], s46 offen lds
    ds_read_b128 v[60:63], v3 offset:2048
    s_and_b32 s46, s3, 1
    s_lshl_b32 s46, s46, 10
    s_add_u32 m0, s46, 161792
    s_nop 0
    buffer_load_dwordx4 v165, s[20:23], s46 offen lds
    s_add_u32 m0, s45, 106496
    s_add_u32 s46, s51, 8192
    buffer_load_dwordx4 v165, s[12:15], s46 offen lds
    s_add_u32 m0, s45, 107520
    s_add_u32 s46, s51, 9216
    buffer_load_dwordx4 v165, s[12:15], s46 offen lds
    s_bfe_u32 s40, s94, 0x40008
    s_add_u32 s40, s89, s40
    s_and_b32 s40, s40, 15
    s_mul_i32 s41, s40, 393216
    s_lshl_b32 s40, s40, 7
    s_add_u32 s40, s40, s36
    s_add_u32 s42, s41, s47
    s_add_u32 s41, s41, s38
    s_add_u32 m0, s44, 32768
    s_add_u32 s46, s40, 0
    buffer_load_dwordx4 v5, s[12:15], s46 offen lds
    s_add_u32 m0, s44, 33792
    s_add_u32 s46, s40, 16384
    buffer_load_dwordx4 v6, s[12:15], s46 offen lds
    s_add_u32 m0, s44, 34816
    s_add_u32 s46, s40, 32768
    buffer_load_dwordx4 v5, s[12:15], s46 offen lds
    s_add_u32 m0, s44, 35840
    s_add_u32 s46, s40, 49152
    buffer_load_dwordx4 v6, s[12:15], s46 offen lds
    s_waitcnt vmcnt(9) lgkmcnt(0)
    s_barrier
    s_add_u32 m0, s45, 114688
    s_add_u32 s46, s41, 2048
    buffer_load_dwordx4 v8, s[16:19], s46 offen lds
    ds_read_b64_tr_b16 v[64:65], v10 offset:57344
    ds_read_b64_tr_b16 v[66:67], v10 offset:57856
    s_add_u32 m0, s43, 114688
    s_add_u32 s46, s41, 2048
    buffer_load_dwordx4 v9, s[16:19], s46 offen lds
    ds_read_b128 v[68:71], v2 offset:16384
    s_add_u32 m0, s45, 122880
    s_add_u32 s46, s41, 4096
    buffer_load_dwordx4 v8, s[16:19], s46 offen lds
    ds_read_b64_tr_b16 v[72:73], v11 offset:57344
    ds_read_b64_tr_b16 v[74:75], v11 offset:57856
    s_add_u32 m0, s43, 122880
    s_add_u32 s46, s41, 4096
    buffer_load_dwordx4 v9, s[16:19], s46 offen lds
    ds_read_b128 v[76:79], v2 offset:18432
    s_bfe_u32 s40, s94, 0x40004
    s_add_u32 s40, s89, s40
    s_and_b32 s40, s40, 15
    s_mul_i32 s41, s40, 393216
    s_lshl_b32 s40, s40, 7
    s_add_u32 s40, s40, s36
    s_add_u32 s42, s41, s47
    s_add_u32 s41, s41, s38
    s_add_u32 m0, s45, 139264
    s_nop 0
    buffer_load_dwordx4 v8, s[16:19], s42 offen lds
    ds_read_b64_tr_b16 v[80:81], v12 offset:57344
    ds_read_b64_tr_b16 v[82:83], v12 offset:57856
    s_add_u32 m0, s43, 139264
    s_nop 0
    buffer_load_dwordx4 v9, s[16:19], s42 offen lds
    ds_read_b128 v[84:87], v3 offset:16384
    s_bfe_u32 s40, s94, 0x4000c
    s_add_u32 s40, s89, s40
    s_and_b32 s40, s40, 15
    s_mul_i32 s41, s40, 393216
    s_lshl_b32 s40, s40, 7
    s_add_u32 s40, s40, s36
    s_add_u32 s42, s41, s47
    s_add_u32 s41, s41, s38
    s_add_u32 m0, s44, 49152
    s_add_u32 s46, s40, 0
    buffer_load_dwordx4 v5, s[12:15], s46 offen lds
    ds_read_b64_tr_b16 v[88:89], v13 offset:57344
    ds_read_b64_tr_b16 v[90:91], v13 offset:57856
    s_add_u32 m0, s44, 50176
    s_add_u32 s46, s40, 16384
    buffer_load_dwordx4 v6, s[12:15], s46 offen lds
    ds_read_b128 v[92:95], v3 offset:18432
    s_add_u32 m0, s44, 51200
    s_add_u32 s46, s40, 32768
    buffer_load_dwordx4 v5, s[12:15], s46 offen lds
    s_add_u32 m0, s44, 52224
    s_add_u32 s46, s40, 49152
    buffer_load_dwordx4 v6, s[12:15], s46 offen lds
    s_add_u32 m0, s45, 131072
    s_add_u32 s46, s41, 2048
    buffer_load_dwordx4 v8, s[16:19], s46 offen lds
    s_waitcnt vmcnt(5) lgkmcnt(0)
    s_barrier
    s_add_u32 m0, s43, 131072
    s_add_u32 s46, s41, 2048
    buffer_load_dwordx4 v9, s[16:19], s46 offen lds
    v_mfma_f32_16x16x32_bf16 v[16:19], v[64:67], v[48:51], 0
    ds_read_b64_tr_b16 v[96:97], v10 offset:61440
    ds_read_b64_tr_b16 v[98:99], v10 offset:61952
    s_add_u32 m0, s45, 65536
    s_add_u32 s46, s41, 4096
    buffer_load_dwordx4 v8, s[16:19], s46 offen lds
    v_mfma_f32_16x16x32_bf16 v[32:35], v[64:67], v[52:55], 0
    ds_read_b128 v[100:103], v2 offset:32768
    s_add_u32 m0, s43, 65536
    s_add_u32 s46, s41, 4096
    buffer_load_dwordx4 v9, s[16:19], s46 offen lds
    v_mfma_f32_16x16x32_bf16 v[20:23], v[72:75], v[48:51], 0
    ds_read_b64_tr_b16 v[104:105], v11 offset:61440
    ds_read_b64_tr_b16 v[106:107], v11 offset:61952
    s_bfe_u32 s40, s94, 0x40008
    s_add_u32 s40, s89, s40
    s_and_b32 s40, s40, 15
    s_mul_i32 s41, s40, 393216
    s_lshl_b32 s40, s40, 7
    s_add_u32 s40, s40, s36
    s_add_u32 s42, s41, s47
    s_add_u32 s41, s41, s38
    s_add_u32 m0, s45, 90112
    s_nop 0
    buffer_load_dwordx4 v8, s[16:19], s42 offen lds
    v_mfma_f32_16x16x32_bf16 v[36:39], v[72:75], v[52:55], 0
    ds_read_b128 v[108:111], v2 offset:34816
    s_add_u32 m0, s43, 90112
    s_nop 0
    buffer_load_dwordx4 v9, s[16:19], s42 offen lds
    v_mfma_f32_16x16x32_bf16 v[24:27], v[80:83], v[48:51], 0
    ds_read_b64_tr_b16 v[112:113], v12 offset:61440
    ds_read_b64_tr_b16 v[114:115], v12 offset:61952
    s_bfe_u32 s40, s94, 0x40010
    s_add_u32 s40, s89, s40
    s_and_b32 s40, s40, 15
    s_mul_i32 s41, s40, 393216
    s_lshl_b32 s40, s40, 7
    s_add_u32 s40, s40, s36
    s_add_u32 s42, s41, s47
    s_add_u32 s41, s41, s38
    s_add_u32 m0, s44, 0
    s_add_u32 s46, s40, 0
    buffer_load_dwordx4 v5, s[12:15], s46 offen lds
    v_mfma_f32_16x16x32_bf16 v[40:43], v[80:83], v[52:55], 0
    ds_read_b128 v[116:119], v3 offset:32768
    s_add_u32 m0, s44, 1024
    s_add_u32 s46, s40, 16384
    buffer_load_dwordx4 v6, s[12:15], s46 offen lds
    v_mfma_f32_16x16x32_bf16 v[28:31], v[88:91], v[48:51], 0
    ds_read_b64_tr_b16 v[120:121], v13 offset:61440
    ds_read_b64_tr_b16 v[122:123], v13 offset:61952
    s_add_u32 m0, s44, 2048
    s_add_u32 s46, s40, 32768
    buffer_load_dwordx4 v5, s[12:15], s46 offen lds
    v_mfma_f32_16x16x32_bf16 v[44:47], v[88:91], v[52:55], 0
    ds_read_b128 v[124:127], v3 offset:34816
    s_add_u32 m0, s44, 3072
    s_add_u32 s46, s40, 49152
    buffer_load_dwordx4 v6, s[12:15], s46 offen lds
    ds_read_b64_tr_b16 v[128:129], v10 offset:49152
    ds_read_b64_tr_b16 v[130:131], v10 offset:49664
    s_add_u32 m0, s45, 73728
    s_add_u32 s46, s41, 2048
    buffer_load_dwordx4 v8, s[16:19], s46 offen lds
    ds_read_b64_tr_b16 v[132:133], v11 offset:49152
    s_waitcnt lgkmcnt(8)
    ds_read_b64_tr_b16 v[134:135], v11 offset:49664
    s_add_u32 m0, s43, 73728
    s_add_u32 s46, s41, 2048
    buffer_load_dwordx4 v9, s[16:19], s46 offen lds
    ds_read_b64_tr_b16 v[136:137], v12 offset:49152
    ds_read_b64_tr_b16 v[138:139], v12 offset:49664
    ds_read_b64_tr_b16 v[140:141], v13 offset:49152
    ds_read_b64_tr_b16 v[142:143], v13 offset:49664
    s_waitcnt vmcnt(6) lgkmcnt(0)
    s_barrier
    s_add_u32 m0, s45, 81920
    s_add_u32 s46, s41, 4096
    buffer_load_dwordx4 v8, s[16:19], s46 offen lds
    v_mfma_f32_16x16x32_bf16 v[16:19], v[96:99], v[56:59], v[16:19]
    ds_read_b64_tr_b16 v[144:145], v10 offset:53248
    ds_read_b64_tr_b16 v[146:147], v10 offset:53760
    s_add_u32 m0, s43, 81920
    s_add_u32 s46, s41, 4096
    buffer_load_dwordx4 v9, s[16:19], s46 offen lds
    v_mfma_f32_16x16x32_bf16 v[32:35], v[96:99], v[60:63], v[32:35]
    ds_read_b128 v[148:151], v2 offset:49152
    s_bfe_u32 s40, s94, 0x40014
    s_add_u32 s40, s89, s40
    s_and_b32 s40, s40, 15
    s_mul_i32 s41, s40, 393216
    s_lshl_b32 s40, s40, 7
    s_add_u32 s40, s40, s36
    s_add_u32 s42, s41, s47
    s_add_u32 s41, s41, s38
    s_add_u32 m0, s44, 16384
    s_add_u32 s46, s40, 0
    buffer_load_dwordx4 v5, s[12:15], s46 offen lds
    v_mfma_f32_16x16x32_bf16 v[20:23], v[104:107], v[56:59], v[20:23]
    ds_read_b64_tr_b16 v[152:153], v11 offset:53248
    ds_read_b64_tr_b16 v[154:155], v11 offset:53760
    s_add_u32 m0, s44, 17408
    s_add_u32 s46, s40, 16384
    buffer_load_dwordx4 v6, s[12:15], s46 offen lds
    v_mfma_f32_16x16x32_bf16 v[36:39], v[104:107], v[60:63], v[36:39]
    ds_read_b128 v[156:159], v2 offset:51200
    s_add_u32 m0, s44, 18432
    s_add_u32 s46, s40, 32768
    buffer_load_dwordx4 v5, s[12:15], s46 offen lds
    v_mfma_f32_16x16x32_bf16 v[24:27], v[112:115], v[56:59], v[24:27]
    ds_read_b64_tr_b16 v[160:161], v12 offset:53248
    ds_read_b64_tr_b16 v[162:163], v12 offset:53760
    s_add_u32 m0, s44, 19456
    s_add_u32 s46, s40, 49152
    buffer_load_dwordx4 v6, s[12:15], s46 offen lds
    v_mfma_f32_16x16x32_bf16 v[40:43], v[112:115], v[60:63], v[40:43]
    ds_read_b128 v[64:67], v3 offset:49152
    s_add_u32 m0, s45, 98304
    s_add_u32 s46, s41, 2048
    buffer_load_dwordx4 v8, s[16:19], s46 offen lds
    v_mfma_f32_16x16x32_bf16 v[28:31], v[120:123], v[56:59], v[28:31]
    ds_read_b64_tr_b16 v[72:73], v13 offset:53248
    ds_read_b64_tr_b16 v[74:75], v13 offset:53760
    s_add_u32 m0, s43, 98304
    s_add_u32 s46, s41, 2048
    buffer_load_dwordx4 v9, s[16:19], s46 offen lds
    v_mfma_f32_16x16x32_bf16 v[44:47], v[120:123], v[60:63], v[44:47]
    ds_read_b128 v[80:83], v3 offset:51200
    s_add_u32 m0, s45, 106496
    s_add_u32 s46, s41, 4096
    buffer_load_dwordx4 v8, s[16:19], s46 offen lds
    v_mfma_f32_16x16x32_bf16 v[16:19], v[128:131], v[68:71], v[16:19]
    ds_read_b64_tr_b16 v[48:49], v10 offset:0
    ds_read_b64_tr_b16 v[50:51], v10 offset:512
    s_add_u32 m0, s43, 106496
    s_add_u32 s46, s41, 4096
    buffer_load_dwordx4 v9, s[16:19], s46 offen lds
    v_mfma_f32_16x16x32_bf16 v[32:35], v[128:131], v[76:79], v[32:35]
    ds_read_b64_tr_b16 v[88:89], v11 offset:0
    s_waitcnt lgkmcnt(8)
    ds_read_b64_tr_b16 v[90:91], v11 offset:512
    s_bfe_u32 s40, s94, 0x4000c
    s_add_u32 s40, s89, s40
    s_and_b32 s40, s40, 15
    s_mul_i32 s41, s40, 393216
    s_lshl_b32 s40, s40, 7
    s_add_u32 s40, s40, s36
    s_add_u32 s42, s41, s47
    s_add_u32 s41, s41, s38
    s_add_u32 m0, s45, 147456
    s_nop 0
    buffer_load_dwordx4 v8, s[16:19], s42 offen lds
    v_mfma_f32_16x16x32_bf16 v[20:23], v[132:135], v[68:71], v[20:23]
    ds_read_b64_tr_b16 v[52:53], v12 offset:0
    ds_read_b64_tr_b16 v[54:55], v12 offset:512
    v_mfma_f32_16x16x32_bf16 v[36:39], v[132:135], v[76:79], v[36:39]
    ds_read_b64_tr_b16 v[96:97], v13 offset:0
    ds_read_b64_tr_b16 v[98:99], v13 offset:512
    v_mfma_f32_16x16x32_bf16 v[24:27], v[136:139], v[68:71], v[24:27]
    v_mfma_f32_16x16x32_bf16 v[40:43], v[136:139], v[76:79], v[40:43]
    v_mfma_f32_16x16x32_bf16 v[28:31], v[140:143], v[68:71], v[28:31]
    v_mfma_f32_16x16x32_bf16 v[44:47], v[140:143], v[76:79], v[44:47]
    s_waitcnt vmcnt(9) lgkmcnt(0)
    s_barrier
    s_add_u32 m0, s43, 147456
    s_nop 0
    buffer_load_dwordx4 v9, s[16:19], s42 offen lds
    v_mfma_f32_16x16x32_bf16 v[16:19], v[144:147], v[84:87], v[16:19]
    ds_read_b64_tr_b16 v[104:105], v10 offset:4096
    ds_read_b64_tr_b16 v[106:107], v10 offset:4608
    s_bfe_u32 s40, s94, 0x40018
    s_add_u32 s40, s89, s40
    s_and_b32 s40, s40, 15
    s_mul_i32 s41, s40, 393216
    s_lshl_b32 s40, s40, 7
    s_add_u32 s40, s40, s36
    s_add_u32 s42, s41, s47
    s_add_u32 s41, s41, s38
    s_add_u32 m0, s44, 32768
    s_add_u32 s46, s40, 0
    buffer_load_dwordx4 v5, s[12:15], s46 offen lds
    v_mfma_f32_16x16x32_bf16 v[32:35], v[144:147], v[92:95], v[32:35]
    ds_read_b128 v[112:115], v2 offset:0
    s_add_u32 m0, s44, 33792
    s_add_u32 s46, s40, 16384
    s_branch IW_s0
IW_w0:
    s_branch IW_r0
IW_s0:
    buffer_load_dwordx4 v6, s[12:15], s46 offen lds
    v_mfma_f32_16x16x32_bf16 v[20:23], v[152:155], v[84:87], v[20:23]
    ds_read_b64_tr_b16 v[56:57], v11 offset:4096
    ds_read_b64_tr_b16 v[58:59], v11 offset:4608
    s_add_u32 m0, s44, 34816
    s_add_u32 s46, s40, 32768
    buffer_load_dwordx4 v5, s[12:15], s46 offen lds
    v_mfma_f32_16x16x32_bf16 v[36:39], v[152:155], v[92:95], v[36:39]
    ds_read_b128 v[120:123], v2 offset:2048
    s_add_u32 m0, s44, 35840
    s_add_u32 s46, s40, 49152
    buffer_load_dwordx4 v6, s[12:15], s46 offen lds
    v_mfma_f32_16x16x32_bf16 v[24:27], v[160:163], v[84:87], v[24:27]
    ds_read_b64_tr_b16 v[60:61], v12 offset:4096
    ds_read_b64_tr_b16 v[62:63], v12 offset:4608
    s_add_u32 m0, s45, 114688
    s_add_u32 s46, s41, 2048
    buffer_load_dwordx4 v8, s[16:19], s46 offen lds
    v_mfma_f32_16x16x32_bf16 v[40:43], v[160:163], v[92:95], v[40:43]
    ds_read_b128 v[128:131], v3 offset:0
    s_add_u32 m0, s43, 114688
    s_add_u32 s46, s41, 2048
    buffer_load_dwordx4 v9, s[16:19], s46 offen lds
    v_mfma_f32_16x16x32_bf16 v[28:31], v[72:75], v[84:87], v[28:31]
    ds_read_b64_tr_b16 v[132:133], v13 offset:4096
    ds_read_b64_tr_b16 v[134:135], v13 offset:4608
    s_add_u32 m0, s45, 122880
    s_add_u32 s46, s41, 4096
    buffer_load_dwordx4 v8, s[16:19], s46 offen lds
    v_mfma_f32_16x16x32_bf16 v[44:47], v[72:75], v[92:95], v[44:47]
    ds_read_b128 v[136:139], v3 offset:2048
    s_add_u32 m0, s43, 122880
    s_add_u32 s46, s41, 4096
    buffer_load_dwordx4 v9, s[16:19], s46 offen lds
    v_mfma_f32_16x16x32_bf16 v[16:19], v[48:51], v[100:103], v[16:19]
    s_bfe_u32 s40, s94, 0x4001c
    s_add_u32 s40, s89, s40
    s_and_b32 s40, s40, 15
    s_mul_i32 s41, s40, 393216
    s_lshl_b32 s40, s40, 7
    s_add_u32 s40, s40, s36
    s_add_u32 s42, s41, s47
    s_add_u32 s41, s41, s38
    s_add_u32 m0, s44, 49152
    s_add_u32 s46, s40, 0
    buffer_load_dwordx4 v5, s[12:15], s46 offen lds
    v_mfma_f32_16x16x32_bf16 v[32:35], v[48:51], v[108:111], v[32:35]
    s_add_u32 m0, s44, 50176
    s_add_u32 s46, s40, 16384
    buffer_load_dwordx4 v6, s[12:15], s46 offen lds
    v_mfma_f32_16x16x32_bf16 v[20:23], v[88:91], v[100:103], v[20:23]
    v_mfma_f32_16x16x32_bf16 v[36:39], v[88:91], v[108:111], v[36:39]
    v_mfma_f32_16x16x32_bf16 v[24:27], v[52:55], v[100:103], v[24:27]
    v_mfma_f32_16x16x32_bf16 v[40:43], v[52:55], v[108:111], v[40:43]
    v_mfma_f32_16x16x32_bf16 v[28:31], v[96:99], v[100:103], v[28:31]
    v_mfma_f32_16x16x32_bf16 v[44:47], v[96:99], v[108:111], v[44:47]
    s_waitcnt vmcnt(10) lgkmcnt(0)
    s_barrier
    s_add_u32 m0, s44, 51200
    s_add_u32 s46, s40, 32768
    buffer_load_dwordx4 v5, s[12:15], s46 offen lds
    v_mfma_f32_16x16x32_bf16 v[16:19], v[104:107], v[116:119], v[16:19]
    ds_read_b64_tr_b16 v[68:69], v10 offset:57344
    ds_read_b64_tr_b16 v[70:71], v10 offset:57856
    s_add_u32 m0, s44, 52224
    s_add_u32 s46, s40, 49152
    buffer_load_dwordx4 v6, s[12:15], s46 offen lds
    v_mfma_f32_16x16x32_bf16 v[32:35], v[104:107], v[124:127], v[32:35]
    ds_read_b128 v[140:143], v2 offset:16384
    s_add_u32 m0, s45, 65536
    s_add_u32 s46, s41, 2048
    buffer_load_dwordx4 v8, s[16:19], s46 offen lds
    v_mfma_f32_16x16x32_bf16 v[20:23], v[56:59], v[116:119], v[20:23]
    ds_read_b64_tr_b16 v[76:77], v11 offset:57344
    ds_read_b64_tr_b16 v[78:79], v11 offset:57856
    s_add_u32 m0, s43, 65536
    s_add_u32 s46, s41, 2048
    buffer_load_dwordx4 v9, s[16:19], s46 offen lds
    v_mfma_f32_16x16x32_bf16 v[36:39], v[56:59], v[124:127], v[36:39]
    ds_read_b128 v[144:147], v2 offset:18432
    s_add_u32 m0, s45, 131072
    s_add_u32 s46, s41, 4096
    buffer_load_dwordx4 v8, s[16:19], s46 offen lds
    v_mfma_f32_16x16x32_bf16 v[24:27], v[60:63], v[116:119], v[24:27]
    ds_read_b64_tr_b16 v[152:153], v12 offset:57344
    ds_read_b64_tr_b16 v[154:155], v12 offset:57856
    s_add_u32 m0, s43, 131072
    s_add_u32 s46, s41, 4096
    buffer_load_dwordx4 v9, s[16:19], s46 offen lds
    v_mfma_f32_16x16x32_bf16 v[40:43], v[60:63], v[124:127], v[40:43]
    ds_read_b128 v[160:163], v3 offset:16384
    s_bfe_u32 s40, s94, 0x40010
    s_add_u32 s40, s89, s40
    s_and_b32 s40, s40, 15
    s_mul_i32 s41, s40, 393216
    s_lshl_b32 s40, s40, 7
    s_add_u32 s40, s40, s36
    s_add_u32 s42, s41, s47
    s_add_u32 s41, s41, s38
    s_add_u32 m0, s45, 139264
    s_nop 0
    buffer_load_dwordx4 v8, s[16:19], s42 offen lds
    v_mfma_f32_16x16x32_bf16 v[28:31], v[132:135], v[116:119], v[28:31]
    ds_read_b64_tr_b16 v[84:85], v13 offset:57344
    ds_read_b64_tr_b16 v[86:87], v13 offset:57856
    s_add_u32 m0, s43, 139264
    s_nop 0
    buffer_load_dwordx4 v9, s[16:19], s42 offen lds
    v_mfma_f32_16x16x32_bf16 v[44:47], v[132:135], v[124:127], v[44:47]
    ds_read_b128 v[72:75], v3 offset:18432
    s_bfe_u32 s40, s95, 0x40000
    s_add_u32 s40, s89, s40
    s_and_b32 s40, s40, 15
    s_mul_i32 s41, s40, 393216
    s_lshl_b32 s40, s40, 7
    s_add_u32 s40, s40, s36
    s_add_u32 s42, s41, s47
    s_add_u32 s41, s41, s38
    s_add_u32 m0, s44, 0
    s_add_u32 s46, s40, 0
    buffer_load_dwordx4 v5, s[12:15], s46 offen lds
    s_add_u32 m0, s44, 1024
    s_add_u32 s46, s40, 16384
    buffer_load_dwordx4 v6, s[12:15], s46 offen lds
    s_add_u32 m0, s44, 2048
    s_add_u32 s46, s40, 32768
    buffer_load_dwordx4 v5, s[12:15], s46 offen lds
    s_waitcnt vmcnt(13) lgkmcnt(0)
    s_barrier
    s_add_u32 m0, s44, 3072
    s_add_u32 s46, s40, 49152
    buffer_load_dwordx4 v6, s[12:15], s46 offen lds
    v_mfma_f32_16x16x32_bf16 v[16:19], v[68:71], v[148:151], v[16:19]
    ds_read_b64_tr_b16 v[92:93], v10 offset:61440
    ds_read_b64_tr_b16 v[94:95], v10 offset:61952
    s_add_u32 m0, s45, 73728
    s_add_u32 s46, s41, 2048
    buffer_load_dwordx4 v8, s[16:19], s46 offen lds
    v_mfma_f32_16x16x32_bf16 v[32:35], v[68:71], v[156:159], v[32:35]
    ds_read_b128 v[48:51], v2 offset:32768
    s_add_u32 m0, s43, 73728
    s_add_u32 s46, s41, 2048
    buffer_load_dwordx4 v9, s[16:19], s46 offen lds
    v_mfma_f32_16x16x32_bf16 v[20:23], v[76:79], v[148:151], v[20:23]
    ds_read_b64_tr_b16 v[88:89], v11 offset:61440
    ds_read_b64_tr_b16 v[90:91], v11 offset:61952
    s_add_u32 m0, s45, 81920
    s_add_u32 s46, s41, 4096
    buffer_load_dwordx4 v8, s[16:19], s46 offen lds
    v_mfma_f32_16x16x32_bf16 v[36:39], v[76:79], v[156:159], v[36:39]
    ds_read_b128 v[52:55], v2 offset:34816
    s_add_u32 m0, s43, 81920
    s_add_u32 s46, s41, 4096
    buffer_load_dwordx4 v9, s[16:19], s46 offen lds
    v_mfma_f32_16x16x32_bf16 v[24:27], v[152:155], v[148:151], v[24:27]
    ds_read_b64_tr_b16 v[100:101], v12 offset:61440
    ds_read_b64_tr_b16 v[102:103], v12 offset:61952
    s_bfe_u32 s40, s95, 0x40004
    s_add_u32 s40, s89, s40
    s_and_b32 s40, s40, 15
    s_mul_i32 s41, s40, 393216
    s_lshl_b32 s40, s40, 7
    s_add_u32 s40, s40, s36
    s_add_u32 s42, s41, s47
    s_add_u32 s41, s41, s38
    s_add_u32 m0, s44, 16384
    s_add_u32 s46, s40, 0
    buffer_load_dwordx4 v5, s[12:15], s46 offen lds
    v_mfma_f32_16x16x32_bf16 v[40:43], v[152:155], v[156:159], v[40:43]
    ds_read_b128 v[96:99], v3 offset:32768
    s_add_u32 m0, s44, 17408
    s_add_u32 s46, s40, 16384
    buffer_load_dwordx4 v6, s[12:15], s46 offen lds
    v_mfma_f32_16x16x32_bf16 v[28:31], v[84:87], v[148:151], v[28:31]
    ds_read_b64_tr_b16 v[108:109], v13 offset:61440
    ds_read_b64_tr_b16 v[110:111], v13 offset:61952
    s_add_u32 m0, s44, 18432
    s_add_u32 s46, s40, 32768
    buffer_load_dwordx4 v5, s[12:15], s46 offen lds
    v_mfma_f32_16x16x32_bf16 v[44:47], v[84:87], v[156:159], v[44:47]
    ds_read_b128 v[104:107], v3 offset:34816
    s_add_u32 m0, s44, 19456
    s_add_u32 s46, s40, 49152
    buffer_load_dwordx4 v6, s[12:15], s46 offen lds
    s_add_u32 m0, s45, 90112
    s_add_u32 s46, s41, 2048
    buffer_load_dwordx4 v8, s[16:19], s46 offen lds
    s_add_u32 m0, s43, 90112
    s_add_u32 s46, s41, 2048
    buffer_load_dwordx4 v9, s[16:19], s46 offen lds
    s_waitcnt vmcnt(14) lgkmcnt(0)
    s_barrier
    s_add_u32 m0, s45, 98304
    s_add_u32 s46, s41, 4096
    buffer_load_dwordx4 v8, s[16:19], s46 offen lds
    v_mfma_f32_16x16x32_bf16 v[16:19], v[92:95], v[64:67], v[16:19]
    ds_read_b64_tr_b16 v[56:57], v10 offset:49152
    ds_read_b64_tr_b16 v[58:59], v10 offset:49664
    s_add_u32 m0, s43, 98304
    s_add_u32 s46, s41, 4096
    buffer_load_dwordx4 v9, s[16:19], s46 offen lds
    v_mfma_f32_16x16x32_bf16 v[32:35], v[92:95], v[80:83], v[32:35]
    ds_read_b128 v[60:63], v2 offset:49152
    s_bfe_u32 s40, s94, 0x40014
    s_add_u32 s40, s89, s40
    s_and_b32 s40, s40, 15
    s_mul_i32 s41, s40, 393216
    s_lshl_b32 s40, s40, 7
    s_add_u32 s40, s40, s36
    s_add_u32 s42, s41, s47
    s_add_u32 s41, s41, s38
    s_add_u32 m0, s45, 106496
    s_nop 0
    buffer_load_dwordx4 v8, s[16:19], s42 offen lds
    v_mfma_f32_16x16x32_bf16 v[20:23], v[88:91], v[64:67], v[20:23]
    ds_read_b64_tr_b16 v[116:117], v11 offset:49152
    ds_read_b64_tr_b16 v[118:119], v11 offset:49664
    s_add_u32 m0, s43, 106496
    s_nop 0
    buffer_load_dwordx4 v9, s[16:19], s42 offen lds
    v_mfma_f32_16x16x32_bf16 v[36:39], v[88:91], v[80:83], v[36:39]
    ds_read_b128 v[132:135], v2 offset:51200
    s_bfe_u32 s40, s95, 0x40008
    s_add_u32 s40, s89, s40
    s_and_b32 s40, s40, 15
    s_mul_i32 s41, s40, 393216
    s_lshl_b32 s40, s40, 7
    s_add_u32 s40, s40, s36
    s_add_u32 s42, s41, s47
    s_add_u32 s41, s41, s38
    s_add_u32 m0, s44, 32768
    s_add_u32 s46, s40, 0
    buffer_load_dwordx4 v5, s[12:15], s46 offen lds
    v_mfma_f32_16x16x32_bf16 v[24:27], v[100:103], v[64:67], v[24:27]
    ds_read_b64_tr_b16 v[124:125], v12 offset:49152
    ds_read_b64_tr_b16 v[126:127], v12 offset:49664
    s_add_u32 m0, s44, 33792
    s_add_u32 s46, s40, 16384
    buffer_load_dwordx4 v6, s[12:15], s46 offen lds
    v_mfma_f32_16x16x32_bf16 v[40:43], v[100:103], v[80:83], v[40:43]
    ds_read_b128 v[68:71], v3 offset:49152
    s_add_u32 m0, s44, 34816
    s_add_u32 s46, s40, 32768
    buffer_load_dwordx4 v5, s[12:15], s46 offen lds
    v_mfma_f32_16x16x32_bf16 v[28:31], v[108:111], v[64:67], v[28:31]
    ds_read_b64_tr_b16 v[76:77], v13 offset:49152
    ds_read_b64_tr_b16 v[78:79], v13 offset:49664
    s_add_u32 m0, s44, 35840
    s_add_u32 s46, s40, 49152
    buffer_load_dwordx4 v6, s[12:15], s46 offen lds
    v_mfma_f32_16x16x32_bf16 v[44:47], v[108:111], v[80:83], v[44:47]
    ds_read_b128 v[152:155], v3 offset:51200
    s_add_u32 m0, s45, 114688
    s_add_u32 s46, s41, 2048
    buffer_load_dwordx4 v8, s[16:19], s46 offen lds
    s_add_u32 m0, s43, 114688
    s_add_u32 s46, s41, 2048
    buffer_load_dwordx4 v9, s[16:19], s46 offen lds
    s_add_u32 m0, s45, 122880
    s_add_u32 s46, s41, 4096
    buffer_load_dwordx4 v8, s[16:19], s46 offen lds
    s_waitcnt vmcnt(17) lgkmcnt(0)
    s_barrier
    s_add_u32 m0, s43, 122880
    s_add_u32 s46, s41, 4096
    buffer_load_dwordx4 v9, s[16:19], s46 offen lds
    v_mfma_f32_16x16x32_bf16 v[16:19], v[56:59], v[112:115], v[16:19]
    ds_read_b64_tr_b16 v[148:149], v10 offset:53248
    ds_read_b64_tr_b16 v[150:151], v10 offset:53760
    s_bfe_u32 s40, s95, 0x4000c
    s_add_u32 s40, s89, s40
    s_and_b32 s40, s40, 15
    s_mul_i32 s41, s40, 393216
    s_lshl_b32 s40, s40, 7
    s_add_u32 s40, s40, s36
    s_add_u32 s42, s41, s47
    s_add_u32 s41, s41, s38
    s_add_u32 m0, s44, 49152
    s_add_u32 s46, s40, 0
    buffer_load_dwordx4 v5, s[12:15], s46 offen lds
    v_mfma_f32_16x16x32_bf16 v[32:35], v[56:59], v[120:123], v[32:35]
    ds_read_b128 v[84:87], v2 offset:0
    s_add_u32 m0, s44, 50176
    s_add_u32 s46, s40, 16384
    buffer_load_dwordx4 v6, s[12:15], s46 offen lds
    v_mfma_f32_16x16x32_bf16 v[20:23], v[116:119], v[112:115], v[20:23]
    ds_read_b64_tr_b16 v[156:157], v11 offset:53248
    ds_read_b64_tr_b16 v[158:159], v11 offset:53760
    s_add_u32 m0, s44, 51200
    s_add_u32 s46, s40, 32768
    buffer_load_dwordx4 v5, s[12:15], s46 offen lds
    v_mfma_f32_16x16x32_bf16 v[36:39], v[116:119], v[120:123], v[36:39]
    ds_read_b128 v[92:95], v2 offset:2048
    s_add_u32 m0, s44, 52224
    s_add_u32 s46, s40, 49152
    buffer_load_dwordx4 v6, s[12:15], s46 offen lds
    v_mfma_f32_16x16x32_bf16 v[24:27], v[124:127], v[112:115], v[24:27]
    ds_read_b64_tr_b16 v[88:89], v12 offset:53248
    ds_read_b64_tr_b16 v[90:91], v12 offset:53760
    s_add_u32 m0, s45, 65536
    s_add_u32 s46, s41, 2048
    buffer_load_dwordx4 v8, s[16:19], s46 offen lds
    v_mfma_f32_16x16x32_bf16 v[40:43], v[124:127], v[120:123], v[40:43]
    ds_read_b128 v[100:103], v3 offset:0
    s_add_u32 m0, s43, 65536
    s_add_u32 s46, s41, 2048
    buffer_load_dwordx4 v9, s[16:19], s46 offen lds
    v_mfma_f32_16x16x32_bf16 v[28:31], v[76:79], v[112:115], v[28:31]
    ds_read_b64_tr_b16 v[64:65], v13 offset:53248
    ds_read_b64_tr_b16 v[66:67], v13 offset:53760
    s_add_u32 m0, s45, 131072
    s_add_u32 s46, s41, 4096
    buffer_load_dwordx4 v8, s[16:19], s46 offen lds
    v_mfma_f32_16x16x32_bf16 v[44:47], v[76:79], v[120:123], v[44:47]
    ds_read_b128 v[108:111], v3 offset:2048
    s_add_u32 m0, s43, 131072
    s_add_u32 s46, s41, 4096
    buffer_load_dwordx4 v9, s[16:19], s46 offen lds
    s_waitcnt vmcnt(16) lgkmcnt(0)
    s_barrier
    s_bfe_u32 s40, s95, 0x40010
    s_add_u32 s40, s89, s40
    s_and_b32 s40, s40, 15
    s_mul_i32 s41, s40, 393216
    s_lshl_b32 s40, s40, 7
    s_add_u32 s40, s40, s36
    s_add_u32 s42, s41, s47
    s_add_u32 s41, s41, s38
    s_add_u32 m0, s44, 0
    s_add_u32 s46, s40, 0
    buffer_load_dwordx4 v5, s[12:15], s46 offen lds
    v_mfma_f32_16x16x32_bf16 v[16:19], v[148:151], v[128:131], v[16:19]
    ds_read_b64_tr_b16 v[80:81], v10 offset:16384
    ds_read_b64_tr_b16 v[82:83], v10 offset:16896
    s_add_u32 m0, s44, 1024
    s_add_u32 s46, s40, 16384
    buffer_load_dwordx4 v6, s[12:15], s46 offen lds
    v_mfma_f32_16x16x32_bf16 v[32:35], v[148:151], v[136:139], v[32:35]
    ds_read_b128 v[56:59], v2 offset:16384
    s_add_u32 m0, s44, 2048
    s_add_u32 s46, s40, 32768
    buffer_load_dwordx4 v5, s[12:15], s46 offen lds
    v_mfma_f32_16x16x32_bf16 v[20:23], v[156:159], v[128:131], v[20:23]
    ds_read_b64_tr_b16 v[116:117], v11 offset:16384
    ds_read_b64_tr_b16 v[118:119], v11 offset:16896
    s_add_u32 m0, s44, 3072
    s_add_u32 s46, s40, 49152
    buffer_load_dwordx4 v6, s[12:15], s46 offen lds
    v_mfma_f32_16x16x32_bf16 v[36:39], v[156:159], v[136:139], v[36:39]
    ds_read_b128 v[124:127], v2 offset:18432
    s_add_u32 m0, s45, 73728
    s_add_u32 s46, s41, 2048
    buffer_load_dwordx4 v8, s[16:19], s46 offen lds
    v_mfma_f32_16x16x32_bf16 v[24:27], v[88:91], v[128:131], v[24:27]
    ds_read_b64_tr_b16 v[112:113], v12 offset:16384
    ds_read_b64_tr_b16 v[114:115], v12 offset:16896
    s_add_u32 m0, s43, 73728
    s_add_u32 s46, s41, 2048
    buffer_load_dwordx4 v9, s[16:19], s46 offen lds
    v_mfma_f32_16x16x32_bf16 v[40:43], v[88:91], v[136:139], v[40:43]
    ds_read_b128 v[76:79], v3 offset:16384
    s_add_u32 m0, s45, 81920
    s_add_u32 s46, s41, 4096
    buffer_load_dwordx4 v8, s[16:19], s46 offen lds
    v_mfma_f32_16x16x32_bf16 v[28:31], v[64:67], v[128:131], v[28:31]
    ds_read_b64_tr_b16 v[120:121], v13 offset:16384
    ds_read_b64_tr_b16 v[122:123], v13 offset:16896
    s_add_u32 m0, s43, 81920
    s_add_u32 s46, s41, 4096
    buffer_load_dwordx4 v9, s[16:19], s46 offen lds
    v_mfma_f32_16x16x32_bf16 v[44:47], v[64:67], v[136:139], v[44:47]
    ds_read_b128 v[148:151], v3 offset:18432
    s_waitcnt vmcnt(16) lgkmcnt(0)
    s_barrier
    s_bfe_u32 s40, s95, 0x40014
    s_add_u32 s40, s89, s40
    s_and_b32 s40, s40, 15
    s_mul_i32 s41, s40, 393216
    s_lshl_b32 s40, s40, 7
    s_add_u32 s40, s40, s36
    s_add_u32 s42, s41, s47
    s_add_u32 s41, s41, s38
    s_add_u32 m0, s44, 16384
    s_add_u32 s46, s40, 0
    buffer_load_dwordx4 v5, s[12:15], s46 offen lds
    v_mfma_f32_16x16x32_bf16 v[16:19], v[80:83], v[140:143], v[16:19]
    ds_read_b64_tr_b16 v[156:157], v10 offset:20480
    ds_read_b64_tr_b16 v[158:159], v10 offset:20992
    s_add_u32 m0, s44, 17408
    s_add_u32 s46, s40, 16384
    buffer_load_dwordx4 v6, s[12:15], s46 offen lds
    v_mfma_f32_16x16x32_bf16 v[32:35], v[80:83], v[144:147], v[32:35]
    ds_read_b128 v[88:91], v2 offset:32768
    s_add_u32 m0, s44, 18432
    s_add_u32 s46, s40, 32768
    buffer_load_dwordx4 v5, s[12:15], s46 offen lds
    v_mfma_f32_16x16x32_bf16 v[20:23], v[116:119], v[140:143], v[20:23]
    ds_read_b64_tr_b16 v[128:129], v11 offset:20480
    ds_read_b64_tr_b16 v[130:131], v11 offset:20992
    s_add_u32 m0, s44, 19456
    s_add_u32 s46, s40, 49152
    buffer_load_dwordx4 v6, s[12:15], s46 offen lds
    v_mfma_f32_16x16x32_bf16 v[36:39], v[116:119], v[144:147], v[36:39]
    ds_read_b128 v[64:67], v2 offset:34816
    s_add_u32 m0, s45, 90112
    s_add_u32 s46, s41, 2048
    buffer_load_dwordx4 v8, s[16:19], s46 offen lds
    v_mfma_f32_16x16x32_bf16 v[24:27], v[112:115], v[140:143], v[24:27]
    ds_read_b64_tr_b16 v[136:137], v12 offset:20480
    ds_read_b64_tr_b16 v[138:139], v12 offset:20992
    s_add_u32 m0, s43, 90112
    s_add_u32 s46, s41, 2048
    buffer_load_dwordx4 v9, s[16:19], s46 offen lds
    v_mfma_f32_16x16x32_bf16 v[40:43], v[112:115], v[144:147], v[40:43]
    ds_read_b128 v[80:83], v3 offset:32768
    s_add_u32 m0, s45, 98304
    s_add_u32 s46, s41, 4096
    buffer_load_dwordx4 v8, s[16:19], s46 offen lds
    v_mfma_f32_16x16x32_bf16 v[28:31], v[120:123], v[140:143], v[28:31]
    ds_read_b64_tr_b16 v[116:117], v13 offset:20480
    ds_read_b64_tr_b16 v[118:119], v13 offset:20992
    s_add_u32 m0, s43, 98304
    s_add_u32 s46, s41, 4096
    buffer_load_dwordx4 v9, s[16:19], s46 offen lds
    v_mfma_f32_16x16x32_bf16 v[44:47], v[120:123], v[144:147], v[44:47]
    ds_read_b128 v[112:115], v3 offset:34816
    s_waitcnt vmcnt(16) lgkmcnt(0)
    s_barrier
    s_bfe_u32 s40, s95, 0x40018
    s_add_u32 s40, s89, s40
    s_and_b32 s40, s40, 15
    s_mul_i32 s41, s40, 393216
    s_lshl_b32 s40, s40, 7
    s_add_u32 s40, s40, s36
    s_add_u32 s42, s41, s47
    s_add_u32 s41, s41, s38
    s_add_u32 m0, s44, 32768
    s_add_u32 s46, s40, 0
    buffer_load_dwordx4 v5, s[12:15], s46 offen lds
    v_mfma_f32_16x16x32_bf16 v[16:19], v[156:159], v[160:163], v[16:19]
    ds_read_b128 v[140:143], v2 offset:49152
    s_add_u32 m0, s44, 33792
    s_add_u32 s46, s40, 16384
    buffer_load_dwordx4 v6, s[12:15], s46 offen lds
    v_mfma_f32_16x16x32_bf16 v[32:35], v[156:159], v[72:75], v[32:35]
    ds_read_b128 v[120:123], v2 offset:51200
    s_add_u32 m0, s44, 34816
    s_add_u32 s46, s40, 32768
    buffer_load_dwordx4 v5, s[12:15], s46 offen lds
    v_mfma_f32_16x16x32_bf16 v[20:23], v[128:131], v[160:163], v[20:23]
    ds_read_b128 v[144:147], v3 offset:49152
    s_add_u32 m0, s44, 35840
    s_add_u32 s46, s40, 49152
    buffer_load_dwordx4 v6, s[12:15], s46 offen lds
    v_mfma_f32_16x16x32_bf16 v[36:39], v[128:131], v[72:75], v[36:39]
    ds_read_b128 v[156:159], v3 offset:51200
    s_add_u32 m0, s45, 106496
    s_add_u32 s46, s41, 2048
    buffer_load_dwordx4 v8, s[16:19], s46 offen lds
    v_mfma_f32_16x16x32_bf16 v[24:27], v[136:139], v[160:163], v[24:27]
    s_add_u32 m0, s43, 106496
    s_add_u32 s46, s41, 2048
    buffer_load_dwordx4 v9, s[16:19], s46 offen lds
    v_mfma_f32_16x16x32_bf16 v[40:43], v[136:139], v[72:75], v[40:43]
    s_add_u32 m0, s45, 114688
    s_add_u32 s46, s41, 4096
    buffer_load_dwordx4 v8, s[16:19], s46 offen lds
    v_mfma_f32_16x16x32_bf16 v[28:31], v[116:119], v[160:163], v[28:31]
    s_add_u32 m0, s43, 114688
    s_add_u32 s46, s41, 4096
    buffer_load_dwordx4 v9, s[16:19], s46 offen lds
    v_mfma_f32_16x16x32_bf16 v[44:47], v[116:119], v[72:75], v[44:47]
    s_waitcnt vmcnt(16) lgkmcnt(0)
    s_barrier
    s_bfe_u32 s40, s95, 0x4001c
    s_add_u32 s40, s89, s40
    s_and_b32 s40, s40, 15
    s_mul_i32 s41, s40, 393216
    s_lshl_b32 s40, s40, 7
    s_add_u32 s40, s40, s36
    s_add_u32 s42, s41, s47
    s_add_u32 s41, s41, s38
    s_add_u32 m0, s44, 49152
    s_add_u32 s46, s40, 0
    buffer_load_dwordx4 v5, s[12:15], s46 offen lds
    s_add_u32 m0, s44, 50176
    s_add_u32 s46, s40, 16384
    buffer_load_dwordx4 v6, s[12:15], s46 offen lds
    s_add_u32 m0, s44, 51200
    s_add_u32 s46, s40, 32768
    buffer_load_dwordx4 v5, s[12:15], s46 offen lds
    s_add_u32 m0, s44, 52224
    s_add_u32 s46, s40, 49152
    buffer_load_dwordx4 v6, s[12:15], s46 offen lds
    s_add_u32 m0, s45, 65536
    s_add_u32 s46, s41, 2048
    buffer_load_dwordx4 v8, s[16:19], s46 offen lds
    s_add_u32 m0, s43, 65536
    s_add_u32 s46, s41, 2048
    buffer_load_dwordx4 v9, s[16:19], s46 offen lds
    s_add_u32 m0, s45, 122880
    s_add_u32 s46, s41, 4096
    buffer_load_dwordx4 v8, s[16:19], s46 offen lds
    s_add_u32 m0, s43, 122880
    s_add_u32 s46, s41, 4096
    buffer_load_dwordx4 v9, s[16:19], s46 offen lds
    s_waitcnt vmcnt(16)
    s_barrier
    s_bfe_u32 s40, s94, 0x40018
    s_add_u32 s40, s89, s40
    s_and_b32 s40, s40, 15
    s_mul_i32 s41, s40, 393216
    s_lshl_b32 s40, s40, 7
    s_add_u32 s40, s40, s36
    s_add_u32 s42, s41, s47
    s_add_u32 s41, s41, s38
    s_add_u32 m0, s45, 147456
    s_nop 0
    buffer_load_dwordx4 v8, s[16:19], s42 offen lds
    s_add_u32 m0, s43, 147456
    s_nop 0
    buffer_load_dwordx4 v9, s[16:19], s42 offen lds
    s_waitcnt vmcnt(10)
    s_barrier
    s_bfe_u32 s40, s95, 0x40010
    s_add_u32 s40, s89, s40
    s_and_b32 s40, s40, 15
    s_mul_i32 s41, s40, 393216
    s_lshl_b32 s40, s40, 7
    s_add_u32 s40, s40, s36
    s_add_u32 s42, s41, s47
    s_add_u32 s41, s41, s38
    s_add_u32 m0, s45, 139264
    s_nop 0
    buffer_load_dwordx4 v8, s[16:19], s42 offen lds
    s_add_u32 m0, s43, 139264
    s_nop 0
    buffer_load_dwordx4 v9, s[16:19], s42 offen lds
    s_waitcnt vmcnt(4)
    s_barrier
    s_bfe_u32 s40, s95, 0x40014
    s_add_u32 s40, s89, s40
    s_and_b32 s40, s40, 15
    s_mul_i32 s41, s40, 393216
    s_lshl_b32 s40, s40, 7
    s_add_u32 s40, s40, s36
    s_add_u32 s42, s41, s47
    s_add_u32 s41, s41, s38
    s_add_u32 m0, s45, 131072
    s_nop 0
    buffer_load_dwordx4 v8, s[16:19], s42 offen lds
    s_add_u32 m0, s43, 131072
    s_nop 0
    buffer_load_dwordx4 v9, s[16:19], s42 offen lds
    s_setprio 1
    v_and_b32 v14, 15, v0
    v_lshlrev_b32 v14, 2, v14
    s_lshl_b32 s50, s3, 7
    s_add_u32 s50, s50, 155648
    v_add_u32 v14, s50, v14
    v_and_b32 v15, 0x30, v0
    v_add_u32 v15, 158208, v15
    v_and_b32 v165, 0xfffffff7, v1

    ds_read_b32 v7, v165 offset:48
FW_1:
    s_waitcnt lgkmcnt(0)
    v_cmp_gt_u32 vcc, 1, v7
    s_cbranch_vccz FO_2
    s_sleep 1
    ds_read_b32 v7, v165 offset:48
    s_branch FW_1
FO_2:
    ds_read2_b32 v[72:73], v14 offset0:0 offset1:0
    ds_read2_b32 v[74:75], v14 offset0:16 offset1:16
    ds_read_b128 v[128:131], v15 offset:0
    ds_read_b128 v[136:139], v15 offset:64
    ds_read_b128 v[160:163], v15 offset:128
    ds_read_b128 v[116:119], v15 offset:192
    v_add_u32 v14, 1024, v14
    s_waitcnt lgkmcnt(3)
    v_fmac_f32 v16, v128, v72
    v_fmac_f32 v17, v129, v72
    v_fmac_f32 v18, v130, v72
    v_fmac_f32 v19, v131, v72
    v_fmac_f32 v32, v128, v74
    s_branch IW_s1
IW_w1:
    s_branch IW_r1
IW_s1:
    v_fmac_f32 v33, v129, v74
    v_fmac_f32 v34, v130, v74
    v_fmac_f32 v35, v131, v74
    s_waitcnt lgkmcnt(2)
    v_fmac_f32 v20, v136, v72
    v_fmac_f32 v21, v137, v72
    v_fmac_f32 v22, v138, v72
    v_fmac_f32 v23, v139, v72
    v_fmac_f32 v36, v136, v74
    v_fmac_f32 v37, v137, v74
    v_fmac_f32 v38, v138, v74
    v_fmac_f32 v39, v139, v74
    s_waitcnt lgkmcnt(1)
    v_fmac_f32 v24, v160, v72
    v_fmac_f32 v25, v161, v72
    v_fmac_f32 v26, v162, v72
    v_fmac_f32 v27, v163, v72
    v_fmac_f32 v40, v160, v74
    v_fmac_f32 v41, v161, v74
    v_fmac_f32 v42, v162, v74
    v_fmac_f32 v43, v163, v74
    s_waitcnt lgkmcnt(0)
    v_fmac_f32 v28, v116, v72
    v_fmac_f32 v29, v117, v72
    v_fmac_f32 v30, v118, v72
    v_fmac_f32 v31, v119, v72
    v_fmac_f32 v44, v116, v74
    v_fmac_f32 v45, v117, v74
    v_fmac_f32 v46, v118, v74
    v_fmac_f32 v47, v119, v74
    s_setprio 3
    s_waitcnt vmcnt(6)
    s_barrier
    s_bfe_u32 s40, s95, 0x40018
    s_add_u32 s40, s89, s40
    s_and_b32 s40, s40, 15
    s_mul_i32 s41, s40, 393216
    s_lshl_b32 s40, s40, 7
    s_add_u32 s40, s40, s36
    s_add_u32 s42, s41, s47
    s_add_u32 s41, s41, s38
    s_add_u32 m0, s45, 81920
    s_nop 0
    buffer_load_dwordx4 v8, s[16:19], s42 offen lds
    s_add_u32 m0, s43, 81920
    s_nop 0
    buffer_load_dwordx4 v9, s[16:19], s42 offen lds
    s_bfe_u32 s40, s95, 0x4001c
    s_add_u32 s40, s89, s40
    s_and_b32 s40, s40, 15
    s_mul_i32 s41, s40, 393216
    s_lshl_b32 s40, s40, 7
    s_add_u32 s40, s40, s36
    s_add_u32 s42, s41, s47
    s_add_u32 s41, s41, s38
    s_add_u32 m0, s45, 73728
    s_nop 0
    buffer_load_dwordx4 v8, s[16:19], s42 offen lds
    s_add_u32 m0, s43, 73728
    s_nop 0
    buffer_load_dwordx4 v9, s[16:19], s42 offen lds
    s_bfe_u32 s40, s94, 0x4001c
    s_add_u32 s40, s89, s40
    s_and_b32 s40, s40, 15
    s_mul_i32 s41, s40, 393216
    s_lshl_b32 s40, s40, 7
    s_add_u32 s40, s40, s36
    s_add_u32 s42, s41, s47
    s_add_u32 s41, s41, s38
    s_add_u32 m0, s45, 98304
    s_nop 0
    buffer_load_dwordx4 v8, s[16:19], s42 offen lds
    s_add_u32 m0, s43, 98304
    s_nop 0
    buffer_load_dwordx4 v9, s[16:19], s42 offen lds
    s_bfe_u32 s40, s95, 0x40000
    s_add_u32 s40, s89, s40
    s_and_b32 s40, s40, 15
    s_mul_i32 s41, s40, 393216
    s_lshl_b32 s40, s40, 7
    s_add_u32 s40, s40, s36
    s_add_u32 s42, s41, s47
    s_add_u32 s41, s41, s38
    s_add_u32 m0, s45, 90112
    s_nop 0
    buffer_load_dwordx4 v8, s[16:19], s42 offen lds
    s_add_u32 m0, s43, 90112
    s_nop 0
    buffer_load_dwordx4 v9, s[16:19], s42 offen lds
    s_bfe_u32 s40, s95, 0x40004
    s_add_u32 s40, s89, s40
    s_and_b32 s40, s40, 15
    s_mul_i32 s41, s40, 393216
    s_lshl_b32 s40, s40, 7
    s_add_u32 s40, s40, s36
    s_add_u32 s42, s41, s47
    s_add_u32 s41, s41, s38
    s_add_u32 m0, s45, 114688
    s_nop 0
    buffer_load_dwordx4 v8, s[16:19], s42 offen lds
    s_add_u32 m0, s43, 114688
    s_nop 0
    buffer_load_dwordx4 v9, s[16:19], s42 offen lds
    s_bfe_u32 s40, s95, 0x40008
    s_add_u32 s40, s89, s40
    s_and_b32 s40, s40, 15
    s_mul_i32 s41, s40, 393216
    s_lshl_b32 s40, s40, 7
    s_add_u32 s40, s40, s36
    s_add_u32 s42, s41, s47
    s_add_u32 s41, s41, s38
    s_add_u32 m0, s45, 106496
    s_nop 0
    buffer_load_dwordx4 v8, s[16:19], s42 offen lds
    s_add_u32 m0, s43, 106496
    s_nop 0
    buffer_load_dwordx4 v9, s[16:19], s42 offen lds
    s_bfe_u32 s40, s95, 0x4000c
    s_add_u32 s40, s89, s40
    s_and_b32 s40, s40, 15
    s_mul_i32 s41, s40, 393216
    s_lshl_b32 s40, s40, 7
    s_add_u32 s40, s40, s36
    s_add_u32 s42, s41, s47
    s_add_u32 s41, s41, s38
    s_add_u32 m0, s45, 122880
    s_nop 0
    buffer_load_dwordx4 v8, s[16:19], s42 offen lds
    s_add_u32 m0, s43, 122880
    s_nop 0
    buffer_load_dwordx4 v9, s[16:19], s42 offen lds
    s_setprio 2
    v_subrev_u32 v5, 24576, v10
    v_subrev_u32 v6, 24576, v11
    v_subrev_u32 v8, 24576, v12
    v_subrev_u32 v9, 24576, v13
    s_add_u32 s16, s72, 0x400000
    s_addc_u32 s17, s73, 0
    s_mov_b32 s18, 0x400000
    s_mov_b32 s19, 0x00020000
    s_add_u32 s24, s72, 0x800000
    s_addc_u32 s25, s73, 0
    s_mov_b32 s26, 0x48000
    s_mov_b32 s27, 0x00020000
    s_mov_b32 s40, 0x21317218
    s_mov_b32 s41, s40
    s_mov_b32 s74, 0x358637bd
    s_mov_b32 s75, s74
    s_mov_b32 s76, 0x5d800000
    s_mov_b32 s77, s76
    s_lshl_b32 s79, s32, 18
    s_lshl_b32 s80, s3, 16
    s_add_u32 s79, s79, s80
    s_lshl_b32 s80, s10, 11
    s_add_u32 s79, s79, s80
    s_add_u32 s80, s79, 0x8000
    s_lshl_b32 s45, s32, 2
    s_add_u32 s45, s45, s3
    s_lshl_b32 s45, s45, 10
    s_mov_b32 s46, 0x3fb8aa3b

    s_add_u32 s54, s45, 0x835000
    s_add_u32 s54, s72, s54
    s_addc_u32 s55, s73, 0
    s_waitcnt vmcnt(8)
    s_mov_b64 exec, 1
    ds_add_u32 v4, v164 offset:112
    s_mov_b64 exec, -1
    ds_read_b32 v7, v1 offset:32
FW_3:
    s_waitcnt lgkmcnt(0)
    v_cmp_gt_u32 vcc, 1, v7
    s_cbranch_vccz FO_4
    s_sleep 2
    ds_read_b32 v7, v1 offset:32
    s_branch FW_3
FO_4:
    ds_read_b32 v7, v1 offset:112
FW_5:
    s_waitcnt lgkmcnt(0)
    v_cmp_gt_u32 vcc, 1, v7
    s_cbranch_vccz FO_6
    ds_read_b32 v7, v1 offset:112
    s_branch FW_5
FO_6:
    ds_read_b64_tr_b16 v[128:129], v10 offset:57344
    ds_read_b64_tr_b16 v[130:131], v10 offset:57856
    ds_read_b64_tr_b16 v[136:137], v11 offset:57344
    ds_read_b64_tr_b16 v[138:139], v11 offset:57856
    ds_read_b64_tr_b16 v[160:161], v12 offset:57344
    ds_read_b64_tr_b16 v[162:163], v12 offset:57856
    ds_read_b64_tr_b16 v[116:117], v13 offset:57344
    ds_read_b64_tr_b16 v[118:119], v13 offset:57856
    ds_read_b64_tr_b16 v[72:73], v10 offset:61440
    ds_read_b64_tr_b16 v[74:75], v10 offset:61952
    s_waitcnt lgkmcnt(8)
    v_mfma_f32_16x16x32_bf16 v[16:19], v[128:131], v[48:51], v[16:19]
    v_mfma_f32_16x16x32_bf16 v[32:35], v[128:131], v[52:55], v[32:35]
    ds_read_b64_tr_b16 v[128:129], v11 offset:61440
    ds_read_b64_tr_b16 v[130:131], v11 offset:61952
    s_waitcnt lgkmcnt(8)
    v_mfma_f32_16x16x32_bf16 v[20:23], v[136:139], v[48:51], v[20:23]
    v_mfma_f32_16x16x32_bf16 v[36:39], v[136:139], v[52:55], v[36:39]
    ds_read_b64_tr_b16 v[136:137], v12 offset:61440
    ds_read_b64_tr_b16 v[138:139], v12 offset:61952
    s_waitcnt lgkmcnt(8)
    v_mfma_f32_16x16x32_bf16 v[24:27], v[160:163], v[48:51], v[24:27]
    v_mfma_f32_16x16x32_bf16 v[40:43], v[160:163], v[52:55], v[40:43]
    ds_read_b64_tr_b16 v[160:161], v13 offset:61440
    ds_read_b64_tr_b16 v[162:163], v13 offset:61952
    s_waitcnt lgkmcnt(8)
    v_mfma_f32_16x16x32_bf16 v[28:31], v[116:119], v[48:51], v[28:31]
    ds_read_b128 v[48:51], v2 offset:0
    v_mfma_f32_16x16x32_bf16 v[44:47], v[116:119], v[52:55], v[44:47]
    ds_read_b64_tr_b16 v[116:117], v10 offset:49152
    ds_read_b64_tr_b16 v[118:119], v10 offset:49664
    s_waitcnt lgkmcnt(9)
    v_mfma_f32_16x16x32_bf16 v[16:19], v[72:75], v[96:99], v[16:19]
    ds_read_b128 v[52:55], v2 offset:2048
    v_mfma_f32_16x16x32_bf16 v[32:35], v[72:75], v[104:107], v[32:35]
    ds_read_b64_tr_b16 v[72:73], v11 offset:49152
    ds_read_b64_tr_b16 v[74:75], v11 offset:49664
    s_waitcnt lgkmcnt(10)
    v_mfma_f32_16x16x32_bf16 v[20:23], v[128:131], v[96:99], v[20:23]
    v_mfma_f32_16x16x32_bf16 v[36:39], v[128:131], v[104:107], v[36:39]
    ds_read_b64_tr_b16 v[128:129], v12 offset:49152
    ds_read_b64_tr_b16 v[130:131], v12 offset:49664
    s_waitcnt lgkmcnt(10)
    v_mfma_f32_16x16x32_bf16 v[24:27], v[136:139], v[96:99], v[24:27]
    v_mfma_f32_16x16x32_bf16 v[40:43], v[136:139], v[104:107], v[40:43]
    ds_read_b64_tr_b16 v[136:137], v13 offset:49152
    ds_read_b64_tr_b16 v[138:139], v13 offset:49664
    s_waitcnt lgkmcnt(10)
    v_mfma_f32_16x16x32_bf16 v[28:31], v[160:163], v[96:99], v[28:31]
    ds_read_b128 v[96:99], v3 offset:0
    v_mfma_f32_16x16x32_bf16 v[44:47], v[160:163], v[104:107], v[44:47]
    ds_read_b64_tr_b16 v[160:161], v10 offset:53248
    ds_read_b64_tr_b16 v[162:163], v10 offset:53760
    s_waitcnt lgkmcnt(10)
    v_mfma_f32_16x16x32_bf16 v[16:19], v[116:119], v[48:51], v[16:19]
    ds_read_b128 v[104:107], v3 offset:2048
    s_waitcnt lgkmcnt(10)
    v_mfma_f32_16x16x32_bf16 v[32:35], v[116:119], v[52:55], v[32:35]
    ds_read_b64_tr_b16 v[116:117], v11 offset:53248
    ds_read_b64_tr_b16 v[118:119], v11 offset:53760
    s_waitcnt lgkmcnt(10)
    v_mfma_f32_16x16x32_bf16 v[20:23], v[72:75], v[48:51], v[20:23]
    v_mfma_f32_16x16x32_bf16 v[36:39], v[72:75], v[52:55], v[36:39]
    ds_read_b64_tr_b16 v[72:73], v12 offset:53248
    ds_read_b64_tr_b16 v[74:75], v12 offset:53760
    s_waitcnt lgkmcnt(10)
    v_mfma_f32_16x16x32_bf16 v[24:27], v[128:131], v[48:51], v[24:27]
    v_mfma_f32_16x16x32_bf16 v[40:43], v[128:131], v[52:55], v[40:43]
    ds_read_b64_tr_b16 v[128:129], v13 offset:53248
    ds_read_b64_tr_b16 v[130:131], v13 offset:53760
    s_waitcnt lgkmcnt(10)
    v_mfma_f32_16x16x32_bf16 v[28:31], v[136:139], v[48:51], v[28:31]
    ds_read_b128 v[48:51], v2 offset:16384
    v_mfma_f32_16x16x32_bf16 v[44:47], v[136:139], v[52:55], v[44:47]
    ds_read_b64_tr_b16 v[136:137], v10 offset:40960
    ds_read_b64_tr_b16 v[138:139], v10 offset:41472
    s_waitcnt lgkmcnt(10)
    v_mfma_f32_16x16x32_bf16 v[16:19], v[160:163], v[96:99], v[16:19]
    ds_read_b128 v[52:55], v2 offset:18432
    s_waitcnt lgkmcnt(10)
    v_mfma_f32_16x16x32_bf16 v[32:35], v[160:163], v[104:107], v[32:35]
    ds_read_b64_tr_b16 v[160:161], v11 offset:40960
    ds_read_b64_tr_b16 v[162:163], v11 offset:41472
    s_waitcnt lgkmcnt(10)
    v_mfma_f32_16x16x32_bf16 v[20:23], v[116:119], v[96:99], v[20:23]
    v_mfma_f32_16x16x32_bf16 v[36:39], v[116:119], v[104:107], v[36:39]
    ds_read_b64_tr_b16 v[116:117], v12 offset:40960
    ds_read_b64_tr_b16 v[118:119], v12 offset:41472
    s_waitcnt lgkmcnt(8)
    v_mov_b32 v165, 2
    s_mov_b64 exec, 1
    ds_write_b32 v4, v165 offset:0
    s_mov_b64 exec, -1
    v_mfma_f32_16x16x32_bf16 v[24:27], v[72:75], v[96:99], v[24:27]
    v_mfma_f32_16x16x32_bf16 v[40:43], v[72:75], v[104:107], v[40:43]
    ds_read_b64_tr_b16 v[72:73], v13 offset:40960
    ds_read_b64_tr_b16 v[74:75], v13 offset:41472
    v_mfma_f32_16x16x32_bf16 v[28:31], v[128:131], v[96:99], v[28:31]
    ds_read_b128 v[96:99], v3 offset:16384
    v_mfma_f32_16x16x32_bf16 v[44:47], v[128:131], v[104:107], v[44:47]
    ds_read_b64_tr_b16 v[128:129], v10 offset:45056
    ds_read_b64_tr_b16 v[130:131], v10 offset:45568
    s_waitcnt lgkmcnt(11)
    v_mfma_f32_16x16x32_bf16 v[16:19], v[136:139], v[48:51], v[16:19]
    ds_read_b128 v[104:107], v3 offset:18432
    s_waitcnt lgkmcnt(11)
    v_mfma_f32_16x16x32_bf16 v[32:35], v[136:139], v[52:55], v[32:35]
    ds_read_b64_tr_b16 v[136:137], v11 offset:45056
    ds_read_b64_tr_b16 v[138:139], v11 offset:45568
    s_waitcnt lgkmcnt(11)
    v_mfma_f32_16x16x32_bf16 v[20:23], v[160:163], v[48:51], v[20:23]
    v_mfma_f32_16x16x32_bf16 v[36:39], v[160:163], v[52:55], v[36:39]
    ds_read_b64_tr_b16 v[160:161], v12 offset:45056
    ds_read_b64_tr_b16 v[162:163], v12 offset:45568
    s_waitcnt lgkmcnt(11)
    v_mfma_f32_16x16x32_bf16 v[24:27], v[116:119], v[48:51], v[24:27]
    v_mfma_f32_16x16x32_bf16 v[40:43], v[116:119], v[52:55], v[40:43]
    ds_read_b64_tr_b16 v[116:117], v13 offset:45056
    ds_read_b64_tr_b16 v[118:119], v13 offset:45568
    s_waitcnt lgkmcnt(10)
    v_mfma_f32_16x16x32_bf16 v[28:31], v[72:75], v[48:51], v[28:31]
    ds_read_b128 v[48:51], v2 offset:32768
    v_mfma_f32_16x16x32_bf16 v[44:47], v[72:75], v[52:55], v[44:47]
    ds_read_b64_tr_b16 v[72:73], v5 offset:16384
    ds_read_b64_tr_b16 v[74:75], v5 offset:16896
    s_waitcnt lgkmcnt(10)
    v_mfma_f32_16x16x32_bf16 v[16:19], v[128:131], v[96:99], v[16:19]
    ds_read_b128 v[52:55], v2 offset:34816
    s_waitcnt lgkmcnt(10)
    v_mfma_f32_16x16x32_bf16 v[32:35], v[128:131], v[104:107], v[32:35]
    ds_read_b64_tr_b16 v[128:129], v6 offset:16384
    ds_read_b64_tr_b16 v[130:131], v6 offset:16896
    s_waitcnt lgkmcnt(10)
    v_mfma_f32_16x16x32_bf16 v[20:23], v[136:139], v[96:99], v[20:23]
    v_mfma_f32_16x16x32_bf16 v[36:39], v[136:139], v[104:107], v[36:39]
    ds_read_b64_tr_b16 v[136:137], v8 offset:16384
    ds_read_b64_tr_b16 v[138:139], v8 offset:16896
    s_waitcnt lgkmcnt(10)
    v_mfma_f32_16x16x32_bf16 v[24:27], v[160:163], v[96:99], v[24:27]
    v_mfma_f32_16x16x32_bf16 v[40:43], v[160:163], v[104:107], v[40:43]
    ds_read_b64_tr_b16 v[160:161], v9 offset:16384
    ds_read_b64_tr_b16 v[162:163], v9 offset:16896
    s_waitcnt lgkmcnt(10)
    v_mfma_f32_16x16x32_bf16 v[28:31], v[116:119], v[96:99], v[28:31]
    ds_read_b128 v[96:99], v3 offset:32768
    v_mfma_f32_16x16x32_bf16 v[44:47], v[116:119], v[104:107], v[44:47]
    ds_read_b64_tr_b16 v[116:117], v5 offset:20480
    ds_read_b64_tr_b16 v[118:119], v5 offset:20992
    s_waitcnt lgkmcnt(10)
    v_mfma_f32_16x16x32_bf16 v[16:19], v[72:75], v[48:51], v[16:19]
    ds_read_b128 v[104:107], v3 offset:34816
    s_waitcnt lgkmcnt(10)
    v_mfma_f32_16x16x32_bf16 v[32:35], v[72:75], v[52:55], v[32:35]
    ds_read_b64_tr_b16 v[72:73], v6 offset:20480
    ds_read_b64_tr_b16 v[74:75], v6 offset:20992
    s_waitcnt lgkmcnt(10)
    v_mfma_f32_16x16x32_bf16 v[20:23], v[128:131], v[48:51], v[20:23]
    v_mfma_f32_16x16x32_bf16 v[36:39], v[128:131], v[52:55], v[36:39]
    ds_read_b64_tr_b16 v[128:129], v8 offset:20480
    ds_read_b64_tr_b16 v[130:131], v8 offset:20992
    s_waitcnt lgkmcnt(10)
    v_mfma_f32_16x16x32_bf16 v[24:27], v[136:139], v[48:51], v[24:27]
    v_mfma_f32_16x16x32_bf16 v[40:43], v[136:139], v[52:55], v[40:43]
    ds_read_b64_tr_b16 v[136:137], v9 offset:20480
    ds_read_b64_tr_b16 v[138:139], v9 offset:20992
    s_waitcnt lgkmcnt(10)
    v_mfma_f32_16x16x32_bf16 v[28:31], v[160:163], v[48:51], v[28:31]
    s_waitcnt vmcnt(0)
    s_mov_b64 exec, 1
    ds_add_u32 v4, v164 offset:112
    s_mov_b64 exec, -1
    ds_read_b128 v[48:51], v2 offset:49152
    v_mfma_f32_16x16x32_bf16 v[44:47], v[160:163], v[52:55], v[44:47]
    ds_read_b64_tr_b16 v[160:161], v5 offset:8192
    ds_read_b64_tr_b16 v[162:163], v5 offset:8704
    s_waitcnt lgkmcnt(11)
    v_mfma_f32_16x16x32_bf16 v[16:19], v[116:119], v[96:99], v[16:19]
    ds_read_b128 v[52:55], v2 offset:51200
    s_waitcnt lgkmcnt(11)
    v_mfma_f32_16x16x32_bf16 v[32:35], v[116:119], v[104:107], v[32:35]
    ds_read_b64_tr_b16 v[116:117], v6 offset:8192
    ds_read_b64_tr_b16 v[118:119], v6 offset:8704
    s_waitcnt lgkmcnt(11)
    v_mfma_f32_16x16x32_bf16 v[20:23], v[72:75], v[96:99], v[20:23]
    v_mfma_f32_16x16x32_bf16 v[36:39], v[72:75], v[104:107], v[36:39]
    ds_read_b64_tr_b16 v[72:73], v8 offset:8192
    ds_read_b64_tr_b16 v[74:75], v8 offset:8704
    s_waitcnt lgkmcnt(9)
    v_mov_b32 v165, 4
    s_mov_b64 exec, 1
    ds_write_b32 v4, v165 offset:0
    s_mov_b64 exec, -1
    v_mfma_f32_16x16x32_bf16 v[24:27], v[128:131], v[96:99], v[24:27]
    v_mfma_f32_16x16x32_bf16 v[40:43], v[128:131], v[104:107], v[40:43]
    ds_read_b64_tr_b16 v[128:129], v9 offset:8192
    ds_read_b64_tr_b16 v[130:131], v9 offset:8704
    v_mfma_f32_16x16x32_bf16 v[28:31], v[136:139], v[96:99], v[28:31]
    ds_read_b128 v[96:99], v3 offset:49152
    v_mfma_f32_16x16x32_bf16 v[44:47], v[136:139], v[104:107], v[44:47]
    ds_read_b64_tr_b16 v[136:137], v5 offset:12288
    ds_read_b64_tr_b16 v[138:139], v5 offset:12800
    s_waitcnt lgkmcnt(11)
    v_mfma_f32_16x16x32_bf16 v[16:19], v[160:163], v[48:51], v[16:19]
    ds_read_b128 v[104:107], v3 offset:51200
    s_waitcnt lgkmcnt(11)
    v_mfma_f32_16x16x32_bf16 v[32:35], v[160:163], v[52:55], v[32:35]
    ds_read_b64_tr_b16 v[160:161], v6 offset:12288
    ds_read_b64_tr_b16 v[162:163], v6 offset:12800
    s_waitcnt lgkmcnt(11)
    v_mfma_f32_16x16x32_bf16 v[20:23], v[116:119], v[48:51], v[20:23]
    v_mfma_f32_16x16x32_bf16 v[36:39], v[116:119], v[52:55], v[36:39]
    ds_read_b64_tr_b16 v[116:117], v8 offset:12288
    ds_read_b64_tr_b16 v[118:119], v8 offset:12800
    s_waitcnt lgkmcnt(11)
    v_mfma_f32_16x16x32_bf16 v[24:27], v[72:75], v[48:51], v[24:27]
    v_mfma_f32_16x16x32_bf16 v[40:43], v[72:75], v[52:55], v[40:43]
    ds_read_b64_tr_b16 v[72:73], v9 offset:12288
    ds_read_b64_tr_b16 v[74:75], v9 offset:12800
    s_waitcnt lgkmcnt(10)
    v_mfma_f32_16x16x32_bf16 v[28:31], v[128:131], v[48:51], v[28:31]
    ds_read_b64_tr_b16 v[48:49], v10 offset:8192
    v_mfma_f32_16x16x32_bf16 v[44:47], v[128:131], v[52:55], v[44:47]
    ds_read_b64_tr_b16 v[50:51], v10 offset:8704
    ds_read_b64_tr_b16 v[128:129], v11 offset:8192
    s_waitcnt lgkmcnt(10)
    v_mfma_f32_16x16x32_bf16 v[16:19], v[136:139], v[96:99], v[16:19]
    ds_read_b64_tr_b16 v[130:131], v11 offset:8704
    s_waitcnt lgkmcnt(10)
    v_mfma_f32_16x16x32_bf16 v[32:35], v[136:139], v[104:107], v[32:35]
    ds_read_b64_tr_b16 v[52:53], v12 offset:8192
    ds_read_b64_tr_b16 v[54:55], v12 offset:8704
    s_waitcnt lgkmcnt(10)
    v_mfma_f32_16x16x32_bf16 v[20:23], v[160:163], v[96:99], v[20:23]
    ds_read_b64_tr_b16 v[136:137], v13 offset:8192
    v_mfma_f32_16x16x32_bf16 v[36:39], v[160:163], v[104:107], v[36:39]
    ds_read_b64_tr_b16 v[138:139], v13 offset:8704
    ds_read_b64_tr_b16 v[160:161], v10 offset:12288
    s_waitcnt lgkmcnt(9)
    v_mov_b32 v165, 5
    s_mov_b64 exec, 1
    ds_write_b32 v4, v165 offset:0
    s_mov_b64 exec, -1
    v_mfma_f32_16x16x32_bf16 v[24:27], v[116:119], v[96:99], v[24:27]
    ds_read_b64_tr_b16 v[162:163], v10 offset:12800
    v_mfma_f32_16x16x32_bf16 v[40:43], v[116:119], v[104:107], v[40:43]
    ds_read_b64_tr_b16 v[116:117], v11 offset:12288
    ds_read_b64_tr_b16 v[118:119], v11 offset:12800
    v_mfma_f32_16x16x32_bf16 v[28:31], v[72:75], v[96:99], v[28:31]
    ds_read_b64_tr_b16 v[96:97], v12 offset:12288
    v_mfma_f32_16x16x32_bf16 v[44:47], v[72:75], v[104:107], v[44:47]
    ds_read_b64_tr_b16 v[98:99], v12 offset:12800
    s_waitcnt lgkmcnt(8)
    ds_read_b64_tr_b16 v[72:73], v13 offset:12288
    s_waitcnt lgkmcnt(14)
    v_mfma_f32_16x16x32_bf16 v[16:19], v[48:51], v[60:63], v[16:19]
    ds_read_b64_tr_b16 v[74:75], v13 offset:12800
    v_mfma_f32_16x16x32_bf16 v[32:35], v[48:51], v[132:135], v[32:35]
    ds_read_b32 v7, v1 offset:112
FW_7:
    s_waitcnt lgkmcnt(0)
    v_cmp_gt_u32 vcc, 2, v7
    s_cbranch_vccz FO_8
    ds_read_b32 v7, v1 offset:112
    s_branch FW_7
FO_8:
    ds_read_b64_tr_b16 v[104:105], v10 offset:0
    ds_read_b64_tr_b16 v[106:107], v10 offset:512
    v_mfma_f32_16x16x32_bf16 v[20:23], v[128:131], v[60:63], v[20:23]
    ds_read_b64_tr_b16 v[48:49], v11 offset:0
    v_mfma_f32_16x16x32_bf16 v[36:39], v[128:131], v[132:135], v[36:39]
    ds_read_b64_tr_b16 v[50:51], v11 offset:512
    ds_read_b64_tr_b16 v[128:129], v12 offset:0
    v_mfma_f32_16x16x32_bf16 v[24:27], v[52:55], v[60:63], v[24:27]
    ds_read_b64_tr_b16 v[130:131], v12 offset:512
    v_mfma_f32_16x16x32_bf16 v[40:43], v[52:55], v[132:135], v[40:43]
    ds_read_b64_tr_b16 v[52:53], v13 offset:0
    ds_read_b64_tr_b16 v[54:55], v13 offset:512
    v_mfma_f32_16x16x32_bf16 v[28:31], v[136:139], v[60:63], v[28:31]
    v_mfma_f32_16x16x32_bf16 v[44:47], v[136:139], v[132:135], v[44:47]
    v_mfma_f32_16x16x32_bf16 v[16:19], v[160:163], v[68:71], v[16:19]
    ds_read_b64_tr_b16 v[60:61], v10 offset:4096
    v_mfma_f32_16x16x32_bf16 v[32:35], v[160:163], v[152:155], v[32:35]
    ds_read_b64_tr_b16 v[62:63], v10 offset:4608
    ds_read_b64_tr_b16 v[136:137], v11 offset:4096
    v_mfma_f32_16x16x32_bf16 v[20:23], v[116:119], v[68:71], v[20:23]
    ds_read_b64_tr_b16 v[138:139], v11 offset:4608
    v_mfma_f32_16x16x32_bf16 v[36:39], v[116:119], v[152:155], v[36:39]
    ds_read_b64_tr_b16 v[132:133], v12 offset:4096
    ds_read_b64_tr_b16 v[134:135], v12 offset:4608
    v_mfma_f32_16x16x32_bf16 v[24:27], v[96:99], v[68:71], v[24:27]
    ds_read_b64_tr_b16 v[160:161], v13 offset:4096
    v_mfma_f32_16x16x32_bf16 v[40:43], v[96:99], v[152:155], v[40:43]
    s_waitcnt lgkmcnt(8)
    ds_read_b64_tr_b16 v[162:163], v13 offset:4608
    v_mfma_f32_16x16x32_bf16 v[28:31], v[72:75], v[68:71], v[28:31]
    v_mfma_f32_16x16x32_bf16 v[44:47], v[72:75], v[152:155], v[44:47]
    s_waitcnt lgkmcnt(14)
    v_mfma_f32_16x16x32_bf16 v[16:19], v[104:107], v[84:87], v[16:19]
    ds_read_b64_tr_b16 v[116:117], v10 offset:24576
    v_mfma_f32_16x16x32_bf16 v[32:35], v[104:107], v[92:95], v[32:35]
    ds_read_b64_tr_b16 v[118:119], v10 offset:25088
    ds_read_b64_tr_b16 v[96:97], v11 offset:24576
    s_waitcnt lgkmcnt(15)
    v_mfma_f32_16x16x32_bf16 v[20:23], v[48:51], v[84:87], v[20:23]
    ds_read_b64_tr_b16 v[98:99], v11 offset:25088
    s_waitcnt lgkmcnt(4)
    v_mov_b32 v165, 7
    s_mov_b64 exec, 1
    ds_write_b32 v4, v165 offset:0
    s_mov_b64 exec, -1
    v_mfma_f32_16x16x32_bf16 v[36:39], v[48:51], v[92:95], v[36:39]
    ds_read_b64_tr_b16 v[68:69], v12 offset:24576
    ds_read_b64_tr_b16 v[70:71], v12 offset:25088
    v_mfma_f32_16x16x32_bf16 v[24:27], v[128:131], v[84:87], v[24:27]
    ds_read_b64_tr_b16 v[72:73], v13 offset:24576
    v_mfma_f32_16x16x32_bf16 v[40:43], v[128:131], v[92:95], v[40:43]
    ds_read_b64_tr_b16 v[74:75], v13 offset:25088
    v_mfma_f32_16x16x32_bf16 v[28:31], v[52:55], v[84:87], v[28:31]
    v_mfma_f32_16x16x32_bf16 v[44:47], v[52:55], v[92:95], v[44:47]
    v_mfma_f32_16x16x32_bf16 v[16:19], v[60:63], v[100:103], v[16:19]
    ds_read_b64_tr_b16 v[152:153], v10 offset:28672
    v_mfma_f32_16x16x32_bf16 v[32:35], v[60:63], v[108:111], v[32:35]
    ds_read_b64_tr_b16 v[154:155], v10 offset:29184
    ds_read_b64_tr_b16 v[104:105], v11 offset:28672
    v_mfma_f32_16x16x32_bf16 v[20:23], v[136:139], v[100:103], v[20:23]
    ds_read_b64_tr_b16 v[106:107], v11 offset:29184
    v_mfma_f32_16x16x32_bf16 v[36:39], v[136:139], v[108:111], v[36:39]
    ds_read_b64_tr_b16 v[48:49], v12 offset:28672
    ds_read_b64_tr_b16 v[50:51], v12 offset:29184
    v_mfma_f32_16x16x32_bf16 v[24:27], v[132:135], v[100:103], v[24:27]
    s_waitcnt lgkmcnt(8)
    ds_read_b64_tr_b16 v[128:129], v13 offset:28672
    v_mfma_f32_16x16x32_bf16 v[40:43], v[132:135], v[108:111], v[40:43]
    ds_read_b64_tr_b16 v[130:131], v13 offset:29184
    v_mfma_f32_16x16x32_bf16 v[28:31], v[160:163], v[100:103], v[28:31]
    v_mfma_f32_16x16x32_bf16 v[44:47], v[160:163], v[108:111], v[44:47]
    s_waitcnt lgkmcnt(15)
    v_mfma_f32_16x16x32_bf16 v[16:19], v[116:119], v[56:59], v[16:19]
    ds_read_b64_tr_b16 v[84:85], v10 offset:16384
    v_mfma_f32_16x16x32_bf16 v[32:35], v[116:119], v[124:127], v[32:35]
    ds_read_b64_tr_b16 v[86:87], v10 offset:16896
    ds_read_b64_tr_b16 v[52:53], v11 offset:16384
    s_waitcnt lgkmcnt(15)
    v_mfma_f32_16x16x32_bf16 v[20:23], v[96:99], v[56:59], v[20:23]
    ds_read_b64_tr_b16 v[54:55], v11 offset:16896
    v_mfma_f32_16x16x32_bf16 v[36:39], v[96:99], v[124:127], v[36:39]
    ds_read_b64_tr_b16 v[92:93], v12 offset:16384
    s_waitcnt lgkmcnt(8)
    ds_read_b64_tr_b16 v[94:95], v12 offset:16896
    s_waitcnt lgkmcnt(15)
    v_mfma_f32_16x16x32_bf16 v[24:27], v[68:71], v[56:59], v[24:27]
    ds_read_b64_tr_b16 v[60:61], v13 offset:16384
    v_mfma_f32_16x16x32_bf16 v[40:43], v[68:71], v[124:127], v[40:43]
    ds_read_b64_tr_b16 v[62:63], v13 offset:16896
    s_waitcnt lgkmcnt(15)
    v_mfma_f32_16x16x32_bf16 v[28:31], v[72:75], v[56:59], v[28:31]
    v_mfma_f32_16x16x32_bf16 v[44:47], v[72:75], v[124:127], v[44:47]
    s_waitcnt lgkmcnt(14)
    v_mfma_f32_16x16x32_bf16 v[16:19], v[152:155], v[76:79], v[16:19]
    ds_read_b64_tr_b16 v[136:137], v10 offset:20480
    v_mfma_f32_16x16x32_bf16 v[32:35], v[152:155], v[148:151], v[32:35]
    ds_read_b64_tr_b16 v[138:139], v10 offset:20992
    ds_read_b64_tr_b16 v[132:133], v11 offset:20480
    s_waitcnt lgkmcnt(15)
    v_mfma_f32_16x16x32_bf16 v[20:23], v[104:107], v[76:79], v[20:23]
    ds_read_b64_tr_b16 v[134:135], v11 offset:20992
    v_mfma_f32_16x16x32_bf16 v[36:39], v[104:107], v[148:151], v[36:39]
    s_waitcnt lgkmcnt(8)
    ds_read_b64_tr_b16 v[100:101], v12 offset:20480
    ds_read_b64_tr_b16 v[102:103], v12 offset:20992
    s_waitcnt lgkmcnt(15)
    v_mfma_f32_16x16x32_bf16 v[24:27], v[48:51], v[76:79], v[24:27]
    ds_read_b64_tr_b16 v[160:161], v13 offset:20480
    v_mfma_f32_16x16x32_bf16 v[40:43], v[48:51], v[148:151], v[40:43]
    ds_read_b64_tr_b16 v[162:163], v13 offset:20992
    s_waitcnt lgkmcnt(15)
    v_mfma_f32_16x16x32_bf16 v[28:31], v[128:131], v[76:79], v[28:31]
    v_mfma_f32_16x16x32_bf16 v[44:47], v[128:131], v[148:151], v[44:47]
    s_waitcnt lgkmcnt(14)
    v_mfma_f32_16x16x32_bf16 v[16:19], v[84:87], v[88:91], v[16:19]
    ds_read_b64_tr_b16 v[108:109], v10 offset:32768
    v_mfma_f32_16x16x32_bf16 v[32:35], v[84:87], v[64:67], v[32:35]
    ds_read_b64_tr_b16 v[110:111], v10 offset:33280
    ds_read_b64_tr_b16 v[116:117], v11 offset:32768
    s_waitcnt lgkmcnt(15)
    v_mfma_f32_16x16x32_bf16 v[20:23], v[52:55], v[88:91], v[20:23]
    s_waitcnt lgkmcnt(8)
    ds_read_b64_tr_b16 v[118:119], v11 offset:33280
    v_mfma_f32_16x16x32_bf16 v[36:39], v[52:55], v[64:67], v[36:39]
    ds_read_b64_tr_b16 v[96:97], v12 offset:32768
    ds_read_b64_tr_b16 v[98:99], v12 offset:33280
    s_waitcnt lgkmcnt(15)
    v_mfma_f32_16x16x32_bf16 v[24:27], v[92:95], v[88:91], v[24:27]
    ds_read_b64_tr_b16 v[68:69], v13 offset:32768
    v_mfma_f32_16x16x32_bf16 v[40:43], v[92:95], v[64:67], v[40:43]
    ds_read_b64_tr_b16 v[70:71], v13 offset:33280
    s_waitcnt lgkmcnt(15)
    v_mfma_f32_16x16x32_bf16 v[28:31], v[60:63], v[88:91], v[28:31]
    v_mfma_f32_16x16x32_bf16 v[44:47], v[60:63], v[64:67], v[44:47]
    s_waitcnt lgkmcnt(14)
    v_mfma_f32_16x16x32_bf16 v[16:19], v[136:139], v[80:83], v[16:19]
    ds_read_b64_tr_b16 v[56:57], v10 offset:36864
    v_mfma_f32_16x16x32_bf16 v[32:35], v[136:139], v[112:115], v[32:35]
    ds_read_b64_tr_b16 v[58:59], v10 offset:37376
    s_waitcnt lgkmcnt(8)
    ds_read_b64_tr_b16 v[72:73], v11 offset:36864
    s_waitcnt lgkmcnt(15)
    v_mfma_f32_16x16x32_bf16 v[20:23], v[132:135], v[80:83], v[20:23]
    ds_read_b64_tr_b16 v[74:75], v11 offset:37376
    v_mfma_f32_16x16x32_bf16 v[36:39], v[132:135], v[112:115], v[36:39]
    ds_read_b64_tr_b16 v[124:125], v12 offset:36864
    ds_read_b64_tr_b16 v[126:127], v12 offset:37376
    s_waitcnt lgkmcnt(15)
    v_mfma_f32_16x16x32_bf16 v[24:27], v[100:103], v[80:83], v[24:27]
    ds_read_b64_tr_b16 v[152:153], v13 offset:36864
    v_mfma_f32_16x16x32_bf16 v[40:43], v[100:103], v[112:115], v[40:43]
    ds_read_b64_tr_b16 v[154:155], v13 offset:37376
    s_waitcnt lgkmcnt(15)
    v_mfma_f32_16x16x32_bf16 v[28:31], v[160:163], v[80:83], v[28:31]
    v_mfma_f32_16x16x32_bf16 v[44:47], v[160:163], v[112:115], v[44:47]
    s_waitcnt lgkmcnt(14)
    v_mfma_f32_16x16x32_bf16 v[16:19], v[108:111], v[140:143], v[16:19]
    ds_read2_b32 v[112:113], v14 offset0:0 offset1:0
    s_waitcnt lgkmcnt(8)
    ds_read2_b32 v[114:115], v14 offset0:16 offset1:16
    v_mfma_f32_16x16x32_bf16 v[32:35], v[108:111], v[120:123], v[32:35]
    s_waitcnt lgkmcnt(14)
    v_mfma_f32_16x16x32_bf16 v[20:23], v[116:119], v[140:143], v[20:23]
    s_waitcnt lgkmcnt(2)
    v_mov_b32 v165, 10
    s_mov_b64 exec, 1
    ds_write_b32 v4, v165 offset:0
    s_mov_b64 exec, -1
    v_mfma_f32_16x16x32_bf16 v[36:39], v[116:119], v[120:123], v[36:39]
    v_mfma_f32_16x16x32_bf16 v[24:27], v[96:99], v[140:143], v[24:27]
    v_mfma_f32_16x16x32_bf16 v[40:43], v[96:99], v[120:123], v[40:43]
    v_mfma_f32_16x16x32_bf16 v[28:31], v[68:71], v[140:143], v[28:31]
    v_mfma_f32_16x16x32_bf16 v[44:47], v[68:71], v[120:123], v[44:47]
    v_mfma_f32_16x16x32_bf16 v[16:19], v[56:59], v[144:147], v[16:19]
    v_mfma_f32_16x16x32_bf16 v[32:35], v[56:59], v[156:159], v[32:35]
    v_mfma_f32_16x16x32_bf16 v[20:23], v[72:75], v[144:147], v[20:23]
    s_branch IW_s2
IW_w2:
    s_branch IW_r2
IW_s2:
    v_mfma_f32_16x16x32_bf16 v[36:39], v[72:75], v[156:159], v[36:39]
    v_mfma_f32_16x16x32_bf16 v[24:27], v[124:127], v[144:147], v[24:27]
    v_mfma_f32_16x16x32_bf16 v[40:43], v[124:127], v[156:159], v[40:43]
    v_mfma_f32_16x16x32_bf16 v[28:31], v[152:155], v[144:147], v[28:31]
    v_mfma_f32_16x16x32_bf16 v[44:47], v[152:155], v[156:159], v[44:47]
    s_setprio 3
    v_lshlrev_b32 v6, 4, v0
    v_lshlrev_b32 v8, 2, v0
    v_add_u32 v8, 40960, v8
    v_mov_b32 v11, 0x35c1a2a0

    s_waitcnt lgkmcnt(2)
    v_pk_mul_f32 v[16:17], v[16:17], v[112:113]
    v_pk_mul_f32 v[18:19], v[18:19], v[112:113]
    v_pk_mul_f32 v[20:21], v[20:21], v[112:113]
    v_pk_mul_f32 v[22:23], v[22:23], v[112:113]
    v_pk_mul_f32 v[24:25], v[24:25], v[112:113]
    v_pk_mul_f32 v[26:27], v[26:27], v[112:113]
    v_pk_mul_f32 v[28:29], v[28:29], v[112:113]
    v_pk_mul_f32 v[30:31], v[30:31], v[112:113]
    s_waitcnt lgkmcnt(1)
    v_pk_mul_f32 v[32:33], v[32:33], v[114:115]
    v_pk_mul_f32 v[34:35], v[34:35], v[114:115]
    v_pk_mul_f32 v[36:37], v[36:37], v[114:115]
    v_pk_mul_f32 v[38:39], v[38:39], v[114:115]
    v_pk_mul_f32 v[40:41], v[40:41], v[114:115]
    v_pk_mul_f32 v[42:43], v[42:43], v[114:115]
    v_pk_mul_f32 v[44:45], v[44:45], v[114:115]
    v_pk_mul_f32 v[46:47], v[46:47], v[114:115]
    v_exp_f32 v80, v16 clamp
    v_exp_f32 v81, v17 clamp
    v_exp_f32 v82, v18 clamp
    v_exp_f32 v83, v19 clamp
    v_exp_f32 v84, v20 clamp
    v_exp_f32 v85, v21 clamp
    v_exp_f32 v86, v22 clamp
    v_exp_f32 v87, v23 clamp
    v_exp_f32 v88, v24 clamp
    v_exp_f32 v89, v25 clamp
    v_exp_f32 v90, v26 clamp
    v_exp_f32 v91, v27 clamp
    v_exp_f32 v92, v28 clamp
    v_exp_f32 v93, v29 clamp
    v_exp_f32 v94, v30 clamp
    v_exp_f32 v95, v31 clamp
    v_exp_f32 v96, v32 clamp
    v_exp_f32 v97, v33 clamp
    v_exp_f32 v98, v34 clamp
    v_exp_f32 v99, v35 clamp
    v_exp_f32 v100, v36 clamp
    v_exp_f32 v101, v37 clamp
    v_exp_f32 v102, v38 clamp
    v_exp_f32 v103, v39 clamp
    v_exp_f32 v104, v40 clamp
    v_exp_f32 v105, v41 clamp
    v_exp_f32 v106, v42 clamp
    v_exp_f32 v107, v43 clamp
    v_exp_f32 v108, v44 clamp
    v_exp_f32 v109, v45 clamp
    v_exp_f32 v110, v46 clamp
    v_exp_f32 v111, v47 clamp
    v_pk_mul_f32 v[16:17], v[16:17], s[40:41] clamp
    v_pk_mul_f32 v[18:19], v[18:19], s[40:41] clamp
    v_pk_mul_f32 v[20:21], v[20:21], s[40:41] clamp
    v_pk_mul_f32 v[22:23], v[22:23], s[40:41] clamp
    v_pk_mul_f32 v[24:25], v[24:25], s[40:41] clamp
    v_pk_mul_f32 v[26:27], v[26:27], s[40:41] clamp
    v_pk_mul_f32 v[28:29], v[28:29], s[40:41] clamp
    v_pk_mul_f32 v[30:31], v[30:31], s[40:41] clamp
    v_pk_mul_f32 v[32:33], v[32:33], s[40:41] clamp
    v_pk_mul_f32 v[34:35], v[34:35], s[40:41] clamp
    v_pk_mul_f32 v[36:37], v[36:37], s[40:41] clamp
    v_pk_mul_f32 v[38:39], v[38:39], s[40:41] clamp
    v_pk_mul_f32 v[40:41], v[40:41], s[40:41] clamp
    v_pk_mul_f32 v[42:43], v[42:43], s[40:41] clamp
    v_pk_mul_f32 v[44:45], v[44:45], s[40:41] clamp
    v_pk_mul_f32 v[46:47], v[46:47], s[40:41] clamp
    v_pk_add_f32 v[80:81], v[80:81], s[74:75]
    v_pk_add_f32 v[82:83], v[82:83], s[74:75]
    v_pk_add_f32 v[84:85], v[84:85], s[74:75]
    v_pk_add_f32 v[86:87], v[86:87], s[74:75]
    v_pk_add_f32 v[88:89], v[88:89], s[74:75]
    v_pk_add_f32 v[90:91], v[90:91], s[74:75]
    v_pk_add_f32 v[92:93], v[92:93], s[74:75]
    v_pk_add_f32 v[94:95], v[94:95], s[74:75]
    v_pk_add_f32 v[96:97], v[96:97], s[74:75]
    v_pk_add_f32 v[98:99], v[98:99], s[74:75]
    v_pk_add_f32 v[100:101], v[100:101], s[74:75]
    v_pk_add_f32 v[102:103], v[102:103], s[74:75]
    v_pk_add_f32 v[104:105], v[104:105], s[74:75]
    v_pk_add_f32 v[106:107], v[106:107], s[74:75]
    v_pk_add_f32 v[108:109], v[108:109], s[74:75]
    v_pk_add_f32 v[110:111], v[110:111], s[74:75]
    v_pk_fma_f32 v[16:17], v[16:17], s[76:77], v[80:81]
    v_pk_fma_f32 v[18:19], v[18:19], s[76:77], v[82:83]
    v_pk_fma_f32 v[20:21], v[20:21], s[76:77], v[84:85]
    v_pk_fma_f32 v[22:23], v[22:23], s[76:77], v[86:87]
    v_pk_fma_f32 v[24:25], v[24:25], s[76:77], v[88:89]
    v_pk_fma_f32 v[26:27], v[26:27], s[76:77], v[90:91]
    v_pk_fma_f32 v[28:29], v[28:29], s[76:77], v[92:93]
    v_pk_fma_f32 v[30:31], v[30:31], s[76:77], v[94:95]
    v_pk_fma_f32 v[32:33], v[32:33], s[76:77], v[96:97]
    v_pk_fma_f32 v[34:35], v[34:35], s[76:77], v[98:99]
    v_pk_fma_f32 v[36:37], v[36:37], s[76:77], v[100:101]
    v_pk_fma_f32 v[38:39], v[38:39], s[76:77], v[102:103]
    v_pk_fma_f32 v[40:41], v[40:41], s[76:77], v[104:105]
    v_pk_fma_f32 v[42:43], v[42:43], s[76:77], v[106:107]
    v_pk_fma_f32 v[44:45], v[44:45], s[76:77], v[108:109]
    v_pk_fma_f32 v[46:47], v[46:47], s[76:77], v[110:111]
    v_cvt_pk_bf16_f32 v112, v16, v17
    v_cvt_pk_bf16_f32 v113, v18, v19
    v_cvt_pk_bf16_f32 v114, v20, v21
    v_cvt_pk_bf16_f32 v115, v22, v23
    v_cvt_pk_bf16_f32 v116, v24, v25
    v_cvt_pk_bf16_f32 v117, v26, v27
    v_cvt_pk_bf16_f32 v118, v28, v29
    v_cvt_pk_bf16_f32 v119, v30, v31
    v_cvt_pk_bf16_f32 v120, v32, v33
    v_cvt_pk_bf16_f32 v121, v34, v35
    v_cvt_pk_bf16_f32 v122, v36, v37
    v_cvt_pk_bf16_f32 v123, v38, v39
    v_cvt_pk_bf16_f32 v124, v40, v41
    v_cvt_pk_bf16_f32 v125, v42, v43
    v_cvt_pk_bf16_f32 v126, v44, v45
    v_cvt_pk_bf16_f32 v127, v46, v47
    s_waitcnt lgkmcnt(0)
    v_and_b32 v9, 0xfffffff7, v1
    v_and_b32 v5, 0x30, v0
    v_add_u32 v5, 159232, v5
    v_and_b32 v8, 15, v0
    v_lshlrev_b32 v8, 6, v8
    v_and_b32 v10, 0x30, v0
    v_add_u32 v8, v8, v10
    v_add_u32 v8, 40960, v8
F_kw:
    ds_read_b32 v7, v9 offset:128
    ds_read_b128 v[32:35], v5 offset:0
    ds_read_b128 v[36:39], v5 offset:64
    ds_read_b128 v[16:19], v8 offset:0
    ds_read_b128 v[20:23], v8 offset:1024
    ds_read_b128 v[24:27], v8 offset:4096
    ds_read_b128 v[28:31], v8 offset:5120
    ds_read_b128 v[56:59], v5 offset:128
    ds_read_b128 v[60:63], v5 offset:192
    ds_read_b128 v[40:43], v8 offset:2048
    ds_read_b128 v[44:47], v8 offset:3072
    ds_read_b128 v[48:51], v8 offset:6144
    ds_read_b128 v[52:55], v8 offset:7168
    s_waitcnt lgkmcnt(12)
    v_cmp_gt_u32 vcc, 2, v7
    s_cbranch_vccz F_kx
    s_waitcnt lgkmcnt(0)
    s_branch F_kw
F_kx:
    s_waitcnt lgkmcnt(10)
    v_cvt_pk_bf16_f32 v136, v32, v33
    v_cvt_pk_bf16_f32 v137, v34, v35
    v_cvt_pk_bf16_f32 v138, v36, v37
    v_cvt_pk_bf16_f32 v139, v38, v39
    s_nop 1
    v_mfma_f32_16x16x32_bf16 v[72:75], v[136:139], v[112:115], 0
    v_mfma_f32_16x16x32_bf16 v[84:87], v[136:139], v[120:123], 0
    s_waitcnt lgkmcnt(8)
    v_cvt_pk_bf16_f32 v128, v16, v17
    v_cvt_pk_bf16_f32 v129, v18, v19
    v_cvt_pk_bf16_f32 v130, v20, v21
    v_cvt_pk_bf16_f32 v131, v22, v23
    s_nop 1
    v_mfma_f32_16x16x32_bf16 v[64:67], v[128:131], v[112:115], 0
    v_mfma_f32_16x16x32_bf16 v[76:79], v[128:131], v[120:123], 0
    s_waitcnt lgkmcnt(6)
    v_cvt_pk_bf16_f32 v132, v24, v25
    v_cvt_pk_bf16_f32 v133, v26, v27
    v_cvt_pk_bf16_f32 v134, v28, v29
    v_cvt_pk_bf16_f32 v135, v30, v31
    s_nop 1
    v_mfma_f32_16x16x32_bf16 v[68:71], v[132:135], v[112:115], 0
    v_mfma_f32_16x16x32_bf16 v[80:83], v[132:135], v[120:123], 0
    s_waitcnt lgkmcnt(4)
    v_cvt_pk_bf16_f32 v148, v56, v57
    v_cvt_pk_bf16_f32 v149, v58, v59
    v_cvt_pk_bf16_f32 v150, v60, v61
    v_cvt_pk_bf16_f32 v151, v62, v63
    v_fma_f32 v72, v72, s46, v11
    v_rcp_f32 v72, v72
    v_fma_f32 v84, v84, s46, v11
    v_rcp_f32 v84, v84
    v_mfma_f32_16x16x32_bf16 v[96:99], v[148:151], v[116:119], 0
    v_mfma_f32_16x16x32_bf16 v[108:111], v[148:151], v[124:127], 0
    s_waitcnt lgkmcnt(2)
    v_cvt_pk_bf16_f32 v140, v40, v41
    v_cvt_pk_bf16_f32 v141, v42, v43
    v_cvt_pk_bf16_f32 v142, v44, v45
    v_cvt_pk_bf16_f32 v143, v46, v47
    s_nop 1
    v_mfma_f32_16x16x32_bf16 v[88:91], v[140:143], v[116:119], 0
    v_mfma_f32_16x16x32_bf16 v[100:103], v[140:143], v[124:127], 0
    s_waitcnt lgkmcnt(0)
    v_cvt_pk_bf16_f32 v144, v48, v49
    v_cvt_pk_bf16_f32 v145, v50, v51
    v_cvt_pk_bf16_f32 v146, v52, v53
    v_cvt_pk_bf16_f32 v147, v54, v55
    s_nop 1
    v_mfma_f32_16x16x32_bf16 v[92:95], v[144:147], v[116:119], 0
    v_mfma_f32_16x16x32_bf16 v[104:107], v[144:147], v[124:127], 0
    v_mul_f32 v64, v64, v72
    v_mul_f32 v65, v65, v72
    v_mul_f32 v66, v66, v72
    v_mul_f32 v67, v67, v72
    v_mul_f32 v68, v68, v72
    v_mul_f32 v69, v69, v72
    v_mul_f32 v70, v70, v72
    v_mul_f32 v71, v71, v72
    v_cvt_pk_bf16_f32 v152, v64, v65
    v_cvt_pk_bf16_f32 v153, v66, v67
    v_cvt_pk_bf16_f32 v154, v68, v69
    v_cvt_pk_bf16_f32 v155, v70, v71
    buffer_store_dwordx4 v[152:155], v6, s[16:19], s79 offen offset:0 sc0 sc1
    v_fma_f32 v96, v96, s46, v11
    v_rcp_f32 v96, v96
    v_fma_f32 v108, v108, s46, v11
    v_rcp_f32 v108, v108
    v_mov_b32 v85, v84
    v_pk_mul_f32 v[76:77], v[76:77], v[84:85]
    v_pk_mul_f32 v[78:79], v[78:79], v[84:85]
    v_pk_mul_f32 v[80:81], v[80:81], v[84:85]
    v_pk_mul_f32 v[82:83], v[82:83], v[84:85]
    v_cvt_pk_bf16_f32 v156, v76, v77
    v_cvt_pk_bf16_f32 v157, v78, v79
    v_cvt_pk_bf16_f32 v158, v80, v81
    v_cvt_pk_bf16_f32 v159, v82, v83
    buffer_store_dwordx4 v[156:159], v6, s[16:19], s80 offen offset:0 sc0 sc1
    v_mov_b32 v97, v96
    v_pk_mul_f32 v[88:89], v[88:89], v[96:97]
    v_pk_mul_f32 v[90:91], v[90:91], v[96:97]
    v_pk_mul_f32 v[92:93], v[92:93], v[96:97]
    v_pk_mul_f32 v[94:95], v[94:95], v[96:97]
    v_cvt_pk_bf16_f32 v160, v88, v89
    v_cvt_pk_bf16_f32 v161, v90, v91
    v_cvt_pk_bf16_f32 v162, v92, v93
    v_cvt_pk_bf16_f32 v163, v94, v95
    buffer_store_dwordx4 v[160:163], v6, s[16:19], s79 offen offset:1024 sc0 sc1
    v_mov_b32 v109, v108
    v_pk_mul_f32 v[100:101], v[100:101], v[108:109]
    v_pk_mul_f32 v[102:103], v[102:103], v[108:109]
    v_pk_mul_f32 v[104:105], v[104:105], v[108:109]
    v_pk_mul_f32 v[106:107], v[106:107], v[108:109]
    v_cvt_pk_bf16_f32 v16, v100, v101
    v_cvt_pk_bf16_f32 v17, v102, v103
    v_cvt_pk_bf16_f32 v18, v104, v105
    v_cvt_pk_bf16_f32 v19, v106, v107
    buffer_store_dwordx4 v[16:19], v6, s[16:19], s80 offen offset:1024 sc0 sc1
    s_mov_b64 exec, 1
    ds_write_b32 v4, v164 offset:144
    s_waitcnt vmcnt(0)
    s_mov_b32 s45, 1
    s_atomic_add s45, s[54:55], 0x0
    s_atomic_add s45, s[54:55], 0x80
    s_atomic_add s45, s[54:55], 0x100
    s_atomic_add s45, s[54:55], 0x180
    ds_add_u32 v4, v164 offset:144
    s_mov_b64 exec, -1
    s_cmp_lg_u32 s3, 0
    s_cbranch_scc1 F_end
    s_setprio 3
    s_lshr_b32 s50, s29, 1
    s_lshl_b32 s50, s50, 2
    s_and_b32 s51, s28, 3
    s_add_u32 s50, s50, s51
    s_lshl_b32 s50, s50, 7
    s_add_u32 s56, s50, 0x845000
    s_add_u32 s56, s72, s56
    s_addc_u32 s57, s73, 0
    v_mov_b32 v2, 159096
    ds_read_b32 v7, v2 offset:0
FW_9:
    s_waitcnt lgkmcnt(0)
    v_cmp_gt_u32 vcc, 1, v7
    s_cbranch_vccz FO_10
    s_sleep 2
    ds_read_b32 v7, v2 offset:0
    s_branch FW_9
FO_10:
    v_and_b32 v2, 7, v0
    v_lshlrev_b32 v2, 2, v2
    v_add_u32 v2, 158976, v2
    ds_read_b32 v2, v2
    s_sub_u32 s51, 15, s28
    s_waitcnt lgkmcnt(0)
    v_bfe_u32 v2, v2, 7, 4
    v_cmp_eq_u32 vcc, s51, v2
    s_cbranch_vccz F_ny

    v_lshrrev_b32 v2, 4, v0
    v_and_b32 v6, 15, v0
    v_lshlrev_b32 v6, 4, v6
    v_lshl_add_u32 v2, v2, 12, v6
    s_lshl_b32 s50, s29, 8
    s_add_u32 s50, s50, 135168

SP_11:
    s_load_dword s58, s[56:57], 0 glc
    s_waitcnt lgkmcnt(0)
    s_cmp_ge_u32 s58, 32
    s_cbranch_scc1 SD_12
    s_sleep 2
    s_branch SP_11
SD_12:
    s_mov_b32 m0, 159744
    s_nop 0
    buffer_load_dwordx4 v2, s[24:27], s50 offen sc0 sc1 lds
    s_add_u32 s50, s50, 16384
    s_add_u32 m0, m0, 1024
    s_nop 0
    buffer_load_dwordx4 v2, s[24:27], s50 offen sc0 sc1 lds
    s_waitcnt vmcnt(0)
    v_mov_b32 v7, 1
    s_mov_b64 exec, 1
    ds_write_b32 v4, v7 offset:96
    s_mov_b64 exec, -1
F_ny:
F_end:
    s_endpgm
F_nl:
    s_sub_u32 s3, s3, 4
    s_setprio 2
    s_lshr_b32 s36, s3, 1
    s_and_b32 s37, s3, 1
    v_and_b32 v1, 15, v0
    v_lshrrev_b32 v2, 4, v0
    v_lshrrev_b32 v3, 1, v1
    v_xor_b32 v3, v3, v2
    v_lshlrev_b32 v3, 4, v3
    v_lshlrev_b32 v1, 7, v1
    s_lshl_b32 s38, s36, 13
    v_add3_u32 v4, v1, v3, s38
    v_xor_b32 v5, 64, v4
    v_add_u32 v6, 0x10000, v4
    v_add_u32 v7, 0x10000, v5
    v_bfe_u32 v1, v0, 2, 2
    v_lshl_add_u32 v3, v2, 3, v1
    v_lshrrev_b32 v1, 1, v1
    v_and_b32 v2, 1, v2
    v_lshl_add_u32 v1, v2, 1, v1
    s_lshl_b32 s38, s37, 1
    s_add_u32 s38, s38, s36
    v_xor_b32 v1, s38, v1
    v_lshlrev_b32 v1, 5, v1
    v_lshl_add_u32 v1, v3, 7, v1
    v_and_b32 v2, 3, v0
    v_lshl_add_u32 v1, v2, 3, v1
    v_add_u32 v8, 0x10000, v1
    v_xor_b32 v9, 32, v8
    v_add_u32 v10, 0x8000, v8
    v_add_u32 v11, 0x8000, v9
    s_mov_b32 s40, 0x21317218
    s_mov_b32 s41, s40
    s_mov_b32 s74, 0x358637bd
    s_mov_b32 s75, s74
    s_mov_b32 s76, 0x5d800000
    s_mov_b32 s77, s76
    v_and_b32 v164, 0x30, v0
    s_lshl_b32 s42, s36, 8
    s_add_u32 s42, s42, 155648
    v_add_u32 v164, s42, v164
    v_and_b32 v165, 15, v0
    v_lshlrev_b32 v165, 2, v165
    s_lshl_b32 s42, s38, 6
    s_add_u32 s42, s42, 158208
    v_add_u32 v165, s42, v165
    s_lshl_b32 s42, s3, 2
    s_add_u32 s42, s42, 159040
    v_mov_b32 v3, s42
    v_lshlrev_b32 v1, 2, v2
    v_add_u32 v1, 159040, v1
    v_xor_b32 v2, 64, v165
    s_lshl_b32 s44, s33, 1
    s_add_u32 s44, s44, s37
    s_mul_i32 s45, s44, 4224
    s_mul_i32 s46, s36, 3072
    s_add_u32 s46, s46, s45
    s_lshl_b32 s47, s36, 10
    s_add_u32 s47, s47, 1024
    s_add_u32 s47, s47, s45
    s_lshl_b32 s48, s36, 6
    s_add_u32 s48, s48, 4096
    s_add_u32 s48, s48, s45
    s_lshl_b32 s49, s44, 10
    s_lshl_b32 s52, s3, 11
    s_add_u32 s52, s52, 65536
    s_lshl_b32 s53, s3, 7
    s_lshl_b32 s43, s36, 6
    s_add_u32 s53, s53, s43
    s_add_u32 s53, s53, 159232
    s_mov_b32 s50, 159068
    s_waitcnt lgkmcnt(0)
    s_lshl_b32 s64, s28, 7
    s_lshl_b32 s65, s3, 5
    s_add_u32 s64, s64, s65
    s_lshl_b32 s42, s64, 11
    s_lshl_b32 s65, s29, 7
    s_add_u32 s42, s42, s65
    s_add_u32 s43, s42, 0x8000
    s_lshl_b32 s66, s44, 1
    s_add_u32 s66, s66, s36
    s_lshl_b32 s66, s66, 4
    s_add_u32 s66, s66, s32
    s_lshl_b32 s66, s66, 10

    s_mov_b32 s12, s4
    s_mov_b32 s13, s5
    s_mov_b32 s14, 0x400000
    s_mov_b32 s15, 0x00020000
    s_mov_b32 s16, s6
    s_mov_b32 s17, s7
    s_mov_b32 s18, 0x600000
    s_mov_b32 s19, 0x00020000
    s_mov_b32 s20, s8
    s_mov_b32 s21, s9
    s_mov_b32 s22, 0x200000
    s_mov_b32 s23, 0x00020000
    s_add_u32 s24, s72, 0x800000
    s_addc_u32 s25, s73, 0
    s_mov_b32 s26, 0x48000
    s_mov_b32 s27, 0x00020000
    s_add_u32 s84, s72, 0xa00000
    s_addc_u32 s85, s73, 0
    s_mov_b32 s86, 0x100000
    s_mov_b32 s87, 0x00020000
    s_barrier
    ds_read_b128 v[12:15], v4 offset:0
    ds_read_b64_tr_b16 v[44:45], v8 offset:0
    ds_read_b64_tr_b16 v[46:47], v8 offset:512
    ds_read_b128 v[16:19], v4 offset:2048
    ds_read_b128 v[20:23], v4 offset:4096
    ds_read_b128 v[24:27], v4 offset:6144
    ds_read_b64_tr_b16 v[48:49], v9 offset:0
    ds_read_b64_tr_b16 v[50:51], v9 offset:512
    ds_read_b64_tr_b16 v[52:53], v8 offset:8192
    ds_read_b64_tr_b16 v[54:55], v8 offset:8704
    ds_read_b64_tr_b16 v[56:57], v9 offset:8192
    ds_read_b64_tr_b16 v[58:59], v9 offset:8704
    s_waitcnt lgkmcnt(9)
    v_mfma_f32_16x16x32_bf16 v[100:103], v[12:15], v[44:47], 0
    ds_read_b128 v[28:31], v5 offset:0
    s_waitcnt lgkmcnt(9)
    v_mfma_f32_16x16x32_bf16 v[104:107], v[16:19], v[44:47], 0
    ds_read_b64_tr_b16 v[60:61], v8 offset:4096
    s_waitcnt lgkmcnt(9)
    v_mfma_f32_16x16x32_bf16 v[108:111], v[20:23], v[44:47], 0
    ds_read_b64_tr_b16 v[62:63], v8 offset:4608
    s_waitcnt lgkmcnt(9)
    v_mfma_f32_16x16x32_bf16 v[112:115], v[24:27], v[44:47], 0
    ds_read_b128 v[32:35], v5 offset:2048
    s_waitcnt lgkmcnt(8)
    v_mfma_f32_16x16x32_bf16 v[116:119], v[12:15], v[48:51], 0
    ds_read_b128 v[36:39], v5 offset:4096
    v_mfma_f32_16x16x32_bf16 v[120:123], v[16:19], v[48:51], 0
    ds_read_b128 v[40:43], v5 offset:6144
    v_mfma_f32_16x16x32_bf16 v[124:127], v[20:23], v[48:51], 0
    ds_read_b64_tr_b16 v[64:65], v9 offset:4096
    v_mfma_f32_16x16x32_bf16 v[128:131], v[24:27], v[48:51], 0
    ds_read_b64_tr_b16 v[66:67], v9 offset:4608
    s_waitcnt lgkmcnt(10)
    v_mfma_f32_16x16x32_bf16 v[132:135], v[12:15], v[52:55], 0
    ds_read_b64_tr_b16 v[44:45], v8 offset:12288
    v_mfma_f32_16x16x32_bf16 v[136:139], v[16:19], v[52:55], 0
    ds_read_b64_tr_b16 v[46:47], v8 offset:12800
    v_mfma_f32_16x16x32_bf16 v[140:143], v[20:23], v[52:55], 0
    ds_read_b64_tr_b16 v[48:49], v9 offset:12288
    v_mfma_f32_16x16x32_bf16 v[144:147], v[24:27], v[52:55], 0
    ds_read_b64_tr_b16 v[50:51], v9 offset:12800
    s_waitcnt lgkmcnt(12)
    v_mfma_f32_16x16x32_bf16 v[148:151], v[12:15], v[56:59], 0
    v_mfma_f32_16x16x32_bf16 v[152:155], v[16:19], v[56:59], 0
    v_mfma_f32_16x16x32_bf16 v[156:159], v[20:23], v[56:59], 0
    v_mfma_f32_16x16x32_bf16 v[160:163], v[24:27], v[56:59], 0
    s_waitcnt lgkmcnt(9)
    v_mfma_f32_16x16x32_bf16 v[100:103], v[28:31], v[60:63], v[100:103]
    s_waitcnt lgkmcnt(8)
    v_mfma_f32_16x16x32_bf16 v[104:107], v[32:35], v[60:63], v[104:107]
    s_waitcnt lgkmcnt(0)
    s_barrier
    v_mfma_f32_16x16x32_bf16 v[108:111], v[36:39], v[60:63], v[108:111]
    ds_read_b128 v[12:15], v4 offset:16384
    v_mfma_f32_16x16x32_bf16 v[112:115], v[40:43], v[60:63], v[112:115]
    ds_read_b64_tr_b16 v[52:53], v8 offset:16384
    v_mfma_f32_16x16x32_bf16 v[116:119], v[28:31], v[64:67], v[116:119]
    ds_read_b64_tr_b16 v[54:55], v8 offset:16896
    v_mfma_f32_16x16x32_bf16 v[120:123], v[32:35], v[64:67], v[120:123]
    ds_read_b128 v[16:19], v4 offset:18432
    v_mfma_f32_16x16x32_bf16 v[124:127], v[36:39], v[64:67], v[124:127]
    ds_read_b128 v[20:23], v4 offset:20480
    v_mfma_f32_16x16x32_bf16 v[128:131], v[40:43], v[64:67], v[128:131]
    ds_read_b128 v[24:27], v4 offset:22528
    v_mfma_f32_16x16x32_bf16 v[132:135], v[28:31], v[44:47], v[132:135]
    ds_read_b64_tr_b16 v[56:57], v9 offset:16384
    v_mfma_f32_16x16x32_bf16 v[136:139], v[32:35], v[44:47], v[136:139]
    ds_read_b64_tr_b16 v[58:59], v9 offset:16896
    v_mfma_f32_16x16x32_bf16 v[140:143], v[36:39], v[44:47], v[140:143]
    ds_read_b64_tr_b16 v[60:61], v8 offset:24576
    v_mfma_f32_16x16x32_bf16 v[144:147], v[40:43], v[44:47], v[144:147]
    ds_read_b64_tr_b16 v[62:63], v8 offset:25088
    v_mfma_f32_16x16x32_bf16 v[148:151], v[28:31], v[48:51], v[148:151]
    ds_read_b64_tr_b16 v[64:65], v9 offset:24576
    v_mfma_f32_16x16x32_bf16 v[152:155], v[32:35], v[48:51], v[152:155]
    ds_read_b64_tr_b16 v[66:67], v9 offset:25088
    v_mfma_f32_16x16x32_bf16 v[156:159], v[36:39], v[48:51], v[156:159]
    v_mfma_f32_16x16x32_bf16 v[160:163], v[40:43], v[48:51], v[160:163]
    s_waitcnt lgkmcnt(9)
    v_mfma_f32_16x16x32_bf16 v[100:103], v[12:15], v[52:55], v[100:103]
    ds_read_b128 v[28:31], v5 offset:16384
    s_waitcnt lgkmcnt(9)
    v_mfma_f32_16x16x32_bf16 v[104:107], v[16:19], v[52:55], v[104:107]
    ds_read_b64_tr_b16 v[44:45], v8 offset:20480
    s_waitcnt lgkmcnt(9)
    v_mfma_f32_16x16x32_bf16 v[108:111], v[20:23], v[52:55], v[108:111]
    ds_read_b64_tr_b16 v[46:47], v8 offset:20992
    s_waitcnt lgkmcnt(9)
    v_mfma_f32_16x16x32_bf16 v[112:115], v[24:27], v[52:55], v[112:115]
    ds_read_b128 v[32:35], v5 offset:18432
    s_waitcnt lgkmcnt(8)
    v_mfma_f32_16x16x32_bf16 v[116:119], v[12:15], v[56:59], v[116:119]
    ds_read_b128 v[36:39], v5 offset:20480
    v_mfma_f32_16x16x32_bf16 v[120:123], v[16:19], v[56:59], v[120:123]
    ds_read_b128 v[40:43], v5 offset:22528
    v_mfma_f32_16x16x32_bf16 v[124:127], v[20:23], v[56:59], v[124:127]
    ds_read_b64_tr_b16 v[48:49], v9 offset:20480
    v_mfma_f32_16x16x32_bf16 v[128:131], v[24:27], v[56:59], v[128:131]
    ds_read_b64_tr_b16 v[50:51], v9 offset:20992
    s_waitcnt lgkmcnt(10)
    v_mfma_f32_16x16x32_bf16 v[132:135], v[12:15], v[60:63], v[132:135]
    ds_read_b64_tr_b16 v[52:53], v8 offset:28672
    v_mfma_f32_16x16x32_bf16 v[136:139], v[16:19], v[60:63], v[136:139]
    ds_read_b64_tr_b16 v[54:55], v8 offset:29184
    v_mfma_f32_16x16x32_bf16 v[140:143], v[20:23], v[60:63], v[140:143]
    ds_read_b64_tr_b16 v[56:57], v9 offset:28672
    v_mfma_f32_16x16x32_bf16 v[144:147], v[24:27], v[60:63], v[144:147]
    ds_read_b64_tr_b16 v[58:59], v9 offset:29184
    s_waitcnt lgkmcnt(12)
    v_mfma_f32_16x16x32_bf16 v[148:151], v[12:15], v[64:67], v[148:151]
    v_mfma_f32_16x16x32_bf16 v[152:155], v[16:19], v[64:67], v[152:155]
    v_mfma_f32_16x16x32_bf16 v[156:159], v[20:23], v[64:67], v[156:159]
    v_mfma_f32_16x16x32_bf16 v[160:163], v[24:27], v[64:67], v[160:163]
    s_waitcnt lgkmcnt(9)
    v_mfma_f32_16x16x32_bf16 v[100:103], v[28:31], v[44:47], v[100:103]
    s_waitcnt lgkmcnt(8)
    v_mfma_f32_16x16x32_bf16 v[104:107], v[32:35], v[44:47], v[104:107]
    s_waitcnt lgkmcnt(0)
    s_barrier
    v_mfma_f32_16x16x32_bf16 v[108:111], v[36:39], v[44:47], v[108:111]
    ds_read_b128 v[12:15], v4 offset:32768
    v_mfma_f32_16x16x32_bf16 v[112:115], v[40:43], v[44:47], v[112:115]
    ds_read_b64_tr_b16 v[60:61], v10 offset:16384
    v_mfma_f32_16x16x32_bf16 v[116:119], v[28:31], v[48:51], v[116:119]
    ds_read_b64_tr_b16 v[62:63], v10 offset:16896
    v_mfma_f32_16x16x32_bf16 v[120:123], v[32:35], v[48:51], v[120:123]
    ds_read_b128 v[16:19], v4 offset:34816
    v_mfma_f32_16x16x32_bf16 v[124:127], v[36:39], v[48:51], v[124:127]
    ds_read_b128 v[20:23], v4 offset:36864
    v_mfma_f32_16x16x32_bf16 v[128:131], v[40:43], v[48:51], v[128:131]
    ds_read_b128 v[24:27], v4 offset:38912
    v_mfma_f32_16x16x32_bf16 v[132:135], v[28:31], v[52:55], v[132:135]
    ds_read_b64_tr_b16 v[64:65], v11 offset:16384
    v_mfma_f32_16x16x32_bf16 v[136:139], v[32:35], v[52:55], v[136:139]
    ds_read_b64_tr_b16 v[66:67], v11 offset:16896
    v_mfma_f32_16x16x32_bf16 v[140:143], v[36:39], v[52:55], v[140:143]
    ds_read_b64_tr_b16 v[44:45], v10 offset:24576
    v_mfma_f32_16x16x32_bf16 v[144:147], v[40:43], v[52:55], v[144:147]
    ds_read_b64_tr_b16 v[46:47], v10 offset:25088
    v_mfma_f32_16x16x32_bf16 v[148:151], v[28:31], v[56:59], v[148:151]
    ds_read_b64_tr_b16 v[48:49], v11 offset:24576
    v_mfma_f32_16x16x32_bf16 v[152:155], v[32:35], v[56:59], v[152:155]
    ds_read_b64_tr_b16 v[50:51], v11 offset:25088
    v_mfma_f32_16x16x32_bf16 v[156:159], v[36:39], v[56:59], v[156:159]
    v_mfma_f32_16x16x32_bf16 v[160:163], v[40:43], v[56:59], v[160:163]
    s_waitcnt lgkmcnt(9)
    v_mfma_f32_16x16x32_bf16 v[100:103], v[12:15], v[60:63], v[100:103]
    ds_read_b128 v[28:31], v5 offset:32768
    s_waitcnt lgkmcnt(9)
    v_mfma_f32_16x16x32_bf16 v[104:107], v[16:19], v[60:63], v[104:107]
    ds_read_b64_tr_b16 v[52:53], v10 offset:20480
    s_waitcnt lgkmcnt(9)
    v_mfma_f32_16x16x32_bf16 v[108:111], v[20:23], v[60:63], v[108:111]
    ds_read_b64_tr_b16 v[54:55], v10 offset:20992
    s_waitcnt lgkmcnt(9)
    v_mfma_f32_16x16x32_bf16 v[112:115], v[24:27], v[60:63], v[112:115]
    ds_read_b128 v[32:35], v5 offset:34816
    s_waitcnt lgkmcnt(8)
    v_mfma_f32_16x16x32_bf16 v[116:119], v[12:15], v[64:67], v[116:119]
    ds_read_b128 v[36:39], v5 offset:36864
    v_mfma_f32_16x16x32_bf16 v[120:123], v[16:19], v[64:67], v[120:123]
    ds_read_b128 v[40:43], v5 offset:38912
    v_mfma_f32_16x16x32_bf16 v[124:127], v[20:23], v[64:67], v[124:127]
    ds_read_b64_tr_b16 v[56:57], v11 offset:20480
    v_mfma_f32_16x16x32_bf16 v[128:131], v[24:27], v[64:67], v[128:131]
    ds_read_b64_tr_b16 v[58:59], v11 offset:20992
    s_waitcnt lgkmcnt(10)
    v_mfma_f32_16x16x32_bf16 v[132:135], v[12:15], v[44:47], v[132:135]
    ds_read_b64_tr_b16 v[60:61], v10 offset:28672
    v_mfma_f32_16x16x32_bf16 v[136:139], v[16:19], v[44:47], v[136:139]
    ds_read_b64_tr_b16 v[62:63], v10 offset:29184
    v_mfma_f32_16x16x32_bf16 v[140:143], v[20:23], v[44:47], v[140:143]
    ds_read_b64_tr_b16 v[64:65], v11 offset:28672
    v_mfma_f32_16x16x32_bf16 v[144:147], v[24:27], v[44:47], v[144:147]
    ds_read_b64_tr_b16 v[66:67], v11 offset:29184
    s_waitcnt lgkmcnt(12)
    v_mfma_f32_16x16x32_bf16 v[148:151], v[12:15], v[48:51], v[148:151]
    v_mfma_f32_16x16x32_bf16 v[152:155], v[16:19], v[48:51], v[152:155]
    v_mfma_f32_16x16x32_bf16 v[156:159], v[20:23], v[48:51], v[156:159]
    v_mfma_f32_16x16x32_bf16 v[160:163], v[24:27], v[48:51], v[160:163]
    s_waitcnt lgkmcnt(9)
    v_mfma_f32_16x16x32_bf16 v[100:103], v[28:31], v[52:55], v[100:103]
    s_waitcnt lgkmcnt(8)
    v_mfma_f32_16x16x32_bf16 v[104:107], v[32:35], v[52:55], v[104:107]
    s_branch IW_s3
IW_w3:
    s_branch IW_r3
IW_s3:
    s_waitcnt lgkmcnt(0)
    s_barrier
    v_mfma_f32_16x16x32_bf16 v[108:111], v[36:39], v[52:55], v[108:111]
    ds_read_b128 v[12:15], v4 offset:49152
    v_mfma_f32_16x16x32_bf16 v[112:115], v[40:43], v[52:55], v[112:115]
    ds_read_b64_tr_b16 v[44:45], v10 offset:32768
    v_mfma_f32_16x16x32_bf16 v[116:119], v[28:31], v[56:59], v[116:119]
    ds_read_b64_tr_b16 v[46:47], v10 offset:33280
    v_mfma_f32_16x16x32_bf16 v[120:123], v[32:35], v[56:59], v[120:123]
    ds_read_b128 v[16:19], v4 offset:51200
    v_mfma_f32_16x16x32_bf16 v[124:127], v[36:39], v[56:59], v[124:127]
    ds_read_b128 v[20:23], v4 offset:53248
    v_mfma_f32_16x16x32_bf16 v[128:131], v[40:43], v[56:59], v[128:131]
    ds_read_b128 v[24:27], v4 offset:55296
    v_mfma_f32_16x16x32_bf16 v[132:135], v[28:31], v[60:63], v[132:135]
    ds_read_b64_tr_b16 v[48:49], v11 offset:32768
    v_mfma_f32_16x16x32_bf16 v[136:139], v[32:35], v[60:63], v[136:139]
    ds_read_b64_tr_b16 v[50:51], v11 offset:33280
    v_mfma_f32_16x16x32_bf16 v[140:143], v[36:39], v[60:63], v[140:143]
    ds_read_b64_tr_b16 v[52:53], v8 offset:0
    v_mfma_f32_16x16x32_bf16 v[144:147], v[40:43], v[60:63], v[144:147]
    ds_read_b64_tr_b16 v[54:55], v8 offset:512
    v_mfma_f32_16x16x32_bf16 v[148:151], v[28:31], v[64:67], v[148:151]
    ds_read_b64_tr_b16 v[56:57], v9 offset:0
    v_mfma_f32_16x16x32_bf16 v[152:155], v[32:35], v[64:67], v[152:155]
    ds_read_b64_tr_b16 v[58:59], v9 offset:512
    v_mfma_f32_16x16x32_bf16 v[156:159], v[36:39], v[64:67], v[156:159]
    v_mfma_f32_16x16x32_bf16 v[160:163], v[40:43], v[64:67], v[160:163]
    s_waitcnt lgkmcnt(9)
    v_mfma_f32_16x16x32_bf16 v[100:103], v[12:15], v[44:47], v[100:103]
    ds_read_b128 v[28:31], v5 offset:49152
    s_waitcnt lgkmcnt(9)
    v_mfma_f32_16x16x32_bf16 v[104:107], v[16:19], v[44:47], v[104:107]
    ds_read_b64_tr_b16 v[60:61], v10 offset:36864
    s_waitcnt lgkmcnt(9)
    v_mfma_f32_16x16x32_bf16 v[108:111], v[20:23], v[44:47], v[108:111]
    ds_read_b64_tr_b16 v[62:63], v10 offset:37376
    s_waitcnt lgkmcnt(9)
    v_mfma_f32_16x16x32_bf16 v[112:115], v[24:27], v[44:47], v[112:115]
    ds_read_b128 v[32:35], v5 offset:51200
    s_waitcnt lgkmcnt(8)
    v_mfma_f32_16x16x32_bf16 v[116:119], v[12:15], v[48:51], v[116:119]
    ds_read_b128 v[36:39], v5 offset:53248
    v_mfma_f32_16x16x32_bf16 v[120:123], v[16:19], v[48:51], v[120:123]
    ds_read_b128 v[40:43], v5 offset:55296
    v_mfma_f32_16x16x32_bf16 v[124:127], v[20:23], v[48:51], v[124:127]
    ds_read_b64_tr_b16 v[64:65], v11 offset:36864
    v_mfma_f32_16x16x32_bf16 v[128:131], v[24:27], v[48:51], v[128:131]
    ds_read_b64_tr_b16 v[66:67], v11 offset:37376
    s_waitcnt lgkmcnt(10)
    v_mfma_f32_16x16x32_bf16 v[132:135], v[12:15], v[52:55], v[132:135]
    ds_read_b64_tr_b16 v[44:45], v8 offset:4096
    v_mfma_f32_16x16x32_bf16 v[136:139], v[16:19], v[52:55], v[136:139]
    ds_read_b64_tr_b16 v[46:47], v8 offset:4608
    v_mfma_f32_16x16x32_bf16 v[140:143], v[20:23], v[52:55], v[140:143]
    ds_read_b64_tr_b16 v[48:49], v9 offset:4096
    v_mfma_f32_16x16x32_bf16 v[144:147], v[24:27], v[52:55], v[144:147]
    ds_read_b64_tr_b16 v[50:51], v9 offset:4608
    s_waitcnt lgkmcnt(12)
    v_mfma_f32_16x16x32_bf16 v[148:151], v[12:15], v[56:59], v[148:151]
    v_mfma_f32_16x16x32_bf16 v[152:155], v[16:19], v[56:59], v[152:155]
    v_mfma_f32_16x16x32_bf16 v[156:159], v[20:23], v[56:59], v[156:159]
    v_mfma_f32_16x16x32_bf16 v[160:163], v[24:27], v[56:59], v[160:163]
    s_waitcnt lgkmcnt(9)
    v_mfma_f32_16x16x32_bf16 v[100:103], v[28:31], v[60:63], v[100:103]
    s_waitcnt lgkmcnt(8)
    v_mfma_f32_16x16x32_bf16 v[104:107], v[32:35], v[60:63], v[104:107]
    s_waitcnt lgkmcnt(0)
    s_barrier
    v_mfma_f32_16x16x32_bf16 v[108:111], v[36:39], v[60:63], v[108:111]
    ds_read_b128 v[12:15], v4 offset:0
    v_mfma_f32_16x16x32_bf16 v[112:115], v[40:43], v[60:63], v[112:115]
    ds_read_b64_tr_b16 v[52:53], v8 offset:8192
    v_mfma_f32_16x16x32_bf16 v[116:119], v[28:31], v[64:67], v[116:119]
    ds_read_b64_tr_b16 v[54:55], v8 offset:8704
    v_mfma_f32_16x16x32_bf16 v[120:123], v[32:35], v[64:67], v[120:123]
    ds_read_b128 v[16:19], v4 offset:2048
    v_mfma_f32_16x16x32_bf16 v[124:127], v[36:39], v[64:67], v[124:127]
    ds_read_b128 v[20:23], v4 offset:4096
    v_mfma_f32_16x16x32_bf16 v[128:131], v[40:43], v[64:67], v[128:131]
    ds_read_b128 v[24:27], v4 offset:6144
    v_mfma_f32_16x16x32_bf16 v[132:135], v[28:31], v[44:47], v[132:135]
    ds_read_b64_tr_b16 v[56:57], v9 offset:8192
    v_mfma_f32_16x16x32_bf16 v[136:139], v[32:35], v[44:47], v[136:139]
    ds_read_b64_tr_b16 v[58:59], v9 offset:8704
    v_mfma_f32_16x16x32_bf16 v[140:143], v[36:39], v[44:47], v[140:143]
    ds_read_b64_tr_b16 v[60:61], v8 offset:16384
    v_mfma_f32_16x16x32_bf16 v[144:147], v[40:43], v[44:47], v[144:147]
    ds_read_b64_tr_b16 v[62:63], v8 offset:16896
    v_mfma_f32_16x16x32_bf16 v[148:151], v[28:31], v[48:51], v[148:151]
    ds_read_b64_tr_b16 v[64:65], v9 offset:16384
    v_mfma_f32_16x16x32_bf16 v[152:155], v[32:35], v[48:51], v[152:155]
    ds_read_b64_tr_b16 v[66:67], v9 offset:16896
    v_mfma_f32_16x16x32_bf16 v[156:159], v[36:39], v[48:51], v[156:159]
    v_mfma_f32_16x16x32_bf16 v[160:163], v[40:43], v[48:51], v[160:163]
    s_waitcnt lgkmcnt(9)
    v_mfma_f32_16x16x32_bf16 v[100:103], v[12:15], v[52:55], v[100:103]
    ds_read_b128 v[28:31], v5 offset:0
    s_waitcnt lgkmcnt(9)
    v_mfma_f32_16x16x32_bf16 v[104:107], v[16:19], v[52:55], v[104:107]
    ds_read_b64_tr_b16 v[44:45], v8 offset:12288
    s_waitcnt lgkmcnt(9)
    v_mfma_f32_16x16x32_bf16 v[108:111], v[20:23], v[52:55], v[108:111]
    ds_read_b64_tr_b16 v[46:47], v8 offset:12800
    s_waitcnt lgkmcnt(9)
    v_mfma_f32_16x16x32_bf16 v[112:115], v[24:27], v[52:55], v[112:115]
    ds_read_b128 v[32:35], v5 offset:2048
    s_waitcnt lgkmcnt(8)
    v_mfma_f32_16x16x32_bf16 v[116:119], v[12:15], v[56:59], v[116:119]
    ds_read_b128 v[36:39], v5 offset:4096
    v_mfma_f32_16x16x32_bf16 v[120:123], v[16:19], v[56:59], v[120:123]
    ds_read_b128 v[40:43], v5 offset:6144
    v_mfma_f32_16x16x32_bf16 v[124:127], v[20:23], v[56:59], v[124:127]
    ds_read_b64_tr_b16 v[48:49], v9 offset:12288
    v_mfma_f32_16x16x32_bf16 v[128:131], v[24:27], v[56:59], v[128:131]
    ds_read_b64_tr_b16 v[50:51], v9 offset:12800
    s_waitcnt lgkmcnt(10)
    v_mfma_f32_16x16x32_bf16 v[132:135], v[12:15], v[60:63], v[132:135]
    ds_read_b64_tr_b16 v[52:53], v8 offset:20480
    v_mfma_f32_16x16x32_bf16 v[136:139], v[16:19], v[60:63], v[136:139]
    ds_read_b64_tr_b16 v[54:55], v8 offset:20992
    v_mfma_f32_16x16x32_bf16 v[140:143], v[20:23], v[60:63], v[140:143]
    ds_read_b64_tr_b16 v[56:57], v9 offset:20480
    v_mfma_f32_16x16x32_bf16 v[144:147], v[24:27], v[60:63], v[144:147]
    ds_read_b64_tr_b16 v[58:59], v9 offset:20992
    s_waitcnt lgkmcnt(12)
    v_mfma_f32_16x16x32_bf16 v[148:151], v[12:15], v[64:67], v[148:151]
    v_mfma_f32_16x16x32_bf16 v[152:155], v[16:19], v[64:67], v[152:155]
    v_mfma_f32_16x16x32_bf16 v[156:159], v[20:23], v[64:67], v[156:159]
    v_mfma_f32_16x16x32_bf16 v[160:163], v[24:27], v[64:67], v[160:163]
    s_waitcnt lgkmcnt(9)
    v_mfma_f32_16x16x32_bf16 v[100:103], v[28:31], v[44:47], v[100:103]
    s_waitcnt lgkmcnt(8)
    v_mfma_f32_16x16x32_bf16 v[104:107], v[32:35], v[44:47], v[104:107]
    s_waitcnt lgkmcnt(0)
    s_barrier
    v_mfma_f32_16x16x32_bf16 v[108:111], v[36:39], v[44:47], v[108:111]
    ds_read_b128 v[12:15], v4 offset:16384
    v_mfma_f32_16x16x32_bf16 v[112:115], v[40:43], v[44:47], v[112:115]
    ds_read_b64_tr_b16 v[60:61], v10 offset:0
    v_mfma_f32_16x16x32_bf16 v[116:119], v[28:31], v[48:51], v[116:119]
    ds_read_b64_tr_b16 v[62:63], v10 offset:512
    v_mfma_f32_16x16x32_bf16 v[120:123], v[32:35], v[48:51], v[120:123]
    ds_read_b128 v[16:19], v4 offset:18432
    v_mfma_f32_16x16x32_bf16 v[124:127], v[36:39], v[48:51], v[124:127]
    ds_read_b128 v[20:23], v4 offset:20480
    v_mfma_f32_16x16x32_bf16 v[128:131], v[40:43], v[48:51], v[128:131]
    ds_read_b128 v[24:27], v4 offset:22528
    v_mfma_f32_16x16x32_bf16 v[132:135], v[28:31], v[52:55], v[132:135]
    ds_read_b64_tr_b16 v[64:65], v11 offset:0
    v_mfma_f32_16x16x32_bf16 v[136:139], v[32:35], v[52:55], v[136:139]
    ds_read_b64_tr_b16 v[66:67], v11 offset:512
    v_mfma_f32_16x16x32_bf16 v[140:143], v[36:39], v[52:55], v[140:143]
    ds_read_b64_tr_b16 v[44:45], v10 offset:8192
    v_mfma_f32_16x16x32_bf16 v[144:147], v[40:43], v[52:55], v[144:147]
    ds_read_b64_tr_b16 v[46:47], v10 offset:8704
    v_mfma_f32_16x16x32_bf16 v[148:151], v[28:31], v[56:59], v[148:151]
    ds_read_b64_tr_b16 v[48:49], v11 offset:8192
    v_mfma_f32_16x16x32_bf16 v[152:155], v[32:35], v[56:59], v[152:155]
    ds_read_b64_tr_b16 v[50:51], v11 offset:8704
    v_mfma_f32_16x16x32_bf16 v[156:159], v[36:39], v[56:59], v[156:159]
    v_mfma_f32_16x16x32_bf16 v[160:163], v[40:43], v[56:59], v[160:163]
    s_waitcnt lgkmcnt(9)
    v_mfma_f32_16x16x32_bf16 v[100:103], v[12:15], v[60:63], v[100:103]
    ds_read_b128 v[28:31], v5 offset:16384
    s_waitcnt lgkmcnt(9)
    v_mfma_f32_16x16x32_bf16 v[104:107], v[16:19], v[60:63], v[104:107]
    ds_read_b64_tr_b16 v[52:53], v10 offset:4096
    s_waitcnt lgkmcnt(9)
    v_mfma_f32_16x16x32_bf16 v[108:111], v[20:23], v[60:63], v[108:111]
    ds_read_b64_tr_b16 v[54:55], v10 offset:4608
    s_waitcnt lgkmcnt(9)
    v_mfma_f32_16x16x32_bf16 v[112:115], v[24:27], v[60:63], v[112:115]
    ds_read_b128 v[32:35], v5 offset:18432
    s_waitcnt lgkmcnt(8)
    v_mfma_f32_16x16x32_bf16 v[116:119], v[12:15], v[64:67], v[116:119]
    ds_read_b128 v[36:39], v5 offset:20480
    v_mfma_f32_16x16x32_bf16 v[120:123], v[16:19], v[64:67], v[120:123]
    ds_read_b128 v[40:43], v5 offset:22528
    v_mfma_f32_16x16x32_bf16 v[124:127], v[20:23], v[64:67], v[124:127]
    ds_read_b64_tr_b16 v[56:57], v11 offset:4096
    v_mfma_f32_16x16x32_bf16 v[128:131], v[24:27], v[64:67], v[128:131]
    ds_read_b64_tr_b16 v[58:59], v11 offset:4608
    s_waitcnt lgkmcnt(10)
    v_mfma_f32_16x16x32_bf16 v[132:135], v[12:15], v[44:47], v[132:135]
    ds_read_b64_tr_b16 v[60:61], v10 offset:12288
    v_mfma_f32_16x16x32_bf16 v[136:139], v[16:19], v[44:47], v[136:139]
    ds_read_b64_tr_b16 v[62:63], v10 offset:12800
    v_mfma_f32_16x16x32_bf16 v[140:143], v[20:23], v[44:47], v[140:143]
    ds_read_b64_tr_b16 v[64:65], v11 offset:12288
    v_mfma_f32_16x16x32_bf16 v[144:147], v[24:27], v[44:47], v[144:147]
    ds_read_b64_tr_b16 v[66:67], v11 offset:12800
    s_waitcnt lgkmcnt(12)
    v_mfma_f32_16x16x32_bf16 v[148:151], v[12:15], v[48:51], v[148:151]
    v_mfma_f32_16x16x32_bf16 v[152:155], v[16:19], v[48:51], v[152:155]
    v_mfma_f32_16x16x32_bf16 v[156:159], v[20:23], v[48:51], v[156:159]
    v_mfma_f32_16x16x32_bf16 v[160:163], v[24:27], v[48:51], v[160:163]
    s_waitcnt lgkmcnt(9)
    v_mfma_f32_16x16x32_bf16 v[100:103], v[28:31], v[52:55], v[100:103]
    s_waitcnt lgkmcnt(8)
    v_mfma_f32_16x16x32_bf16 v[104:107], v[32:35], v[52:55], v[104:107]
    s_waitcnt lgkmcnt(0)
    s_barrier
    v_mfma_f32_16x16x32_bf16 v[108:111], v[36:39], v[52:55], v[108:111]
    ds_read_b128 v[12:15], v4 offset:32768
    v_mfma_f32_16x16x32_bf16 v[112:115], v[40:43], v[52:55], v[112:115]
    ds_read_b64_tr_b16 v[44:45], v10 offset:16384
    v_mfma_f32_16x16x32_bf16 v[116:119], v[28:31], v[56:59], v[116:119]
    ds_read_b64_tr_b16 v[46:47], v10 offset:16896
    v_mfma_f32_16x16x32_bf16 v[120:123], v[32:35], v[56:59], v[120:123]
    ds_read_b128 v[16:19], v4 offset:34816
    v_mfma_f32_16x16x32_bf16 v[124:127], v[36:39], v[56:59], v[124:127]
    ds_read_b128 v[20:23], v4 offset:36864
    v_mfma_f32_16x16x32_bf16 v[128:131], v[40:43], v[56:59], v[128:131]
    ds_read_b128 v[24:27], v4 offset:38912
    v_mfma_f32_16x16x32_bf16 v[132:135], v[28:31], v[60:63], v[132:135]
    ds_read_b64_tr_b16 v[48:49], v11 offset:16384
    v_mfma_f32_16x16x32_bf16 v[136:139], v[32:35], v[60:63], v[136:139]
    ds_read_b64_tr_b16 v[50:51], v11 offset:16896
    v_mfma_f32_16x16x32_bf16 v[140:143], v[36:39], v[60:63], v[140:143]
    ds_read_b64_tr_b16 v[52:53], v10 offset:24576
    v_mfma_f32_16x16x32_bf16 v[144:147], v[40:43], v[60:63], v[144:147]
    ds_read_b64_tr_b16 v[54:55], v10 offset:25088
    v_mfma_f32_16x16x32_bf16 v[148:151], v[28:31], v[64:67], v[148:151]
    ds_read_b64_tr_b16 v[56:57], v11 offset:24576
    v_mfma_f32_16x16x32_bf16 v[152:155], v[32:35], v[64:67], v[152:155]
    ds_read_b64_tr_b16 v[58:59], v11 offset:25088
    v_mfma_f32_16x16x32_bf16 v[156:159], v[36:39], v[64:67], v[156:159]
    v_mfma_f32_16x16x32_bf16 v[160:163], v[40:43], v[64:67], v[160:163]
    s_waitcnt lgkmcnt(9)
    v_mfma_f32_16x16x32_bf16 v[100:103], v[12:15], v[44:47], v[100:103]
    ds_read_b128 v[28:31], v5 offset:32768
    s_waitcnt lgkmcnt(9)
    v_mfma_f32_16x16x32_bf16 v[104:107], v[16:19], v[44:47], v[104:107]
    ds_read_b64_tr_b16 v[60:61], v10 offset:20480
    s_waitcnt lgkmcnt(9)
    v_mfma_f32_16x16x32_bf16 v[108:111], v[20:23], v[44:47], v[108:111]
    ds_read_b64_tr_b16 v[62:63], v10 offset:20992
    s_waitcnt lgkmcnt(9)
    v_mfma_f32_16x16x32_bf16 v[112:115], v[24:27], v[44:47], v[112:115]
    ds_read_b128 v[32:35], v5 offset:34816
    s_waitcnt lgkmcnt(8)
    v_mfma_f32_16x16x32_bf16 v[116:119], v[12:15], v[48:51], v[116:119]
    ds_read_b128 v[36:39], v5 offset:36864
    v_mfma_f32_16x16x32_bf16 v[120:123], v[16:19], v[48:51], v[120:123]
    ds_read_b128 v[40:43], v5 offset:38912
    v_mfma_f32_16x16x32_bf16 v[124:127], v[20:23], v[48:51], v[124:127]
    ds_read_b64_tr_b16 v[64:65], v11 offset:20480
    v_mfma_f32_16x16x32_bf16 v[128:131], v[24:27], v[48:51], v[128:131]
    ds_read_b64_tr_b16 v[66:67], v11 offset:20992
    s_waitcnt lgkmcnt(10)
    v_mfma_f32_16x16x32_bf16 v[132:135], v[12:15], v[52:55], v[132:135]
    ds_read_b64_tr_b16 v[44:45], v10 offset:28672
    v_mfma_f32_16x16x32_bf16 v[136:139], v[16:19], v[52:55], v[136:139]
    ds_read_b64_tr_b16 v[46:47], v10 offset:29184
    v_mfma_f32_16x16x32_bf16 v[140:143], v[20:23], v[52:55], v[140:143]
    ds_read_b64_tr_b16 v[48:49], v11 offset:28672
    v_mfma_f32_16x16x32_bf16 v[144:147], v[24:27], v[52:55], v[144:147]
    ds_read_b64_tr_b16 v[50:51], v11 offset:29184
    s_waitcnt lgkmcnt(12)
    v_mfma_f32_16x16x32_bf16 v[148:151], v[12:15], v[56:59], v[148:151]
    v_mfma_f32_16x16x32_bf16 v[152:155], v[16:19], v[56:59], v[152:155]
    v_mfma_f32_16x16x32_bf16 v[156:159], v[20:23], v[56:59], v[156:159]
    v_mfma_f32_16x16x32_bf16 v[160:163], v[24:27], v[56:59], v[160:163]
    s_waitcnt lgkmcnt(9)
    v_mfma_f32_16x16x32_bf16 v[100:103], v[28:31], v[60:63], v[100:103]
    s_waitcnt lgkmcnt(8)
    v_mfma_f32_16x16x32_bf16 v[104:107], v[32:35], v[60:63], v[104:107]
    s_waitcnt lgkmcnt(0)
    s_barrier
    v_mfma_f32_16x16x32_bf16 v[108:111], v[36:39], v[60:63], v[108:111]
    ds_read_b128 v[12:15], v4 offset:49152
    v_mfma_f32_16x16x32_bf16 v[112:115], v[40:43], v[60:63], v[112:115]
    ds_read_b64_tr_b16 v[52:53], v8 offset:0
    v_mfma_f32_16x16x32_bf16 v[116:119], v[28:31], v[64:67], v[116:119]
    ds_read_b64_tr_b16 v[54:55], v8 offset:512
    v_mfma_f32_16x16x32_bf16 v[120:123], v[32:35], v[64:67], v[120:123]
    ds_read_b128 v[16:19], v4 offset:51200
    v_mfma_f32_16x16x32_bf16 v[124:127], v[36:39], v[64:67], v[124:127]
    ds_read_b128 v[20:23], v4 offset:53248
    v_mfma_f32_16x16x32_bf16 v[128:131], v[40:43], v[64:67], v[128:131]
    ds_read_b128 v[24:27], v4 offset:55296
    v_mfma_f32_16x16x32_bf16 v[132:135], v[28:31], v[44:47], v[132:135]
    ds_read_b64_tr_b16 v[56:57], v9 offset:0
    v_mfma_f32_16x16x32_bf16 v[136:139], v[32:35], v[44:47], v[136:139]
    ds_read_b64_tr_b16 v[58:59], v9 offset:512
    v_mfma_f32_16x16x32_bf16 v[140:143], v[36:39], v[44:47], v[140:143]
    ds_read_b64_tr_b16 v[60:61], v10 offset:32768
    v_mfma_f32_16x16x32_bf16 v[144:147], v[40:43], v[44:47], v[144:147]
    ds_read_b64_tr_b16 v[62:63], v10 offset:33280
    v_mfma_f32_16x16x32_bf16 v[148:151], v[28:31], v[48:51], v[148:151]
    ds_read_b64_tr_b16 v[64:65], v11 offset:32768
    v_mfma_f32_16x16x32_bf16 v[152:155], v[32:35], v[48:51], v[152:155]
    ds_read_b64_tr_b16 v[66:67], v11 offset:33280
    v_mfma_f32_16x16x32_bf16 v[156:159], v[36:39], v[48:51], v[156:159]
    v_mfma_f32_16x16x32_bf16 v[160:163], v[40:43], v[48:51], v[160:163]
    s_waitcnt lgkmcnt(9)
    v_mfma_f32_16x16x32_bf16 v[100:103], v[12:15], v[52:55], v[100:103]
    ds_read_b128 v[28:31], v5 offset:49152
    s_waitcnt lgkmcnt(9)
    v_mfma_f32_16x16x32_bf16 v[104:107], v[16:19], v[52:55], v[104:107]
    ds_read_b64_tr_b16 v[44:45], v8 offset:4096
    s_waitcnt lgkmcnt(9)
    v_mfma_f32_16x16x32_bf16 v[108:111], v[20:23], v[52:55], v[108:111]
    ds_read_b64_tr_b16 v[46:47], v8 offset:4608
    s_waitcnt lgkmcnt(9)
    v_mfma_f32_16x16x32_bf16 v[112:115], v[24:27], v[52:55], v[112:115]
    ds_read_b128 v[32:35], v5 offset:51200
    s_waitcnt lgkmcnt(8)
    v_mfma_f32_16x16x32_bf16 v[116:119], v[12:15], v[56:59], v[116:119]
    ds_read_b128 v[36:39], v5 offset:53248
    v_mfma_f32_16x16x32_bf16 v[120:123], v[16:19], v[56:59], v[120:123]
    ds_read_b128 v[40:43], v5 offset:55296
    v_mfma_f32_16x16x32_bf16 v[124:127], v[20:23], v[56:59], v[124:127]
    ds_read_b64_tr_b16 v[48:49], v9 offset:4096
    v_mfma_f32_16x16x32_bf16 v[128:131], v[24:27], v[56:59], v[128:131]
    ds_read_b64_tr_b16 v[50:51], v9 offset:4608
    s_waitcnt lgkmcnt(10)
    v_mfma_f32_16x16x32_bf16 v[132:135], v[12:15], v[60:63], v[132:135]
    ds_read_b64_tr_b16 v[52:53], v10 offset:36864
    v_mfma_f32_16x16x32_bf16 v[136:139], v[16:19], v[60:63], v[136:139]
    ds_read_b64_tr_b16 v[54:55], v10 offset:37376
    v_mfma_f32_16x16x32_bf16 v[140:143], v[20:23], v[60:63], v[140:143]
    ds_read_b64_tr_b16 v[56:57], v11 offset:36864
    v_mfma_f32_16x16x32_bf16 v[144:147], v[24:27], v[60:63], v[144:147]
    ds_read_b64_tr_b16 v[58:59], v11 offset:37376
    s_waitcnt lgkmcnt(12)
    v_mfma_f32_16x16x32_bf16 v[148:151], v[12:15], v[64:67], v[148:151]
    v_mfma_f32_16x16x32_bf16 v[152:155], v[16:19], v[64:67], v[152:155]
    v_mfma_f32_16x16x32_bf16 v[156:159], v[20:23], v[64:67], v[156:159]
    v_mfma_f32_16x16x32_bf16 v[160:163], v[24:27], v[64:67], v[160:163]
    s_waitcnt lgkmcnt(9)
    v_mfma_f32_16x16x32_bf16 v[100:103], v[28:31], v[44:47], v[100:103]
    s_waitcnt lgkmcnt(8)
    v_mfma_f32_16x16x32_bf16 v[104:107], v[32:35], v[44:47], v[104:107]
    s_waitcnt lgkmcnt(0)
    s_barrier
    v_mfma_f32_16x16x32_bf16 v[108:111], v[36:39], v[44:47], v[108:111]
    ds_read_b128 v[12:15], v4 offset:0
    v_mfma_f32_16x16x32_bf16 v[112:115], v[40:43], v[44:47], v[112:115]
    ds_read_b64_tr_b16 v[60:61], v8 offset:8192
    v_mfma_f32_16x16x32_bf16 v[116:119], v[28:31], v[48:51], v[116:119]
    ds_read_b64_tr_b16 v[62:63], v8 offset:8704
    v_mfma_f32_16x16x32_bf16 v[120:123], v[32:35], v[48:51], v[120:123]
    ds_read_b128 v[16:19], v4 offset:2048
    v_mfma_f32_16x16x32_bf16 v[124:127], v[36:39], v[48:51], v[124:127]
    ds_read_b128 v[20:23], v4 offset:4096
    v_mfma_f32_16x16x32_bf16 v[128:131], v[40:43], v[48:51], v[128:131]
    ds_read_b128 v[24:27], v4 offset:6144
    v_mfma_f32_16x16x32_bf16 v[132:135], v[28:31], v[52:55], v[132:135]
    ds_read_b64_tr_b16 v[64:65], v9 offset:8192
    v_mfma_f32_16x16x32_bf16 v[136:139], v[32:35], v[52:55], v[136:139]
    ds_read_b64_tr_b16 v[66:67], v9 offset:8704
    v_mfma_f32_16x16x32_bf16 v[140:143], v[36:39], v[52:55], v[140:143]
    ds_read_b64_tr_b16 v[44:45], v8 offset:16384
    v_mfma_f32_16x16x32_bf16 v[144:147], v[40:43], v[52:55], v[144:147]
    ds_read_b64_tr_b16 v[46:47], v8 offset:16896
    v_mfma_f32_16x16x32_bf16 v[148:151], v[28:31], v[56:59], v[148:151]
    ds_read_b64_tr_b16 v[48:49], v9 offset:16384
    v_mfma_f32_16x16x32_bf16 v[152:155], v[32:35], v[56:59], v[152:155]
    ds_read_b64_tr_b16 v[50:51], v9 offset:16896
    v_mfma_f32_16x16x32_bf16 v[156:159], v[36:39], v[56:59], v[156:159]
    v_mfma_f32_16x16x32_bf16 v[160:163], v[40:43], v[56:59], v[160:163]
    s_waitcnt lgkmcnt(9)
    v_mfma_f32_16x16x32_bf16 v[100:103], v[12:15], v[60:63], v[100:103]
    ds_read_b128 v[28:31], v5 offset:0
    s_waitcnt lgkmcnt(9)
    v_mfma_f32_16x16x32_bf16 v[104:107], v[16:19], v[60:63], v[104:107]
    ds_read_b64_tr_b16 v[52:53], v8 offset:12288
    s_waitcnt lgkmcnt(9)
    v_mfma_f32_16x16x32_bf16 v[108:111], v[20:23], v[60:63], v[108:111]
    ds_read_b64_tr_b16 v[54:55], v8 offset:12800
    s_waitcnt lgkmcnt(9)
    v_mfma_f32_16x16x32_bf16 v[112:115], v[24:27], v[60:63], v[112:115]
    ds_read_b128 v[32:35], v5 offset:2048
    s_waitcnt lgkmcnt(8)
    v_mfma_f32_16x16x32_bf16 v[116:119], v[12:15], v[64:67], v[116:119]
    ds_read_b128 v[36:39], v5 offset:4096
    v_mfma_f32_16x16x32_bf16 v[120:123], v[16:19], v[64:67], v[120:123]
    ds_read_b128 v[40:43], v5 offset:6144
    v_mfma_f32_16x16x32_bf16 v[124:127], v[20:23], v[64:67], v[124:127]
    ds_read_b64_tr_b16 v[56:57], v9 offset:12288
    v_mfma_f32_16x16x32_bf16 v[128:131], v[24:27], v[64:67], v[128:131]
    ds_read_b64_tr_b16 v[58:59], v9 offset:12800
    s_waitcnt lgkmcnt(10)
    v_mfma_f32_16x16x32_bf16 v[132:135], v[12:15], v[44:47], v[132:135]
    ds_read_b64_tr_b16 v[60:61], v8 offset:20480
    v_mfma_f32_16x16x32_bf16 v[136:139], v[16:19], v[44:47], v[136:139]
    ds_read_b64_tr_b16 v[62:63], v8 offset:20992
    v_mfma_f32_16x16x32_bf16 v[140:143], v[20:23], v[44:47], v[140:143]
    ds_read_b64_tr_b16 v[64:65], v9 offset:20480
    v_mfma_f32_16x16x32_bf16 v[144:147], v[24:27], v[44:47], v[144:147]
    ds_read_b64_tr_b16 v[66:67], v9 offset:20992
    s_waitcnt lgkmcnt(12)
    v_mfma_f32_16x16x32_bf16 v[148:151], v[12:15], v[48:51], v[148:151]
    v_mfma_f32_16x16x32_bf16 v[152:155], v[16:19], v[48:51], v[152:155]
    v_mfma_f32_16x16x32_bf16 v[156:159], v[20:23], v[48:51], v[156:159]
    v_mfma_f32_16x16x32_bf16 v[160:163], v[24:27], v[48:51], v[160:163]
    s_waitcnt lgkmcnt(9)
    v_mfma_f32_16x16x32_bf16 v[100:103], v[28:31], v[52:55], v[100:103]
    s_waitcnt lgkmcnt(8)
    v_mfma_f32_16x16x32_bf16 v[104:107], v[32:35], v[52:55], v[104:107]
    s_waitcnt lgkmcnt(0)
    s_barrier
    v_mfma_f32_16x16x32_bf16 v[108:111], v[36:39], v[52:55], v[108:111]
    ds_read_b128 v[12:15], v4 offset:16384
    v_mfma_f32_16x16x32_bf16 v[112:115], v[40:43], v[52:55], v[112:115]
    ds_read_b64_tr_b16 v[44:45], v8 offset:24576
    v_mfma_f32_16x16x32_bf16 v[116:119], v[28:31], v[56:59], v[116:119]
    ds_read_b64_tr_b16 v[46:47], v8 offset:25088
    v_mfma_f32_16x16x32_bf16 v[120:123], v[32:35], v[56:59], v[120:123]
    ds_read_b128 v[16:19], v4 offset:18432
    v_mfma_f32_16x16x32_bf16 v[124:127], v[36:39], v[56:59], v[124:127]
    ds_read_b128 v[20:23], v4 offset:20480
    v_mfma_f32_16x16x32_bf16 v[128:131], v[40:43], v[56:59], v[128:131]
    ds_read_b128 v[24:27], v4 offset:22528
    v_mfma_f32_16x16x32_bf16 v[132:135], v[28:31], v[60:63], v[132:135]
    ds_read_b64_tr_b16 v[48:49], v9 offset:24576
    v_mfma_f32_16x16x32_bf16 v[136:139], v[32:35], v[60:63], v[136:139]
    ds_read_b64_tr_b16 v[50:51], v9 offset:25088
    v_mfma_f32_16x16x32_bf16 v[140:143], v[36:39], v[60:63], v[140:143]
    ds_read_b64_tr_b16 v[52:53], v10 offset:0
    v_mfma_f32_16x16x32_bf16 v[144:147], v[40:43], v[60:63], v[144:147]
    ds_read_b64_tr_b16 v[54:55], v10 offset:512
    v_mfma_f32_16x16x32_bf16 v[148:151], v[28:31], v[64:67], v[148:151]
    ds_read_b64_tr_b16 v[56:57], v11 offset:0
    v_mfma_f32_16x16x32_bf16 v[152:155], v[32:35], v[64:67], v[152:155]
    ds_read_b64_tr_b16 v[58:59], v11 offset:512
    v_mfma_f32_16x16x32_bf16 v[156:159], v[36:39], v[64:67], v[156:159]
    v_mfma_f32_16x16x32_bf16 v[160:163], v[40:43], v[64:67], v[160:163]
    s_waitcnt lgkmcnt(9)
    v_mfma_f32_16x16x32_bf16 v[100:103], v[12:15], v[44:47], v[100:103]
    ds_read_b128 v[28:31], v5 offset:16384
    s_waitcnt lgkmcnt(9)
    v_mfma_f32_16x16x32_bf16 v[104:107], v[16:19], v[44:47], v[104:107]
    ds_read_b64_tr_b16 v[60:61], v8 offset:28672
    s_waitcnt lgkmcnt(9)
    v_mfma_f32_16x16x32_bf16 v[108:111], v[20:23], v[44:47], v[108:111]
    ds_read_b64_tr_b16 v[62:63], v8 offset:29184
    s_waitcnt lgkmcnt(9)
    v_mfma_f32_16x16x32_bf16 v[112:115], v[24:27], v[44:47], v[112:115]
    ds_read_b128 v[32:35], v5 offset:18432
    s_waitcnt lgkmcnt(8)
    v_mfma_f32_16x16x32_bf16 v[116:119], v[12:15], v[48:51], v[116:119]
    ds_read_b128 v[36:39], v5 offset:20480
    v_mfma_f32_16x16x32_bf16 v[120:123], v[16:19], v[48:51], v[120:123]
    ds_read_b128 v[40:43], v5 offset:22528
    v_mfma_f32_16x16x32_bf16 v[124:127], v[20:23], v[48:51], v[124:127]
    ds_read_b64_tr_b16 v[64:65], v9 offset:28672
    v_mfma_f32_16x16x32_bf16 v[128:131], v[24:27], v[48:51], v[128:131]
    ds_read_b64_tr_b16 v[66:67], v9 offset:29184
    s_waitcnt lgkmcnt(10)
    v_mfma_f32_16x16x32_bf16 v[132:135], v[12:15], v[52:55], v[132:135]
    ds_read_b64_tr_b16 v[44:45], v10 offset:4096
    v_mfma_f32_16x16x32_bf16 v[136:139], v[16:19], v[52:55], v[136:139]
    ds_read_b64_tr_b16 v[46:47], v10 offset:4608
    v_mfma_f32_16x16x32_bf16 v[140:143], v[20:23], v[52:55], v[140:143]
    ds_read_b64_tr_b16 v[48:49], v11 offset:4096
    v_mfma_f32_16x16x32_bf16 v[144:147], v[24:27], v[52:55], v[144:147]
    ds_read_b64_tr_b16 v[50:51], v11 offset:4608
    s_waitcnt lgkmcnt(12)
    v_mfma_f32_16x16x32_bf16 v[148:151], v[12:15], v[56:59], v[148:151]
    v_mfma_f32_16x16x32_bf16 v[152:155], v[16:19], v[56:59], v[152:155]
    v_mfma_f32_16x16x32_bf16 v[156:159], v[20:23], v[56:59], v[156:159]
    v_mfma_f32_16x16x32_bf16 v[160:163], v[24:27], v[56:59], v[160:163]
    s_waitcnt lgkmcnt(9)
    v_mfma_f32_16x16x32_bf16 v[100:103], v[28:31], v[60:63], v[100:103]
    s_waitcnt lgkmcnt(8)
    v_mfma_f32_16x16x32_bf16 v[104:107], v[32:35], v[60:63], v[104:107]
    s_waitcnt lgkmcnt(0)
    s_barrier
    v_mfma_f32_16x16x32_bf16 v[108:111], v[36:39], v[60:63], v[108:111]
    ds_read_b128 v[12:15], v4 offset:32768
    v_mfma_f32_16x16x32_bf16 v[112:115], v[40:43], v[60:63], v[112:115]
    ds_read_b64_tr_b16 v[52:53], v10 offset:16384
    v_mfma_f32_16x16x32_bf16 v[116:119], v[28:31], v[64:67], v[116:119]
    ds_read_b64_tr_b16 v[54:55], v10 offset:16896
    v_mfma_f32_16x16x32_bf16 v[120:123], v[32:35], v[64:67], v[120:123]
    ds_read_b128 v[16:19], v4 offset:34816
    v_mfma_f32_16x16x32_bf16 v[124:127], v[36:39], v[64:67], v[124:127]
    ds_read_b128 v[20:23], v4 offset:36864
    v_mfma_f32_16x16x32_bf16 v[128:131], v[40:43], v[64:67], v[128:131]
    ds_read_b128 v[24:27], v4 offset:38912
    v_mfma_f32_16x16x32_bf16 v[132:135], v[28:31], v[44:47], v[132:135]
    ds_read_b64_tr_b16 v[56:57], v11 offset:16384
    v_mfma_f32_16x16x32_bf16 v[136:139], v[32:35], v[44:47], v[136:139]
    ds_read_b64_tr_b16 v[58:59], v11 offset:16896
    v_mfma_f32_16x16x32_bf16 v[140:143], v[36:39], v[44:47], v[140:143]
    ds_read_b64_tr_b16 v[60:61], v10 offset:24576
    v_mfma_f32_16x16x32_bf16 v[144:147], v[40:43], v[44:47], v[144:147]
    ds_read_b64_tr_b16 v[62:63], v10 offset:25088
    v_mfma_f32_16x16x32_bf16 v[148:151], v[28:31], v[48:51], v[148:151]
    ds_read_b64_tr_b16 v[64:65], v11 offset:24576
    v_mfma_f32_16x16x32_bf16 v[152:155], v[32:35], v[48:51], v[152:155]
    ds_read_b64_tr_b16 v[66:67], v11 offset:25088
    v_mfma_f32_16x16x32_bf16 v[156:159], v[36:39], v[48:51], v[156:159]
    v_mfma_f32_16x16x32_bf16 v[160:163], v[40:43], v[48:51], v[160:163]
    s_waitcnt lgkmcnt(9)
    v_mfma_f32_16x16x32_bf16 v[100:103], v[12:15], v[52:55], v[100:103]
    ds_read_b128 v[28:31], v5 offset:32768
    s_waitcnt lgkmcnt(9)
    v_mfma_f32_16x16x32_bf16 v[104:107], v[16:19], v[52:55], v[104:107]
    ds_read_b64_tr_b16 v[44:45], v10 offset:20480
    s_waitcnt lgkmcnt(9)
    v_mfma_f32_16x16x32_bf16 v[108:111], v[20:23], v[52:55], v[108:111]
    ds_read_b64_tr_b16 v[46:47], v10 offset:20992
    s_waitcnt lgkmcnt(9)
    v_mfma_f32_16x16x32_bf16 v[112:115], v[24:27], v[52:55], v[112:115]
    ds_read_b128 v[32:35], v5 offset:34816
    s_waitcnt lgkmcnt(8)
    v_mfma_f32_16x16x32_bf16 v[116:119], v[12:15], v[56:59], v[116:119]
    ds_read_b128 v[36:39], v5 offset:36864
    v_mfma_f32_16x16x32_bf16 v[120:123], v[16:19], v[56:59], v[120:123]
    ds_read_b128 v[40:43], v5 offset:38912
    v_mfma_f32_16x16x32_bf16 v[124:127], v[20:23], v[56:59], v[124:127]
    ds_read_b64_tr_b16 v[48:49], v11 offset:20480
    v_mfma_f32_16x16x32_bf16 v[128:131], v[24:27], v[56:59], v[128:131]
    ds_read_b64_tr_b16 v[50:51], v11 offset:20992
    s_waitcnt lgkmcnt(10)
    v_mfma_f32_16x16x32_bf16 v[132:135], v[12:15], v[60:63], v[132:135]
    ds_read_b64_tr_b16 v[52:53], v10 offset:28672
    v_mfma_f32_16x16x32_bf16 v[136:139], v[16:19], v[60:63], v[136:139]
    ds_read_b64_tr_b16 v[54:55], v10 offset:29184
    v_mfma_f32_16x16x32_bf16 v[140:143], v[20:23], v[60:63], v[140:143]
    ds_read_b64_tr_b16 v[56:57], v11 offset:28672
    v_mfma_f32_16x16x32_bf16 v[144:147], v[24:27], v[60:63], v[144:147]
    ds_read_b64_tr_b16 v[58:59], v11 offset:29184
    s_waitcnt lgkmcnt(12)
    v_mfma_f32_16x16x32_bf16 v[148:151], v[12:15], v[64:67], v[148:151]
    v_mfma_f32_16x16x32_bf16 v[152:155], v[16:19], v[64:67], v[152:155]
    v_mfma_f32_16x16x32_bf16 v[156:159], v[20:23], v[64:67], v[156:159]
    v_mfma_f32_16x16x32_bf16 v[160:163], v[24:27], v[64:67], v[160:163]
    s_waitcnt lgkmcnt(9)
    v_mfma_f32_16x16x32_bf16 v[100:103], v[28:31], v[44:47], v[100:103]
    s_waitcnt lgkmcnt(8)
    v_mfma_f32_16x16x32_bf16 v[104:107], v[32:35], v[44:47], v[104:107]
    s_waitcnt lgkmcnt(0)
    s_barrier
    v_mfma_f32_16x16x32_bf16 v[108:111], v[36:39], v[44:47], v[108:111]
    ds_read_b128 v[12:15], v4 offset:49152
    v_mfma_f32_16x16x32_bf16 v[112:115], v[40:43], v[44:47], v[112:115]
    ds_read_b64_tr_b16 v[60:61], v8 offset:0
    v_mfma_f32_16x16x32_bf16 v[116:119], v[28:31], v[48:51], v[116:119]
    ds_read_b64_tr_b16 v[62:63], v8 offset:512
    v_mfma_f32_16x16x32_bf16 v[120:123], v[32:35], v[48:51], v[120:123]
    ds_read_b128 v[16:19], v4 offset:51200
    v_mfma_f32_16x16x32_bf16 v[124:127], v[36:39], v[48:51], v[124:127]
    ds_read_b128 v[20:23], v4 offset:53248
    v_mfma_f32_16x16x32_bf16 v[128:131], v[40:43], v[48:51], v[128:131]
    ds_read_b128 v[24:27], v4 offset:55296
    v_mfma_f32_16x16x32_bf16 v[132:135], v[28:31], v[52:55], v[132:135]
    ds_read_b64_tr_b16 v[64:65], v9 offset:0
    v_mfma_f32_16x16x32_bf16 v[136:139], v[32:35], v[52:55], v[136:139]
    ds_read_b64_tr_b16 v[66:67], v9 offset:512
    v_mfma_f32_16x16x32_bf16 v[140:143], v[36:39], v[52:55], v[140:143]
    ds_read_b64_tr_b16 v[44:45], v10 offset:32768
    s_branch IW_s4
IW_w4:
    s_branch IW_r4
IW_s4:
    v_mfma_f32_16x16x32_bf16 v[144:147], v[40:43], v[52:55], v[144:147]
    ds_read_b64_tr_b16 v[46:47], v10 offset:33280
    v_mfma_f32_16x16x32_bf16 v[148:151], v[28:31], v[56:59], v[148:151]
    ds_read_b64_tr_b16 v[48:49], v11 offset:32768
    v_mfma_f32_16x16x32_bf16 v[152:155], v[32:35], v[56:59], v[152:155]
    ds_read_b64_tr_b16 v[50:51], v11 offset:33280
    v_mfma_f32_16x16x32_bf16 v[156:159], v[36:39], v[56:59], v[156:159]
    v_mfma_f32_16x16x32_bf16 v[160:163], v[40:43], v[56:59], v[160:163]
    s_waitcnt lgkmcnt(9)
    v_mfma_f32_16x16x32_bf16 v[100:103], v[12:15], v[60:63], v[100:103]
    ds_read_b128 v[28:31], v5 offset:49152
    s_waitcnt lgkmcnt(9)
    v_mfma_f32_16x16x32_bf16 v[104:107], v[16:19], v[60:63], v[104:107]
    ds_read_b64_tr_b16 v[52:53], v8 offset:4096
    s_waitcnt lgkmcnt(9)
    v_mfma_f32_16x16x32_bf16 v[108:111], v[20:23], v[60:63], v[108:111]
    ds_read_b64_tr_b16 v[54:55], v8 offset:4608
    s_waitcnt lgkmcnt(9)
    v_mfma_f32_16x16x32_bf16 v[112:115], v[24:27], v[60:63], v[112:115]
    ds_read_b128 v[32:35], v5 offset:51200
    s_waitcnt lgkmcnt(8)
    v_mfma_f32_16x16x32_bf16 v[116:119], v[12:15], v[64:67], v[116:119]
    ds_read_b128 v[36:39], v5 offset:53248
    v_mfma_f32_16x16x32_bf16 v[120:123], v[16:19], v[64:67], v[120:123]
    ds_read_b128 v[40:43], v5 offset:55296
    v_mfma_f32_16x16x32_bf16 v[124:127], v[20:23], v[64:67], v[124:127]
    ds_read_b64_tr_b16 v[56:57], v9 offset:4096
    v_mfma_f32_16x16x32_bf16 v[128:131], v[24:27], v[64:67], v[128:131]
    ds_read_b64_tr_b16 v[58:59], v9 offset:4608
    s_waitcnt lgkmcnt(10)
    v_mfma_f32_16x16x32_bf16 v[132:135], v[12:15], v[44:47], v[132:135]
    ds_read_b64_tr_b16 v[60:61], v10 offset:36864
    v_mfma_f32_16x16x32_bf16 v[136:139], v[16:19], v[44:47], v[136:139]
    ds_read_b64_tr_b16 v[62:63], v10 offset:37376
    v_mfma_f32_16x16x32_bf16 v[140:143], v[20:23], v[44:47], v[140:143]
    ds_read_b64_tr_b16 v[64:65], v11 offset:36864
    v_mfma_f32_16x16x32_bf16 v[144:147], v[24:27], v[44:47], v[144:147]
    ds_read_b64_tr_b16 v[66:67], v11 offset:37376
    s_waitcnt lgkmcnt(12)
    v_mfma_f32_16x16x32_bf16 v[148:151], v[12:15], v[48:51], v[148:151]
    v_mfma_f32_16x16x32_bf16 v[152:155], v[16:19], v[48:51], v[152:155]
    v_mfma_f32_16x16x32_bf16 v[156:159], v[20:23], v[48:51], v[156:159]
    v_mfma_f32_16x16x32_bf16 v[160:163], v[24:27], v[48:51], v[160:163]
    s_waitcnt lgkmcnt(9)
    v_mfma_f32_16x16x32_bf16 v[100:103], v[28:31], v[52:55], v[100:103]
    s_waitcnt lgkmcnt(8)
    v_mfma_f32_16x16x32_bf16 v[104:107], v[32:35], v[52:55], v[104:107]
    s_waitcnt lgkmcnt(0)
    s_barrier
    v_mfma_f32_16x16x32_bf16 v[108:111], v[36:39], v[52:55], v[108:111]
    ds_read_b128 v[12:15], v4 offset:0
    v_mfma_f32_16x16x32_bf16 v[112:115], v[40:43], v[52:55], v[112:115]
    ds_read_b64_tr_b16 v[44:45], v8 offset:8192
    v_mfma_f32_16x16x32_bf16 v[116:119], v[28:31], v[56:59], v[116:119]
    ds_read_b64_tr_b16 v[46:47], v8 offset:8704
    v_mfma_f32_16x16x32_bf16 v[120:123], v[32:35], v[56:59], v[120:123]
    ds_read_b128 v[16:19], v4 offset:2048
    v_mfma_f32_16x16x32_bf16 v[124:127], v[36:39], v[56:59], v[124:127]
    ds_read_b128 v[20:23], v4 offset:4096
    v_mfma_f32_16x16x32_bf16 v[128:131], v[40:43], v[56:59], v[128:131]
    ds_read_b128 v[24:27], v4 offset:6144
    v_mfma_f32_16x16x32_bf16 v[132:135], v[28:31], v[60:63], v[132:135]
    ds_read_b64_tr_b16 v[48:49], v9 offset:8192
    v_mfma_f32_16x16x32_bf16 v[136:139], v[32:35], v[60:63], v[136:139]
    ds_read_b64_tr_b16 v[50:51], v9 offset:8704
    v_mfma_f32_16x16x32_bf16 v[140:143], v[36:39], v[60:63], v[140:143]
    ds_read_b64_tr_b16 v[52:53], v8 offset:16384
    v_mfma_f32_16x16x32_bf16 v[144:147], v[40:43], v[60:63], v[144:147]
    ds_read_b64_tr_b16 v[54:55], v8 offset:16896
    v_mfma_f32_16x16x32_bf16 v[148:151], v[28:31], v[64:67], v[148:151]
    ds_read_b64_tr_b16 v[56:57], v9 offset:16384
    v_mfma_f32_16x16x32_bf16 v[152:155], v[32:35], v[64:67], v[152:155]
    ds_read_b64_tr_b16 v[58:59], v9 offset:16896
    v_mfma_f32_16x16x32_bf16 v[156:159], v[36:39], v[64:67], v[156:159]
    v_mfma_f32_16x16x32_bf16 v[160:163], v[40:43], v[64:67], v[160:163]
    s_waitcnt lgkmcnt(9)
    v_mfma_f32_16x16x32_bf16 v[100:103], v[12:15], v[44:47], v[100:103]
    ds_read_b128 v[28:31], v5 offset:0
    s_waitcnt lgkmcnt(9)
    v_mfma_f32_16x16x32_bf16 v[104:107], v[16:19], v[44:47], v[104:107]
    ds_read_b64_tr_b16 v[60:61], v8 offset:12288
    s_waitcnt lgkmcnt(9)
    v_mfma_f32_16x16x32_bf16 v[108:111], v[20:23], v[44:47], v[108:111]
    ds_read_b64_tr_b16 v[62:63], v8 offset:12800
    s_waitcnt lgkmcnt(9)
    v_mfma_f32_16x16x32_bf16 v[112:115], v[24:27], v[44:47], v[112:115]
    ds_read_b128 v[32:35], v5 offset:2048
    s_waitcnt lgkmcnt(8)
    v_mfma_f32_16x16x32_bf16 v[116:119], v[12:15], v[48:51], v[116:119]
    ds_read_b128 v[36:39], v5 offset:4096
    v_mfma_f32_16x16x32_bf16 v[120:123], v[16:19], v[48:51], v[120:123]
    ds_read_b128 v[40:43], v5 offset:6144
    v_mfma_f32_16x16x32_bf16 v[124:127], v[20:23], v[48:51], v[124:127]
    ds_read_b64_tr_b16 v[64:65], v9 offset:12288
    v_mfma_f32_16x16x32_bf16 v[128:131], v[24:27], v[48:51], v[128:131]
    ds_read_b64_tr_b16 v[66:67], v9 offset:12800
    s_waitcnt lgkmcnt(10)
    v_mfma_f32_16x16x32_bf16 v[132:135], v[12:15], v[52:55], v[132:135]
    ds_read_b64_tr_b16 v[44:45], v8 offset:20480
    v_mfma_f32_16x16x32_bf16 v[136:139], v[16:19], v[52:55], v[136:139]
    ds_read_b64_tr_b16 v[46:47], v8 offset:20992
    v_mfma_f32_16x16x32_bf16 v[140:143], v[20:23], v[52:55], v[140:143]
    ds_read_b64_tr_b16 v[48:49], v9 offset:20480
    v_mfma_f32_16x16x32_bf16 v[144:147], v[24:27], v[52:55], v[144:147]
    ds_read_b64_tr_b16 v[50:51], v9 offset:20992
    s_waitcnt lgkmcnt(12)
    v_mfma_f32_16x16x32_bf16 v[148:151], v[12:15], v[56:59], v[148:151]
    v_mfma_f32_16x16x32_bf16 v[152:155], v[16:19], v[56:59], v[152:155]
    v_mfma_f32_16x16x32_bf16 v[156:159], v[20:23], v[56:59], v[156:159]
    v_mfma_f32_16x16x32_bf16 v[160:163], v[24:27], v[56:59], v[160:163]
    s_waitcnt lgkmcnt(9)
    v_mfma_f32_16x16x32_bf16 v[100:103], v[28:31], v[60:63], v[100:103]
    s_waitcnt lgkmcnt(8)
    v_mfma_f32_16x16x32_bf16 v[104:107], v[32:35], v[60:63], v[104:107]
    s_waitcnt lgkmcnt(0)
    s_barrier
    v_mfma_f32_16x16x32_bf16 v[108:111], v[36:39], v[60:63], v[108:111]
    ds_read_b128 v[12:15], v4 offset:16384
    v_mfma_f32_16x16x32_bf16 v[112:115], v[40:43], v[60:63], v[112:115]
    ds_read_b64_tr_b16 v[52:53], v8 offset:24576
    v_mfma_f32_16x16x32_bf16 v[116:119], v[28:31], v[64:67], v[116:119]
    ds_read_b64_tr_b16 v[54:55], v8 offset:25088
    v_mfma_f32_16x16x32_bf16 v[120:123], v[32:35], v[64:67], v[120:123]
    ds_read_b128 v[16:19], v4 offset:18432
    v_mfma_f32_16x16x32_bf16 v[124:127], v[36:39], v[64:67], v[124:127]
    ds_read_b128 v[20:23], v4 offset:20480
    v_mfma_f32_16x16x32_bf16 v[128:131], v[40:43], v[64:67], v[128:131]
    ds_read_b128 v[24:27], v4 offset:22528
    v_mfma_f32_16x16x32_bf16 v[132:135], v[28:31], v[44:47], v[132:135]
    ds_read_b64_tr_b16 v[56:57], v9 offset:24576
    v_mfma_f32_16x16x32_bf16 v[136:139], v[32:35], v[44:47], v[136:139]
    ds_read_b64_tr_b16 v[58:59], v9 offset:25088
    v_mfma_f32_16x16x32_bf16 v[140:143], v[36:39], v[44:47], v[140:143]
    ds_read_b64_tr_b16 v[60:61], v10 offset:0
    v_mfma_f32_16x16x32_bf16 v[144:147], v[40:43], v[44:47], v[144:147]
    ds_read_b64_tr_b16 v[62:63], v10 offset:512
    v_mfma_f32_16x16x32_bf16 v[148:151], v[28:31], v[48:51], v[148:151]
    ds_read_b64_tr_b16 v[64:65], v11 offset:0
    v_mfma_f32_16x16x32_bf16 v[152:155], v[32:35], v[48:51], v[152:155]
    ds_read_b64_tr_b16 v[66:67], v11 offset:512
    v_mfma_f32_16x16x32_bf16 v[156:159], v[36:39], v[48:51], v[156:159]
    v_mfma_f32_16x16x32_bf16 v[160:163], v[40:43], v[48:51], v[160:163]
    s_waitcnt lgkmcnt(9)
    v_mfma_f32_16x16x32_bf16 v[100:103], v[12:15], v[52:55], v[100:103]
    ds_read_b128 v[28:31], v5 offset:16384
    s_waitcnt lgkmcnt(9)
    v_mfma_f32_16x16x32_bf16 v[104:107], v[16:19], v[52:55], v[104:107]
    ds_read_b64_tr_b16 v[44:45], v8 offset:28672
    s_waitcnt lgkmcnt(9)
    v_mfma_f32_16x16x32_bf16 v[108:111], v[20:23], v[52:55], v[108:111]
    ds_read_b64_tr_b16 v[46:47], v8 offset:29184
    s_waitcnt lgkmcnt(9)
    v_mfma_f32_16x16x32_bf16 v[112:115], v[24:27], v[52:55], v[112:115]
    ds_read_b128 v[32:35], v5 offset:18432
    s_waitcnt lgkmcnt(8)
    v_mfma_f32_16x16x32_bf16 v[116:119], v[12:15], v[56:59], v[116:119]
    ds_read_b128 v[36:39], v5 offset:20480
    v_mfma_f32_16x16x32_bf16 v[120:123], v[16:19], v[56:59], v[120:123]
    ds_read_b128 v[40:43], v5 offset:22528
    v_mfma_f32_16x16x32_bf16 v[124:127], v[20:23], v[56:59], v[124:127]
    ds_read_b64_tr_b16 v[48:49], v9 offset:28672
    v_mfma_f32_16x16x32_bf16 v[128:131], v[24:27], v[56:59], v[128:131]
    ds_read_b64_tr_b16 v[50:51], v9 offset:29184
    s_waitcnt lgkmcnt(10)
    v_mfma_f32_16x16x32_bf16 v[132:135], v[12:15], v[60:63], v[132:135]
    ds_read_b64_tr_b16 v[52:53], v10 offset:4096
    v_mfma_f32_16x16x32_bf16 v[136:139], v[16:19], v[60:63], v[136:139]
    ds_read_b64_tr_b16 v[54:55], v10 offset:4608
    v_mfma_f32_16x16x32_bf16 v[140:143], v[20:23], v[60:63], v[140:143]
    ds_read_b64_tr_b16 v[56:57], v11 offset:4096
    v_mfma_f32_16x16x32_bf16 v[144:147], v[24:27], v[60:63], v[144:147]
    ds_read_b64_tr_b16 v[58:59], v11 offset:4608
    s_waitcnt lgkmcnt(12)
    v_mfma_f32_16x16x32_bf16 v[148:151], v[12:15], v[64:67], v[148:151]
    v_mfma_f32_16x16x32_bf16 v[152:155], v[16:19], v[64:67], v[152:155]
    v_mfma_f32_16x16x32_bf16 v[156:159], v[20:23], v[64:67], v[156:159]
    v_mfma_f32_16x16x32_bf16 v[160:163], v[24:27], v[64:67], v[160:163]
    s_waitcnt lgkmcnt(9)
    v_mfma_f32_16x16x32_bf16 v[100:103], v[28:31], v[44:47], v[100:103]
    s_waitcnt lgkmcnt(8)
    v_mfma_f32_16x16x32_bf16 v[104:107], v[32:35], v[44:47], v[104:107]
    s_waitcnt lgkmcnt(0)
    s_barrier
    v_mfma_f32_16x16x32_bf16 v[108:111], v[36:39], v[44:47], v[108:111]
    ds_read_b128 v[12:15], v4 offset:32768
    v_mfma_f32_16x16x32_bf16 v[112:115], v[40:43], v[44:47], v[112:115]
    ds_read_b64_tr_b16 v[60:61], v10 offset:8192
    v_mfma_f32_16x16x32_bf16 v[116:119], v[28:31], v[48:51], v[116:119]
    ds_read_b64_tr_b16 v[62:63], v10 offset:8704
    v_mfma_f32_16x16x32_bf16 v[120:123], v[32:35], v[48:51], v[120:123]
    ds_read_b128 v[16:19], v4 offset:34816
    v_mfma_f32_16x16x32_bf16 v[124:127], v[36:39], v[48:51], v[124:127]
    ds_read_b128 v[20:23], v4 offset:36864
    v_mfma_f32_16x16x32_bf16 v[128:131], v[40:43], v[48:51], v[128:131]
    ds_read_b128 v[24:27], v4 offset:38912
    v_mfma_f32_16x16x32_bf16 v[132:135], v[28:31], v[52:55], v[132:135]
    ds_read_b64_tr_b16 v[64:65], v11 offset:8192
    v_mfma_f32_16x16x32_bf16 v[136:139], v[32:35], v[52:55], v[136:139]
    ds_read_b64_tr_b16 v[66:67], v11 offset:8704
    v_mfma_f32_16x16x32_bf16 v[140:143], v[36:39], v[52:55], v[140:143]
    ds_read_b64_tr_b16 v[44:45], v10 offset:16384
    v_mfma_f32_16x16x32_bf16 v[144:147], v[40:43], v[52:55], v[144:147]
    ds_read_b64_tr_b16 v[46:47], v10 offset:16896
    v_mfma_f32_16x16x32_bf16 v[148:151], v[28:31], v[56:59], v[148:151]
    ds_read_b64_tr_b16 v[48:49], v11 offset:16384
    v_mfma_f32_16x16x32_bf16 v[152:155], v[32:35], v[56:59], v[152:155]
    ds_read_b64_tr_b16 v[50:51], v11 offset:16896
    v_mfma_f32_16x16x32_bf16 v[156:159], v[36:39], v[56:59], v[156:159]
    v_mfma_f32_16x16x32_bf16 v[160:163], v[40:43], v[56:59], v[160:163]
    s_waitcnt lgkmcnt(9)
    v_mfma_f32_16x16x32_bf16 v[100:103], v[12:15], v[60:63], v[100:103]
    ds_read_b128 v[28:31], v5 offset:32768
    s_waitcnt lgkmcnt(9)
    v_mfma_f32_16x16x32_bf16 v[104:107], v[16:19], v[60:63], v[104:107]
    ds_read_b64_tr_b16 v[52:53], v10 offset:12288
    s_waitcnt lgkmcnt(9)
    v_mfma_f32_16x16x32_bf16 v[108:111], v[20:23], v[60:63], v[108:111]
    ds_read_b64_tr_b16 v[54:55], v10 offset:12800
    s_waitcnt lgkmcnt(9)
    v_mfma_f32_16x16x32_bf16 v[112:115], v[24:27], v[60:63], v[112:115]
    ds_read_b128 v[32:35], v5 offset:34816
    s_waitcnt lgkmcnt(8)
    v_mfma_f32_16x16x32_bf16 v[116:119], v[12:15], v[64:67], v[116:119]
    ds_read_b128 v[36:39], v5 offset:36864
    v_mfma_f32_16x16x32_bf16 v[120:123], v[16:19], v[64:67], v[120:123]
    ds_read_b128 v[40:43], v5 offset:38912
    v_mfma_f32_16x16x32_bf16 v[124:127], v[20:23], v[64:67], v[124:127]
    ds_read_b64_tr_b16 v[56:57], v11 offset:12288
    v_mfma_f32_16x16x32_bf16 v[128:131], v[24:27], v[64:67], v[128:131]
    ds_read_b64_tr_b16 v[58:59], v11 offset:12800
    s_waitcnt lgkmcnt(10)
    v_mfma_f32_16x16x32_bf16 v[132:135], v[12:15], v[44:47], v[132:135]
    ds_read_b64_tr_b16 v[60:61], v10 offset:20480
    v_mfma_f32_16x16x32_bf16 v[136:139], v[16:19], v[44:47], v[136:139]
    ds_read_b64_tr_b16 v[62:63], v10 offset:20992
    v_mfma_f32_16x16x32_bf16 v[140:143], v[20:23], v[44:47], v[140:143]
    ds_read_b64_tr_b16 v[64:65], v11 offset:20480
    v_mfma_f32_16x16x32_bf16 v[144:147], v[24:27], v[44:47], v[144:147]
    ds_read_b64_tr_b16 v[66:67], v11 offset:20992
    s_waitcnt lgkmcnt(12)
    v_mfma_f32_16x16x32_bf16 v[148:151], v[12:15], v[48:51], v[148:151]
    v_mfma_f32_16x16x32_bf16 v[152:155], v[16:19], v[48:51], v[152:155]
    v_mfma_f32_16x16x32_bf16 v[156:159], v[20:23], v[48:51], v[156:159]
    v_mfma_f32_16x16x32_bf16 v[160:163], v[24:27], v[48:51], v[160:163]
    s_waitcnt lgkmcnt(9)
    v_mfma_f32_16x16x32_bf16 v[100:103], v[28:31], v[52:55], v[100:103]
    s_waitcnt lgkmcnt(8)
    v_mfma_f32_16x16x32_bf16 v[104:107], v[32:35], v[52:55], v[104:107]
    s_waitcnt lgkmcnt(0)
    s_barrier
    v_mfma_f32_16x16x32_bf16 v[108:111], v[36:39], v[52:55], v[108:111]
    ds_read_b128 v[12:15], v4 offset:49152
    v_mfma_f32_16x16x32_bf16 v[112:115], v[40:43], v[52:55], v[112:115]
    ds_read_b64_tr_b16 v[44:45], v8 offset:0
    v_mfma_f32_16x16x32_bf16 v[116:119], v[28:31], v[56:59], v[116:119]
    ds_read_b64_tr_b16 v[46:47], v8 offset:512
    v_mfma_f32_16x16x32_bf16 v[120:123], v[32:35], v[56:59], v[120:123]
    ds_read_b128 v[16:19], v4 offset:51200
    v_mfma_f32_16x16x32_bf16 v[124:127], v[36:39], v[56:59], v[124:127]
    ds_read_b128 v[20:23], v4 offset:53248
    v_mfma_f32_16x16x32_bf16 v[128:131], v[40:43], v[56:59], v[128:131]
    ds_read_b128 v[24:27], v4 offset:55296
    v_mfma_f32_16x16x32_bf16 v[132:135], v[28:31], v[60:63], v[132:135]
    ds_read_b64_tr_b16 v[48:49], v9 offset:0
    v_mfma_f32_16x16x32_bf16 v[136:139], v[32:35], v[60:63], v[136:139]
    ds_read_b64_tr_b16 v[50:51], v9 offset:512
    v_mfma_f32_16x16x32_bf16 v[140:143], v[36:39], v[60:63], v[140:143]
    ds_read_b64_tr_b16 v[52:53], v10 offset:24576
    v_mfma_f32_16x16x32_bf16 v[144:147], v[40:43], v[60:63], v[144:147]
    ds_read_b64_tr_b16 v[54:55], v10 offset:25088
    v_mfma_f32_16x16x32_bf16 v[148:151], v[28:31], v[64:67], v[148:151]
    ds_read_b64_tr_b16 v[56:57], v11 offset:24576
    v_mfma_f32_16x16x32_bf16 v[152:155], v[32:35], v[64:67], v[152:155]
    ds_read_b64_tr_b16 v[58:59], v11 offset:25088
    v_mfma_f32_16x16x32_bf16 v[156:159], v[36:39], v[64:67], v[156:159]
    v_mfma_f32_16x16x32_bf16 v[160:163], v[40:43], v[64:67], v[160:163]
    ds_read_b32 v68, v1 offset:48
    s_waitcnt lgkmcnt(10)
    v_mfma_f32_16x16x32_bf16 v[100:103], v[12:15], v[44:47], v[100:103]
    ds_read_b128 v[28:31], v5 offset:49152
    s_waitcnt lgkmcnt(10)
    v_mfma_f32_16x16x32_bf16 v[104:107], v[16:19], v[44:47], v[104:107]
    ds_read_b64_tr_b16 v[60:61], v8 offset:4096
    s_waitcnt lgkmcnt(10)
    v_mfma_f32_16x16x32_bf16 v[108:111], v[20:23], v[44:47], v[108:111]
    ds_read_b64_tr_b16 v[62:63], v8 offset:4608
    s_waitcnt lgkmcnt(10)
    v_mfma_f32_16x16x32_bf16 v[112:115], v[24:27], v[44:47], v[112:115]
    ds_read_b128 v[32:35], v5 offset:51200
    s_waitcnt lgkmcnt(9)
    v_mfma_f32_16x16x32_bf16 v[116:119], v[12:15], v[48:51], v[116:119]
    ds_read_b128 v[36:39], v5 offset:53248
    v_mfma_f32_16x16x32_bf16 v[120:123], v[16:19], v[48:51], v[120:123]
    ds_read_b128 v[40:43], v5 offset:55296
    v_mfma_f32_16x16x32_bf16 v[124:127], v[20:23], v[48:51], v[124:127]
    ds_read_b64_tr_b16 v[64:65], v9 offset:4096
    v_mfma_f32_16x16x32_bf16 v[128:131], v[24:27], v[48:51], v[128:131]
    ds_read_b64_tr_b16 v[66:67], v9 offset:4608
    s_waitcnt lgkmcnt(11)
    v_mfma_f32_16x16x32_bf16 v[132:135], v[12:15], v[52:55], v[132:135]
    ds_read_b64_tr_b16 v[44:45], v10 offset:28672
    v_mfma_f32_16x16x32_bf16 v[136:139], v[16:19], v[52:55], v[136:139]
    ds_read_b64_tr_b16 v[46:47], v10 offset:29184
    v_mfma_f32_16x16x32_bf16 v[140:143], v[20:23], v[52:55], v[140:143]
    ds_read_b64_tr_b16 v[48:49], v11 offset:28672
    v_mfma_f32_16x16x32_bf16 v[144:147], v[24:27], v[52:55], v[144:147]
    ds_read_b64_tr_b16 v[50:51], v11 offset:29184
    s_waitcnt lgkmcnt(13)
    v_mfma_f32_16x16x32_bf16 v[148:151], v[12:15], v[56:59], v[148:151]
    v_mfma_f32_16x16x32_bf16 v[152:155], v[16:19], v[56:59], v[152:155]
    v_mfma_f32_16x16x32_bf16 v[156:159], v[20:23], v[56:59], v[156:159]
    v_mfma_f32_16x16x32_bf16 v[160:163], v[24:27], v[56:59], v[160:163]
    s_waitcnt lgkmcnt(9)
    v_mfma_f32_16x16x32_bf16 v[100:103], v[28:31], v[60:63], v[100:103]
    v_lshlrev_b32 v18, 4, v0
    v_add_u32 v12, s52, v18
    s_waitcnt lgkmcnt(8)
    v_mfma_f32_16x16x32_bf16 v[104:107], v[32:35], v[60:63], v[104:107]
    v_xor_b32 v13, 4096, v12
    v_and_b32 v14, 0x30, v0
    s_waitcnt lgkmcnt(0)
    s_barrier
    v_cmp_gt_u32 vcc, 1, v68
    s_nop 0
    s_and_b32 vcc_lo, vcc_lo, 3
    s_cbranch_scc0 SCK_13
    v_and_b32 v69, 1, v0
    v_lshlrev_b32 v69, 2, v69
    v_add_u32 v69, 159088, v69
    ds_read_b32 v68, v69 offset:0
FW_14:
    s_waitcnt lgkmcnt(0)
    v_cmp_gt_u32 vcc, 1, v68
    s_cbranch_vccz FO_15
    ds_read_b32 v68, v69 offset:0
    s_branch FW_14
FO_15:
SCK_13:
    v_mfma_f32_16x16x32_bf16 v[108:111], v[36:39], v[60:63], v[108:111]
    ds_read_b128 v[68:71], v164 offset:0
    v_add_u32 v14, s53, v14
    v_mfma_f32_16x16x32_bf16 v[112:115], v[40:43], v[60:63], v[112:115]
    ds_read2_b32 v[52:53], v165 offset0:64 offset1:64
    v_xor_b32 v15, 64, v14
    v_mfma_f32_16x16x32_bf16 v[116:119], v[28:31], v[64:67], v[116:119]
    ds_read2_b32 v[54:55], v2 offset0:64 offset1:64
    v_lshlrev_b32 v19, 2, v0
    v_mfma_f32_16x16x32_bf16 v[120:123], v[32:35], v[64:67], v[120:123]
    ds_read2_b32 v[56:57], v165 offset0:128 offset1:128
    v_add_u32 v16, s53, v19
    v_mfma_f32_16x16x32_bf16 v[124:127], v[36:39], v[64:67], v[124:127]
    ds_read2_b32 v[58:59], v2 offset0:128 offset1:128
    v_xor_b32 v17, 256, v16
    v_mfma_f32_16x16x32_bf16 v[128:131], v[40:43], v[64:67], v[128:131]
    ds_read_b128 v[72:75], v164 offset:1024
    v_xor_b32 v18, 8, v3
    v_mfma_f32_16x16x32_bf16 v[132:135], v[28:31], v[44:47], v[132:135]
    ds_read_b128 v[76:79], v164 offset:64
    v_writelane_b32 v18, s50, 1
    v_mfma_f32_16x16x32_bf16 v[136:139], v[32:35], v[44:47], v[136:139]
    ds_read_b128 v[80:83], v164 offset:1088
    v_mov_b32 v20, 0x3f803f80
    v_mfma_f32_16x16x32_bf16 v[140:143], v[36:39], v[44:47], v[140:143]
    ds_read_b128 v[84:87], v164 offset:128
    v_mov_b32 v21, 0x3f803f80
    v_mfma_f32_16x16x32_bf16 v[144:147], v[40:43], v[44:47], v[144:147]
    ds_read_b128 v[88:91], v164 offset:1152
    v_mov_b32 v22, 0x3f803f80
    v_mfma_f32_16x16x32_bf16 v[148:151], v[28:31], v[48:51], v[148:151]
    ds_read_b128 v[92:95], v164 offset:192
    v_mov_b32 v23, 0x3f803f80
    v_mfma_f32_16x16x32_bf16 v[152:155], v[32:35], v[48:51], v[152:155]
    ds_read_b128 v[96:99], v164 offset:1216
    v_mov_b32 v24, 1
    v_and_b32 v4, 15, v0
    v_mfma_f32_16x16x32_bf16 v[156:159], v[36:39], v[48:51], v[156:159]
    v_bfe_u32 v5, v0, 4, 1
    v_lshlrev_b32 v5, 5, v5
    v_mfma_f32_16x16x32_bf16 v[160:163], v[40:43], v[48:51], v[160:163]
    v_lshrrev_b32 v6, 5, v0
    v_lshl_add_u32 v5, v6, 4, v5
    v_lshl_add_u32 v7, v4, 11, v5
    v_lshlrev_b32 v6, 4, v0
    v_and_b32 v8, 0x300, v6
    v_lshl_add_u32 v8, v4, 2, v8
    s_waitcnt lgkmcnt(10)
    v_pk_fma_f32 v[100:101], v[68:69], v[52:53], v[100:101]
    v_pk_fma_f32 v[102:103], v[70:71], v[52:53], v[102:103]
    s_waitcnt lgkmcnt(9)
    v_pk_fma_f32 v[116:117], v[68:69], v[54:55], v[116:117]
    v_pk_fma_f32 v[118:119], v[70:71], v[54:55], v[118:119]
    s_waitcnt lgkmcnt(8)
    v_pk_fma_f32 v[132:133], v[68:69], v[56:57], v[132:133]
    v_pk_fma_f32 v[134:135], v[70:71], v[56:57], v[134:135]
    s_waitcnt lgkmcnt(7)
    v_pk_fma_f32 v[148:149], v[68:69], v[58:59], v[148:149]
    v_pk_fma_f32 v[150:151], v[70:71], v[58:59], v[150:151]
    s_waitcnt lgkmcnt(6)
    v_pk_mul_f32 v[100:101], v[100:101], v[72:73]
    v_pk_mul_f32 v[102:103], v[102:103], v[74:75]
    v_pk_mul_f32 v[116:117], v[116:117], v[72:73]
    v_pk_mul_f32 v[118:119], v[118:119], v[74:75]
    v_pk_mul_f32 v[132:133], v[132:133], v[72:73]
    v_pk_mul_f32 v[134:135], v[134:135], v[74:75]
    v_pk_mul_f32 v[148:149], v[148:149], v[72:73]
    v_pk_mul_f32 v[150:151], v[150:151], v[74:75]
    v_exp_f32 v28, v100 clamp
    v_exp_f32 v29, v101 clamp
    v_exp_f32 v30, v102 clamp
    v_exp_f32 v31, v103 clamp
    v_exp_f32 v32, v116 clamp
    v_exp_f32 v33, v117 clamp
    v_exp_f32 v34, v118 clamp
    v_exp_f32 v35, v119 clamp
    v_cvt_pk_bf16_f32 v132, v132, v133
    v_cvt_pk_bf16_f32 v133, v134, v135
    v_cvt_pk_bf16_f32 v148, v148, v149
    v_cvt_pk_bf16_f32 v149, v150, v151
    v_pk_mul_f32 v[100:101], v[100:101], s[40:41] clamp
    v_pk_mul_f32 v[102:103], v[102:103], s[40:41] clamp
    v_pk_mul_f32 v[116:117], v[116:117], s[40:41] clamp
    v_pk_mul_f32 v[118:119], v[118:119], s[40:41] clamp
    v_pk_add_f32 v[28:29], v[28:29], s[74:75]
    v_pk_add_f32 v[30:31], v[30:31], s[74:75]
    v_pk_add_f32 v[32:33], v[32:33], s[74:75]
    v_pk_add_f32 v[34:35], v[34:35], s[74:75]
    v_pk_fma_f32 v[100:101], v[100:101], s[76:77], v[28:29]
    v_pk_fma_f32 v[102:103], v[102:103], s[76:77], v[30:31]
    v_pk_fma_f32 v[116:117], v[116:117], s[76:77], v[32:33]
    v_pk_fma_f32 v[118:119], v[118:119], s[76:77], v[34:35]
    v_cvt_pk_bf16_f32 v100, v100, v101
    v_cvt_pk_bf16_f32 v101, v102, v103
    v_cvt_pk_bf16_f32 v116, v116, v117
    v_cvt_pk_bf16_f32 v117, v118, v119
    s_waitcnt lgkmcnt(5)
    v_pk_fma_f32 v[104:105], v[76:77], v[52:53], v[104:105]
    v_pk_fma_f32 v[106:107], v[78:79], v[52:53], v[106:107]
    v_pk_fma_f32 v[120:121], v[76:77], v[54:55], v[120:121]
    v_pk_fma_f32 v[122:123], v[78:79], v[54:55], v[122:123]
    v_pk_fma_f32 v[136:137], v[76:77], v[56:57], v[136:137]
    v_pk_fma_f32 v[138:139], v[78:79], v[56:57], v[138:139]
    v_pk_fma_f32 v[152:153], v[76:77], v[58:59], v[152:153]
    v_pk_fma_f32 v[154:155], v[78:79], v[58:59], v[154:155]
    s_waitcnt lgkmcnt(4)
    v_pk_mul_f32 v[104:105], v[104:105], v[80:81]
    v_pk_mul_f32 v[106:107], v[106:107], v[82:83]
    v_pk_mul_f32 v[120:121], v[120:121], v[80:81]
    v_pk_mul_f32 v[122:123], v[122:123], v[82:83]
    v_pk_mul_f32 v[136:137], v[136:137], v[80:81]
    v_pk_mul_f32 v[138:139], v[138:139], v[82:83]
    v_pk_mul_f32 v[152:153], v[152:153], v[80:81]
    v_pk_mul_f32 v[154:155], v[154:155], v[82:83]
    v_exp_f32 v36, v104 clamp
    v_exp_f32 v37, v105 clamp
    v_exp_f32 v38, v106 clamp
    v_exp_f32 v39, v107 clamp
    v_exp_f32 v40, v120 clamp
    v_exp_f32 v41, v121 clamp
    v_exp_f32 v42, v122 clamp
    v_exp_f32 v43, v123 clamp
    v_cvt_pk_bf16_f32 v134, v136, v137
    v_cvt_pk_bf16_f32 v135, v138, v139
    v_cvt_pk_bf16_f32 v150, v152, v153
    v_cvt_pk_bf16_f32 v151, v154, v155
    v_pk_mul_f32 v[104:105], v[104:105], s[40:41] clamp
    v_pk_mul_f32 v[106:107], v[106:107], s[40:41] clamp
    v_pk_mul_f32 v[120:121], v[120:121], s[40:41] clamp
    v_pk_mul_f32 v[122:123], v[122:123], s[40:41] clamp
    v_pk_add_f32 v[36:37], v[36:37], s[74:75]
    v_pk_add_f32 v[38:39], v[38:39], s[74:75]
    v_pk_add_f32 v[40:41], v[40:41], s[74:75]
    v_pk_add_f32 v[42:43], v[42:43], s[74:75]
    v_pk_fma_f32 v[104:105], v[104:105], s[76:77], v[36:37]
    v_pk_fma_f32 v[106:107], v[106:107], s[76:77], v[38:39]
    v_pk_fma_f32 v[120:121], v[120:121], s[76:77], v[40:41]
    v_pk_fma_f32 v[122:123], v[122:123], s[76:77], v[42:43]
    v_cvt_pk_bf16_f32 v102, v104, v105
    v_cvt_pk_bf16_f32 v103, v106, v107
    v_cvt_pk_bf16_f32 v118, v120, v121
    v_cvt_pk_bf16_f32 v119, v122, v123
    s_waitcnt lgkmcnt(3)
    v_pk_fma_f32 v[108:109], v[84:85], v[52:53], v[108:109]
    v_pk_fma_f32 v[110:111], v[86:87], v[52:53], v[110:111]
    v_pk_fma_f32 v[124:125], v[84:85], v[54:55], v[124:125]
    v_pk_fma_f32 v[126:127], v[86:87], v[54:55], v[126:127]
    v_pk_fma_f32 v[140:141], v[84:85], v[56:57], v[140:141]
    v_pk_fma_f32 v[142:143], v[86:87], v[56:57], v[142:143]
    v_pk_fma_f32 v[156:157], v[84:85], v[58:59], v[156:157]
    v_pk_fma_f32 v[158:159], v[86:87], v[58:59], v[158:159]
    s_waitcnt lgkmcnt(2)
    v_pk_mul_f32 v[108:109], v[108:109], v[88:89]
    v_pk_mul_f32 v[110:111], v[110:111], v[90:91]
    v_pk_mul_f32 v[124:125], v[124:125], v[88:89]
    v_pk_mul_f32 v[126:127], v[126:127], v[90:91]
    v_pk_mul_f32 v[140:141], v[140:141], v[88:89]
    v_pk_mul_f32 v[142:143], v[142:143], v[90:91]
    v_pk_mul_f32 v[156:157], v[156:157], v[88:89]
    v_pk_mul_f32 v[158:159], v[158:159], v[90:91]
    v_mfma_f32_16x16x32_bf16 v[60:63], v[148:151], v[100:103], 0
    v_exp_f32 v28, v108 clamp
    v_exp_f32 v29, v109 clamp
    v_mfma_f32_16x16x32_bf16 v[64:67], v[148:151], v[116:119], 0
    v_exp_f32 v30, v110 clamp
    v_exp_f32 v31, v111 clamp
    v_mfma_f32_16x16x32_bf16 v[68:71], v[100:103], v[20:23], 0
    v_exp_f32 v32, v124 clamp
    v_exp_f32 v33, v125 clamp
    v_exp_f32 v34, v126 clamp
    v_exp_f32 v35, v127 clamp
    v_cvt_pk_bf16_f32 v136, v140, v141
    v_cvt_pk_bf16_f32 v137, v142, v143
    v_cvt_pk_bf16_f32 v152, v156, v157
    v_cvt_pk_bf16_f32 v153, v158, v159
    v_pk_mul_f32 v[108:109], v[108:109], s[40:41] clamp
    v_pk_mul_f32 v[110:111], v[110:111], s[40:41] clamp
    v_pk_mul_f32 v[124:125], v[124:125], s[40:41] clamp
    v_pk_mul_f32 v[126:127], v[126:127], s[40:41] clamp
    v_pk_add_f32 v[28:29], v[28:29], s[74:75]
    v_pk_add_f32 v[30:31], v[30:31], s[74:75]
    v_pk_add_f32 v[32:33], v[32:33], s[74:75]
    v_pk_add_f32 v[34:35], v[34:35], s[74:75]
    v_pk_fma_f32 v[108:109], v[108:109], s[76:77], v[28:29]
    v_pk_fma_f32 v[110:111], v[110:111], s[76:77], v[30:31]
    v_pk_fma_f32 v[124:125], v[124:125], s[76:77], v[32:33]
    v_pk_fma_f32 v[126:127], v[126:127], s[76:77], v[34:35]
    v_cvt_pk_bf16_f32 v104, v108, v109
    v_cvt_pk_bf16_f32 v105, v110, v111
    v_cvt_pk_bf16_f32 v120, v124, v125
    v_cvt_pk_bf16_f32 v121, v126, v127
    s_waitcnt lgkmcnt(1)
    v_pk_fma_f32 v[112:113], v[92:93], v[52:53], v[112:113]
    v_pk_fma_f32 v[114:115], v[94:95], v[52:53], v[114:115]
    v_pk_fma_f32 v[128:129], v[92:93], v[54:55], v[128:129]
    v_pk_fma_f32 v[130:131], v[94:95], v[54:55], v[130:131]
    v_pk_fma_f32 v[144:145], v[92:93], v[56:57], v[144:145]
    v_pk_fma_f32 v[146:147], v[94:95], v[56:57], v[146:147]
    v_pk_fma_f32 v[160:161], v[92:93], v[58:59], v[160:161]
    v_pk_fma_f32 v[162:163], v[94:95], v[58:59], v[162:163]
    s_waitcnt lgkmcnt(0)
    v_pk_mul_f32 v[112:113], v[112:113], v[96:97]
    v_pk_mul_f32 v[114:115], v[114:115], v[98:99]
    v_pk_mul_f32 v[128:129], v[128:129], v[96:97]
    v_pk_mul_f32 v[130:131], v[130:131], v[98:99]
    v_pk_mul_f32 v[144:145], v[144:145], v[96:97]
    v_pk_mul_f32 v[146:147], v[146:147], v[98:99]
    v_pk_mul_f32 v[160:161], v[160:161], v[96:97]
    v_pk_mul_f32 v[162:163], v[162:163], v[98:99]
    v_mfma_f32_16x16x32_bf16 v[72:75], v[116:119], v[20:23], 0
    v_exp_f32 v36, v112 clamp
    v_exp_f32 v37, v113 clamp
    v_mfma_f32_16x16x32_bf16 v[44:47], v[132:135], v[100:103], 0
    v_exp_f32 v38, v114 clamp
    v_exp_f32 v39, v115 clamp
    v_mfma_f32_16x16x32_bf16 v[48:51], v[132:135], v[116:119], 0
    v_exp_f32 v40, v128 clamp
    v_exp_f32 v41, v129 clamp
    v_exp_f32 v42, v130 clamp
    v_exp_f32 v43, v131 clamp
    s_branch IW_s5
IW_w5:
    s_branch IW_r5
IW_s5:
    v_cvt_pk_bf16_f32 v138, v144, v145
    v_cvt_pk_bf16_f32 v139, v146, v147
    v_cvt_pk_bf16_f32 v154, v160, v161
    v_cvt_pk_bf16_f32 v155, v162, v163
    v_pk_mul_f32 v[112:113], v[112:113], s[40:41] clamp
    v_pk_mul_f32 v[114:115], v[114:115], s[40:41] clamp
    v_pk_mul_f32 v[128:129], v[128:129], s[40:41] clamp
    v_pk_mul_f32 v[130:131], v[130:131], s[40:41] clamp
    v_pk_add_f32 v[36:37], v[36:37], s[74:75]
    v_pk_add_f32 v[38:39], v[38:39], s[74:75]
    v_pk_add_f32 v[40:41], v[40:41], s[74:75]
    v_pk_add_f32 v[42:43], v[42:43], s[74:75]
    v_pk_fma_f32 v[112:113], v[112:113], s[76:77], v[36:37]
    v_pk_fma_f32 v[114:115], v[114:115], s[76:77], v[38:39]
    v_pk_fma_f32 v[128:129], v[128:129], s[76:77], v[40:41]
    v_pk_fma_f32 v[130:131], v[130:131], s[76:77], v[42:43]
    v_cvt_pk_bf16_f32 v106, v112, v113
    v_cvt_pk_bf16_f32 v107, v114, v115
    v_cvt_pk_bf16_f32 v122, v128, v129
    v_cvt_pk_bf16_f32 v123, v130, v131
    v_mfma_f32_16x16x32_bf16 v[60:63], v[152:155], v[104:107], v[60:63]
    s_nop 0
    v_mfma_f32_16x16x32_bf16 v[64:67], v[152:155], v[120:123], v[64:67]
    v_mfma_f32_16x16x32_bf16 v[68:71], v[104:107], v[20:23], v[68:71]
    v_mfma_f32_16x16x32_bf16 v[72:75], v[120:123], v[20:23], v[72:75]
    v_mfma_f32_16x16x32_bf16 v[44:47], v[136:139], v[104:107], v[44:47]
    v_mfma_f32_16x16x32_bf16 v[48:51], v[136:139], v[120:123], v[48:51]
    buffer_load_dwordx4 v[140:143], v7, s[12:15], s42 offen offset:0
    buffer_load_dwordx4 v[144:147], v7, s[12:15], s42 offen offset:64
    buffer_load_dwordx4 v[156:159], v7, s[12:15], s43 offen offset:0
    buffer_load_dwordx4 v[160:163], v7, s[12:15], s43 offen offset:64
    ds_write_b128 v12, v[60:63] offset:0
    ds_write_b128 v12, v[64:67] offset:1024
    s_mov_b32 exec_lo, 0x10001
    s_mov_b32 exec_hi, 0x10001
    ds_write_b128 v14, v[68:71]
    ds_write_b128 v15, v[72:75]
    s_mov_b64 exec, 1
    ds_write_b32 v3, v24 offset:32
    s_mov_b64 exec, -1
F_xw:
    ds_read_b32 v25, v18 offset:32
    ds_read_b128 v[28:31], v13 offset:1024
    ds_read_b128 v[32:35], v13
    ds_read_b32 v26, v16
    ds_read_b32 v27, v17
    s_waitcnt lgkmcnt(4)
    v_cmp_eq_u32 vcc, 0, v25
    s_cbranch_vccz F_xx
    s_waitcnt lgkmcnt(0)
    s_branch F_xw
F_xx:
    s_waitcnt lgkmcnt(3)
    v_add_f32 v44, v44, v28
    v_add_f32 v45, v45, v29
    v_add_f32 v46, v46, v30
    v_add_f32 v47, v47, v31
    buffer_atomic_add_f32 v44, v8, s[24:27], s46 offen offset:0
    buffer_atomic_add_f32 v45, v8, s[24:27], s46 offen offset:64
    buffer_atomic_add_f32 v46, v8, s[24:27], s46 offen offset:128
    buffer_atomic_add_f32 v47, v8, s[24:27], s46 offen offset:192
    s_waitcnt lgkmcnt(2)
    v_add_f32 v48, v48, v32
    v_add_f32 v49, v49, v33
    v_add_f32 v50, v50, v34
    v_add_f32 v51, v51, v35
    buffer_atomic_add_f32 v48, v8, s[24:27], s47 offen offset:0
    buffer_atomic_add_f32 v49, v8, s[24:27], s47 offen offset:64
    buffer_atomic_add_f32 v50, v8, s[24:27], s47 offen offset:128
    buffer_atomic_add_f32 v51, v8, s[24:27], s47 offen offset:192
    s_waitcnt lgkmcnt(0)
    v_add_f32 v26, v26, v27
    s_mov_b64 exec, 0xffff
    buffer_atomic_add_f32 v26, v19, s[24:27], s48 offen
    s_mov_b64 exec, 1
    ds_add_u32 v3, v24 offset:32
    s_mov_b64 exec, -1
    s_setprio 2
    v_mov_b32 v2, v7
    s_lshl_b32 s47, s3, 7
    s_add_u32 s47, s47, 157184
    v_lshlrev_b32 v5, 2, v4
    v_add_u32 v5, s47, v5
    ds_read2_b32 v[76:77], v5 offset0:0 offset1:128
    ds_read2_b32 v[78:79], v5 offset0:16 offset1:144
    v_lshrrev_b32 v4, 3, v0
    v_and_b32 v5, 7, v0
    v_lshrrev_b32 v6, 1, v4
    v_lshlrev_b32 v7, 1, v6
    v_xor_b32 v7, v5, v7
    v_lshlrev_b32 v7, 4, v7
    v_lshl_add_u32 v40, v4, 11, v7
    v_and_b32 v6, 1, v6
    v_lshlrev_b32 v6, 1, v6
    v_xor_b32 v41, v5, v6
    v_xor_b32 v42, 4, v41
    v_lshlrev_b32 v41, 4, v41
    v_lshlrev_b32 v42, 4, v42
    v_mul_u32_u24 v7, 6144, v4
    v_add_u32 v41, v41, v7
    v_add_u32 v42, v42, v7
    v_add_u32 v42, 49152, v42
    s_mul_i32 s56, s3, 98304
    s_lshl_b32 s47, s10, 7
    s_add_u32 s56, s56, s47
    s_lshl_b32 s57, s29, 7
    s_lshl_b32 s47, s3, 15
    s_add_u32 s57, s57, s47
    s_and_b32 s81, s28, 3
    s_mul_i32 s81, s81, 4
    s_lshr_b32 s47, s28, 2
    s_mul_i32 s47, s47, 1
    s_add_u32 s81, s81, s47
    s_lshl_b32 s78, s3, 11
    s_lshl_b32 s44, s10, 1
    s_add_u32 s44, s44, s37
    s_mul_i32 s45, s44, 4224
    s_mov_b32 s52, s45
    s_add_u32 s53, s45, 4096
    s_lshl_b32 s51, s44, 3
    s_and_b32 s47, s32, 3
    s_add_u32 s51, s51, s47
    s_lshl_b32 s51, s51, 7
    v_xor_b32 v18, 8, v3
    v_mov_b32 v25, 0

    s_add_u32 s54, s51, 0x82d000
    s_add_u32 s54, s72, s54
    s_addc_u32 s55, s73, 0
    s_add_u32 s82, s49, 0x82d000
    s_add_u32 s82, s72, s82
    s_addc_u32 s83, s73, 0
    s_lshl_b32 s57, s29, 7
    s_and_b32 s47, s3, 1
    s_lshl_b32 s79, s47, 12
    s_lshl_b32 s47, s47, 16
    s_add_u32 s57, s57, s47

    s_setprio 2
    s_waitcnt lgkmcnt(0)
    v_mul_f32 v76, v76, v77
    v_add_f32 v77, 1.0, v77
    v_mul_f32 v78, v78, v79
    v_add_f32 v79, 1.0, v79
    s_waitcnt vmcnt(9)
    v_lshlrev_b32 v100, 16, v140
    v_and_b32 v101, 0xffff0000, v140
    v_lshlrev_b32 v102, 16, v141
    v_and_b32 v103, 0xffff0000, v141
    v_lshlrev_b32 v104, 16, v142
    v_and_b32 v105, 0xffff0000, v142
    v_lshlrev_b32 v106, 16, v143
    v_and_b32 v107, 0xffff0000, v143
    v_fma_f32 v100, v100, v77, v76
    v_fma_f32 v101, v101, v77, v76
    v_fma_f32 v102, v102, v77, v76
    v_fma_f32 v103, v103, v77, v76
    v_fma_f32 v104, v104, v77, v76
    v_fma_f32 v105, v105, v77, v76
    v_fma_f32 v106, v106, v77, v76
    v_fma_f32 v107, v107, v77, v76
    v_lshlrev_b32 v108, 16, v144
    v_and_b32 v109, 0xffff0000, v144
    v_lshlrev_b32 v110, 16, v145
    v_and_b32 v111, 0xffff0000, v145
    v_lshlrev_b32 v112, 16, v146
    v_and_b32 v113, 0xffff0000, v146
    v_lshlrev_b32 v114, 16, v147
    v_and_b32 v115, 0xffff0000, v147
    v_fma_f32 v108, v108, v77, v76
    v_fma_f32 v109, v109, v77, v76
    v_fma_f32 v110, v110, v77, v76
    v_fma_f32 v111, v111, v77, v76
    v_fma_f32 v112, v112, v77, v76
    v_fma_f32 v113, v113, v77, v76
    v_fma_f32 v114, v114, v77, v76
    v_fma_f32 v115, v115, v77, v76
    v_lshlrev_b32 v116, 16, v156
    v_and_b32 v117, 0xffff0000, v156
    v_lshlrev_b32 v118, 16, v157
    v_and_b32 v119, 0xffff0000, v157
    v_lshlrev_b32 v120, 16, v158
    v_and_b32 v121, 0xffff0000, v158
    v_lshlrev_b32 v122, 16, v159
    v_and_b32 v123, 0xffff0000, v159
    v_fma_f32 v116, v116, v79, v78
    v_fma_f32 v117, v117, v79, v78
    v_fma_f32 v118, v118, v79, v78
    v_fma_f32 v119, v119, v79, v78
    v_fma_f32 v120, v120, v79, v78
    v_fma_f32 v121, v121, v79, v78
    v_fma_f32 v122, v122, v79, v78
    v_fma_f32 v123, v123, v79, v78
    v_lshlrev_b32 v124, 16, v160
    v_and_b32 v125, 0xffff0000, v160
    v_lshlrev_b32 v126, 16, v161
    v_and_b32 v127, 0xffff0000, v161
    v_lshlrev_b32 v128, 16, v162
    v_and_b32 v129, 0xffff0000, v162
    v_lshlrev_b32 v130, 16, v163
    v_and_b32 v131, 0xffff0000, v163
    v_fma_f32 v124, v124, v79, v78
    v_fma_f32 v125, v125, v79, v78
    v_fma_f32 v126, v126, v79, v78
    v_fma_f32 v127, v127, v79, v78
    v_fma_f32 v128, v128, v79, v78
    v_fma_f32 v129, v129, v79, v78
    v_fma_f32 v130, v130, v79, v78
    v_fma_f32 v131, v131, v79, v78
    v_permlane16_swap_b32 v100, v104
    v_permlane16_swap_b32 v101, v105
    v_permlane16_swap_b32 v102, v106
    v_permlane16_swap_b32 v103, v107
    v_permlane16_swap_b32 v108, v112
    v_permlane16_swap_b32 v109, v113
    v_permlane16_swap_b32 v110, v114
    v_permlane16_swap_b32 v111, v115
    v_permlane16_swap_b32 v116, v120
    v_permlane16_swap_b32 v117, v121
    v_permlane16_swap_b32 v118, v122
    v_permlane16_swap_b32 v119, v123
    v_permlane16_swap_b32 v124, v128
    v_permlane16_swap_b32 v125, v129
    v_permlane16_swap_b32 v126, v130
    v_permlane16_swap_b32 v127, v131
    s_setprio 2
    s_cmp_lt_u32 s3, 2
    s_cbranch_scc1 F_w0
    v_cmp_gt_u32 vcc, 1, v25
    s_cbranch_vccz CW_16
    ds_read_b32 v25, v1 offset:0
FW_17:
    s_waitcnt lgkmcnt(0)
    v_cmp_gt_u32 vcc, 1, v25
    s_cbranch_vccz FO_18
    s_sleep 2
    ds_read_b32 v25, v1 offset:0
    s_branch FW_17
FO_18:
CW_16:
    s_add_u32 s47, s81, 0
    s_and_b32 s47, s47, 15
    s_lshl_b32 s47, s47, 17
    s_add_u32 m0, s79, 147456
    s_add_u32 s47, s47, s57
    buffer_load_dwordx4 v40, s[20:23], s47 offen lds
    s_add_u32 m0, m0, 1024
    s_add_u32 s47, s47, 16384
    buffer_load_dwordx4 v40, s[20:23], s47 offen lds
    s_add_u32 m0, m0, 1024
    s_add_u32 s47, s47, 16384
    buffer_load_dwordx4 v40, s[20:23], s47 offen lds
    s_add_u32 m0, m0, 1024
    s_add_u32 s47, s47, 16384
    buffer_load_dwordx4 v40, s[20:23], s47 offen lds
    v_cmp_gt_u32 vcc, 2, v25
    s_cbranch_vccz CW_19
    ds_read_b32 v25, v1 offset:0
FW_20:
    s_waitcnt lgkmcnt(0)
    v_cmp_gt_u32 vcc, 2, v25
    s_cbranch_vccz FO_21
    s_sleep 2
    ds_read_b32 v25, v1 offset:0
    s_branch FW_20
FO_21:
CW_19:
    s_add_u32 s47, s81, 1
    s_and_b32 s47, s47, 15
    s_lshl_b32 s47, s47, 17
    s_add_u32 m0, s79, 0
    s_add_u32 s47, s47, s57
    buffer_load_dwordx4 v40, s[20:23], s47 offen lds
    s_add_u32 m0, m0, 1024
    s_add_u32 s47, s47, 16384
    buffer_load_dwordx4 v40, s[20:23], s47 offen lds
    s_add_u32 m0, m0, 1024
    s_add_u32 s47, s47, 16384
    buffer_load_dwordx4 v40, s[20:23], s47 offen lds
    s_add_u32 m0, m0, 1024
    s_add_u32 s47, s47, 16384
    buffer_load_dwordx4 v40, s[20:23], s47 offen lds
    s_waitcnt vmcnt(8)
    s_branch F_w1
F_w0:
    s_waitcnt vmcnt(0)
F_w1:
    s_mov_b32 s49, 1
    s_atomic_add s49, s[82:83], 0x0
    s_atomic_add s49, s[82:83], 0x80
    s_atomic_add s49, s[82:83], 0x100
    s_atomic_add s49, s[82:83], 0x180
    v_mov_b32 v26, 3
    s_mov_b64 exec, 1
    ds_write_b32 v3, v26 offset:32
    s_mov_b64 exec, -1
    s_cmp_ge_u32 s3, 2
    s_cbranch_scc1 F_wo
    ds_read_b32 v26, v18 offset:32
FW_22:
    s_waitcnt lgkmcnt(0)
    v_cmp_gt_u32 vcc, 2, v26
    s_cbranch_vccz FO_23
    ds_read_b32 v26, v18 offset:32
    s_branch FW_22
FO_23:
    v_cmp_gt_u32 vcc, 4, v25
    s_cbranch_vccz CW_24
    ds_read_b32 v25, v1 offset:0
FW_25:
    s_waitcnt lgkmcnt(0)
    v_cmp_gt_u32 vcc, 4, v25
    s_cbranch_vccz FO_26
    s_sleep 2
    ds_read_b32 v25, v1 offset:0
    s_branch FW_25
FO_26:
CW_24:
    v_lshlrev_b32 v9, 4, v0
    s_lshl_b32 s50, s3, 7
    s_add_u32 s50, s50, 159232
    s_add_u32 m0, s78, 40960
SP_27:
    s_load_dword s58, s[54:55], 0 glc
    s_waitcnt lgkmcnt(0)
    s_cmp_ge_u32 s58, 32
    s_cbranch_scc1 SD_28
    s_sleep 1
    s_branch SP_27
SD_28:
    buffer_load_dwordx4 v9, s[24:27], s52 offen offset:0 sc1 lds
    buffer_load_dwordx4 v9, s[24:27], s52 offen offset:1024 sc1 lds
    s_add_u32 m0, m0, 2048
    s_nop 0
    buffer_load_dwordx4 v9, s[24:27], s52 offen offset:2048 sc1 lds
    buffer_load_dwordx4 v9, s[24:27], s52 offen offset:3072 sc1 lds
    s_mov_b32 m0, s50
    s_mov_b32 exec_hi, 0
    buffer_load_dword v19, s[24:27], s53 offen sc1 lds
    s_mov_b64 exec, 1
    s_lshl_b32 s50, s3, 2
    s_add_u32 m0, s50, 159168
    s_add_u32 s51, s51, 184320
    buffer_load_dword v19, s[24:27], s51 offen sc1 lds
    s_waitcnt vmcnt(0)
    s_mov_b64 exec, 1
    v_mov_b32 v26, 32
    ds_write_b32 v3, v26 offset:128
    s_mov_b64 exec, -1
    s_branch F_wj
F_wo:
    v_cmp_gt_u32 vcc, 2, v25
    s_cbranch_vccz CW_29
    ds_read_b32 v25, v1 offset:0
FW_30:
    s_waitcnt lgkmcnt(0)
    v_cmp_gt_u32 vcc, 2, v25
    s_cbranch_vccz FO_31
    s_sleep 2
    ds_read_b32 v25, v1 offset:0
    s_branch FW_30
FO_31:
CW_29:
    s_add_u32 s47, s81, 2
    s_and_b32 s47, s47, 15
    s_lshl_b32 s47, s47, 17
    s_add_u32 m0, s79, 8192
    s_add_u32 s47, s47, s57
    buffer_load_dwordx4 v40, s[20:23], s47 offen lds
    s_add_u32 m0, m0, 1024
    s_add_u32 s47, s47, 16384
    buffer_load_dwordx4 v40, s[20:23], s47 offen lds
    s_add_u32 m0, m0, 1024
    s_add_u32 s47, s47, 16384
    buffer_load_dwordx4 v40, s[20:23], s47 offen lds
    s_add_u32 m0, m0, 1024
    s_add_u32 s47, s47, 16384
    buffer_load_dwordx4 v40, s[20:23], s47 offen lds
    v_cmp_gt_u32 vcc, 2, v25
    s_cbranch_vccz CW_32
    ds_read_b32 v25, v1 offset:0
FW_33:
    s_waitcnt lgkmcnt(0)
    v_cmp_gt_u32 vcc, 2, v25
    s_cbranch_vccz FO_34
    s_sleep 2
    ds_read_b32 v25, v1 offset:0
    s_branch FW_33
FO_34:
CW_32:
    s_waitcnt vmcnt(8)
    s_add_u32 s47, s81, 3
    s_and_b32 s47, s47, 15
    s_lshl_b32 s47, s47, 17
    s_add_u32 m0, s79, 139264
    s_add_u32 s47, s47, s57
    buffer_load_dwordx4 v40, s[20:23], s47 offen lds
    s_add_u32 m0, m0, 1024
    s_add_u32 s47, s47, 16384
    buffer_load_dwordx4 v40, s[20:23], s47 offen lds
    s_add_u32 m0, m0, 1024
    s_add_u32 s47, s47, 16384
    buffer_load_dwordx4 v40, s[20:23], s47 offen lds
    s_add_u32 m0, m0, 1024
    s_add_u32 s47, s47, 16384
    buffer_load_dwordx4 v40, s[20:23], s47 offen lds
    v_cmp_gt_u32 vcc, 3, v25
    s_cbranch_vccz CW_35
    ds_read_b32 v25, v1 offset:0
FW_36:
    s_waitcnt lgkmcnt(0)
    v_cmp_gt_u32 vcc, 3, v25
    s_cbranch_vccz FO_37
    s_sleep 2
    ds_read_b32 v25, v1 offset:0
    s_branch FW_36
FO_37:
CW_35:
    s_waitcnt vmcnt(8)
    s_add_u32 s47, s81, 4
    s_and_b32 s47, s47, 15
    s_lshl_b32 s47, s47, 17
    s_add_u32 m0, s79, 16384
    s_add_u32 s47, s47, s57
    buffer_load_dwordx4 v40, s[20:23], s47 offen lds
    s_add_u32 m0, m0, 1024
    s_add_u32 s47, s47, 16384
    buffer_load_dwordx4 v40, s[20:23], s47 offen lds
    s_add_u32 m0, m0, 1024
    s_add_u32 s47, s47, 16384
    buffer_load_dwordx4 v40, s[20:23], s47 offen lds
    s_add_u32 m0, m0, 1024
    s_add_u32 s47, s47, 16384
    buffer_load_dwordx4 v40, s[20:23], s47 offen lds
    v_cmp_gt_u32 vcc, 3, v25
    s_cbranch_vccz CW_38
    ds_read_b32 v25, v1 offset:0
FW_39:
    s_waitcnt lgkmcnt(0)
    v_cmp_gt_u32 vcc, 3, v25
    s_cbranch_vccz FO_40
    s_sleep 2
    ds_read_b32 v25, v1 offset:0
    s_branch FW_39
FO_40:
CW_38:
    s_waitcnt vmcnt(8)
    s_add_u32 s47, s81, 5
    s_and_b32 s47, s47, 15
    s_lshl_b32 s47, s47, 17
    s_add_u32 m0, s79, 24576
    s_add_u32 s47, s47, s57
    buffer_load_dwordx4 v40, s[20:23], s47 offen lds
    s_add_u32 m0, m0, 1024
    s_add_u32 s47, s47, 16384
    buffer_load_dwordx4 v40, s[20:23], s47 offen lds
    s_add_u32 m0, m0, 1024
    s_add_u32 s47, s47, 16384
    buffer_load_dwordx4 v40, s[20:23], s47 offen lds
    s_add_u32 m0, m0, 1024
    s_add_u32 s47, s47, 16384
    buffer_load_dwordx4 v40, s[20:23], s47 offen lds
    v_cmp_gt_u32 vcc, 3, v25
    s_cbranch_vccz CW_41
    ds_read_b32 v25, v1 offset:0
FW_42:
    s_waitcnt lgkmcnt(0)
    v_cmp_gt_u32 vcc, 3, v25
    s_cbranch_vccz FO_43
    s_sleep 2
    ds_read_b32 v25, v1 offset:0
    s_branch FW_42
FO_43:
CW_41:
    s_waitcnt vmcnt(8)
    s_add_u32 s47, s81, 6
    s_and_b32 s47, s47, 15
    s_lshl_b32 s47, s47, 17
    s_add_u32 m0, s79, 131072
    s_add_u32 s47, s47, s57
    buffer_load_dwordx4 v40, s[20:23], s47 offen lds
    s_add_u32 m0, m0, 1024
    s_add_u32 s47, s47, 16384
    buffer_load_dwordx4 v40, s[20:23], s47 offen lds
    s_add_u32 m0, m0, 1024
    s_add_u32 s47, s47, 16384
    buffer_load_dwordx4 v40, s[20:23], s47 offen lds
    s_add_u32 m0, m0, 1024
    s_add_u32 s47, s47, 16384
    buffer_load_dwordx4 v40, s[20:23], s47 offen lds
    v_cmp_gt_u32 vcc, 4, v25
    s_cbranch_vccz CW_44
    ds_read_b32 v25, v1 offset:0
FW_45:
    s_waitcnt lgkmcnt(0)
    v_cmp_gt_u32 vcc, 4, v25
    s_cbranch_vccz FO_46
    s_sleep 2
    ds_read_b32 v25, v1 offset:0
    s_branch FW_45
FO_46:
CW_44:
    s_waitcnt vmcnt(8)
    s_add_u32 s47, s81, 7
    s_and_b32 s47, s47, 15
    s_lshl_b32 s47, s47, 17
    s_add_u32 m0, s79, 81920
    s_add_u32 s47, s47, s57
    buffer_load_dwordx4 v40, s[20:23], s47 offen lds
    s_add_u32 m0, m0, 1024
    s_add_u32 s47, s47, 16384
    buffer_load_dwordx4 v40, s[20:23], s47 offen lds
    s_add_u32 m0, m0, 1024
    s_add_u32 s47, s47, 16384
    buffer_load_dwordx4 v40, s[20:23], s47 offen lds
    s_add_u32 m0, m0, 1024
    s_add_u32 s47, s47, 16384
    buffer_load_dwordx4 v40, s[20:23], s47 offen lds
    v_cmp_gt_u32 vcc, 5, v25
    s_cbranch_vccz CW_47
    ds_read_b32 v25, v1 offset:0
FW_48:
    s_waitcnt lgkmcnt(0)
    v_cmp_gt_u32 vcc, 5, v25
    s_cbranch_vccz FO_49
    s_sleep 2
    ds_read_b32 v25, v1 offset:0
    s_branch FW_48
FO_49:
CW_47:
    s_waitcnt vmcnt(8)
    s_add_u32 s47, s81, 8
    s_and_b32 s47, s47, 15
    s_lshl_b32 s47, s47, 17
    s_add_u32 m0, s79, 49152
    s_add_u32 s47, s47, s57
    buffer_load_dwordx4 v40, s[20:23], s47 offen lds
    s_add_u32 m0, m0, 1024
    s_add_u32 s47, s47, 16384
    buffer_load_dwordx4 v40, s[20:23], s47 offen lds
    s_add_u32 m0, m0, 1024
    s_add_u32 s47, s47, 16384
    buffer_load_dwordx4 v40, s[20:23], s47 offen lds
    s_add_u32 m0, m0, 1024
    s_add_u32 s47, s47, 16384
    buffer_load_dwordx4 v40, s[20:23], s47 offen lds
    v_cmp_gt_u32 vcc, 5, v25
    s_cbranch_vccz CW_50
    ds_read_b32 v25, v1 offset:0
FW_51:
    s_waitcnt lgkmcnt(0)
    v_cmp_gt_u32 vcc, 5, v25
    s_cbranch_vccz FO_52
    s_sleep 2
    ds_read_b32 v25, v1 offset:0
    s_branch FW_51
FO_52:
CW_50:
    s_waitcnt vmcnt(8)
    s_add_u32 s47, s81, 9
    s_and_b32 s47, s47, 15
    s_lshl_b32 s47, s47, 17
    s_add_u32 m0, s79, 57344
    s_add_u32 s47, s47, s57
    buffer_load_dwordx4 v40, s[20:23], s47 offen lds
    s_add_u32 m0, m0, 1024
    s_add_u32 s47, s47, 16384
    buffer_load_dwordx4 v40, s[20:23], s47 offen lds
    s_add_u32 m0, m0, 1024
    s_add_u32 s47, s47, 16384
    buffer_load_dwordx4 v40, s[20:23], s47 offen lds
    s_add_u32 m0, m0, 1024
    s_add_u32 s47, s47, 16384
    buffer_load_dwordx4 v40, s[20:23], s47 offen lds
    v_cmp_gt_u32 vcc, 5, v25
    s_cbranch_vccz CW_53
    ds_read_b32 v25, v1 offset:0
FW_54:
    s_waitcnt lgkmcnt(0)
    v_cmp_gt_u32 vcc, 5, v25
    s_cbranch_vccz FO_55
    s_sleep 2
    ds_read_b32 v25, v1 offset:0
    s_branch FW_54
FO_55:
CW_53:
    s_waitcnt vmcnt(8)
    s_add_u32 s47, s81, 10
    s_and_b32 s47, s47, 15
    s_lshl_b32 s47, s47, 17
    s_add_u32 m0, s79, 73728
    s_add_u32 s47, s47, s57
    buffer_load_dwordx4 v40, s[20:23], s47 offen lds
    s_add_u32 m0, m0, 1024
    s_add_u32 s47, s47, 16384
    buffer_load_dwordx4 v40, s[20:23], s47 offen lds
    s_add_u32 m0, m0, 1024
    s_add_u32 s47, s47, 16384
    buffer_load_dwordx4 v40, s[20:23], s47 offen lds
    s_add_u32 m0, m0, 1024
    s_add_u32 s47, s47, 16384
    buffer_load_dwordx4 v40, s[20:23], s47 offen lds
    v_cmp_gt_u32 vcc, 6, v25
    s_cbranch_vccz CW_56
    ds_read_b32 v25, v1 offset:0
FW_57:
    s_waitcnt lgkmcnt(0)
    v_cmp_gt_u32 vcc, 6, v25
    s_cbranch_vccz FO_58
    s_sleep 2
    ds_read_b32 v25, v1 offset:0
    s_branch FW_57
FO_58:
CW_56:
    s_waitcnt vmcnt(8)
    s_add_u32 s47, s81, 11
    s_and_b32 s47, s47, 15
    s_lshl_b32 s47, s47, 17
    s_add_u32 m0, s79, 98304
    s_add_u32 s47, s47, s57
    buffer_load_dwordx4 v40, s[20:23], s47 offen lds
    s_add_u32 m0, m0, 1024
    s_add_u32 s47, s47, 16384
    buffer_load_dwordx4 v40, s[20:23], s47 offen lds
    s_add_u32 m0, m0, 1024
    s_add_u32 s47, s47, 16384
    buffer_load_dwordx4 v40, s[20:23], s47 offen lds
    s_add_u32 m0, m0, 1024
    s_add_u32 s47, s47, 16384
    buffer_load_dwordx4 v40, s[20:23], s47 offen lds
    v_cmp_gt_u32 vcc, 7, v25
    s_cbranch_vccz CW_59
    ds_read_b32 v25, v1 offset:0
FW_60:
    s_waitcnt lgkmcnt(0)
    v_cmp_gt_u32 vcc, 7, v25
    s_cbranch_vccz FO_61
    s_sleep 2
    ds_read_b32 v25, v1 offset:0
    s_branch FW_60
FO_61:
CW_59:
    s_waitcnt vmcnt(8)
    s_add_u32 s47, s81, 12
    s_and_b32 s47, s47, 15
    s_lshl_b32 s47, s47, 17
    s_add_u32 m0, s79, 90112
    s_add_u32 s47, s47, s57
    buffer_load_dwordx4 v40, s[20:23], s47 offen lds
    s_add_u32 m0, m0, 1024
    s_add_u32 s47, s47, 16384
    buffer_load_dwordx4 v40, s[20:23], s47 offen lds
    s_add_u32 m0, m0, 1024
    s_add_u32 s47, s47, 16384
    buffer_load_dwordx4 v40, s[20:23], s47 offen lds
    s_add_u32 m0, m0, 1024
    s_add_u32 s47, s47, 16384
    buffer_load_dwordx4 v40, s[20:23], s47 offen lds
    v_cmp_gt_u32 vcc, 8, v25
    s_cbranch_vccz CW_62
    ds_read_b32 v25, v1 offset:0
FW_63:
    s_waitcnt lgkmcnt(0)
    v_cmp_gt_u32 vcc, 8, v25
    s_cbranch_vccz FO_64
    s_sleep 2
    ds_read_b32 v25, v1 offset:0
    s_branch FW_63
FO_64:
CW_62:
    s_waitcnt vmcnt(8)
    s_add_u32 s47, s81, 13
    s_and_b32 s47, s47, 15
    s_lshl_b32 s47, s47, 17
    s_add_u32 m0, s79, 114688
    s_add_u32 s47, s47, s57
    buffer_load_dwordx4 v40, s[20:23], s47 offen lds
    s_add_u32 m0, m0, 1024
    s_add_u32 s47, s47, 16384
    buffer_load_dwordx4 v40, s[20:23], s47 offen lds
    s_add_u32 m0, m0, 1024
    s_add_u32 s47, s47, 16384
    buffer_load_dwordx4 v40, s[20:23], s47 offen lds
    s_add_u32 m0, m0, 1024
    s_add_u32 s47, s47, 16384
    buffer_load_dwordx4 v40, s[20:23], s47 offen lds
    v_cmp_gt_u32 vcc, 9, v25
    s_cbranch_vccz CW_65
    ds_read_b32 v25, v1 offset:0
FW_66:
    s_waitcnt lgkmcnt(0)
    v_cmp_gt_u32 vcc, 9, v25
    s_cbranch_vccz FO_67
    s_sleep 2
    ds_read_b32 v25, v1 offset:0
    s_branch FW_66
FO_67:
CW_65:
    s_waitcnt vmcnt(8)
    s_add_u32 s47, s81, 14
    s_and_b32 s47, s47, 15
    s_lshl_b32 s47, s47, 17
    s_add_u32 m0, s79, 106496
    s_add_u32 s47, s47, s57
    buffer_load_dwordx4 v40, s[20:23], s47 offen lds
    s_add_u32 m0, m0, 1024
    s_add_u32 s47, s47, 16384
    buffer_load_dwordx4 v40, s[20:23], s47 offen lds
    s_add_u32 m0, m0, 1024
    s_add_u32 s47, s47, 16384
    buffer_load_dwordx4 v40, s[20:23], s47 offen lds
    s_add_u32 m0, m0, 1024
    s_add_u32 s47, s47, 16384
    buffer_load_dwordx4 v40, s[20:23], s47 offen lds
    v_cmp_gt_u32 vcc, 10, v25
    s_cbranch_vccz CW_68
    ds_read_b32 v25, v1 offset:0
FW_69:
    s_waitcnt lgkmcnt(0)
    v_cmp_gt_u32 vcc, 10, v25
    s_cbranch_vccz FO_70
    s_sleep 2
    ds_read_b32 v25, v1 offset:0
    s_branch FW_69
FO_70:
CW_68:
    s_waitcnt vmcnt(8)
    s_add_u32 s47, s81, 15
    s_and_b32 s47, s47, 15
    s_lshl_b32 s47, s47, 17
    s_add_u32 m0, s79, 122880
    s_add_u32 s47, s47, s57
    buffer_load_dwordx4 v40, s[20:23], s47 offen lds
    s_add_u32 m0, m0, 1024
    s_add_u32 s47, s47, 16384
    buffer_load_dwordx4 v40, s[20:23], s47 offen lds
    s_add_u32 m0, m0, 1024
    s_add_u32 s47, s47, 16384
    buffer_load_dwordx4 v40, s[20:23], s47 offen lds
    s_add_u32 m0, m0, 1024
    s_add_u32 s47, s47, 16384
    buffer_load_dwordx4 v40, s[20:23], s47 offen lds
F_wj:
    v_mov_b32 v5, 159096
    s_branch IW_s6
IW_w6:
    s_branch IW_r6
IW_s6:
    ds_read_b32 v6, v5 offset:0
FW_71:
    s_waitcnt lgkmcnt(0)
    v_cmp_gt_u32 vcc, 1, v6
    s_cbranch_vccz FO_72
    s_sleep 1
    ds_read_b32 v6, v5 offset:0
    s_branch FW_71
FO_72:
    v_and_b32 v5, 7, v0
    v_lshlrev_b32 v5, 2, v5
    v_add_u32 v5, 158976, v5
    ds_read_b32 v5, v5
    s_lshr_b32 s47, s64, 5
    s_sub_u32 s47, 63, s47
    s_mov_b64 s[60:61], 0
    s_waitcnt lgkmcnt(0)
    v_bfe_u32 v5, v5, 5, 6
    v_cmp_eq_u32 vcc, s47, v5
    s_cbranch_vccz F_ns

    v_mov_b32 v5, 158976
    ds_read_b128 v[44:47], v5
    ds_read_b128 v[48:51], v5 offset:16
    v_and_b32 v6, 15, v0
    v_add_u32 v6, s64, v6
    v_sub_u32 v6, 2047, v6
    v_subrev_u32 v7, 16, v6
    v_mov_b32 v164, 0
    v_mov_b32 v165, 0
    s_waitcnt lgkmcnt(0)
    v_and_b32 v5, 0x7ff, v44
    v_or_b32 v44, 0x4000, v44
    v_cmp_eq_u32 vcc, v5, v6
    v_cmp_eq_u32 s[62:63], v5, v7
    s_nop 0
    v_cndmask_b32 v164, v164, v44, vcc
    v_cndmask_b32 v165, v165, v44, s[62:63]
    v_and_b32 v5, 0x7ff, v45
    v_or_b32 v45, 0x4800, v45
    v_cmp_eq_u32 vcc, v5, v6
    v_cmp_eq_u32 s[62:63], v5, v7
    s_nop 0
    v_cndmask_b32 v164, v164, v45, vcc
    v_cndmask_b32 v165, v165, v45, s[62:63]
    v_and_b32 v5, 0x7ff, v46
    v_or_b32 v46, 0x5000, v46
    v_cmp_eq_u32 vcc, v5, v6
    v_cmp_eq_u32 s[62:63], v5, v7
    s_nop 0
    v_cndmask_b32 v164, v164, v46, vcc
    v_cndmask_b32 v165, v165, v46, s[62:63]
    v_and_b32 v5, 0x7ff, v47
    v_or_b32 v47, 0x5800, v47
    v_cmp_eq_u32 vcc, v5, v6
    v_cmp_eq_u32 s[62:63], v5, v7
    s_nop 0
    v_cndmask_b32 v164, v164, v47, vcc
    v_cndmask_b32 v165, v165, v47, s[62:63]
    v_and_b32 v5, 0x7ff, v48
    v_or_b32 v48, 0x6000, v48
    v_cmp_eq_u32 vcc, v5, v6
    v_cmp_eq_u32 s[62:63], v5, v7
    s_nop 0
    v_cndmask_b32 v164, v164, v48, vcc
    v_cndmask_b32 v165, v165, v48, s[62:63]
    v_and_b32 v5, 0x7ff, v49
    v_or_b32 v49, 0x6800, v49
    v_cmp_eq_u32 vcc, v5, v6
    v_cmp_eq_u32 s[62:63], v5, v7
    s_nop 0
    v_cndmask_b32 v164, v164, v49, vcc
    v_cndmask_b32 v165, v165, v49, s[62:63]
    v_and_b32 v5, 0x7ff, v50
    v_or_b32 v50, 0x7000, v50
    v_cmp_eq_u32 vcc, v5, v6
    v_cmp_eq_u32 s[62:63], v5, v7
    s_nop 0
    v_cndmask_b32 v164, v164, v50, vcc
    v_cndmask_b32 v165, v165, v50, s[62:63]
    v_and_b32 v5, 0x7ff, v51
    v_or_b32 v51, 0x7800, v51
    v_cmp_eq_u32 vcc, v5, v6
    v_cmp_eq_u32 s[62:63], v5, v7
    s_nop 0
    v_cndmask_b32 v164, v164, v51, vcc
    v_cndmask_b32 v165, v165, v51, s[62:63]
    s_mov_b32 s47, 0xbfb8aa3b
    v_and_b32 v7, 0x30, v0
    v_add_u32 v7, 159744, v7
    v_cmp_ne_u32 s[74:75], 0, v164
    v_bfe_u32 v5, v164, 11, 3
    v_lshl_add_u32 v162, v5, 8, v7
    v_and_b32 v5, 0xffff0000, v164
    v_ashrrev_i32 v6, 31, v5
    v_not_b32 v6, v6
    v_or_b32 v6, 0x80000000, v6
    v_xor_b32 v5, v5, v6
    v_and_b32 v5, 0xffff0000, v5
    v_mul_f32 v5, s47, v5
    v_exp_f32 v5, v5
    s_nop 0
    v_add_f32 v5, 1.0, v5
    v_rcp_f32 v5, v5
    s_nop 0
    v_cvt_pk_bf16_f32 v5, v5, v5
    v_lshlrev_b32 v164, 16, v5
    v_cmp_ne_u32 s[76:77], 0, v165
    v_bfe_u32 v5, v165, 11, 3
    v_lshl_add_u32 v163, v5, 8, v7
    v_and_b32 v5, 0xffff0000, v165
    v_ashrrev_i32 v6, 31, v5
    v_not_b32 v6, v6
    v_or_b32 v6, 0x80000000, v6
    v_xor_b32 v5, v5, v6
    v_and_b32 v5, 0xffff0000, v5
    v_mul_f32 v5, s47, v5
    v_exp_f32 v5, v5
    s_nop 0
    v_add_f32 v5, 1.0, v5
    v_rcp_f32 v5, v5
    s_nop 0
    v_cvt_pk_bf16_f32 v5, v5, v5
    v_lshlrev_b32 v165, 16, v5
    v_mov_b32 v161, 159136
    s_mov_b64 s[60:61], 1
F_ns:
    s_lshl_b32 s51, s28, 2
    s_add_u32 s51, s51, s3
    s_lshl_b32 s51, s51, 3
    s_and_b32 s47, s29, 3
    s_add_u32 s51, s51, s47
    s_lshl_b32 s51, s51, 7

    s_add_u32 s54, s51, 0x835000
    s_add_u32 s54, s72, s54
    s_addc_u32 s55, s73, 0
    v_lshlrev_b32 v98, 4, v0
    v_lshrrev_b32 v16, 4, v0
    v_bfe_u32 v17, v0, 2, 2
    v_lshl_add_u32 v17, v16, 2, v17
    v_bfe_u32 v16, v17, 1, 2
    v_lshlrev_b32 v16, 5, v16
    v_lshl_add_u32 v16, v17, 7, v16
    v_and_b32 v17, 3, v0
    v_lshl_add_u32 v4, v17, 3, v16
    v_xor_b32 v5, 32, v4
    v_xor_b32 v6, 64, v4
    v_xor_b32 v7, 96, v4
    s_lshl_b32 s79, s28, 18
    s_lshl_b32 s80, s3, 16
    s_add_u32 s79, s79, s80
    s_lshl_b32 s81, s81, 11
    v_mov_b32 v99, 1

    v_add_u32 v8, 57344, v4
    v_add_u32 v9, 57344, v5
    v_add_u32 v10, 57344, v6
    v_add_u32 v11, 57344, v7
    v_add_u32 v12, 114688, v4
    v_add_u32 v13, 114688, v5
    v_add_u32 v14, 114688, v6
    v_add_u32 v15, 114688, v7
    s_add_u32 s16, s72, 0x400000
    s_addc_u32 s17, s73, 0
    s_mov_b32 s18, 0x400000
    s_mov_b32 s19, 0x00020000
    s_mov_b32 s12, s68
    s_mov_b32 s13, s69
    s_mov_b32 s14, 0x400000
    s_mov_b32 s15, 0x00020000
    s_add_u32 s80, s81, 0
    s_and_b32 s80, s80, 0x7fff
    s_add_u32 s4, s80, s79
    s_add_u32 s80, s81, 2048
    s_and_b32 s80, s80, 0x7fff
    s_add_u32 s5, s80, s79
    s_add_u32 s80, s81, 4096
    s_and_b32 s80, s80, 0x7fff
    s_add_u32 s6, s80, s79
    s_add_u32 s80, s81, 6144
    s_and_b32 s80, s80, 0x7fff
    s_add_u32 s7, s80, s79
    s_add_u32 s80, s81, 8192
    s_and_b32 s80, s80, 0x7fff
    s_add_u32 s8, s80, s79
    s_add_u32 s80, s81, 10240
    s_and_b32 s80, s80, 0x7fff
    s_add_u32 s9, s80, s79
    s_add_u32 s80, s81, 12288
    s_and_b32 s80, s80, 0x7fff
    s_add_u32 s10, s80, s79
    s_add_u32 s80, s81, 14336
    s_and_b32 s80, s80, 0x7fff
    s_add_u32 s11, s80, s79
    s_add_u32 s80, s81, 16384
    s_and_b32 s80, s80, 0x7fff
    s_add_u32 s30, s80, s79
    s_add_u32 s80, s81, 18432
    s_and_b32 s80, s80, 0x7fff
    s_add_u32 s31, s80, s79
    s_add_u32 s80, s81, 20480
    s_and_b32 s80, s80, 0x7fff
    s_add_u32 s32, s80, s79
    s_add_u32 s80, s81, 22528
    s_and_b32 s80, s80, 0x7fff
    s_add_u32 s33, s80, s79
    s_add_u32 s80, s81, 24576
    s_and_b32 s80, s80, 0x7fff
    s_add_u32 s34, s80, s79
    s_add_u32 s80, s81, 26624
    s_and_b32 s80, s80, 0x7fff
    s_add_u32 s35, s80, s79
    s_add_u32 s80, s81, 28672
    s_and_b32 s80, s80, 0x7fff
    s_add_u32 s36, s80, s79
    s_add_u32 s80, s81, 30720
    s_and_b32 s80, s80, 0x7fff
    s_add_u32 s37, s80, s79
    v_add_u32 v97, 0x8000, v98
    s_setprio 2
    s_mov_b32 s50, 0
F_op:
    s_load_dword s47, s[54:55], 0 glc
    s_getreg_b32 s51, hwreg(HW_REG_IB_STS)
    s_and_b32 s51, s51, 0xc0000f
    s_or_b32 s51, s51, s50
    s_cbranch_scc1 F_oq
    s_mov_b64 exec, 1
    ds_write_b32 v3, v99 offset:160
    s_mov_b64 exec, -1
    s_mov_b32 s50, 1
F_oq:
    s_waitcnt lgkmcnt(0)
    s_cmp_lt_u32 s47, 16
    s_cbranch_scc1 F_op
    buffer_load_dwordx4 v[48:51], v98, s[16:19], s4 offen offset:0 sc1
    buffer_load_dwordx4 v[52:55], v97, s[16:19], s4 offen offset:0 sc1
    buffer_load_dwordx4 v[56:59], v98, s[16:19], s4 offen offset:1024 sc1
    buffer_load_dwordx4 v[60:63], v97, s[16:19], s4 offen offset:1024 sc1
    buffer_load_dwordx4 v[64:67], v98, s[16:19], s5 offen offset:0 sc1
    buffer_load_dwordx4 v[68:71], v97, s[16:19], s5 offen offset:0 sc1
    buffer_load_dwordx4 v[72:75], v98, s[16:19], s5 offen offset:1024 sc1
    buffer_load_dwordx4 v[76:79], v97, s[16:19], s5 offen offset:1024 sc1
    buffer_load_dwordx4 v[80:83], v98, s[16:19], s6 offen offset:0 sc1
    buffer_load_dwordx4 v[84:87], v97, s[16:19], s6 offen offset:0 sc1
    buffer_load_dwordx4 v[88:91], v98, s[16:19], s6 offen offset:1024 sc1
    buffer_load_dwordx4 v[92:95], v97, s[16:19], s6 offen offset:1024 sc1
    s_cmp_lg_u32 s50, 0
    s_cbranch_scc1 F_or
    s_waitcnt vmcnt(12)
    s_mov_b64 exec, 1
    ds_write_b32 v3, v99 offset:160
    s_mov_b64 exec, -1
F_or:
    v_or_b32 v17, 8, v1
    ds_read_b32 v16, v17 offset:160
FW_73:
    s_waitcnt lgkmcnt(0)
    v_cmp_gt_u32 vcc, 1, v16
    s_cbranch_vccz FO_74
    ds_read_b32 v16, v17 offset:160
    s_branch FW_73
FO_74:
    v_and_b32 v1, 0x3fff, v2
    v_bfe_u32 v99, v0, 3, 1
    v_lshl_add_u32 v1, v99, 6, v1
    ds_read_b64_tr_b16 v[16:17], v12 offset:32768
    ds_read_b64_tr_b16 v[18:19], v12 offset:34816
    ds_read_b64_tr_b16 v[20:21], v13 offset:32768
    ds_read_b64_tr_b16 v[22:23], v13 offset:34816
    ds_read_b64_tr_b16 v[24:25], v14 offset:32768
    ds_read_b64_tr_b16 v[26:27], v14 offset:34816
    ds_read_b64_tr_b16 v[28:29], v15 offset:32768
    ds_read_b64_tr_b16 v[30:31], v15 offset:34816
    s_waitcnt vmcnt(10) lgkmcnt(0)
    v_mfma_f32_16x16x32_bf16 v[100:103], v[16:19], v[48:51], v[100:103]
    ds_read_b64_tr_b16 v[32:33], v12 offset:36864
    ds_read_b64_tr_b16 v[34:35], v12 offset:38912
    v_mfma_f32_16x16x32_bf16 v[116:119], v[16:19], v[52:55], v[116:119]
    ds_read_b64_tr_b16 v[36:37], v13 offset:36864
    ds_read_b64_tr_b16 v[38:39], v13 offset:38912
    v_mfma_f32_16x16x32_bf16 v[104:107], v[20:23], v[48:51], v[104:107]
    ds_read_b64_tr_b16 v[40:41], v14 offset:36864
    ds_read_b64_tr_b16 v[42:43], v14 offset:38912
    v_mfma_f32_16x16x32_bf16 v[120:123], v[20:23], v[52:55], v[120:123]
    ds_read_b64_tr_b16 v[44:45], v15 offset:36864
    ds_read_b64_tr_b16 v[46:47], v15 offset:38912
    v_mfma_f32_16x16x32_bf16 v[108:111], v[24:27], v[48:51], v[108:111]
    buffer_load_dwordx4 v[132:135], v98, s[16:19], s7 offen offset:0 sc1
    v_mfma_f32_16x16x32_bf16 v[124:127], v[24:27], v[52:55], v[124:127]
    v_mfma_f32_16x16x32_bf16 v[112:115], v[28:31], v[48:51], v[112:115]
    buffer_load_dwordx4 v[136:139], v97, s[16:19], s7 offen offset:0 sc1
    v_mfma_f32_16x16x32_bf16 v[128:131], v[28:31], v[52:55], v[128:131]
    s_waitcnt vmcnt(10) lgkmcnt(0)
    v_mfma_f32_16x16x32_bf16 v[100:103], v[32:35], v[56:59], v[100:103]
    ds_read_b64_tr_b16 v[16:17], v4 offset:0
    ds_read_b64_tr_b16 v[18:19], v4 offset:2048
    v_mfma_f32_16x16x32_bf16 v[116:119], v[32:35], v[60:63], v[116:119]
    ds_read_b64_tr_b16 v[20:21], v5 offset:0
    ds_read_b64_tr_b16 v[22:23], v5 offset:2048
    v_mfma_f32_16x16x32_bf16 v[104:107], v[36:39], v[56:59], v[104:107]
    ds_read_b64_tr_b16 v[24:25], v6 offset:0
    ds_read_b64_tr_b16 v[26:27], v6 offset:2048
    v_mfma_f32_16x16x32_bf16 v[120:123], v[36:39], v[60:63], v[120:123]
    ds_read_b64_tr_b16 v[28:29], v7 offset:0
    ds_read_b64_tr_b16 v[30:31], v7 offset:2048
    v_mfma_f32_16x16x32_bf16 v[108:111], v[40:43], v[56:59], v[108:111]
    buffer_load_dwordx4 v[48:51], v98, s[16:19], s7 offen offset:1024 sc1
    v_mfma_f32_16x16x32_bf16 v[124:127], v[40:43], v[60:63], v[124:127]
    v_mfma_f32_16x16x32_bf16 v[112:115], v[44:47], v[56:59], v[112:115]
    buffer_load_dwordx4 v[52:55], v97, s[16:19], s7 offen offset:1024 sc1
    v_mfma_f32_16x16x32_bf16 v[128:131], v[44:47], v[60:63], v[128:131]
    s_waitcnt vmcnt(10) lgkmcnt(0)
    v_mfma_f32_16x16x32_bf16 v[100:103], v[16:19], v[64:67], v[100:103]
    ds_read_b64_tr_b16 v[32:33], v4 offset:4096
    ds_read_b64_tr_b16 v[34:35], v4 offset:6144
    v_mfma_f32_16x16x32_bf16 v[116:119], v[16:19], v[68:71], v[116:119]
    ds_read_b64_tr_b16 v[36:37], v5 offset:4096
    ds_read_b64_tr_b16 v[38:39], v5 offset:6144
    v_mfma_f32_16x16x32_bf16 v[104:107], v[20:23], v[64:67], v[104:107]
    ds_read_b64_tr_b16 v[40:41], v6 offset:4096
    ds_read_b64_tr_b16 v[42:43], v6 offset:6144
    v_mfma_f32_16x16x32_bf16 v[120:123], v[20:23], v[68:71], v[120:123]
    ds_read_b64_tr_b16 v[44:45], v7 offset:4096
    ds_read_b64_tr_b16 v[46:47], v7 offset:6144
    v_mfma_f32_16x16x32_bf16 v[108:111], v[24:27], v[64:67], v[108:111]
    buffer_load_dwordx4 v[56:59], v98, s[16:19], s8 offen offset:0 sc1
    v_mfma_f32_16x16x32_bf16 v[124:127], v[24:27], v[68:71], v[124:127]
    v_mfma_f32_16x16x32_bf16 v[112:115], v[28:31], v[64:67], v[112:115]
    buffer_load_dwordx4 v[60:63], v97, s[16:19], s8 offen offset:0 sc1
    v_mfma_f32_16x16x32_bf16 v[128:131], v[28:31], v[68:71], v[128:131]
    s_waitcnt vmcnt(10) lgkmcnt(0)
    v_mfma_f32_16x16x32_bf16 v[100:103], v[32:35], v[72:75], v[100:103]
    ds_read_b64_tr_b16 v[16:17], v4 offset:8192
    ds_read_b64_tr_b16 v[18:19], v4 offset:10240
    v_mfma_f32_16x16x32_bf16 v[116:119], v[32:35], v[76:79], v[116:119]
    ds_read_b64_tr_b16 v[20:21], v5 offset:8192
    ds_read_b64_tr_b16 v[22:23], v5 offset:10240
    v_mfma_f32_16x16x32_bf16 v[104:107], v[36:39], v[72:75], v[104:107]
    ds_read_b64_tr_b16 v[24:25], v6 offset:8192
    ds_read_b64_tr_b16 v[26:27], v6 offset:10240
    v_mfma_f32_16x16x32_bf16 v[120:123], v[36:39], v[76:79], v[120:123]
    ds_read_b64_tr_b16 v[28:29], v7 offset:8192
    ds_read_b64_tr_b16 v[30:31], v7 offset:10240
    v_mfma_f32_16x16x32_bf16 v[108:111], v[40:43], v[72:75], v[108:111]
    buffer_load_dwordx4 v[64:67], v98, s[16:19], s8 offen offset:1024 sc1
    v_mfma_f32_16x16x32_bf16 v[124:127], v[40:43], v[76:79], v[124:127]
    v_mfma_f32_16x16x32_bf16 v[112:115], v[44:47], v[72:75], v[112:115]
    buffer_load_dwordx4 v[68:71], v97, s[16:19], s8 offen offset:1024 sc1
    v_mfma_f32_16x16x32_bf16 v[128:131], v[44:47], v[76:79], v[128:131]
    s_waitcnt vmcnt(10) lgkmcnt(0)
    v_mfma_f32_16x16x32_bf16 v[100:103], v[16:19], v[80:83], v[100:103]
    ds_read_b64_tr_b16 v[32:33], v4 offset:12288
    ds_read_b64_tr_b16 v[34:35], v4 offset:14336
    v_mfma_f32_16x16x32_bf16 v[116:119], v[16:19], v[84:87], v[116:119]
    ds_read_b64_tr_b16 v[36:37], v5 offset:12288
    ds_read_b64_tr_b16 v[38:39], v5 offset:14336
    v_mfma_f32_16x16x32_bf16 v[104:107], v[20:23], v[80:83], v[104:107]
    ds_read_b64_tr_b16 v[40:41], v6 offset:12288
    ds_read_b64_tr_b16 v[42:43], v6 offset:14336
    v_mfma_f32_16x16x32_bf16 v[120:123], v[20:23], v[84:87], v[120:123]
    ds_read_b64_tr_b16 v[44:45], v7 offset:12288
    ds_read_b64_tr_b16 v[46:47], v7 offset:14336
    v_mfma_f32_16x16x32_bf16 v[108:111], v[24:27], v[80:83], v[108:111]
    buffer_load_dwordx4 v[72:75], v98, s[16:19], s9 offen offset:0 sc1
    v_mfma_f32_16x16x32_bf16 v[124:127], v[24:27], v[84:87], v[124:127]
    v_mfma_f32_16x16x32_bf16 v[112:115], v[28:31], v[80:83], v[112:115]
    buffer_load_dwordx4 v[76:79], v97, s[16:19], s9 offen offset:0 sc1
    v_mfma_f32_16x16x32_bf16 v[128:131], v[28:31], v[84:87], v[128:131]
    s_waitcnt vmcnt(10) lgkmcnt(0)
    v_mfma_f32_16x16x32_bf16 v[100:103], v[32:35], v[88:91], v[100:103]
    ds_read_b64_tr_b16 v[16:17], v12 offset:24576
    ds_read_b64_tr_b16 v[18:19], v12 offset:26624
    v_mfma_f32_16x16x32_bf16 v[116:119], v[32:35], v[92:95], v[116:119]
    ds_read_b64_tr_b16 v[20:21], v13 offset:24576
    ds_read_b64_tr_b16 v[22:23], v13 offset:26624
    v_mfma_f32_16x16x32_bf16 v[104:107], v[36:39], v[88:91], v[104:107]
    ds_read_b64_tr_b16 v[24:25], v14 offset:24576
    ds_read_b64_tr_b16 v[26:27], v14 offset:26624
    v_mfma_f32_16x16x32_bf16 v[120:123], v[36:39], v[92:95], v[120:123]
    ds_read_b64_tr_b16 v[28:29], v15 offset:24576
    ds_read_b64_tr_b16 v[30:31], v15 offset:26624
    v_mfma_f32_16x16x32_bf16 v[108:111], v[40:43], v[88:91], v[108:111]
    buffer_load_dwordx4 v[80:83], v98, s[16:19], s9 offen offset:1024 sc1
    v_mfma_f32_16x16x32_bf16 v[124:127], v[40:43], v[92:95], v[124:127]
    v_mfma_f32_16x16x32_bf16 v[112:115], v[44:47], v[88:91], v[112:115]
    buffer_load_dwordx4 v[84:87], v97, s[16:19], s9 offen offset:1024 sc1
    v_mfma_f32_16x16x32_bf16 v[128:131], v[44:47], v[92:95], v[128:131]
    s_waitcnt vmcnt(10) lgkmcnt(0)
    v_mfma_f32_16x16x32_bf16 v[100:103], v[16:19], v[132:135], v[100:103]
    ds_read_b64_tr_b16 v[32:33], v12 offset:28672
    ds_read_b64_tr_b16 v[34:35], v12 offset:30720
    v_mfma_f32_16x16x32_bf16 v[116:119], v[16:19], v[136:139], v[116:119]
    ds_read_b64_tr_b16 v[36:37], v13 offset:28672
    ds_read_b64_tr_b16 v[38:39], v13 offset:30720
    v_mfma_f32_16x16x32_bf16 v[104:107], v[20:23], v[132:135], v[104:107]
    ds_read_b64_tr_b16 v[40:41], v14 offset:28672
    ds_read_b64_tr_b16 v[42:43], v14 offset:30720
    v_mfma_f32_16x16x32_bf16 v[120:123], v[20:23], v[136:139], v[120:123]
    ds_read_b64_tr_b16 v[44:45], v15 offset:28672
    ds_read_b64_tr_b16 v[46:47], v15 offset:30720
    v_mfma_f32_16x16x32_bf16 v[108:111], v[24:27], v[132:135], v[108:111]
    buffer_load_dwordx4 v[88:91], v98, s[16:19], s10 offen offset:0 sc1
    v_mfma_f32_16x16x32_bf16 v[124:127], v[24:27], v[136:139], v[124:127]
    v_mfma_f32_16x16x32_bf16 v[112:115], v[28:31], v[132:135], v[112:115]
    buffer_load_dwordx4 v[92:95], v97, s[16:19], s10 offen offset:0 sc1
    v_mfma_f32_16x16x32_bf16 v[128:131], v[28:31], v[136:139], v[128:131]
    s_waitcnt vmcnt(10) lgkmcnt(0)
    v_mfma_f32_16x16x32_bf16 v[100:103], v[32:35], v[48:51], v[100:103]
    ds_read_b64_tr_b16 v[16:17], v4 offset:16384
    ds_read_b64_tr_b16 v[18:19], v4 offset:18432
    v_mfma_f32_16x16x32_bf16 v[116:119], v[32:35], v[52:55], v[116:119]
    ds_read_b64_tr_b16 v[20:21], v5 offset:16384
    ds_read_b64_tr_b16 v[22:23], v5 offset:18432
    v_mfma_f32_16x16x32_bf16 v[104:107], v[36:39], v[48:51], v[104:107]
    ds_read_b64_tr_b16 v[24:25], v6 offset:16384
    ds_read_b64_tr_b16 v[26:27], v6 offset:18432
    v_mfma_f32_16x16x32_bf16 v[120:123], v[36:39], v[52:55], v[120:123]
    ds_read_b64_tr_b16 v[28:29], v7 offset:16384
    ds_read_b64_tr_b16 v[30:31], v7 offset:18432
    v_mfma_f32_16x16x32_bf16 v[108:111], v[40:43], v[48:51], v[108:111]
    buffer_load_dwordx4 v[132:135], v98, s[16:19], s10 offen offset:1024 sc1
    v_mfma_f32_16x16x32_bf16 v[124:127], v[40:43], v[52:55], v[124:127]
    v_mfma_f32_16x16x32_bf16 v[112:115], v[44:47], v[48:51], v[112:115]
    buffer_load_dwordx4 v[136:139], v97, s[16:19], s10 offen offset:1024 sc1
    v_mfma_f32_16x16x32_bf16 v[128:131], v[44:47], v[52:55], v[128:131]
    s_waitcnt vmcnt(10) lgkmcnt(0)
    v_mfma_f32_16x16x32_bf16 v[100:103], v[16:19], v[56:59], v[100:103]
    ds_read_b64_tr_b16 v[32:33], v4 offset:20480
    ds_read_b64_tr_b16 v[34:35], v4 offset:22528
    v_mfma_f32_16x16x32_bf16 v[116:119], v[16:19], v[60:63], v[116:119]
    ds_read_b64_tr_b16 v[36:37], v5 offset:20480
    ds_read_b64_tr_b16 v[38:39], v5 offset:22528
    v_mfma_f32_16x16x32_bf16 v[104:107], v[20:23], v[56:59], v[104:107]
    ds_read_b64_tr_b16 v[40:41], v6 offset:20480
    ds_read_b64_tr_b16 v[42:43], v6 offset:22528
    v_mfma_f32_16x16x32_bf16 v[120:123], v[20:23], v[60:63], v[120:123]
    ds_read_b64_tr_b16 v[44:45], v7 offset:20480
    ds_read_b64_tr_b16 v[46:47], v7 offset:22528
    v_mfma_f32_16x16x32_bf16 v[108:111], v[24:27], v[56:59], v[108:111]
    buffer_load_dwordx4 v[48:51], v98, s[16:19], s11 offen offset:0 sc1
    v_mfma_f32_16x16x32_bf16 v[124:127], v[24:27], v[60:63], v[124:127]
    v_mfma_f32_16x16x32_bf16 v[112:115], v[28:31], v[56:59], v[112:115]
    buffer_load_dwordx4 v[52:55], v97, s[16:19], s11 offen offset:0 sc1
    v_mfma_f32_16x16x32_bf16 v[128:131], v[28:31], v[60:63], v[128:131]
    s_waitcnt vmcnt(10) lgkmcnt(0)
    v_mfma_f32_16x16x32_bf16 v[100:103], v[32:35], v[64:67], v[100:103]
    ds_read_b64_tr_b16 v[16:17], v4 offset:24576
    ds_read_b64_tr_b16 v[18:19], v4 offset:26624
    v_mfma_f32_16x16x32_bf16 v[116:119], v[32:35], v[68:71], v[116:119]
    ds_read_b64_tr_b16 v[20:21], v5 offset:24576
    ds_read_b64_tr_b16 v[22:23], v5 offset:26624
    v_mfma_f32_16x16x32_bf16 v[104:107], v[36:39], v[64:67], v[104:107]
    ds_read_b64_tr_b16 v[24:25], v6 offset:24576
    ds_read_b64_tr_b16 v[26:27], v6 offset:26624
    v_mfma_f32_16x16x32_bf16 v[120:123], v[36:39], v[68:71], v[120:123]
    ds_read_b64_tr_b16 v[28:29], v7 offset:24576
    ds_read_b64_tr_b16 v[30:31], v7 offset:26624
    v_mfma_f32_16x16x32_bf16 v[108:111], v[40:43], v[64:67], v[108:111]
    buffer_load_dwordx4 v[56:59], v98, s[16:19], s11 offen offset:1024 sc1
    v_mfma_f32_16x16x32_bf16 v[124:127], v[40:43], v[68:71], v[124:127]
    v_mfma_f32_16x16x32_bf16 v[112:115], v[44:47], v[64:67], v[112:115]
    buffer_load_dwordx4 v[60:63], v97, s[16:19], s11 offen offset:1024 sc1
    v_mfma_f32_16x16x32_bf16 v[128:131], v[44:47], v[68:71], v[128:131]
    s_waitcnt vmcnt(10) lgkmcnt(0)
    v_mfma_f32_16x16x32_bf16 v[100:103], v[16:19], v[72:75], v[100:103]
    ds_read_b64_tr_b16 v[32:33], v4 offset:28672
    ds_read_b64_tr_b16 v[34:35], v4 offset:30720
    v_mfma_f32_16x16x32_bf16 v[116:119], v[16:19], v[76:79], v[116:119]
    ds_read_b64_tr_b16 v[36:37], v5 offset:28672
    ds_read_b64_tr_b16 v[38:39], v5 offset:30720
    v_mfma_f32_16x16x32_bf16 v[104:107], v[20:23], v[72:75], v[104:107]
    ds_read_b64_tr_b16 v[40:41], v6 offset:28672
    ds_read_b64_tr_b16 v[42:43], v6 offset:30720
    v_mfma_f32_16x16x32_bf16 v[120:123], v[20:23], v[76:79], v[120:123]
    ds_read_b64_tr_b16 v[44:45], v7 offset:28672
    ds_read_b64_tr_b16 v[46:47], v7 offset:30720
    v_mfma_f32_16x16x32_bf16 v[108:111], v[24:27], v[72:75], v[108:111]
    buffer_load_dwordx4 v[64:67], v98, s[16:19], s30 offen offset:0 sc1
    v_mfma_f32_16x16x32_bf16 v[124:127], v[24:27], v[76:79], v[124:127]
    v_mfma_f32_16x16x32_bf16 v[112:115], v[28:31], v[72:75], v[112:115]
    buffer_load_dwordx4 v[68:71], v97, s[16:19], s30 offen offset:0 sc1
    v_mfma_f32_16x16x32_bf16 v[128:131], v[28:31], v[76:79], v[128:131]
    s_waitcnt vmcnt(10) lgkmcnt(0)
    v_mfma_f32_16x16x32_bf16 v[100:103], v[32:35], v[80:83], v[100:103]
    ds_read_b64_tr_b16 v[16:17], v12 offset:16384
    ds_read_b64_tr_b16 v[18:19], v12 offset:18432
    v_mfma_f32_16x16x32_bf16 v[116:119], v[32:35], v[84:87], v[116:119]
    ds_read_b64_tr_b16 v[20:21], v13 offset:16384
    ds_read_b64_tr_b16 v[22:23], v13 offset:18432
    v_mfma_f32_16x16x32_bf16 v[104:107], v[36:39], v[80:83], v[104:107]
    ds_read_b64_tr_b16 v[24:25], v14 offset:16384
    ds_read_b64_tr_b16 v[26:27], v14 offset:18432
    v_mfma_f32_16x16x32_bf16 v[120:123], v[36:39], v[84:87], v[120:123]
    ds_read_b64_tr_b16 v[28:29], v15 offset:16384
    ds_read_b64_tr_b16 v[30:31], v15 offset:18432
    v_mfma_f32_16x16x32_bf16 v[108:111], v[40:43], v[80:83], v[108:111]
    buffer_load_dwordx4 v[72:75], v98, s[16:19], s30 offen offset:1024 sc1
    v_mfma_f32_16x16x32_bf16 v[124:127], v[40:43], v[84:87], v[124:127]
    v_mfma_f32_16x16x32_bf16 v[112:115], v[44:47], v[80:83], v[112:115]
    buffer_load_dwordx4 v[76:79], v97, s[16:19], s30 offen offset:1024 sc1
    v_mfma_f32_16x16x32_bf16 v[128:131], v[44:47], v[84:87], v[128:131]
    s_waitcnt vmcnt(10) lgkmcnt(0)
    v_mfma_f32_16x16x32_bf16 v[100:103], v[16:19], v[88:91], v[100:103]
    ds_read_b64_tr_b16 v[32:33], v12 offset:20480
    ds_read_b64_tr_b16 v[34:35], v12 offset:22528
    v_mfma_f32_16x16x32_bf16 v[116:119], v[16:19], v[92:95], v[116:119]
    ds_read_b64_tr_b16 v[36:37], v13 offset:20480
    ds_read_b64_tr_b16 v[38:39], v13 offset:22528
    v_mfma_f32_16x16x32_bf16 v[104:107], v[20:23], v[88:91], v[104:107]
    ds_read_b64_tr_b16 v[40:41], v14 offset:20480
    ds_read_b64_tr_b16 v[42:43], v14 offset:22528
    v_mfma_f32_16x16x32_bf16 v[120:123], v[20:23], v[92:95], v[120:123]
    ds_read_b64_tr_b16 v[44:45], v15 offset:20480
    ds_read_b64_tr_b16 v[46:47], v15 offset:22528
    v_mfma_f32_16x16x32_bf16 v[108:111], v[24:27], v[88:91], v[108:111]
    buffer_load_dwordx4 v[80:83], v98, s[16:19], s31 offen offset:0 sc1
    v_mfma_f32_16x16x32_bf16 v[124:127], v[24:27], v[92:95], v[124:127]
    v_mfma_f32_16x16x32_bf16 v[112:115], v[28:31], v[88:91], v[112:115]
    buffer_load_dwordx4 v[84:87], v97, s[16:19], s31 offen offset:0 sc1
    v_mfma_f32_16x16x32_bf16 v[128:131], v[28:31], v[92:95], v[128:131]
    s_waitcnt vmcnt(10) lgkmcnt(0)
    v_mfma_f32_16x16x32_bf16 v[100:103], v[32:35], v[132:135], v[100:103]
    ds_read_b64_tr_b16 v[16:17], v8 offset:24576
    ds_read_b64_tr_b16 v[18:19], v8 offset:26624
    v_mfma_f32_16x16x32_bf16 v[116:119], v[32:35], v[136:139], v[116:119]
    ds_read_b64_tr_b16 v[20:21], v9 offset:24576
    ds_read_b64_tr_b16 v[22:23], v9 offset:26624
    v_mfma_f32_16x16x32_bf16 v[104:107], v[36:39], v[132:135], v[104:107]
    ds_read_b64_tr_b16 v[24:25], v10 offset:24576
    ds_read_b64_tr_b16 v[26:27], v10 offset:26624
    v_mfma_f32_16x16x32_bf16 v[120:123], v[36:39], v[136:139], v[120:123]
    ds_read_b64_tr_b16 v[28:29], v11 offset:24576
    ds_read_b64_tr_b16 v[30:31], v11 offset:26624
    v_mfma_f32_16x16x32_bf16 v[108:111], v[40:43], v[132:135], v[108:111]
    buffer_load_dwordx4 v[88:91], v98, s[16:19], s31 offen offset:1024 sc1
    v_mfma_f32_16x16x32_bf16 v[124:127], v[40:43], v[136:139], v[124:127]
    v_mfma_f32_16x16x32_bf16 v[112:115], v[44:47], v[132:135], v[112:115]
    buffer_load_dwordx4 v[92:95], v97, s[16:19], s31 offen offset:1024 sc1
    v_mfma_f32_16x16x32_bf16 v[128:131], v[44:47], v[136:139], v[128:131]
    s_waitcnt vmcnt(10) lgkmcnt(0)
    v_mfma_f32_16x16x32_bf16 v[100:103], v[16:19], v[48:51], v[100:103]
    ds_read_b64_tr_b16 v[32:33], v8 offset:28672
    ds_read_b64_tr_b16 v[34:35], v8 offset:30720
    v_mfma_f32_16x16x32_bf16 v[116:119], v[16:19], v[52:55], v[116:119]
    ds_read_b64_tr_b16 v[36:37], v9 offset:28672
    ds_read_b64_tr_b16 v[38:39], v9 offset:30720
    v_mfma_f32_16x16x32_bf16 v[104:107], v[20:23], v[48:51], v[104:107]
    ds_read_b64_tr_b16 v[40:41], v10 offset:28672
    ds_read_b64_tr_b16 v[42:43], v10 offset:30720
    v_mfma_f32_16x16x32_bf16 v[120:123], v[20:23], v[52:55], v[120:123]
    ds_read_b64_tr_b16 v[44:45], v11 offset:28672
    ds_read_b64_tr_b16 v[46:47], v11 offset:30720
    v_mfma_f32_16x16x32_bf16 v[108:111], v[24:27], v[48:51], v[108:111]
    buffer_load_dwordx4 v[132:135], v98, s[16:19], s32 offen offset:0 sc1
    v_mfma_f32_16x16x32_bf16 v[124:127], v[24:27], v[52:55], v[124:127]
    v_mfma_f32_16x16x32_bf16 v[112:115], v[28:31], v[48:51], v[112:115]
    buffer_load_dwordx4 v[136:139], v97, s[16:19], s32 offen offset:0 sc1
    v_mfma_f32_16x16x32_bf16 v[128:131], v[28:31], v[52:55], v[128:131]
    s_waitcnt vmcnt(10) lgkmcnt(0)
    v_mfma_f32_16x16x32_bf16 v[100:103], v[32:35], v[56:59], v[100:103]
    ds_read_b64_tr_b16 v[16:17], v4 offset:49152
    ds_read_b64_tr_b16 v[18:19], v4 offset:51200
    v_mfma_f32_16x16x32_bf16 v[116:119], v[32:35], v[60:63], v[116:119]
    ds_read_b64_tr_b16 v[20:21], v5 offset:49152
    ds_read_b64_tr_b16 v[22:23], v5 offset:51200
    v_mfma_f32_16x16x32_bf16 v[104:107], v[36:39], v[56:59], v[104:107]
    ds_read_b64_tr_b16 v[24:25], v6 offset:49152
    ds_read_b64_tr_b16 v[26:27], v6 offset:51200
    v_mfma_f32_16x16x32_bf16 v[120:123], v[36:39], v[60:63], v[120:123]
    ds_read_b64_tr_b16 v[28:29], v7 offset:49152
    ds_read_b64_tr_b16 v[30:31], v7 offset:51200
    v_mfma_f32_16x16x32_bf16 v[108:111], v[40:43], v[56:59], v[108:111]
    buffer_load_dwordx4 v[48:51], v98, s[16:19], s32 offen offset:1024 sc1
    v_mfma_f32_16x16x32_bf16 v[124:127], v[40:43], v[60:63], v[124:127]
    v_mfma_f32_16x16x32_bf16 v[112:115], v[44:47], v[56:59], v[112:115]
    buffer_load_dwordx4 v[52:55], v97, s[16:19], s32 offen offset:1024 sc1
    v_mfma_f32_16x16x32_bf16 v[128:131], v[44:47], v[60:63], v[128:131]
    s_waitcnt vmcnt(10) lgkmcnt(0)
    v_mfma_f32_16x16x32_bf16 v[100:103], v[16:19], v[64:67], v[100:103]
    ds_read_b64_tr_b16 v[32:33], v4 offset:53248
    ds_read_b64_tr_b16 v[34:35], v4 offset:55296
    v_mfma_f32_16x16x32_bf16 v[116:119], v[16:19], v[68:71], v[116:119]
    ds_read_b64_tr_b16 v[36:37], v5 offset:53248
    ds_read_b64_tr_b16 v[38:39], v5 offset:55296
    v_mfma_f32_16x16x32_bf16 v[104:107], v[20:23], v[64:67], v[104:107]
    ds_read_b64_tr_b16 v[40:41], v6 offset:53248
    ds_read_b64_tr_b16 v[42:43], v6 offset:55296
    v_mfma_f32_16x16x32_bf16 v[120:123], v[20:23], v[68:71], v[120:123]
    ds_read_b64_tr_b16 v[44:45], v7 offset:53248
    ds_read_b64_tr_b16 v[46:47], v7 offset:55296
    v_mfma_f32_16x16x32_bf16 v[108:111], v[24:27], v[64:67], v[108:111]
    s_branch IW_s7
IW_w7:
    s_branch IW_r7
IW_s7:
    buffer_load_dwordx4 v[56:59], v98, s[16:19], s33 offen offset:0 sc1
    v_mfma_f32_16x16x32_bf16 v[124:127], v[24:27], v[68:71], v[124:127]
    v_mfma_f32_16x16x32_bf16 v[112:115], v[28:31], v[64:67], v[112:115]
    buffer_load_dwordx4 v[60:63], v97, s[16:19], s33 offen offset:0 sc1
    v_mfma_f32_16x16x32_bf16 v[128:131], v[28:31], v[68:71], v[128:131]
    s_waitcnt vmcnt(10) lgkmcnt(0)
    v_mfma_f32_16x16x32_bf16 v[100:103], v[32:35], v[72:75], v[100:103]
    ds_read_b64_tr_b16 v[16:17], v8 offset:0
    ds_read_b64_tr_b16 v[18:19], v8 offset:2048
    v_mfma_f32_16x16x32_bf16 v[116:119], v[32:35], v[76:79], v[116:119]
    ds_read_b64_tr_b16 v[20:21], v9 offset:0
    ds_read_b64_tr_b16 v[22:23], v9 offset:2048
    v_mfma_f32_16x16x32_bf16 v[104:107], v[36:39], v[72:75], v[104:107]
    ds_read_b64_tr_b16 v[24:25], v10 offset:0
    ds_read_b64_tr_b16 v[26:27], v10 offset:2048
    v_mfma_f32_16x16x32_bf16 v[120:123], v[36:39], v[76:79], v[120:123]
    ds_read_b64_tr_b16 v[28:29], v11 offset:0
    ds_read_b64_tr_b16 v[30:31], v11 offset:2048
    v_mfma_f32_16x16x32_bf16 v[108:111], v[40:43], v[72:75], v[108:111]
    buffer_load_dwordx4 v[64:67], v98, s[16:19], s33 offen offset:1024 sc1
    v_mfma_f32_16x16x32_bf16 v[124:127], v[40:43], v[76:79], v[124:127]
    v_mfma_f32_16x16x32_bf16 v[112:115], v[44:47], v[72:75], v[112:115]
    buffer_load_dwordx4 v[68:71], v97, s[16:19], s33 offen offset:1024 sc1
    v_mfma_f32_16x16x32_bf16 v[128:131], v[44:47], v[76:79], v[128:131]
    s_waitcnt vmcnt(10) lgkmcnt(0)
    v_mfma_f32_16x16x32_bf16 v[100:103], v[16:19], v[80:83], v[100:103]
    ds_read_b64_tr_b16 v[32:33], v8 offset:4096
    ds_read_b64_tr_b16 v[34:35], v8 offset:6144
    v_mfma_f32_16x16x32_bf16 v[116:119], v[16:19], v[84:87], v[116:119]
    ds_read_b64_tr_b16 v[36:37], v9 offset:4096
    ds_read_b64_tr_b16 v[38:39], v9 offset:6144
    v_mfma_f32_16x16x32_bf16 v[104:107], v[20:23], v[80:83], v[104:107]
    ds_read_b64_tr_b16 v[40:41], v10 offset:4096
    ds_read_b64_tr_b16 v[42:43], v10 offset:6144
    v_mfma_f32_16x16x32_bf16 v[120:123], v[20:23], v[84:87], v[120:123]
    ds_read_b64_tr_b16 v[44:45], v11 offset:4096
    ds_read_b64_tr_b16 v[46:47], v11 offset:6144
    v_mfma_f32_16x16x32_bf16 v[108:111], v[24:27], v[80:83], v[108:111]
    buffer_load_dwordx4 v[72:75], v98, s[16:19], s34 offen offset:0 sc1
    v_mfma_f32_16x16x32_bf16 v[124:127], v[24:27], v[84:87], v[124:127]
    v_mfma_f32_16x16x32_bf16 v[112:115], v[28:31], v[80:83], v[112:115]
    buffer_load_dwordx4 v[76:79], v97, s[16:19], s34 offen offset:0 sc1
    v_mfma_f32_16x16x32_bf16 v[128:131], v[28:31], v[84:87], v[128:131]
    s_waitcnt vmcnt(10) lgkmcnt(0)
    v_mfma_f32_16x16x32_bf16 v[100:103], v[32:35], v[88:91], v[100:103]
    ds_read_b64_tr_b16 v[16:17], v8 offset:16384
    ds_read_b64_tr_b16 v[18:19], v8 offset:18432
    v_mfma_f32_16x16x32_bf16 v[116:119], v[32:35], v[92:95], v[116:119]
    ds_read_b64_tr_b16 v[20:21], v9 offset:16384
    ds_read_b64_tr_b16 v[22:23], v9 offset:18432
    v_mfma_f32_16x16x32_bf16 v[104:107], v[36:39], v[88:91], v[104:107]
    ds_read_b64_tr_b16 v[24:25], v10 offset:16384
    ds_read_b64_tr_b16 v[26:27], v10 offset:18432
    v_mfma_f32_16x16x32_bf16 v[120:123], v[36:39], v[92:95], v[120:123]
    ds_read_b64_tr_b16 v[28:29], v11 offset:16384
    ds_read_b64_tr_b16 v[30:31], v11 offset:18432
    v_mfma_f32_16x16x32_bf16 v[108:111], v[40:43], v[88:91], v[108:111]
    buffer_load_dwordx4 v[80:83], v98, s[16:19], s34 offen offset:1024 sc1
    v_mfma_f32_16x16x32_bf16 v[124:127], v[40:43], v[92:95], v[124:127]
    v_mfma_f32_16x16x32_bf16 v[112:115], v[44:47], v[88:91], v[112:115]
    buffer_load_dwordx4 v[84:87], v97, s[16:19], s34 offen offset:1024 sc1
    v_mfma_f32_16x16x32_bf16 v[128:131], v[44:47], v[92:95], v[128:131]
    s_waitcnt vmcnt(10) lgkmcnt(0)
    v_mfma_f32_16x16x32_bf16 v[100:103], v[16:19], v[132:135], v[100:103]
    ds_read_b64_tr_b16 v[32:33], v8 offset:20480
    ds_read_b64_tr_b16 v[34:35], v8 offset:22528
    v_mfma_f32_16x16x32_bf16 v[116:119], v[16:19], v[136:139], v[116:119]
    ds_read_b64_tr_b16 v[36:37], v9 offset:20480
    ds_read_b64_tr_b16 v[38:39], v9 offset:22528
    v_mfma_f32_16x16x32_bf16 v[104:107], v[20:23], v[132:135], v[104:107]
    ds_read_b64_tr_b16 v[40:41], v10 offset:20480
    ds_read_b64_tr_b16 v[42:43], v10 offset:22528
    v_mfma_f32_16x16x32_bf16 v[120:123], v[20:23], v[136:139], v[120:123]
    ds_read_b64_tr_b16 v[44:45], v11 offset:20480
    ds_read_b64_tr_b16 v[46:47], v11 offset:22528
    v_mfma_f32_16x16x32_bf16 v[108:111], v[24:27], v[132:135], v[108:111]
    buffer_load_dwordx4 v[88:91], v98, s[16:19], s35 offen offset:0 sc1
    v_mfma_f32_16x16x32_bf16 v[124:127], v[24:27], v[136:139], v[124:127]
    v_mfma_f32_16x16x32_bf16 v[112:115], v[28:31], v[132:135], v[112:115]
    buffer_load_dwordx4 v[92:95], v97, s[16:19], s35 offen offset:0 sc1
    v_mfma_f32_16x16x32_bf16 v[128:131], v[28:31], v[136:139], v[128:131]
    s_waitcnt vmcnt(10) lgkmcnt(0)
    v_mfma_f32_16x16x32_bf16 v[100:103], v[32:35], v[48:51], v[100:103]
    ds_read_b64_tr_b16 v[16:17], v8 offset:40960
    ds_read_b64_tr_b16 v[18:19], v8 offset:43008
    v_mfma_f32_16x16x32_bf16 v[116:119], v[32:35], v[52:55], v[116:119]
    ds_read_b64_tr_b16 v[20:21], v9 offset:40960
    ds_read_b64_tr_b16 v[22:23], v9 offset:43008
    v_mfma_f32_16x16x32_bf16 v[104:107], v[36:39], v[48:51], v[104:107]
    ds_read_b64_tr_b16 v[24:25], v10 offset:40960
    ds_read_b64_tr_b16 v[26:27], v10 offset:43008
    v_mfma_f32_16x16x32_bf16 v[120:123], v[36:39], v[52:55], v[120:123]
    ds_read_b64_tr_b16 v[28:29], v11 offset:40960
    ds_read_b64_tr_b16 v[30:31], v11 offset:43008
    v_mfma_f32_16x16x32_bf16 v[108:111], v[40:43], v[48:51], v[108:111]
    buffer_load_dwordx4 v[132:135], v98, s[16:19], s35 offen offset:1024 sc1
    v_mfma_f32_16x16x32_bf16 v[124:127], v[40:43], v[52:55], v[124:127]
    v_mfma_f32_16x16x32_bf16 v[112:115], v[44:47], v[48:51], v[112:115]
    buffer_load_dwordx4 v[136:139], v97, s[16:19], s35 offen offset:1024 sc1
    v_mfma_f32_16x16x32_bf16 v[128:131], v[44:47], v[52:55], v[128:131]
    s_waitcnt vmcnt(10) lgkmcnt(0)
    v_mfma_f32_16x16x32_bf16 v[100:103], v[16:19], v[56:59], v[100:103]
    ds_read_b64_tr_b16 v[32:33], v8 offset:45056
    ds_read_b64_tr_b16 v[34:35], v8 offset:47104
    v_mfma_f32_16x16x32_bf16 v[116:119], v[16:19], v[60:63], v[116:119]
    ds_read_b64_tr_b16 v[36:37], v9 offset:45056
    ds_read_b64_tr_b16 v[38:39], v9 offset:47104
    v_mfma_f32_16x16x32_bf16 v[104:107], v[20:23], v[56:59], v[104:107]
    ds_read_b64_tr_b16 v[40:41], v10 offset:45056
    ds_read_b64_tr_b16 v[42:43], v10 offset:47104
    v_mfma_f32_16x16x32_bf16 v[120:123], v[20:23], v[60:63], v[120:123]
    ds_read_b64_tr_b16 v[44:45], v11 offset:45056
    ds_read_b64_tr_b16 v[46:47], v11 offset:47104
    v_mfma_f32_16x16x32_bf16 v[108:111], v[24:27], v[56:59], v[108:111]
    buffer_load_dwordx4 v[48:51], v98, s[16:19], s36 offen offset:0 sc1
    v_mfma_f32_16x16x32_bf16 v[124:127], v[24:27], v[60:63], v[124:127]
    v_mfma_f32_16x16x32_bf16 v[112:115], v[28:31], v[56:59], v[112:115]
    buffer_load_dwordx4 v[52:55], v97, s[16:19], s36 offen offset:0 sc1
    v_mfma_f32_16x16x32_bf16 v[128:131], v[28:31], v[60:63], v[128:131]
    s_waitcnt vmcnt(10) lgkmcnt(0)
    v_mfma_f32_16x16x32_bf16 v[100:103], v[32:35], v[64:67], v[100:103]
    ds_read_b64_tr_b16 v[16:17], v8 offset:32768
    ds_read_b64_tr_b16 v[18:19], v8 offset:34816
    v_mfma_f32_16x16x32_bf16 v[116:119], v[32:35], v[68:71], v[116:119]
    ds_read_b64_tr_b16 v[20:21], v9 offset:32768
    ds_read_b64_tr_b16 v[22:23], v9 offset:34816
    v_mfma_f32_16x16x32_bf16 v[104:107], v[36:39], v[64:67], v[104:107]
    ds_read_b64_tr_b16 v[24:25], v10 offset:32768
    ds_read_b64_tr_b16 v[26:27], v10 offset:34816
    v_mfma_f32_16x16x32_bf16 v[120:123], v[36:39], v[68:71], v[120:123]
    ds_read_b64_tr_b16 v[28:29], v11 offset:32768
    ds_read_b64_tr_b16 v[30:31], v11 offset:34816
    v_mfma_f32_16x16x32_bf16 v[108:111], v[40:43], v[64:67], v[108:111]
    buffer_load_dwordx4 v[56:59], v98, s[16:19], s36 offen offset:1024 sc1
    v_mfma_f32_16x16x32_bf16 v[124:127], v[40:43], v[68:71], v[124:127]
    v_mfma_f32_16x16x32_bf16 v[112:115], v[44:47], v[64:67], v[112:115]
    buffer_load_dwordx4 v[60:63], v97, s[16:19], s36 offen offset:1024 sc1
    v_mfma_f32_16x16x32_bf16 v[128:131], v[44:47], v[68:71], v[128:131]
    s_waitcnt vmcnt(10) lgkmcnt(0)
    v_mfma_f32_16x16x32_bf16 v[100:103], v[16:19], v[72:75], v[100:103]
    ds_read_b64_tr_b16 v[32:33], v8 offset:36864
    ds_read_b64_tr_b16 v[34:35], v8 offset:38912
    v_mfma_f32_16x16x32_bf16 v[116:119], v[16:19], v[76:79], v[116:119]
    ds_read_b64_tr_b16 v[36:37], v9 offset:36864
    ds_read_b64_tr_b16 v[38:39], v9 offset:38912
    v_mfma_f32_16x16x32_bf16 v[104:107], v[20:23], v[72:75], v[104:107]
    ds_read_b64_tr_b16 v[40:41], v10 offset:36864
    ds_read_b64_tr_b16 v[42:43], v10 offset:38912
    v_mfma_f32_16x16x32_bf16 v[120:123], v[20:23], v[76:79], v[120:123]
    ds_read_b64_tr_b16 v[44:45], v11 offset:36864
    ds_read_b64_tr_b16 v[46:47], v11 offset:38912
    v_mfma_f32_16x16x32_bf16 v[108:111], v[24:27], v[72:75], v[108:111]
    buffer_load_dwordx4 v[64:67], v98, s[16:19], s37 offen offset:0 sc1
    v_mfma_f32_16x16x32_bf16 v[124:127], v[24:27], v[76:79], v[124:127]
    v_mfma_f32_16x16x32_bf16 v[112:115], v[28:31], v[72:75], v[112:115]
    buffer_load_dwordx4 v[68:71], v97, s[16:19], s37 offen offset:0 sc1
    v_mfma_f32_16x16x32_bf16 v[128:131], v[28:31], v[76:79], v[128:131]
    s_waitcnt vmcnt(10) lgkmcnt(0)
    v_mfma_f32_16x16x32_bf16 v[100:103], v[32:35], v[80:83], v[100:103]
    ds_read_b64_tr_b16 v[16:17], v12 offset:0
    ds_read_b64_tr_b16 v[18:19], v12 offset:2048
    v_mfma_f32_16x16x32_bf16 v[116:119], v[32:35], v[84:87], v[116:119]
    ds_read_b64_tr_b16 v[20:21], v13 offset:0
    ds_read_b64_tr_b16 v[22:23], v13 offset:2048
    v_mfma_f32_16x16x32_bf16 v[104:107], v[36:39], v[80:83], v[104:107]
    ds_read_b64_tr_b16 v[24:25], v14 offset:0
    ds_read_b64_tr_b16 v[26:27], v14 offset:2048
    v_mfma_f32_16x16x32_bf16 v[120:123], v[36:39], v[84:87], v[120:123]
    ds_read_b64_tr_b16 v[28:29], v15 offset:0
    ds_read_b64_tr_b16 v[30:31], v15 offset:2048
    v_mfma_f32_16x16x32_bf16 v[108:111], v[40:43], v[80:83], v[108:111]
    buffer_load_dwordx4 v[72:75], v98, s[16:19], s37 offen offset:1024 sc1
    v_mfma_f32_16x16x32_bf16 v[124:127], v[40:43], v[84:87], v[124:127]
    v_mfma_f32_16x16x32_bf16 v[112:115], v[44:47], v[80:83], v[112:115]
    buffer_load_dwordx4 v[76:79], v97, s[16:19], s37 offen offset:1024 sc1
    v_mfma_f32_16x16x32_bf16 v[128:131], v[44:47], v[84:87], v[128:131]
    s_waitcnt vmcnt(10) lgkmcnt(0)
    v_mfma_f32_16x16x32_bf16 v[100:103], v[16:19], v[88:91], v[100:103]
    ds_read_b64_tr_b16 v[32:33], v12 offset:4096
    ds_read_b64_tr_b16 v[34:35], v12 offset:6144
    v_mfma_f32_16x16x32_bf16 v[116:119], v[16:19], v[92:95], v[116:119]
    ds_read_b64_tr_b16 v[36:37], v13 offset:4096
    ds_read_b64_tr_b16 v[38:39], v13 offset:6144
    v_mfma_f32_16x16x32_bf16 v[104:107], v[20:23], v[88:91], v[104:107]
    ds_read_b64_tr_b16 v[40:41], v14 offset:4096
    ds_read_b64_tr_b16 v[42:43], v14 offset:6144
    v_mfma_f32_16x16x32_bf16 v[120:123], v[20:23], v[92:95], v[120:123]
    ds_read_b64_tr_b16 v[44:45], v15 offset:4096
    ds_read_b64_tr_b16 v[46:47], v15 offset:6144
    v_mfma_f32_16x16x32_bf16 v[108:111], v[24:27], v[88:91], v[108:111]
    v_mfma_f32_16x16x32_bf16 v[124:127], v[24:27], v[92:95], v[124:127]
    v_mfma_f32_16x16x32_bf16 v[112:115], v[28:31], v[88:91], v[112:115]
    v_mfma_f32_16x16x32_bf16 v[128:131], v[28:31], v[92:95], v[128:131]
    s_waitcnt vmcnt(8) lgkmcnt(0)
    v_mfma_f32_16x16x32_bf16 v[100:103], v[32:35], v[132:135], v[100:103]
    ds_read_b64_tr_b16 v[16:17], v8 offset:49152
    ds_read_b64_tr_b16 v[18:19], v8 offset:51200
    v_mfma_f32_16x16x32_bf16 v[116:119], v[32:35], v[136:139], v[116:119]
    ds_read_b64_tr_b16 v[20:21], v9 offset:49152
    ds_read_b64_tr_b16 v[22:23], v9 offset:51200
    v_mfma_f32_16x16x32_bf16 v[104:107], v[36:39], v[132:135], v[104:107]
    ds_read_b64_tr_b16 v[24:25], v10 offset:49152
    ds_read_b64_tr_b16 v[26:27], v10 offset:51200
    v_mfma_f32_16x16x32_bf16 v[120:123], v[36:39], v[136:139], v[120:123]
    ds_read_b64_tr_b16 v[28:29], v11 offset:49152
    ds_read_b64_tr_b16 v[30:31], v11 offset:51200
    v_mfma_f32_16x16x32_bf16 v[108:111], v[40:43], v[132:135], v[108:111]
    v_mfma_f32_16x16x32_bf16 v[124:127], v[40:43], v[136:139], v[124:127]
    v_mfma_f32_16x16x32_bf16 v[112:115], v[44:47], v[132:135], v[112:115]
    v_mfma_f32_16x16x32_bf16 v[128:131], v[44:47], v[136:139], v[128:131]
    s_waitcnt vmcnt(6) lgkmcnt(0)
    v_mfma_f32_16x16x32_bf16 v[100:103], v[16:19], v[48:51], v[100:103]
    ds_read_b64_tr_b16 v[32:33], v8 offset:53248
    ds_read_b64_tr_b16 v[34:35], v8 offset:55296
    v_mfma_f32_16x16x32_bf16 v[116:119], v[16:19], v[52:55], v[116:119]
    ds_read_b64_tr_b16 v[36:37], v9 offset:53248
    ds_read_b64_tr_b16 v[38:39], v9 offset:55296
    v_mfma_f32_16x16x32_bf16 v[104:107], v[20:23], v[48:51], v[104:107]
    ds_read_b64_tr_b16 v[40:41], v10 offset:53248
    ds_read_b64_tr_b16 v[42:43], v10 offset:55296
    v_mfma_f32_16x16x32_bf16 v[120:123], v[20:23], v[52:55], v[120:123]
    ds_read_b64_tr_b16 v[44:45], v11 offset:53248
    ds_read_b64_tr_b16 v[46:47], v11 offset:55296
    v_mfma_f32_16x16x32_bf16 v[108:111], v[24:27], v[48:51], v[108:111]
    v_mfma_f32_16x16x32_bf16 v[124:127], v[24:27], v[52:55], v[124:127]
    v_mfma_f32_16x16x32_bf16 v[112:115], v[28:31], v[48:51], v[112:115]
    v_mfma_f32_16x16x32_bf16 v[128:131], v[28:31], v[52:55], v[128:131]
    s_waitcnt vmcnt(4) lgkmcnt(0)
    v_mfma_f32_16x16x32_bf16 v[100:103], v[32:35], v[56:59], v[100:103]
    ds_read_b64_tr_b16 v[16:17], v12 offset:8192
    ds_read_b64_tr_b16 v[18:19], v12 offset:10240
    v_mfma_f32_16x16x32_bf16 v[116:119], v[32:35], v[60:63], v[116:119]
    ds_read_b64_tr_b16 v[20:21], v13 offset:8192
    ds_read_b64_tr_b16 v[22:23], v13 offset:10240
    v_mfma_f32_16x16x32_bf16 v[104:107], v[36:39], v[56:59], v[104:107]
    ds_read_b64_tr_b16 v[24:25], v14 offset:8192
    ds_read_b64_tr_b16 v[26:27], v14 offset:10240
    v_mfma_f32_16x16x32_bf16 v[120:123], v[36:39], v[60:63], v[120:123]
    ds_read_b64_tr_b16 v[28:29], v15 offset:8192
    ds_read_b64_tr_b16 v[30:31], v15 offset:10240
    v_mfma_f32_16x16x32_bf16 v[108:111], v[40:43], v[56:59], v[108:111]
    v_mfma_f32_16x16x32_bf16 v[124:127], v[40:43], v[60:63], v[124:127]
    v_mfma_f32_16x16x32_bf16 v[112:115], v[44:47], v[56:59], v[112:115]
    v_mfma_f32_16x16x32_bf16 v[128:131], v[44:47], v[60:63], v[128:131]
    s_waitcnt vmcnt(2) lgkmcnt(0)
    v_mfma_f32_16x16x32_bf16 v[100:103], v[16:19], v[64:67], v[100:103]
    ds_read_b64_tr_b16 v[32:33], v12 offset:12288
    ds_read_b64_tr_b16 v[34:35], v12 offset:14336
    v_mfma_f32_16x16x32_bf16 v[116:119], v[16:19], v[68:71], v[116:119]
    ds_read_b64_tr_b16 v[36:37], v13 offset:12288
    ds_read_b64_tr_b16 v[38:39], v13 offset:14336
    v_mfma_f32_16x16x32_bf16 v[104:107], v[20:23], v[64:67], v[104:107]
    ds_read_b64_tr_b16 v[40:41], v14 offset:12288
    ds_read_b64_tr_b16 v[42:43], v14 offset:14336
    v_mfma_f32_16x16x32_bf16 v[120:123], v[20:23], v[68:71], v[120:123]
    ds_read_b64_tr_b16 v[44:45], v15 offset:12288
    ds_read_b64_tr_b16 v[46:47], v15 offset:14336
    v_mfma_f32_16x16x32_bf16 v[108:111], v[24:27], v[64:67], v[108:111]
    v_mfma_f32_16x16x32_bf16 v[124:127], v[24:27], v[68:71], v[124:127]
    v_mfma_f32_16x16x32_bf16 v[112:115], v[28:31], v[64:67], v[112:115]
    v_mfma_f32_16x16x32_bf16 v[128:131], v[28:31], v[68:71], v[128:131]
    s_waitcnt vmcnt(0) lgkmcnt(0)
    s_cmp_eq_u64 s[60:61], 0
    s_cbranch_scc1 F_y0
    ds_read_b32 v160, v161
    ds_read_b128 v[48:51], v162 offset:0
    ds_read_b128 v[52:55], v162 offset:64
    ds_read_b128 v[56:59], v162 offset:128
    ds_read_b128 v[60:63], v162 offset:192
    ds_read_b128 v[64:67], v163 offset:0
    ds_read_b128 v[68:71], v163 offset:64
    ds_read_b128 v[80:83], v163 offset:128
    ds_read_b128 v[84:87], v163 offset:192
F_y0:
    v_mfma_f32_16x16x32_bf16 v[100:103], v[32:35], v[72:75], v[100:103]
    v_mfma_f32_16x16x32_bf16 v[104:107], v[36:39], v[72:75], v[104:107]
    v_mfma_f32_16x16x32_bf16 v[108:111], v[40:43], v[72:75], v[108:111]
    v_mfma_f32_16x16x32_bf16 v[112:115], v[44:47], v[72:75], v[112:115]
    v_mfma_f32_16x16x32_bf16 v[116:119], v[32:35], v[76:79], v[116:119]
    v_mfma_f32_16x16x32_bf16 v[120:123], v[36:39], v[76:79], v[120:123]
    v_mfma_f32_16x16x32_bf16 v[124:127], v[40:43], v[76:79], v[124:127]
    v_mfma_f32_16x16x32_bf16 v[128:131], v[44:47], v[76:79], v[128:131]
    s_cmp_eq_u64 s[60:61], 0
    s_cbranch_scc1 F_fin
F_y1:
    s_waitcnt lgkmcnt(0)
    v_cmp_eq_u32 vcc, 0, v160
    s_cbranch_vccz F_y2
    ds_read_b32 v160, v161
    ds_read_b128 v[48:51], v162 offset:0
    ds_read_b128 v[52:55], v162 offset:64
    ds_read_b128 v[56:59], v162 offset:128
    ds_read_b128 v[60:63], v162 offset:192
    ds_read_b128 v[64:67], v163 offset:0
    ds_read_b128 v[68:71], v163 offset:64
    ds_read_b128 v[80:83], v163 offset:128
    ds_read_b128 v[84:87], v163 offset:192
    s_branch F_y1
F_y2:
    s_nop 4
    s_mov_b64 exec, s[74:75]
    s_cbranch_execz F_rb_75
    v_fmac_f32 v100, v48, v164
    v_fmac_f32 v101, v49, v164
    v_fmac_f32 v102, v50, v164
    v_fmac_f32 v103, v51, v164
    v_fmac_f32 v104, v52, v164
    v_fmac_f32 v105, v53, v164
    v_fmac_f32 v106, v54, v164
    v_fmac_f32 v107, v55, v164
    v_fmac_f32 v108, v56, v164
    v_fmac_f32 v109, v57, v164
    v_fmac_f32 v110, v58, v164
    v_fmac_f32 v111, v59, v164
    v_fmac_f32 v112, v60, v164
    v_fmac_f32 v113, v61, v164
    v_fmac_f32 v114, v62, v164
    v_fmac_f32 v115, v63, v164
F_rb_75:
    s_mov_b64 exec, s[76:77]
    s_cbranch_execz F_rb_76
    v_fmac_f32 v116, v64, v165
    v_fmac_f32 v117, v65, v165
    v_fmac_f32 v118, v66, v165
    v_fmac_f32 v119, v67, v165
    v_fmac_f32 v120, v68, v165
    v_fmac_f32 v121, v69, v165
    v_fmac_f32 v122, v70, v165
    v_fmac_f32 v123, v71, v165
    v_fmac_f32 v124, v80, v165
    v_fmac_f32 v125, v81, v165
    v_fmac_f32 v126, v82, v165
    v_fmac_f32 v127, v83, v165
    v_fmac_f32 v128, v84, v165
    v_fmac_f32 v129, v85, v165
    v_fmac_f32 v130, v86, v165
    v_fmac_f32 v131, v87, v165
F_rb_76:
    s_mov_b64 exec, -1
F_fin:
    v_cvt_pk_bf16_f32 v16, v100, v101
    v_cvt_pk_bf16_f32 v17, v102, v103
    v_cvt_pk_bf16_f32 v18, v104, v105
    v_cvt_pk_bf16_f32 v19, v106, v107
    v_cvt_pk_bf16_f32 v20, v108, v109
    v_cvt_pk_bf16_f32 v21, v110, v111
    v_cvt_pk_bf16_f32 v22, v112, v113
    v_cvt_pk_bf16_f32 v23, v114, v115
    v_permlane16_swap_b32 v16, v18
    v_permlane16_swap_b32 v17, v19
    v_permlane16_swap_b32 v20, v22
    v_permlane16_swap_b32 v21, v23
    v_mov_b32 v4, v16
    v_mov_b32 v5, v17
    v_mov_b32 v6, v18
    v_mov_b32 v7, v19
    v_mov_b32_dpp v16, v20 row_ror:8 row_mask:0xf bank_mask:0xc
    v_mov_b32_dpp v17, v21 row_ror:8 row_mask:0xf bank_mask:0xc
    v_mov_b32_dpp v18, v22 row_ror:8 row_mask:0xf bank_mask:0xc
    v_mov_b32_dpp v19, v23 row_ror:8 row_mask:0xf bank_mask:0xc
    v_mov_b32_dpp v20, v4 row_ror:8 row_mask:0xf bank_mask:0x3
    v_mov_b32_dpp v21, v5 row_ror:8 row_mask:0xf bank_mask:0x3
    v_mov_b32_dpp v22, v6 row_ror:8 row_mask:0xf bank_mask:0x3
    v_mov_b32_dpp v23, v7 row_ror:8 row_mask:0xf bank_mask:0x3
    s_add_u32 s44, s42, 0x4000
    buffer_store_dwordx4 v[16:19], v1, s[12:15], s42 offen sc1
    buffer_store_dwordx4 v[20:23], v1, s[12:15], s44 offen sc1
    v_cvt_pk_bf16_f32 v24, v116, v117
    v_cvt_pk_bf16_f32 v25, v118, v119
    v_cvt_pk_bf16_f32 v26, v120, v121
    v_cvt_pk_bf16_f32 v27, v122, v123
    v_cvt_pk_bf16_f32 v28, v124, v125
    v_cvt_pk_bf16_f32 v29, v126, v127
    v_cvt_pk_bf16_f32 v30, v128, v129
    v_cvt_pk_bf16_f32 v31, v130, v131
    v_permlane16_swap_b32 v24, v26
    v_permlane16_swap_b32 v25, v27
    v_permlane16_swap_b32 v28, v30
    v_permlane16_swap_b32 v29, v31
    v_mov_b32 v4, v24
    v_mov_b32 v5, v25
    v_mov_b32 v6, v26
    v_mov_b32 v7, v27
    v_mov_b32_dpp v24, v28 row_ror:8 row_mask:0xf bank_mask:0xc
    v_mov_b32_dpp v25, v29 row_ror:8 row_mask:0xf bank_mask:0xc
    v_mov_b32_dpp v26, v30 row_ror:8 row_mask:0xf bank_mask:0xc
    v_mov_b32_dpp v27, v31 row_ror:8 row_mask:0xf bank_mask:0xc
    v_mov_b32_dpp v28, v4 row_ror:8 row_mask:0xf bank_mask:0x3
    v_mov_b32_dpp v29, v5 row_ror:8 row_mask:0xf bank_mask:0x3
    v_mov_b32_dpp v30, v6 row_ror:8 row_mask:0xf bank_mask:0x3
    v_mov_b32_dpp v31, v7 row_ror:8 row_mask:0xf bank_mask:0x3
    s_add_u32 s44, s43, 0x4000
    buffer_store_dwordx4 v[24:27], v1, s[12:15], s43 offen sc1
    buffer_store_dwordx4 v[28:31], v1, s[12:15], s44 offen sc1
    s_endpgm
F_aux:
    s_setprio 3
    s_sub_u32 s3, s3, 8
    s_mov_b32 s88, s3
    v_lshrrev_b32 v5, 4, v0
    s_cmp_eq_u32 s3, 1
    s_mov_b32 s45, 73728
    s_cselect_b32 s45, 65536, s45
    s_cmp_eq_u32 s3, 2
    s_cselect_b32 s45, 147456, s45
    v_bfe_u32 v60, v0, 2, 2
    v_lshl_add_u32 v62, v5, 3, v60
    v_lshrrev_b32 v60, 1, v60
    v_and_b32 v63, 1, v5
    v_lshl_add_u32 v60, v63, 1, v60
    v_lshlrev_b32 v60, 5, v60
    v_lshl_add_u32 v60, v62, 7, v60
    v_and_b32 v63, 3, v0
    v_lshl_add_u32 v60, v63, 3, v60
    v_add_u32 v62, s45, v60
    v_xor_b32 v63, 32, v62
    v_xor_b32 v64, 64, v62
    v_xor_b32 v65, 96, v62
    v_lshlrev_b32 v2, 4, v0
    v_lshlrev_b32 v3, 2, v0
    v_and_b32 v7, 15, v0
    v_and_b32 v8, 7, v0
    v_lshlrev_b32 v8, 4, v8
    v_lshl_add_u32 v8, v5, 7, v8
    v_bfe_u32 v9, v0, 3, 1
    v_lshl_add_u32 v4, v9, 11, v8
    v_and_b32 v9, 1, v0
    v_lshlrev_b32 v59, 2, v7
    s_lshl_b32 s76, s32, 4
    s_add_u32 s76, s76, s33
    s_lshl_b32 s77, s76, 3
    s_lshl_b32 s44, s3, 1
    s_add_u32 s77, s77, s44
    v_mov_b32 v12, 0
    v_mov_b32 v13, 0
    v_mov_b32 v14, 0
    v_mov_b32 v15, 0
    s_lshl_b32 s75, s3, 4
    s_add_u32 s75, s75, s33
    s_lshl_b32 s44, s3, 2
    s_add_u32 s44, s44, 159040
    v_mov_b32 v10, s44

    v_mov_b32 v32, 0x3f803f80
    v_mov_b32 v33, 0x3f803f80
    v_mov_b32 v34, 0x3f803f80
    v_mov_b32 v35, 0x3f803f80
    v_mov_b32 v36, 0x3f803f80
    v_mov_b32 v37, 0x3f803f80
    v_mov_b32 v38, 0x3f803f80
    v_mov_b32 v39, 0x3f803f80
    v_mov_b32 v40, 0x3f803f80
    v_mov_b32 v41, 0x3f803f80
    v_mov_b32 v42, 0x3f803f80
    v_mov_b32 v43, 0x3f803f80
    v_mov_b32 v44, 0x3f803f80
    v_mov_b32 v45, 0x3f803f80
    v_mov_b32 v46, 0x3f803f80
    v_mov_b32 v47, 0x3f803f80
    s_waitcnt lgkmcnt(0)
    s_mov_b32 s20, s4
    s_mov_b32 s21, s5
    s_mov_b32 s22, 0x400000
    s_mov_b32 s23, 0x00020000
    s_mov_b32 s19, 0x20000
    s_add_u32 s40, s72, 0x850000
    s_addc_u32 s41, s73, 0
    s_mov_b32 s42, 0xd000
    s_mov_b32 s43, 0x00020000
    s_cmp_lg_u32 s3, 0
    s_cbranch_scc1 F_z0
    s_getpc_b64 s[46:47]
F_pc:
    s_sub_u32 s46, s46, F_pc-parallel_sum__linear_attn_block__moe_arch_mod__prompt_kernel
    s_subb_u32 s47, s47, 0
    s_and_b32 s44, s31, 7
    s_lshl_b32 s44, s44, 13
    v_lshlrev_b32 v67, 7, v0
    v_add_u32 v67, s44, v67
    v_min_u32 v67, F_codeend-parallel_sum__linear_attn_block__moe_arch_mod__prompt_kernel-4, v67
    global_load_dword v61, v67, s[46:47]
    s_cmp_lg_u32 s75, 0
    s_cbranch_scc1 F_z0
    s_lshl_b32 s44, s32, 9
    s_add_u32 s44, s44, 32768
    s_mov_b32 exec_hi, 0
    buffer_store_dwordx4 v[12:15], v2, s[40:43], s44 offen sc0 sc1
    s_mul_i32 s44, s32, 768
    s_add_u32 s44, s44, 40960
    s_mov_b32 exec_hi, 0xffff
    buffer_store_dwordx4 v[12:15], v2, s[40:43], s44 offen sc0 sc1
    s_mov_b64 exec, -1
F_z0:

    s_and_b32 s89, s2, 0xdd
    s_bfe_u32 s44, s2, 0x10005
    s_lshl_b32 s44, s44, 1
    s_or_b32 s89, s89, s44
    s_bfe_u32 s44, s2, 0x10001
    s_xor_b32 s44, s44, 1
    s_lshl_b32 s44, s44, 5
    s_or_b32 s89, s89, s44
    s_xor_b32 s89, s89, 0

    s_and_b32 s36, s89, 3
    s_bfe_u32 s37, s89, 0x10002
    s_lshr_b32 s38, s89, 3
    s_cmp_eq_u32 s37, 0
    s_cselect_b32 s16, s62, s64
    s_cselect_b32 s17, s63, s65
    s_cmp_lt_u32 s89, 224
    s_cselect_b32 s18, 7340032, 0
    v_mul_u32_u24 v6, 57344, v5
    v_lshl_add_u32 v6, v7, 4, v6
    s_lshl_b32 s44, s36, 2
    s_add_u32 s44, s44, s3
    s_mul_i32 s54, s44, 458752
    s_lshl_b32 s45, s38, 8
    s_add_u32 s54, s54, s45
    s_lshl_b32 s55, s44, 7

    s_add_u32 s39, s35, 2
    s_and_b32 s39, s39, 7
    s_lshl_b32 s10, s34, 3
    s_add_u32 s10, s10, s30

    s_mul_i32 s10, s10, 112
    s_mul_i32 s79, s3, 28
    s_add_u32 s10, s10, s79
    s_lshl_b32 s78, s10, 11
    s_lshl_b32 s79, s39, 8
    s_add_u32 s78, s78, s79
    v_mul_u32_u24 v160, 14336, v5
    v_lshl_add_u32 v160, v7, 4, v160

    s_mov_b32 s80, s66
    s_mov_b32 s81, s67
    s_mov_b32 s82, 0x700000
    s_mov_b32 s83, 0x00020000
    s_barrier
    s_bitcmp0_b32 s3, 0
    s_cbranch_scc1 F_cs1
    ds_read_b64_tr_b16 v[72:73], v62 offset:0
    ds_read_b64_tr_b16 v[74:75], v62 offset:512
    ds_read_b64_tr_b16 v[76:77], v62 offset:4096
    ds_read_b64_tr_b16 v[78:79], v62 offset:4608
    ds_read_b64_tr_b16 v[80:81], v63 offset:0
    ds_read_b64_tr_b16 v[82:83], v63 offset:512
    ds_read_b64_tr_b16 v[84:85], v63 offset:4096
    ds_read_b64_tr_b16 v[86:87], v63 offset:4608
    s_waitcnt lgkmcnt(4)
    ds_read_b64_tr_b16 v[88:89], v64 offset:0
    ds_read_b64_tr_b16 v[90:91], v64 offset:512
    ds_read_b64_tr_b16 v[92:93], v64 offset:4096
    ds_read_b64_tr_b16 v[94:95], v64 offset:4608
    ds_read_b64_tr_b16 v[96:97], v65 offset:0
    ds_read_b64_tr_b16 v[98:99], v65 offset:512
    ds_read_b64_tr_b16 v[100:101], v65 offset:4096
    ds_read_b64_tr_b16 v[102:103], v65 offset:4608
    s_branch F_cs2
F_cs1:
    v_add_u32 v60, 159040, v3
    s_mov_b32 exec_hi, 0xffff
    ds_write_b32 v60, v12
    s_mov_b64 exec, -1
F_cs2:
    s_add_u32 s24, s72, 0x800000
    s_addc_u32 s25, s73, 0
    s_mov_b32 s26, 0x48000
    s_mov_b32 s27, 0x00020000
    s_mov_b32 s48, s70
    s_mov_b32 s49, s71
    s_mov_b32 s50, 0x100
    s_mov_b32 s51, 0x00020000
    s_lshl_b32 s47, s32, 9
    s_add_u32 s56, s47, 0x858000
    s_add_u32 s56, s72, s56
    s_addc_u32 s57, s73, 0
    s_lshl_b32 s47, s33, 9
    s_add_u32 s58, s47, 0x858100
    s_add_u32 s58, s72, s58
    s_addc_u32 s59, s73, 0
    v_mov_b32 v68, 0x3f803f80
    v_mov_b32 v69, 0x3f803f80
    v_mov_b32 v70, 0x3f803f80
    v_mov_b32 v71, 0x3f803f80
    s_waitcnt lgkmcnt(0)
    s_cmp_lg_u32 s75, 0
    s_cbranch_scc1 F_z4
    s_lshl_b32 s45, s32, 2
    s_add_u32 s44, s70, s45
    s_addc_u32 s45, s71, 0
    s_mov_b32 s46, 1
    s_waitcnt vmcnt(0)
    s_atomic_add s46, s[44:45], 0
F_z4:

    s_bitcmp0_b32 s3, 0
    s_cbranch_scc1 F_c2a
    v_mfma_f32_16x16x32_bf16 v[104:107], v[68:71], v[72:75], 0
    v_mfma_f32_16x16x32_bf16 v[108:111], v[68:71], v[80:83], 0
    v_mfma_f32_16x16x32_bf16 v[112:115], v[68:71], v[88:91], 0
    v_mfma_f32_16x16x32_bf16 v[116:119], v[68:71], v[96:99], 0
    v_mfma_f32_16x16x32_bf16 v[104:107], v[68:71], v[76:79], v[104:107]
    v_mfma_f32_16x16x32_bf16 v[108:111], v[68:71], v[84:87], v[108:111]
    v_mfma_f32_16x16x32_bf16 v[112:115], v[68:71], v[92:95], v[112:115]
    v_mfma_f32_16x16x32_bf16 v[116:119], v[68:71], v[100:103], v[116:119]
    v_cmp_eq_u32 vcc, 1, v5
    s_nop 4
    v_cndmask_b32 v66, v104, v108, vcc
    v_cmp_eq_u32 vcc, 2, v5
    s_nop 1
    v_cndmask_b32 v66, v66, v112, vcc
    v_cmp_eq_u32 vcc, 3, v5
    s_nop 1
    v_cndmask_b32 v66, v66, v116, vcc

F_c2a:
    s_barrier
    s_cmp_lg_u32 s3, 2
    s_cbranch_scc1 F_cs3
    ds_read_b64_tr_b16 v[72:73], v62 offset:0
    ds_read_b64_tr_b16 v[74:75], v62 offset:512
    ds_read_b64_tr_b16 v[76:77], v62 offset:4096
    ds_read_b64_tr_b16 v[78:79], v62 offset:4608
    ds_read_b64_tr_b16 v[80:81], v63 offset:0
    ds_read_b64_tr_b16 v[82:83], v63 offset:512
    ds_read_b64_tr_b16 v[84:85], v63 offset:4096
    s_branch IW_s8
IW_w8:
    s_branch IW_r8
IW_s8:
    ds_read_b64_tr_b16 v[86:87], v63 offset:4608
    s_waitcnt lgkmcnt(4)
    ds_read_b64_tr_b16 v[88:89], v64 offset:0
    ds_read_b64_tr_b16 v[90:91], v64 offset:512
    ds_read_b64_tr_b16 v[92:93], v64 offset:4096
    ds_read_b64_tr_b16 v[94:95], v64 offset:4608
    ds_read_b64_tr_b16 v[96:97], v65 offset:0
    ds_read_b64_tr_b16 v[98:99], v65 offset:512
    ds_read_b64_tr_b16 v[100:101], v65 offset:4096
    ds_read_b64_tr_b16 v[102:103], v65 offset:4608
    s_waitcnt lgkmcnt(0)
F_cs3:
    s_cmp_lg_u32 s3, 0
    s_cbranch_scc1 EV_78
    s_branch IW_w8
IW_r8:
EV_78:
    s_cmp_lg_u32 s3, 1
    s_cbranch_scc1 EV_79
    s_branch IW_w0
IW_r0:
EV_79:
    s_cmp_lg_u32 s3, 2
    s_cbranch_scc1 EV_80
    s_branch IW_w1
IW_r1:
EV_80:
    s_cmp_lg_u32 s3, 3
    s_cbranch_scc1 EV_81
    s_branch IW_w3
IW_r3:
EV_81:
    s_barrier
    s_cmp_lt_u32 s3, 2
    s_mov_b32 s44, 98304
    s_cselect_b32 s44, 98304, s44
    s_lshl_b32 s45, s3, 12
    s_add_u32 s44, s44, s45
    v_add_u32 v4, s44, v4
    v_add_u32 v8, 161792, v8
    ds_read_b128 v[16:19], v4 offset:0
    ds_read_b128 v[20:23], v4 offset:512
    ds_read_b128 v[24:27], v4 offset:1024
    ds_read_b128 v[28:31], v4 offset:1536
    s_mov_b32 exec_lo, 0x00ff00ff
    s_mov_b32 exec_hi, 0x00ff00ff
    ds_read_b128 v[32:35], v8 offset:0
    ds_read_b128 v[36:39], v8 offset:512
    ds_read_b128 v[40:43], v8 offset:1024
    ds_read_b128 v[44:47], v8 offset:1536
    s_mov_b64 exec, -1
    s_waitcnt lgkmcnt(0)
    v_mfma_f32_16x16x32_bf16 v[120:123], v[16:19], v[16:19], 0
    v_mfma_f32_16x16x32_bf16 v[124:127], v[16:19], v[32:35], 0
    v_mfma_f32_16x16x32_bf16 v[128:131], v[32:35], v[32:35], 0
    v_mfma_f32_16x16x32_bf16 v[120:123], v[20:23], v[20:23], v[120:123]
    v_mfma_f32_16x16x32_bf16 v[124:127], v[20:23], v[36:39], v[124:127]
    v_mfma_f32_16x16x32_bf16 v[128:131], v[36:39], v[36:39], v[128:131]
    v_mfma_f32_16x16x32_bf16 v[120:123], v[24:27], v[24:27], v[120:123]
    v_mfma_f32_16x16x32_bf16 v[124:127], v[24:27], v[40:43], v[124:127]
    v_mfma_f32_16x16x32_bf16 v[128:131], v[40:43], v[40:43], v[128:131]
    v_mfma_f32_16x16x32_bf16 v[120:123], v[28:31], v[28:31], v[120:123]
    v_mfma_f32_16x16x32_bf16 v[124:127], v[28:31], v[44:47], v[124:127]
    v_mfma_f32_16x16x32_bf16 v[128:131], v[44:47], v[44:47], v[128:131]
    s_cmp_lg_u32 s3, 2
    s_cbranch_scc1 F_c2b
    v_mfma_f32_16x16x32_bf16 v[104:107], v[68:71], v[72:75], 0
    v_mfma_f32_16x16x32_bf16 v[108:111], v[68:71], v[80:83], 0
    v_mfma_f32_16x16x32_bf16 v[112:115], v[68:71], v[88:91], 0
    v_mfma_f32_16x16x32_bf16 v[116:119], v[68:71], v[96:99], 0
    v_mfma_f32_16x16x32_bf16 v[104:107], v[68:71], v[76:79], v[104:107]
    v_mfma_f32_16x16x32_bf16 v[108:111], v[68:71], v[84:87], v[108:111]
    v_mfma_f32_16x16x32_bf16 v[112:115], v[68:71], v[92:95], v[112:115]
    v_mfma_f32_16x16x32_bf16 v[116:119], v[68:71], v[100:103], v[116:119]
    v_cmp_eq_u32 vcc, 1, v5
    s_nop 4
    v_cndmask_b32 v66, v104, v108, vcc
    v_cmp_eq_u32 vcc, 2, v5
    s_nop 1
    v_cndmask_b32 v66, v66, v112, vcc
    v_cmp_eq_u32 vcc, 3, v5
    s_nop 1
    v_cndmask_b32 v66, v66, v116, vcc

F_c2b:
    s_cmp_lg_u32 s3, 0
    s_cbranch_scc1 F_r1
    buffer_load_dword v11, v59, s[48:51], 0 offen sc0 sc1
F_r1:
    s_cmp_lg_u32 s3, 0
    s_cbranch_scc1 EV_83
    s_branch IW_w4
IW_r4:
EV_83:
    s_cmp_lg_u32 s3, 1
    s_cbranch_scc1 EV_84
    s_branch IW_w9
IW_r9:
EV_84:
    s_cmp_lg_u32 s3, 2
    s_cbranch_scc1 EV_85
    s_branch IW_w10
IW_r10:
EV_85:
    s_cmp_lg_u32 s3, 3
    s_cbranch_scc1 EV_86
    s_nop 0
EV_86:
    s_barrier
    v_and_b32 v52, 3, v0
    v_cmp_eq_u32 vcc, 1, v52
    s_nop 1
    v_cndmask_b32 v120, v120, v121, vcc
    v_cndmask_b32 v124, v124, v125, vcc
    v_cndmask_b32 v128, v128, v129, vcc
    v_cmp_eq_u32 vcc, 2, v52
    s_nop 1
    v_cndmask_b32 v120, v120, v122, vcc
    v_cndmask_b32 v124, v124, v126, vcc
    v_cndmask_b32 v128, v128, v130, vcc
    v_cmp_eq_u32 vcc, 3, v52
    s_nop 1
    v_cndmask_b32 v120, v120, v123, vcc
    v_cndmask_b32 v124, v124, v127, vcc
    v_cndmask_b32 v128, v128, v131, vcc
    v_add_f32_dpp v120, v120, v120 quad_perm:[1,0,3,2] row_mask:0xf bank_mask:0xf
    v_add_f32_dpp v124, v124, v124 quad_perm:[1,0,3,2] row_mask:0xf bank_mask:0xf
    v_add_f32_dpp v128, v128, v128 quad_perm:[1,0,3,2] row_mask:0xf bank_mask:0xf
    v_add_f32_dpp v120, v120, v120 quad_perm:[2,3,0,1] row_mask:0xf bank_mask:0xf
    v_add_f32_dpp v124, v124, v124 quad_perm:[2,3,0,1] row_mask:0xf bank_mask:0xf
    v_add_f32_dpp v128, v128, v128 quad_perm:[2,3,0,1] row_mask:0xf bank_mask:0xf
    v_readlane_b32 s44, v124, 8
    v_readlane_b32 s45, v124, 24
    v_readlane_b32 s46, v124, 40
    v_readlane_b32 s47, v124, 56
    v_mov_b32 v48, s44
    v_mov_b32 v52, s45
    s_nop 0
    v_writelane_b32 v48, s46, 1
    v_writelane_b32 v52, s47, 1
    v_readlane_b32 s44, v120, 0
    v_readlane_b32 s45, v120, 20
    v_readlane_b32 s46, v120, 40
    v_readlane_b32 s47, v120, 60
    v_mov_b32 v49, s44
    v_mov_b32 v53, s45
    s_nop 0
    v_writelane_b32 v49, s46, 1
    v_writelane_b32 v53, s47, 1
    v_readlane_b32 s44, v124, 0
    v_readlane_b32 s45, v124, 20
    v_readlane_b32 s46, v124, 32
    v_readlane_b32 s47, v124, 52
    v_mov_b32 v50, s44
    v_mov_b32 v54, s45
    s_nop 0
    v_writelane_b32 v50, s46, 1
    v_writelane_b32 v54, s47, 1
    v_readlane_b32 s44, v128, 8
    v_readlane_b32 s45, v128, 24
    v_readlane_b32 s46, v128, 8
    v_readlane_b32 s47, v128, 24
    v_mov_b32 v51, s44
    v_mov_b32 v55, s45
    s_nop 0
    v_writelane_b32 v51, s46, 1
    v_writelane_b32 v55, s47, 1
    v_add_f32 v48, v48, v52
    v_add_f32 v49, v49, v53
    v_add_f32 v50, v50, v54
    v_add_f32 v51, v51, v55
    v_mul_f32 v48, 0x3a800000, v48
    v_mul_f32 v49, 0x3a800000, v49
    v_fma_f32 v49, -v48, v48, v49
    v_max_f32 v49, 0, v49
    v_cvt_pk_bf16_f32 v52, v48, v49
    v_lshlrev_b32 v48, 16, v52
    v_and_b32 v49, 0xffff0000, v52
    v_add_f32 v49, 0x3727c5ac, v49
    v_cvt_pk_bf16_f32 v49, v49, v49
    v_lshlrev_b32 v49, 16, v49
    v_sqrt_f32 v49, v49
    s_nop 0
    v_cvt_pk_bf16_f32 v49, v49, v49
    v_lshlrev_b32 v49, 16, v49
    v_rcp_f32 v49, v49
    v_xor_b32 v48, 0x80000000, v48
    v_fma_f32 v50, v48, v51, v50
    v_mul_f32 v50, v50, v49
    v_cvt_pk_bf16_f32 v50, v50, v50
    v_and_b32 v50, 0xffff0000, v50
    v_ashrrev_i32 v51, 31, v50
    v_or_b32 v51, 0x80000000, v51
    v_xor_b32 v50, v50, v51
    v_and_b32 v50, 0xffff0000, v50
    s_sub_u32 s44, 2047, s77
    v_sub_u32 v51, s44, v9
    v_or_b32 v50, v50, v51
    s_lshl_b32 s44, s3, 1
    v_add_u32 v52, s44, v9
    v_lshlrev_b32 v53, 3, v52
    v_lshlrev_b32 v52, 2, v52
    v_add_u32 v53, 159744, v53
    v_add_u32 v52, 159808, v52
    s_mov_b64 exec, 3
    ds_write_b64 v53, v[48:49]
    ds_write_b32 v52, v50
    s_mov_b64 exec, -1
    s_waitcnt lgkmcnt(0)

    s_cmp_lg_u32 s3, 0
    s_cbranch_scc1 F_a0r
F_a0p:
    s_waitcnt vmcnt(0)
    v_cmp_eq_u32 vcc, 0, v11
    s_cbranch_vccz F_a0r
    s_sleep 4
    buffer_load_dword v11, v59, s[48:51], 0 offen sc0 sc1
    s_branch F_a0p
F_a0r:
    s_barrier
    s_cmp_eq_u32 s3, 0
    s_cbranch_scc1 F_ax0
    s_mul_i32 s44, s33, 768
    s_add_u32 s44, s44, 40960
    s_add_u32 s45, s3, 1
    s_lshr_b32 s45, s45, 1
    s_cmp_eq_u32 s3, 2
    s_cselect_b32 s45, 0, s45
    s_lshl_b32 s45, s45, 8
    s_add_u32 s44, s44, s45
    buffer_atomic_add_f32 v66, v3, s[40:43], s44 offen
    s_mul_i32 s44, s2, 1152
    s_mul_i32 s45, s3, 384
    s_add_u32 s44, s44, s45
    s_sub_u32 s44, s44, 384
    s_mov_b64 exec, 0xffffff
    buffer_store_dwordx4 v[12:15], v2, s[24:27], s44 offen sc0 sc1
    s_mov_b64 exec, -1
    s_branch F_s1
F_ax0:
    v_add_u32 v60, 159744, v3
    ds_read_b32 v60, v60
    s_lshl_b32 s44, s76, 7
    s_mov_b32 exec_hi, 0
    s_waitcnt lgkmcnt(0)
    buffer_store_dword v60, v3, s[40:43], s44 offen sc0 sc1
    s_mov_b64 exec, -1
F_s1:

    s_barrier
    v_mov_b32 v4, 159144
    v_mov_b32 v8, 1
    s_lshr_b32 s47, s32, 2
    s_lshl_b32 s47, s47, 11
    s_add_u32 s86, s47, 0x858180
    s_add_u32 s86, s72, s86
    s_addc_u32 s87, s73, 0
    s_waitcnt vmcnt(0)
    s_mov_b64 exec, 1
    ds_add_rtn_u32 v9, v4, v8
    s_waitcnt lgkmcnt(0)
    v_readfirstlane_b32 s44, v9
    s_mov_b64 exec, -1
    s_cmp_lg_u32 s44, 3
    s_cbranch_scc1 F_a0s
    s_mov_b32 s74, 1
    s_atomic_add s74, s[86:87], 0
    s_atomic_add s74, s[56:57], 0
    s_atomic_add s74, s[58:59], 0
F_a0s:

    s_barrier
    s_mul_i32 s53, s2, 37
    s_and_b32 s53, s53, 255
    s_mul_i32 s53, s53, 4
    s_lshr_b32 s53, s53, 8
    s_branch F_swx
F_sw0:
    s_add_u32 s91, s54, 0
    buffer_load_dwordx4 v[72:75], v6, s[16:19], s91 offen nt
    s_add_u32 s91, s54, 7168
    buffer_load_dwordx4 v[76:79], v6, s[16:19], s91 offen nt
    s_add_u32 s91, s54, 14336
    buffer_load_dwordx4 v[80:83], v6, s[16:19], s91 offen nt
    s_add_u32 s91, s54, 21504
    buffer_load_dwordx4 v[84:87], v6, s[16:19], s91 offen nt
    s_add_u32 s91, s54, 28672
    buffer_load_dwordx4 v[88:91], v6, s[16:19], s91 offen nt
    s_add_u32 s91, s54, 35840
    buffer_load_dwordx4 v[92:95], v6, s[16:19], s91 offen nt
    s_add_u32 s91, s54, 43008
    buffer_load_dwordx4 v[96:99], v6, s[16:19], s91 offen nt
    s_add_u32 s91, s54, 50176
    buffer_load_dwordx4 v[100:103], v6, s[16:19], s91 offen nt
    s_setpc_b64 s[34:35]
F_swx:
    s_cmp_eq_u32 s3, 2
    s_cbranch_scc1 F_ax2
    s_cmp_eq_u32 s3, 1
    s_cbranch_scc1 F_ax1
    s_cmp_eq_u32 s3, 0
    s_cbranch_scc1 F_ax0b
    s_barrier
    s_cmp_lg_u32 s53, 0
    s_cbranch_scc1 SW_87
    s_call_b64 s[34:35], F_sw0
SW_87:
    s_branch IW_w5
IW_r5:
    s_barrier
    s_cmp_lg_u32 s53, 1
    s_cbranch_scc1 SW_88
    s_call_b64 s[34:35], F_sw0
SW_88:
    s_branch IW_w7
IW_r7:
    s_barrier
    s_cmp_lg_u32 s53, 2
    s_cbranch_scc1 SW_89
    s_call_b64 s[34:35], F_sw0
SW_89:
    s_nop 0
    s_barrier
    s_cmp_lg_u32 s53, 3
    s_cbranch_scc1 SW_90
    s_call_b64 s[34:35], F_sw0
SW_90:
    s_nop 0
    s_barrier
    s_nop 0
    s_barrier
    s_nop 0
    s_barrier
    s_add_u32 s91, s54, 229376
    buffer_load_dwordx4 v[104:107], v6, s[16:19], s91 offen nt
    s_add_u32 s91, s54, 236544
    buffer_load_dwordx4 v[108:111], v6, s[16:19], s91 offen nt
    s_add_u32 s91, s54, 243712
    buffer_load_dwordx4 v[112:115], v6, s[16:19], s91 offen nt
    s_add_u32 s91, s54, 250880
    buffer_load_dwordx4 v[116:119], v6, s[16:19], s91 offen nt
    s_nop 0
    s_load_dword s76, s[56:57], 0 glc
    s_barrier
    s_add_u32 s91, s54, 258048
    buffer_load_dwordx4 v[120:123], v6, s[16:19], s91 offen nt
    s_add_u32 s91, s54, 265216
    buffer_load_dwordx4 v[124:127], v6, s[16:19], s91 offen nt
    s_add_u32 s91, s54, 272384
    buffer_load_dwordx4 v[128:131], v6, s[16:19], s91 offen nt
    s_add_u32 s91, s54, 279552
    buffer_load_dwordx4 v[132:135], v6, s[16:19], s91 offen nt
    s_waitcnt lgkmcnt(0)
    s_cmp_lt_u32 s76, 1000
    s_cbranch_scc1 F_g3
    v_mov_b32 v4, 1
    s_mov_b64 exec, 1
    ds_write_b32 v10, v4 offset:48
    s_mov_b64 exec, -1
    s_mov_b32 s88, 0
F_g3:
    s_barrier
    s_branch F_aj
F_ax1:
    s_barrier
    s_cmp_lg_u32 s53, 0
    s_cbranch_scc1 SW_91
    s_call_b64 s[34:35], F_sw0
SW_91:
    s_branch IW_w6
IW_r6:
    s_barrier
    s_cmp_lg_u32 s53, 1
    s_cbranch_scc1 SW_92
    s_call_b64 s[34:35], F_sw0
SW_92:
    s_nop 0
    s_barrier
    s_cmp_lg_u32 s53, 2
    s_cbranch_scc1 SW_93
    s_call_b64 s[34:35], F_sw0
SW_93:
    s_nop 0
    s_mul_i32 s44, s33, 768
    s_add_u32 s44, s44, 40960
    s_barrier
    s_cmp_lg_u32 s53, 3
    s_cbranch_scc1 SW_94
    s_call_b64 s[34:35], F_sw0
SW_94:
    s_load_dword s76, s[58:59], 0 glc
    s_barrier
    s_waitcnt lgkmcnt(0)
    s_cmp_ge_u32 s76, 16
    s_cbranch_scc1 GC_95
SP_96:
    s_load_dword s76, s[58:59], 0 glc
    s_waitcnt lgkmcnt(0)
    s_cmp_ge_u32 s76, 16
    s_cbranch_scc1 SD_97
    s_sleep 3
    s_branch SP_96
SD_97:
GC_95:
    s_barrier
    s_sleep 4
    s_mov_b32 m0, 158208
    s_mov_b32 exec_hi, 0xffff
    buffer_load_dwordx4 v2, s[40:43], s44 offen sc0 sc1 lds
    s_mov_b64 exec, -1
    s_barrier
    s_add_u32 s91, s54, 229376
    buffer_load_dwordx4 v[104:107], v6, s[16:19], s91 offen nt
    s_add_u32 s91, s54, 236544
    buffer_load_dwordx4 v[108:111], v6, s[16:19], s91 offen nt
    s_add_u32 s91, s54, 243712
    buffer_load_dwordx4 v[112:115], v6, s[16:19], s91 offen nt
    s_add_u32 s91, s54, 250880
    buffer_load_dwordx4 v[116:119], v6, s[16:19], s91 offen nt
    s_barrier
    s_add_u32 s91, s54, 258048
    buffer_load_dwordx4 v[120:123], v6, s[16:19], s91 offen nt
    s_add_u32 s91, s54, 265216
    buffer_load_dwordx4 v[124:127], v6, s[16:19], s91 offen nt
    s_add_u32 s91, s54, 272384
    buffer_load_dwordx4 v[128:131], v6, s[16:19], s91 offen nt
    s_add_u32 s91, s54, 279552
    buffer_load_dwordx4 v[132:135], v6, s[16:19], s91 offen nt
    s_waitcnt vmcnt(8)
    v_mov_b32 v4, 1
    s_mov_b64 exec, 1
    ds_write_b32 v10, v4 offset:48
    s_mov_b64 exec, -1
    s_barrier
    s_branch F_aj
IW_w9:
    s_branch IW_r9
F_ax0b:
    s_barrier
    s_cmp_lg_u32 s53, 0
    s_cbranch_scc1 SW_98
    s_call_b64 s[34:35], F_sw0
SW_98:
    s_branch IW_w2
IW_r2:
    s_barrier
    s_cmp_lg_u32 s53, 1
    s_cbranch_scc1 SW_99
    s_call_b64 s[34:35], F_sw0
SW_99:
    s_nop 0
    s_barrier
    s_cmp_lg_u32 s53, 2
    s_cbranch_scc1 SW_100
    s_call_b64 s[34:35], F_sw0
SW_100:
    s_nop 0
    s_lshl_b32 s47, s28, 9
    s_waitcnt lgkmcnt(0)
    s_add_u32 s58, s47, 0x858000
    s_add_u32 s58, s72, s58
    s_addc_u32 s59, s73, 0
    s_lshl_b32 s44, s32, 11
    s_lshl_b32 s45, s28, 11
    v_lshrrev_b32 v11, 2, v0
    v_and_b32 v9, 3, v0
    v_lshlrev_b32 v9, 4, v9
    v_lshl_add_u32 v11, v11, 7, v9

    s_barrier
    s_cmp_lg_u32 s53, 3
    s_cbranch_scc1 SW_101
    s_call_b64 s[34:35], F_sw0
SW_101:
    s_load_dword s76, s[56:57], 0 glc
    s_load_dword s77, s[58:59], 0 glc
    s_barrier
    s_waitcnt lgkmcnt(0)
    s_cmp_ge_u32 s76, 16
    s_cbranch_scc1 GC_102
SP_103:
    s_load_dword s76, s[56:57], 0 glc
    s_waitcnt lgkmcnt(0)
    s_cmp_ge_u32 s76, 16
    s_cbranch_scc1 SD_104
    s_sleep 3
    s_branch SP_103
SD_104:
GC_102:
    s_cmp_ge_u32 s77, 16
    s_cbranch_scc1 GC_105
SP_106:
    s_load_dword s77, s[58:59], 0 glc
    s_waitcnt lgkmcnt(0)
    s_cmp_ge_u32 s77, 16
    s_cbranch_scc1 SD_107
    s_sleep 3
    s_branch SP_106
SD_107:
GC_105:
    s_barrier
    s_sleep 4
    buffer_load_dwordx4 v[32:35], v11, s[40:43], s44 offen sc0 sc1
    buffer_load_dwordx4 v[36:39], v11, s[40:43], s45 offen sc0 sc1
    v_lshlrev_b32 v9, 3, v0
    v_add_u32 v9, 155648, v9
    s_mov_b32 s44, 0x3fb8aa3b

    s_barrier
    s_add_u32 s91, s54, 229376
    buffer_load_dwordx4 v[104:107], v6, s[16:19], s91 offen nt
    s_add_u32 s91, s54, 236544
    buffer_load_dwordx4 v[108:111], v6, s[16:19], s91 offen nt
    s_add_u32 s91, s54, 243712
    buffer_load_dwordx4 v[112:115], v6, s[16:19], s91 offen nt
    s_add_u32 s91, s54, 250880
    buffer_load_dwordx4 v[116:119], v6, s[16:19], s91 offen nt
    s_barrier
    s_add_u32 s91, s54, 258048
    buffer_load_dwordx4 v[120:123], v6, s[16:19], s91 offen nt
    s_add_u32 s91, s54, 265216
    buffer_load_dwordx4 v[124:127], v6, s[16:19], s91 offen nt
    s_add_u32 s91, s54, 272384
    buffer_load_dwordx4 v[128:131], v6, s[16:19], s91 offen nt
    s_add_u32 s91, s54, 279552
    buffer_load_dwordx4 v[132:135], v6, s[16:19], s91 offen nt
    s_waitcnt vmcnt(8)
    v_swap_b32 v33, v34
    v_swap_b32 v37, v38
    v_mul_f32 v40, s44, v34
    v_mul_f32 v41, s44, v35
    ds_write_b64 v9, v[32:33]
    ds_write_b64 v9, v[40:41] offset:1024
    ds_write_b64 v9, v[36:37] offset:1536
    ds_write_b64 v9, v[38:39] offset:2048

    v_mov_b32 v4, 1
    s_mov_b64 exec, 1
    ds_write_b32 v10, v4 offset:48
    s_mov_b64 exec, -1
    s_barrier
    s_branch F_aj
F_ax2:
    s_cmp_lg_u32 s2, 248
    s_cbranch_scc1 F_a2n
    s_waitcnt lgkmcnt(0)
    s_mov_b32 s74, 7
    v_lshrrev_b32 v11, 1, v0
    v_and_b32 v9, 1, v0
    v_lshlrev_b32 v9, 4, v9
    v_lshl_add_u32 v11, v11, 7, v9
    v_lshlrev_b32 v9, 9, v0
    v_mov_b32 v8, 1000
F_a2l:

    s_load_dword s60, s[40:41], 0x8180 glc
    s_load_dword s61, s[40:41], 0x8980 glc
    s_load_dword s62, s[40:41], 0x9180 glc
    s_load_dword s63, s[40:41], 0x9980 glc
    s_waitcnt lgkmcnt(0)
    s_add_u32 s60, s60, s61
    s_add_u32 s62, s62, s63
    s_add_u32 s60, s60, s62
    s_cmp_ge_u32 s60, 256
    s_cbranch_scc1 F_a2t

    s_cmp_ge_u32 s74, 17
    s_cbranch_scc1 DB_108
    s_barrier
    s_add_u32 s74, s74, 1
DB_108:
    s_branch F_a2l
F_a2t:
    s_movk_i32 s44, 0
    buffer_load_dwordx4 v[16:19], v11, s[40:43], s44 offen offset:64 sc0 sc1
    s_movk_i32 s44, 4096
    buffer_load_dwordx4 v[20:23], v11, s[40:43], s44 offen offset:64 sc0 sc1
    s_movk_i32 s44, 8192
    buffer_load_dwordx4 v[24:27], v11, s[40:43], s44 offen offset:64 sc0 sc1
    s_movk_i32 s44, 12288
    buffer_load_dwordx4 v[28:31], v11, s[40:43], s44 offen offset:64 sc0 sc1
    s_movk_i32 s44, 16384
    buffer_load_dwordx4 v[32:35], v11, s[40:43], s44 offen offset:64 sc0 sc1
    s_movk_i32 s44, 20480
    buffer_load_dwordx4 v[36:39], v11, s[40:43], s44 offen offset:64 sc0 sc1
    s_movk_i32 s44, 24576
    buffer_load_dwordx4 v[40:43], v11, s[40:43], s44 offen offset:64 sc0 sc1
    s_movk_i32 s44, 28672
    buffer_load_dwordx4 v[44:47], v11, s[40:43], s44 offen offset:64 sc0 sc1
    s_mov_b32 s44, 32768
    s_mov_b64 exec, 0xffff
    buffer_atomic_add v8, v9, s[40:43], s44 offen
    s_mov_b64 exec, -1

    s_cmp_ge_u32 s74, 17
    s_cbranch_scc1 DB_109
    s_barrier
    s_add_u32 s74, s74, 1
DB_109:
    s_waitcnt vmcnt(1)
    v_max3_u32 v48, v16, v17, v18
    v_med3_u32 v49, v16, v17, v18
    v_min3_u32 v50, v16, v17, v18
    v_med3_u32 v50, v49, v50, v19
    v_med3_u32 v49, v48, v49, v19
    v_max_u32 v48, v48, v19
    v_med3_u32 v50, v49, v50, v20
    v_med3_u32 v49, v48, v49, v20
    v_max_u32 v48, v48, v20
    v_med3_u32 v50, v49, v50, v21
    v_med3_u32 v49, v48, v49, v21
    v_max_u32 v48, v48, v21
    v_med3_u32 v50, v49, v50, v22
    v_med3_u32 v49, v48, v49, v22
    v_max_u32 v48, v48, v22
    v_med3_u32 v50, v49, v50, v23
    v_med3_u32 v49, v48, v49, v23
    v_max_u32 v48, v48, v23
    v_med3_u32 v50, v49, v50, v24
    v_med3_u32 v49, v48, v49, v24
    v_max_u32 v48, v48, v24
    v_med3_u32 v50, v49, v50, v25
    v_med3_u32 v49, v48, v49, v25
    v_max_u32 v48, v48, v25
    v_med3_u32 v50, v49, v50, v26
    v_med3_u32 v49, v48, v49, v26
    v_max_u32 v48, v48, v26
    v_med3_u32 v50, v49, v50, v27
    v_med3_u32 v49, v48, v49, v27
    v_max_u32 v48, v48, v27
    v_med3_u32 v50, v49, v50, v28
    v_med3_u32 v49, v48, v49, v28
    v_max_u32 v48, v48, v28
    v_med3_u32 v50, v49, v50, v29
    v_med3_u32 v49, v48, v49, v29
    v_max_u32 v48, v48, v29
    v_med3_u32 v50, v49, v50, v30
    v_med3_u32 v49, v48, v49, v30
    v_max_u32 v48, v48, v30
    v_med3_u32 v50, v49, v50, v31
    v_med3_u32 v49, v48, v49, v31
    v_max_u32 v48, v48, v31
    v_med3_u32 v50, v49, v50, v32
    v_med3_u32 v49, v48, v49, v32
    v_max_u32 v48, v48, v32
    v_med3_u32 v50, v49, v50, v33
    v_med3_u32 v49, v48, v49, v33
    v_max_u32 v48, v48, v33
    v_med3_u32 v50, v49, v50, v34
    v_med3_u32 v49, v48, v49, v34
    v_max_u32 v48, v48, v34
    v_med3_u32 v50, v49, v50, v35
    v_med3_u32 v49, v48, v49, v35
    v_max_u32 v48, v48, v35
    v_med3_u32 v50, v49, v50, v36
    v_med3_u32 v49, v48, v49, v36
    v_max_u32 v48, v48, v36
    v_med3_u32 v50, v49, v50, v37
    v_med3_u32 v49, v48, v49, v37
    v_max_u32 v48, v48, v37
    v_med3_u32 v50, v49, v50, v38
    v_med3_u32 v49, v48, v49, v38
    v_max_u32 v48, v48, v38
    v_med3_u32 v50, v49, v50, v39
    v_med3_u32 v49, v48, v49, v39
    v_max_u32 v48, v48, v39
    v_med3_u32 v50, v49, v50, v40
    v_med3_u32 v49, v48, v49, v40
    v_max_u32 v48, v48, v40
    v_med3_u32 v50, v49, v50, v41
    v_med3_u32 v49, v48, v49, v41
    v_max_u32 v48, v48, v41
    v_med3_u32 v50, v49, v50, v42
    v_med3_u32 v49, v48, v49, v42
    v_max_u32 v48, v48, v42
    v_med3_u32 v50, v49, v50, v43
    v_med3_u32 v49, v48, v49, v43
    v_max_u32 v48, v48, v43
    v_med3_u32 v50, v49, v50, v44
    v_med3_u32 v49, v48, v49, v44
    v_max_u32 v48, v48, v44
    v_med3_u32 v50, v49, v50, v45
    v_med3_u32 v49, v48, v49, v45
    v_max_u32 v48, v48, v45
    v_med3_u32 v50, v49, v50, v46
    v_med3_u32 v49, v48, v49, v46
    v_max_u32 v48, v48, v46
    v_med3_u32 v50, v49, v50, v47
    v_med3_u32 v49, v48, v49, v47
    v_max_u32 v48, v48, v47
    s_mov_b32 s53, 0
    v_max_u32 v4, v48, v49
    s_nop 1
    v_max_u32_dpp v4, v4, v4 row_shr:1 row_mask:0xf bank_mask:0xf bound_ctrl:0
    s_nop 1
    v_max_u32_dpp v4, v4, v4 row_shr:2 row_mask:0xf bank_mask:0xf bound_ctrl:0
    s_nop 1
    v_max_u32_dpp v4, v4, v4 row_shr:4 row_mask:0xf bank_mask:0xf bound_ctrl:0
    s_nop 1
    v_max_u32_dpp v4, v4, v4 row_shr:8 row_mask:0xf bank_mask:0xf bound_ctrl:0
    s_nop 1
    v_max_u32_dpp v4, v4, v4 row_bcast:15 row_mask:0xa bank_mask:0xf
    s_nop 1
    v_max_u32_dpp v4, v4, v4 row_bcast:31 row_mask:0xc bank_mask:0xf
    s_nop 0
    v_readlane_b32 s52, v4, 63
    s_nop 0
    s_add_u32 s53, s53, s52
    v_writelane_b32 v13, s53, 0
    v_subrev_u32 v48, s52, v48
    v_subrev_u32 v49, s52, v49
    v_max_u32 v4, v48, v49
    s_nop 1
    v_max_u32_dpp v4, v4, v4 row_shr:1 row_mask:0xf bank_mask:0xf bound_ctrl:0
    s_nop 1
    v_max_u32_dpp v4, v4, v4 row_shr:2 row_mask:0xf bank_mask:0xf bound_ctrl:0
    s_nop 1
    v_max_u32_dpp v4, v4, v4 row_shr:4 row_mask:0xf bank_mask:0xf bound_ctrl:0
    s_nop 1
    v_max_u32_dpp v4, v4, v4 row_shr:8 row_mask:0xf bank_mask:0xf bound_ctrl:0
    s_nop 1
    v_max_u32_dpp v4, v4, v4 row_bcast:15 row_mask:0xa bank_mask:0xf
    s_nop 1
    v_max_u32_dpp v4, v4, v4 row_bcast:31 row_mask:0xc bank_mask:0xf
    s_nop 0
    v_readlane_b32 s52, v4, 63
    s_nop 0
    s_add_u32 s53, s53, s52
    v_writelane_b32 v13, s53, 1
    v_subrev_u32 v48, s52, v48
    v_subrev_u32 v49, s52, v49
    v_max_u32 v4, v48, v49
    s_nop 1
    v_max_u32_dpp v4, v4, v4 row_shr:1 row_mask:0xf bank_mask:0xf bound_ctrl:0
    s_nop 1
    v_max_u32_dpp v4, v4, v4 row_shr:2 row_mask:0xf bank_mask:0xf bound_ctrl:0
    s_nop 1
    v_max_u32_dpp v4, v4, v4 row_shr:4 row_mask:0xf bank_mask:0xf bound_ctrl:0
    s_nop 1
    v_max_u32_dpp v4, v4, v4 row_shr:8 row_mask:0xf bank_mask:0xf bound_ctrl:0
    s_nop 1
    v_max_u32_dpp v4, v4, v4 row_bcast:15 row_mask:0xa bank_mask:0xf
    s_nop 1
    v_max_u32_dpp v4, v4, v4 row_bcast:31 row_mask:0xc bank_mask:0xf
    s_nop 0
    v_readlane_b32 s52, v4, 63
    s_nop 0
    s_add_u32 s53, s53, s52
    v_writelane_b32 v13, s53, 2
    v_subrev_u32 v48, s52, v48
    v_subrev_u32 v49, s52, v49
    v_max_u32 v4, v48, v49
    s_nop 1
    v_max_u32_dpp v4, v4, v4 row_shr:1 row_mask:0xf bank_mask:0xf bound_ctrl:0
    s_nop 1
    v_max_u32_dpp v4, v4, v4 row_shr:2 row_mask:0xf bank_mask:0xf bound_ctrl:0
    s_nop 1
    v_max_u32_dpp v4, v4, v4 row_shr:4 row_mask:0xf bank_mask:0xf bound_ctrl:0
    s_nop 1
    v_max_u32_dpp v4, v4, v4 row_shr:8 row_mask:0xf bank_mask:0xf bound_ctrl:0
    s_nop 1
    v_max_u32_dpp v4, v4, v4 row_bcast:15 row_mask:0xa bank_mask:0xf
    s_nop 1
    v_max_u32_dpp v4, v4, v4 row_bcast:31 row_mask:0xc bank_mask:0xf
    s_nop 0
    v_readlane_b32 s52, v4, 63
    s_nop 0
    s_add_u32 s53, s53, s52
    v_writelane_b32 v13, s53, 3
    v_subrev_u32 v48, s52, v48
    v_subrev_u32 v49, s52, v49
    v_max_u32 v4, v48, v49
    s_nop 1
    v_max_u32_dpp v4, v4, v4 row_shr:1 row_mask:0xf bank_mask:0xf bound_ctrl:0
    s_nop 1
    v_max_u32_dpp v4, v4, v4 row_shr:2 row_mask:0xf bank_mask:0xf bound_ctrl:0
    s_nop 1
    v_max_u32_dpp v4, v4, v4 row_shr:4 row_mask:0xf bank_mask:0xf bound_ctrl:0
    s_nop 1
    v_max_u32_dpp v4, v4, v4 row_shr:8 row_mask:0xf bank_mask:0xf bound_ctrl:0
    s_nop 1
    v_max_u32_dpp v4, v4, v4 row_bcast:15 row_mask:0xa bank_mask:0xf
    s_nop 1
    v_max_u32_dpp v4, v4, v4 row_bcast:31 row_mask:0xc bank_mask:0xf
    s_nop 0
    v_readlane_b32 s52, v4, 63
    s_nop 0
    s_add_u32 s53, s53, s52
    v_writelane_b32 v13, s53, 4
    v_subrev_u32 v48, s52, v48
    v_subrev_u32 v49, s52, v49
    v_max_u32 v4, v48, v49
    s_nop 1
    v_max_u32_dpp v4, v4, v4 row_shr:1 row_mask:0xf bank_mask:0xf bound_ctrl:0
    s_nop 1
    v_max_u32_dpp v4, v4, v4 row_shr:2 row_mask:0xf bank_mask:0xf bound_ctrl:0
    s_nop 1
    v_max_u32_dpp v4, v4, v4 row_shr:4 row_mask:0xf bank_mask:0xf bound_ctrl:0
    s_nop 1
    v_max_u32_dpp v4, v4, v4 row_shr:8 row_mask:0xf bank_mask:0xf bound_ctrl:0
    s_nop 1
    v_max_u32_dpp v4, v4, v4 row_bcast:15 row_mask:0xa bank_mask:0xf
    s_nop 1
    v_max_u32_dpp v4, v4, v4 row_bcast:31 row_mask:0xc bank_mask:0xf
    s_nop 0
    v_readlane_b32 s52, v4, 63
    s_nop 0
    s_add_u32 s53, s53, s52
    v_writelane_b32 v13, s53, 5
    v_subrev_u32 v48, s52, v48
    v_subrev_u32 v49, s52, v49
    v_max_u32 v4, v48, v49
    s_nop 1
    v_max_u32_dpp v4, v4, v4 row_shr:1 row_mask:0xf bank_mask:0xf bound_ctrl:0
    s_nop 1
    v_max_u32_dpp v4, v4, v4 row_shr:2 row_mask:0xf bank_mask:0xf bound_ctrl:0
    s_nop 1
    v_max_u32_dpp v4, v4, v4 row_shr:4 row_mask:0xf bank_mask:0xf bound_ctrl:0
    s_nop 1
    v_max_u32_dpp v4, v4, v4 row_shr:8 row_mask:0xf bank_mask:0xf bound_ctrl:0
    s_nop 1
    v_max_u32_dpp v4, v4, v4 row_bcast:15 row_mask:0xa bank_mask:0xf
    s_nop 1
    v_max_u32_dpp v4, v4, v4 row_bcast:31 row_mask:0xc bank_mask:0xf
    s_nop 0
    v_readlane_b32 s52, v4, 63
    s_nop 0
    s_add_u32 s53, s53, s52
    v_writelane_b32 v13, s53, 6
    v_subrev_u32 v48, s52, v48
    v_subrev_u32 v49, s52, v49
    v_max_u32 v4, v48, v49
    s_nop 1
    v_max_u32_dpp v4, v4, v4 row_shr:1 row_mask:0xf bank_mask:0xf bound_ctrl:0
    s_nop 1
    v_max_u32_dpp v4, v4, v4 row_shr:2 row_mask:0xf bank_mask:0xf bound_ctrl:0
    s_nop 1
    v_max_u32_dpp v4, v4, v4 row_shr:4 row_mask:0xf bank_mask:0xf bound_ctrl:0
    s_nop 1
    v_max_u32_dpp v4, v4, v4 row_shr:8 row_mask:0xf bank_mask:0xf bound_ctrl:0
    s_nop 1
    v_max_u32_dpp v4, v4, v4 row_bcast:15 row_mask:0xa bank_mask:0xf
    s_nop 1
    v_max_u32_dpp v4, v4, v4 row_bcast:31 row_mask:0xc bank_mask:0xf
    s_nop 0
    v_readlane_b32 s52, v4, 63
    s_nop 0
    s_add_u32 s53, s53, s52
    v_writelane_b32 v13, s53, 7
    v_cmp_lt_u32 vcc, s53, v50
    s_cbranch_vccz F_a2k
    s_mov_b32 s53, 0
    s_mov_b32 s52, 0
    s_mov_b32 s64, 0
F_a2f:
    v_subrev_u32 v16, s52, v16
    v_subrev_u32 v17, s52, v17
    v_subrev_u32 v18, s52, v18
    v_subrev_u32 v19, s52, v19
    v_subrev_u32 v20, s52, v20
    v_subrev_u32 v21, s52, v21
    v_subrev_u32 v22, s52, v22
    v_subrev_u32 v23, s52, v23
    v_subrev_u32 v24, s52, v24
    v_subrev_u32 v25, s52, v25
    v_subrev_u32 v26, s52, v26
    v_subrev_u32 v27, s52, v27
    v_subrev_u32 v28, s52, v28
    v_subrev_u32 v29, s52, v29
    v_subrev_u32 v30, s52, v30
    v_subrev_u32 v31, s52, v31
    v_subrev_u32 v32, s52, v32
    v_subrev_u32 v33, s52, v33
    v_subrev_u32 v34, s52, v34
    v_subrev_u32 v35, s52, v35
    v_subrev_u32 v36, s52, v36
    v_subrev_u32 v37, s52, v37
    v_subrev_u32 v38, s52, v38
    v_subrev_u32 v39, s52, v39
    v_subrev_u32 v40, s52, v40
    v_subrev_u32 v41, s52, v41
    v_subrev_u32 v42, s52, v42
    v_subrev_u32 v43, s52, v43
    v_subrev_u32 v44, s52, v44
    v_subrev_u32 v45, s52, v45
    v_subrev_u32 v46, s52, v46
    v_subrev_u32 v47, s52, v47
    v_max3_u32 v4, v16, v17, v18
    v_max3_u32 v12, v19, v20, v21
    v_max3_u32 v4, v4, v22, v23
    v_max3_u32 v12, v12, v24, v25
    v_max3_u32 v4, v4, v26, v27
    v_max3_u32 v12, v12, v28, v29
    v_max3_u32 v4, v4, v30, v31
    v_max3_u32 v12, v12, v32, v33
    v_max3_u32 v4, v4, v34, v35
    v_max3_u32 v12, v12, v36, v37
    v_max3_u32 v4, v4, v38, v39
    v_max3_u32 v12, v12, v40, v41
    v_max3_u32 v4, v4, v42, v43
    v_max3_u32 v12, v12, v44, v45
    v_max3_u32 v4, v4, v46, v47
    v_max_u32 v4, v4, v12
    s_nop 1
    v_max_u32_dpp v4, v4, v4 row_shr:1 row_mask:0xf bank_mask:0xf bound_ctrl:0
    s_nop 1
    v_max_u32_dpp v4, v4, v4 row_shr:2 row_mask:0xf bank_mask:0xf bound_ctrl:0
    s_nop 1
    v_max_u32_dpp v4, v4, v4 row_shr:4 row_mask:0xf bank_mask:0xf bound_ctrl:0
    s_nop 1
    v_max_u32_dpp v4, v4, v4 row_shr:8 row_mask:0xf bank_mask:0xf bound_ctrl:0
    s_nop 1
    v_max_u32_dpp v4, v4, v4 row_bcast:15 row_mask:0xa bank_mask:0xf
    s_nop 1
    v_max_u32_dpp v4, v4, v4 row_bcast:31 row_mask:0xc bank_mask:0xf
    s_nop 0
    v_readlane_b32 s52, v4, 63
    s_nop 0
    s_add_u32 s53, s53, s52
    s_mov_b32 m0, s64
    v_writelane_b32 v13, s53, m0
    s_cmp_ge_u32 s74, 17
    s_cbranch_scc1 DB_110
    s_barrier
    s_add_u32 s74, s74, 1
DB_110:
    s_add_u32 s64, s64, 1
    s_cmp_lt_u32 s64, 8
    s_cbranch_scc1 F_a2f
F_a2k:
    v_and_b32 v4, 7, v0
    v_lshlrev_b32 v4, 2, v4
    ds_bpermute_b32 v12, v4, v13
    v_lshrrev_b32 v9, 3, v0
    v_lshl_add_u32 v4, v9, 9, v4
    s_mov_b32 s44, 32896
    s_mov_b32 s45, 36992
    s_waitcnt lgkmcnt(0)
    v_or_b32 v12, 0x8000, v12
    buffer_store_dword v12, v4, s[40:43], s44 offen sc0 sc1
    buffer_store_dword v12, v4, s[40:43], s45 offen sc0 sc1

F_a2m:
    s_cmp_ge_u32 s74, 17
    s_cbranch_scc1 DB_111
    s_barrier
    s_add_u32 s74, s74, 1
DB_111:
    s_cmp_lt_u32 s74, 17
    s_cbranch_scc1 F_a2m
    s_add_u32 s91, s54, 0
    buffer_load_dwordx4 v[72:75], v6, s[16:19], s91 offen nt
    s_add_u32 s91, s54, 7168
    buffer_load_dwordx4 v[76:79], v6, s[16:19], s91 offen nt
    s_add_u32 s91, s54, 14336
    buffer_load_dwordx4 v[80:83], v6, s[16:19], s91 offen nt
    s_add_u32 s91, s54, 21504
    buffer_load_dwordx4 v[84:87], v6, s[16:19], s91 offen nt
    s_add_u32 s91, s54, 28672
    buffer_load_dwordx4 v[88:91], v6, s[16:19], s91 offen nt
    s_add_u32 s91, s54, 35840
    buffer_load_dwordx4 v[92:95], v6, s[16:19], s91 offen nt
    s_add_u32 s91, s54, 43008
    buffer_load_dwordx4 v[96:99], v6, s[16:19], s91 offen nt
    s_add_u32 s91, s54, 50176
    buffer_load_dwordx4 v[100:103], v6, s[16:19], s91 offen nt
    s_add_u32 s91, s54, 229376
    buffer_load_dwordx4 v[104:107], v6, s[16:19], s91 offen nt
    s_add_u32 s91, s54, 236544
    buffer_load_dwordx4 v[108:111], v6, s[16:19], s91 offen nt
    s_add_u32 s91, s54, 243712
    buffer_load_dwordx4 v[112:115], v6, s[16:19], s91 offen nt
    s_add_u32 s91, s54, 250880
    buffer_load_dwordx4 v[116:119], v6, s[16:19], s91 offen nt
    s_add_u32 s91, s54, 258048
    buffer_load_dwordx4 v[120:123], v6, s[16:19], s91 offen nt
    s_add_u32 s91, s54, 265216
    buffer_load_dwordx4 v[124:127], v6, s[16:19], s91 offen nt
    s_add_u32 s91, s54, 272384
    buffer_load_dwordx4 v[128:131], v6, s[16:19], s91 offen nt
    s_add_u32 s91, s54, 279552
    buffer_load_dwordx4 v[132:135], v6, s[16:19], s91 offen nt
    s_branch F_aj2
IW_w10:
    s_branch IW_r10
F_a2n:
    s_barrier
    s_cmp_lg_u32 s53, 0
    s_cbranch_scc1 SW_112
    s_call_b64 s[34:35], F_sw0
SW_112:
    s_branch IW_w11
IW_r11:
    s_barrier
    s_cmp_lg_u32 s53, 1
    s_cbranch_scc1 SW_113
    s_call_b64 s[34:35], F_sw0
SW_113:
    s_nop 0
    s_barrier
    s_cmp_lg_u32 s53, 2
    s_cbranch_scc1 SW_114
    s_call_b64 s[34:35], F_sw0
SW_114:
    s_nop 0
    s_barrier
    s_cmp_lg_u32 s53, 3
    s_cbranch_scc1 SW_115
    s_call_b64 s[34:35], F_sw0
SW_115:
    s_nop 0
    s_barrier
    s_nop 0
    s_barrier
    s_nop 0
    s_barrier
    s_add_u32 s91, s54, 229376
    buffer_load_dwordx4 v[104:107], v6, s[16:19], s91 offen nt
    s_add_u32 s91, s54, 236544
    buffer_load_dwordx4 v[108:111], v6, s[16:19], s91 offen nt
    s_add_u32 s91, s54, 243712
    buffer_load_dwordx4 v[112:115], v6, s[16:19], s91 offen nt
    s_add_u32 s91, s54, 250880
    buffer_load_dwordx4 v[116:119], v6, s[16:19], s91 offen nt
    s_nop 0
    s_load_dwordx8 s[60:67], s[56:57], 128 glc
    s_barrier
    s_add_u32 s91, s54, 258048
    buffer_load_dwordx4 v[120:123], v6, s[16:19], s91 offen nt
    s_add_u32 s91, s54, 265216
    buffer_load_dwordx4 v[124:127], v6, s[16:19], s91 offen nt
    s_add_u32 s91, s54, 272384
    buffer_load_dwordx4 v[128:131], v6, s[16:19], s91 offen nt
    s_add_u32 s91, s54, 279552
    buffer_load_dwordx4 v[132:135], v6, s[16:19], s91 offen nt
    s_waitcnt lgkmcnt(0)
    s_and_b64 s[44:45], s[60:61], s[62:63]
    s_and_b64 s[44:45], s[44:45], s[64:65]
    s_and_b64 s[44:45], s[44:45], s[66:67]
    s_and_b32 s44, s44, s45
    s_bitcmp1_b32 s44, 15
    s_cbranch_scc0 F_a2q
    s_andn2_b32 s60, s60, 0x8000
    v_writelane_b32 v12, s60, 0
    s_andn2_b32 s61, s61, 0x8000
    v_writelane_b32 v12, s61, 1
    s_andn2_b32 s62, s62, 0x8000
    v_writelane_b32 v12, s62, 2
    s_andn2_b32 s63, s63, 0x8000
    v_writelane_b32 v12, s63, 3
    s_andn2_b32 s64, s64, 0x8000
    v_writelane_b32 v12, s64, 4
    s_andn2_b32 s65, s65, 0x8000
    v_writelane_b32 v12, s65, 5
    s_andn2_b32 s66, s66, 0x8000
    v_writelane_b32 v12, s66, 6
    s_andn2_b32 s67, s67, 0x8000
    v_writelane_b32 v12, s67, 7
    v_add_u32 v4, 158976, v3
    s_mov_b64 exec, 0xff
    ds_write_b32 v4, v12
    s_mov_b64 exec, -1
    v_mov_b32 v4, 1
    s_mov_b64 exec, 1
    ds_write_b32 v10, v4 offset:48
    s_mov_b64 exec, -1
    s_waitcnt lgkmcnt(0)
    s_mov_b32 s88, 1
    s_branch F_a2r
F_a2q:
    s_load_dwordx8 s[60:67], s[56:57], 128 glc
F_a2r:
    s_barrier
    s_cmp_lg_u32 s88, 2
    s_cbranch_scc1 F_aj
    s_waitcnt lgkmcnt(0)
    s_and_b64 s[44:45], s[60:61], s[62:63]
    s_and_b64 s[44:45], s[44:45], s[64:65]
    s_and_b64 s[44:45], s[44:45], s[66:67]
    s_and_b32 s44, s44, s45
    s_bitcmp1_b32 s44, 15
    s_cbranch_scc0 F_a2s
    s_andn2_b32 s60, s60, 0x8000
    v_writelane_b32 v12, s60, 0
    s_andn2_b32 s61, s61, 0x8000
    v_writelane_b32 v12, s61, 1
    s_andn2_b32 s62, s62, 0x8000
    v_writelane_b32 v12, s62, 2
    s_andn2_b32 s63, s63, 0x8000
    v_writelane_b32 v12, s63, 3
    s_andn2_b32 s64, s64, 0x8000
    v_writelane_b32 v12, s64, 4
    s_andn2_b32 s65, s65, 0x8000
    v_writelane_b32 v12, s65, 5
    s_andn2_b32 s66, s66, 0x8000
    v_writelane_b32 v12, s66, 6
    s_andn2_b32 s67, s67, 0x8000
    v_writelane_b32 v12, s67, 7
    v_add_u32 v4, 158976, v3
    s_mov_b64 exec, 0xff
    ds_write_b32 v4, v12
    s_mov_b64 exec, -1
    v_mov_b32 v4, 1
    s_mov_b64 exec, 1
    ds_write_b32 v10, v4 offset:48
    s_mov_b64 exec, -1
    s_mov_b32 s88, 1
F_a2s:
    v_mov_b32 v4, 1
    s_mov_b64 exec, 1
    ds_write_b32 v10, v4 offset:176
    s_mov_b64 exec, -1
F_aj:
    s_mov_b32 s74, 0
F_aj2:
    v_and_b32 v13, 3, v0
    v_lshlrev_b32 v13, 2, v13
    v_add_u32 v13, 159040, v13

    s_cmp_lt_u32 s3, 2
    s_mov_b32 s75, 65536
    s_cselect_b32 s75, 32768, s75
    s_and_b32 s44, s3, 1
    s_lshl_b32 s44, s44, 12
    s_add_u32 s75, s75, s44
    s_add_u32 s12, s72, 0x900000
    s_addc_u32 s13, s73, 0
    s_mov_b32 s14, 0xe0000
    s_mov_b32 s15, 0x00020000
    s_mov_b32 s47, s10
    v_mov_b32 v4, 159096
    ds_read_b32 v9, v4
    s_waitcnt lgkmcnt(0)
    v_readfirstlane_b32 s79, v9
    s_nop 0
    s_cmp_lg_u32 s79, 0
    s_cbranch_scc1 F_xf
    s_cmp_eq_u32 s2, 248
    s_cbranch_scc1 F_xe
    ds_read_b32 v9, v4 offset:128
FW_116:
    s_waitcnt lgkmcnt(0)
    v_cmp_gt_u32 vcc, 1, v9
    s_cbranch_vccz FO_117
    ds_read_b32 v9, v4 offset:128
    s_branch FW_116
FO_117:
    ds_read_b32 v9, v4
    s_waitcnt lgkmcnt(0)
    v_readfirstlane_b32 s79, v9
    s_nop 0
    s_cmp_eq_u32 s79, 0
    s_cbranch_scc1 F_xe
F_xf:
    v_and_b32 v4, 7, v0
    v_lshlrev_b32 v4, 2, v4
    v_add_u32 v4, 158976, v4
    ds_read_b32 v4, v4
    s_waitcnt lgkmcnt(0)
    v_and_b32 v4, 0x7ff, v4
    v_sub_u32 v4, 2047, v4
    v_and_b32 v11, 7, v4
    v_lshrrev_b32 v9, 3, v4
    v_lshlrev_b32 v9, 7, v9
    v_lshl_add_u32 v9, v11, 3, v9
    v_lshlrev_b32 v4, 11, v4
    v_lshl_add_u32 v4, v5, 4, v4
    buffer_load_dwordx4 v[64:67], v4, s[20:23], s55 offen
    buffer_load_dwordx4 v[68:71], v4, s[20:23], s55 offen offset:64
    buffer_load_dwordx2 v[14:15], v9, s[40:43], 0 offen sc0 sc1

F_xe:
    s_cmp_lg_u32 s74, 0
    s_cbranch_scc1 JB_118
    s_barrier
JB_118:
    s_cmp_lg_u32 s88, 3
    s_cbranch_scc1 F_g4
SP_119:
    s_load_dword s76, s[56:57], 0 glc
    s_waitcnt lgkmcnt(0)
    s_cmp_ge_u32 s76, 1000
    s_cbranch_scc1 SD_120
    s_sleep 3
    s_branch SP_119
SD_120:
    v_mov_b32 v4, 1
    s_mov_b64 exec, 1
    ds_write_b32 v10, v4 offset:48
    s_mov_b64 exec, -1
F_g4:
    s_setprio 1
    s_cmp_lg_u32 s79, 0
    s_cbranch_scc1 F_xd
    s_cmp_lg_u32 s88, 2
    s_cbranch_scc1 F_se
F_sc:
    s_load_dwordx8 s[60:67], s[56:57], 128 glc
    s_waitcnt lgkmcnt(0)
    s_and_b64 s[44:45], s[60:61], s[62:63]
    s_and_b64 s[44:45], s[44:45], s[64:65]
    s_and_b64 s[44:45], s[44:45], s[66:67]
    s_and_b32 s44, s44, s45
    s_bitcmp1_b32 s44, 15
    s_cbranch_scc1 F_sd
    s_sleep 4
    s_branch F_sc
F_sd:
    s_andn2_b32 s60, s60, 0x8000
    v_writelane_b32 v12, s60, 0
    s_andn2_b32 s61, s61, 0x8000
    v_writelane_b32 v12, s61, 1
    s_andn2_b32 s62, s62, 0x8000
    v_writelane_b32 v12, s62, 2
    s_andn2_b32 s63, s63, 0x8000
    v_writelane_b32 v12, s63, 3
    s_andn2_b32 s64, s64, 0x8000
    v_writelane_b32 v12, s64, 4
    s_andn2_b32 s65, s65, 0x8000
    v_writelane_b32 v12, s65, 5
    s_andn2_b32 s66, s66, 0x8000
    v_writelane_b32 v12, s66, 6
    s_andn2_b32 s67, s67, 0x8000
    v_writelane_b32 v12, s67, 7
    v_add_u32 v4, 158976, v3
    s_mov_b64 exec, 0xff
    ds_write_b32 v4, v12
    s_mov_b64 exec, -1
    v_mov_b32 v4, 1
    s_mov_b64 exec, 1
    ds_write_b32 v10, v4 offset:48
    s_mov_b64 exec, -1
F_se:
    v_mov_b32 v4, 159096
    ds_read_b32 v9, v4 offset:0
FW_121:
    s_waitcnt lgkmcnt(0)
    v_cmp_gt_u32 vcc, 1, v9
    s_cbranch_vccz FO_122
    s_sleep 1
    ds_read_b32 v9, v4 offset:0
    s_branch FW_121
FO_122:
    v_and_b32 v4, 7, v0
    v_lshlrev_b32 v4, 2, v4
    v_add_u32 v4, 158976, v4
    ds_read_b32 v4, v4
    s_waitcnt lgkmcnt(0)
    v_and_b32 v4, 0x7ff, v4
    v_sub_u32 v4, 2047, v4
    v_and_b32 v11, 7, v4
    v_lshrrev_b32 v9, 3, v4
    v_lshlrev_b32 v9, 7, v9
    v_lshl_add_u32 v9, v11, 3, v9
    v_lshlrev_b32 v4, 11, v4
    v_lshl_add_u32 v4, v5, 4, v4
    buffer_load_dwordx4 v[64:67], v4, s[20:23], s55 offen
    buffer_load_dwordx4 v[68:71], v4, s[20:23], s55 offen offset:64
    buffer_load_dwordx2 v[14:15], v9, s[40:43], 0 offen sc0 sc1

F_xd:
    s_mov_b32 s52, 0x05040100
    s_mov_b32 s53, 0x07060302
    s_setprio 1
    s_cmp_ge_u32 s89, 224
    s_cbranch_scc1 F_adown
    s_waitcnt vmcnt(11)
    v_perm_b32 v16, v76, v72, s52
    v_perm_b32 v17, v84, v80, s52
    v_perm_b32 v18, v92, v88, s52
    v_perm_b32 v19, v100, v96, s52
    v_perm_b32 v20, v76, v72, s53
    v_perm_b32 v21, v84, v80, s53
    v_perm_b32 v22, v92, v88, s53
    v_perm_b32 v23, v100, v96, s53
    v_perm_b32 v24, v77, v73, s52
    v_perm_b32 v25, v85, v81, s52
    v_perm_b32 v26, v93, v89, s52
    v_perm_b32 v27, v101, v97, s52
    v_perm_b32 v28, v77, v73, s53
    v_perm_b32 v29, v85, v81, s53
    v_perm_b32 v30, v93, v89, s53
    v_perm_b32 v31, v101, v97, s53
    v_perm_b32 v144, v78, v74, s52
    v_perm_b32 v145, v86, v82, s52
    v_perm_b32 v146, v94, v90, s52
    v_perm_b32 v147, v102, v98, s52
    v_perm_b32 v148, v78, v74, s53
    v_perm_b32 v149, v86, v82, s53
    v_perm_b32 v150, v94, v90, s53
    v_perm_b32 v151, v102, v98, s53
    v_perm_b32 v152, v79, v75, s52
    v_perm_b32 v153, v87, v83, s52
    v_perm_b32 v154, v95, v91, s52
    v_perm_b32 v155, v103, v99, s52
    v_perm_b32 v156, v79, v75, s53
    v_perm_b32 v157, v87, v83, s53
    v_perm_b32 v158, v95, v91, s53
    v_perm_b32 v159, v103, v99, s53
    s_and_b32 s44, s3, 1
    s_lshl_b32 s44, s44, 12
    s_add_u32 s44, s44, 65536

    v_and_b32 v8, 1, v5
    v_lshrrev_b32 v9, 1, v5
    v_lshl_add_u32 v4, v9, 3, v8
    v_lshlrev_b32 v9, 8, v4
    v_xor_b32 v4, v7, v4
    v_lshl_add_u32 v4, v4, 4, v9
    v_add_u32 v136, s44, v4
    v_xor_b32 v137, 32, v136
    v_xor_b32 v138, 64, v136
    v_xor_b32 v139, 96, v136
    v_add_u32 v8, 8, v10
    s_lshl_b32 s44, s3, 2
    v_add_u32 v140, s44, v5
    v_xor_b32 v140, v140, v7
    v_lshlrev_b32 v140, 4, v140
    v_lshl_add_u32 v140, v7, 8, v140
    v_add_u32 v140, 65536, v140
    s_lshl_b32 s44, s3, 10
    s_lshl_b32 s77, s36, 1
    s_add_u32 s77, s77, s37
    s_mul_i32 s77, s77, 114688
    s_lshl_b32 s46, s38, 12
    s_add_u32 s77, s77, s46
    s_add_u32 s77, s77, s44
    s_lshl_b32 s46, s38, 9
    v_mov_b32 v9, 159148
    v_mov_b32 v11, 1
    v_and_b32 v141, 0xfffffff7, v13

    s_add_u32 s56, s46, 0x829000
    s_add_u32 s56, s72, s56
    s_addc_u32 s57, s73, 0
    s_waitcnt vmcnt(3)
    v_perm_b32 v72, v108, v104, s52
    v_perm_b32 v73, v116, v112, s52
    v_perm_b32 v74, v124, v120, s52
    v_perm_b32 v75, v132, v128, s52
    v_perm_b32 v76, v108, v104, s53
    v_perm_b32 v77, v116, v112, s53
    v_perm_b32 v78, v124, v120, s53
    v_perm_b32 v79, v132, v128, s53
    v_perm_b32 v80, v109, v105, s52
    v_perm_b32 v81, v117, v113, s52
    v_perm_b32 v82, v125, v121, s52
    v_perm_b32 v83, v133, v129, s52
    v_perm_b32 v84, v109, v105, s53
    v_perm_b32 v85, v117, v113, s53
    v_perm_b32 v86, v125, v121, s53
    v_perm_b32 v87, v133, v129, s53
    v_perm_b32 v88, v110, v106, s52
    v_perm_b32 v89, v118, v114, s52
    v_perm_b32 v90, v126, v122, s52
    v_perm_b32 v91, v134, v130, s52
    v_perm_b32 v92, v110, v106, s53
    v_perm_b32 v93, v118, v114, s53
    v_perm_b32 v94, v126, v122, s53
    v_perm_b32 v95, v134, v130, s53
    v_perm_b32 v96, v111, v107, s52
    v_perm_b32 v97, v119, v115, s52
    v_perm_b32 v98, v127, v123, s52
    v_perm_b32 v99, v135, v131, s52
    v_perm_b32 v100, v111, v107, s53
    v_perm_b32 v101, v119, v115, s53
    v_perm_b32 v102, v127, v123, s53
    v_perm_b32 v103, v135, v131, s53
    s_waitcnt vmcnt(0)
    s_setprio 1
    v_lshlrev_b32 v34, 16, v64
    v_and_b32 v35, 0xffff0000, v64
    v_lshlrev_b32 v36, 16, v65
    v_and_b32 v37, 0xffff0000, v65
    v_lshlrev_b32 v38, 16, v66
    v_and_b32 v39, 0xffff0000, v66
    v_lshlrev_b32 v40, 16, v67
    v_and_b32 v41, 0xffff0000, v67
    v_lshlrev_b32 v42, 16, v68
    v_and_b32 v43, 0xffff0000, v68
    v_lshlrev_b32 v44, 16, v69
    v_and_b32 v45, 0xffff0000, v69
    v_lshlrev_b32 v46, 16, v70
    v_and_b32 v47, 0xffff0000, v70
    v_lshlrev_b32 v48, 16, v71
    v_and_b32 v49, 0xffff0000, v71
    v_add_f32 v34, v34, v14
    v_add_f32 v35, v35, v14
    v_add_f32 v36, v36, v14
    v_add_f32 v37, v37, v14
    v_add_f32 v38, v38, v14
    v_add_f32 v39, v39, v14
    v_add_f32 v40, v40, v14
    v_add_f32 v41, v41, v14
    v_add_f32 v42, v42, v14
    v_add_f32 v43, v43, v14
    v_add_f32 v44, v44, v14
    v_add_f32 v45, v45, v14
    v_add_f32 v46, v46, v14
    v_add_f32 v47, v47, v14
    v_add_f32 v48, v48, v14
    v_add_f32 v49, v49, v14
    v_cvt_pk_bf16_f32 v64, v34, v35
    v_cvt_pk_bf16_f32 v65, v36, v37
    v_cvt_pk_bf16_f32 v66, v38, v39
    v_cvt_pk_bf16_f32 v67, v40, v41
    v_cvt_pk_bf16_f32 v68, v42, v43
    v_cvt_pk_bf16_f32 v69, v44, v45
    v_cvt_pk_bf16_f32 v70, v46, v47
    v_cvt_pk_bf16_f32 v71, v48, v49
    v_lshlrev_b32 v34, 16, v64
    v_and_b32 v35, 0xffff0000, v64
    v_lshlrev_b32 v36, 16, v65
    v_and_b32 v37, 0xffff0000, v65
    v_lshlrev_b32 v38, 16, v66
    v_and_b32 v39, 0xffff0000, v66
    v_lshlrev_b32 v40, 16, v67
    v_and_b32 v41, 0xffff0000, v67
    v_lshlrev_b32 v42, 16, v68
    v_and_b32 v43, 0xffff0000, v68
    v_lshlrev_b32 v44, 16, v69
    v_and_b32 v45, 0xffff0000, v69
    v_lshlrev_b32 v46, 16, v70
    v_and_b32 v47, 0xffff0000, v70
    v_lshlrev_b32 v48, 16, v71
    v_and_b32 v49, 0xffff0000, v71
    v_mul_f32 v34, v34, v15
    v_mul_f32 v35, v35, v15
    v_mul_f32 v36, v36, v15
    v_mul_f32 v37, v37, v15
    v_mul_f32 v38, v38, v15
    v_mul_f32 v39, v39, v15
    v_mul_f32 v40, v40, v15
    v_mul_f32 v41, v41, v15
    v_mul_f32 v42, v42, v15
    v_mul_f32 v43, v43, v15
    v_mul_f32 v44, v44, v15
    v_mul_f32 v45, v45, v15
    v_mul_f32 v46, v46, v15
    v_mul_f32 v47, v47, v15
    v_mul_f32 v48, v48, v15
    v_mul_f32 v49, v49, v15
    v_cvt_pk_bf16_f32 v64, v34, v35
    v_cvt_pk_bf16_f32 v65, v36, v37
    v_cvt_pk_bf16_f32 v66, v38, v39
    v_cvt_pk_bf16_f32 v67, v40, v41
    v_cvt_pk_bf16_f32 v68, v42, v43
    v_cvt_pk_bf16_f32 v69, v44, v45
    v_cvt_pk_bf16_f32 v70, v46, v47
    v_cvt_pk_bf16_f32 v71, v48, v49
    v_cmp_gt_u32 vcc, 32, v0
    v_mfma_f32_16x16x32_bf16 v[32:35], v[64:67], v[16:19], 0
    v_mfma_f32_16x16x32_bf16 v[48:51], v[64:67], v[144:147], 0
    v_mfma_f32_16x16x32_bf16 v[36:39], v[64:67], v[20:23], 0
    v_mfma_f32_16x16x32_bf16 v[52:55], v[64:67], v[148:151], 0
    v_mfma_f32_16x16x32_bf16 v[40:43], v[64:67], v[24:27], 0
    v_mfma_f32_16x16x32_bf16 v[56:59], v[64:67], v[152:155], 0
    v_mfma_f32_16x16x32_bf16 v[44:47], v[64:67], v[28:31], 0
    v_mfma_f32_16x16x32_bf16 v[60:63], v[64:67], v[156:159], 0
    v_mfma_f32_16x16x32_bf16 v[32:35], v[68:71], v[72:75], v[32:35]
    v_mfma_f32_16x16x32_bf16 v[48:51], v[68:71], v[88:91], v[48:51]
    v_mfma_f32_16x16x32_bf16 v[36:39], v[68:71], v[76:79], v[36:39]
    v_mfma_f32_16x16x32_bf16 v[52:55], v[68:71], v[92:95], v[52:55]
    v_mfma_f32_16x16x32_bf16 v[40:43], v[68:71], v[80:83], v[40:43]
    v_mfma_f32_16x16x32_bf16 v[56:59], v[68:71], v[96:99], v[56:59]
    v_mfma_f32_16x16x32_bf16 v[44:47], v[68:71], v[84:87], v[44:47]
    v_mfma_f32_16x16x32_bf16 v[60:63], v[68:71], v[100:103], v[60:63]
    s_nop 1
    v_cndmask_b32 v32, v48, v32, vcc
    v_cndmask_b32 v33, v49, v33, vcc
    v_cndmask_b32 v34, v50, v34, vcc
    v_cndmask_b32 v35, v51, v35, vcc
    v_cndmask_b32 v36, v52, v36, vcc
    v_cndmask_b32 v37, v53, v37, vcc
    v_cndmask_b32 v38, v54, v38, vcc
    v_cndmask_b32 v39, v55, v39, vcc
    v_cndmask_b32 v40, v56, v40, vcc
    v_cndmask_b32 v41, v57, v41, vcc
    v_cndmask_b32 v42, v58, v42, vcc
    v_cndmask_b32 v43, v59, v43, vcc
    v_cndmask_b32 v44, v60, v44, vcc
    v_cndmask_b32 v45, v61, v45, vcc
    v_cndmask_b32 v46, v62, v46, vcc
    v_cndmask_b32 v47, v63, v47, vcc
    s_setprio 3
    ds_read_b32 v12, v13 offset:32
FW_123:
    s_waitcnt lgkmcnt(0)
    v_cmp_gt_u32 vcc, 2, v12
    s_cbranch_vccz FO_124
    s_sleep 1
    ds_read_b32 v12, v13 offset:32
    s_branch FW_123
FO_124:
    s_cmp_lt_u32 s3, 2
    s_cbranch_scc1 F_t1
    ds_write_b128 v136, v[32:35] offset:0
    ds_write_b128 v137, v[36:39] offset:512
    ds_write_b128 v138, v[40:43] offset:1024
    ds_write_b128 v139, v[44:47] offset:1536
    s_mov_b64 exec, 1
    s_branch IW_s11
IW_w11:
    s_branch IW_r11
IW_s11:
    ds_write_b32 v10, v11 offset:64
    s_mov_b64 exec, -1
    s_add_u32 s45, s78, 0
    buffer_load_dwordx4 v[16:19], v160, s[80:83], s45 offen nt
    s_add_u32 s45, s78, 2048
    buffer_load_dwordx4 v[20:23], v160, s[80:83], s45 offen nt
    s_add_u32 s45, s78, 4096
    buffer_load_dwordx4 v[24:27], v160, s[80:83], s45 offen nt
    s_add_u32 s45, s78, 6144
    buffer_load_dwordx4 v[28:31], v160, s[80:83], s45 offen nt
    s_add_u32 s45, s78, 8192
    buffer_load_dwordx4 v[144:147], v160, s[80:83], s45 offen nt
    s_add_u32 s45, s78, 10240
    buffer_load_dwordx4 v[148:151], v160, s[80:83], s45 offen nt
    s_add_u32 s45, s78, 12288
    buffer_load_dwordx4 v[152:155], v160, s[80:83], s45 offen nt
    s_branch F_t2
F_t1:
    s_add_u32 s45, s78, 0
    buffer_load_dwordx4 v[16:19], v160, s[80:83], s45 offen nt
    s_add_u32 s45, s78, 2048
    buffer_load_dwordx4 v[20:23], v160, s[80:83], s45 offen nt
    s_add_u32 s45, s78, 4096
    buffer_load_dwordx4 v[24:27], v160, s[80:83], s45 offen nt
    s_add_u32 s45, s78, 6144
    buffer_load_dwordx4 v[28:31], v160, s[80:83], s45 offen nt
    s_add_u32 s45, s78, 8192
    buffer_load_dwordx4 v[144:147], v160, s[80:83], s45 offen nt
    s_add_u32 s45, s78, 10240
    buffer_load_dwordx4 v[148:151], v160, s[80:83], s45 offen nt
    s_add_u32 s45, s78, 12288
    buffer_load_dwordx4 v[152:155], v160, s[80:83], s45 offen nt
F_t3:
    ds_read_b32 v12, v8 offset:64
    ds_read_b128 v[80:83], v136 offset:0
    ds_read_b128 v[84:87], v137 offset:512
    ds_read_b128 v[88:91], v138 offset:1024
    ds_read_b128 v[92:95], v139 offset:1536
    s_waitcnt lgkmcnt(0)
    v_cmp_eq_u32 vcc, 0, v12
    s_cbranch_vccnz F_t3
    v_add_f32 v32, v32, v80
    v_add_f32 v33, v33, v81
    v_add_f32 v34, v34, v82
    v_add_f32 v35, v35, v83
    v_add_f32 v36, v36, v84
    v_add_f32 v37, v37, v85
    v_add_f32 v38, v38, v86
    v_add_f32 v39, v39, v87
    v_add_f32 v40, v40, v88
    v_add_f32 v41, v41, v89
    v_add_f32 v42, v42, v90
    v_add_f32 v43, v43, v91
    v_add_f32 v44, v44, v92
    v_add_f32 v45, v45, v93
    v_add_f32 v46, v46, v94
    v_add_f32 v47, v47, v95
    ds_write_b128 v136, v[32:35] offset:0
    ds_write_b128 v137, v[36:39] offset:512
    ds_write_b128 v138, v[40:43] offset:1024
    ds_write_b128 v139, v[44:47] offset:1536
    s_mov_b64 exec, 1
    ds_write_b32 v10, v11 offset:64
    s_mov_b64 exec, -1
F_t2:
F_t4:
    ds_read_b32 v12, v141 offset:64
    ds_read_b128 v[80:83], v140
    ds_read_b128 v[84:87], v140 offset:4096
    s_waitcnt lgkmcnt(0)
    v_cmp_eq_u32 vcc, 0, v12
    s_cbranch_vccnz F_t4
    v_add_f32 v72, v80, v84
    v_add_f32 v73, v81, v85
    v_add_f32 v74, v82, v86
    v_add_f32 v75, v83, v87
    buffer_store_dwordx4 v[72:75], v2, s[12:15], s77 offen sc0 sc1
    v_mov_b32 v4, 2
    s_mov_b64 exec, 1
    ds_write_b32 v10, v4 offset:64
    s_mov_b64 exec, -1
    s_waitcnt vmcnt(0)
    s_mov_b64 exec, 1
    ds_add_rtn_u32 v9, v9, v11
    s_waitcnt lgkmcnt(0)
    v_readfirstlane_b32 s44, v9
    s_mov_b64 exec, -1
    s_cmp_lg_u32 s44, 3
    s_cbranch_scc1 F_ad2

    s_mov_b32 s74, 1
    s_atomic_add s74, s[56:57], 0x0
    s_atomic_add s74, s[56:57], 0x80
    s_atomic_add s74, s[56:57], 0x100
    s_atomic_add s74, s[56:57], 0x180
    s_branch F_ad2
F_adown:
    s_add_u32 s45, s78, 0
    buffer_load_dwordx4 v[16:19], v160, s[80:83], s45 offen nt
    s_add_u32 s45, s78, 2048
    buffer_load_dwordx4 v[20:23], v160, s[80:83], s45 offen nt
    s_add_u32 s45, s78, 4096
    buffer_load_dwordx4 v[24:27], v160, s[80:83], s45 offen nt
    s_add_u32 s45, s78, 6144
    buffer_load_dwordx4 v[28:31], v160, s[80:83], s45 offen nt
    s_add_u32 s45, s78, 8192
    buffer_load_dwordx4 v[144:147], v160, s[80:83], s45 offen nt
    s_add_u32 s45, s78, 10240
    buffer_load_dwordx4 v[148:151], v160, s[80:83], s45 offen nt
    s_add_u32 s45, s78, 12288
    buffer_load_dwordx4 v[152:155], v160, s[80:83], s45 offen nt
    v_mov_b32 v4, 2
    s_mov_b64 exec, 1
    ds_write_b32 v10, v4 offset:64
    s_mov_b64 exec, -1
F_ad2:
    v_min_u32 v4, 55, v0
    v_lshlrev_b32 v4, 4, v4
    s_lshl_b32 s38, s47, 5
    s_and_b32 s46, s39, 3
    s_lshr_b32 s44, s47, 7
    s_lshl_b32 s44, s44, 2
    s_add_u32 s44, s44, s46
    s_lshl_b32 s44, s44, 7
    s_add_u32 s45, s47, 111
    s_lshr_b32 s45, s45, 7
    s_lshl_b32 s45, s45, 2
    s_add_u32 s45, s45, s46
    s_lshl_b32 s45, s45, 7
    s_waitcnt lgkmcnt(0)

    s_add_u32 s56, s44, 0x829000
    s_add_u32 s56, s72, s56
    s_addc_u32 s57, s73, 0
    s_add_u32 s58, s45, 0x829000
    s_add_u32 s58, s72, s58
    s_addc_u32 s59, s73, 0
    v_mov_b32 v156, 0
    v_mov_b32 v157, 0
    v_mov_b32 v158, 0
    v_mov_b32 v159, 0
    s_mov_b32 s48, 0xbfb8aa3b
    ds_read_b32 v12, v13 offset:0
FW_125:
    s_waitcnt lgkmcnt(0)
    v_cmp_gt_u32 vcc, 4, v12
    s_cbranch_vccz FO_126
    s_sleep 1
    ds_read_b32 v12, v13 offset:0
    s_branch FW_125
FO_126:
    ds_read_b32 v12, v13 offset:64
FW_127:
    s_waitcnt lgkmcnt(0)
    v_cmp_gt_u32 vcc, 2, v12
    s_cbranch_vccz FO_128
    s_sleep 1
    ds_read_b32 v12, v13 offset:64
    s_branch FW_127
FO_128:
    ds_read_b32 v12, v13 offset:32
FW_129:
    s_waitcnt lgkmcnt(0)
    v_cmp_gt_u32 vcc, 2, v12
    s_cbranch_vccz FO_130
    s_sleep 1
    ds_read_b32 v12, v13 offset:32
    s_branch FW_129
FO_130:
    s_mov_b32 s44, s75
    v_lshlrev_b32 v9, 3, v0
    v_add_u32 v9, s44, v9
    ds_write_b64 v9, v[156:157]
    v_lshrrev_b32 v11, 1, v0
    v_mul_u32_u24 v9, 37, v11
    v_lshrrev_b32 v9, 8, v9
    v_add_u32 v11, v11, v9
    v_lshlrev_b32 v11, 1, v11
    v_and_b32 v9, 1, v0
    v_lshl_add_u32 v11, v9, 8, v11
    v_add_u32 v11, s44, v11
    v_and_b32 v9, 7, v0
    v_lshlrev_b32 v9, 6, v9
    v_lshl_add_u32 v9, v5, 4, v9
    v_add_u32 v9, s44, v9

    s_setprio 1
    s_waitcnt vmcnt(0)
    v_perm_b32 v72, v20, v16, s52
    v_perm_b32 v73, v28, v24, s52
    v_perm_b32 v74, v148, v144, s52
    v_perm_b32 v75, v156, v152, s52
    v_perm_b32 v76, v20, v16, s53
    v_perm_b32 v77, v28, v24, s53
    v_perm_b32 v78, v148, v144, s53
    v_perm_b32 v79, v156, v152, s53
    v_perm_b32 v80, v21, v17, s52
    v_perm_b32 v81, v29, v25, s52
    v_perm_b32 v82, v149, v145, s52
    v_perm_b32 v83, v157, v153, s52
    v_perm_b32 v84, v21, v17, s53
    v_perm_b32 v85, v29, v25, s53
    v_perm_b32 v86, v149, v145, s53
    v_perm_b32 v87, v157, v153, s53
    v_perm_b32 v88, v22, v18, s52
    v_perm_b32 v89, v30, v26, s52
    v_perm_b32 v90, v150, v146, s52
    v_perm_b32 v91, v158, v154, s52
    v_perm_b32 v92, v22, v18, s53
    v_perm_b32 v93, v30, v26, s53
    v_perm_b32 v94, v150, v146, s53
    v_perm_b32 v95, v158, v154, s53
    v_perm_b32 v96, v23, v19, s52
    v_perm_b32 v97, v31, v27, s52
    v_perm_b32 v98, v151, v147, s52
    v_perm_b32 v99, v159, v155, s52
    v_perm_b32 v100, v23, v19, s53
    v_perm_b32 v101, v31, v27, s53
    v_perm_b32 v102, v151, v147, s53
    v_perm_b32 v103, v159, v155, s53
    v_and_b32 v16, 1, v5
    v_lshlrev_b32 v16, 11, v16
    v_lshl_add_u32 v16, v7, 5, v16
    v_lshrrev_b32 v8, 1, v5
    v_lshl_add_u32 v16, v8, 4, v16
    v_add_u32 v16, s75, v16
    s_lshl_b32 s44, s3, 10
    s_add_u32 s44, s44, 32768
    v_add_u32 v17, s44, v3
    v_add_u32 v18, 32768, v17
    v_mov_b32 v19, 1
    s_lshl_b32 s60, s3, 13
    s_lshl_b32 s45, s39, 9
    s_add_u32 s60, s60, s45
    s_add_u32 s60, s60, 135168
    s_add_u32 s61, s60, 4096

    s_add_u32 s62, s45, 0x845000
    s_add_u32 s62, s72, s62
    s_addc_u32 s63, s73, 0
    s_setprio 3
    s_cmp_lg_u32 s3, 0
    s_cbranch_scc1 F_pp
F_p1:
    s_load_dword s76, s[56:57], 0 glc
    s_load_dword s77, s[58:59], 0 glc
    s_waitcnt lgkmcnt(0)
    s_min_u32 s76, s76, s77
    s_cmp_ge_u32 s76, 8
    s_cbranch_scc1 F_p2
    s_sleep 2
    s_branch F_p1
F_p2:
    v_mov_b32 v12, 3
    s_mov_b64 exec, 1
    ds_write_b32 v10, v12 offset:64
    s_mov_b64 exec, -1
F_pp:
    v_mov_b32 v8, 159104
    ds_read_b32 v12, v8 offset:0
FW_131:
    s_waitcnt lgkmcnt(0)
    v_cmp_gt_u32 vcc, 3, v12
    s_cbranch_vccz FO_132
    s_sleep 1
    ds_read_b32 v12, v8 offset:0
    s_branch FW_131
FO_132:
    s_add_u32 s45, s38, 0
    buffer_load_dwordx4 v[32:35], v4, s[12:15], s45 offen sc0 sc1
    s_add_u32 s45, s38, 114688
    buffer_load_dwordx4 v[36:39], v4, s[12:15], s45 offen sc0 sc1
    s_add_u32 s45, s38, 229376
    buffer_load_dwordx4 v[40:43], v4, s[12:15], s45 offen sc0 sc1
    s_add_u32 s45, s38, 344064
    buffer_load_dwordx4 v[44:47], v4, s[12:15], s45 offen sc0 sc1
    s_add_u32 s45, s38, 458752
    buffer_load_dwordx4 v[48:51], v4, s[12:15], s45 offen sc0 sc1
    s_add_u32 s45, s38, 573440
    buffer_load_dwordx4 v[52:55], v4, s[12:15], s45 offen sc0 sc1
    s_add_u32 s45, s38, 688128
    buffer_load_dwordx4 v[56:59], v4, s[12:15], s45 offen sc0 sc1
    s_add_u32 s45, s38, 802816
    buffer_load_dwordx4 v[60:63], v4, s[12:15], s45 offen sc0 sc1
    s_waitcnt vmcnt(0)
    v_add_f32 v32, v32, v40
    v_add_f32 v48, v48, v56
    v_add_f32 v33, v33, v41
    v_add_f32 v49, v49, v57
    v_add_f32 v34, v34, v42
    v_add_f32 v50, v50, v58
    v_add_f32 v35, v35, v43
    v_add_f32 v51, v51, v59
    v_add_f32 v32, v32, v48
    v_add_f32 v33, v33, v49
    v_add_f32 v34, v34, v50
    v_add_f32 v35, v35, v51
    v_add_f32 v36, v36, v44
    v_add_f32 v52, v52, v60
    v_add_f32 v37, v37, v45
    v_add_f32 v53, v53, v61
    v_add_f32 v38, v38, v46
    v_add_f32 v54, v54, v62
    v_add_f32 v39, v39, v47
    v_add_f32 v55, v55, v63
    v_add_f32 v36, v36, v52
    v_add_f32 v37, v37, v53
    v_add_f32 v38, v38, v54
    v_add_f32 v39, v39, v55
    v_cvt_pk_bf16_f32 v40, v32, v36
    v_cvt_pk_bf16_f32 v41, v33, v37
    v_cvt_pk_bf16_f32 v42, v34, v38
    v_cvt_pk_bf16_f32 v43, v35, v39
    v_lshlrev_b32 v32, 16, v40
    v_and_b32 v36, 0xffff0000, v40
    v_lshlrev_b32 v33, 16, v41
    v_and_b32 v37, 0xffff0000, v41
    v_lshlrev_b32 v34, 16, v42
    v_and_b32 v38, 0xffff0000, v42
    v_lshlrev_b32 v35, 16, v43
    v_and_b32 v39, 0xffff0000, v43
    v_mul_f32 v40, s48, v32
    v_mul_f32 v41, s48, v33
    v_mul_f32 v42, s48, v34
    v_mul_f32 v43, s48, v35
    v_exp_f32 v40, v40
    v_exp_f32 v41, v41
    v_exp_f32 v42, v42
    v_exp_f32 v43, v43
    v_add_f32 v40, 1.0, v40
    v_add_f32 v41, 1.0, v41
    v_add_f32 v42, 1.0, v42
    v_add_f32 v43, 1.0, v43
    v_rcp_f32 v40, v40
    v_rcp_f32 v41, v41
    v_rcp_f32 v42, v42
    v_rcp_f32 v43, v43
    v_mul_f32 v32, v32, v40
    v_mul_f32 v33, v33, v41
    v_mul_f32 v34, v34, v42
    v_mul_f32 v35, v35, v43
    v_cvt_pk_bf16_f32 v32, v32, v32
    v_cvt_pk_bf16_f32 v33, v33, v33
    v_cvt_pk_bf16_f32 v34, v34, v34
    v_cvt_pk_bf16_f32 v35, v35, v35
    v_lshlrev_b32 v32, 16, v32
    v_lshlrev_b32 v33, 16, v33
    v_lshlrev_b32 v34, 16, v34
    v_lshlrev_b32 v35, 16, v35
    v_mul_f32 v32, v32, v36
    v_mul_f32 v33, v33, v37
    v_mul_f32 v34, v34, v38
    v_mul_f32 v35, v35, v39
    v_cvt_pk_bf16_f32 v32, v32, v32
    v_cvt_pk_bf16_f32 v33, v33, v33
    v_cvt_pk_bf16_f32 v34, v34, v34
    v_cvt_pk_bf16_f32 v35, v35, v35
    s_mov_b32 exec_hi, 0xffffff
    ds_write_b16 v11, v32 offset:0
    ds_write_b16 v11, v33 offset:64
    ds_write_b16 v11, v34 offset:128
    ds_write_b16 v11, v35 offset:192
    s_mov_b64 exec, -1
    ds_read_b128 v[64:67], v9
    v_cmp_gt_u32 vcc, 32, v0
    s_waitcnt lgkmcnt(0)
    v_mfma_f32_16x16x32_bf16 v[104:107], v[64:67], v[72:75], 0
    v_mfma_f32_16x16x32_bf16 v[120:123], v[64:67], v[88:91], 0
    v_mfma_f32_16x16x32_bf16 v[108:111], v[64:67], v[76:79], 0
    v_mfma_f32_16x16x32_bf16 v[124:127], v[64:67], v[92:95], 0
    v_mfma_f32_16x16x32_bf16 v[112:115], v[64:67], v[80:83], 0
    v_mfma_f32_16x16x32_bf16 v[128:131], v[64:67], v[96:99], 0
    v_mfma_f32_16x16x32_bf16 v[116:119], v[64:67], v[84:87], 0
    v_mfma_f32_16x16x32_bf16 v[132:135], v[64:67], v[100:103], 0
    s_nop 1
    v_cndmask_b32 v136, v120, v104, vcc
    v_cndmask_b32 v140, v121, v105, vcc
    v_cndmask_b32 v144, v122, v106, vcc
    v_cndmask_b32 v148, v123, v107, vcc
    v_cndmask_b32 v137, v124, v108, vcc
    v_cndmask_b32 v141, v125, v109, vcc
    v_cndmask_b32 v145, v126, v110, vcc
    v_cndmask_b32 v149, v127, v111, vcc
    v_cndmask_b32 v138, v128, v112, vcc
    v_cndmask_b32 v142, v129, v113, vcc
    v_cndmask_b32 v146, v130, v114, vcc
    v_cndmask_b32 v150, v131, v115, vcc
    v_cndmask_b32 v139, v132, v116, vcc
    v_cndmask_b32 v143, v133, v117, vcc
    v_cndmask_b32 v147, v134, v118, vcc
    v_cndmask_b32 v151, v135, v119, vcc
    ds_write_b128 v16, v[136:139] offset:0
    ds_write_b128 v16, v[140:143] offset:512
    ds_write_b128 v16, v[144:147] offset:1024
    ds_write_b128 v16, v[148:151] offset:1536
    s_mov_b64 exec, 1
    ds_write_b32 v10, v19 offset:80
    s_mov_b64 exec, -1
F_d1:
    ds_read_b32 v12, v13 offset:80
    ds_read2st64_b32 v[32:33], v17 offset0:0 offset1:1
    ds_read2st64_b32 v[34:35], v17 offset0:2 offset1:3
    ds_read2st64_b32 v[36:37], v17 offset0:16 offset1:17
    ds_read2st64_b32 v[38:39], v17 offset0:18 offset1:19
    ds_read2st64_b32 v[40:41], v18 offset0:0 offset1:1
    ds_read2st64_b32 v[42:43], v18 offset0:2 offset1:3
    ds_read2st64_b32 v[44:45], v18 offset0:16 offset1:17
    ds_read2st64_b32 v[46:47], v18 offset0:18 offset1:19
    s_waitcnt lgkmcnt(0)
    v_cmp_eq_u32 vcc, 0, v12
    s_cbranch_vccnz F_d1
    v_add_f32 v32, v32, v36
    v_add_f32 v40, v40, v44
    v_add_f32 v33, v33, v37
    v_add_f32 v41, v41, v45
    v_add_f32 v34, v34, v38
    v_add_f32 v42, v42, v46
    v_add_f32 v35, v35, v39
    v_add_f32 v43, v43, v47
    v_add_f32 v32, v32, v40
    buffer_atomic_add_f32 v32, v3, s[24:27], s60 offen offset:0
    v_add_f32 v33, v33, v41
    buffer_atomic_add_f32 v33, v3, s[24:27], s60 offen offset:256
    v_add_f32 v34, v34, v42
    buffer_atomic_add_f32 v34, v3, s[24:27], s61 offen offset:0
    v_add_f32 v35, v35, v43
    buffer_atomic_add_f32 v35, v3, s[24:27], s61 offen offset:256
    v_mov_b32 v4, 159140
    v_mov_b32 v8, 1
    s_waitcnt vmcnt(0)
    s_mov_b64 exec, 1
    ds_add_rtn_u32 v9, v4, v8
    s_waitcnt lgkmcnt(0)
    v_readfirstlane_b32 s44, v9
    s_mov_b64 exec, -1
    s_cmp_lg_u32 s44, 3
    s_cbranch_scc1 F_ye
    s_mov_b32 s44, 1
    s_atomic_add s44, s[62:63], 0
    s_atomic_add s44, s[62:63], 0x80
    s_atomic_add s44, s[62:63], 0x100
    s_atomic_add s44, s[62:63], 0x180
F_ye:

    s_endpgm
F_codeend:
.section .rodata,"a"
.p2align 6
.amdhsa_kernel parallel_sum__linear_attn_block__moe_arch_mod__prompt_kernel
  .amdhsa_next_free_vgpr 168
  .amdhsa_next_free_sgpr 98
  .amdhsa_accum_offset 168
  .amdhsa_group_segment_fixed_size 0
  .amdhsa_kernarg_size 88
  .amdhsa_user_sgpr_count 2
  .amdhsa_user_sgpr_kernarg_segment_ptr 1
  .amdhsa_system_sgpr_workgroup_id_x 1
  .amdhsa_float_denorm_mode_32 3
  .amdhsa_float_denorm_mode_16_64 3
.end_amdhsa_kernel
```

```asm
; @launch grid=(256,1,1) block=(768,1,1) lds=163840
.amdgcn_target "amdgcn-amd-amdhsa--gfx950"
.text
.globl parallel_sum__linear_attn_block__moe_arch_mod__prompt_kernel
.p2align 12
.p2align 8
.type parallel_sum__linear_attn_block__moe_arch_mod__prompt_kernel,@function
parallel_sum__linear_attn_block__moe_arch_mod__prompt_kernel:
    s_load_dwordx4 s[4:7], s[0:1], 0
    s_load_dwordx2 s[8:9], s[0:1], 16
    s_load_dwordx8 s[60:67], s[0:1], 32
    s_load_dwordx4 s[68:71], s[0:1], 64
    s_load_dwordx2 s[72:73], s[0:1], 80
    s_cmp_ge_u32 s2, 256
    s_cbranch_scc1 F_end
    v_lshrrev_b32 v1, 6, v0
    v_and_b32 v0, 63, v0
    s_and_b32 s30, s2, 7
    v_readfirstlane_b32 s3, v1
    s_lshr_b32 s31, s2, 3
    s_and_b32 s36, s30, 1
    s_lshl_b32 s32, s36, 3
    s_and_b32 s35, s31, 7
    s_add_u32 s32, s32, s35
    s_lshr_b32 s37, s30, 1
    s_lshl_b32 s33, s37, 2
    s_lshr_b32 s34, s31, 3
    s_add_u32 s33, s33, s34
    s_add_u32 s10, s33, 0
    s_and_b32 s10, s10, 15
    s_add_u32 s11, s35, s34
    s_and_b32 s11, s11, 3
    s_and_b32 s28, s32, 11
    s_and_b32 s29, s37, 1
    s_lshl_b32 s29, s29, 2
    s_add_u32 s28, s28, s29
    s_lshr_b32 s29, s37, 1
    s_lshl_b32 s29, s29, 3
    s_and_b32 s38, s35, 4
    s_add_u32 s29, s29, s38
    s_add_u32 s38, s34, 1
    s_and_b32 s38, s38, 3
    s_add_u32 s29, s29, s38

    s_lshl_b32 s11, s34, 1
    s_add_u32 s11, s11, s35
    s_and_b32 s11, s11, 7
    s_mul_i32 s89, s36, 8
    s_mul_i32 s38, s37, 2
    s_add_u32 s89, s89, s38

    s_mov_b32 s94, 0x73156420
    s_mov_b32 s95, 0xfb9dea8c
    s_cmp_eq_u32 s11, 1
    s_cselect_b32 s94, 0x62047531, s94
    s_cselect_b32 s95, 0xea8cfb9d, s95
    s_cmp_eq_u32 s11, 2
    s_cselect_b32 s94, 0x53710642, s94
    s_cselect_b32 s95, 0xdbf9cae8, s95
    s_cmp_eq_u32 s11, 3
    s_cselect_b32 s94, 0x42601753, s94
    s_cselect_b32 s95, 0xcae8dbf9, s95
    s_cmp_eq_u32 s11, 4
    s_cselect_b32 s94, 0x58320164, s94
    s_cselect_b32 s95, 0xfdbec9a7, s95
    s_cmp_eq_u32 s11, 5
    s_cselect_b32 s94, 0x49231075, s94
    s_cselect_b32 s95, 0xecafd8b6, s95
    s_cmp_eq_u32 s11, 6
    s_cselect_b32 s94, 0xa5143206, s94
    s_cselect_b32 s95, 0xfd9ebc87, s95
    s_cmp_eq_u32 s11, 7
    s_cselect_b32 s94, 0xb4052317, s94
    s_cselect_b32 s95, 0xec8fad96, s95
    s_cmp_ge_u32 s3, 8
    s_cbranch_scc1 F_aux
    s_cmp_ge_u32 s3, 4
    s_cbranch_scc1 F_nl
    v_lshrrev_b32 v2, 3, v0
    v_and_b32 v3, 7, v0
    v_lshrrev_b32 v4, 1, v2
    v_xor_b32 v5, v3, v4
    v_xor_b32 v6, 4, v5
    v_lshlrev_b32 v5, 4, v5
    v_lshlrev_b32 v6, 4, v6
    v_lshlrev_b32 v7, 11, v2
    v_add_u32 v5, v5, v7
    v_add_u32 v6, v6, v7
    v_and_b32 v4, 1, v4
    v_lshlrev_b32 v4, 1, v4
    v_xor_b32 v8, v3, v4
    v_xor_b32 v9, 4, v8
    v_lshlrev_b32 v8, 4, v8
    v_lshlrev_b32 v9, 4, v9
    v_mul_u32_u24 v7, 6144, v2
    v_add_u32 v8, v8, v7
    v_add_u32 v9, v9, v7
    v_add_u32 v9, 49152, v9
    s_lshl_b32 s36, s32, 18
    s_lshl_b32 s37, s3, 16
    s_add_u32 s36, s36, s37
    s_lshl_b32 s38, s33, 7
    s_mul_i32 s37, s3, 98304
    s_add_u32 s38, s38, s37
    s_lshl_b32 s47, s10, 7
    s_add_u32 s47, s47, s37
    s_lshl_b32 s44, s3, 12
    s_lshl_b32 s45, s3, 11
    s_add_u32 s43, s45, 1024
    s_mov_b32 s14, 4194304
    s_mov_b32 s15, 0x20000
    s_mov_b32 s18, 6291456
    s_mov_b32 s19, 0x20000
    s_waitcnt lgkmcnt(0)
    s_mov_b32 s12, s4
    s_mov_b32 s13, s5
    s_mov_b32 s16, s6
    s_mov_b32 s17, s7

    s_setprio 3
    s_bfe_u32 s40, s94, 0x40000
    s_add_u32 s40, s89, s40
    s_and_b32 s40, s40, 15
    s_mul_i32 s41, s40, 393216
    s_lshl_b32 s40, s40, 7
    s_add_u32 s40, s40, s36
    s_add_u32 s42, s41, s47
    s_add_u32 s41, s41, s38
    s_add_u32 m0, s44, 0
    s_add_u32 s46, s40, 0
    buffer_load_dwordx4 v5, s[12:15], s46 offen lds
    s_add_u32 m0, s44, 1024
    s_add_u32 s46, s40, 16384
    buffer_load_dwordx4 v6, s[12:15], s46 offen lds
    s_add_u32 m0, s44, 2048
    s_add_u32 s46, s40, 32768
    buffer_load_dwordx4 v5, s[12:15], s46 offen lds
    s_add_u32 m0, s44, 3072
    s_add_u32 s46, s40, 49152
    buffer_load_dwordx4 v6, s[12:15], s46 offen lds
    s_add_u32 m0, s45, 65536
    s_add_u32 s46, s41, 2048
    buffer_load_dwordx4 v8, s[16:19], s46 offen lds
    s_add_u32 m0, s43, 65536
    s_add_u32 s46, s41, 2048
    buffer_load_dwordx4 v9, s[16:19], s46 offen lds
    s_add_u32 m0, s45, 73728
    s_add_u32 s46, s41, 4096
    buffer_load_dwordx4 v8, s[16:19], s46 offen lds
    s_add_u32 m0, s43, 73728
    s_add_u32 s46, s41, 4096
    buffer_load_dwordx4 v9, s[16:19], s46 offen lds
    s_add_u32 m0, s45, 147456
    s_nop 0
    buffer_load_dwordx4 v8, s[16:19], s42 offen lds
    s_add_u32 m0, s43, 147456
    s_nop 0
    buffer_load_dwordx4 v9, s[16:19], s42 offen lds
    s_bfe_u32 s40, s94, 0x40004
    s_add_u32 s40, s89, s40
    s_and_b32 s40, s40, 15
    s_mul_i32 s41, s40, 393216
    s_lshl_b32 s40, s40, 7
    s_add_u32 s40, s40, s36
    s_add_u32 s42, s41, s47
    s_add_u32 s41, s41, s38
    s_add_u32 m0, s44, 16384
    s_add_u32 s46, s40, 0
    buffer_load_dwordx4 v5, s[12:15], s46 offen lds
    s_add_u32 m0, s44, 17408
    s_add_u32 s46, s40, 16384
    buffer_load_dwordx4 v6, s[12:15], s46 offen lds
    s_add_u32 m0, s44, 18432
    s_add_u32 s46, s40, 32768
    buffer_load_dwordx4 v5, s[12:15], s46 offen lds
    s_add_u32 m0, s44, 19456
    s_add_u32 s46, s40, 49152
    buffer_load_dwordx4 v6, s[12:15], s46 offen lds
    s_add_u32 m0, s45, 81920
    s_add_u32 s46, s41, 2048
    buffer_load_dwordx4 v8, s[16:19], s46 offen lds
    s_add_u32 m0, s43, 81920
    s_add_u32 s46, s41, 2048
    buffer_load_dwordx4 v9, s[16:19], s46 offen lds
    v_and_b32 v1, 15, v0
    v_lshrrev_b32 v7, 4, v0
    v_lshrrev_b32 v3, 1, v1
    v_xor_b32 v3, v3, v7
    v_lshlrev_b32 v3, 4, v3
    v_lshlrev_b32 v1, 7, v1
    v_add3_u32 v2, v1, v3, s44
    v_xor_b32 v3, 64, v2
    v_add_u32 v14, 0x10000, v2
    v_add_u32 v15, 0x10000, v3
    v_bfe_u32 v1, v0, 2, 2
    v_lshl_add_u32 v4, v7, 3, v1
    v_lshrrev_b32 v1, 1, v1
    v_and_b32 v7, 1, v7
    v_lshl_add_u32 v1, v7, 1, v1
    v_lshlrev_b32 v1, 5, v1
    v_lshl_add_u32 v1, v4, 7, v1
    v_and_b32 v7, 3, v0
    v_lshl_add_u32 v1, v7, 3, v1
    v_add_u32 v10, 90112, v1
    v_xor_b32 v11, 32, v10
    v_xor_b32 v12, 64, v10
    v_xor_b32 v13, 96, v10
    v_lshlrev_b32 v1, 2, v7
    v_add_u32 v1, 159040, v1
    s_lshl_b32 s50, s3, 2
    s_add_u32 s50, s50, 159040
    v_mov_b32 v4, s50
    v_mov_b32 v164, 1

    s_waitcnt vmcnt(8)
    s_barrier
    s_add_u32 m0, s45, 90112
    s_add_u32 s46, s41, 4096
    buffer_load_dwordx4 v8, s[16:19], s46 offen lds
    ds_read_b128 v[48:51], v2 offset:0
    s_add_u32 m0, s43, 90112
    s_add_u32 s46, s41, 4096
    buffer_load_dwordx4 v9, s[16:19], s46 offen lds
    ds_read_b128 v[52:55], v2 offset:2048
    s_lshl_b32 s51, s32, 4
    s_add_u32 s51, s51, s33
    s_lshl_b32 s51, s51, 14
    s_add_u32 s51, s51, s45
    v_lshlrev_b32 v165, 4, v0
    s_mov_b32 s20, s60
    s_mov_b32 s21, s61
    s_mov_b32 s22, 0x800
    s_mov_b32 s23, 0x00020000
    s_add_u32 m0, s45, 98304
    s_add_u32 s46, s51, 0
    buffer_load_dwordx4 v165, s[12:15], s46 offen lds
    ds_read_b128 v[56:59], v3 offset:0
    s_add_u32 m0, s45, 99328
    s_add_u32 s46, s51, 1024
    buffer_load_dwordx4 v165, s[12:15], s46 offen lds
    ds_read_b128 v[60:63], v3 offset:2048
    s_and_b32 s46, s3, 1
    s_lshl_b32 s46, s46, 10
    s_add_u32 m0, s46, 161792
    s_nop 0
    buffer_load_dwordx4 v165, s[20:23], s46 offen lds
    s_add_u32 m0, s45, 106496
    s_add_u32 s46, s51, 8192
    buffer_load_dwordx4 v165, s[12:15], s46 offen lds
    s_add_u32 m0, s45, 107520
    s_add_u32 s46, s51, 9216
    buffer_load_dwordx4 v165, s[12:15], s46 offen lds
    s_bfe_u32 s40, s94, 0x40008
    s_add_u32 s40, s89, s40
    s_and_b32 s40, s40, 15
    s_mul_i32 s41, s40, 393216
    s_lshl_b32 s40, s40, 7
    s_add_u32 s40, s40, s36
    s_add_u32 s42, s41, s47
    s_add_u32 s41, s41, s38
    s_add_u32 m0, s44, 32768
    s_add_u32 s46, s40, 0
    buffer_load_dwordx4 v5, s[12:15], s46 offen lds
    s_add_u32 m0, s44, 33792
    s_add_u32 s46, s40, 16384
    buffer_load_dwordx4 v6, s[12:15], s46 offen lds
    s_add_u32 m0, s44, 34816
    s_add_u32 s46, s40, 32768
    buffer_load_dwordx4 v5, s[12:15], s46 offen lds
    s_add_u32 m0, s44, 35840
    s_add_u32 s46, s40, 49152
    buffer_load_dwordx4 v6, s[12:15], s46 offen lds
    s_waitcnt vmcnt(9) lgkmcnt(0)
    s_barrier
    s_add_u32 m0, s45, 114688
    s_add_u32 s46, s41, 2048
    buffer_load_dwordx4 v8, s[16:19], s46 offen lds
    ds_read_b64_tr_b16 v[64:65], v10 offset:57344
    ds_read_b64_tr_b16 v[66:67], v10 offset:57856
    s_add_u32 m0, s43, 114688
    s_add_u32 s46, s41, 2048
    buffer_load_dwordx4 v9, s[16:19], s46 offen lds
    ds_read_b128 v[68:71], v2 offset:16384
    s_add_u32 m0, s45, 122880
    s_add_u32 s46, s41, 4096
    buffer_load_dwordx4 v8, s[16:19], s46 offen lds
    ds_read_b64_tr_b16 v[72:73], v11 offset:57344
    ds_read_b64_tr_b16 v[74:75], v11 offset:57856
    s_add_u32 m0, s43, 122880
    s_add_u32 s46, s41, 4096
    buffer_load_dwordx4 v9, s[16:19], s46 offen lds
    ds_read_b128 v[76:79], v2 offset:18432
    s_bfe_u32 s40, s94, 0x40004
    s_add_u32 s40, s89, s40
    s_and_b32 s40, s40, 15
    s_mul_i32 s41, s40, 393216
    s_lshl_b32 s40, s40, 7
    s_add_u32 s40, s40, s36
    s_add_u32 s42, s41, s47
    s_add_u32 s41, s41, s38
    s_add_u32 m0, s45, 139264
    s_nop 0
    buffer_load_dwordx4 v8, s[16:19], s42 offen lds
    ds_read_b64_tr_b16 v[80:81], v12 offset:57344
    ds_read_b64_tr_b16 v[82:83], v12 offset:57856
    s_add_u32 m0, s43, 139264
    s_nop 0
    buffer_load_dwordx4 v9, s[16:19], s42 offen lds
    ds_read_b128 v[84:87], v3 offset:16384
    s_bfe_u32 s40, s94, 0x4000c
    s_add_u32 s40, s89, s40
    s_and_b32 s40, s40, 15
    s_mul_i32 s41, s40, 393216
    s_lshl_b32 s40, s40, 7
    s_add_u32 s40, s40, s36
    s_add_u32 s42, s41, s47
    s_add_u32 s41, s41, s38
    s_add_u32 m0, s44, 49152
    s_add_u32 s46, s40, 0
    buffer_load_dwordx4 v5, s[12:15], s46 offen lds
    ds_read_b64_tr_b16 v[88:89], v13 offset:57344
    ds_read_b64_tr_b16 v[90:91], v13 offset:57856
    s_add_u32 m0, s44, 50176
    s_add_u32 s46, s40, 16384
    buffer_load_dwordx4 v6, s[12:15], s46 offen lds
    ds_read_b128 v[92:95], v3 offset:18432
    s_add_u32 m0, s44, 51200
    s_add_u32 s46, s40, 32768
    buffer_load_dwordx4 v5, s[12:15], s46 offen lds
    s_add_u32 m0, s44, 52224
    s_add_u32 s46, s40, 49152
    buffer_load_dwordx4 v6, s[12:15], s46 offen lds
    s_add_u32 m0, s45, 131072
    s_add_u32 s46, s41, 2048
    buffer_load_dwordx4 v8, s[16:19], s46 offen lds
    s_waitcnt vmcnt(5) lgkmcnt(0)
    s_barrier
    s_add_u32 m0, s43, 131072
    s_add_u32 s46, s41, 2048
    buffer_load_dwordx4 v9, s[16:19], s46 offen lds
    v_mfma_f32_16x16x32_bf16 v[16:19], v[64:67], v[48:51], 0
    ds_read_b64_tr_b16 v[96:97], v10 offset:61440
    ds_read_b64_tr_b16 v[98:99], v10 offset:61952
    s_add_u32 m0, s45, 65536
    s_add_u32 s46, s41, 4096
    buffer_load_dwordx4 v8, s[16:19], s46 offen lds
    v_mfma_f32_16x16x32_bf16 v[32:35], v[64:67], v[52:55], 0
    ds_read_b128 v[100:103], v2 offset:32768
    s_add_u32 m0, s43, 65536
    s_add_u32 s46, s41, 4096
    buffer_load_dwordx4 v9, s[16:19], s46 offen lds
    v_mfma_f32_16x16x32_bf16 v[20:23], v[72:75], v[48:51], 0
    ds_read_b64_tr_b16 v[104:105], v11 offset:61440
    ds_read_b64_tr_b16 v[106:107], v11 offset:61952
    s_bfe_u32 s40, s94, 0x40008
    s_add_u32 s40, s89, s40
    s_and_b32 s40, s40, 15
    s_mul_i32 s41, s40, 393216
    s_lshl_b32 s40, s40, 7
    s_add_u32 s40, s40, s36
    s_add_u32 s42, s41, s47
    s_add_u32 s41, s41, s38
    s_add_u32 m0, s45, 90112
    s_nop 0
    buffer_load_dwordx4 v8, s[16:19], s42 offen lds
    v_mfma_f32_16x16x32_bf16 v[36:39], v[72:75], v[52:55], 0
    ds_read_b128 v[108:111], v2 offset:34816
    s_add_u32 m0, s43, 90112
    s_nop 0
    buffer_load_dwordx4 v9, s[16:19], s42 offen lds
    v_mfma_f32_16x16x32_bf16 v[24:27], v[80:83], v[48:51], 0
    ds_read_b64_tr_b16 v[112:113], v12 offset:61440
    ds_read_b64_tr_b16 v[114:115], v12 offset:61952
    s_bfe_u32 s40, s94, 0x40010
    s_add_u32 s40, s89, s40
    s_and_b32 s40, s40, 15
    s_mul_i32 s41, s40, 393216
    s_lshl_b32 s40, s40, 7
    s_add_u32 s40, s40, s36
    s_add_u32 s42, s41, s47
    s_add_u32 s41, s41, s38
    s_add_u32 m0, s44, 0
    s_add_u32 s46, s40, 0
    buffer_load_dwordx4 v5, s[12:15], s46 offen lds
    v_mfma_f32_16x16x32_bf16 v[40:43], v[80:83], v[52:55], 0
    ds_read_b128 v[116:119], v3 offset:32768
    s_add_u32 m0, s44, 1024
    s_add_u32 s46, s40, 16384
    buffer_load_dwordx4 v6, s[12:15], s46 offen lds
    v_mfma_f32_16x16x32_bf16 v[28:31], v[88:91], v[48:51], 0
    ds_read_b64_tr_b16 v[120:121], v13 offset:61440
    ds_read_b64_tr_b16 v[122:123], v13 offset:61952
    s_add_u32 m0, s44, 2048
    s_add_u32 s46, s40, 32768
    buffer_load_dwordx4 v5, s[12:15], s46 offen lds
    v_mfma_f32_16x16x32_bf16 v[44:47], v[88:91], v[52:55], 0
    ds_read_b128 v[124:127], v3 offset:34816
    s_add_u32 m0, s44, 3072
    s_add_u32 s46, s40, 49152
    buffer_load_dwordx4 v6, s[12:15], s46 offen lds
    ds_read_b64_tr_b16 v[128:129], v10 offset:49152
    ds_read_b64_tr_b16 v[130:131], v10 offset:49664
    s_add_u32 m0, s45, 73728
    s_add_u32 s46, s41, 2048
    buffer_load_dwordx4 v8, s[16:19], s46 offen lds
    ds_read_b64_tr_b16 v[132:133], v11 offset:49152
    s_waitcnt lgkmcnt(8)
    ds_read_b64_tr_b16 v[134:135], v11 offset:49664
    s_add_u32 m0, s43, 73728
    s_add_u32 s46, s41, 2048
    buffer_load_dwordx4 v9, s[16:19], s46 offen lds
    ds_read_b64_tr_b16 v[136:137], v12 offset:49152
    ds_read_b64_tr_b16 v[138:139], v12 offset:49664
    ds_read_b64_tr_b16 v[140:141], v13 offset:49152
    ds_read_b64_tr_b16 v[142:143], v13 offset:49664
    s_waitcnt vmcnt(6) lgkmcnt(0)
    s_barrier
    s_add_u32 m0, s45, 81920
    s_add_u32 s46, s41, 4096
    buffer_load_dwordx4 v8, s[16:19], s46 offen lds
    v_mfma_f32_16x16x32_bf16 v[16:19], v[96:99], v[56:59], v[16:19]
    ds_read_b64_tr_b16 v[144:145], v10 offset:53248
    ds_read_b64_tr_b16 v[146:147], v10 offset:53760
    s_add_u32 m0, s43, 81920
    s_add_u32 s46, s41, 4096
    buffer_load_dwordx4 v9, s[16:19], s46 offen lds
    v_mfma_f32_16x16x32_bf16 v[32:35], v[96:99], v[60:63], v[32:35]
    ds_read_b128 v[148:151], v2 offset:49152
    s_bfe_u32 s40, s94, 0x40014
    s_add_u32 s40, s89, s40
    s_and_b32 s40, s40, 15
    s_mul_i32 s41, s40, 393216
    s_lshl_b32 s40, s40, 7
    s_add_u32 s40, s40, s36
    s_add_u32 s42, s41, s47
    s_add_u32 s41, s41, s38
    s_add_u32 m0, s44, 16384
    s_add_u32 s46, s40, 0
    buffer_load_dwordx4 v5, s[12:15], s46 offen lds
    v_mfma_f32_16x16x32_bf16 v[20:23], v[104:107], v[56:59], v[20:23]
    ds_read_b64_tr_b16 v[152:153], v11 offset:53248
    ds_read_b64_tr_b16 v[154:155], v11 offset:53760
    s_add_u32 m0, s44, 17408
    s_add_u32 s46, s40, 16384
    buffer_load_dwordx4 v6, s[12:15], s46 offen lds
    v_mfma_f32_16x16x32_bf16 v[36:39], v[104:107], v[60:63], v[36:39]
    ds_read_b128 v[156:159], v2 offset:51200
    s_add_u32 m0, s44, 18432
    s_add_u32 s46, s40, 32768
    buffer_load_dwordx4 v5, s[12:15], s46 offen lds
    v_mfma_f32_16x16x32_bf16 v[24:27], v[112:115], v[56:59], v[24:27]
    ds_read_b64_tr_b16 v[160:161], v12 offset:53248
    ds_read_b64_tr_b16 v[162:163], v12 offset:53760
    s_add_u32 m0, s44, 19456
    s_add_u32 s46, s40, 49152
    buffer_load_dwordx4 v6, s[12:15], s46 offen lds
    v_mfma_f32_16x16x32_bf16 v[40:43], v[112:115], v[60:63], v[40:43]
    ds_read_b128 v[64:67], v3 offset:49152
    s_add_u32 m0, s45, 98304
    s_add_u32 s46, s41, 2048
    buffer_load_dwordx4 v8, s[16:19], s46 offen lds
    v_mfma_f32_16x16x32_bf16 v[28:31], v[120:123], v[56:59], v[28:31]
    ds_read_b64_tr_b16 v[72:73], v13 offset:53248
    ds_read_b64_tr_b16 v[74:75], v13 offset:53760
    s_add_u32 m0, s43, 98304
    s_add_u32 s46, s41, 2048
    buffer_load_dwordx4 v9, s[16:19], s46 offen lds
    v_mfma_f32_16x16x32_bf16 v[44:47], v[120:123], v[60:63], v[44:47]
    ds_read_b128 v[80:83], v3 offset:51200
    s_add_u32 m0, s45, 106496
    s_add_u32 s46, s41, 4096
    buffer_load_dwordx4 v8, s[16:19], s46 offen lds
    v_mfma_f32_16x16x32_bf16 v[16:19], v[128:131], v[68:71], v[16:19]
    ds_read_b64_tr_b16 v[48:49], v10 offset:0
    ds_read_b64_tr_b16 v[50:51], v10 offset:512
    s_add_u32 m0, s43, 106496
    s_add_u32 s46, s41, 4096
    buffer_load_dwordx4 v9, s[16:19], s46 offen lds
    v_mfma_f32_16x16x32_bf16 v[32:35], v[128:131], v[76:79], v[32:35]
    ds_read_b64_tr_b16 v[88:89], v11 offset:0
    s_waitcnt lgkmcnt(8)
    ds_read_b64_tr_b16 v[90:91], v11 offset:512
    s_bfe_u32 s40, s94, 0x4000c
    s_add_u32 s40, s89, s40
    s_and_b32 s40, s40, 15
    s_mul_i32 s41, s40, 393216
    s_lshl_b32 s40, s40, 7
    s_add_u32 s40, s40, s36
    s_add_u32 s42, s41, s47
    s_add_u32 s41, s41, s38
    s_add_u32 m0, s45, 147456
    s_nop 0
    buffer_load_dwordx4 v8, s[16:19], s42 offen lds
    v_mfma_f32_16x16x32_bf16 v[20:23], v[132:135], v[68:71], v[20:23]
    ds_read_b64_tr_b16 v[52:53], v12 offset:0
    ds_read_b64_tr_b16 v[54:55], v12 offset:512
    v_mfma_f32_16x16x32_bf16 v[36:39], v[132:135], v[76:79], v[36:39]
    ds_read_b64_tr_b16 v[96:97], v13 offset:0
    ds_read_b64_tr_b16 v[98:99], v13 offset:512
    v_mfma_f32_16x16x32_bf16 v[24:27], v[136:139], v[68:71], v[24:27]
    v_mfma_f32_16x16x32_bf16 v[40:43], v[136:139], v[76:79], v[40:43]
    v_mfma_f32_16x16x32_bf16 v[28:31], v[140:143], v[68:71], v[28:31]
    v_mfma_f32_16x16x32_bf16 v[44:47], v[140:143], v[76:79], v[44:47]
    s_waitcnt vmcnt(9) lgkmcnt(0)
    s_barrier
    s_add_u32 m0, s43, 147456
    s_nop 0
    buffer_load_dwordx4 v9, s[16:19], s42 offen lds
    v_mfma_f32_16x16x32_bf16 v[16:19], v[144:147], v[84:87], v[16:19]
    ds_read_b64_tr_b16 v[104:105], v10 offset:4096
    ds_read_b64_tr_b16 v[106:107], v10 offset:4608
    s_bfe_u32 s40, s94, 0x40018
    s_add_u32 s40, s89, s40
    s_and_b32 s40, s40, 15
    s_mul_i32 s41, s40, 393216
    s_lshl_b32 s40, s40, 7
    s_add_u32 s40, s40, s36
    s_add_u32 s42, s41, s47
    s_add_u32 s41, s41, s38
    s_add_u32 m0, s44, 32768
    s_add_u32 s46, s40, 0
    buffer_load_dwordx4 v5, s[12:15], s46 offen lds
    v_mfma_f32_16x16x32_bf16 v[32:35], v[144:147], v[92:95], v[32:35]
    ds_read_b128 v[112:115], v2 offset:0
    s_add_u32 m0, s44, 33792
    s_add_u32 s46, s40, 16384
    s_branch IW_s0
IW_w0:
    s_branch IW_r0
IW_s0:
    buffer_load_dwordx4 v6, s[12:15], s46 offen lds
    v_mfma_f32_16x16x32_bf16 v[20:23], v[152:155], v[84:87], v[20:23]
    ds_read_b64_tr_b16 v[56:57], v11 offset:4096
    ds_read_b64_tr_b16 v[58:59], v11 offset:4608
    s_add_u32 m0, s44, 34816
    s_add_u32 s46, s40, 32768
    buffer_load_dwordx4 v5, s[12:15], s46 offen lds
    v_mfma_f32_16x16x32_bf16 v[36:39], v[152:155], v[92:95], v[36:39]
    ds_read_b128 v[120:123], v2 offset:2048
    s_add_u32 m0, s44, 35840
    s_add_u32 s46, s40, 49152
    buffer_load_dwordx4 v6, s[12:15], s46 offen lds
    v_mfma_f32_16x16x32_bf16 v[24:27], v[160:163], v[84:87], v[24:27]
    ds_read_b64_tr_b16 v[60:61], v12 offset:4096
    ds_read_b64_tr_b16 v[62:63], v12 offset:4608
    s_add_u32 m0, s45, 114688
    s_add_u32 s46, s41, 2048
    buffer_load_dwordx4 v8, s[16:19], s46 offen lds
    v_mfma_f32_16x16x32_bf16 v[40:43], v[160:163], v[92:95], v[40:43]
    ds_read_b128 v[128:131], v3 offset:0
    s_add_u32 m0, s43, 114688
    s_add_u32 s46, s41, 2048
    buffer_load_dwordx4 v9, s[16:19], s46 offen lds
    v_mfma_f32_16x16x32_bf16 v[28:31], v[72:75], v[84:87], v[28:31]
    ds_read_b64_tr_b16 v[132:133], v13 offset:4096
    ds_read_b64_tr_b16 v[134:135], v13 offset:4608
    s_add_u32 m0, s45, 122880
    s_add_u32 s46, s41, 4096
    buffer_load_dwordx4 v8, s[16:19], s46 offen lds
    v_mfma_f32_16x16x32_bf16 v[44:47], v[72:75], v[92:95], v[44:47]
    ds_read_b128 v[136:139], v3 offset:2048
    s_add_u32 m0, s43, 122880
    s_add_u32 s46, s41, 4096
    buffer_load_dwordx4 v9, s[16:19], s46 offen lds
    v_mfma_f32_16x16x32_bf16 v[16:19], v[48:51], v[100:103], v[16:19]
    s_bfe_u32 s40, s94, 0x4001c
    s_add_u32 s40, s89, s40
    s_and_b32 s40, s40, 15
    s_mul_i32 s41, s40, 393216
    s_lshl_b32 s40, s40, 7
    s_add_u32 s40, s40, s36
    s_add_u32 s42, s41, s47
    s_add_u32 s41, s41, s38
    s_add_u32 m0, s44, 49152
    s_add_u32 s46, s40, 0
    buffer_load_dwordx4 v5, s[12:15], s46 offen lds
    v_mfma_f32_16x16x32_bf16 v[32:35], v[48:51], v[108:111], v[32:35]
    s_add_u32 m0, s44, 50176
    s_add_u32 s46, s40, 16384
    buffer_load_dwordx4 v6, s[12:15], s46 offen lds
    v_mfma_f32_16x16x32_bf16 v[20:23], v[88:91], v[100:103], v[20:23]
    v_mfma_f32_16x16x32_bf16 v[36:39], v[88:91], v[108:111], v[36:39]
    v_mfma_f32_16x16x32_bf16 v[24:27], v[52:55], v[100:103], v[24:27]
    v_mfma_f32_16x16x32_bf16 v[40:43], v[52:55], v[108:111], v[40:43]
    v_mfma_f32_16x16x32_bf16 v[28:31], v[96:99], v[100:103], v[28:31]
    v_mfma_f32_16x16x32_bf16 v[44:47], v[96:99], v[108:111], v[44:47]
    s_waitcnt vmcnt(10) lgkmcnt(0)
    s_barrier
    s_add_u32 m0, s44, 51200
    s_add_u32 s46, s40, 32768
    buffer_load_dwordx4 v5, s[12:15], s46 offen lds
    v_mfma_f32_16x16x32_bf16 v[16:19], v[104:107], v[116:119], v[16:19]
    ds_read_b64_tr_b16 v[68:69], v10 offset:57344
    ds_read_b64_tr_b16 v[70:71], v10 offset:57856
    s_add_u32 m0, s44, 52224
    s_add_u32 s46, s40, 49152
    buffer_load_dwordx4 v6, s[12:15], s46 offen lds
    v_mfma_f32_16x16x32_bf16 v[32:35], v[104:107], v[124:127], v[32:35]
    ds_read_b128 v[140:143], v2 offset:16384
    s_add_u32 m0, s45, 65536
    s_add_u32 s46, s41, 2048
    buffer_load_dwordx4 v8, s[16:19], s46 offen lds
    v_mfma_f32_16x16x32_bf16 v[20:23], v[56:59], v[116:119], v[20:23]
    ds_read_b64_tr_b16 v[76:77], v11 offset:57344
    ds_read_b64_tr_b16 v[78:79], v11 offset:57856
    s_add_u32 m0, s43, 65536
    s_add_u32 s46, s41, 2048
    buffer_load_dwordx4 v9, s[16:19], s46 offen lds
    v_mfma_f32_16x16x32_bf16 v[36:39], v[56:59], v[124:127], v[36:39]
    ds_read_b128 v[144:147], v2 offset:18432
    s_add_u32 m0, s45, 131072
    s_add_u32 s46, s41, 4096
    buffer_load_dwordx4 v8, s[16:19], s46 offen lds
    v_mfma_f32_16x16x32_bf16 v[24:27], v[60:63], v[116:119], v[24:27]
    ds_read_b64_tr_b16 v[152:153], v12 offset:57344
    ds_read_b64_tr_b16 v[154:155], v12 offset:57856
    s_add_u32 m0, s43, 131072
    s_add_u32 s46, s41, 4096
    buffer_load_dwordx4 v9, s[16:19], s46 offen lds
    v_mfma_f32_16x16x32_bf16 v[40:43], v[60:63], v[124:127], v[40:43]
    ds_read_b128 v[160:163], v3 offset:16384
    s_bfe_u32 s40, s94, 0x40010
    s_add_u32 s40, s89, s40
    s_and_b32 s40, s40, 15
    s_mul_i32 s41, s40, 393216
    s_lshl_b32 s40, s40, 7
    s_add_u32 s40, s40, s36
    s_add_u32 s42, s41, s47
    s_add_u32 s41, s41, s38
    s_add_u32 m0, s45, 139264
    s_nop 0
    buffer_load_dwordx4 v8, s[16:19], s42 offen lds
    v_mfma_f32_16x16x32_bf16 v[28:31], v[132:135], v[116:119], v[28:31]
    ds_read_b64_tr_b16 v[84:85], v13 offset:57344
    ds_read_b64_tr_b16 v[86:87], v13 offset:57856
    s_add_u32 m0, s43, 139264
    s_nop 0
    buffer_load_dwordx4 v9, s[16:19], s42 offen lds
    v_mfma_f32_16x16x32_bf16 v[44:47], v[132:135], v[124:127], v[44:47]
    ds_read_b128 v[72:75], v3 offset:18432
    s_bfe_u32 s40, s95, 0x40000
    s_add_u32 s40, s89, s40
    s_and_b32 s40, s40, 15
    s_mul_i32 s41, s40, 393216
    s_lshl_b32 s40, s40, 7
    s_add_u32 s40, s40, s36
    s_add_u32 s42, s41, s47
    s_add_u32 s41, s41, s38
    s_add_u32 m0, s44, 0
    s_add_u32 s46, s40, 0
    buffer_load_dwordx4 v5, s[12:15], s46 offen lds
    s_add_u32 m0, s44, 1024
    s_add_u32 s46, s40, 16384
    buffer_load_dwordx4 v6, s[12:15], s46 offen lds
    s_add_u32 m0, s44, 2048
    s_add_u32 s46, s40, 32768
    buffer_load_dwordx4 v5, s[12:15], s46 offen lds
    s_waitcnt vmcnt(13) lgkmcnt(0)
    s_barrier
    s_add_u32 m0, s44, 3072
    s_add_u32 s46, s40, 49152
    buffer_load_dwordx4 v6, s[12:15], s46 offen lds
    v_mfma_f32_16x16x32_bf16 v[16:19], v[68:71], v[148:151], v[16:19]
    ds_read_b64_tr_b16 v[92:93], v10 offset:61440
    ds_read_b64_tr_b16 v[94:95], v10 offset:61952
    s_add_u32 m0, s45, 73728
    s_add_u32 s46, s41, 2048
    buffer_load_dwordx4 v8, s[16:19], s46 offen lds
    v_mfma_f32_16x16x32_bf16 v[32:35], v[68:71], v[156:159], v[32:35]
    ds_read_b128 v[48:51], v2 offset:32768
    s_add_u32 m0, s43, 73728
    s_add_u32 s46, s41, 2048
    buffer_load_dwordx4 v9, s[16:19], s46 offen lds
    v_mfma_f32_16x16x32_bf16 v[20:23], v[76:79], v[148:151], v[20:23]
    ds_read_b64_tr_b16 v[88:89], v11 offset:61440
    ds_read_b64_tr_b16 v[90:91], v11 offset:61952
    s_add_u32 m0, s45, 81920
    s_add_u32 s46, s41, 4096
    buffer_load_dwordx4 v8, s[16:19], s46 offen lds
    v_mfma_f32_16x16x32_bf16 v[36:39], v[76:79], v[156:159], v[36:39]
    ds_read_b128 v[52:55], v2 offset:34816
    s_add_u32 m0, s43, 81920
    s_add_u32 s46, s41, 4096
    buffer_load_dwordx4 v9, s[16:19], s46 offen lds
    v_mfma_f32_16x16x32_bf16 v[24:27], v[152:155], v[148:151], v[24:27]
    ds_read_b64_tr_b16 v[100:101], v12 offset:61440
    ds_read_b64_tr_b16 v[102:103], v12 offset:61952
    s_bfe_u32 s40, s95, 0x40004
    s_add_u32 s40, s89, s40
    s_and_b32 s40, s40, 15
    s_mul_i32 s41, s40, 393216
    s_lshl_b32 s40, s40, 7
    s_add_u32 s40, s40, s36
    s_add_u32 s42, s41, s47
    s_add_u32 s41, s41, s38
    s_add_u32 m0, s44, 16384
    s_add_u32 s46, s40, 0
    buffer_load_dwordx4 v5, s[12:15], s46 offen lds
    v_mfma_f32_16x16x32_bf16 v[40:43], v[152:155], v[156:159], v[40:43]
    ds_read_b128 v[96:99], v3 offset:32768
    s_add_u32 m0, s44, 17408
    s_add_u32 s46, s40, 16384
    buffer_load_dwordx4 v6, s[12:15], s46 offen lds
    v_mfma_f32_16x16x32_bf16 v[28:31], v[84:87], v[148:151], v[28:31]
    ds_read_b64_tr_b16 v[108:109], v13 offset:61440
    ds_read_b64_tr_b16 v[110:111], v13 offset:61952
    s_add_u32 m0, s44, 18432
    s_add_u32 s46, s40, 32768
    buffer_load_dwordx4 v5, s[12:15], s46 offen lds
    v_mfma_f32_16x16x32_bf16 v[44:47], v[84:87], v[156:159], v[44:47]
    ds_read_b128 v[104:107], v3 offset:34816
    s_add_u32 m0, s44, 19456
    s_add_u32 s46, s40, 49152
    buffer_load_dwordx4 v6, s[12:15], s46 offen lds
    s_add_u32 m0, s45, 90112
    s_add_u32 s46, s41, 2048
    buffer_load_dwordx4 v8, s[16:19], s46 offen lds
    s_add_u32 m0, s43, 90112
    s_add_u32 s46, s41, 2048
    buffer_load_dwordx4 v9, s[16:19], s46 offen lds
    s_waitcnt vmcnt(14) lgkmcnt(0)
    s_barrier
    s_add_u32 m0, s45, 98304
    s_add_u32 s46, s41, 4096
    buffer_load_dwordx4 v8, s[16:19], s46 offen lds
    v_mfma_f32_16x16x32_bf16 v[16:19], v[92:95], v[64:67], v[16:19]
    ds_read_b64_tr_b16 v[56:57], v10 offset:49152
    ds_read_b64_tr_b16 v[58:59], v10 offset:49664
    s_add_u32 m0, s43, 98304
    s_add_u32 s46, s41, 4096
    buffer_load_dwordx4 v9, s[16:19], s46 offen lds
    v_mfma_f32_16x16x32_bf16 v[32:35], v[92:95], v[80:83], v[32:35]
    ds_read_b128 v[60:63], v2 offset:49152
    s_bfe_u32 s40, s94, 0x40014
    s_add_u32 s40, s89, s40
    s_and_b32 s40, s40, 15
    s_mul_i32 s41, s40, 393216
    s_lshl_b32 s40, s40, 7
    s_add_u32 s40, s40, s36
    s_add_u32 s42, s41, s47
    s_add_u32 s41, s41, s38
    s_add_u32 m0, s45, 106496
    s_nop 0
    buffer_load_dwordx4 v8, s[16:19], s42 offen lds
    v_mfma_f32_16x16x32_bf16 v[20:23], v[88:91], v[64:67], v[20:23]
    ds_read_b64_tr_b16 v[116:117], v11 offset:49152
    ds_read_b64_tr_b16 v[118:119], v11 offset:49664
    s_add_u32 m0, s43, 106496
    s_nop 0
    buffer_load_dwordx4 v9, s[16:19], s42 offen lds
    v_mfma_f32_16x16x32_bf16 v[36:39], v[88:91], v[80:83], v[36:39]
    ds_read_b128 v[132:135], v2 offset:51200
    s_bfe_u32 s40, s95, 0x40008
    s_add_u32 s40, s89, s40
    s_and_b32 s40, s40, 15
    s_mul_i32 s41, s40, 393216
    s_lshl_b32 s40, s40, 7
    s_add_u32 s40, s40, s36
    s_add_u32 s42, s41, s47
    s_add_u32 s41, s41, s38
    s_add_u32 m0, s44, 32768
    s_add_u32 s46, s40, 0
    buffer_load_dwordx4 v5, s[12:15], s46 offen lds
    v_mfma_f32_16x16x32_bf16 v[24:27], v[100:103], v[64:67], v[24:27]
    ds_read_b64_tr_b16 v[124:125], v12 offset:49152
    ds_read_b64_tr_b16 v[126:127], v12 offset:49664
    s_add_u32 m0, s44, 33792
    s_add_u32 s46, s40, 16384
    buffer_load_dwordx4 v6, s[12:15], s46 offen lds
    v_mfma_f32_16x16x32_bf16 v[40:43], v[100:103], v[80:83], v[40:43]
    ds_read_b128 v[68:71], v3 offset:49152
    s_add_u32 m0, s44, 34816
    s_add_u32 s46, s40, 32768
    buffer_load_dwordx4 v5, s[12:15], s46 offen lds
    v_mfma_f32_16x16x32_bf16 v[28:31], v[108:111], v[64:67], v[28:31]
    ds_read_b64_tr_b16 v[76:77], v13 offset:49152
    ds_read_b64_tr_b16 v[78:79], v13 offset:49664
    s_add_u32 m0, s44, 35840
    s_add_u32 s46, s40, 49152
    buffer_load_dwordx4 v6, s[12:15], s46 offen lds
    v_mfma_f32_16x16x32_bf16 v[44:47], v[108:111], v[80:83], v[44:47]
    ds_read_b128 v[152:155], v3 offset:51200
    s_add_u32 m0, s45, 114688
    s_add_u32 s46, s41, 2048
    buffer_load_dwordx4 v8, s[16:19], s46 offen lds
    s_add_u32 m0, s43, 114688
    s_add_u32 s46, s41, 2048
    buffer_load_dwordx4 v9, s[16:19], s46 offen lds
    s_add_u32 m0, s45, 122880
    s_add_u32 s46, s41, 4096
    buffer_load_dwordx4 v8, s[16:19], s46 offen lds
    s_waitcnt vmcnt(17) lgkmcnt(0)
    s_barrier
    s_add_u32 m0, s43, 122880
    s_add_u32 s46, s41, 4096
    buffer_load_dwordx4 v9, s[16:19], s46 offen lds
    v_mfma_f32_16x16x32_bf16 v[16:19], v[56:59], v[112:115], v[16:19]
    ds_read_b64_tr_b16 v[148:149], v10 offset:53248
    ds_read_b64_tr_b16 v[150:151], v10 offset:53760
    s_bfe_u32 s40, s95, 0x4000c
    s_add_u32 s40, s89, s40
    s_and_b32 s40, s40, 15
    s_mul_i32 s41, s40, 393216
    s_lshl_b32 s40, s40, 7
    s_add_u32 s40, s40, s36
    s_add_u32 s42, s41, s47
    s_add_u32 s41, s41, s38
    s_add_u32 m0, s44, 49152
    s_add_u32 s46, s40, 0
    buffer_load_dwordx4 v5, s[12:15], s46 offen lds
    v_mfma_f32_16x16x32_bf16 v[32:35], v[56:59], v[120:123], v[32:35]
    ds_read_b128 v[84:87], v2 offset:0
    s_add_u32 m0, s44, 50176
    s_add_u32 s46, s40, 16384
    buffer_load_dwordx4 v6, s[12:15], s46 offen lds
    v_mfma_f32_16x16x32_bf16 v[20:23], v[116:119], v[112:115], v[20:23]
    ds_read_b64_tr_b16 v[156:157], v11 offset:53248
    ds_read_b64_tr_b16 v[158:159], v11 offset:53760
    s_add_u32 m0, s44, 51200
    s_add_u32 s46, s40, 32768
    buffer_load_dwordx4 v5, s[12:15], s46 offen lds
    v_mfma_f32_16x16x32_bf16 v[36:39], v[116:119], v[120:123], v[36:39]
    ds_read_b128 v[92:95], v2 offset:2048
    s_add_u32 m0, s44, 52224
    s_add_u32 s46, s40, 49152
    buffer_load_dwordx4 v6, s[12:15], s46 offen lds
    v_mfma_f32_16x16x32_bf16 v[24:27], v[124:127], v[112:115], v[24:27]
    ds_read_b64_tr_b16 v[88:89], v12 offset:53248
    ds_read_b64_tr_b16 v[90:91], v12 offset:53760
    s_add_u32 m0, s45, 65536
    s_add_u32 s46, s41, 2048
    buffer_load_dwordx4 v8, s[16:19], s46 offen lds
    v_mfma_f32_16x16x32_bf16 v[40:43], v[124:127], v[120:123], v[40:43]
    ds_read_b128 v[100:103], v3 offset:0
    s_add_u32 m0, s43, 65536
    s_add_u32 s46, s41, 2048
    buffer_load_dwordx4 v9, s[16:19], s46 offen lds
    v_mfma_f32_16x16x32_bf16 v[28:31], v[76:79], v[112:115], v[28:31]
    ds_read_b64_tr_b16 v[64:65], v13 offset:53248
    ds_read_b64_tr_b16 v[66:67], v13 offset:53760
    s_add_u32 m0, s45, 131072
    s_add_u32 s46, s41, 4096
    buffer_load_dwordx4 v8, s[16:19], s46 offen lds
    v_mfma_f32_16x16x32_bf16 v[44:47], v[76:79], v[120:123], v[44:47]
    ds_read_b128 v[108:111], v3 offset:2048
    s_add_u32 m0, s43, 131072
    s_add_u32 s46, s41, 4096
    buffer_load_dwordx4 v9, s[16:19], s46 offen lds
    s_waitcnt vmcnt(16) lgkmcnt(0)
    s_barrier
    s_bfe_u32 s40, s95, 0x40010
    s_add_u32 s40, s89, s40
    s_and_b32 s40, s40, 15
    s_mul_i32 s41, s40, 393216
    s_lshl_b32 s40, s40, 7
    s_add_u32 s40, s40, s36
    s_add_u32 s42, s41, s47
    s_add_u32 s41, s41, s38
    s_add_u32 m0, s44, 0
    s_add_u32 s46, s40, 0
    buffer_load_dwordx4 v5, s[12:15], s46 offen lds
    v_mfma_f32_16x16x32_bf16 v[16:19], v[148:151], v[128:131], v[16:19]
    ds_read_b64_tr_b16 v[80:81], v10 offset:16384
    ds_read_b64_tr_b16 v[82:83], v10 offset:16896
    s_add_u32 m0, s44, 1024
    s_add_u32 s46, s40, 16384
    buffer_load_dwordx4 v6, s[12:15], s46 offen lds
    v_mfma_f32_16x16x32_bf16 v[32:35], v[148:151], v[136:139], v[32:35]
    ds_read_b128 v[56:59], v2 offset:16384
    s_add_u32 m0, s44, 2048
    s_add_u32 s46, s40, 32768
    buffer_load_dwordx4 v5, s[12:15], s46 offen lds
    v_mfma_f32_16x16x32_bf16 v[20:23], v[156:159], v[128:131], v[20:23]
    ds_read_b64_tr_b16 v[116:117], v11 offset:16384
    ds_read_b64_tr_b16 v[118:119], v11 offset:16896
    s_add_u32 m0, s44, 3072
    s_add_u32 s46, s40, 49152
    buffer_load_dwordx4 v6, s[12:15], s46 offen lds
    v_mfma_f32_16x16x32_bf16 v[36:39], v[156:159], v[136:139], v[36:39]
    ds_read_b128 v[124:127], v2 offset:18432
    s_add_u32 m0, s45, 73728
    s_add_u32 s46, s41, 2048
    buffer_load_dwordx4 v8, s[16:19], s46 offen lds
    v_mfma_f32_16x16x32_bf16 v[24:27], v[88:91], v[128:131], v[24:27]
    ds_read_b64_tr_b16 v[112:113], v12 offset:16384
    ds_read_b64_tr_b16 v[114:115], v12 offset:16896
    s_add_u32 m0, s43, 73728
    s_add_u32 s46, s41, 2048
    buffer_load_dwordx4 v9, s[16:19], s46 offen lds
    v_mfma_f32_16x16x32_bf16 v[40:43], v[88:91], v[136:139], v[40:43]
    ds_read_b128 v[76:79], v3 offset:16384
    s_add_u32 m0, s45, 81920
    s_add_u32 s46, s41, 4096
    buffer_load_dwordx4 v8, s[16:19], s46 offen lds
    v_mfma_f32_16x16x32_bf16 v[28:31], v[64:67], v[128:131], v[28:31]
    ds_read_b64_tr_b16 v[120:121], v13 offset:16384
    ds_read_b64_tr_b16 v[122:123], v13 offset:16896
    s_add_u32 m0, s43, 81920
    s_add_u32 s46, s41, 4096
    buffer_load_dwordx4 v9, s[16:19], s46 offen lds
    v_mfma_f32_16x16x32_bf16 v[44:47], v[64:67], v[136:139], v[44:47]
    ds_read_b128 v[148:151], v3 offset:18432
    s_waitcnt vmcnt(16) lgkmcnt(0)
    s_barrier
    s_bfe_u32 s40, s95, 0x40014
    s_add_u32 s40, s89, s40
    s_and_b32 s40, s40, 15
    s_mul_i32 s41, s40, 393216
    s_lshl_b32 s40, s40, 7
    s_add_u32 s40, s40, s36
    s_add_u32 s42, s41, s47
    s_add_u32 s41, s41, s38
    s_add_u32 m0, s44, 16384
    s_add_u32 s46, s40, 0
    buffer_load_dwordx4 v5, s[12:15], s46 offen lds
    v_mfma_f32_16x16x32_bf16 v[16:19], v[80:83], v[140:143], v[16:19]
    ds_read_b64_tr_b16 v[156:157], v10 offset:20480
    ds_read_b64_tr_b16 v[158:159], v10 offset:20992
    s_add_u32 m0, s44, 17408
    s_add_u32 s46, s40, 16384
    buffer_load_dwordx4 v6, s[12:15], s46 offen lds
    v_mfma_f32_16x16x32_bf16 v[32:35], v[80:83], v[144:147], v[32:35]
    ds_read_b128 v[88:91], v2 offset:32768
    s_add_u32 m0, s44, 18432
    s_add_u32 s46, s40, 32768
    buffer_load_dwordx4 v5, s[12:15], s46 offen lds
    v_mfma_f32_16x16x32_bf16 v[20:23], v[116:119], v[140:143], v[20:23]
    ds_read_b64_tr_b16 v[128:129], v11 offset:20480
    ds_read_b64_tr_b16 v[130:131], v11 offset:20992
    s_add_u32 m0, s44, 19456
    s_add_u32 s46, s40, 49152
    buffer_load_dwordx4 v6, s[12:15], s46 offen lds
    v_mfma_f32_16x16x32_bf16 v[36:39], v[116:119], v[144:147], v[36:39]
    ds_read_b128 v[64:67], v2 offset:34816
    s_add_u32 m0, s45, 90112
    s_add_u32 s46, s41, 2048
    buffer_load_dwordx4 v8, s[16:19], s46 offen lds
    v_mfma_f32_16x16x32_bf16 v[24:27], v[112:115], v[140:143], v[24:27]
    ds_read_b64_tr_b16 v[136:137], v12 offset:20480
    ds_read_b64_tr_b16 v[138:139], v12 offset:20992
    s_add_u32 m0, s43, 90112
    s_add_u32 s46, s41, 2048
    buffer_load_dwordx4 v9, s[16:19], s46 offen lds
    v_mfma_f32_16x16x32_bf16 v[40:43], v[112:115], v[144:147], v[40:43]
    ds_read_b128 v[80:83], v3 offset:32768
    s_add_u32 m0, s45, 98304
    s_add_u32 s46, s41, 4096
    buffer_load_dwordx4 v8, s[16:19], s46 offen lds
    v_mfma_f32_16x16x32_bf16 v[28:31], v[120:123], v[140:143], v[28:31]
    ds_read_b64_tr_b16 v[116:117], v13 offset:20480
    ds_read_b64_tr_b16 v[118:119], v13 offset:20992
    s_add_u32 m0, s43, 98304
    s_add_u32 s46, s41, 4096
    buffer_load_dwordx4 v9, s[16:19], s46 offen lds
    v_mfma_f32_16x16x32_bf16 v[44:47], v[120:123], v[144:147], v[44:47]
    ds_read_b128 v[112:115], v3 offset:34816
    s_waitcnt vmcnt(16) lgkmcnt(0)
    s_barrier
    s_bfe_u32 s40, s95, 0x40018
    s_add_u32 s40, s89, s40
    s_and_b32 s40, s40, 15
    s_mul_i32 s41, s40, 393216
    s_lshl_b32 s40, s40, 7
    s_add_u32 s40, s40, s36
    s_add_u32 s42, s41, s47
    s_add_u32 s41, s41, s38
    s_add_u32 m0, s44, 32768
    s_add_u32 s46, s40, 0
    buffer_load_dwordx4 v5, s[12:15], s46 offen lds
    v_mfma_f32_16x16x32_bf16 v[16:19], v[156:159], v[160:163], v[16:19]
    ds_read_b128 v[140:143], v2 offset:49152
    s_add_u32 m0, s44, 33792
    s_add_u32 s46, s40, 16384
    buffer_load_dwordx4 v6, s[12:15], s46 offen lds
    v_mfma_f32_16x16x32_bf16 v[32:35], v[156:159], v[72:75], v[32:35]
    ds_read_b128 v[120:123], v2 offset:51200
    s_add_u32 m0, s44, 34816
    s_add_u32 s46, s40, 32768
    buffer_load_dwordx4 v5, s[12:15], s46 offen lds
    v_mfma_f32_16x16x32_bf16 v[20:23], v[128:131], v[160:163], v[20:23]
    ds_read_b128 v[144:147], v3 offset:49152
    s_add_u32 m0, s44, 35840
    s_add_u32 s46, s40, 49152
    buffer_load_dwordx4 v6, s[12:15], s46 offen lds
    v_mfma_f32_16x16x32_bf16 v[36:39], v[128:131], v[72:75], v[36:39]
    ds_read_b128 v[156:159], v3 offset:51200
    s_add_u32 m0, s45, 106496
    s_add_u32 s46, s41, 2048
    buffer_load_dwordx4 v8, s[16:19], s46 offen lds
    v_mfma_f32_16x16x32_bf16 v[24:27], v[136:139], v[160:163], v[24:27]
    s_add_u32 m0, s43, 106496
    s_add_u32 s46, s41, 2048
    buffer_load_dwordx4 v9, s[16:19], s46 offen lds
    v_mfma_f32_16x16x32_bf16 v[40:43], v[136:139], v[72:75], v[40:43]
    s_add_u32 m0, s45, 114688
    s_add_u32 s46, s41, 4096
    buffer_load_dwordx4 v8, s[16:19], s46 offen lds
    v_mfma_f32_16x16x32_bf16 v[28:31], v[116:119], v[160:163], v[28:31]
    s_add_u32 m0, s43, 114688
    s_add_u32 s46, s41, 4096
    buffer_load_dwordx4 v9, s[16:19], s46 offen lds
    v_mfma_f32_16x16x32_bf16 v[44:47], v[116:119], v[72:75], v[44:47]
    s_waitcnt vmcnt(16) lgkmcnt(0)
    s_barrier
    s_bfe_u32 s40, s95, 0x4001c
    s_add_u32 s40, s89, s40
    s_and_b32 s40, s40, 15
    s_mul_i32 s41, s40, 393216
    s_lshl_b32 s40, s40, 7
    s_add_u32 s40, s40, s36
    s_add_u32 s42, s41, s47
    s_add_u32 s41, s41, s38
    s_add_u32 m0, s44, 49152
    s_add_u32 s46, s40, 0
    buffer_load_dwordx4 v5, s[12:15], s46 offen lds
    s_add_u32 m0, s44, 50176
    s_add_u32 s46, s40, 16384
    buffer_load_dwordx4 v6, s[12:15], s46 offen lds
    s_add_u32 m0, s44, 51200
    s_add_u32 s46, s40, 32768
    buffer_load_dwordx4 v5, s[12:15], s46 offen lds
    s_add_u32 m0, s44, 52224
    s_add_u32 s46, s40, 49152
    buffer_load_dwordx4 v6, s[12:15], s46 offen lds
    s_add_u32 m0, s45, 65536
    s_add_u32 s46, s41, 2048
    buffer_load_dwordx4 v8, s[16:19], s46 offen lds
    s_add_u32 m0, s43, 65536
    s_add_u32 s46, s41, 2048
    buffer_load_dwordx4 v9, s[16:19], s46 offen lds
    s_add_u32 m0, s45, 122880
    s_add_u32 s46, s41, 4096
    buffer_load_dwordx4 v8, s[16:19], s46 offen lds
    s_add_u32 m0, s43, 122880
    s_add_u32 s46, s41, 4096
    buffer_load_dwordx4 v9, s[16:19], s46 offen lds
    s_waitcnt vmcnt(16)
    s_barrier
    s_bfe_u32 s40, s94, 0x40018
    s_add_u32 s40, s89, s40
    s_and_b32 s40, s40, 15
    s_mul_i32 s41, s40, 393216
    s_lshl_b32 s40, s40, 7
    s_add_u32 s40, s40, s36
    s_add_u32 s42, s41, s47
    s_add_u32 s41, s41, s38
    s_add_u32 m0, s45, 147456
    s_nop 0
    buffer_load_dwordx4 v8, s[16:19], s42 offen lds
    s_add_u32 m0, s43, 147456
    s_nop 0
    buffer_load_dwordx4 v9, s[16:19], s42 offen lds
    s_waitcnt vmcnt(10)
    s_barrier
    s_bfe_u32 s40, s95, 0x40010
    s_add_u32 s40, s89, s40
    s_and_b32 s40, s40, 15
    s_mul_i32 s41, s40, 393216
    s_lshl_b32 s40, s40, 7
    s_add_u32 s40, s40, s36
    s_add_u32 s42, s41, s47
    s_add_u32 s41, s41, s38
    s_add_u32 m0, s45, 139264
    s_nop 0
    buffer_load_dwordx4 v8, s[16:19], s42 offen lds
    s_add_u32 m0, s43, 139264
    s_nop 0
    buffer_load_dwordx4 v9, s[16:19], s42 offen lds
    s_waitcnt vmcnt(4)
    s_barrier
    s_bfe_u32 s40, s95, 0x40014
    s_add_u32 s40, s89, s40
    s_and_b32 s40, s40, 15
    s_mul_i32 s41, s40, 393216
    s_lshl_b32 s40, s40, 7
    s_add_u32 s40, s40, s36
    s_add_u32 s42, s41, s47
    s_add_u32 s41, s41, s38
    s_add_u32 m0, s45, 131072
    s_nop 0
    buffer_load_dwordx4 v8, s[16:19], s42 offen lds
    s_add_u32 m0, s43, 131072
    s_nop 0
    buffer_load_dwordx4 v9, s[16:19], s42 offen lds
    s_setprio 1
    v_and_b32 v14, 15, v0
    v_lshlrev_b32 v14, 2, v14
    s_lshl_b32 s50, s3, 7
    s_add_u32 s50, s50, 155648
    v_add_u32 v14, s50, v14
    v_and_b32 v15, 0x30, v0
    v_add_u32 v15, 158208, v15
    v_and_b32 v165, 0xfffffff7, v1

    ds_read_b32 v7, v165 offset:48
FW_1:
    s_waitcnt lgkmcnt(0)
    v_cmp_gt_u32 vcc, 1, v7
    s_cbranch_vccz FO_2
    s_sleep 1
    ds_read_b32 v7, v165 offset:48
    s_branch FW_1
FO_2:
    ds_read2_b32 v[72:73], v14 offset0:0 offset1:0
    ds_read2_b32 v[74:75], v14 offset0:16 offset1:16
    ds_read_b128 v[128:131], v15 offset:0
    ds_read_b128 v[136:139], v15 offset:64
    ds_read_b128 v[160:163], v15 offset:128
    ds_read_b128 v[116:119], v15 offset:192
    v_add_u32 v14, 1024, v14
    s_waitcnt lgkmcnt(3)
    v_fmac_f32 v16, v128, v72
    v_fmac_f32 v17, v129, v72
    v_fmac_f32 v18, v130, v72
    v_fmac_f32 v19, v131, v72
    v_fmac_f32 v32, v128, v74
    s_branch IW_s1
IW_w1:
    s_branch IW_r1
IW_s1:
    v_fmac_f32 v33, v129, v74
    v_fmac_f32 v34, v130, v74
    v_fmac_f32 v35, v131, v74
    s_waitcnt lgkmcnt(2)
    v_fmac_f32 v20, v136, v72
    v_fmac_f32 v21, v137, v72
    v_fmac_f32 v22, v138, v72
    v_fmac_f32 v23, v139, v72
    v_fmac_f32 v36, v136, v74
    v_fmac_f32 v37, v137, v74
    v_fmac_f32 v38, v138, v74
    v_fmac_f32 v39, v139, v74
    s_waitcnt lgkmcnt(1)
    v_fmac_f32 v24, v160, v72
    v_fmac_f32 v25, v161, v72
    v_fmac_f32 v26, v162, v72
    v_fmac_f32 v27, v163, v72
    v_fmac_f32 v40, v160, v74
    v_fmac_f32 v41, v161, v74
    v_fmac_f32 v42, v162, v74
    v_fmac_f32 v43, v163, v74
    s_waitcnt lgkmcnt(0)
    v_fmac_f32 v28, v116, v72
    v_fmac_f32 v29, v117, v72
    v_fmac_f32 v30, v118, v72
    v_fmac_f32 v31, v119, v72
    v_fmac_f32 v44, v116, v74
    v_fmac_f32 v45, v117, v74
    v_fmac_f32 v46, v118, v74
    v_fmac_f32 v47, v119, v74
    s_setprio 3
    s_waitcnt vmcnt(6)
    s_barrier
    s_bfe_u32 s40, s95, 0x40018
    s_add_u32 s40, s89, s40
    s_and_b32 s40, s40, 15
    s_mul_i32 s41, s40, 393216
    s_lshl_b32 s40, s40, 7
    s_add_u32 s40, s40, s36
    s_add_u32 s42, s41, s47
    s_add_u32 s41, s41, s38
    s_add_u32 m0, s45, 81920
    s_nop 0
    buffer_load_dwordx4 v8, s[16:19], s42 offen lds
    s_add_u32 m0, s43, 81920
    s_nop 0
    buffer_load_dwordx4 v9, s[16:19], s42 offen lds
    s_bfe_u32 s40, s95, 0x4001c
    s_add_u32 s40, s89, s40
    s_and_b32 s40, s40, 15
    s_mul_i32 s41, s40, 393216
    s_lshl_b32 s40, s40, 7
    s_add_u32 s40, s40, s36
    s_add_u32 s42, s41, s47
    s_add_u32 s41, s41, s38
    s_add_u32 m0, s45, 73728
    s_nop 0
    buffer_load_dwordx4 v8, s[16:19], s42 offen lds
    s_add_u32 m0, s43, 73728
    s_nop 0
    buffer_load_dwordx4 v9, s[16:19], s42 offen lds
    s_bfe_u32 s40, s94, 0x4001c
    s_add_u32 s40, s89, s40
    s_and_b32 s40, s40, 15
    s_mul_i32 s41, s40, 393216
    s_lshl_b32 s40, s40, 7
    s_add_u32 s40, s40, s36
    s_add_u32 s42, s41, s47
    s_add_u32 s41, s41, s38
    s_add_u32 m0, s45, 98304
    s_nop 0
    buffer_load_dwordx4 v8, s[16:19], s42 offen lds
    s_add_u32 m0, s43, 98304
    s_nop 0
    buffer_load_dwordx4 v9, s[16:19], s42 offen lds
    s_bfe_u32 s40, s95, 0x40000
    s_add_u32 s40, s89, s40
    s_and_b32 s40, s40, 15
    s_mul_i32 s41, s40, 393216
    s_lshl_b32 s40, s40, 7
    s_add_u32 s40, s40, s36
    s_add_u32 s42, s41, s47
    s_add_u32 s41, s41, s38
    s_add_u32 m0, s45, 90112
    s_nop 0
    buffer_load_dwordx4 v8, s[16:19], s42 offen lds
    s_add_u32 m0, s43, 90112
    s_nop 0
    buffer_load_dwordx4 v9, s[16:19], s42 offen lds
    s_bfe_u32 s40, s95, 0x40004
    s_add_u32 s40, s89, s40
    s_and_b32 s40, s40, 15
    s_mul_i32 s41, s40, 393216
    s_lshl_b32 s40, s40, 7
    s_add_u32 s40, s40, s36
    s_add_u32 s42, s41, s47
    s_add_u32 s41, s41, s38
    s_add_u32 m0, s45, 114688
    s_nop 0
    buffer_load_dwordx4 v8, s[16:19], s42 offen lds
    s_add_u32 m0, s43, 114688
    s_nop 0
    buffer_load_dwordx4 v9, s[16:19], s42 offen lds
    s_bfe_u32 s40, s95, 0x40008
    s_add_u32 s40, s89, s40
    s_and_b32 s40, s40, 15
    s_mul_i32 s41, s40, 393216
    s_lshl_b32 s40, s40, 7
    s_add_u32 s40, s40, s36
    s_add_u32 s42, s41, s47
    s_add_u32 s41, s41, s38
    s_add_u32 m0, s45, 106496
    s_nop 0
    buffer_load_dwordx4 v8, s[16:19], s42 offen lds
    s_add_u32 m0, s43, 106496
    s_nop 0
    buffer_load_dwordx4 v9, s[16:19], s42 offen lds
    s_bfe_u32 s40, s95, 0x4000c
    s_add_u32 s40, s89, s40
    s_and_b32 s40, s40, 15
    s_mul_i32 s41, s40, 393216
    s_lshl_b32 s40, s40, 7
    s_add_u32 s40, s40, s36
    s_add_u32 s42, s41, s47
    s_add_u32 s41, s41, s38
    s_add_u32 m0, s45, 122880
    s_nop 0
    buffer_load_dwordx4 v8, s[16:19], s42 offen lds
    s_add_u32 m0, s43, 122880
    s_nop 0
    buffer_load_dwordx4 v9, s[16:19], s42 offen lds
    s_setprio 2
    v_subrev_u32 v5, 24576, v10
    v_subrev_u32 v6, 24576, v11
    v_subrev_u32 v8, 24576, v12
    v_subrev_u32 v9, 24576, v13
    s_add_u32 s16, s72, 0x400000
    s_addc_u32 s17, s73, 0
    s_mov_b32 s18, 0x400000
    s_mov_b32 s19, 0x00020000
    s_add_u32 s24, s72, 0x800000
    s_addc_u32 s25, s73, 0
    s_mov_b32 s26, 0x48000
    s_mov_b32 s27, 0x00020000
    s_mov_b32 s40, 0x21317218
    s_mov_b32 s41, s40
    s_mov_b32 s74, 0x358637bd
    s_mov_b32 s75, s74
    s_mov_b32 s76, 0x5d800000
    s_mov_b32 s77, s76
    s_lshl_b32 s79, s32, 18
    s_lshl_b32 s80, s3, 16
    s_add_u32 s79, s79, s80
    s_lshl_b32 s80, s10, 11
    s_add_u32 s79, s79, s80
    s_add_u32 s80, s79, 0x8000
    s_lshl_b32 s45, s32, 2
    s_add_u32 s45, s45, s3
    s_lshl_b32 s45, s45, 10
    s_mov_b32 s46, 0x3fb8aa3b

    s_add_u32 s54, s45, 0x835000
    s_add_u32 s54, s72, s54
    s_addc_u32 s55, s73, 0
    s_waitcnt vmcnt(8)
    s_mov_b64 exec, 1
    ds_add_u32 v4, v164 offset:112
    s_mov_b64 exec, -1
    ds_read_b32 v7, v1 offset:32
FW_3:
    s_waitcnt lgkmcnt(0)
    v_cmp_gt_u32 vcc, 1, v7
    s_cbranch_vccz FO_4
    s_sleep 2
    ds_read_b32 v7, v1 offset:32
    s_branch FW_3
FO_4:
    ds_read_b32 v7, v1 offset:112
FW_5:
    s_waitcnt lgkmcnt(0)
    v_cmp_gt_u32 vcc, 1, v7
    s_cbranch_vccz FO_6
    ds_read_b32 v7, v1 offset:112
    s_branch FW_5
FO_6:
    ds_read_b64_tr_b16 v[128:129], v10 offset:57344
    ds_read_b64_tr_b16 v[130:131], v10 offset:57856
    ds_read_b64_tr_b16 v[136:137], v11 offset:57344
    ds_read_b64_tr_b16 v[138:139], v11 offset:57856
    ds_read_b64_tr_b16 v[160:161], v12 offset:57344
    ds_read_b64_tr_b16 v[162:163], v12 offset:57856
    ds_read_b64_tr_b16 v[116:117], v13 offset:57344
    ds_read_b64_tr_b16 v[118:119], v13 offset:57856
    ds_read_b64_tr_b16 v[72:73], v10 offset:61440
    ds_read_b64_tr_b16 v[74:75], v10 offset:61952
    s_waitcnt lgkmcnt(8)
    v_mfma_f32_16x16x32_bf16 v[16:19], v[128:131], v[48:51], v[16:19]
    v_mfma_f32_16x16x32_bf16 v[32:35], v[128:131], v[52:55], v[32:35]
    ds_read_b64_tr_b16 v[128:129], v11 offset:61440
    ds_read_b64_tr_b16 v[130:131], v11 offset:61952
    s_waitcnt lgkmcnt(8)
    v_mfma_f32_16x16x32_bf16 v[20:23], v[136:139], v[48:51], v[20:23]
    v_mfma_f32_16x16x32_bf16 v[36:39], v[136:139], v[52:55], v[36:39]
    ds_read_b64_tr_b16 v[136:137], v12 offset:61440
    ds_read_b64_tr_b16 v[138:139], v12 offset:61952
    s_waitcnt lgkmcnt(8)
    v_mfma_f32_16x16x32_bf16 v[24:27], v[160:163], v[48:51], v[24:27]
    v_mfma_f32_16x16x32_bf16 v[40:43], v[160:163], v[52:55], v[40:43]
    ds_read_b64_tr_b16 v[160:161], v13 offset:61440
    ds_read_b64_tr_b16 v[162:163], v13 offset:61952
    s_waitcnt lgkmcnt(8)
    v_mfma_f32_16x16x32_bf16 v[28:31], v[116:119], v[48:51], v[28:31]
    ds_read_b128 v[48:51], v2 offset:0
    v_mfma_f32_16x16x32_bf16 v[44:47], v[116:119], v[52:55], v[44:47]
    ds_read_b64_tr_b16 v[116:117], v10 offset:49152
    ds_read_b64_tr_b16 v[118:119], v10 offset:49664
    s_waitcnt lgkmcnt(9)
    v_mfma_f32_16x16x32_bf16 v[16:19], v[72:75], v[96:99], v[16:19]
    ds_read_b128 v[52:55], v2 offset:2048
    v_mfma_f32_16x16x32_bf16 v[32:35], v[72:75], v[104:107], v[32:35]
    ds_read_b64_tr_b16 v[72:73], v11 offset:49152
    ds_read_b64_tr_b16 v[74:75], v11 offset:49664
    s_waitcnt lgkmcnt(10)
    v_mfma_f32_16x16x32_bf16 v[20:23], v[128:131], v[96:99], v[20:23]
    v_mfma_f32_16x16x32_bf16 v[36:39], v[128:131], v[104:107], v[36:39]
    ds_read_b64_tr_b16 v[128:129], v12 offset:49152
    ds_read_b64_tr_b16 v[130:131], v12 offset:49664
    s_waitcnt lgkmcnt(10)
    v_mfma_f32_16x16x32_bf16 v[24:27], v[136:139], v[96:99], v[24:27]
    v_mfma_f32_16x16x32_bf16 v[40:43], v[136:139], v[104:107], v[40:43]
    ds_read_b64_tr_b16 v[136:137], v13 offset:49152
    ds_read_b64_tr_b16 v[138:139], v13 offset:49664
    s_waitcnt lgkmcnt(10)
    v_mfma_f32_16x16x32_bf16 v[28:31], v[160:163], v[96:99], v[28:31]
    ds_read_b128 v[96:99], v3 offset:0
    v_mfma_f32_16x16x32_bf16 v[44:47], v[160:163], v[104:107], v[44:47]
    ds_read_b64_tr_b16 v[160:161], v10 offset:53248
    ds_read_b64_tr_b16 v[162:163], v10 offset:53760
    s_waitcnt lgkmcnt(10)
    v_mfma_f32_16x16x32_bf16 v[16:19], v[116:119], v[48:51], v[16:19]
    ds_read_b128 v[104:107], v3 offset:2048
    s_waitcnt lgkmcnt(10)
    v_mfma_f32_16x16x32_bf16 v[32:35], v[116:119], v[52:55], v[32:35]
    ds_read_b64_tr_b16 v[116:117], v11 offset:53248
    ds_read_b64_tr_b16 v[118:119], v11 offset:53760
    s_waitcnt lgkmcnt(10)
    v_mfma_f32_16x16x32_bf16 v[20:23], v[72:75], v[48:51], v[20:23]
    v_mfma_f32_16x16x32_bf16 v[36:39], v[72:75], v[52:55], v[36:39]
    ds_read_b64_tr_b16 v[72:73], v12 offset:53248
    ds_read_b64_tr_b16 v[74:75], v12 offset:53760
    s_waitcnt lgkmcnt(10)
    v_mfma_f32_16x16x32_bf16 v[24:27], v[128:131], v[48:51], v[24:27]
    v_mfma_f32_16x16x32_bf16 v[40:43], v[128:131], v[52:55], v[40:43]
    ds_read_b64_tr_b16 v[128:129], v13 offset:53248
    ds_read_b64_tr_b16 v[130:131], v13 offset:53760
    s_waitcnt lgkmcnt(10)
    v_mfma_f32_16x16x32_bf16 v[28:31], v[136:139], v[48:51], v[28:31]
    ds_read_b128 v[48:51], v2 offset:16384
    v_mfma_f32_16x16x32_bf16 v[44:47], v[136:139], v[52:55], v[44:47]
    ds_read_b64_tr_b16 v[136:137], v10 offset:40960
    ds_read_b64_tr_b16 v[138:139], v10 offset:41472
    s_waitcnt lgkmcnt(10)
    v_mfma_f32_16x16x32_bf16 v[16:19], v[160:163], v[96:99], v[16:19]
    ds_read_b128 v[52:55], v2 offset:18432
    s_waitcnt lgkmcnt(10)
    v_mfma_f32_16x16x32_bf16 v[32:35], v[160:163], v[104:107], v[32:35]
    ds_read_b64_tr_b16 v[160:161], v11 offset:40960
    ds_read_b64_tr_b16 v[162:163], v11 offset:41472
    s_waitcnt lgkmcnt(10)
    v_mfma_f32_16x16x32_bf16 v[20:23], v[116:119], v[96:99], v[20:23]
    v_mfma_f32_16x16x32_bf16 v[36:39], v[116:119], v[104:107], v[36:39]
    ds_read_b64_tr_b16 v[116:117], v12 offset:40960
    ds_read_b64_tr_b16 v[118:119], v12 offset:41472
    s_waitcnt lgkmcnt(8)
    v_mov_b32 v165, 2
    s_mov_b64 exec, 1
    ds_write_b32 v4, v165 offset:0
    s_mov_b64 exec, -1
    v_mfma_f32_16x16x32_bf16 v[24:27], v[72:75], v[96:99], v[24:27]
    v_mfma_f32_16x16x32_bf16 v[40:43], v[72:75], v[104:107], v[40:43]
    ds_read_b64_tr_b16 v[72:73], v13 offset:40960
    ds_read_b64_tr_b16 v[74:75], v13 offset:41472
    v_mfma_f32_16x16x32_bf16 v[28:31], v[128:131], v[96:99], v[28:31]
    ds_read_b128 v[96:99], v3 offset:16384
    v_mfma_f32_16x16x32_bf16 v[44:47], v[128:131], v[104:107], v[44:47]
    ds_read_b64_tr_b16 v[128:129], v10 offset:45056
    ds_read_b64_tr_b16 v[130:131], v10 offset:45568
    s_waitcnt lgkmcnt(11)
    v_mfma_f32_16x16x32_bf16 v[16:19], v[136:139], v[48:51], v[16:19]
    ds_read_b128 v[104:107], v3 offset:18432
    s_waitcnt lgkmcnt(11)
    v_mfma_f32_16x16x32_bf16 v[32:35], v[136:139], v[52:55], v[32:35]
    ds_read_b64_tr_b16 v[136:137], v11 offset:45056
    ds_read_b64_tr_b16 v[138:139], v11 offset:45568
    s_waitcnt lgkmcnt(11)
    v_mfma_f32_16x16x32_bf16 v[20:23], v[160:163], v[48:51], v[20:23]
    v_mfma_f32_16x16x32_bf16 v[36:39], v[160:163], v[52:55], v[36:39]
    ds_read_b64_tr_b16 v[160:161], v12 offset:45056
    ds_read_b64_tr_b16 v[162:163], v12 offset:45568
    s_waitcnt lgkmcnt(11)
    v_mfma_f32_16x16x32_bf16 v[24:27], v[116:119], v[48:51], v[24:27]
    v_mfma_f32_16x16x32_bf16 v[40:43], v[116:119], v[52:55], v[40:43]
    ds_read_b64_tr_b16 v[116:117], v13 offset:45056
    ds_read_b64_tr_b16 v[118:119], v13 offset:45568
    s_waitcnt lgkmcnt(10)
    v_mfma_f32_16x16x32_bf16 v[28:31], v[72:75], v[48:51], v[28:31]
    ds_read_b128 v[48:51], v2 offset:32768
    v_mfma_f32_16x16x32_bf16 v[44:47], v[72:75], v[52:55], v[44:47]
    ds_read_b64_tr_b16 v[72:73], v5 offset:16384
    ds_read_b64_tr_b16 v[74:75], v5 offset:16896
    s_waitcnt lgkmcnt(10)
    v_mfma_f32_16x16x32_bf16 v[16:19], v[128:131], v[96:99], v[16:19]
    ds_read_b128 v[52:55], v2 offset:34816
    s_waitcnt lgkmcnt(10)
    v_mfma_f32_16x16x32_bf16 v[32:35], v[128:131], v[104:107], v[32:35]
    ds_read_b64_tr_b16 v[128:129], v6 offset:16384
    ds_read_b64_tr_b16 v[130:131], v6 offset:16896
    s_waitcnt lgkmcnt(10)
    v_mfma_f32_16x16x32_bf16 v[20:23], v[136:139], v[96:99], v[20:23]
    v_mfma_f32_16x16x32_bf16 v[36:39], v[136:139], v[104:107], v[36:39]
    ds_read_b64_tr_b16 v[136:137], v8 offset:16384
    ds_read_b64_tr_b16 v[138:139], v8 offset:16896
    s_waitcnt lgkmcnt(10)
    v_mfma_f32_16x16x32_bf16 v[24:27], v[160:163], v[96:99], v[24:27]
    v_mfma_f32_16x16x32_bf16 v[40:43], v[160:163], v[104:107], v[40:43]
    ds_read_b64_tr_b16 v[160:161], v9 offset:16384
    ds_read_b64_tr_b16 v[162:163], v9 offset:16896
    s_waitcnt lgkmcnt(10)
    v_mfma_f32_16x16x32_bf16 v[28:31], v[116:119], v[96:99], v[28:31]
    ds_read_b128 v[96:99], v3 offset:32768
    v_mfma_f32_16x16x32_bf16 v[44:47], v[116:119], v[104:107], v[44:47]
    ds_read_b64_tr_b16 v[116:117], v5 offset:20480
    ds_read_b64_tr_b16 v[118:119], v5 offset:20992
    s_waitcnt lgkmcnt(10)
    v_mfma_f32_16x16x32_bf16 v[16:19], v[72:75], v[48:51], v[16:19]
    ds_read_b128 v[104:107], v3 offset:34816
    s_waitcnt lgkmcnt(10)
    v_mfma_f32_16x16x32_bf16 v[32:35], v[72:75], v[52:55], v[32:35]
    ds_read_b64_tr_b16 v[72:73], v6 offset:20480
    ds_read_b64_tr_b16 v[74:75], v6 offset:20992
    s_waitcnt lgkmcnt(10)
    v_mfma_f32_16x16x32_bf16 v[20:23], v[128:131], v[48:51], v[20:23]
    v_mfma_f32_16x16x32_bf16 v[36:39], v[128:131], v[52:55], v[36:39]
    ds_read_b64_tr_b16 v[128:129], v8 offset:20480
    ds_read_b64_tr_b16 v[130:131], v8 offset:20992
    s_waitcnt lgkmcnt(10)
    v_mfma_f32_16x16x32_bf16 v[24:27], v[136:139], v[48:51], v[24:27]
    v_mfma_f32_16x16x32_bf16 v[40:43], v[136:139], v[52:55], v[40:43]
    ds_read_b64_tr_b16 v[136:137], v9 offset:20480
    ds_read_b64_tr_b16 v[138:139], v9 offset:20992
    s_waitcnt lgkmcnt(10)
    v_mfma_f32_16x16x32_bf16 v[28:31], v[160:163], v[48:51], v[28:31]
    s_waitcnt vmcnt(0)
    s_mov_b64 exec, 1
    ds_add_u32 v4, v164 offset:112
    s_mov_b64 exec, -1
    ds_read_b128 v[48:51], v2 offset:49152
    v_mfma_f32_16x16x32_bf16 v[44:47], v[160:163], v[52:55], v[44:47]
    ds_read_b64_tr_b16 v[160:161], v5 offset:8192
    ds_read_b64_tr_b16 v[162:163], v5 offset:8704
    s_waitcnt lgkmcnt(11)
    v_mfma_f32_16x16x32_bf16 v[16:19], v[116:119], v[96:99], v[16:19]
    ds_read_b128 v[52:55], v2 offset:51200
    s_waitcnt lgkmcnt(11)
    v_mfma_f32_16x16x32_bf16 v[32:35], v[116:119], v[104:107], v[32:35]
    ds_read_b64_tr_b16 v[116:117], v6 offset:8192
    ds_read_b64_tr_b16 v[118:119], v6 offset:8704
    s_waitcnt lgkmcnt(11)
    v_mfma_f32_16x16x32_bf16 v[20:23], v[72:75], v[96:99], v[20:23]
    v_mfma_f32_16x16x32_bf16 v[36:39], v[72:75], v[104:107], v[36:39]
    ds_read_b64_tr_b16 v[72:73], v8 offset:8192
    ds_read_b64_tr_b16 v[74:75], v8 offset:8704
    s_waitcnt lgkmcnt(9)
    v_mov_b32 v165, 4
    s_mov_b64 exec, 1
    ds_write_b32 v4, v165 offset:0
    s_mov_b64 exec, -1
    v_mfma_f32_16x16x32_bf16 v[24:27], v[128:131], v[96:99], v[24:27]
    v_mfma_f32_16x16x32_bf16 v[40:43], v[128:131], v[104:107], v[40:43]
    ds_read_b64_tr_b16 v[128:129], v9 offset:8192
    ds_read_b64_tr_b16 v[130:131], v9 offset:8704
    v_mfma_f32_16x16x32_bf16 v[28:31], v[136:139], v[96:99], v[28:31]
    ds_read_b128 v[96:99], v3 offset:49152
    v_mfma_f32_16x16x32_bf16 v[44:47], v[136:139], v[104:107], v[44:47]
    ds_read_b64_tr_b16 v[136:137], v5 offset:12288
    ds_read_b64_tr_b16 v[138:139], v5 offset:12800
    s_waitcnt lgkmcnt(11)
    v_mfma_f32_16x16x32_bf16 v[16:19], v[160:163], v[48:51], v[16:19]
    ds_read_b128 v[104:107], v3 offset:51200
    s_waitcnt lgkmcnt(11)
    v_mfma_f32_16x16x32_bf16 v[32:35], v[160:163], v[52:55], v[32:35]
    ds_read_b64_tr_b16 v[160:161], v6 offset:12288
    ds_read_b64_tr_b16 v[162:163], v6 offset:12800
    s_waitcnt lgkmcnt(11)
    v_mfma_f32_16x16x32_bf16 v[20:23], v[116:119], v[48:51], v[20:23]
    v_mfma_f32_16x16x32_bf16 v[36:39], v[116:119], v[52:55], v[36:39]
    ds_read_b64_tr_b16 v[116:117], v8 offset:12288
    ds_read_b64_tr_b16 v[118:119], v8 offset:12800
    s_waitcnt lgkmcnt(11)
    v_mfma_f32_16x16x32_bf16 v[24:27], v[72:75], v[48:51], v[24:27]
    v_mfma_f32_16x16x32_bf16 v[40:43], v[72:75], v[52:55], v[40:43]
    ds_read_b64_tr_b16 v[72:73], v9 offset:12288
    ds_read_b64_tr_b16 v[74:75], v9 offset:12800
    s_waitcnt lgkmcnt(10)
    v_mfma_f32_16x16x32_bf16 v[28:31], v[128:131], v[48:51], v[28:31]
    ds_read_b64_tr_b16 v[48:49], v10 offset:8192
    v_mfma_f32_16x16x32_bf16 v[44:47], v[128:131], v[52:55], v[44:47]
    ds_read_b64_tr_b16 v[50:51], v10 offset:8704
    ds_read_b64_tr_b16 v[128:129], v11 offset:8192
    s_waitcnt lgkmcnt(10)
    v_mfma_f32_16x16x32_bf16 v[16:19], v[136:139], v[96:99], v[16:19]
    ds_read_b64_tr_b16 v[130:131], v11 offset:8704
    s_waitcnt lgkmcnt(10)
    v_mfma_f32_16x16x32_bf16 v[32:35], v[136:139], v[104:107], v[32:35]
    ds_read_b64_tr_b16 v[52:53], v12 offset:8192
    ds_read_b64_tr_b16 v[54:55], v12 offset:8704
    s_waitcnt lgkmcnt(10)
    v_mfma_f32_16x16x32_bf16 v[20:23], v[160:163], v[96:99], v[20:23]
    ds_read_b64_tr_b16 v[136:137], v13 offset:8192
    v_mfma_f32_16x16x32_bf16 v[36:39], v[160:163], v[104:107], v[36:39]
    ds_read_b64_tr_b16 v[138:139], v13 offset:8704
    ds_read_b64_tr_b16 v[160:161], v10 offset:12288
    s_waitcnt lgkmcnt(9)
    v_mov_b32 v165, 5
    s_mov_b64 exec, 1
    ds_write_b32 v4, v165 offset:0
    s_mov_b64 exec, -1
    v_mfma_f32_16x16x32_bf16 v[24:27], v[116:119], v[96:99], v[24:27]
    ds_read_b64_tr_b16 v[162:163], v10 offset:12800
    v_mfma_f32_16x16x32_bf16 v[40:43], v[116:119], v[104:107], v[40:43]
    ds_read_b64_tr_b16 v[116:117], v11 offset:12288
    ds_read_b64_tr_b16 v[118:119], v11 offset:12800
    v_mfma_f32_16x16x32_bf16 v[28:31], v[72:75], v[96:99], v[28:31]
    ds_read_b64_tr_b16 v[96:97], v12 offset:12288
    v_mfma_f32_16x16x32_bf16 v[44:47], v[72:75], v[104:107], v[44:47]
    ds_read_b64_tr_b16 v[98:99], v12 offset:12800
    s_waitcnt lgkmcnt(8)
    ds_read_b64_tr_b16 v[72:73], v13 offset:12288
    s_waitcnt lgkmcnt(14)
    v_mfma_f32_16x16x32_bf16 v[16:19], v[48:51], v[60:63], v[16:19]
    ds_read_b64_tr_b16 v[74:75], v13 offset:12800
    v_mfma_f32_16x16x32_bf16 v[32:35], v[48:51], v[132:135], v[32:35]
    ds_read_b32 v7, v1 offset:112
FW_7:
    s_waitcnt lgkmcnt(0)
    v_cmp_gt_u32 vcc, 2, v7
    s_cbranch_vccz FO_8
    ds_read_b32 v7, v1 offset:112
    s_branch FW_7
FO_8:
    ds_read_b64_tr_b16 v[104:105], v10 offset:0
    ds_read_b64_tr_b16 v[106:107], v10 offset:512
    v_mfma_f32_16x16x32_bf16 v[20:23], v[128:131], v[60:63], v[20:23]
    ds_read_b64_tr_b16 v[48:49], v11 offset:0
    v_mfma_f32_16x16x32_bf16 v[36:39], v[128:131], v[132:135], v[36:39]
    ds_read_b64_tr_b16 v[50:51], v11 offset:512
    ds_read_b64_tr_b16 v[128:129], v12 offset:0
    v_mfma_f32_16x16x32_bf16 v[24:27], v[52:55], v[60:63], v[24:27]
    ds_read_b64_tr_b16 v[130:131], v12 offset:512
    v_mfma_f32_16x16x32_bf16 v[40:43], v[52:55], v[132:135], v[40:43]
    ds_read_b64_tr_b16 v[52:53], v13 offset:0
    ds_read_b64_tr_b16 v[54:55], v13 offset:512
    v_mfma_f32_16x16x32_bf16 v[28:31], v[136:139], v[60:63], v[28:31]
    v_mfma_f32_16x16x32_bf16 v[44:47], v[136:139], v[132:135], v[44:47]
    v_mfma_f32_16x16x32_bf16 v[16:19], v[160:163], v[68:71], v[16:19]
    ds_read_b64_tr_b16 v[60:61], v10 offset:4096
    v_mfma_f32_16x16x32_bf16 v[32:35], v[160:163], v[152:155], v[32:35]
    ds_read_b64_tr_b16 v[62:63], v10 offset:4608
    ds_read_b64_tr_b16 v[136:137], v11 offset:4096
    v_mfma_f32_16x16x32_bf16 v[20:23], v[116:119], v[68:71], v[20:23]
    ds_read_b64_tr_b16 v[138:139], v11 offset:4608
    v_mfma_f32_16x16x32_bf16 v[36:39], v[116:119], v[152:155], v[36:39]
    ds_read_b64_tr_b16 v[132:133], v12 offset:4096
    ds_read_b64_tr_b16 v[134:135], v12 offset:4608
    v_mfma_f32_16x16x32_bf16 v[24:27], v[96:99], v[68:71], v[24:27]
    ds_read_b64_tr_b16 v[160:161], v13 offset:4096
    v_mfma_f32_16x16x32_bf16 v[40:43], v[96:99], v[152:155], v[40:43]
    s_waitcnt lgkmcnt(8)
    ds_read_b64_tr_b16 v[162:163], v13 offset:4608
    v_mfma_f32_16x16x32_bf16 v[28:31], v[72:75], v[68:71], v[28:31]
    v_mfma_f32_16x16x32_bf16 v[44:47], v[72:75], v[152:155], v[44:47]
    s_waitcnt lgkmcnt(14)
    v_mfma_f32_16x16x32_bf16 v[16:19], v[104:107], v[84:87], v[16:19]
    ds_read_b64_tr_b16 v[116:117], v10 offset:24576
    v_mfma_f32_16x16x32_bf16 v[32:35], v[104:107], v[92:95], v[32:35]
    ds_read_b64_tr_b16 v[118:119], v10 offset:25088
    ds_read_b64_tr_b16 v[96:97], v11 offset:24576
    s_waitcnt lgkmcnt(15)
    v_mfma_f32_16x16x32_bf16 v[20:23], v[48:51], v[84:87], v[20:23]
    ds_read_b64_tr_b16 v[98:99], v11 offset:25088
    s_waitcnt lgkmcnt(4)
    v_mov_b32 v165, 7
    s_mov_b64 exec, 1
    ds_write_b32 v4, v165 offset:0
    s_mov_b64 exec, -1
    v_mfma_f32_16x16x32_bf16 v[36:39], v[48:51], v[92:95], v[36:39]
    ds_read_b64_tr_b16 v[68:69], v12 offset:24576
    ds_read_b64_tr_b16 v[70:71], v12 offset:25088
    v_mfma_f32_16x16x32_bf16 v[24:27], v[128:131], v[84:87], v[24:27]
    ds_read_b64_tr_b16 v[72:73], v13 offset:24576
    v_mfma_f32_16x16x32_bf16 v[40:43], v[128:131], v[92:95], v[40:43]
    ds_read_b64_tr_b16 v[74:75], v13 offset:25088
    v_mfma_f32_16x16x32_bf16 v[28:31], v[52:55], v[84:87], v[28:31]
    v_mfma_f32_16x16x32_bf16 v[44:47], v[52:55], v[92:95], v[44:47]
    v_mfma_f32_16x16x32_bf16 v[16:19], v[60:63], v[100:103], v[16:19]
    ds_read_b64_tr_b16 v[152:153], v10 offset:28672
    v_mfma_f32_16x16x32_bf16 v[32:35], v[60:63], v[108:111], v[32:35]
    ds_read_b64_tr_b16 v[154:155], v10 offset:29184
    ds_read_b64_tr_b16 v[104:105], v11 offset:28672
    v_mfma_f32_16x16x32_bf16 v[20:23], v[136:139], v[100:103], v[20:23]
    ds_read_b64_tr_b16 v[106:107], v11 offset:29184
    v_mfma_f32_16x16x32_bf16 v[36:39], v[136:139], v[108:111], v[36:39]
    ds_read_b64_tr_b16 v[48:49], v12 offset:28672
    ds_read_b64_tr_b16 v[50:51], v12 offset:29184
    v_mfma_f32_16x16x32_bf16 v[24:27], v[132:135], v[100:103], v[24:27]
    s_waitcnt lgkmcnt(8)
    ds_read_b64_tr_b16 v[128:129], v13 offset:28672
    v_mfma_f32_16x16x32_bf16 v[40:43], v[132:135], v[108:111], v[40:43]
    ds_read_b64_tr_b16 v[130:131], v13 offset:29184
    v_mfma_f32_16x16x32_bf16 v[28:31], v[160:163], v[100:103], v[28:31]
    v_mfma_f32_16x16x32_bf16 v[44:47], v[160:163], v[108:111], v[44:47]
    s_waitcnt lgkmcnt(15)
    v_mfma_f32_16x16x32_bf16 v[16:19], v[116:119], v[56:59], v[16:19]
    ds_read_b64_tr_b16 v[84:85], v10 offset:16384
    v_mfma_f32_16x16x32_bf16 v[32:35], v[116:119], v[124:127], v[32:35]
    ds_read_b64_tr_b16 v[86:87], v10 offset:16896
    ds_read_b64_tr_b16 v[52:53], v11 offset:16384
    s_waitcnt lgkmcnt(15)
    v_mfma_f32_16x16x32_bf16 v[20:23], v[96:99], v[56:59], v[20:23]
    ds_read_b64_tr_b16 v[54:55], v11 offset:16896
    v_mfma_f32_16x16x32_bf16 v[36:39], v[96:99], v[124:127], v[36:39]
    ds_read_b64_tr_b16 v[92:93], v12 offset:16384
    s_waitcnt lgkmcnt(8)
    ds_read_b64_tr_b16 v[94:95], v12 offset:16896
    s_waitcnt lgkmcnt(15)
    v_mfma_f32_16x16x32_bf16 v[24:27], v[68:71], v[56:59], v[24:27]
    ds_read_b64_tr_b16 v[60:61], v13 offset:16384
    v_mfma_f32_16x16x32_bf16 v[40:43], v[68:71], v[124:127], v[40:43]
    ds_read_b64_tr_b16 v[62:63], v13 offset:16896
    s_waitcnt lgkmcnt(15)
    v_mfma_f32_16x16x32_bf16 v[28:31], v[72:75], v[56:59], v[28:31]
    v_mfma_f32_16x16x32_bf16 v[44:47], v[72:75], v[124:127], v[44:47]
    s_waitcnt lgkmcnt(14)
    v_mfma_f32_16x16x32_bf16 v[16:19], v[152:155], v[76:79], v[16:19]
    ds_read_b64_tr_b16 v[136:137], v10 offset:20480
    v_mfma_f32_16x16x32_bf16 v[32:35], v[152:155], v[148:151], v[32:35]
    ds_read_b64_tr_b16 v[138:139], v10 offset:20992
    ds_read_b64_tr_b16 v[132:133], v11 offset:20480
    s_waitcnt lgkmcnt(15)
    v_mfma_f32_16x16x32_bf16 v[20:23], v[104:107], v[76:79], v[20:23]
    ds_read_b64_tr_b16 v[134:135], v11 offset:20992
    v_mfma_f32_16x16x32_bf16 v[36:39], v[104:107], v[148:151], v[36:39]
    s_waitcnt lgkmcnt(8)
    ds_read_b64_tr_b16 v[100:101], v12 offset:20480
    ds_read_b64_tr_b16 v[102:103], v12 offset:20992
    s_waitcnt lgkmcnt(15)
    v_mfma_f32_16x16x32_bf16 v[24:27], v[48:51], v[76:79], v[24:27]
    ds_read_b64_tr_b16 v[160:161], v13 offset:20480
    v_mfma_f32_16x16x32_bf16 v[40:43], v[48:51], v[148:151], v[40:43]
    ds_read_b64_tr_b16 v[162:163], v13 offset:20992
    s_waitcnt lgkmcnt(15)
    v_mfma_f32_16x16x32_bf16 v[28:31], v[128:131], v[76:79], v[28:31]
    v_mfma_f32_16x16x32_bf16 v[44:47], v[128:131], v[148:151], v[44:47]
    s_waitcnt lgkmcnt(14)
    v_mfma_f32_16x16x32_bf16 v[16:19], v[84:87], v[88:91], v[16:19]
    ds_read_b64_tr_b16 v[108:109], v10 offset:32768
    v_mfma_f32_16x16x32_bf16 v[32:35], v[84:87], v[64:67], v[32:35]
    ds_read_b64_tr_b16 v[110:111], v10 offset:33280
    ds_read_b64_tr_b16 v[116:117], v11 offset:32768
    s_waitcnt lgkmcnt(15)
    v_mfma_f32_16x16x32_bf16 v[20:23], v[52:55], v[88:91], v[20:23]
    s_waitcnt lgkmcnt(8)
    ds_read_b64_tr_b16 v[118:119], v11 offset:33280
    v_mfma_f32_16x16x32_bf16 v[36:39], v[52:55], v[64:67], v[36:39]
    ds_read_b64_tr_b16 v[96:97], v12 offset:32768
    ds_read_b64_tr_b16 v[98:99], v12 offset:33280
    s_waitcnt lgkmcnt(15)
    v_mfma_f32_16x16x32_bf16 v[24:27], v[92:95], v[88:91], v[24:27]
    ds_read_b64_tr_b16 v[68:69], v13 offset:32768
    v_mfma_f32_16x16x32_bf16 v[40:43], v[92:95], v[64:67], v[40:43]
    ds_read_b64_tr_b16 v[70:71], v13 offset:33280
    s_waitcnt lgkmcnt(15)
    v_mfma_f32_16x16x32_bf16 v[28:31], v[60:63], v[88:91], v[28:31]
    v_mfma_f32_16x16x32_bf16 v[44:47], v[60:63], v[64:67], v[44:47]
    s_waitcnt lgkmcnt(14)
    v_mfma_f32_16x16x32_bf16 v[16:19], v[136:139], v[80:83], v[16:19]
    ds_read_b64_tr_b16 v[56:57], v10 offset:36864
    v_mfma_f32_16x16x32_bf16 v[32:35], v[136:139], v[112:115], v[32:35]
    ds_read_b64_tr_b16 v[58:59], v10 offset:37376
    s_waitcnt lgkmcnt(8)
    ds_read_b64_tr_b16 v[72:73], v11 offset:36864
    s_waitcnt lgkmcnt(15)
    v_mfma_f32_16x16x32_bf16 v[20:23], v[132:135], v[80:83], v[20:23]
    ds_read_b64_tr_b16 v[74:75], v11 offset:37376
    v_mfma_f32_16x16x32_bf16 v[36:39], v[132:135], v[112:115], v[36:39]
    ds_read_b64_tr_b16 v[124:125], v12 offset:36864
    ds_read_b64_tr_b16 v[126:127], v12 offset:37376
    s_waitcnt lgkmcnt(15)
    v_mfma_f32_16x16x32_bf16 v[24:27], v[100:103], v[80:83], v[24:27]
    ds_read_b64_tr_b16 v[152:153], v13 offset:36864
    v_mfma_f32_16x16x32_bf16 v[40:43], v[100:103], v[112:115], v[40:43]
    ds_read_b64_tr_b16 v[154:155], v13 offset:37376
    s_waitcnt lgkmcnt(15)
    v_mfma_f32_16x16x32_bf16 v[28:31], v[160:163], v[80:83], v[28:31]
    v_mfma_f32_16x16x32_bf16 v[44:47], v[160:163], v[112:115], v[44:47]
    s_waitcnt lgkmcnt(14)
    v_mfma_f32_16x16x32_bf16 v[16:19], v[108:111], v[140:143], v[16:19]
    ds_read2_b32 v[112:113], v14 offset0:0 offset1:0
    s_waitcnt lgkmcnt(8)
    ds_read2_b32 v[114:115], v14 offset0:16 offset1:16
    v_mfma_f32_16x16x32_bf16 v[32:35], v[108:111], v[120:123], v[32:35]
    s_waitcnt lgkmcnt(14)
    v_mfma_f32_16x16x32_bf16 v[20:23], v[116:119], v[140:143], v[20:23]
    s_waitcnt lgkmcnt(2)
    v_mov_b32 v165, 10
    s_mov_b64 exec, 1
    ds_write_b32 v4, v165 offset:0
    s_mov_b64 exec, -1
    v_mfma_f32_16x16x32_bf16 v[36:39], v[116:119], v[120:123], v[36:39]
    v_mfma_f32_16x16x32_bf16 v[24:27], v[96:99], v[140:143], v[24:27]
    v_mfma_f32_16x16x32_bf16 v[40:43], v[96:99], v[120:123], v[40:43]
    v_mfma_f32_16x16x32_bf16 v[28:31], v[68:71], v[140:143], v[28:31]
    v_mfma_f32_16x16x32_bf16 v[44:47], v[68:71], v[120:123], v[44:47]
    v_mfma_f32_16x16x32_bf16 v[16:19], v[56:59], v[144:147], v[16:19]
    v_mfma_f32_16x16x32_bf16 v[32:35], v[56:59], v[156:159], v[32:35]
    v_mfma_f32_16x16x32_bf16 v[20:23], v[72:75], v[144:147], v[20:23]
    s_branch IW_s2
IW_w2:
    s_branch IW_r2
IW_s2:
    v_mfma_f32_16x16x32_bf16 v[36:39], v[72:75], v[156:159], v[36:39]
    v_mfma_f32_16x16x32_bf16 v[24:27], v[124:127], v[144:147], v[24:27]
    v_mfma_f32_16x16x32_bf16 v[40:43], v[124:127], v[156:159], v[40:43]
    v_mfma_f32_16x16x32_bf16 v[28:31], v[152:155], v[144:147], v[28:31]
    v_mfma_f32_16x16x32_bf16 v[44:47], v[152:155], v[156:159], v[44:47]
    s_setprio 3
    v_lshlrev_b32 v6, 4, v0
    v_lshlrev_b32 v8, 2, v0
    v_add_u32 v8, 40960, v8
    v_mov_b32 v11, 0x35c1a2a0

    s_waitcnt lgkmcnt(2)
    v_pk_mul_f32 v[16:17], v[16:17], v[112:113]
    v_pk_mul_f32 v[18:19], v[18:19], v[112:113]
    v_pk_mul_f32 v[20:21], v[20:21], v[112:113]
    v_pk_mul_f32 v[22:23], v[22:23], v[112:113]
    v_pk_mul_f32 v[24:25], v[24:25], v[112:113]
    v_pk_mul_f32 v[26:27], v[26:27], v[112:113]
    v_pk_mul_f32 v[28:29], v[28:29], v[112:113]
    v_pk_mul_f32 v[30:31], v[30:31], v[112:113]
    s_waitcnt lgkmcnt(1)
    v_pk_mul_f32 v[32:33], v[32:33], v[114:115]
    v_pk_mul_f32 v[34:35], v[34:35], v[114:115]
    v_pk_mul_f32 v[36:37], v[36:37], v[114:115]
    v_pk_mul_f32 v[38:39], v[38:39], v[114:115]
    v_pk_mul_f32 v[40:41], v[40:41], v[114:115]
    v_pk_mul_f32 v[42:43], v[42:43], v[114:115]
    v_pk_mul_f32 v[44:45], v[44:45], v[114:115]
    v_pk_mul_f32 v[46:47], v[46:47], v[114:115]
    v_exp_f32 v80, v16 clamp
    v_exp_f32 v81, v17 clamp
    v_exp_f32 v82, v18 clamp
    v_exp_f32 v83, v19 clamp
    v_exp_f32 v84, v20 clamp
    v_exp_f32 v85, v21 clamp
    v_exp_f32 v86, v22 clamp
    v_exp_f32 v87, v23 clamp
    v_exp_f32 v88, v24 clamp
    v_exp_f32 v89, v25 clamp
    v_exp_f32 v90, v26 clamp
    v_exp_f32 v91, v27 clamp
    v_exp_f32 v92, v28 clamp
    v_exp_f32 v93, v29 clamp
    v_exp_f32 v94, v30 clamp
    v_exp_f32 v95, v31 clamp
    v_exp_f32 v96, v32 clamp
    v_exp_f32 v97, v33 clamp
    v_exp_f32 v98, v34 clamp
    v_exp_f32 v99, v35 clamp
    v_exp_f32 v100, v36 clamp
    v_exp_f32 v101, v37 clamp
    v_exp_f32 v102, v38 clamp
    v_exp_f32 v103, v39 clamp
    v_exp_f32 v104, v40 clamp
    v_exp_f32 v105, v41 clamp
    v_exp_f32 v106, v42 clamp
    v_exp_f32 v107, v43 clamp
    v_exp_f32 v108, v44 clamp
    v_exp_f32 v109, v45 clamp
    v_exp_f32 v110, v46 clamp
    v_exp_f32 v111, v47 clamp
    v_pk_mul_f32 v[16:17], v[16:17], s[40:41] clamp
    v_pk_mul_f32 v[18:19], v[18:19], s[40:41] clamp
    v_pk_mul_f32 v[20:21], v[20:21], s[40:41] clamp
    v_pk_mul_f32 v[22:23], v[22:23], s[40:41] clamp
    v_pk_mul_f32 v[24:25], v[24:25], s[40:41] clamp
    v_pk_mul_f32 v[26:27], v[26:27], s[40:41] clamp
    v_pk_mul_f32 v[28:29], v[28:29], s[40:41] clamp
    v_pk_mul_f32 v[30:31], v[30:31], s[40:41] clamp
    v_pk_mul_f32 v[32:33], v[32:33], s[40:41] clamp
    v_pk_mul_f32 v[34:35], v[34:35], s[40:41] clamp
    v_pk_mul_f32 v[36:37], v[36:37], s[40:41] clamp
    v_pk_mul_f32 v[38:39], v[38:39], s[40:41] clamp
    v_pk_mul_f32 v[40:41], v[40:41], s[40:41] clamp
    v_pk_mul_f32 v[42:43], v[42:43], s[40:41] clamp
    v_pk_mul_f32 v[44:45], v[44:45], s[40:41] clamp
    v_pk_mul_f32 v[46:47], v[46:47], s[40:41] clamp
    v_pk_add_f32 v[80:81], v[80:81], s[74:75]
    v_pk_add_f32 v[82:83], v[82:83], s[74:75]
    v_pk_add_f32 v[84:85], v[84:85], s[74:75]
    v_pk_add_f32 v[86:87], v[86:87], s[74:75]
    v_pk_add_f32 v[88:89], v[88:89], s[74:75]
    v_pk_add_f32 v[90:91], v[90:91], s[74:75]
    v_pk_add_f32 v[92:93], v[92:93], s[74:75]
    v_pk_add_f32 v[94:95], v[94:95], s[74:75]
    v_pk_add_f32 v[96:97], v[96:97], s[74:75]
    v_pk_add_f32 v[98:99], v[98:99], s[74:75]
    v_pk_add_f32 v[100:101], v[100:101], s[74:75]
    v_pk_add_f32 v[102:103], v[102:103], s[74:75]
    v_pk_add_f32 v[104:105], v[104:105], s[74:75]
    v_pk_add_f32 v[106:107], v[106:107], s[74:75]
    v_pk_add_f32 v[108:109], v[108:109], s[74:75]
    v_pk_add_f32 v[110:111], v[110:111], s[74:75]
    v_pk_fma_f32 v[16:17], v[16:17], s[76:77], v[80:81]
    v_pk_fma_f32 v[18:19], v[18:19], s[76:77], v[82:83]
    v_pk_fma_f32 v[20:21], v[20:21], s[76:77], v[84:85]
    v_pk_fma_f32 v[22:23], v[22:23], s[76:77], v[86:87]
    v_pk_fma_f32 v[24:25], v[24:25], s[76:77], v[88:89]
    v_pk_fma_f32 v[26:27], v[26:27], s[76:77], v[90:91]
    v_pk_fma_f32 v[28:29], v[28:29], s[76:77], v[92:93]
    v_pk_fma_f32 v[30:31], v[30:31], s[76:77], v[94:95]
    v_pk_fma_f32 v[32:33], v[32:33], s[76:77], v[96:97]
    v_pk_fma_f32 v[34:35], v[34:35], s[76:77], v[98:99]
    v_pk_fma_f32 v[36:37], v[36:37], s[76:77], v[100:101]
    v_pk_fma_f32 v[38:39], v[38:39], s[76:77], v[102:103]
    v_pk_fma_f32 v[40:41], v[40:41], s[76:77], v[104:105]
    v_pk_fma_f32 v[42:43], v[42:43], s[76:77], v[106:107]
    v_pk_fma_f32 v[44:45], v[44:45], s[76:77], v[108:109]
    v_pk_fma_f32 v[46:47], v[46:47], s[76:77], v[110:111]
    v_cvt_pk_bf16_f32 v112, v16, v17
    v_cvt_pk_bf16_f32 v113, v18, v19
    v_cvt_pk_bf16_f32 v114, v20, v21
    v_cvt_pk_bf16_f32 v115, v22, v23
    v_cvt_pk_bf16_f32 v116, v24, v25
    v_cvt_pk_bf16_f32 v117, v26, v27
    v_cvt_pk_bf16_f32 v118, v28, v29
    v_cvt_pk_bf16_f32 v119, v30, v31
    v_cvt_pk_bf16_f32 v120, v32, v33
    v_cvt_pk_bf16_f32 v121, v34, v35
    v_cvt_pk_bf16_f32 v122, v36, v37
    v_cvt_pk_bf16_f32 v123, v38, v39
    v_cvt_pk_bf16_f32 v124, v40, v41
    v_cvt_pk_bf16_f32 v125, v42, v43
    v_cvt_pk_bf16_f32 v126, v44, v45
    v_cvt_pk_bf16_f32 v127, v46, v47
    s_waitcnt lgkmcnt(0)
    v_and_b32 v9, 0xfffffff7, v1
    v_and_b32 v5, 0x30, v0
    v_add_u32 v5, 159232, v5
    v_and_b32 v8, 15, v0
    v_lshlrev_b32 v8, 6, v8
    v_and_b32 v10, 0x30, v0
    v_add_u32 v8, v8, v10
    v_add_u32 v8, 40960, v8
F_kw:
    ds_read_b32 v7, v9 offset:128
    ds_read_b128 v[32:35], v5 offset:0
    ds_read_b128 v[36:39], v5 offset:64
    ds_read_b128 v[16:19], v8 offset:0
    ds_read_b128 v[20:23], v8 offset:1024
    ds_read_b128 v[24:27], v8 offset:4096
    ds_read_b128 v[28:31], v8 offset:5120
    ds_read_b128 v[56:59], v5 offset:128
    ds_read_b128 v[60:63], v5 offset:192
    ds_read_b128 v[40:43], v8 offset:2048
    ds_read_b128 v[44:47], v8 offset:3072
    ds_read_b128 v[48:51], v8 offset:6144
    ds_read_b128 v[52:55], v8 offset:7168
    s_waitcnt lgkmcnt(12)
    v_cmp_gt_u32 vcc, 2, v7
    s_cbranch_vccz F_kx
    s_waitcnt lgkmcnt(0)
    s_branch F_kw
F_kx:
    s_waitcnt lgkmcnt(10)
    v_cvt_pk_bf16_f32 v136, v32, v33
    v_cvt_pk_bf16_f32 v137, v34, v35
    v_cvt_pk_bf16_f32 v138, v36, v37
    v_cvt_pk_bf16_f32 v139, v38, v39
    s_nop 1
    v_mfma_f32_16x16x32_bf16 v[72:75], v[136:139], v[112:115], 0
    v_mfma_f32_16x16x32_bf16 v[84:87], v[136:139], v[120:123], 0
    s_waitcnt lgkmcnt(8)
    v_cvt_pk_bf16_f32 v128, v16, v17
    v_cvt_pk_bf16_f32 v129, v18, v19
    v_cvt_pk_bf16_f32 v130, v20, v21
    v_cvt_pk_bf16_f32 v131, v22, v23
    s_nop 1
    v_mfma_f32_16x16x32_bf16 v[64:67], v[128:131], v[112:115], 0
    v_mfma_f32_16x16x32_bf16 v[76:79], v[128:131], v[120:123], 0
    s_waitcnt lgkmcnt(6)
    v_cvt_pk_bf16_f32 v132, v24, v25
    v_cvt_pk_bf16_f32 v133, v26, v27
    v_cvt_pk_bf16_f32 v134, v28, v29
    v_cvt_pk_bf16_f32 v135, v30, v31
    s_nop 1
    v_mfma_f32_16x16x32_bf16 v[68:71], v[132:135], v[112:115], 0
    v_mfma_f32_16x16x32_bf16 v[80:83], v[132:135], v[120:123], 0
    s_waitcnt lgkmcnt(4)
    v_cvt_pk_bf16_f32 v148, v56, v57
    v_cvt_pk_bf16_f32 v149, v58, v59
    v_cvt_pk_bf16_f32 v150, v60, v61
    v_cvt_pk_bf16_f32 v151, v62, v63
    v_fma_f32 v72, v72, s46, v11
    v_rcp_f32 v72, v72
    v_fma_f32 v84, v84, s46, v11
    v_rcp_f32 v84, v84
    v_mfma_f32_16x16x32_bf16 v[96:99], v[148:151], v[116:119], 0
    v_mfma_f32_16x16x32_bf16 v[108:111], v[148:151], v[124:127], 0
    s_waitcnt lgkmcnt(2)
    v_cvt_pk_bf16_f32 v140, v40, v41
    v_cvt_pk_bf16_f32 v141, v42, v43
    v_cvt_pk_bf16_f32 v142, v44, v45
    v_cvt_pk_bf16_f32 v143, v46, v47
    s_nop 1
    v_mfma_f32_16x16x32_bf16 v[88:91], v[140:143], v[116:119], 0
    v_mfma_f32_16x16x32_bf16 v[100:103], v[140:143], v[124:127], 0
    s_waitcnt lgkmcnt(0)
    v_cvt_pk_bf16_f32 v144, v48, v49
    v_cvt_pk_bf16_f32 v145, v50, v51
    v_cvt_pk_bf16_f32 v146, v52, v53
    v_cvt_pk_bf16_f32 v147, v54, v55
    s_nop 1
    v_mfma_f32_16x16x32_bf16 v[92:95], v[144:147], v[116:119], 0
    v_mfma_f32_16x16x32_bf16 v[104:107], v[144:147], v[124:127], 0
    v_mul_f32 v64, v64, v72
    v_mul_f32 v65, v65, v72
    v_mul_f32 v66, v66, v72
    v_mul_f32 v67, v67, v72
    v_mul_f32 v68, v68, v72
    v_mul_f32 v69, v69, v72
    v_mul_f32 v70, v70, v72
    v_mul_f32 v71, v71, v72
    v_cvt_pk_bf16_f32 v152, v64, v65
    v_cvt_pk_bf16_f32 v153, v66, v67
    v_cvt_pk_bf16_f32 v154, v68, v69
    v_cvt_pk_bf16_f32 v155, v70, v71
    buffer_store_dwordx4 v[152:155], v6, s[16:19], s79 offen offset:0 sc0 sc1
    v_fma_f32 v96, v96, s46, v11
    v_rcp_f32 v96, v96
    v_fma_f32 v108, v108, s46, v11
    v_rcp_f32 v108, v108
    v_mov_b32 v85, v84
    v_pk_mul_f32 v[76:77], v[76:77], v[84:85]
    v_pk_mul_f32 v[78:79], v[78:79], v[84:85]
    v_pk_mul_f32 v[80:81], v[80:81], v[84:85]
    v_pk_mul_f32 v[82:83], v[82:83], v[84:85]
    v_cvt_pk_bf16_f32 v156, v76, v77
    v_cvt_pk_bf16_f32 v157, v78, v79
    v_cvt_pk_bf16_f32 v158, v80, v81
    v_cvt_pk_bf16_f32 v159, v82, v83
    buffer_store_dwordx4 v[156:159], v6, s[16:19], s80 offen offset:0 sc0 sc1
    v_mov_b32 v97, v96
    v_pk_mul_f32 v[88:89], v[88:89], v[96:97]
    v_pk_mul_f32 v[90:91], v[90:91], v[96:97]
    v_pk_mul_f32 v[92:93], v[92:93], v[96:97]
    v_pk_mul_f32 v[94:95], v[94:95], v[96:97]
    v_cvt_pk_bf16_f32 v160, v88, v89
    v_cvt_pk_bf16_f32 v161, v90, v91
    v_cvt_pk_bf16_f32 v162, v92, v93
    v_cvt_pk_bf16_f32 v163, v94, v95
    buffer_store_dwordx4 v[160:163], v6, s[16:19], s79 offen offset:1024 sc0 sc1
    v_mov_b32 v109, v108
    v_pk_mul_f32 v[100:101], v[100:101], v[108:109]
    v_pk_mul_f32 v[102:103], v[102:103], v[108:109]
    v_pk_mul_f32 v[104:105], v[104:105], v[108:109]
    v_pk_mul_f32 v[106:107], v[106:107], v[108:109]
    v_cvt_pk_bf16_f32 v16, v100, v101
    v_cvt_pk_bf16_f32 v17, v102, v103
    v_cvt_pk_bf16_f32 v18, v104, v105
    v_cvt_pk_bf16_f32 v19, v106, v107
    buffer_store_dwordx4 v[16:19], v6, s[16:19], s80 offen offset:1024 sc0 sc1
    s_mov_b64 exec, 1
    ds_write_b32 v4, v164 offset:144
    s_waitcnt vmcnt(0)
    s_mov_b32 s45, 1
    s_atomic_add s45, s[54:55], 0x0
    s_atomic_add s45, s[54:55], 0x80
    s_atomic_add s45, s[54:55], 0x100
    s_atomic_add s45, s[54:55], 0x180
    ds_add_u32 v4, v164 offset:144
    s_mov_b64 exec, -1
    s_cmp_lg_u32 s3, 0
    s_cbranch_scc1 F_end
    s_setprio 3
    s_lshr_b32 s50, s29, 1
    s_lshl_b32 s50, s50, 2
    s_and_b32 s51, s28, 3
    s_add_u32 s50, s50, s51
    s_lshl_b32 s50, s50, 7
    s_add_u32 s56, s50, 0x845000
    s_add_u32 s56, s72, s56
    s_addc_u32 s57, s73, 0
    v_mov_b32 v2, 159096
    ds_read_b32 v7, v2 offset:0
FW_9:
    s_waitcnt lgkmcnt(0)
    v_cmp_gt_u32 vcc, 1, v7
    s_cbranch_vccz FO_10
    s_sleep 2
    ds_read_b32 v7, v2 offset:0
    s_branch FW_9
FO_10:
    v_and_b32 v2, 7, v0
    v_lshlrev_b32 v2, 2, v2
    v_add_u32 v2, 158976, v2
    ds_read_b32 v2, v2
    s_sub_u32 s51, 15, s28
    s_waitcnt lgkmcnt(0)
    v_bfe_u32 v2, v2, 7, 4
    v_cmp_eq_u32 vcc, s51, v2
    s_cbranch_vccz F_ny

    v_lshrrev_b32 v2, 4, v0
    v_and_b32 v6, 15, v0
    v_lshlrev_b32 v6, 4, v6
    v_lshl_add_u32 v2, v2, 12, v6
    s_lshl_b32 s50, s29, 8
    s_add_u32 s50, s50, 135168

SP_11:
    s_load_dword s58, s[56:57], 0 glc
    s_waitcnt lgkmcnt(0)
    s_cmp_ge_u32 s58, 32
    s_cbranch_scc1 SD_12
    s_sleep 2
    s_branch SP_11
SD_12:
    s_mov_b32 m0, 159744
    s_nop 0
    buffer_load_dwordx4 v2, s[24:27], s50 offen sc0 sc1 lds
    s_add_u32 s50, s50, 16384
    s_add_u32 m0, m0, 1024
    s_nop 0
    buffer_load_dwordx4 v2, s[24:27], s50 offen sc0 sc1 lds
    s_waitcnt vmcnt(0)
    v_mov_b32 v7, 1
    s_mov_b64 exec, 1
    ds_write_b32 v4, v7 offset:96
    s_mov_b64 exec, -1
F_ny:
F_end:
    s_endpgm
F_nl:
    s_sub_u32 s3, s3, 4
    s_setprio 2
    s_lshr_b32 s36, s3, 1
    s_and_b32 s37, s3, 1
    v_and_b32 v1, 15, v0
    v_lshrrev_b32 v2, 4, v0
    v_lshrrev_b32 v3, 1, v1
    v_xor_b32 v3, v3, v2
    v_lshlrev_b32 v3, 4, v3
    v_lshlrev_b32 v1, 7, v1
    s_lshl_b32 s38, s36, 13
    v_add3_u32 v4, v1, v3, s38
    v_xor_b32 v5, 64, v4
    v_add_u32 v6, 0x10000, v4
    v_add_u32 v7, 0x10000, v5
    v_bfe_u32 v1, v0, 2, 2
    v_lshl_add_u32 v3, v2, 3, v1
    v_lshrrev_b32 v1, 1, v1
    v_and_b32 v2, 1, v2
    v_lshl_add_u32 v1, v2, 1, v1
    s_lshl_b32 s38, s37, 1
    s_add_u32 s38, s38, s36
    v_xor_b32 v1, s38, v1
    v_lshlrev_b32 v1, 5, v1
    v_lshl_add_u32 v1, v3, 7, v1
    v_and_b32 v2, 3, v0
    v_lshl_add_u32 v1, v2, 3, v1
    v_add_u32 v8, 0x10000, v1
    v_xor_b32 v9, 32, v8
    v_add_u32 v10, 0x8000, v8
    v_add_u32 v11, 0x8000, v9
    s_mov_b32 s40, 0x21317218
    s_mov_b32 s41, s40
    s_mov_b32 s74, 0x358637bd
    s_mov_b32 s75, s74
    s_mov_b32 s76, 0x5d800000
    s_mov_b32 s77, s76
    v_and_b32 v164, 0x30, v0
    s_lshl_b32 s42, s36, 8
    s_add_u32 s42, s42, 155648
    v_add_u32 v164, s42, v164
    v_and_b32 v165, 15, v0
    v_lshlrev_b32 v165, 2, v165
    s_lshl_b32 s42, s38, 6
    s_add_u32 s42, s42, 158208
    v_add_u32 v165, s42, v165
    s_lshl_b32 s42, s3, 2
    s_add_u32 s42, s42, 159040
    v_mov_b32 v3, s42
    v_lshlrev_b32 v1, 2, v2
    v_add_u32 v1, 159040, v1
    v_xor_b32 v2, 64, v165
    s_lshl_b32 s44, s33, 1
    s_add_u32 s44, s44, s37
    s_lshl_b32 s45, s44, 12
    s_mul_i32 s46, s36, 3072
    s_add_u32 s46, s46, s45
    s_lshl_b32 s47, s36, 10
    s_add_u32 s47, s47, 1024
    s_add_u32 s47, s47, s45
    s_lshl_b32 s48, s36, 6
    s_add_u32 s48, s48, 0x20000
    s_lshl_b32 s49, s44, 7
    s_add_u32 s48, s48, s49
    s_lshl_b32 s49, s44, 10
    s_lshl_b32 s52, s3, 11
    s_add_u32 s52, s52, 65536
    s_lshl_b32 s53, s3, 7
    s_lshl_b32 s43, s36, 6
    s_add_u32 s53, s53, s43
    s_add_u32 s53, s53, 159232
    s_mov_b32 s50, 159068
    s_waitcnt lgkmcnt(0)
    s_lshl_b32 s64, s28, 7
    s_lshl_b32 s65, s3, 5
    s_add_u32 s64, s64, s65
    s_lshl_b32 s42, s64, 11
    s_lshl_b32 s65, s29, 7
    s_add_u32 s42, s42, s65
    s_add_u32 s43, s42, 0x8000
    s_lshl_b32 s66, s44, 1
    s_add_u32 s66, s66, s36
    s_lshl_b32 s66, s66, 4
    s_add_u32 s66, s66, s32
    s_lshl_b32 s66, s66, 10

    s_mov_b32 s12, s4
    s_mov_b32 s13, s5
    s_mov_b32 s14, 0x400000
    s_mov_b32 s15, 0x00020000
    s_mov_b32 s16, s6
    s_mov_b32 s17, s7
    s_mov_b32 s18, 0x600000
    s_mov_b32 s19, 0x00020000
    s_mov_b32 s20, s8
    s_mov_b32 s21, s9
    s_mov_b32 s22, 0x200000
    s_mov_b32 s23, 0x00020000
    s_add_u32 s24, s72, 0x800000
    s_addc_u32 s25, s73, 0
    s_mov_b32 s26, 0x48000
    s_mov_b32 s27, 0x00020000
    s_add_u32 s84, s72, 0xa00000
    s_addc_u32 s85, s73, 0
    s_mov_b32 s86, 0x100000
    s_mov_b32 s87, 0x00020000
    s_barrier
    ds_read_b128 v[12:15], v4 offset:0
    ds_read_b64_tr_b16 v[44:45], v8 offset:0
    ds_read_b64_tr_b16 v[46:47], v8 offset:512
    ds_read_b128 v[16:19], v4 offset:2048
    ds_read_b128 v[20:23], v4 offset:4096
    ds_read_b128 v[24:27], v4 offset:6144
    ds_read_b64_tr_b16 v[48:49], v9 offset:0
    ds_read_b64_tr_b16 v[50:51], v9 offset:512
    ds_read_b64_tr_b16 v[52:53], v8 offset:8192
    ds_read_b64_tr_b16 v[54:55], v8 offset:8704
    ds_read_b64_tr_b16 v[56:57], v9 offset:8192
    ds_read_b64_tr_b16 v[58:59], v9 offset:8704
    s_waitcnt lgkmcnt(9)
    v_mfma_f32_16x16x32_bf16 v[100:103], v[12:15], v[44:47], 0
    ds_read_b128 v[28:31], v5 offset:0
    s_waitcnt lgkmcnt(9)
    v_mfma_f32_16x16x32_bf16 v[104:107], v[16:19], v[44:47], 0
    ds_read_b64_tr_b16 v[60:61], v8 offset:4096
    s_waitcnt lgkmcnt(9)
    v_mfma_f32_16x16x32_bf16 v[108:111], v[20:23], v[44:47], 0
    ds_read_b64_tr_b16 v[62:63], v8 offset:4608
    s_waitcnt lgkmcnt(9)
    v_mfma_f32_16x16x32_bf16 v[112:115], v[24:27], v[44:47], 0
    ds_read_b128 v[32:35], v5 offset:2048
    s_waitcnt lgkmcnt(8)
    v_mfma_f32_16x16x32_bf16 v[116:119], v[12:15], v[48:51], 0
    ds_read_b128 v[36:39], v5 offset:4096
    v_mfma_f32_16x16x32_bf16 v[120:123], v[16:19], v[48:51], 0
    ds_read_b128 v[40:43], v5 offset:6144
    v_mfma_f32_16x16x32_bf16 v[124:127], v[20:23], v[48:51], 0
    ds_read_b64_tr_b16 v[64:65], v9 offset:4096
    v_mfma_f32_16x16x32_bf16 v[128:131], v[24:27], v[48:51], 0
    ds_read_b64_tr_b16 v[66:67], v9 offset:4608
    s_waitcnt lgkmcnt(10)
    v_mfma_f32_16x16x32_bf16 v[132:135], v[12:15], v[52:55], 0
    ds_read_b64_tr_b16 v[44:45], v8 offset:12288
    v_mfma_f32_16x16x32_bf16 v[136:139], v[16:19], v[52:55], 0
    ds_read_b64_tr_b16 v[46:47], v8 offset:12800
    v_mfma_f32_16x16x32_bf16 v[140:143], v[20:23], v[52:55], 0
    ds_read_b64_tr_b16 v[48:49], v9 offset:12288
    v_mfma_f32_16x16x32_bf16 v[144:147], v[24:27], v[52:55], 0
    ds_read_b64_tr_b16 v[50:51], v9 offset:12800
    s_waitcnt lgkmcnt(12)
    v_mfma_f32_16x16x32_bf16 v[148:151], v[12:15], v[56:59], 0
    v_mfma_f32_16x16x32_bf16 v[152:155], v[16:19], v[56:59], 0
    v_mfma_f32_16x16x32_bf16 v[156:159], v[20:23], v[56:59], 0
    v_mfma_f32_16x16x32_bf16 v[160:163], v[24:27], v[56:59], 0
    s_waitcnt lgkmcnt(9)
    v_mfma_f32_16x16x32_bf16 v[100:103], v[28:31], v[60:63], v[100:103]
    s_waitcnt lgkmcnt(8)
    v_mfma_f32_16x16x32_bf16 v[104:107], v[32:35], v[60:63], v[104:107]
    s_waitcnt lgkmcnt(0)
    s_barrier
    v_mfma_f32_16x16x32_bf16 v[108:111], v[36:39], v[60:63], v[108:111]
    ds_read_b128 v[12:15], v4 offset:16384
    v_mfma_f32_16x16x32_bf16 v[112:115], v[40:43], v[60:63], v[112:115]
    ds_read_b64_tr_b16 v[52:53], v8 offset:16384
    v_mfma_f32_16x16x32_bf16 v[116:119], v[28:31], v[64:67], v[116:119]
    ds_read_b64_tr_b16 v[54:55], v8 offset:16896
    v_mfma_f32_16x16x32_bf16 v[120:123], v[32:35], v[64:67], v[120:123]
    ds_read_b128 v[16:19], v4 offset:18432
    v_mfma_f32_16x16x32_bf16 v[124:127], v[36:39], v[64:67], v[124:127]
    ds_read_b128 v[20:23], v4 offset:20480
    v_mfma_f32_16x16x32_bf16 v[128:131], v[40:43], v[64:67], v[128:131]
    ds_read_b128 v[24:27], v4 offset:22528
    v_mfma_f32_16x16x32_bf16 v[132:135], v[28:31], v[44:47], v[132:135]
    ds_read_b64_tr_b16 v[56:57], v9 offset:16384
    v_mfma_f32_16x16x32_bf16 v[136:139], v[32:35], v[44:47], v[136:139]
    ds_read_b64_tr_b16 v[58:59], v9 offset:16896
    v_mfma_f32_16x16x32_bf16 v[140:143], v[36:39], v[44:47], v[140:143]
    ds_read_b64_tr_b16 v[60:61], v8 offset:24576
    v_mfma_f32_16x16x32_bf16 v[144:147], v[40:43], v[44:47], v[144:147]
    ds_read_b64_tr_b16 v[62:63], v8 offset:25088
    v_mfma_f32_16x16x32_bf16 v[148:151], v[28:31], v[48:51], v[148:151]
    ds_read_b64_tr_b16 v[64:65], v9 offset:24576
    v_mfma_f32_16x16x32_bf16 v[152:155], v[32:35], v[48:51], v[152:155]
    ds_read_b64_tr_b16 v[66:67], v9 offset:25088
    v_mfma_f32_16x16x32_bf16 v[156:159], v[36:39], v[48:51], v[156:159]
    v_mfma_f32_16x16x32_bf16 v[160:163], v[40:43], v[48:51], v[160:163]
    s_waitcnt lgkmcnt(9)
    v_mfma_f32_16x16x32_bf16 v[100:103], v[12:15], v[52:55], v[100:103]
    ds_read_b128 v[28:31], v5 offset:16384
    s_waitcnt lgkmcnt(9)
    v_mfma_f32_16x16x32_bf16 v[104:107], v[16:19], v[52:55], v[104:107]
    ds_read_b64_tr_b16 v[44:45], v8 offset:20480
    s_waitcnt lgkmcnt(9)
    v_mfma_f32_16x16x32_bf16 v[108:111], v[20:23], v[52:55], v[108:111]
    ds_read_b64_tr_b16 v[46:47], v8 offset:20992
    s_waitcnt lgkmcnt(9)
    v_mfma_f32_16x16x32_bf16 v[112:115], v[24:27], v[52:55], v[112:115]
    ds_read_b128 v[32:35], v5 offset:18432
    s_waitcnt lgkmcnt(8)
    v_mfma_f32_16x16x32_bf16 v[116:119], v[12:15], v[56:59], v[116:119]
    ds_read_b128 v[36:39], v5 offset:20480
    v_mfma_f32_16x16x32_bf16 v[120:123], v[16:19], v[56:59], v[120:123]
    ds_read_b128 v[40:43], v5 offset:22528
    v_mfma_f32_16x16x32_bf16 v[124:127], v[20:23], v[56:59], v[124:127]
    ds_read_b64_tr_b16 v[48:49], v9 offset:20480
    v_mfma_f32_16x16x32_bf16 v[128:131], v[24:27], v[56:59], v[128:131]
    ds_read_b64_tr_b16 v[50:51], v9 offset:20992
    s_waitcnt lgkmcnt(10)
    v_mfma_f32_16x16x32_bf16 v[132:135], v[12:15], v[60:63], v[132:135]
    ds_read_b64_tr_b16 v[52:53], v8 offset:28672
    v_mfma_f32_16x16x32_bf16 v[136:139], v[16:19], v[60:63], v[136:139]
    ds_read_b64_tr_b16 v[54:55], v8 offset:29184
    v_mfma_f32_16x16x32_bf16 v[140:143], v[20:23], v[60:63], v[140:143]
    ds_read_b64_tr_b16 v[56:57], v9 offset:28672
    v_mfma_f32_16x16x32_bf16 v[144:147], v[24:27], v[60:63], v[144:147]
    ds_read_b64_tr_b16 v[58:59], v9 offset:29184
    s_waitcnt lgkmcnt(12)
    v_mfma_f32_16x16x32_bf16 v[148:151], v[12:15], v[64:67], v[148:151]
    v_mfma_f32_16x16x32_bf16 v[152:155], v[16:19], v[64:67], v[152:155]
    v_mfma_f32_16x16x32_bf16 v[156:159], v[20:23], v[64:67], v[156:159]
    v_mfma_f32_16x16x32_bf16 v[160:163], v[24:27], v[64:67], v[160:163]
    s_waitcnt lgkmcnt(9)
    v_mfma_f32_16x16x32_bf16 v[100:103], v[28:31], v[44:47], v[100:103]
    s_waitcnt lgkmcnt(8)
    v_mfma_f32_16x16x32_bf16 v[104:107], v[32:35], v[44:47], v[104:107]
    s_waitcnt lgkmcnt(0)
    s_barrier
    v_mfma_f32_16x16x32_bf16 v[108:111], v[36:39], v[44:47], v[108:111]
    ds_read_b128 v[12:15], v4 offset:32768
    v_mfma_f32_16x16x32_bf16 v[112:115], v[40:43], v[44:47], v[112:115]
    ds_read_b64_tr_b16 v[60:61], v10 offset:16384
    v_mfma_f32_16x16x32_bf16 v[116:119], v[28:31], v[48:51], v[116:119]
    ds_read_b64_tr_b16 v[62:63], v10 offset:16896
    v_mfma_f32_16x16x32_bf16 v[120:123], v[32:35], v[48:51], v[120:123]
    ds_read_b128 v[16:19], v4 offset:34816
    v_mfma_f32_16x16x32_bf16 v[124:127], v[36:39], v[48:51], v[124:127]
    ds_read_b128 v[20:23], v4 offset:36864
    v_mfma_f32_16x16x32_bf16 v[128:131], v[40:43], v[48:51], v[128:131]
    ds_read_b128 v[24:27], v4 offset:38912
    v_mfma_f32_16x16x32_bf16 v[132:135], v[28:31], v[52:55], v[132:135]
    ds_read_b64_tr_b16 v[64:65], v11 offset:16384
    v_mfma_f32_16x16x32_bf16 v[136:139], v[32:35], v[52:55], v[136:139]
    ds_read_b64_tr_b16 v[66:67], v11 offset:16896
    v_mfma_f32_16x16x32_bf16 v[140:143], v[36:39], v[52:55], v[140:143]
    ds_read_b64_tr_b16 v[44:45], v10 offset:24576
    v_mfma_f32_16x16x32_bf16 v[144:147], v[40:43], v[52:55], v[144:147]
    ds_read_b64_tr_b16 v[46:47], v10 offset:25088
    v_mfma_f32_16x16x32_bf16 v[148:151], v[28:31], v[56:59], v[148:151]
    ds_read_b64_tr_b16 v[48:49], v11 offset:24576
    v_mfma_f32_16x16x32_bf16 v[152:155], v[32:35], v[56:59], v[152:155]
    ds_read_b64_tr_b16 v[50:51], v11 offset:25088
    v_mfma_f32_16x16x32_bf16 v[156:159], v[36:39], v[56:59], v[156:159]
    v_mfma_f32_16x16x32_bf16 v[160:163], v[40:43], v[56:59], v[160:163]
    s_waitcnt lgkmcnt(9)
    v_mfma_f32_16x16x32_bf16 v[100:103], v[12:15], v[60:63], v[100:103]
    ds_read_b128 v[28:31], v5 offset:32768
    s_waitcnt lgkmcnt(9)
    v_mfma_f32_16x16x32_bf16 v[104:107], v[16:19], v[60:63], v[104:107]
    ds_read_b64_tr_b16 v[52:53], v10 offset:20480
    s_waitcnt lgkmcnt(9)
    v_mfma_f32_16x16x32_bf16 v[108:111], v[20:23], v[60:63], v[108:111]
    ds_read_b64_tr_b16 v[54:55], v10 offset:20992
    s_waitcnt lgkmcnt(9)
    v_mfma_f32_16x16x32_bf16 v[112:115], v[24:27], v[60:63], v[112:115]
    ds_read_b128 v[32:35], v5 offset:34816
    s_waitcnt lgkmcnt(8)
    v_mfma_f32_16x16x32_bf16 v[116:119], v[12:15], v[64:67], v[116:119]
    ds_read_b128 v[36:39], v5 offset:36864
    v_mfma_f32_16x16x32_bf16 v[120:123], v[16:19], v[64:67], v[120:123]
    ds_read_b128 v[40:43], v5 offset:38912
    v_mfma_f32_16x16x32_bf16 v[124:127], v[20:23], v[64:67], v[124:127]
    ds_read_b64_tr_b16 v[56:57], v11 offset:20480
    v_mfma_f32_16x16x32_bf16 v[128:131], v[24:27], v[64:67], v[128:131]
    ds_read_b64_tr_b16 v[58:59], v11 offset:20992
    s_waitcnt lgkmcnt(10)
    v_mfma_f32_16x16x32_bf16 v[132:135], v[12:15], v[44:47], v[132:135]
    ds_read_b64_tr_b16 v[60:61], v10 offset:28672
    v_mfma_f32_16x16x32_bf16 v[136:139], v[16:19], v[44:47], v[136:139]
    ds_read_b64_tr_b16 v[62:63], v10 offset:29184
    v_mfma_f32_16x16x32_bf16 v[140:143], v[20:23], v[44:47], v[140:143]
    ds_read_b64_tr_b16 v[64:65], v11 offset:28672
    v_mfma_f32_16x16x32_bf16 v[144:147], v[24:27], v[44:47], v[144:147]
    ds_read_b64_tr_b16 v[66:67], v11 offset:29184
    s_waitcnt lgkmcnt(12)
    v_mfma_f32_16x16x32_bf16 v[148:151], v[12:15], v[48:51], v[148:151]
    v_mfma_f32_16x16x32_bf16 v[152:155], v[16:19], v[48:51], v[152:155]
    v_mfma_f32_16x16x32_bf16 v[156:159], v[20:23], v[48:51], v[156:159]
    v_mfma_f32_16x16x32_bf16 v[160:163], v[24:27], v[48:51], v[160:163]
    s_waitcnt lgkmcnt(9)
    v_mfma_f32_16x16x32_bf16 v[100:103], v[28:31], v[52:55], v[100:103]
    s_waitcnt lgkmcnt(8)
    v_mfma_f32_16x16x32_bf16 v[104:107], v[32:35], v[52:55], v[104:107]
    s_branch IW_s3
IW_w3:
    s_branch IW_r3
IW_s3:
    s_waitcnt lgkmcnt(0)
    s_barrier
    v_mfma_f32_16x16x32_bf16 v[108:111], v[36:39], v[52:55], v[108:111]
    ds_read_b128 v[12:15], v4 offset:49152
    v_mfma_f32_16x16x32_bf16 v[112:115], v[40:43], v[52:55], v[112:115]
    ds_read_b64_tr_b16 v[44:45], v10 offset:32768
    v_mfma_f32_16x16x32_bf16 v[116:119], v[28:31], v[56:59], v[116:119]
    ds_read_b64_tr_b16 v[46:47], v10 offset:33280
    v_mfma_f32_16x16x32_bf16 v[120:123], v[32:35], v[56:59], v[120:123]
    ds_read_b128 v[16:19], v4 offset:51200
    v_mfma_f32_16x16x32_bf16 v[124:127], v[36:39], v[56:59], v[124:127]
    ds_read_b128 v[20:23], v4 offset:53248
    v_mfma_f32_16x16x32_bf16 v[128:131], v[40:43], v[56:59], v[128:131]
    ds_read_b128 v[24:27], v4 offset:55296
    v_mfma_f32_16x16x32_bf16 v[132:135], v[28:31], v[60:63], v[132:135]
    ds_read_b64_tr_b16 v[48:49], v11 offset:32768
    v_mfma_f32_16x16x32_bf16 v[136:139], v[32:35], v[60:63], v[136:139]
    ds_read_b64_tr_b16 v[50:51], v11 offset:33280
    v_mfma_f32_16x16x32_bf16 v[140:143], v[36:39], v[60:63], v[140:143]
    ds_read_b64_tr_b16 v[52:53], v8 offset:0
    v_mfma_f32_16x16x32_bf16 v[144:147], v[40:43], v[60:63], v[144:147]
    ds_read_b64_tr_b16 v[54:55], v8 offset:512
    v_mfma_f32_16x16x32_bf16 v[148:151], v[28:31], v[64:67], v[148:151]
    ds_read_b64_tr_b16 v[56:57], v9 offset:0
    v_mfma_f32_16x16x32_bf16 v[152:155], v[32:35], v[64:67], v[152:155]
    ds_read_b64_tr_b16 v[58:59], v9 offset:512
    v_mfma_f32_16x16x32_bf16 v[156:159], v[36:39], v[64:67], v[156:159]
    v_mfma_f32_16x16x32_bf16 v[160:163], v[40:43], v[64:67], v[160:163]
    s_waitcnt lgkmcnt(9)
    v_mfma_f32_16x16x32_bf16 v[100:103], v[12:15], v[44:47], v[100:103]
    ds_read_b128 v[28:31], v5 offset:49152
    s_waitcnt lgkmcnt(9)
    v_mfma_f32_16x16x32_bf16 v[104:107], v[16:19], v[44:47], v[104:107]
    ds_read_b64_tr_b16 v[60:61], v10 offset:36864
    s_waitcnt lgkmcnt(9)
    v_mfma_f32_16x16x32_bf16 v[108:111], v[20:23], v[44:47], v[108:111]
    ds_read_b64_tr_b16 v[62:63], v10 offset:37376
    s_waitcnt lgkmcnt(9)
    v_mfma_f32_16x16x32_bf16 v[112:115], v[24:27], v[44:47], v[112:115]
    ds_read_b128 v[32:35], v5 offset:51200
    s_waitcnt lgkmcnt(8)
    v_mfma_f32_16x16x32_bf16 v[116:119], v[12:15], v[48:51], v[116:119]
    ds_read_b128 v[36:39], v5 offset:53248
    v_mfma_f32_16x16x32_bf16 v[120:123], v[16:19], v[48:51], v[120:123]
    ds_read_b128 v[40:43], v5 offset:55296
    v_mfma_f32_16x16x32_bf16 v[124:127], v[20:23], v[48:51], v[124:127]
    ds_read_b64_tr_b16 v[64:65], v11 offset:36864
    v_mfma_f32_16x16x32_bf16 v[128:131], v[24:27], v[48:51], v[128:131]
    ds_read_b64_tr_b16 v[66:67], v11 offset:37376
    s_waitcnt lgkmcnt(10)
    v_mfma_f32_16x16x32_bf16 v[132:135], v[12:15], v[52:55], v[132:135]
    ds_read_b64_tr_b16 v[44:45], v8 offset:4096
    v_mfma_f32_16x16x32_bf16 v[136:139], v[16:19], v[52:55], v[136:139]
    ds_read_b64_tr_b16 v[46:47], v8 offset:4608
    v_mfma_f32_16x16x32_bf16 v[140:143], v[20:23], v[52:55], v[140:143]
    ds_read_b64_tr_b16 v[48:49], v9 offset:4096
    v_mfma_f32_16x16x32_bf16 v[144:147], v[24:27], v[52:55], v[144:147]
    ds_read_b64_tr_b16 v[50:51], v9 offset:4608
    s_waitcnt lgkmcnt(12)
    v_mfma_f32_16x16x32_bf16 v[148:151], v[12:15], v[56:59], v[148:151]
    v_mfma_f32_16x16x32_bf16 v[152:155], v[16:19], v[56:59], v[152:155]
    v_mfma_f32_16x16x32_bf16 v[156:159], v[20:23], v[56:59], v[156:159]
    v_mfma_f32_16x16x32_bf16 v[160:163], v[24:27], v[56:59], v[160:163]
    s_waitcnt lgkmcnt(9)
    v_mfma_f32_16x16x32_bf16 v[100:103], v[28:31], v[60:63], v[100:103]
    s_waitcnt lgkmcnt(8)
    v_mfma_f32_16x16x32_bf16 v[104:107], v[32:35], v[60:63], v[104:107]
    s_waitcnt lgkmcnt(0)
    s_barrier
    v_mfma_f32_16x16x32_bf16 v[108:111], v[36:39], v[60:63], v[108:111]
    ds_read_b128 v[12:15], v4 offset:0
    v_mfma_f32_16x16x32_bf16 v[112:115], v[40:43], v[60:63], v[112:115]
    ds_read_b64_tr_b16 v[52:53], v8 offset:8192
    v_mfma_f32_16x16x32_bf16 v[116:119], v[28:31], v[64:67], v[116:119]
    ds_read_b64_tr_b16 v[54:55], v8 offset:8704
    v_mfma_f32_16x16x32_bf16 v[120:123], v[32:35], v[64:67], v[120:123]
    ds_read_b128 v[16:19], v4 offset:2048
    v_mfma_f32_16x16x32_bf16 v[124:127], v[36:39], v[64:67], v[124:127]
    ds_read_b128 v[20:23], v4 offset:4096
    v_mfma_f32_16x16x32_bf16 v[128:131], v[40:43], v[64:67], v[128:131]
    ds_read_b128 v[24:27], v4 offset:6144
    v_mfma_f32_16x16x32_bf16 v[132:135], v[28:31], v[44:47], v[132:135]
    ds_read_b64_tr_b16 v[56:57], v9 offset:8192
    v_mfma_f32_16x16x32_bf16 v[136:139], v[32:35], v[44:47], v[136:139]
    ds_read_b64_tr_b16 v[58:59], v9 offset:8704
    v_mfma_f32_16x16x32_bf16 v[140:143], v[36:39], v[44:47], v[140:143]
    ds_read_b64_tr_b16 v[60:61], v8 offset:16384
    v_mfma_f32_16x16x32_bf16 v[144:147], v[40:43], v[44:47], v[144:147]
    ds_read_b64_tr_b16 v[62:63], v8 offset:16896
    v_mfma_f32_16x16x32_bf16 v[148:151], v[28:31], v[48:51], v[148:151]
    ds_read_b64_tr_b16 v[64:65], v9 offset:16384
    v_mfma_f32_16x16x32_bf16 v[152:155], v[32:35], v[48:51], v[152:155]
    ds_read_b64_tr_b16 v[66:67], v9 offset:16896
    v_mfma_f32_16x16x32_bf16 v[156:159], v[36:39], v[48:51], v[156:159]
    v_mfma_f32_16x16x32_bf16 v[160:163], v[40:43], v[48:51], v[160:163]
    s_waitcnt lgkmcnt(9)
    v_mfma_f32_16x16x32_bf16 v[100:103], v[12:15], v[52:55], v[100:103]
    ds_read_b128 v[28:31], v5 offset:0
    s_waitcnt lgkmcnt(9)
    v_mfma_f32_16x16x32_bf16 v[104:107], v[16:19], v[52:55], v[104:107]
    ds_read_b64_tr_b16 v[44:45], v8 offset:12288
    s_waitcnt lgkmcnt(9)
    v_mfma_f32_16x16x32_bf16 v[108:111], v[20:23], v[52:55], v[108:111]
    ds_read_b64_tr_b16 v[46:47], v8 offset:12800
    s_waitcnt lgkmcnt(9)
    v_mfma_f32_16x16x32_bf16 v[112:115], v[24:27], v[52:55], v[112:115]
    ds_read_b128 v[32:35], v5 offset:2048
    s_waitcnt lgkmcnt(8)
    v_mfma_f32_16x16x32_bf16 v[116:119], v[12:15], v[56:59], v[116:119]
    ds_read_b128 v[36:39], v5 offset:4096
    v_mfma_f32_16x16x32_bf16 v[120:123], v[16:19], v[56:59], v[120:123]
    ds_read_b128 v[40:43], v5 offset:6144
    v_mfma_f32_16x16x32_bf16 v[124:127], v[20:23], v[56:59], v[124:127]
    ds_read_b64_tr_b16 v[48:49], v9 offset:12288
    v_mfma_f32_16x16x32_bf16 v[128:131], v[24:27], v[56:59], v[128:131]
    ds_read_b64_tr_b16 v[50:51], v9 offset:12800
    s_waitcnt lgkmcnt(10)
    v_mfma_f32_16x16x32_bf16 v[132:135], v[12:15], v[60:63], v[132:135]
    ds_read_b64_tr_b16 v[52:53], v8 offset:20480
    v_mfma_f32_16x16x32_bf16 v[136:139], v[16:19], v[60:63], v[136:139]
    ds_read_b64_tr_b16 v[54:55], v8 offset:20992
    v_mfma_f32_16x16x32_bf16 v[140:143], v[20:23], v[60:63], v[140:143]
    ds_read_b64_tr_b16 v[56:57], v9 offset:20480
    v_mfma_f32_16x16x32_bf16 v[144:147], v[24:27], v[60:63], v[144:147]
    ds_read_b64_tr_b16 v[58:59], v9 offset:20992
    s_waitcnt lgkmcnt(12)
    v_mfma_f32_16x16x32_bf16 v[148:151], v[12:15], v[64:67], v[148:151]
    v_mfma_f32_16x16x32_bf16 v[152:155], v[16:19], v[64:67], v[152:155]
    v_mfma_f32_16x16x32_bf16 v[156:159], v[20:23], v[64:67], v[156:159]
    v_mfma_f32_16x16x32_bf16 v[160:163], v[24:27], v[64:67], v[160:163]
    s_waitcnt lgkmcnt(9)
    v_mfma_f32_16x16x32_bf16 v[100:103], v[28:31], v[44:47], v[100:103]
    s_waitcnt lgkmcnt(8)
    v_mfma_f32_16x16x32_bf16 v[104:107], v[32:35], v[44:47], v[104:107]
    s_waitcnt lgkmcnt(0)
    s_barrier
    v_mfma_f32_16x16x32_bf16 v[108:111], v[36:39], v[44:47], v[108:111]
    ds_read_b128 v[12:15], v4 offset:16384
    v_mfma_f32_16x16x32_bf16 v[112:115], v[40:43], v[44:47], v[112:115]
    ds_read_b64_tr_b16 v[60:61], v10 offset:0
    v_mfma_f32_16x16x32_bf16 v[116:119], v[28:31], v[48:51], v[116:119]
    ds_read_b64_tr_b16 v[62:63], v10 offset:512
    v_mfma_f32_16x16x32_bf16 v[120:123], v[32:35], v[48:51], v[120:123]
    ds_read_b128 v[16:19], v4 offset:18432
    v_mfma_f32_16x16x32_bf16 v[124:127], v[36:39], v[48:51], v[124:127]
    ds_read_b128 v[20:23], v4 offset:20480
    v_mfma_f32_16x16x32_bf16 v[128:131], v[40:43], v[48:51], v[128:131]
    ds_read_b128 v[24:27], v4 offset:22528
    v_mfma_f32_16x16x32_bf16 v[132:135], v[28:31], v[52:55], v[132:135]
    ds_read_b64_tr_b16 v[64:65], v11 offset:0
    v_mfma_f32_16x16x32_bf16 v[136:139], v[32:35], v[52:55], v[136:139]
    ds_read_b64_tr_b16 v[66:67], v11 offset:512
    v_mfma_f32_16x16x32_bf16 v[140:143], v[36:39], v[52:55], v[140:143]
    ds_read_b64_tr_b16 v[44:45], v10 offset:8192
    v_mfma_f32_16x16x32_bf16 v[144:147], v[40:43], v[52:55], v[144:147]
    ds_read_b64_tr_b16 v[46:47], v10 offset:8704
    v_mfma_f32_16x16x32_bf16 v[148:151], v[28:31], v[56:59], v[148:151]
    ds_read_b64_tr_b16 v[48:49], v11 offset:8192
    v_mfma_f32_16x16x32_bf16 v[152:155], v[32:35], v[56:59], v[152:155]
    ds_read_b64_tr_b16 v[50:51], v11 offset:8704
    v_mfma_f32_16x16x32_bf16 v[156:159], v[36:39], v[56:59], v[156:159]
    v_mfma_f32_16x16x32_bf16 v[160:163], v[40:43], v[56:59], v[160:163]
    s_waitcnt lgkmcnt(9)
    v_mfma_f32_16x16x32_bf16 v[100:103], v[12:15], v[60:63], v[100:103]
    ds_read_b128 v[28:31], v5 offset:16384
    s_waitcnt lgkmcnt(9)
    v_mfma_f32_16x16x32_bf16 v[104:107], v[16:19], v[60:63], v[104:107]
    ds_read_b64_tr_b16 v[52:53], v10 offset:4096
    s_waitcnt lgkmcnt(9)
    v_mfma_f32_16x16x32_bf16 v[108:111], v[20:23], v[60:63], v[108:111]
    ds_read_b64_tr_b16 v[54:55], v10 offset:4608
    s_waitcnt lgkmcnt(9)
    v_mfma_f32_16x16x32_bf16 v[112:115], v[24:27], v[60:63], v[112:115]
    ds_read_b128 v[32:35], v5 offset:18432
    s_waitcnt lgkmcnt(8)
    v_mfma_f32_16x16x32_bf16 v[116:119], v[12:15], v[64:67], v[116:119]
    ds_read_b128 v[36:39], v5 offset:20480
    v_mfma_f32_16x16x32_bf16 v[120:123], v[16:19], v[64:67], v[120:123]
    ds_read_b128 v[40:43], v5 offset:22528
    v_mfma_f32_16x16x32_bf16 v[124:127], v[20:23], v[64:67], v[124:127]
    ds_read_b64_tr_b16 v[56:57], v11 offset:4096
    v_mfma_f32_16x16x32_bf16 v[128:131], v[24:27], v[64:67], v[128:131]
    ds_read_b64_tr_b16 v[58:59], v11 offset:4608
    s_waitcnt lgkmcnt(10)
    v_mfma_f32_16x16x32_bf16 v[132:135], v[12:15], v[44:47], v[132:135]
    ds_read_b64_tr_b16 v[60:61], v10 offset:12288
    v_mfma_f32_16x16x32_bf16 v[136:139], v[16:19], v[44:47], v[136:139]
    ds_read_b64_tr_b16 v[62:63], v10 offset:12800
    v_mfma_f32_16x16x32_bf16 v[140:143], v[20:23], v[44:47], v[140:143]
    ds_read_b64_tr_b16 v[64:65], v11 offset:12288
    v_mfma_f32_16x16x32_bf16 v[144:147], v[24:27], v[44:47], v[144:147]
    ds_read_b64_tr_b16 v[66:67], v11 offset:12800
    s_waitcnt lgkmcnt(12)
    v_mfma_f32_16x16x32_bf16 v[148:151], v[12:15], v[48:51], v[148:151]
    v_mfma_f32_16x16x32_bf16 v[152:155], v[16:19], v[48:51], v[152:155]
    v_mfma_f32_16x16x32_bf16 v[156:159], v[20:23], v[48:51], v[156:159]
    v_mfma_f32_16x16x32_bf16 v[160:163], v[24:27], v[48:51], v[160:163]
    s_waitcnt lgkmcnt(9)
    v_mfma_f32_16x16x32_bf16 v[100:103], v[28:31], v[52:55], v[100:103]
    s_waitcnt lgkmcnt(8)
    v_mfma_f32_16x16x32_bf16 v[104:107], v[32:35], v[52:55], v[104:107]
    s_waitcnt lgkmcnt(0)
    s_barrier
    v_mfma_f32_16x16x32_bf16 v[108:111], v[36:39], v[52:55], v[108:111]
    ds_read_b128 v[12:15], v4 offset:32768
    v_mfma_f32_16x16x32_bf16 v[112:115], v[40:43], v[52:55], v[112:115]
    ds_read_b64_tr_b16 v[44:45], v10 offset:16384
    v_mfma_f32_16x16x32_bf16 v[116:119], v[28:31], v[56:59], v[116:119]
    ds_read_b64_tr_b16 v[46:47], v10 offset:16896
    v_mfma_f32_16x16x32_bf16 v[120:123], v[32:35], v[56:59], v[120:123]
    ds_read_b128 v[16:19], v4 offset:34816
    v_mfma_f32_16x16x32_bf16 v[124:127], v[36:39], v[56:59], v[124:127]
    ds_read_b128 v[20:23], v4 offset:36864
    v_mfma_f32_16x16x32_bf16 v[128:131], v[40:43], v[56:59], v[128:131]
    ds_read_b128 v[24:27], v4 offset:38912
    v_mfma_f32_16x16x32_bf16 v[132:135], v[28:31], v[60:63], v[132:135]
    ds_read_b64_tr_b16 v[48:49], v11 offset:16384
    v_mfma_f32_16x16x32_bf16 v[136:139], v[32:35], v[60:63], v[136:139]
    ds_read_b64_tr_b16 v[50:51], v11 offset:16896
    v_mfma_f32_16x16x32_bf16 v[140:143], v[36:39], v[60:63], v[140:143]
    ds_read_b64_tr_b16 v[52:53], v10 offset:24576
    v_mfma_f32_16x16x32_bf16 v[144:147], v[40:43], v[60:63], v[144:147]
    ds_read_b64_tr_b16 v[54:55], v10 offset:25088
    v_mfma_f32_16x16x32_bf16 v[148:151], v[28:31], v[64:67], v[148:151]
    ds_read_b64_tr_b16 v[56:57], v11 offset:24576
    v_mfma_f32_16x16x32_bf16 v[152:155], v[32:35], v[64:67], v[152:155]
    ds_read_b64_tr_b16 v[58:59], v11 offset:25088
    v_mfma_f32_16x16x32_bf16 v[156:159], v[36:39], v[64:67], v[156:159]
    v_mfma_f32_16x16x32_bf16 v[160:163], v[40:43], v[64:67], v[160:163]
    s_waitcnt lgkmcnt(9)
    v_mfma_f32_16x16x32_bf16 v[100:103], v[12:15], v[44:47], v[100:103]
    ds_read_b128 v[28:31], v5 offset:32768
    s_waitcnt lgkmcnt(9)
    v_mfma_f32_16x16x32_bf16 v[104:107], v[16:19], v[44:47], v[104:107]
    ds_read_b64_tr_b16 v[60:61], v10 offset:20480
    s_waitcnt lgkmcnt(9)
    v_mfma_f32_16x16x32_bf16 v[108:111], v[20:23], v[44:47], v[108:111]
    ds_read_b64_tr_b16 v[62:63], v10 offset:20992
    s_waitcnt lgkmcnt(9)
    v_mfma_f32_16x16x32_bf16 v[112:115], v[24:27], v[44:47], v[112:115]
    ds_read_b128 v[32:35], v5 offset:34816
    s_waitcnt lgkmcnt(8)
    v_mfma_f32_16x16x32_bf16 v[116:119], v[12:15], v[48:51], v[116:119]
    ds_read_b128 v[36:39], v5 offset:36864
    v_mfma_f32_16x16x32_bf16 v[120:123], v[16:19], v[48:51], v[120:123]
    ds_read_b128 v[40:43], v5 offset:38912
    v_mfma_f32_16x16x32_bf16 v[124:127], v[20:23], v[48:51], v[124:127]
    ds_read_b64_tr_b16 v[64:65], v11 offset:20480
    v_mfma_f32_16x16x32_bf16 v[128:131], v[24:27], v[48:51], v[128:131]
    ds_read_b64_tr_b16 v[66:67], v11 offset:20992
    s_waitcnt lgkmcnt(10)
    v_mfma_f32_16x16x32_bf16 v[132:135], v[12:15], v[52:55], v[132:135]
    ds_read_b64_tr_b16 v[44:45], v10 offset:28672
    v_mfma_f32_16x16x32_bf16 v[136:139], v[16:19], v[52:55], v[136:139]
    ds_read_b64_tr_b16 v[46:47], v10 offset:29184
    v_mfma_f32_16x16x32_bf16 v[140:143], v[20:23], v[52:55], v[140:143]
    ds_read_b64_tr_b16 v[48:49], v11 offset:28672
    v_mfma_f32_16x16x32_bf16 v[144:147], v[24:27], v[52:55], v[144:147]
    ds_read_b64_tr_b16 v[50:51], v11 offset:29184
    s_waitcnt lgkmcnt(12)
    v_mfma_f32_16x16x32_bf16 v[148:151], v[12:15], v[56:59], v[148:151]
    v_mfma_f32_16x16x32_bf16 v[152:155], v[16:19], v[56:59], v[152:155]
    v_mfma_f32_16x16x32_bf16 v[156:159], v[20:23], v[56:59], v[156:159]
    v_mfma_f32_16x16x32_bf16 v[160:163], v[24:27], v[56:59], v[160:163]
    s_waitcnt lgkmcnt(9)
    v_mfma_f32_16x16x32_bf16 v[100:103], v[28:31], v[60:63], v[100:103]
    s_waitcnt lgkmcnt(8)
    v_mfma_f32_16x16x32_bf16 v[104:107], v[32:35], v[60:63], v[104:107]
    s_waitcnt lgkmcnt(0)
    s_barrier
    v_mfma_f32_16x16x32_bf16 v[108:111], v[36:39], v[60:63], v[108:111]
    ds_read_b128 v[12:15], v4 offset:49152
    v_mfma_f32_16x16x32_bf16 v[112:115], v[40:43], v[60:63], v[112:115]
    ds_read_b64_tr_b16 v[52:53], v8 offset:0
    v_mfma_f32_16x16x32_bf16 v[116:119], v[28:31], v[64:67], v[116:119]
    ds_read_b64_tr_b16 v[54:55], v8 offset:512
    v_mfma_f32_16x16x32_bf16 v[120:123], v[32:35], v[64:67], v[120:123]
    ds_read_b128 v[16:19], v4 offset:51200
    v_mfma_f32_16x16x32_bf16 v[124:127], v[36:39], v[64:67], v[124:127]
    ds_read_b128 v[20:23], v4 offset:53248
    v_mfma_f32_16x16x32_bf16 v[128:131], v[40:43], v[64:67], v[128:131]
    ds_read_b128 v[24:27], v4 offset:55296
    v_mfma_f32_16x16x32_bf16 v[132:135], v[28:31], v[44:47], v[132:135]
    ds_read_b64_tr_b16 v[56:57], v9 offset:0
    v_mfma_f32_16x16x32_bf16 v[136:139], v[32:35], v[44:47], v[136:139]
    ds_read_b64_tr_b16 v[58:59], v9 offset:512
    v_mfma_f32_16x16x32_bf16 v[140:143], v[36:39], v[44:47], v[140:143]
    ds_read_b64_tr_b16 v[60:61], v10 offset:32768
    v_mfma_f32_16x16x32_bf16 v[144:147], v[40:43], v[44:47], v[144:147]
    ds_read_b64_tr_b16 v[62:63], v10 offset:33280
    v_mfma_f32_16x16x32_bf16 v[148:151], v[28:31], v[48:51], v[148:151]
    ds_read_b64_tr_b16 v[64:65], v11 offset:32768
    v_mfma_f32_16x16x32_bf16 v[152:155], v[32:35], v[48:51], v[152:155]
    ds_read_b64_tr_b16 v[66:67], v11 offset:33280
    v_mfma_f32_16x16x32_bf16 v[156:159], v[36:39], v[48:51], v[156:159]
    v_mfma_f32_16x16x32_bf16 v[160:163], v[40:43], v[48:51], v[160:163]
    s_waitcnt lgkmcnt(9)
    v_mfma_f32_16x16x32_bf16 v[100:103], v[12:15], v[52:55], v[100:103]
    ds_read_b128 v[28:31], v5 offset:49152
    s_waitcnt lgkmcnt(9)
    v_mfma_f32_16x16x32_bf16 v[104:107], v[16:19], v[52:55], v[104:107]
    ds_read_b64_tr_b16 v[44:45], v8 offset:4096
    s_waitcnt lgkmcnt(9)
    v_mfma_f32_16x16x32_bf16 v[108:111], v[20:23], v[52:55], v[108:111]
    ds_read_b64_tr_b16 v[46:47], v8 offset:4608
    s_waitcnt lgkmcnt(9)
    v_mfma_f32_16x16x32_bf16 v[112:115], v[24:27], v[52:55], v[112:115]
    ds_read_b128 v[32:35], v5 offset:51200
    s_waitcnt lgkmcnt(8)
    v_mfma_f32_16x16x32_bf16 v[116:119], v[12:15], v[56:59], v[116:119]
    ds_read_b128 v[36:39], v5 offset:53248
    v_mfma_f32_16x16x32_bf16 v[120:123], v[16:19], v[56:59], v[120:123]
    ds_read_b128 v[40:43], v5 offset:55296
    v_mfma_f32_16x16x32_bf16 v[124:127], v[20:23], v[56:59], v[124:127]
    ds_read_b64_tr_b16 v[48:49], v9 offset:4096
    v_mfma_f32_16x16x32_bf16 v[128:131], v[24:27], v[56:59], v[128:131]
    ds_read_b64_tr_b16 v[50:51], v9 offset:4608
    s_waitcnt lgkmcnt(10)
    v_mfma_f32_16x16x32_bf16 v[132:135], v[12:15], v[60:63], v[132:135]
    ds_read_b64_tr_b16 v[52:53], v10 offset:36864
    v_mfma_f32_16x16x32_bf16 v[136:139], v[16:19], v[60:63], v[136:139]
    ds_read_b64_tr_b16 v[54:55], v10 offset:37376
    v_mfma_f32_16x16x32_bf16 v[140:143], v[20:23], v[60:63], v[140:143]
    ds_read_b64_tr_b16 v[56:57], v11 offset:36864
    v_mfma_f32_16x16x32_bf16 v[144:147], v[24:27], v[60:63], v[144:147]
    ds_read_b64_tr_b16 v[58:59], v11 offset:37376
    s_waitcnt lgkmcnt(12)
    v_mfma_f32_16x16x32_bf16 v[148:151], v[12:15], v[64:67], v[148:151]
    v_mfma_f32_16x16x32_bf16 v[152:155], v[16:19], v[64:67], v[152:155]
    v_mfma_f32_16x16x32_bf16 v[156:159], v[20:23], v[64:67], v[156:159]
    v_mfma_f32_16x16x32_bf16 v[160:163], v[24:27], v[64:67], v[160:163]
    s_waitcnt lgkmcnt(9)
    v_mfma_f32_16x16x32_bf16 v[100:103], v[28:31], v[44:47], v[100:103]
    s_waitcnt lgkmcnt(8)
    v_mfma_f32_16x16x32_bf16 v[104:107], v[32:35], v[44:47], v[104:107]
    s_waitcnt lgkmcnt(0)
    s_barrier
    v_mfma_f32_16x16x32_bf16 v[108:111], v[36:39], v[44:47], v[108:111]
    ds_read_b128 v[12:15], v4 offset:0
    v_mfma_f32_16x16x32_bf16 v[112:115], v[40:43], v[44:47], v[112:115]
    ds_read_b64_tr_b16 v[60:61], v8 offset:8192
    v_mfma_f32_16x16x32_bf16 v[116:119], v[28:31], v[48:51], v[116:119]
    ds_read_b64_tr_b16 v[62:63], v8 offset:8704
    v_mfma_f32_16x16x32_bf16 v[120:123], v[32:35], v[48:51], v[120:123]
    ds_read_b128 v[16:19], v4 offset:2048
    v_mfma_f32_16x16x32_bf16 v[124:127], v[36:39], v[48:51], v[124:127]
    ds_read_b128 v[20:23], v4 offset:4096
    v_mfma_f32_16x16x32_bf16 v[128:131], v[40:43], v[48:51], v[128:131]
    ds_read_b128 v[24:27], v4 offset:6144
    v_mfma_f32_16x16x32_bf16 v[132:135], v[28:31], v[52:55], v[132:135]
    ds_read_b64_tr_b16 v[64:65], v9 offset:8192
    v_mfma_f32_16x16x32_bf16 v[136:139], v[32:35], v[52:55], v[136:139]
    ds_read_b64_tr_b16 v[66:67], v9 offset:8704
    v_mfma_f32_16x16x32_bf16 v[140:143], v[36:39], v[52:55], v[140:143]
    ds_read_b64_tr_b16 v[44:45], v8 offset:16384
    v_mfma_f32_16x16x32_bf16 v[144:147], v[40:43], v[52:55], v[144:147]
    ds_read_b64_tr_b16 v[46:47], v8 offset:16896
    v_mfma_f32_16x16x32_bf16 v[148:151], v[28:31], v[56:59], v[148:151]
    ds_read_b64_tr_b16 v[48:49], v9 offset:16384
    v_mfma_f32_16x16x32_bf16 v[152:155], v[32:35], v[56:59], v[152:155]
    ds_read_b64_tr_b16 v[50:51], v9 offset:16896
    v_mfma_f32_16x16x32_bf16 v[156:159], v[36:39], v[56:59], v[156:159]
    v_mfma_f32_16x16x32_bf16 v[160:163], v[40:43], v[56:59], v[160:163]
    s_waitcnt lgkmcnt(9)
    v_mfma_f32_16x16x32_bf16 v[100:103], v[12:15], v[60:63], v[100:103]
    ds_read_b128 v[28:31], v5 offset:0
    s_waitcnt lgkmcnt(9)
    v_mfma_f32_16x16x32_bf16 v[104:107], v[16:19], v[60:63], v[104:107]
    ds_read_b64_tr_b16 v[52:53], v8 offset:12288
    s_waitcnt lgkmcnt(9)
    v_mfma_f32_16x16x32_bf16 v[108:111], v[20:23], v[60:63], v[108:111]
    ds_read_b64_tr_b16 v[54:55], v8 offset:12800
    s_waitcnt lgkmcnt(9)
    v_mfma_f32_16x16x32_bf16 v[112:115], v[24:27], v[60:63], v[112:115]
    ds_read_b128 v[32:35], v5 offset:2048
    s_waitcnt lgkmcnt(8)
    v_mfma_f32_16x16x32_bf16 v[116:119], v[12:15], v[64:67], v[116:119]
    ds_read_b128 v[36:39], v5 offset:4096
    v_mfma_f32_16x16x32_bf16 v[120:123], v[16:19], v[64:67], v[120:123]
    ds_read_b128 v[40:43], v5 offset:6144
    v_mfma_f32_16x16x32_bf16 v[124:127], v[20:23], v[64:67], v[124:127]
    ds_read_b64_tr_b16 v[56:57], v9 offset:12288
    v_mfma_f32_16x16x32_bf16 v[128:131], v[24:27], v[64:67], v[128:131]
    ds_read_b64_tr_b16 v[58:59], v9 offset:12800
    s_waitcnt lgkmcnt(10)
    v_mfma_f32_16x16x32_bf16 v[132:135], v[12:15], v[44:47], v[132:135]
    ds_read_b64_tr_b16 v[60:61], v8 offset:20480
    v_mfma_f32_16x16x32_bf16 v[136:139], v[16:19], v[44:47], v[136:139]
    ds_read_b64_tr_b16 v[62:63], v8 offset:20992
    v_mfma_f32_16x16x32_bf16 v[140:143], v[20:23], v[44:47], v[140:143]
    ds_read_b64_tr_b16 v[64:65], v9 offset:20480
    v_mfma_f32_16x16x32_bf16 v[144:147], v[24:27], v[44:47], v[144:147]
    ds_read_b64_tr_b16 v[66:67], v9 offset:20992
    s_waitcnt lgkmcnt(12)
    v_mfma_f32_16x16x32_bf16 v[148:151], v[12:15], v[48:51], v[148:151]
    v_mfma_f32_16x16x32_bf16 v[152:155], v[16:19], v[48:51], v[152:155]
    v_mfma_f32_16x16x32_bf16 v[156:159], v[20:23], v[48:51], v[156:159]
    v_mfma_f32_16x16x32_bf16 v[160:163], v[24:27], v[48:51], v[160:163]
    s_waitcnt lgkmcnt(9)
    v_mfma_f32_16x16x32_bf16 v[100:103], v[28:31], v[52:55], v[100:103]
    s_waitcnt lgkmcnt(8)
    v_mfma_f32_16x16x32_bf16 v[104:107], v[32:35], v[52:55], v[104:107]
    s_waitcnt lgkmcnt(0)
    s_barrier
    v_mfma_f32_16x16x32_bf16 v[108:111], v[36:39], v[52:55], v[108:111]
    ds_read_b128 v[12:15], v4 offset:16384
    v_mfma_f32_16x16x32_bf16 v[112:115], v[40:43], v[52:55], v[112:115]
    ds_read_b64_tr_b16 v[44:45], v8 offset:24576
    v_mfma_f32_16x16x32_bf16 v[116:119], v[28:31], v[56:59], v[116:119]
    ds_read_b64_tr_b16 v[46:47], v8 offset:25088
    v_mfma_f32_16x16x32_bf16 v[120:123], v[32:35], v[56:59], v[120:123]
    ds_read_b128 v[16:19], v4 offset:18432
    v_mfma_f32_16x16x32_bf16 v[124:127], v[36:39], v[56:59], v[124:127]
    ds_read_b128 v[20:23], v4 offset:20480
    v_mfma_f32_16x16x32_bf16 v[128:131], v[40:43], v[56:59], v[128:131]
    ds_read_b128 v[24:27], v4 offset:22528
    v_mfma_f32_16x16x32_bf16 v[132:135], v[28:31], v[60:63], v[132:135]
    ds_read_b64_tr_b16 v[48:49], v9 offset:24576
    v_mfma_f32_16x16x32_bf16 v[136:139], v[32:35], v[60:63], v[136:139]
    ds_read_b64_tr_b16 v[50:51], v9 offset:25088
    v_mfma_f32_16x16x32_bf16 v[140:143], v[36:39], v[60:63], v[140:143]
    ds_read_b64_tr_b16 v[52:53], v10 offset:0
    v_mfma_f32_16x16x32_bf16 v[144:147], v[40:43], v[60:63], v[144:147]
    ds_read_b64_tr_b16 v[54:55], v10 offset:512
    v_mfma_f32_16x16x32_bf16 v[148:151], v[28:31], v[64:67], v[148:151]
    ds_read_b64_tr_b16 v[56:57], v11 offset:0
    v_mfma_f32_16x16x32_bf16 v[152:155], v[32:35], v[64:67], v[152:155]
    ds_read_b64_tr_b16 v[58:59], v11 offset:512
    v_mfma_f32_16x16x32_bf16 v[156:159], v[36:39], v[64:67], v[156:159]
    v_mfma_f32_16x16x32_bf16 v[160:163], v[40:43], v[64:67], v[160:163]
    s_waitcnt lgkmcnt(9)
    v_mfma_f32_16x16x32_bf16 v[100:103], v[12:15], v[44:47], v[100:103]
    ds_read_b128 v[28:31], v5 offset:16384
    s_waitcnt lgkmcnt(9)
    v_mfma_f32_16x16x32_bf16 v[104:107], v[16:19], v[44:47], v[104:107]
    ds_read_b64_tr_b16 v[60:61], v8 offset:28672
    s_waitcnt lgkmcnt(9)
    v_mfma_f32_16x16x32_bf16 v[108:111], v[20:23], v[44:47], v[108:111]
    ds_read_b64_tr_b16 v[62:63], v8 offset:29184
    s_waitcnt lgkmcnt(9)
    v_mfma_f32_16x16x32_bf16 v[112:115], v[24:27], v[44:47], v[112:115]
    ds_read_b128 v[32:35], v5 offset:18432
    s_waitcnt lgkmcnt(8)
    v_mfma_f32_16x16x32_bf16 v[116:119], v[12:15], v[48:51], v[116:119]
    ds_read_b128 v[36:39], v5 offset:20480
    v_mfma_f32_16x16x32_bf16 v[120:123], v[16:19], v[48:51], v[120:123]
    ds_read_b128 v[40:43], v5 offset:22528
    v_mfma_f32_16x16x32_bf16 v[124:127], v[20:23], v[48:51], v[124:127]
    ds_read_b64_tr_b16 v[64:65], v9 offset:28672
    v_mfma_f32_16x16x32_bf16 v[128:131], v[24:27], v[48:51], v[128:131]
    ds_read_b64_tr_b16 v[66:67], v9 offset:29184
    s_waitcnt lgkmcnt(10)
    v_mfma_f32_16x16x32_bf16 v[132:135], v[12:15], v[52:55], v[132:135]
    ds_read_b64_tr_b16 v[44:45], v10 offset:4096
    v_mfma_f32_16x16x32_bf16 v[136:139], v[16:19], v[52:55], v[136:139]
    ds_read_b64_tr_b16 v[46:47], v10 offset:4608
    v_mfma_f32_16x16x32_bf16 v[140:143], v[20:23], v[52:55], v[140:143]
    ds_read_b64_tr_b16 v[48:49], v11 offset:4096
    v_mfma_f32_16x16x32_bf16 v[144:147], v[24:27], v[52:55], v[144:147]
    ds_read_b64_tr_b16 v[50:51], v11 offset:4608
    s_waitcnt lgkmcnt(12)
    v_mfma_f32_16x16x32_bf16 v[148:151], v[12:15], v[56:59], v[148:151]
    v_mfma_f32_16x16x32_bf16 v[152:155], v[16:19], v[56:59], v[152:155]
    v_mfma_f32_16x16x32_bf16 v[156:159], v[20:23], v[56:59], v[156:159]
    v_mfma_f32_16x16x32_bf16 v[160:163], v[24:27], v[56:59], v[160:163]
    s_waitcnt lgkmcnt(9)
    v_mfma_f32_16x16x32_bf16 v[100:103], v[28:31], v[60:63], v[100:103]
    s_waitcnt lgkmcnt(8)
    v_mfma_f32_16x16x32_bf16 v[104:107], v[32:35], v[60:63], v[104:107]
    s_waitcnt lgkmcnt(0)
    s_barrier
    v_mfma_f32_16x16x32_bf16 v[108:111], v[36:39], v[60:63], v[108:111]
    ds_read_b128 v[12:15], v4 offset:32768
    v_mfma_f32_16x16x32_bf16 v[112:115], v[40:43], v[60:63], v[112:115]
    ds_read_b64_tr_b16 v[52:53], v10 offset:16384
    v_mfma_f32_16x16x32_bf16 v[116:119], v[28:31], v[64:67], v[116:119]
    ds_read_b64_tr_b16 v[54:55], v10 offset:16896
    v_mfma_f32_16x16x32_bf16 v[120:123], v[32:35], v[64:67], v[120:123]
    ds_read_b128 v[16:19], v4 offset:34816
    v_mfma_f32_16x16x32_bf16 v[124:127], v[36:39], v[64:67], v[124:127]
    ds_read_b128 v[20:23], v4 offset:36864
    v_mfma_f32_16x16x32_bf16 v[128:131], v[40:43], v[64:67], v[128:131]
    ds_read_b128 v[24:27], v4 offset:38912
    v_mfma_f32_16x16x32_bf16 v[132:135], v[28:31], v[44:47], v[132:135]
    ds_read_b64_tr_b16 v[56:57], v11 offset:16384
    v_mfma_f32_16x16x32_bf16 v[136:139], v[32:35], v[44:47], v[136:139]
    ds_read_b64_tr_b16 v[58:59], v11 offset:16896
    v_mfma_f32_16x16x32_bf16 v[140:143], v[36:39], v[44:47], v[140:143]
    ds_read_b64_tr_b16 v[60:61], v10 offset:24576
    v_mfma_f32_16x16x32_bf16 v[144:147], v[40:43], v[44:47], v[144:147]
    ds_read_b64_tr_b16 v[62:63], v10 offset:25088
    v_mfma_f32_16x16x32_bf16 v[148:151], v[28:31], v[48:51], v[148:151]
    ds_read_b64_tr_b16 v[64:65], v11 offset:24576
    v_mfma_f32_16x16x32_bf16 v[152:155], v[32:35], v[48:51], v[152:155]
    ds_read_b64_tr_b16 v[66:67], v11 offset:25088
    v_mfma_f32_16x16x32_bf16 v[156:159], v[36:39], v[48:51], v[156:159]
    v_mfma_f32_16x16x32_bf16 v[160:163], v[40:43], v[48:51], v[160:163]
    s_waitcnt lgkmcnt(9)
    v_mfma_f32_16x16x32_bf16 v[100:103], v[12:15], v[52:55], v[100:103]
    ds_read_b128 v[28:31], v5 offset:32768
    s_waitcnt lgkmcnt(9)
    v_mfma_f32_16x16x32_bf16 v[104:107], v[16:19], v[52:55], v[104:107]
    ds_read_b64_tr_b16 v[44:45], v10 offset:20480
    s_waitcnt lgkmcnt(9)
    v_mfma_f32_16x16x32_bf16 v[108:111], v[20:23], v[52:55], v[108:111]
    ds_read_b64_tr_b16 v[46:47], v10 offset:20992
    s_waitcnt lgkmcnt(9)
    v_mfma_f32_16x16x32_bf16 v[112:115], v[24:27], v[52:55], v[112:115]
    ds_read_b128 v[32:35], v5 offset:34816
    s_waitcnt lgkmcnt(8)
    v_mfma_f32_16x16x32_bf16 v[116:119], v[12:15], v[56:59], v[116:119]
    ds_read_b128 v[36:39], v5 offset:36864
    v_mfma_f32_16x16x32_bf16 v[120:123], v[16:19], v[56:59], v[120:123]
    ds_read_b128 v[40:43], v5 offset:38912
    v_mfma_f32_16x16x32_bf16 v[124:127], v[20:23], v[56:59], v[124:127]
    ds_read_b64_tr_b16 v[48:49], v11 offset:20480
    v_mfma_f32_16x16x32_bf16 v[128:131], v[24:27], v[56:59], v[128:131]
    ds_read_b64_tr_b16 v[50:51], v11 offset:20992
    s_waitcnt lgkmcnt(10)
    v_mfma_f32_16x16x32_bf16 v[132:135], v[12:15], v[60:63], v[132:135]
    ds_read_b64_tr_b16 v[52:53], v10 offset:28672
    v_mfma_f32_16x16x32_bf16 v[136:139], v[16:19], v[60:63], v[136:139]
    ds_read_b64_tr_b16 v[54:55], v10 offset:29184
    v_mfma_f32_16x16x32_bf16 v[140:143], v[20:23], v[60:63], v[140:143]
    ds_read_b64_tr_b16 v[56:57], v11 offset:28672
    v_mfma_f32_16x16x32_bf16 v[144:147], v[24:27], v[60:63], v[144:147]
    ds_read_b64_tr_b16 v[58:59], v11 offset:29184
    s_waitcnt lgkmcnt(12)
    v_mfma_f32_16x16x32_bf16 v[148:151], v[12:15], v[64:67], v[148:151]
    v_mfma_f32_16x16x32_bf16 v[152:155], v[16:19], v[64:67], v[152:155]
    v_mfma_f32_16x16x32_bf16 v[156:159], v[20:23], v[64:67], v[156:159]
    v_mfma_f32_16x16x32_bf16 v[160:163], v[24:27], v[64:67], v[160:163]
    s_waitcnt lgkmcnt(9)
    v_mfma_f32_16x16x32_bf16 v[100:103], v[28:31], v[44:47], v[100:103]
    s_waitcnt lgkmcnt(8)
    v_mfma_f32_16x16x32_bf16 v[104:107], v[32:35], v[44:47], v[104:107]
    s_waitcnt lgkmcnt(0)
    s_barrier
    v_mfma_f32_16x16x32_bf16 v[108:111], v[36:39], v[44:47], v[108:111]
    ds_read_b128 v[12:15], v4 offset:49152
    v_mfma_f32_16x16x32_bf16 v[112:115], v[40:43], v[44:47], v[112:115]
    ds_read_b64_tr_b16 v[60:61], v8 offset:0
    v_mfma_f32_16x16x32_bf16 v[116:119], v[28:31], v[48:51], v[116:119]
    ds_read_b64_tr_b16 v[62:63], v8 offset:512
    v_mfma_f32_16x16x32_bf16 v[120:123], v[32:35], v[48:51], v[120:123]
    ds_read_b128 v[16:19], v4 offset:51200
    v_mfma_f32_16x16x32_bf16 v[124:127], v[36:39], v[48:51], v[124:127]
    ds_read_b128 v[20:23], v4 offset:53248
    v_mfma_f32_16x16x32_bf16 v[128:131], v[40:43], v[48:51], v[128:131]
    ds_read_b128 v[24:27], v4 offset:55296
    v_mfma_f32_16x16x32_bf16 v[132:135], v[28:31], v[52:55], v[132:135]
    ds_read_b64_tr_b16 v[64:65], v9 offset:0
    v_mfma_f32_16x16x32_bf16 v[136:139], v[32:35], v[52:55], v[136:139]
    ds_read_b64_tr_b16 v[66:67], v9 offset:512
    v_mfma_f32_16x16x32_bf16 v[140:143], v[36:39], v[52:55], v[140:143]
    ds_read_b64_tr_b16 v[44:45], v10 offset:32768
    s_branch IW_s4
IW_w4:
    s_branch IW_r4
IW_s4:
    v_mfma_f32_16x16x32_bf16 v[144:147], v[40:43], v[52:55], v[144:147]
    ds_read_b64_tr_b16 v[46:47], v10 offset:33280
    v_mfma_f32_16x16x32_bf16 v[148:151], v[28:31], v[56:59], v[148:151]
    ds_read_b64_tr_b16 v[48:49], v11 offset:32768
    v_mfma_f32_16x16x32_bf16 v[152:155], v[32:35], v[56:59], v[152:155]
    ds_read_b64_tr_b16 v[50:51], v11 offset:33280
    v_mfma_f32_16x16x32_bf16 v[156:159], v[36:39], v[56:59], v[156:159]
    v_mfma_f32_16x16x32_bf16 v[160:163], v[40:43], v[56:59], v[160:163]
    s_waitcnt lgkmcnt(9)
    v_mfma_f32_16x16x32_bf16 v[100:103], v[12:15], v[60:63], v[100:103]
    ds_read_b128 v[28:31], v5 offset:49152
    s_waitcnt lgkmcnt(9)
    v_mfma_f32_16x16x32_bf16 v[104:107], v[16:19], v[60:63], v[104:107]
    ds_read_b64_tr_b16 v[52:53], v8 offset:4096
    s_waitcnt lgkmcnt(9)
    v_mfma_f32_16x16x32_bf16 v[108:111], v[20:23], v[60:63], v[108:111]
    ds_read_b64_tr_b16 v[54:55], v8 offset:4608
    s_waitcnt lgkmcnt(9)
    v_mfma_f32_16x16x32_bf16 v[112:115], v[24:27], v[60:63], v[112:115]
    ds_read_b128 v[32:35], v5 offset:51200
    s_waitcnt lgkmcnt(8)
    v_mfma_f32_16x16x32_bf16 v[116:119], v[12:15], v[64:67], v[116:119]
    ds_read_b128 v[36:39], v5 offset:53248
    v_mfma_f32_16x16x32_bf16 v[120:123], v[16:19], v[64:67], v[120:123]
    ds_read_b128 v[40:43], v5 offset:55296
    v_mfma_f32_16x16x32_bf16 v[124:127], v[20:23], v[64:67], v[124:127]
    ds_read_b64_tr_b16 v[56:57], v9 offset:4096
    v_mfma_f32_16x16x32_bf16 v[128:131], v[24:27], v[64:67], v[128:131]
    ds_read_b64_tr_b16 v[58:59], v9 offset:4608
    s_waitcnt lgkmcnt(10)
    v_mfma_f32_16x16x32_bf16 v[132:135], v[12:15], v[44:47], v[132:135]
    ds_read_b64_tr_b16 v[60:61], v10 offset:36864
    v_mfma_f32_16x16x32_bf16 v[136:139], v[16:19], v[44:47], v[136:139]
    ds_read_b64_tr_b16 v[62:63], v10 offset:37376
    v_mfma_f32_16x16x32_bf16 v[140:143], v[20:23], v[44:47], v[140:143]
    ds_read_b64_tr_b16 v[64:65], v11 offset:36864
    v_mfma_f32_16x16x32_bf16 v[144:147], v[24:27], v[44:47], v[144:147]
    ds_read_b64_tr_b16 v[66:67], v11 offset:37376
    s_waitcnt lgkmcnt(12)
    v_mfma_f32_16x16x32_bf16 v[148:151], v[12:15], v[48:51], v[148:151]
    v_mfma_f32_16x16x32_bf16 v[152:155], v[16:19], v[48:51], v[152:155]
    v_mfma_f32_16x16x32_bf16 v[156:159], v[20:23], v[48:51], v[156:159]
    v_mfma_f32_16x16x32_bf16 v[160:163], v[24:27], v[48:51], v[160:163]
    s_waitcnt lgkmcnt(9)
    v_mfma_f32_16x16x32_bf16 v[100:103], v[28:31], v[52:55], v[100:103]
    s_waitcnt lgkmcnt(8)
    v_mfma_f32_16x16x32_bf16 v[104:107], v[32:35], v[52:55], v[104:107]
    s_waitcnt lgkmcnt(0)
    s_barrier
    v_mfma_f32_16x16x32_bf16 v[108:111], v[36:39], v[52:55], v[108:111]
    ds_read_b128 v[12:15], v4 offset:0
    v_mfma_f32_16x16x32_bf16 v[112:115], v[40:43], v[52:55], v[112:115]
    ds_read_b64_tr_b16 v[44:45], v8 offset:8192
    v_mfma_f32_16x16x32_bf16 v[116:119], v[28:31], v[56:59], v[116:119]
    ds_read_b64_tr_b16 v[46:47], v8 offset:8704
    v_mfma_f32_16x16x32_bf16 v[120:123], v[32:35], v[56:59], v[120:123]
    ds_read_b128 v[16:19], v4 offset:2048
    v_mfma_f32_16x16x32_bf16 v[124:127], v[36:39], v[56:59], v[124:127]
    ds_read_b128 v[20:23], v4 offset:4096
    v_mfma_f32_16x16x32_bf16 v[128:131], v[40:43], v[56:59], v[128:131]
    ds_read_b128 v[24:27], v4 offset:6144
    v_mfma_f32_16x16x32_bf16 v[132:135], v[28:31], v[60:63], v[132:135]
    ds_read_b64_tr_b16 v[48:49], v9 offset:8192
    v_mfma_f32_16x16x32_bf16 v[136:139], v[32:35], v[60:63], v[136:139]
    ds_read_b64_tr_b16 v[50:51], v9 offset:8704
    v_mfma_f32_16x16x32_bf16 v[140:143], v[36:39], v[60:63], v[140:143]
    ds_read_b64_tr_b16 v[52:53], v8 offset:16384
    v_mfma_f32_16x16x32_bf16 v[144:147], v[40:43], v[60:63], v[144:147]
    ds_read_b64_tr_b16 v[54:55], v8 offset:16896
    v_mfma_f32_16x16x32_bf16 v[148:151], v[28:31], v[64:67], v[148:151]
    ds_read_b64_tr_b16 v[56:57], v9 offset:16384
    v_mfma_f32_16x16x32_bf16 v[152:155], v[32:35], v[64:67], v[152:155]
    ds_read_b64_tr_b16 v[58:59], v9 offset:16896
    v_mfma_f32_16x16x32_bf16 v[156:159], v[36:39], v[64:67], v[156:159]
    v_mfma_f32_16x16x32_bf16 v[160:163], v[40:43], v[64:67], v[160:163]
    s_waitcnt lgkmcnt(9)
    v_mfma_f32_16x16x32_bf16 v[100:103], v[12:15], v[44:47], v[100:103]
    ds_read_b128 v[28:31], v5 offset:0
    s_waitcnt lgkmcnt(9)
    v_mfma_f32_16x16x32_bf16 v[104:107], v[16:19], v[44:47], v[104:107]
    ds_read_b64_tr_b16 v[60:61], v8 offset:12288
    s_waitcnt lgkmcnt(9)
    v_mfma_f32_16x16x32_bf16 v[108:111], v[20:23], v[44:47], v[108:111]
    ds_read_b64_tr_b16 v[62:63], v8 offset:12800
    s_waitcnt lgkmcnt(9)
    v_mfma_f32_16x16x32_bf16 v[112:115], v[24:27], v[44:47], v[112:115]
    ds_read_b128 v[32:35], v5 offset:2048
    s_waitcnt lgkmcnt(8)
    v_mfma_f32_16x16x32_bf16 v[116:119], v[12:15], v[48:51], v[116:119]
    ds_read_b128 v[36:39], v5 offset:4096
    v_mfma_f32_16x16x32_bf16 v[120:123], v[16:19], v[48:51], v[120:123]
    ds_read_b128 v[40:43], v5 offset:6144
    v_mfma_f32_16x16x32_bf16 v[124:127], v[20:23], v[48:51], v[124:127]
    ds_read_b64_tr_b16 v[64:65], v9 offset:12288
    v_mfma_f32_16x16x32_bf16 v[128:131], v[24:27], v[48:51], v[128:131]
    ds_read_b64_tr_b16 v[66:67], v9 offset:12800
    s_waitcnt lgkmcnt(10)
    v_mfma_f32_16x16x32_bf16 v[132:135], v[12:15], v[52:55], v[132:135]
    ds_read_b64_tr_b16 v[44:45], v8 offset:20480
    v_mfma_f32_16x16x32_bf16 v[136:139], v[16:19], v[52:55], v[136:139]
    ds_read_b64_tr_b16 v[46:47], v8 offset:20992
    v_mfma_f32_16x16x32_bf16 v[140:143], v[20:23], v[52:55], v[140:143]
    ds_read_b64_tr_b16 v[48:49], v9 offset:20480
    v_mfma_f32_16x16x32_bf16 v[144:147], v[24:27], v[52:55], v[144:147]
    ds_read_b64_tr_b16 v[50:51], v9 offset:20992
    s_waitcnt lgkmcnt(12)
    v_mfma_f32_16x16x32_bf16 v[148:151], v[12:15], v[56:59], v[148:151]
    v_mfma_f32_16x16x32_bf16 v[152:155], v[16:19], v[56:59], v[152:155]
    v_mfma_f32_16x16x32_bf16 v[156:159], v[20:23], v[56:59], v[156:159]
    v_mfma_f32_16x16x32_bf16 v[160:163], v[24:27], v[56:59], v[160:163]
    s_waitcnt lgkmcnt(9)
    v_mfma_f32_16x16x32_bf16 v[100:103], v[28:31], v[60:63], v[100:103]
    s_waitcnt lgkmcnt(8)
    v_mfma_f32_16x16x32_bf16 v[104:107], v[32:35], v[60:63], v[104:107]
    s_waitcnt lgkmcnt(0)
    s_barrier
    v_mfma_f32_16x16x32_bf16 v[108:111], v[36:39], v[60:63], v[108:111]
    ds_read_b128 v[12:15], v4 offset:16384
    v_mfma_f32_16x16x32_bf16 v[112:115], v[40:43], v[60:63], v[112:115]
    ds_read_b64_tr_b16 v[52:53], v8 offset:24576
    v_mfma_f32_16x16x32_bf16 v[116:119], v[28:31], v[64:67], v[116:119]
    ds_read_b64_tr_b16 v[54:55], v8 offset:25088
    v_mfma_f32_16x16x32_bf16 v[120:123], v[32:35], v[64:67], v[120:123]
    ds_read_b128 v[16:19], v4 offset:18432
    v_mfma_f32_16x16x32_bf16 v[124:127], v[36:39], v[64:67], v[124:127]
    ds_read_b128 v[20:23], v4 offset:20480
    v_mfma_f32_16x16x32_bf16 v[128:131], v[40:43], v[64:67], v[128:131]
    ds_read_b128 v[24:27], v4 offset:22528
    v_mfma_f32_16x16x32_bf16 v[132:135], v[28:31], v[44:47], v[132:135]
    ds_read_b64_tr_b16 v[56:57], v9 offset:24576
    v_mfma_f32_16x16x32_bf16 v[136:139], v[32:35], v[44:47], v[136:139]
    ds_read_b64_tr_b16 v[58:59], v9 offset:25088
    v_mfma_f32_16x16x32_bf16 v[140:143], v[36:39], v[44:47], v[140:143]
    ds_read_b64_tr_b16 v[60:61], v10 offset:0
    v_mfma_f32_16x16x32_bf16 v[144:147], v[40:43], v[44:47], v[144:147]
    ds_read_b64_tr_b16 v[62:63], v10 offset:512
    v_mfma_f32_16x16x32_bf16 v[148:151], v[28:31], v[48:51], v[148:151]
    ds_read_b64_tr_b16 v[64:65], v11 offset:0
    v_mfma_f32_16x16x32_bf16 v[152:155], v[32:35], v[48:51], v[152:155]
    ds_read_b64_tr_b16 v[66:67], v11 offset:512
    v_mfma_f32_16x16x32_bf16 v[156:159], v[36:39], v[48:51], v[156:159]
    v_mfma_f32_16x16x32_bf16 v[160:163], v[40:43], v[48:51], v[160:163]
    s_waitcnt lgkmcnt(9)
    v_mfma_f32_16x16x32_bf16 v[100:103], v[12:15], v[52:55], v[100:103]
    ds_read_b128 v[28:31], v5 offset:16384
    s_waitcnt lgkmcnt(9)
    v_mfma_f32_16x16x32_bf16 v[104:107], v[16:19], v[52:55], v[104:107]
    ds_read_b64_tr_b16 v[44:45], v8 offset:28672
    s_waitcnt lgkmcnt(9)
    v_mfma_f32_16x16x32_bf16 v[108:111], v[20:23], v[52:55], v[108:111]
    ds_read_b64_tr_b16 v[46:47], v8 offset:29184
    s_waitcnt lgkmcnt(9)
    v_mfma_f32_16x16x32_bf16 v[112:115], v[24:27], v[52:55], v[112:115]
    ds_read_b128 v[32:35], v5 offset:18432
    s_waitcnt lgkmcnt(8)
    v_mfma_f32_16x16x32_bf16 v[116:119], v[12:15], v[56:59], v[116:119]
    ds_read_b128 v[36:39], v5 offset:20480
    v_mfma_f32_16x16x32_bf16 v[120:123], v[16:19], v[56:59], v[120:123]
    ds_read_b128 v[40:43], v5 offset:22528
    v_mfma_f32_16x16x32_bf16 v[124:127], v[20:23], v[56:59], v[124:127]
    ds_read_b64_tr_b16 v[48:49], v9 offset:28672
    v_mfma_f32_16x16x32_bf16 v[128:131], v[24:27], v[56:59], v[128:131]
    ds_read_b64_tr_b16 v[50:51], v9 offset:29184
    s_waitcnt lgkmcnt(10)
    v_mfma_f32_16x16x32_bf16 v[132:135], v[12:15], v[60:63], v[132:135]
    ds_read_b64_tr_b16 v[52:53], v10 offset:4096
    v_mfma_f32_16x16x32_bf16 v[136:139], v[16:19], v[60:63], v[136:139]
    ds_read_b64_tr_b16 v[54:55], v10 offset:4608
    v_mfma_f32_16x16x32_bf16 v[140:143], v[20:23], v[60:63], v[140:143]
    ds_read_b64_tr_b16 v[56:57], v11 offset:4096
    v_mfma_f32_16x16x32_bf16 v[144:147], v[24:27], v[60:63], v[144:147]
    ds_read_b64_tr_b16 v[58:59], v11 offset:4608
    s_waitcnt lgkmcnt(12)
    v_mfma_f32_16x16x32_bf16 v[148:151], v[12:15], v[64:67], v[148:151]
    v_mfma_f32_16x16x32_bf16 v[152:155], v[16:19], v[64:67], v[152:155]
    v_mfma_f32_16x16x32_bf16 v[156:159], v[20:23], v[64:67], v[156:159]
    v_mfma_f32_16x16x32_bf16 v[160:163], v[24:27], v[64:67], v[160:163]
    s_waitcnt lgkmcnt(9)
    v_mfma_f32_16x16x32_bf16 v[100:103], v[28:31], v[44:47], v[100:103]
    s_waitcnt lgkmcnt(8)
    v_mfma_f32_16x16x32_bf16 v[104:107], v[32:35], v[44:47], v[104:107]
    s_waitcnt lgkmcnt(0)
    s_barrier
    v_mfma_f32_16x16x32_bf16 v[108:111], v[36:39], v[44:47], v[108:111]
    ds_read_b128 v[12:15], v4 offset:32768
    v_mfma_f32_16x16x32_bf16 v[112:115], v[40:43], v[44:47], v[112:115]
    ds_read_b64_tr_b16 v[60:61], v10 offset:8192
    v_mfma_f32_16x16x32_bf16 v[116:119], v[28:31], v[48:51], v[116:119]
    ds_read_b64_tr_b16 v[62:63], v10 offset:8704
    v_mfma_f32_16x16x32_bf16 v[120:123], v[32:35], v[48:51], v[120:123]
    ds_read_b128 v[16:19], v4 offset:34816
    v_mfma_f32_16x16x32_bf16 v[124:127], v[36:39], v[48:51], v[124:127]
    ds_read_b128 v[20:23], v4 offset:36864
    v_mfma_f32_16x16x32_bf16 v[128:131], v[40:43], v[48:51], v[128:131]
    ds_read_b128 v[24:27], v4 offset:38912
    v_mfma_f32_16x16x32_bf16 v[132:135], v[28:31], v[52:55], v[132:135]
    ds_read_b64_tr_b16 v[64:65], v11 offset:8192
    v_mfma_f32_16x16x32_bf16 v[136:139], v[32:35], v[52:55], v[136:139]
    ds_read_b64_tr_b16 v[66:67], v11 offset:8704
    v_mfma_f32_16x16x32_bf16 v[140:143], v[36:39], v[52:55], v[140:143]
    ds_read_b64_tr_b16 v[44:45], v10 offset:16384
    v_mfma_f32_16x16x32_bf16 v[144:147], v[40:43], v[52:55], v[144:147]
    ds_read_b64_tr_b16 v[46:47], v10 offset:16896
    v_mfma_f32_16x16x32_bf16 v[148:151], v[28:31], v[56:59], v[148:151]
    ds_read_b64_tr_b16 v[48:49], v11 offset:16384
    v_mfma_f32_16x16x32_bf16 v[152:155], v[32:35], v[56:59], v[152:155]
    ds_read_b64_tr_b16 v[50:51], v11 offset:16896
    v_mfma_f32_16x16x32_bf16 v[156:159], v[36:39], v[56:59], v[156:159]
    v_mfma_f32_16x16x32_bf16 v[160:163], v[40:43], v[56:59], v[160:163]
    s_waitcnt lgkmcnt(9)
    v_mfma_f32_16x16x32_bf16 v[100:103], v[12:15], v[60:63], v[100:103]
    ds_read_b128 v[28:31], v5 offset:32768
    s_waitcnt lgkmcnt(9)
    v_mfma_f32_16x16x32_bf16 v[104:107], v[16:19], v[60:63], v[104:107]
    ds_read_b64_tr_b16 v[52:53], v10 offset:12288
    s_waitcnt lgkmcnt(9)
    v_mfma_f32_16x16x32_bf16 v[108:111], v[20:23], v[60:63], v[108:111]
    ds_read_b64_tr_b16 v[54:55], v10 offset:12800
    s_waitcnt lgkmcnt(9)
    v_mfma_f32_16x16x32_bf16 v[112:115], v[24:27], v[60:63], v[112:115]
    ds_read_b128 v[32:35], v5 offset:34816
    s_waitcnt lgkmcnt(8)
    v_mfma_f32_16x16x32_bf16 v[116:119], v[12:15], v[64:67], v[116:119]
    ds_read_b128 v[36:39], v5 offset:36864
    v_mfma_f32_16x16x32_bf16 v[120:123], v[16:19], v[64:67], v[120:123]
    ds_read_b128 v[40:43], v5 offset:38912
    v_mfma_f32_16x16x32_bf16 v[124:127], v[20:23], v[64:67], v[124:127]
    ds_read_b64_tr_b16 v[56:57], v11 offset:12288
    v_mfma_f32_16x16x32_bf16 v[128:131], v[24:27], v[64:67], v[128:131]
    ds_read_b64_tr_b16 v[58:59], v11 offset:12800
    s_waitcnt lgkmcnt(10)
    v_mfma_f32_16x16x32_bf16 v[132:135], v[12:15], v[44:47], v[132:135]
    ds_read_b64_tr_b16 v[60:61], v10 offset:20480
    v_mfma_f32_16x16x32_bf16 v[136:139], v[16:19], v[44:47], v[136:139]
    ds_read_b64_tr_b16 v[62:63], v10 offset:20992
    v_mfma_f32_16x16x32_bf16 v[140:143], v[20:23], v[44:47], v[140:143]
    ds_read_b64_tr_b16 v[64:65], v11 offset:20480
    v_mfma_f32_16x16x32_bf16 v[144:147], v[24:27], v[44:47], v[144:147]
    ds_read_b64_tr_b16 v[66:67], v11 offset:20992
    s_waitcnt lgkmcnt(12)
    v_mfma_f32_16x16x32_bf16 v[148:151], v[12:15], v[48:51], v[148:151]
    v_mfma_f32_16x16x32_bf16 v[152:155], v[16:19], v[48:51], v[152:155]
    v_mfma_f32_16x16x32_bf16 v[156:159], v[20:23], v[48:51], v[156:159]
    v_mfma_f32_16x16x32_bf16 v[160:163], v[24:27], v[48:51], v[160:163]
    s_waitcnt lgkmcnt(9)
    v_mfma_f32_16x16x32_bf16 v[100:103], v[28:31], v[52:55], v[100:103]
    s_waitcnt lgkmcnt(8)
    v_mfma_f32_16x16x32_bf16 v[104:107], v[32:35], v[52:55], v[104:107]
    s_waitcnt lgkmcnt(0)
    s_barrier
    v_mfma_f32_16x16x32_bf16 v[108:111], v[36:39], v[52:55], v[108:111]
    ds_read_b128 v[12:15], v4 offset:49152
    v_mfma_f32_16x16x32_bf16 v[112:115], v[40:43], v[52:55], v[112:115]
    ds_read_b64_tr_b16 v[44:45], v8 offset:0
    v_mfma_f32_16x16x32_bf16 v[116:119], v[28:31], v[56:59], v[116:119]
    ds_read_b64_tr_b16 v[46:47], v8 offset:512
    v_mfma_f32_16x16x32_bf16 v[120:123], v[32:35], v[56:59], v[120:123]
    ds_read_b128 v[16:19], v4 offset:51200
    v_mfma_f32_16x16x32_bf16 v[124:127], v[36:39], v[56:59], v[124:127]
    ds_read_b128 v[20:23], v4 offset:53248
    v_mfma_f32_16x16x32_bf16 v[128:131], v[40:43], v[56:59], v[128:131]
    ds_read_b128 v[24:27], v4 offset:55296
    v_mfma_f32_16x16x32_bf16 v[132:135], v[28:31], v[60:63], v[132:135]
    ds_read_b64_tr_b16 v[48:49], v9 offset:0
    v_mfma_f32_16x16x32_bf16 v[136:139], v[32:35], v[60:63], v[136:139]
    ds_read_b64_tr_b16 v[50:51], v9 offset:512
    v_mfma_f32_16x16x32_bf16 v[140:143], v[36:39], v[60:63], v[140:143]
    ds_read_b64_tr_b16 v[52:53], v10 offset:24576
    v_mfma_f32_16x16x32_bf16 v[144:147], v[40:43], v[60:63], v[144:147]
    ds_read_b64_tr_b16 v[54:55], v10 offset:25088
    v_mfma_f32_16x16x32_bf16 v[148:151], v[28:31], v[64:67], v[148:151]
    ds_read_b64_tr_b16 v[56:57], v11 offset:24576
    v_mfma_f32_16x16x32_bf16 v[152:155], v[32:35], v[64:67], v[152:155]
    ds_read_b64_tr_b16 v[58:59], v11 offset:25088
    v_mfma_f32_16x16x32_bf16 v[156:159], v[36:39], v[64:67], v[156:159]
    v_mfma_f32_16x16x32_bf16 v[160:163], v[40:43], v[64:67], v[160:163]
    ds_read_b32 v68, v1 offset:48
    s_waitcnt lgkmcnt(10)
    v_mfma_f32_16x16x32_bf16 v[100:103], v[12:15], v[44:47], v[100:103]
    ds_read_b128 v[28:31], v5 offset:49152
    s_waitcnt lgkmcnt(10)
    v_mfma_f32_16x16x32_bf16 v[104:107], v[16:19], v[44:47], v[104:107]
    ds_read_b64_tr_b16 v[60:61], v8 offset:4096
    s_waitcnt lgkmcnt(10)
    v_mfma_f32_16x16x32_bf16 v[108:111], v[20:23], v[44:47], v[108:111]
    ds_read_b64_tr_b16 v[62:63], v8 offset:4608
    s_waitcnt lgkmcnt(10)
    v_mfma_f32_16x16x32_bf16 v[112:115], v[24:27], v[44:47], v[112:115]
    ds_read_b128 v[32:35], v5 offset:51200
    s_waitcnt lgkmcnt(9)
    v_mfma_f32_16x16x32_bf16 v[116:119], v[12:15], v[48:51], v[116:119]
    ds_read_b128 v[36:39], v5 offset:53248
    v_mfma_f32_16x16x32_bf16 v[120:123], v[16:19], v[48:51], v[120:123]
    ds_read_b128 v[40:43], v5 offset:55296
    v_mfma_f32_16x16x32_bf16 v[124:127], v[20:23], v[48:51], v[124:127]
    ds_read_b64_tr_b16 v[64:65], v9 offset:4096
    v_mfma_f32_16x16x32_bf16 v[128:131], v[24:27], v[48:51], v[128:131]
    ds_read_b64_tr_b16 v[66:67], v9 offset:4608
    s_waitcnt lgkmcnt(11)
    v_mfma_f32_16x16x32_bf16 v[132:135], v[12:15], v[52:55], v[132:135]
    ds_read_b64_tr_b16 v[44:45], v10 offset:28672
    v_mfma_f32_16x16x32_bf16 v[136:139], v[16:19], v[52:55], v[136:139]
    ds_read_b64_tr_b16 v[46:47], v10 offset:29184
    v_mfma_f32_16x16x32_bf16 v[140:143], v[20:23], v[52:55], v[140:143]
    ds_read_b64_tr_b16 v[48:49], v11 offset:28672
    v_mfma_f32_16x16x32_bf16 v[144:147], v[24:27], v[52:55], v[144:147]
    ds_read_b64_tr_b16 v[50:51], v11 offset:29184
    s_waitcnt lgkmcnt(13)
    v_mfma_f32_16x16x32_bf16 v[148:151], v[12:15], v[56:59], v[148:151]
    v_mfma_f32_16x16x32_bf16 v[152:155], v[16:19], v[56:59], v[152:155]
    v_mfma_f32_16x16x32_bf16 v[156:159], v[20:23], v[56:59], v[156:159]
    v_mfma_f32_16x16x32_bf16 v[160:163], v[24:27], v[56:59], v[160:163]
    s_waitcnt lgkmcnt(9)
    v_mfma_f32_16x16x32_bf16 v[100:103], v[28:31], v[60:63], v[100:103]
    v_lshlrev_b32 v18, 4, v0
    v_add_u32 v12, s52, v18
    s_waitcnt lgkmcnt(8)
    v_mfma_f32_16x16x32_bf16 v[104:107], v[32:35], v[60:63], v[104:107]
    v_xor_b32 v13, 4096, v12
    v_and_b32 v14, 0x30, v0
    s_waitcnt lgkmcnt(0)
    s_barrier
    v_cmp_gt_u32 vcc, 1, v68
    s_nop 0
    s_and_b32 vcc_lo, vcc_lo, 3
    s_cbranch_scc0 SCK_13
    v_and_b32 v69, 1, v0
    v_lshlrev_b32 v69, 2, v69
    v_add_u32 v69, 159088, v69
    ds_read_b32 v68, v69 offset:0
FW_14:
    s_waitcnt lgkmcnt(0)
    v_cmp_gt_u32 vcc, 1, v68
    s_cbranch_vccz FO_15
    ds_read_b32 v68, v69 offset:0
    s_branch FW_14
FO_15:
SCK_13:
    v_mfma_f32_16x16x32_bf16 v[108:111], v[36:39], v[60:63], v[108:111]
    ds_read_b128 v[68:71], v164 offset:0
    v_add_u32 v14, s53, v14
    v_mfma_f32_16x16x32_bf16 v[112:115], v[40:43], v[60:63], v[112:115]
    ds_read2_b32 v[52:53], v165 offset0:64 offset1:64
    v_xor_b32 v15, 64, v14
    v_mfma_f32_16x16x32_bf16 v[116:119], v[28:31], v[64:67], v[116:119]
    ds_read2_b32 v[54:55], v2 offset0:64 offset1:64
    v_lshlrev_b32 v19, 2, v0
    v_mfma_f32_16x16x32_bf16 v[120:123], v[32:35], v[64:67], v[120:123]
    ds_read2_b32 v[56:57], v165 offset0:128 offset1:128
    v_add_u32 v16, s53, v19
    v_mfma_f32_16x16x32_bf16 v[124:127], v[36:39], v[64:67], v[124:127]
    ds_read2_b32 v[58:59], v2 offset0:128 offset1:128
    v_xor_b32 v17, 256, v16
    v_mfma_f32_16x16x32_bf16 v[128:131], v[40:43], v[64:67], v[128:131]
    ds_read_b128 v[72:75], v164 offset:1024
    v_xor_b32 v18, 8, v3
    v_mfma_f32_16x16x32_bf16 v[132:135], v[28:31], v[44:47], v[132:135]
    ds_read_b128 v[76:79], v164 offset:64
    v_writelane_b32 v18, s50, 1
    v_mfma_f32_16x16x32_bf16 v[136:139], v[32:35], v[44:47], v[136:139]
    ds_read_b128 v[80:83], v164 offset:1088
    v_mov_b32 v20, 0x3f803f80
    v_mfma_f32_16x16x32_bf16 v[140:143], v[36:39], v[44:47], v[140:143]
    ds_read_b128 v[84:87], v164 offset:128
    v_mov_b32 v21, 0x3f803f80
    v_mfma_f32_16x16x32_bf16 v[144:147], v[40:43], v[44:47], v[144:147]
    ds_read_b128 v[88:91], v164 offset:1152
    v_mov_b32 v22, 0x3f803f80
    v_mfma_f32_16x16x32_bf16 v[148:151], v[28:31], v[48:51], v[148:151]
    ds_read_b128 v[92:95], v164 offset:192
    v_mov_b32 v23, 0x3f803f80
    v_mfma_f32_16x16x32_bf16 v[152:155], v[32:35], v[48:51], v[152:155]
    ds_read_b128 v[96:99], v164 offset:1216
    v_mov_b32 v24, 1
    v_and_b32 v4, 15, v0
    v_mfma_f32_16x16x32_bf16 v[156:159], v[36:39], v[48:51], v[156:159]
    v_bfe_u32 v5, v0, 4, 1
    v_lshlrev_b32 v5, 5, v5
    v_mfma_f32_16x16x32_bf16 v[160:163], v[40:43], v[48:51], v[160:163]
    v_lshrrev_b32 v6, 5, v0
    v_lshl_add_u32 v5, v6, 4, v5
    v_lshl_add_u32 v7, v4, 11, v5
    v_lshlrev_b32 v6, 4, v0
    v_and_b32 v8, 0x300, v6
    v_lshl_add_u32 v8, v4, 2, v8
    s_waitcnt lgkmcnt(10)
    v_pk_fma_f32 v[100:101], v[68:69], v[52:53], v[100:101]
    v_pk_fma_f32 v[102:103], v[70:71], v[52:53], v[102:103]
    s_waitcnt lgkmcnt(9)
    v_pk_fma_f32 v[116:117], v[68:69], v[54:55], v[116:117]
    v_pk_fma_f32 v[118:119], v[70:71], v[54:55], v[118:119]
    s_waitcnt lgkmcnt(8)
    v_pk_fma_f32 v[132:133], v[68:69], v[56:57], v[132:133]
    v_pk_fma_f32 v[134:135], v[70:71], v[56:57], v[134:135]
    s_waitcnt lgkmcnt(7)
    v_pk_fma_f32 v[148:149], v[68:69], v[58:59], v[148:149]
    v_pk_fma_f32 v[150:151], v[70:71], v[58:59], v[150:151]
    s_waitcnt lgkmcnt(6)
    v_pk_mul_f32 v[100:101], v[100:101], v[72:73]
    v_pk_mul_f32 v[102:103], v[102:103], v[74:75]
    v_pk_mul_f32 v[116:117], v[116:117], v[72:73]
    v_pk_mul_f32 v[118:119], v[118:119], v[74:75]
    v_pk_mul_f32 v[132:133], v[132:133], v[72:73]
    v_pk_mul_f32 v[134:135], v[134:135], v[74:75]
    v_pk_mul_f32 v[148:149], v[148:149], v[72:73]
    v_pk_mul_f32 v[150:151], v[150:151], v[74:75]
    v_exp_f32 v28, v100 clamp
    v_exp_f32 v29, v101 clamp
    v_exp_f32 v30, v102 clamp
    v_exp_f32 v31, v103 clamp
    v_exp_f32 v32, v116 clamp
    v_exp_f32 v33, v117 clamp
    v_exp_f32 v34, v118 clamp
    v_exp_f32 v35, v119 clamp
    v_cvt_pk_bf16_f32 v132, v132, v133
    v_cvt_pk_bf16_f32 v133, v134, v135
    v_cvt_pk_bf16_f32 v148, v148, v149
    v_cvt_pk_bf16_f32 v149, v150, v151
    v_pk_mul_f32 v[100:101], v[100:101], s[40:41] clamp
    v_pk_mul_f32 v[102:103], v[102:103], s[40:41] clamp
    v_pk_mul_f32 v[116:117], v[116:117], s[40:41] clamp
    v_pk_mul_f32 v[118:119], v[118:119], s[40:41] clamp
    v_pk_add_f32 v[28:29], v[28:29], s[74:75]
    v_pk_add_f32 v[30:31], v[30:31], s[74:75]
    v_pk_add_f32 v[32:33], v[32:33], s[74:75]
    v_pk_add_f32 v[34:35], v[34:35], s[74:75]
    v_pk_fma_f32 v[100:101], v[100:101], s[76:77], v[28:29]
    v_pk_fma_f32 v[102:103], v[102:103], s[76:77], v[30:31]
    v_pk_fma_f32 v[116:117], v[116:117], s[76:77], v[32:33]
    v_pk_fma_f32 v[118:119], v[118:119], s[76:77], v[34:35]
    v_cvt_pk_bf16_f32 v100, v100, v101
    v_cvt_pk_bf16_f32 v101, v102, v103
    v_cvt_pk_bf16_f32 v116, v116, v117
    v_cvt_pk_bf16_f32 v117, v118, v119
    s_waitcnt lgkmcnt(5)
    v_pk_fma_f32 v[104:105], v[76:77], v[52:53], v[104:105]
    v_pk_fma_f32 v[106:107], v[78:79], v[52:53], v[106:107]
    v_pk_fma_f32 v[120:121], v[76:77], v[54:55], v[120:121]
    v_pk_fma_f32 v[122:123], v[78:79], v[54:55], v[122:123]
    v_pk_fma_f32 v[136:137], v[76:77], v[56:57], v[136:137]
    v_pk_fma_f32 v[138:139], v[78:79], v[56:57], v[138:139]
    v_pk_fma_f32 v[152:153], v[76:77], v[58:59], v[152:153]
    v_pk_fma_f32 v[154:155], v[78:79], v[58:59], v[154:155]
    s_waitcnt lgkmcnt(4)
    v_pk_mul_f32 v[104:105], v[104:105], v[80:81]
    v_pk_mul_f32 v[106:107], v[106:107], v[82:83]
    v_pk_mul_f32 v[120:121], v[120:121], v[80:81]
    v_pk_mul_f32 v[122:123], v[122:123], v[82:83]
    v_pk_mul_f32 v[136:137], v[136:137], v[80:81]
    v_pk_mul_f32 v[138:139], v[138:139], v[82:83]
    v_pk_mul_f32 v[152:153], v[152:153], v[80:81]
    v_pk_mul_f32 v[154:155], v[154:155], v[82:83]
    v_exp_f32 v36, v104 clamp
    v_exp_f32 v37, v105 clamp
    v_exp_f32 v38, v106 clamp
    v_exp_f32 v39, v107 clamp
    v_exp_f32 v40, v120 clamp
    v_exp_f32 v41, v121 clamp
    v_exp_f32 v42, v122 clamp
    v_exp_f32 v43, v123 clamp
    v_cvt_pk_bf16_f32 v134, v136, v137
    v_cvt_pk_bf16_f32 v135, v138, v139
    v_cvt_pk_bf16_f32 v150, v152, v153
    v_cvt_pk_bf16_f32 v151, v154, v155
    v_pk_mul_f32 v[104:105], v[104:105], s[40:41] clamp
    v_pk_mul_f32 v[106:107], v[106:107], s[40:41] clamp
    v_pk_mul_f32 v[120:121], v[120:121], s[40:41] clamp
    v_pk_mul_f32 v[122:123], v[122:123], s[40:41] clamp
    v_pk_add_f32 v[36:37], v[36:37], s[74:75]
    v_pk_add_f32 v[38:39], v[38:39], s[74:75]
    v_pk_add_f32 v[40:41], v[40:41], s[74:75]
    v_pk_add_f32 v[42:43], v[42:43], s[74:75]
    v_pk_fma_f32 v[104:105], v[104:105], s[76:77], v[36:37]
    v_pk_fma_f32 v[106:107], v[106:107], s[76:77], v[38:39]
    v_pk_fma_f32 v[120:121], v[120:121], s[76:77], v[40:41]
    v_pk_fma_f32 v[122:123], v[122:123], s[76:77], v[42:43]
    v_cvt_pk_bf16_f32 v102, v104, v105
    v_cvt_pk_bf16_f32 v103, v106, v107
    v_cvt_pk_bf16_f32 v118, v120, v121
    v_cvt_pk_bf16_f32 v119, v122, v123
    s_waitcnt lgkmcnt(3)
    v_pk_fma_f32 v[108:109], v[84:85], v[52:53], v[108:109]
    v_pk_fma_f32 v[110:111], v[86:87], v[52:53], v[110:111]
    v_pk_fma_f32 v[124:125], v[84:85], v[54:55], v[124:125]
    v_pk_fma_f32 v[126:127], v[86:87], v[54:55], v[126:127]
    v_pk_fma_f32 v[140:141], v[84:85], v[56:57], v[140:141]
    v_pk_fma_f32 v[142:143], v[86:87], v[56:57], v[142:143]
    v_pk_fma_f32 v[156:157], v[84:85], v[58:59], v[156:157]
    v_pk_fma_f32 v[158:159], v[86:87], v[58:59], v[158:159]
    s_waitcnt lgkmcnt(2)
    v_pk_mul_f32 v[108:109], v[108:109], v[88:89]
    v_pk_mul_f32 v[110:111], v[110:111], v[90:91]
    v_pk_mul_f32 v[124:125], v[124:125], v[88:89]
    v_pk_mul_f32 v[126:127], v[126:127], v[90:91]
    v_pk_mul_f32 v[140:141], v[140:141], v[88:89]
    v_pk_mul_f32 v[142:143], v[142:143], v[90:91]
    v_pk_mul_f32 v[156:157], v[156:157], v[88:89]
    v_pk_mul_f32 v[158:159], v[158:159], v[90:91]
    v_mfma_f32_16x16x32_bf16 v[60:63], v[148:151], v[100:103], 0
    v_exp_f32 v28, v108 clamp
    v_exp_f32 v29, v109 clamp
    v_mfma_f32_16x16x32_bf16 v[64:67], v[148:151], v[116:119], 0
    v_exp_f32 v30, v110 clamp
    v_exp_f32 v31, v111 clamp
    v_mfma_f32_16x16x32_bf16 v[68:71], v[100:103], v[20:23], 0
    v_exp_f32 v32, v124 clamp
    v_exp_f32 v33, v125 clamp
    v_exp_f32 v34, v126 clamp
    v_exp_f32 v35, v127 clamp
    v_cvt_pk_bf16_f32 v136, v140, v141
    v_cvt_pk_bf16_f32 v137, v142, v143
    v_cvt_pk_bf16_f32 v152, v156, v157
    v_cvt_pk_bf16_f32 v153, v158, v159
    v_pk_mul_f32 v[108:109], v[108:109], s[40:41] clamp
    v_pk_mul_f32 v[110:111], v[110:111], s[40:41] clamp
    v_pk_mul_f32 v[124:125], v[124:125], s[40:41] clamp
    v_pk_mul_f32 v[126:127], v[126:127], s[40:41] clamp
    v_pk_add_f32 v[28:29], v[28:29], s[74:75]
    v_pk_add_f32 v[30:31], v[30:31], s[74:75]
    v_pk_add_f32 v[32:33], v[32:33], s[74:75]
    v_pk_add_f32 v[34:35], v[34:35], s[74:75]
    v_pk_fma_f32 v[108:109], v[108:109], s[76:77], v[28:29]
    v_pk_fma_f32 v[110:111], v[110:111], s[76:77], v[30:31]
    v_pk_fma_f32 v[124:125], v[124:125], s[76:77], v[32:33]
    v_pk_fma_f32 v[126:127], v[126:127], s[76:77], v[34:35]
    v_cvt_pk_bf16_f32 v104, v108, v109
    v_cvt_pk_bf16_f32 v105, v110, v111
    v_cvt_pk_bf16_f32 v120, v124, v125
    v_cvt_pk_bf16_f32 v121, v126, v127
    s_waitcnt lgkmcnt(1)
    v_pk_fma_f32 v[112:113], v[92:93], v[52:53], v[112:113]
    v_pk_fma_f32 v[114:115], v[94:95], v[52:53], v[114:115]
    v_pk_fma_f32 v[128:129], v[92:93], v[54:55], v[128:129]
    v_pk_fma_f32 v[130:131], v[94:95], v[54:55], v[130:131]
    v_pk_fma_f32 v[144:145], v[92:93], v[56:57], v[144:145]
    v_pk_fma_f32 v[146:147], v[94:95], v[56:57], v[146:147]
    v_pk_fma_f32 v[160:161], v[92:93], v[58:59], v[160:161]
    v_pk_fma_f32 v[162:163], v[94:95], v[58:59], v[162:163]
    s_waitcnt lgkmcnt(0)
    v_pk_mul_f32 v[112:113], v[112:113], v[96:97]
    v_pk_mul_f32 v[114:115], v[114:115], v[98:99]
    v_pk_mul_f32 v[128:129], v[128:129], v[96:97]
    v_pk_mul_f32 v[130:131], v[130:131], v[98:99]
    v_pk_mul_f32 v[144:145], v[144:145], v[96:97]
    v_pk_mul_f32 v[146:147], v[146:147], v[98:99]
    v_pk_mul_f32 v[160:161], v[160:161], v[96:97]
    v_pk_mul_f32 v[162:163], v[162:163], v[98:99]
    v_mfma_f32_16x16x32_bf16 v[72:75], v[116:119], v[20:23], 0
    v_exp_f32 v36, v112 clamp
    v_exp_f32 v37, v113 clamp
    v_mfma_f32_16x16x32_bf16 v[44:47], v[132:135], v[100:103], 0
    v_exp_f32 v38, v114 clamp
    v_exp_f32 v39, v115 clamp
    v_mfma_f32_16x16x32_bf16 v[48:51], v[132:135], v[116:119], 0
    v_exp_f32 v40, v128 clamp
    v_exp_f32 v41, v129 clamp
    v_exp_f32 v42, v130 clamp
    v_exp_f32 v43, v131 clamp
    s_branch IW_s5
IW_w5:
    s_branch IW_r5
IW_s5:
    v_cvt_pk_bf16_f32 v138, v144, v145
    v_cvt_pk_bf16_f32 v139, v146, v147
    v_cvt_pk_bf16_f32 v154, v160, v161
    v_cvt_pk_bf16_f32 v155, v162, v163
    v_pk_mul_f32 v[112:113], v[112:113], s[40:41] clamp
    v_pk_mul_f32 v[114:115], v[114:115], s[40:41] clamp
    v_pk_mul_f32 v[128:129], v[128:129], s[40:41] clamp
    v_pk_mul_f32 v[130:131], v[130:131], s[40:41] clamp
    v_pk_add_f32 v[36:37], v[36:37], s[74:75]
    v_pk_add_f32 v[38:39], v[38:39], s[74:75]
    v_pk_add_f32 v[40:41], v[40:41], s[74:75]
    v_pk_add_f32 v[42:43], v[42:43], s[74:75]
    v_pk_fma_f32 v[112:113], v[112:113], s[76:77], v[36:37]
    v_pk_fma_f32 v[114:115], v[114:115], s[76:77], v[38:39]
    v_pk_fma_f32 v[128:129], v[128:129], s[76:77], v[40:41]
    v_pk_fma_f32 v[130:131], v[130:131], s[76:77], v[42:43]
    v_cvt_pk_bf16_f32 v106, v112, v113
    v_cvt_pk_bf16_f32 v107, v114, v115
    v_cvt_pk_bf16_f32 v122, v128, v129
    v_cvt_pk_bf16_f32 v123, v130, v131
    v_mfma_f32_16x16x32_bf16 v[60:63], v[152:155], v[104:107], v[60:63]
    s_nop 0
    v_mfma_f32_16x16x32_bf16 v[64:67], v[152:155], v[120:123], v[64:67]
    v_mfma_f32_16x16x32_bf16 v[68:71], v[104:107], v[20:23], v[68:71]
    v_mfma_f32_16x16x32_bf16 v[72:75], v[120:123], v[20:23], v[72:75]
    v_mfma_f32_16x16x32_bf16 v[44:47], v[136:139], v[104:107], v[44:47]
    v_mfma_f32_16x16x32_bf16 v[48:51], v[136:139], v[120:123], v[48:51]
    buffer_load_dwordx4 v[140:143], v7, s[12:15], s42 offen offset:0
    buffer_load_dwordx4 v[144:147], v7, s[12:15], s42 offen offset:64
    buffer_load_dwordx4 v[156:159], v7, s[12:15], s43 offen offset:0
    buffer_load_dwordx4 v[160:163], v7, s[12:15], s43 offen offset:64
    ds_write_b128 v12, v[60:63] offset:0
    ds_write_b128 v12, v[64:67] offset:1024
    s_mov_b32 exec_lo, 0x10001
    s_mov_b32 exec_hi, 0x10001
    ds_write_b128 v14, v[68:71]
    ds_write_b128 v15, v[72:75]
    s_mov_b64 exec, 1
    ds_write_b32 v3, v24 offset:32
    s_mov_b64 exec, -1
F_xw:
    ds_read_b32 v25, v18 offset:32
    ds_read_b128 v[28:31], v13 offset:1024
    ds_read_b128 v[32:35], v13
    ds_read_b32 v26, v16
    ds_read_b32 v27, v17
    s_waitcnt lgkmcnt(4)
    v_cmp_eq_u32 vcc, 0, v25
    s_cbranch_vccz F_xx
    s_waitcnt lgkmcnt(0)
    s_branch F_xw
F_xx:
    s_waitcnt lgkmcnt(3)
    v_add_f32 v44, v44, v28
    v_add_f32 v45, v45, v29
    v_add_f32 v46, v46, v30
    v_add_f32 v47, v47, v31
    buffer_atomic_add_f32 v44, v8, s[24:27], s46 offen offset:0
    buffer_atomic_add_f32 v45, v8, s[24:27], s46 offen offset:64
    buffer_atomic_add_f32 v46, v8, s[24:27], s46 offen offset:128
    buffer_atomic_add_f32 v47, v8, s[24:27], s46 offen offset:192
    s_waitcnt lgkmcnt(2)
    v_add_f32 v48, v48, v32
    v_add_f32 v49, v49, v33
    v_add_f32 v50, v50, v34
    v_add_f32 v51, v51, v35
    buffer_atomic_add_f32 v48, v8, s[24:27], s47 offen offset:0
    buffer_atomic_add_f32 v49, v8, s[24:27], s47 offen offset:64
    buffer_atomic_add_f32 v50, v8, s[24:27], s47 offen offset:128
    buffer_atomic_add_f32 v51, v8, s[24:27], s47 offen offset:192
    s_waitcnt lgkmcnt(0)
    v_add_f32 v26, v26, v27
    s_mov_b64 exec, 0xffff
    buffer_atomic_add_f32 v26, v19, s[24:27], s48 offen
    s_mov_b64 exec, 1
    ds_add_u32 v3, v24 offset:32
    s_mov_b64 exec, -1
    s_setprio 2
    v_mov_b32 v2, v7
    s_lshl_b32 s47, s3, 7
    s_add_u32 s47, s47, 157184
    v_lshlrev_b32 v5, 2, v4
    v_add_u32 v5, s47, v5
    ds_read2_b32 v[76:77], v5 offset0:0 offset1:128
    ds_read2_b32 v[78:79], v5 offset0:16 offset1:144
    v_lshrrev_b32 v4, 3, v0
    v_and_b32 v5, 7, v0
    v_lshrrev_b32 v6, 1, v4
    v_lshlrev_b32 v7, 1, v6
    v_xor_b32 v7, v5, v7
    v_lshlrev_b32 v7, 4, v7
    v_lshl_add_u32 v40, v4, 11, v7
    v_and_b32 v6, 1, v6
    v_lshlrev_b32 v6, 1, v6
    v_xor_b32 v41, v5, v6
    v_xor_b32 v42, 4, v41
    v_lshlrev_b32 v41, 4, v41
    v_lshlrev_b32 v42, 4, v42
    v_mul_u32_u24 v7, 6144, v4
    v_add_u32 v41, v41, v7
    v_add_u32 v42, v42, v7
    v_add_u32 v42, 49152, v42
    s_mul_i32 s56, s3, 98304
    s_lshl_b32 s47, s10, 7
    s_add_u32 s56, s56, s47
    s_lshl_b32 s57, s29, 7
    s_lshl_b32 s47, s3, 15
    s_add_u32 s57, s57, s47
    s_and_b32 s81, s28, 3
    s_mul_i32 s81, s81, 4
    s_lshr_b32 s47, s28, 2
    s_mul_i32 s47, s47, 1
    s_add_u32 s81, s81, s47
    s_lshl_b32 s78, s3, 11
    s_lshl_b32 s44, s10, 1
    s_add_u32 s44, s44, s37
    s_lshl_b32 s45, s44, 12
    s_mov_b32 s52, s45
    s_lshl_b32 s53, s44, 7
    s_add_u32 s53, s53, 0x20000
    s_lshl_b32 s51, s44, 3
    s_and_b32 s47, s32, 3
    s_add_u32 s51, s51, s47
    s_lshl_b32 s51, s51, 7
    v_xor_b32 v18, 8, v3
    v_mov_b32 v25, 0

    s_add_u32 s54, s51, 0x82d000
    s_add_u32 s54, s72, s54
    s_addc_u32 s55, s73, 0
    s_add_u32 s82, s49, 0x82d000
    s_add_u32 s82, s72, s82
    s_addc_u32 s83, s73, 0
    s_lshl_b32 s57, s29, 7
    s_and_b32 s47, s3, 1
    s_lshl_b32 s79, s47, 12
    s_lshl_b32 s47, s47, 16
    s_add_u32 s57, s57, s47

    s_setprio 2
    s_waitcnt lgkmcnt(0)
    v_mul_f32 v76, v76, v77
    v_add_f32 v77, 1.0, v77
    v_mul_f32 v78, v78, v79
    v_add_f32 v79, 1.0, v79
    s_waitcnt vmcnt(9)
    v_lshlrev_b32 v100, 16, v140
    v_and_b32 v101, 0xffff0000, v140
    v_lshlrev_b32 v102, 16, v141
    v_and_b32 v103, 0xffff0000, v141
    v_lshlrev_b32 v104, 16, v142
    v_and_b32 v105, 0xffff0000, v142
    v_lshlrev_b32 v106, 16, v143
    v_and_b32 v107, 0xffff0000, v143
    v_fma_f32 v100, v100, v77, v76
    v_fma_f32 v101, v101, v77, v76
    v_fma_f32 v102, v102, v77, v76
    v_fma_f32 v103, v103, v77, v76
    v_fma_f32 v104, v104, v77, v76
    v_fma_f32 v105, v105, v77, v76
    v_fma_f32 v106, v106, v77, v76
    v_fma_f32 v107, v107, v77, v76
    v_lshlrev_b32 v108, 16, v144
    v_and_b32 v109, 0xffff0000, v144
    v_lshlrev_b32 v110, 16, v145
    v_and_b32 v111, 0xffff0000, v145
    v_lshlrev_b32 v112, 16, v146
    v_and_b32 v113, 0xffff0000, v146
    v_lshlrev_b32 v114, 16, v147
    v_and_b32 v115, 0xffff0000, v147
    v_fma_f32 v108, v108, v77, v76
    v_fma_f32 v109, v109, v77, v76
    v_fma_f32 v110, v110, v77, v76
    v_fma_f32 v111, v111, v77, v76
    v_fma_f32 v112, v112, v77, v76
    v_fma_f32 v113, v113, v77, v76
    v_fma_f32 v114, v114, v77, v76
    v_fma_f32 v115, v115, v77, v76
    v_lshlrev_b32 v116, 16, v156
    v_and_b32 v117, 0xffff0000, v156
    v_lshlrev_b32 v118, 16, v157
    v_and_b32 v119, 0xffff0000, v157
    v_lshlrev_b32 v120, 16, v158
    v_and_b32 v121, 0xffff0000, v158
    v_lshlrev_b32 v122, 16, v159
    v_and_b32 v123, 0xffff0000, v159
    v_fma_f32 v116, v116, v79, v78
    v_fma_f32 v117, v117, v79, v78
    v_fma_f32 v118, v118, v79, v78
    v_fma_f32 v119, v119, v79, v78
    v_fma_f32 v120, v120, v79, v78
    v_fma_f32 v121, v121, v79, v78
    v_fma_f32 v122, v122, v79, v78
    v_fma_f32 v123, v123, v79, v78
    v_lshlrev_b32 v124, 16, v160
    v_and_b32 v125, 0xffff0000, v160
    v_lshlrev_b32 v126, 16, v161
    v_and_b32 v127, 0xffff0000, v161
    v_lshlrev_b32 v128, 16, v162
    v_and_b32 v129, 0xffff0000, v162
    v_lshlrev_b32 v130, 16, v163
    v_and_b32 v131, 0xffff0000, v163
    v_fma_f32 v124, v124, v79, v78
    v_fma_f32 v125, v125, v79, v78
    v_fma_f32 v126, v126, v79, v78
    v_fma_f32 v127, v127, v79, v78
    v_fma_f32 v128, v128, v79, v78
    v_fma_f32 v129, v129, v79, v78
    v_fma_f32 v130, v130, v79, v78
    v_fma_f32 v131, v131, v79, v78
    v_permlane16_swap_b32 v100, v104
    v_permlane16_swap_b32 v101, v105
    v_permlane16_swap_b32 v102, v106
    v_permlane16_swap_b32 v103, v107
    v_permlane16_swap_b32 v108, v112
    v_permlane16_swap_b32 v109, v113
    v_permlane16_swap_b32 v110, v114
    v_permlane16_swap_b32 v111, v115
    v_permlane16_swap_b32 v116, v120
    v_permlane16_swap_b32 v117, v121
    v_permlane16_swap_b32 v118, v122
    v_permlane16_swap_b32 v119, v123
    v_permlane16_swap_b32 v124, v128
    v_permlane16_swap_b32 v125, v129
    v_permlane16_swap_b32 v126, v130
    v_permlane16_swap_b32 v127, v131
    s_setprio 2
    s_cmp_lt_u32 s3, 2
    s_cbranch_scc1 F_w0
    v_cmp_gt_u32 vcc, 1, v25
    s_cbranch_vccz CW_16
    ds_read_b32 v25, v1 offset:0
FW_17:
    s_waitcnt lgkmcnt(0)
    v_cmp_gt_u32 vcc, 1, v25
    s_cbranch_vccz FO_18
    s_sleep 2
    ds_read_b32 v25, v1 offset:0
    s_branch FW_17
FO_18:
CW_16:
    s_add_u32 s47, s81, 0
    s_and_b32 s47, s47, 15
    s_lshl_b32 s47, s47, 17
    s_add_u32 m0, s79, 147456
    s_add_u32 s47, s47, s57
    buffer_load_dwordx4 v40, s[20:23], s47 offen lds
    s_add_u32 m0, m0, 1024
    s_add_u32 s47, s47, 16384
    buffer_load_dwordx4 v40, s[20:23], s47 offen lds
    s_add_u32 m0, m0, 1024
    s_add_u32 s47, s47, 16384
    buffer_load_dwordx4 v40, s[20:23], s47 offen lds
    s_add_u32 m0, m0, 1024
    s_add_u32 s47, s47, 16384
    buffer_load_dwordx4 v40, s[20:23], s47 offen lds
    v_cmp_gt_u32 vcc, 2, v25
    s_cbranch_vccz CW_19
    ds_read_b32 v25, v1 offset:0
FW_20:
    s_waitcnt lgkmcnt(0)
    v_cmp_gt_u32 vcc, 2, v25
    s_cbranch_vccz FO_21
    s_sleep 2
    ds_read_b32 v25, v1 offset:0
    s_branch FW_20
FO_21:
CW_19:
    s_add_u32 s47, s81, 1
    s_and_b32 s47, s47, 15
    s_lshl_b32 s47, s47, 17
    s_add_u32 m0, s79, 0
    s_add_u32 s47, s47, s57
    buffer_load_dwordx4 v40, s[20:23], s47 offen lds
    s_add_u32 m0, m0, 1024
    s_add_u32 s47, s47, 16384
    buffer_load_dwordx4 v40, s[20:23], s47 offen lds
    s_add_u32 m0, m0, 1024
    s_add_u32 s47, s47, 16384
    buffer_load_dwordx4 v40, s[20:23], s47 offen lds
    s_add_u32 m0, m0, 1024
    s_add_u32 s47, s47, 16384
    buffer_load_dwordx4 v40, s[20:23], s47 offen lds
    s_waitcnt vmcnt(8)
    s_branch F_w1
F_w0:
    s_waitcnt vmcnt(0)
F_w1:
    s_mov_b32 s49, 1
    s_atomic_add s49, s[82:83], 0x0
    s_atomic_add s49, s[82:83], 0x80
    s_atomic_add s49, s[82:83], 0x100
    s_atomic_add s49, s[82:83], 0x180
    v_mov_b32 v26, 3
    s_mov_b64 exec, 1
    ds_write_b32 v3, v26 offset:32
    s_mov_b64 exec, -1
    s_cmp_ge_u32 s3, 2
    s_cbranch_scc1 F_wo
    ds_read_b32 v26, v18 offset:32
FW_22:
    s_waitcnt lgkmcnt(0)
    v_cmp_gt_u32 vcc, 2, v26
    s_cbranch_vccz FO_23
    ds_read_b32 v26, v18 offset:32
    s_branch FW_22
FO_23:
    v_cmp_gt_u32 vcc, 4, v25
    s_cbranch_vccz CW_24
    ds_read_b32 v25, v1 offset:0
FW_25:
    s_waitcnt lgkmcnt(0)
    v_cmp_gt_u32 vcc, 4, v25
    s_cbranch_vccz FO_26
    s_sleep 2
    ds_read_b32 v25, v1 offset:0
    s_branch FW_25
FO_26:
CW_24:
    v_lshlrev_b32 v9, 4, v0
    s_lshl_b32 s50, s3, 7
    s_add_u32 s50, s50, 159232
    s_add_u32 m0, s78, 40960
SP_27:
    s_load_dword s58, s[54:55], 0 glc
    s_waitcnt lgkmcnt(0)
    s_cmp_ge_u32 s58, 32
    s_cbranch_scc1 SD_28
    s_sleep 1
    s_branch SP_27
SD_28:
    buffer_load_dwordx4 v9, s[24:27], s52 offen offset:0 sc1 lds
    buffer_load_dwordx4 v9, s[24:27], s52 offen offset:1024 sc1 lds
    s_add_u32 m0, m0, 2048
    s_nop 0
    buffer_load_dwordx4 v9, s[24:27], s52 offen offset:2048 sc1 lds
    buffer_load_dwordx4 v9, s[24:27], s52 offen offset:3072 sc1 lds
    s_mov_b32 m0, s50
    s_mov_b32 exec_hi, 0
    buffer_load_dword v19, s[24:27], s53 offen sc1 lds
    s_mov_b64 exec, 1
    s_lshl_b32 s50, s3, 2
    s_add_u32 m0, s50, 159168
    s_add_u32 s51, s51, 184320
    buffer_load_dword v19, s[24:27], s51 offen sc1 lds
    s_waitcnt vmcnt(0)
    s_mov_b64 exec, 1
    v_mov_b32 v26, 32
    ds_write_b32 v3, v26 offset:128
    s_mov_b64 exec, -1
    s_branch F_wj
F_wo:
    v_cmp_gt_u32 vcc, 2, v25
    s_cbranch_vccz CW_29
    ds_read_b32 v25, v1 offset:0
FW_30:
    s_waitcnt lgkmcnt(0)
    v_cmp_gt_u32 vcc, 2, v25
    s_cbranch_vccz FO_31
    s_sleep 2
    ds_read_b32 v25, v1 offset:0
    s_branch FW_30
FO_31:
CW_29:
    s_add_u32 s47, s81, 2
    s_and_b32 s47, s47, 15
    s_lshl_b32 s47, s47, 17
    s_add_u32 m0, s79, 8192
    s_add_u32 s47, s47, s57
    buffer_load_dwordx4 v40, s[20:23], s47 offen lds
    s_add_u32 m0, m0, 1024
    s_add_u32 s47, s47, 16384
    buffer_load_dwordx4 v40, s[20:23], s47 offen lds
    s_add_u32 m0, m0, 1024
    s_add_u32 s47, s47, 16384
    buffer_load_dwordx4 v40, s[20:23], s47 offen lds
    s_add_u32 m0, m0, 1024
    s_add_u32 s47, s47, 16384
    buffer_load_dwordx4 v40, s[20:23], s47 offen lds
    v_cmp_gt_u32 vcc, 2, v25
    s_cbranch_vccz CW_32
    ds_read_b32 v25, v1 offset:0
FW_33:
    s_waitcnt lgkmcnt(0)
    v_cmp_gt_u32 vcc, 2, v25
    s_cbranch_vccz FO_34
    s_sleep 2
    ds_read_b32 v25, v1 offset:0
    s_branch FW_33
FO_34:
CW_32:
    s_waitcnt vmcnt(8)
    s_add_u32 s47, s81, 3
    s_and_b32 s47, s47, 15
    s_lshl_b32 s47, s47, 17
    s_add_u32 m0, s79, 139264
    s_add_u32 s47, s47, s57
    buffer_load_dwordx4 v40, s[20:23], s47 offen lds
    s_add_u32 m0, m0, 1024
    s_add_u32 s47, s47, 16384
    buffer_load_dwordx4 v40, s[20:23], s47 offen lds
    s_add_u32 m0, m0, 1024
    s_add_u32 s47, s47, 16384
    buffer_load_dwordx4 v40, s[20:23], s47 offen lds
    s_add_u32 m0, m0, 1024
    s_add_u32 s47, s47, 16384
    buffer_load_dwordx4 v40, s[20:23], s47 offen lds
    v_cmp_gt_u32 vcc, 3, v25
    s_cbranch_vccz CW_35
    ds_read_b32 v25, v1 offset:0
FW_36:
    s_waitcnt lgkmcnt(0)
    v_cmp_gt_u32 vcc, 3, v25
    s_cbranch_vccz FO_37
    s_sleep 2
    ds_read_b32 v25, v1 offset:0
    s_branch FW_36
FO_37:
CW_35:
    s_waitcnt vmcnt(8)
    s_add_u32 s47, s81, 4
    s_and_b32 s47, s47, 15
    s_lshl_b32 s47, s47, 17
    s_add_u32 m0, s79, 16384
    s_add_u32 s47, s47, s57
    buffer_load_dwordx4 v40, s[20:23], s47 offen lds
    s_add_u32 m0, m0, 1024
    s_add_u32 s47, s47, 16384
    buffer_load_dwordx4 v40, s[20:23], s47 offen lds
    s_add_u32 m0, m0, 1024
    s_add_u32 s47, s47, 16384
    buffer_load_dwordx4 v40, s[20:23], s47 offen lds
    s_add_u32 m0, m0, 1024
    s_add_u32 s47, s47, 16384
    buffer_load_dwordx4 v40, s[20:23], s47 offen lds
    v_cmp_gt_u32 vcc, 3, v25
    s_cbranch_vccz CW_38
    ds_read_b32 v25, v1 offset:0
FW_39:
    s_waitcnt lgkmcnt(0)
    v_cmp_gt_u32 vcc, 3, v25
    s_cbranch_vccz FO_40
    s_sleep 2
    ds_read_b32 v25, v1 offset:0
    s_branch FW_39
FO_40:
CW_38:
    s_waitcnt vmcnt(8)
    s_add_u32 s47, s81, 5
    s_and_b32 s47, s47, 15
    s_lshl_b32 s47, s47, 17
    s_add_u32 m0, s79, 24576
    s_add_u32 s47, s47, s57
    buffer_load_dwordx4 v40, s[20:23], s47 offen lds
    s_add_u32 m0, m0, 1024
    s_add_u32 s47, s47, 16384
    buffer_load_dwordx4 v40, s[20:23], s47 offen lds
    s_add_u32 m0, m0, 1024
    s_add_u32 s47, s47, 16384
    buffer_load_dwordx4 v40, s[20:23], s47 offen lds
    s_add_u32 m0, m0, 1024
    s_add_u32 s47, s47, 16384
    buffer_load_dwordx4 v40, s[20:23], s47 offen lds
    v_cmp_gt_u32 vcc, 3, v25
    s_cbranch_vccz CW_41
    ds_read_b32 v25, v1 offset:0
FW_42:
    s_waitcnt lgkmcnt(0)
    v_cmp_gt_u32 vcc, 3, v25
    s_cbranch_vccz FO_43
    s_sleep 2
    ds_read_b32 v25, v1 offset:0
    s_branch FW_42
FO_43:
CW_41:
    s_waitcnt vmcnt(8)
    s_add_u32 s47, s81, 6
    s_and_b32 s47, s47, 15
    s_lshl_b32 s47, s47, 17
    s_add_u32 m0, s79, 131072
    s_add_u32 s47, s47, s57
    buffer_load_dwordx4 v40, s[20:23], s47 offen lds
    s_add_u32 m0, m0, 1024
    s_add_u32 s47, s47, 16384
    buffer_load_dwordx4 v40, s[20:23], s47 offen lds
    s_add_u32 m0, m0, 1024
    s_add_u32 s47, s47, 16384
    buffer_load_dwordx4 v40, s[20:23], s47 offen lds
    s_add_u32 m0, m0, 1024
    s_add_u32 s47, s47, 16384
    buffer_load_dwordx4 v40, s[20:23], s47 offen lds
    v_cmp_gt_u32 vcc, 4, v25
    s_cbranch_vccz CW_44
    ds_read_b32 v25, v1 offset:0
FW_45:
    s_waitcnt lgkmcnt(0)
    v_cmp_gt_u32 vcc, 4, v25
    s_cbranch_vccz FO_46
    s_sleep 2
    ds_read_b32 v25, v1 offset:0
    s_branch FW_45
FO_46:
CW_44:
    s_waitcnt vmcnt(8)
    s_add_u32 s47, s81, 7
    s_and_b32 s47, s47, 15
    s_lshl_b32 s47, s47, 17
    s_add_u32 m0, s79, 81920
    s_add_u32 s47, s47, s57
    buffer_load_dwordx4 v40, s[20:23], s47 offen lds
    s_add_u32 m0, m0, 1024
    s_add_u32 s47, s47, 16384
    buffer_load_dwordx4 v40, s[20:23], s47 offen lds
    s_add_u32 m0, m0, 1024
    s_add_u32 s47, s47, 16384
    buffer_load_dwordx4 v40, s[20:23], s47 offen lds
    s_add_u32 m0, m0, 1024
    s_add_u32 s47, s47, 16384
    buffer_load_dwordx4 v40, s[20:23], s47 offen lds
    v_cmp_gt_u32 vcc, 5, v25
    s_cbranch_vccz CW_47
    ds_read_b32 v25, v1 offset:0
FW_48:
    s_waitcnt lgkmcnt(0)
    v_cmp_gt_u32 vcc, 5, v25
    s_cbranch_vccz FO_49
    s_sleep 2
    ds_read_b32 v25, v1 offset:0
    s_branch FW_48
FO_49:
CW_47:
    s_waitcnt vmcnt(8)
    s_add_u32 s47, s81, 8
    s_and_b32 s47, s47, 15
    s_lshl_b32 s47, s47, 17
    s_add_u32 m0, s79, 49152
    s_add_u32 s47, s47, s57
    buffer_load_dwordx4 v40, s[20:23], s47 offen lds
    s_add_u32 m0, m0, 1024
    s_add_u32 s47, s47, 16384
    buffer_load_dwordx4 v40, s[20:23], s47 offen lds
    s_add_u32 m0, m0, 1024
    s_add_u32 s47, s47, 16384
    buffer_load_dwordx4 v40, s[20:23], s47 offen lds
    s_add_u32 m0, m0, 1024
    s_add_u32 s47, s47, 16384
    buffer_load_dwordx4 v40, s[20:23], s47 offen lds
    v_cmp_gt_u32 vcc, 5, v25
    s_cbranch_vccz CW_50
    ds_read_b32 v25, v1 offset:0
FW_51:
    s_waitcnt lgkmcnt(0)
    v_cmp_gt_u32 vcc, 5, v25
    s_cbranch_vccz FO_52
    s_sleep 2
    ds_read_b32 v25, v1 offset:0
    s_branch FW_51
FO_52:
CW_50:
    s_waitcnt vmcnt(8)
    s_add_u32 s47, s81, 9
    s_and_b32 s47, s47, 15
    s_lshl_b32 s47, s47, 17
    s_add_u32 m0, s79, 57344
    s_add_u32 s47, s47, s57
    buffer_load_dwordx4 v40, s[20:23], s47 offen lds
    s_add_u32 m0, m0, 1024
    s_add_u32 s47, s47, 16384
    buffer_load_dwordx4 v40, s[20:23], s47 offen lds
    s_add_u32 m0, m0, 1024
    s_add_u32 s47, s47, 16384
    buffer_load_dwordx4 v40, s[20:23], s47 offen lds
    s_add_u32 m0, m0, 1024
    s_add_u32 s47, s47, 16384
    buffer_load_dwordx4 v40, s[20:23], s47 offen lds
    v_cmp_gt_u32 vcc, 5, v25
    s_cbranch_vccz CW_53
    ds_read_b32 v25, v1 offset:0
FW_54:
    s_waitcnt lgkmcnt(0)
    v_cmp_gt_u32 vcc, 5, v25
    s_cbranch_vccz FO_55
    s_sleep 2
    ds_read_b32 v25, v1 offset:0
    s_branch FW_54
FO_55:
CW_53:
    s_waitcnt vmcnt(8)
    s_add_u32 s47, s81, 10
    s_and_b32 s47, s47, 15
    s_lshl_b32 s47, s47, 17
    s_add_u32 m0, s79, 73728
    s_add_u32 s47, s47, s57
    buffer_load_dwordx4 v40, s[20:23], s47 offen lds
    s_add_u32 m0, m0, 1024
    s_add_u32 s47, s47, 16384
    buffer_load_dwordx4 v40, s[20:23], s47 offen lds
    s_add_u32 m0, m0, 1024
    s_add_u32 s47, s47, 16384
    buffer_load_dwordx4 v40, s[20:23], s47 offen lds
    s_add_u32 m0, m0, 1024
    s_add_u32 s47, s47, 16384
    buffer_load_dwordx4 v40, s[20:23], s47 offen lds
    v_cmp_gt_u32 vcc, 6, v25
    s_cbranch_vccz CW_56
    ds_read_b32 v25, v1 offset:0
FW_57:
    s_waitcnt lgkmcnt(0)
    v_cmp_gt_u32 vcc, 6, v25
    s_cbranch_vccz FO_58
    s_sleep 2
    ds_read_b32 v25, v1 offset:0
    s_branch FW_57
FO_58:
CW_56:
    s_waitcnt vmcnt(8)
    s_add_u32 s47, s81, 11
    s_and_b32 s47, s47, 15
    s_lshl_b32 s47, s47, 17
    s_add_u32 m0, s79, 98304
    s_add_u32 s47, s47, s57
    buffer_load_dwordx4 v40, s[20:23], s47 offen lds
    s_add_u32 m0, m0, 1024
    s_add_u32 s47, s47, 16384
    buffer_load_dwordx4 v40, s[20:23], s47 offen lds
    s_add_u32 m0, m0, 1024
    s_add_u32 s47, s47, 16384
    buffer_load_dwordx4 v40, s[20:23], s47 offen lds
    s_add_u32 m0, m0, 1024
    s_add_u32 s47, s47, 16384
    buffer_load_dwordx4 v40, s[20:23], s47 offen lds
    v_cmp_gt_u32 vcc, 7, v25
    s_cbranch_vccz CW_59
    ds_read_b32 v25, v1 offset:0
FW_60:
    s_waitcnt lgkmcnt(0)
    v_cmp_gt_u32 vcc, 7, v25
    s_cbranch_vccz FO_61
    s_sleep 2
    ds_read_b32 v25, v1 offset:0
    s_branch FW_60
FO_61:
CW_59:
    s_waitcnt vmcnt(8)
    s_add_u32 s47, s81, 12
    s_and_b32 s47, s47, 15
    s_lshl_b32 s47, s47, 17
    s_add_u32 m0, s79, 90112
    s_add_u32 s47, s47, s57
    buffer_load_dwordx4 v40, s[20:23], s47 offen lds
    s_add_u32 m0, m0, 1024
    s_add_u32 s47, s47, 16384
    buffer_load_dwordx4 v40, s[20:23], s47 offen lds
    s_add_u32 m0, m0, 1024
    s_add_u32 s47, s47, 16384
    buffer_load_dwordx4 v40, s[20:23], s47 offen lds
    s_add_u32 m0, m0, 1024
    s_add_u32 s47, s47, 16384
    buffer_load_dwordx4 v40, s[20:23], s47 offen lds
    v_cmp_gt_u32 vcc, 8, v25
    s_cbranch_vccz CW_62
    ds_read_b32 v25, v1 offset:0
FW_63:
    s_waitcnt lgkmcnt(0)
    v_cmp_gt_u32 vcc, 8, v25
    s_cbranch_vccz FO_64
    s_sleep 2
    ds_read_b32 v25, v1 offset:0
    s_branch FW_63
FO_64:
CW_62:
    s_waitcnt vmcnt(8)
    s_add_u32 s47, s81, 13
    s_and_b32 s47, s47, 15
    s_lshl_b32 s47, s47, 17
    s_add_u32 m0, s79, 114688
    s_add_u32 s47, s47, s57
    buffer_load_dwordx4 v40, s[20:23], s47 offen lds
    s_add_u32 m0, m0, 1024
    s_add_u32 s47, s47, 16384
    buffer_load_dwordx4 v40, s[20:23], s47 offen lds
    s_add_u32 m0, m0, 1024
    s_add_u32 s47, s47, 16384
    buffer_load_dwordx4 v40, s[20:23], s47 offen lds
    s_add_u32 m0, m0, 1024
    s_add_u32 s47, s47, 16384
    buffer_load_dwordx4 v40, s[20:23], s47 offen lds
    v_cmp_gt_u32 vcc, 9, v25
    s_cbranch_vccz CW_65
    ds_read_b32 v25, v1 offset:0
FW_66:
    s_waitcnt lgkmcnt(0)
    v_cmp_gt_u32 vcc, 9, v25
    s_cbranch_vccz FO_67
    s_sleep 2
    ds_read_b32 v25, v1 offset:0
    s_branch FW_66
FO_67:
CW_65:
    s_waitcnt vmcnt(8)
    s_add_u32 s47, s81, 14
    s_and_b32 s47, s47, 15
    s_lshl_b32 s47, s47, 17
    s_add_u32 m0, s79, 106496
    s_add_u32 s47, s47, s57
    buffer_load_dwordx4 v40, s[20:23], s47 offen lds
    s_add_u32 m0, m0, 1024
    s_add_u32 s47, s47, 16384
    buffer_load_dwordx4 v40, s[20:23], s47 offen lds
    s_add_u32 m0, m0, 1024
    s_add_u32 s47, s47, 16384
    buffer_load_dwordx4 v40, s[20:23], s47 offen lds
    s_add_u32 m0, m0, 1024
    s_add_u32 s47, s47, 16384
    buffer_load_dwordx4 v40, s[20:23], s47 offen lds
    v_cmp_gt_u32 vcc, 10, v25
    s_cbranch_vccz CW_68
    ds_read_b32 v25, v1 offset:0
FW_69:
    s_waitcnt lgkmcnt(0)
    v_cmp_gt_u32 vcc, 10, v25
    s_cbranch_vccz FO_70
    s_sleep 2
    ds_read_b32 v25, v1 offset:0
    s_branch FW_69
FO_70:
CW_68:
    s_waitcnt vmcnt(8)
    s_add_u32 s47, s81, 15
    s_and_b32 s47, s47, 15
    s_lshl_b32 s47, s47, 17
    s_add_u32 m0, s79, 122880
    s_add_u32 s47, s47, s57
    buffer_load_dwordx4 v40, s[20:23], s47 offen lds
    s_add_u32 m0, m0, 1024
    s_add_u32 s47, s47, 16384
    buffer_load_dwordx4 v40, s[20:23], s47 offen lds
    s_add_u32 m0, m0, 1024
    s_add_u32 s47, s47, 16384
    buffer_load_dwordx4 v40, s[20:23], s47 offen lds
    s_add_u32 m0, m0, 1024
    s_add_u32 s47, s47, 16384
    buffer_load_dwordx4 v40, s[20:23], s47 offen lds
F_wj:
    v_mov_b32 v5, 159096
    s_branch IW_s6
IW_w6:
    s_branch IW_r6
IW_s6:
    ds_read_b32 v6, v5 offset:0
FW_71:
    s_waitcnt lgkmcnt(0)
    v_cmp_gt_u32 vcc, 1, v6
    s_cbranch_vccz FO_72
    s_sleep 1
    ds_read_b32 v6, v5 offset:0
    s_branch FW_71
FO_72:
    v_and_b32 v5, 7, v0
    v_lshlrev_b32 v5, 2, v5
    v_add_u32 v5, 158976, v5
    ds_read_b32 v5, v5
    s_lshr_b32 s47, s64, 5
    s_sub_u32 s47, 63, s47
    s_mov_b64 s[60:61], 0
    s_waitcnt lgkmcnt(0)
    v_bfe_u32 v5, v5, 5, 6
    v_cmp_eq_u32 vcc, s47, v5
    s_cbranch_vccz F_ns

    v_mov_b32 v5, 158976
    ds_read_b128 v[44:47], v5
    ds_read_b128 v[48:51], v5 offset:16
    v_and_b32 v6, 15, v0
    v_add_u32 v6, s64, v6
    v_sub_u32 v6, 2047, v6
    v_subrev_u32 v7, 16, v6
    v_mov_b32 v164, 0
    v_mov_b32 v165, 0
    s_waitcnt lgkmcnt(0)
    v_and_b32 v5, 0x7ff, v44
    v_or_b32 v44, 0x4000, v44
    v_cmp_eq_u32 vcc, v5, v6
    v_cmp_eq_u32 s[62:63], v5, v7
    s_nop 0
    v_cndmask_b32 v164, v164, v44, vcc
    v_cndmask_b32 v165, v165, v44, s[62:63]
    v_and_b32 v5, 0x7ff, v45
    v_or_b32 v45, 0x4800, v45
    v_cmp_eq_u32 vcc, v5, v6
    v_cmp_eq_u32 s[62:63], v5, v7
    s_nop 0
    v_cndmask_b32 v164, v164, v45, vcc
    v_cndmask_b32 v165, v165, v45, s[62:63]
    v_and_b32 v5, 0x7ff, v46
    v_or_b32 v46, 0x5000, v46
    v_cmp_eq_u32 vcc, v5, v6
    v_cmp_eq_u32 s[62:63], v5, v7
    s_nop 0
    v_cndmask_b32 v164, v164, v46, vcc
    v_cndmask_b32 v165, v165, v46, s[62:63]
    v_and_b32 v5, 0x7ff, v47
    v_or_b32 v47, 0x5800, v47
    v_cmp_eq_u32 vcc, v5, v6
    v_cmp_eq_u32 s[62:63], v5, v7
    s_nop 0
    v_cndmask_b32 v164, v164, v47, vcc
    v_cndmask_b32 v165, v165, v47, s[62:63]
    v_and_b32 v5, 0x7ff, v48
    v_or_b32 v48, 0x6000, v48
    v_cmp_eq_u32 vcc, v5, v6
    v_cmp_eq_u32 s[62:63], v5, v7
    s_nop 0
    v_cndmask_b32 v164, v164, v48, vcc
    v_cndmask_b32 v165, v165, v48, s[62:63]
    v_and_b32 v5, 0x7ff, v49
    v_or_b32 v49, 0x6800, v49
    v_cmp_eq_u32 vcc, v5, v6
    v_cmp_eq_u32 s[62:63], v5, v7
    s_nop 0
    v_cndmask_b32 v164, v164, v49, vcc
    v_cndmask_b32 v165, v165, v49, s[62:63]
    v_and_b32 v5, 0x7ff, v50
    v_or_b32 v50, 0x7000, v50
    v_cmp_eq_u32 vcc, v5, v6
    v_cmp_eq_u32 s[62:63], v5, v7
    s_nop 0
    v_cndmask_b32 v164, v164, v50, vcc
    v_cndmask_b32 v165, v165, v50, s[62:63]
    v_and_b32 v5, 0x7ff, v51
    v_or_b32 v51, 0x7800, v51
    v_cmp_eq_u32 vcc, v5, v6
    v_cmp_eq_u32 s[62:63], v5, v7
    s_nop 0
    v_cndmask_b32 v164, v164, v51, vcc
    v_cndmask_b32 v165, v165, v51, s[62:63]
    s_mov_b32 s47, 0xbfb8aa3b
    v_and_b32 v7, 0x30, v0
    v_add_u32 v7, 159744, v7
    v_cmp_ne_u32 s[74:75], 0, v164
    v_bfe_u32 v5, v164, 11, 3
    v_lshl_add_u32 v162, v5, 8, v7
    v_and_b32 v5, 0xffff0000, v164
    v_ashrrev_i32 v6, 31, v5
    v_not_b32 v6, v6
    v_or_b32 v6, 0x80000000, v6
    v_xor_b32 v5, v5, v6
    v_and_b32 v5, 0xffff0000, v5
    v_mul_f32 v5, s47, v5
    v_exp_f32 v5, v5
    s_nop 0
    v_add_f32 v5, 1.0, v5
    v_rcp_f32 v5, v5
    s_nop 0
    v_cvt_pk_bf16_f32 v5, v5, v5
    v_lshlrev_b32 v164, 16, v5
    v_cmp_ne_u32 s[76:77], 0, v165
    v_bfe_u32 v5, v165, 11, 3
    v_lshl_add_u32 v163, v5, 8, v7
    v_and_b32 v5, 0xffff0000, v165
    v_ashrrev_i32 v6, 31, v5
    v_not_b32 v6, v6
    v_or_b32 v6, 0x80000000, v6
    v_xor_b32 v5, v5, v6
    v_and_b32 v5, 0xffff0000, v5
    v_mul_f32 v5, s47, v5
    v_exp_f32 v5, v5
    s_nop 0
    v_add_f32 v5, 1.0, v5
    v_rcp_f32 v5, v5
    s_nop 0
    v_cvt_pk_bf16_f32 v5, v5, v5
    v_lshlrev_b32 v165, 16, v5
    v_mov_b32 v161, 159136
    s_mov_b64 s[60:61], 1
F_ns:
    s_lshl_b32 s51, s28, 2
    s_add_u32 s51, s51, s3
    s_lshl_b32 s51, s51, 3
    s_and_b32 s47, s29, 3
    s_add_u32 s51, s51, s47
    s_lshl_b32 s51, s51, 7

    s_add_u32 s54, s51, 0x835000
    s_add_u32 s54, s72, s54
    s_addc_u32 s55, s73, 0
    v_lshlrev_b32 v98, 4, v0
    v_lshrrev_b32 v16, 4, v0
    v_bfe_u32 v17, v0, 2, 2
    v_lshl_add_u32 v17, v16, 2, v17
    v_bfe_u32 v16, v17, 1, 2
    v_lshlrev_b32 v16, 5, v16
    v_lshl_add_u32 v16, v17, 7, v16
    v_and_b32 v17, 3, v0
    v_lshl_add_u32 v4, v17, 3, v16
    v_xor_b32 v5, 32, v4
    v_xor_b32 v6, 64, v4
    v_xor_b32 v7, 96, v4
    s_lshl_b32 s79, s28, 18
    s_lshl_b32 s80, s3, 16
    s_add_u32 s79, s79, s80
    s_lshl_b32 s81, s81, 11
    v_mov_b32 v99, 1

    v_add_u32 v8, 57344, v4
    v_add_u32 v9, 57344, v5
    v_add_u32 v10, 57344, v6
    v_add_u32 v11, 57344, v7
    v_add_u32 v12, 114688, v4
    v_add_u32 v13, 114688, v5
    v_add_u32 v14, 114688, v6
    v_add_u32 v15, 114688, v7
    s_add_u32 s16, s72, 0x400000
    s_addc_u32 s17, s73, 0
    s_mov_b32 s18, 0x400000
    s_mov_b32 s19, 0x00020000
    s_mov_b32 s12, s68
    s_mov_b32 s13, s69
    s_mov_b32 s14, 0x400000
    s_mov_b32 s15, 0x00020000
    s_add_u32 s80, s81, 0
    s_and_b32 s80, s80, 0x7fff
    s_add_u32 s4, s80, s79
    s_add_u32 s80, s81, 2048
    s_and_b32 s80, s80, 0x7fff
    s_add_u32 s5, s80, s79
    s_add_u32 s80, s81, 4096
    s_and_b32 s80, s80, 0x7fff
    s_add_u32 s6, s80, s79
    s_add_u32 s80, s81, 6144
    s_and_b32 s80, s80, 0x7fff
    s_add_u32 s7, s80, s79
    s_add_u32 s80, s81, 8192
    s_and_b32 s80, s80, 0x7fff
    s_add_u32 s8, s80, s79
    s_add_u32 s80, s81, 10240
    s_and_b32 s80, s80, 0x7fff
    s_add_u32 s9, s80, s79
    s_add_u32 s80, s81, 12288
    s_and_b32 s80, s80, 0x7fff
    s_add_u32 s10, s80, s79
    s_add_u32 s80, s81, 14336
    s_and_b32 s80, s80, 0x7fff
    s_add_u32 s11, s80, s79
    s_add_u32 s80, s81, 16384
    s_and_b32 s80, s80, 0x7fff
    s_add_u32 s30, s80, s79
    s_add_u32 s80, s81, 18432
    s_and_b32 s80, s80, 0x7fff
    s_add_u32 s31, s80, s79
    s_add_u32 s80, s81, 20480
    s_and_b32 s80, s80, 0x7fff
    s_add_u32 s32, s80, s79
    s_add_u32 s80, s81, 22528
    s_and_b32 s80, s80, 0x7fff
    s_add_u32 s33, s80, s79
    s_add_u32 s80, s81, 24576
    s_and_b32 s80, s80, 0x7fff
    s_add_u32 s34, s80, s79
    s_add_u32 s80, s81, 26624
    s_and_b32 s80, s80, 0x7fff
    s_add_u32 s35, s80, s79
    s_add_u32 s80, s81, 28672
    s_and_b32 s80, s80, 0x7fff
    s_add_u32 s36, s80, s79
    s_add_u32 s80, s81, 30720
    s_and_b32 s80, s80, 0x7fff
    s_add_u32 s37, s80, s79
    v_add_u32 v97, 0x8000, v98
    s_setprio 2
    s_mov_b32 s50, 0
F_op:
    s_load_dword s47, s[54:55], 0 glc
    s_getreg_b32 s51, hwreg(HW_REG_IB_STS)
    s_and_b32 s51, s51, 0xc0000f
    s_or_b32 s51, s51, s50
    s_cbranch_scc1 F_oq
    s_mov_b64 exec, 1
    ds_write_b32 v3, v99 offset:160
    s_mov_b64 exec, -1
    s_mov_b32 s50, 1
F_oq:
    s_waitcnt lgkmcnt(0)
    s_cmp_lt_u32 s47, 16
    s_cbranch_scc1 F_op
    buffer_load_dwordx4 v[48:51], v98, s[16:19], s4 offen offset:0 sc1
    buffer_load_dwordx4 v[52:55], v97, s[16:19], s4 offen offset:0 sc1
    buffer_load_dwordx4 v[56:59], v98, s[16:19], s4 offen offset:1024 sc1
    buffer_load_dwordx4 v[60:63], v97, s[16:19], s4 offen offset:1024 sc1
    buffer_load_dwordx4 v[64:67], v98, s[16:19], s5 offen offset:0 sc1
    buffer_load_dwordx4 v[68:71], v97, s[16:19], s5 offen offset:0 sc1
    buffer_load_dwordx4 v[72:75], v98, s[16:19], s5 offen offset:1024 sc1
    buffer_load_dwordx4 v[76:79], v97, s[16:19], s5 offen offset:1024 sc1
    buffer_load_dwordx4 v[80:83], v98, s[16:19], s6 offen offset:0 sc1
    buffer_load_dwordx4 v[84:87], v97, s[16:19], s6 offen offset:0 sc1
    buffer_load_dwordx4 v[88:91], v98, s[16:19], s6 offen offset:1024 sc1
    buffer_load_dwordx4 v[92:95], v97, s[16:19], s6 offen offset:1024 sc1
    s_cmp_lg_u32 s50, 0
    s_cbranch_scc1 F_or
    s_waitcnt vmcnt(12)
    s_mov_b64 exec, 1
    ds_write_b32 v3, v99 offset:160
    s_mov_b64 exec, -1
F_or:
    v_or_b32 v17, 8, v1
    ds_read_b32 v16, v17 offset:160
FW_73:
    s_waitcnt lgkmcnt(0)
    v_cmp_gt_u32 vcc, 1, v16
    s_cbranch_vccz FO_74
    ds_read_b32 v16, v17 offset:160
    s_branch FW_73
FO_74:
    v_and_b32 v1, 0x3fff, v2
    v_bfe_u32 v99, v0, 3, 1
    v_lshl_add_u32 v1, v99, 6, v1
    ds_read_b64_tr_b16 v[16:17], v12 offset:32768
    ds_read_b64_tr_b16 v[18:19], v12 offset:34816
    ds_read_b64_tr_b16 v[20:21], v13 offset:32768
    ds_read_b64_tr_b16 v[22:23], v13 offset:34816
    ds_read_b64_tr_b16 v[24:25], v14 offset:32768
    ds_read_b64_tr_b16 v[26:27], v14 offset:34816
    ds_read_b64_tr_b16 v[28:29], v15 offset:32768
    ds_read_b64_tr_b16 v[30:31], v15 offset:34816
    s_waitcnt vmcnt(10) lgkmcnt(0)
    v_mfma_f32_16x16x32_bf16 v[100:103], v[16:19], v[48:51], v[100:103]
    ds_read_b64_tr_b16 v[32:33], v12 offset:36864
    ds_read_b64_tr_b16 v[34:35], v12 offset:38912
    v_mfma_f32_16x16x32_bf16 v[116:119], v[16:19], v[52:55], v[116:119]
    ds_read_b64_tr_b16 v[36:37], v13 offset:36864
    ds_read_b64_tr_b16 v[38:39], v13 offset:38912
    v_mfma_f32_16x16x32_bf16 v[104:107], v[20:23], v[48:51], v[104:107]
    ds_read_b64_tr_b16 v[40:41], v14 offset:36864
    ds_read_b64_tr_b16 v[42:43], v14 offset:38912
    v_mfma_f32_16x16x32_bf16 v[120:123], v[20:23], v[52:55], v[120:123]
    ds_read_b64_tr_b16 v[44:45], v15 offset:36864
    ds_read_b64_tr_b16 v[46:47], v15 offset:38912
    v_mfma_f32_16x16x32_bf16 v[108:111], v[24:27], v[48:51], v[108:111]
    buffer_load_dwordx4 v[132:135], v98, s[16:19], s7 offen offset:0 sc1
    v_mfma_f32_16x16x32_bf16 v[124:127], v[24:27], v[52:55], v[124:127]
    v_mfma_f32_16x16x32_bf16 v[112:115], v[28:31], v[48:51], v[112:115]
    buffer_load_dwordx4 v[136:139], v97, s[16:19], s7 offen offset:0 sc1
    v_mfma_f32_16x16x32_bf16 v[128:131], v[28:31], v[52:55], v[128:131]
    s_waitcnt vmcnt(10) lgkmcnt(0)
    v_mfma_f32_16x16x32_bf16 v[100:103], v[32:35], v[56:59], v[100:103]
    ds_read_b64_tr_b16 v[16:17], v4 offset:0
    ds_read_b64_tr_b16 v[18:19], v4 offset:2048
    v_mfma_f32_16x16x32_bf16 v[116:119], v[32:35], v[60:63], v[116:119]
    ds_read_b64_tr_b16 v[20:21], v5 offset:0
    ds_read_b64_tr_b16 v[22:23], v5 offset:2048
    v_mfma_f32_16x16x32_bf16 v[104:107], v[36:39], v[56:59], v[104:107]
    ds_read_b64_tr_b16 v[24:25], v6 offset:0
    ds_read_b64_tr_b16 v[26:27], v6 offset:2048
    v_mfma_f32_16x16x32_bf16 v[120:123], v[36:39], v[60:63], v[120:123]
    ds_read_b64_tr_b16 v[28:29], v7 offset:0
    ds_read_b64_tr_b16 v[30:31], v7 offset:2048
    v_mfma_f32_16x16x32_bf16 v[108:111], v[40:43], v[56:59], v[108:111]
    buffer_load_dwordx4 v[48:51], v98, s[16:19], s7 offen offset:1024 sc1
    v_mfma_f32_16x16x32_bf16 v[124:127], v[40:43], v[60:63], v[124:127]
    v_mfma_f32_16x16x32_bf16 v[112:115], v[44:47], v[56:59], v[112:115]
    buffer_load_dwordx4 v[52:55], v97, s[16:19], s7 offen offset:1024 sc1
    v_mfma_f32_16x16x32_bf16 v[128:131], v[44:47], v[60:63], v[128:131]
    s_waitcnt vmcnt(10) lgkmcnt(0)
    v_mfma_f32_16x16x32_bf16 v[100:103], v[16:19], v[64:67], v[100:103]
    ds_read_b64_tr_b16 v[32:33], v4 offset:4096
    ds_read_b64_tr_b16 v[34:35], v4 offset:6144
    v_mfma_f32_16x16x32_bf16 v[116:119], v[16:19], v[68:71], v[116:119]
    ds_read_b64_tr_b16 v[36:37], v5 offset:4096
    ds_read_b64_tr_b16 v[38:39], v5 offset:6144
    v_mfma_f32_16x16x32_bf16 v[104:107], v[20:23], v[64:67], v[104:107]
    ds_read_b64_tr_b16 v[40:41], v6 offset:4096
    ds_read_b64_tr_b16 v[42:43], v6 offset:6144
    v_mfma_f32_16x16x32_bf16 v[120:123], v[20:23], v[68:71], v[120:123]
    ds_read_b64_tr_b16 v[44:45], v7 offset:4096
    ds_read_b64_tr_b16 v[46:47], v7 offset:6144
    v_mfma_f32_16x16x32_bf16 v[108:111], v[24:27], v[64:67], v[108:111]
    buffer_load_dwordx4 v[56:59], v98, s[16:19], s8 offen offset:0 sc1
    v_mfma_f32_16x16x32_bf16 v[124:127], v[24:27], v[68:71], v[124:127]
    v_mfma_f32_16x16x32_bf16 v[112:115], v[28:31], v[64:67], v[112:115]
    buffer_load_dwordx4 v[60:63], v97, s[16:19], s8 offen offset:0 sc1
    v_mfma_f32_16x16x32_bf16 v[128:131], v[28:31], v[68:71], v[128:131]
    s_waitcnt vmcnt(10) lgkmcnt(0)
    v_mfma_f32_16x16x32_bf16 v[100:103], v[32:35], v[72:75], v[100:103]
    ds_read_b64_tr_b16 v[16:17], v4 offset:8192
    ds_read_b64_tr_b16 v[18:19], v4 offset:10240
    v_mfma_f32_16x16x32_bf16 v[116:119], v[32:35], v[76:79], v[116:119]
    ds_read_b64_tr_b16 v[20:21], v5 offset:8192
    ds_read_b64_tr_b16 v[22:23], v5 offset:10240
    v_mfma_f32_16x16x32_bf16 v[104:107], v[36:39], v[72:75], v[104:107]
    ds_read_b64_tr_b16 v[24:25], v6 offset:8192
    ds_read_b64_tr_b16 v[26:27], v6 offset:10240
    v_mfma_f32_16x16x32_bf16 v[120:123], v[36:39], v[76:79], v[120:123]
    ds_read_b64_tr_b16 v[28:29], v7 offset:8192
    ds_read_b64_tr_b16 v[30:31], v7 offset:10240
    v_mfma_f32_16x16x32_bf16 v[108:111], v[40:43], v[72:75], v[108:111]
    buffer_load_dwordx4 v[64:67], v98, s[16:19], s8 offen offset:1024 sc1
    v_mfma_f32_16x16x32_bf16 v[124:127], v[40:43], v[76:79], v[124:127]
    v_mfma_f32_16x16x32_bf16 v[112:115], v[44:47], v[72:75], v[112:115]
    buffer_load_dwordx4 v[68:71], v97, s[16:19], s8 offen offset:1024 sc1
    v_mfma_f32_16x16x32_bf16 v[128:131], v[44:47], v[76:79], v[128:131]
    s_waitcnt vmcnt(10) lgkmcnt(0)
    v_mfma_f32_16x16x32_bf16 v[100:103], v[16:19], v[80:83], v[100:103]
    ds_read_b64_tr_b16 v[32:33], v4 offset:12288
    ds_read_b64_tr_b16 v[34:35], v4 offset:14336
    v_mfma_f32_16x16x32_bf16 v[116:119], v[16:19], v[84:87], v[116:119]
    ds_read_b64_tr_b16 v[36:37], v5 offset:12288
    ds_read_b64_tr_b16 v[38:39], v5 offset:14336
    v_mfma_f32_16x16x32_bf16 v[104:107], v[20:23], v[80:83], v[104:107]
    ds_read_b64_tr_b16 v[40:41], v6 offset:12288
    ds_read_b64_tr_b16 v[42:43], v6 offset:14336
    v_mfma_f32_16x16x32_bf16 v[120:123], v[20:23], v[84:87], v[120:123]
    ds_read_b64_tr_b16 v[44:45], v7 offset:12288
    ds_read_b64_tr_b16 v[46:47], v7 offset:14336
    v_mfma_f32_16x16x32_bf16 v[108:111], v[24:27], v[80:83], v[108:111]
    buffer_load_dwordx4 v[72:75], v98, s[16:19], s9 offen offset:0 sc1
    v_mfma_f32_16x16x32_bf16 v[124:127], v[24:27], v[84:87], v[124:127]
    v_mfma_f32_16x16x32_bf16 v[112:115], v[28:31], v[80:83], v[112:115]
    buffer_load_dwordx4 v[76:79], v97, s[16:19], s9 offen offset:0 sc1
    v_mfma_f32_16x16x32_bf16 v[128:131], v[28:31], v[84:87], v[128:131]
    s_waitcnt vmcnt(10) lgkmcnt(0)
    v_mfma_f32_16x16x32_bf16 v[100:103], v[32:35], v[88:91], v[100:103]
    ds_read_b64_tr_b16 v[16:17], v12 offset:24576
    ds_read_b64_tr_b16 v[18:19], v12 offset:26624
    v_mfma_f32_16x16x32_bf16 v[116:119], v[32:35], v[92:95], v[116:119]
    ds_read_b64_tr_b16 v[20:21], v13 offset:24576
    ds_read_b64_tr_b16 v[22:23], v13 offset:26624
    v_mfma_f32_16x16x32_bf16 v[104:107], v[36:39], v[88:91], v[104:107]
    ds_read_b64_tr_b16 v[24:25], v14 offset:24576
    ds_read_b64_tr_b16 v[26:27], v14 offset:26624
    v_mfma_f32_16x16x32_bf16 v[120:123], v[36:39], v[92:95], v[120:123]
    ds_read_b64_tr_b16 v[28:29], v15 offset:24576
    ds_read_b64_tr_b16 v[30:31], v15 offset:26624
    v_mfma_f32_16x16x32_bf16 v[108:111], v[40:43], v[88:91], v[108:111]
    buffer_load_dwordx4 v[80:83], v98, s[16:19], s9 offen offset:1024 sc1
    v_mfma_f32_16x16x32_bf16 v[124:127], v[40:43], v[92:95], v[124:127]
    v_mfma_f32_16x16x32_bf16 v[112:115], v[44:47], v[88:91], v[112:115]
    buffer_load_dwordx4 v[84:87], v97, s[16:19], s9 offen offset:1024 sc1
    v_mfma_f32_16x16x32_bf16 v[128:131], v[44:47], v[92:95], v[128:131]
    s_waitcnt vmcnt(10) lgkmcnt(0)
    v_mfma_f32_16x16x32_bf16 v[100:103], v[16:19], v[132:135], v[100:103]
    ds_read_b64_tr_b16 v[32:33], v12 offset:28672
    ds_read_b64_tr_b16 v[34:35], v12 offset:30720
    v_mfma_f32_16x16x32_bf16 v[116:119], v[16:19], v[136:139], v[116:119]
    ds_read_b64_tr_b16 v[36:37], v13 offset:28672
    ds_read_b64_tr_b16 v[38:39], v13 offset:30720
    v_mfma_f32_16x16x32_bf16 v[104:107], v[20:23], v[132:135], v[104:107]
    ds_read_b64_tr_b16 v[40:41], v14 offset:28672
    ds_read_b64_tr_b16 v[42:43], v14 offset:30720
    v_mfma_f32_16x16x32_bf16 v[120:123], v[20:23], v[136:139], v[120:123]
    ds_read_b64_tr_b16 v[44:45], v15 offset:28672
    ds_read_b64_tr_b16 v[46:47], v15 offset:30720
    v_mfma_f32_16x16x32_bf16 v[108:111], v[24:27], v[132:135], v[108:111]
    buffer_load_dwordx4 v[88:91], v98, s[16:19], s10 offen offset:0 sc1
    v_mfma_f32_16x16x32_bf16 v[124:127], v[24:27], v[136:139], v[124:127]
    v_mfma_f32_16x16x32_bf16 v[112:115], v[28:31], v[132:135], v[112:115]
    buffer_load_dwordx4 v[92:95], v97, s[16:19], s10 offen offset:0 sc1
    v_mfma_f32_16x16x32_bf16 v[128:131], v[28:31], v[136:139], v[128:131]
    s_waitcnt vmcnt(10) lgkmcnt(0)
    v_mfma_f32_16x16x32_bf16 v[100:103], v[32:35], v[48:51], v[100:103]
    ds_read_b64_tr_b16 v[16:17], v4 offset:16384
    ds_read_b64_tr_b16 v[18:19], v4 offset:18432
    v_mfma_f32_16x16x32_bf16 v[116:119], v[32:35], v[52:55], v[116:119]
    ds_read_b64_tr_b16 v[20:21], v5 offset:16384
    ds_read_b64_tr_b16 v[22:23], v5 offset:18432
    v_mfma_f32_16x16x32_bf16 v[104:107], v[36:39], v[48:51], v[104:107]
    ds_read_b64_tr_b16 v[24:25], v6 offset:16384
    ds_read_b64_tr_b16 v[26:27], v6 offset:18432
    v_mfma_f32_16x16x32_bf16 v[120:123], v[36:39], v[52:55], v[120:123]
    ds_read_b64_tr_b16 v[28:29], v7 offset:16384
    ds_read_b64_tr_b16 v[30:31], v7 offset:18432
    v_mfma_f32_16x16x32_bf16 v[108:111], v[40:43], v[48:51], v[108:111]
    buffer_load_dwordx4 v[132:135], v98, s[16:19], s10 offen offset:1024 sc1
    v_mfma_f32_16x16x32_bf16 v[124:127], v[40:43], v[52:55], v[124:127]
    v_mfma_f32_16x16x32_bf16 v[112:115], v[44:47], v[48:51], v[112:115]
    buffer_load_dwordx4 v[136:139], v97, s[16:19], s10 offen offset:1024 sc1
    v_mfma_f32_16x16x32_bf16 v[128:131], v[44:47], v[52:55], v[128:131]
    s_waitcnt vmcnt(10) lgkmcnt(0)
    v_mfma_f32_16x16x32_bf16 v[100:103], v[16:19], v[56:59], v[100:103]
    ds_read_b64_tr_b16 v[32:33], v4 offset:20480
    ds_read_b64_tr_b16 v[34:35], v4 offset:22528
    v_mfma_f32_16x16x32_bf16 v[116:119], v[16:19], v[60:63], v[116:119]
    ds_read_b64_tr_b16 v[36:37], v5 offset:20480
    ds_read_b64_tr_b16 v[38:39], v5 offset:22528
    v_mfma_f32_16x16x32_bf16 v[104:107], v[20:23], v[56:59], v[104:107]
    ds_read_b64_tr_b16 v[40:41], v6 offset:20480
    ds_read_b64_tr_b16 v[42:43], v6 offset:22528
    v_mfma_f32_16x16x32_bf16 v[120:123], v[20:23], v[60:63], v[120:123]
    ds_read_b64_tr_b16 v[44:45], v7 offset:20480
    ds_read_b64_tr_b16 v[46:47], v7 offset:22528
    v_mfma_f32_16x16x32_bf16 v[108:111], v[24:27], v[56:59], v[108:111]
    buffer_load_dwordx4 v[48:51], v98, s[16:19], s11 offen offset:0 sc1
    v_mfma_f32_16x16x32_bf16 v[124:127], v[24:27], v[60:63], v[124:127]
    v_mfma_f32_16x16x32_bf16 v[112:115], v[28:31], v[56:59], v[112:115]
    buffer_load_dwordx4 v[52:55], v97, s[16:19], s11 offen offset:0 sc1
    v_mfma_f32_16x16x32_bf16 v[128:131], v[28:31], v[60:63], v[128:131]
    s_waitcnt vmcnt(10) lgkmcnt(0)
    v_mfma_f32_16x16x32_bf16 v[100:103], v[32:35], v[64:67], v[100:103]
    ds_read_b64_tr_b16 v[16:17], v4 offset:24576
    ds_read_b64_tr_b16 v[18:19], v4 offset:26624
    v_mfma_f32_16x16x32_bf16 v[116:119], v[32:35], v[68:71], v[116:119]
    ds_read_b64_tr_b16 v[20:21], v5 offset:24576
    ds_read_b64_tr_b16 v[22:23], v5 offset:26624
    v_mfma_f32_16x16x32_bf16 v[104:107], v[36:39], v[64:67], v[104:107]
    ds_read_b64_tr_b16 v[24:25], v6 offset:24576
    ds_read_b64_tr_b16 v[26:27], v6 offset:26624
    v_mfma_f32_16x16x32_bf16 v[120:123], v[36:39], v[68:71], v[120:123]
    ds_read_b64_tr_b16 v[28:29], v7 offset:24576
    ds_read_b64_tr_b16 v[30:31], v7 offset:26624
    v_mfma_f32_16x16x32_bf16 v[108:111], v[40:43], v[64:67], v[108:111]
    buffer_load_dwordx4 v[56:59], v98, s[16:19], s11 offen offset:1024 sc1
    v_mfma_f32_16x16x32_bf16 v[124:127], v[40:43], v[68:71], v[124:127]
    v_mfma_f32_16x16x32_bf16 v[112:115], v[44:47], v[64:67], v[112:115]
    buffer_load_dwordx4 v[60:63], v97, s[16:19], s11 offen offset:1024 sc1
    v_mfma_f32_16x16x32_bf16 v[128:131], v[44:47], v[68:71], v[128:131]
    s_waitcnt vmcnt(10) lgkmcnt(0)
    v_mfma_f32_16x16x32_bf16 v[100:103], v[16:19], v[72:75], v[100:103]
    ds_read_b64_tr_b16 v[32:33], v4 offset:28672
    ds_read_b64_tr_b16 v[34:35], v4 offset:30720
    v_mfma_f32_16x16x32_bf16 v[116:119], v[16:19], v[76:79], v[116:119]
    ds_read_b64_tr_b16 v[36:37], v5 offset:28672
    ds_read_b64_tr_b16 v[38:39], v5 offset:30720
    v_mfma_f32_16x16x32_bf16 v[104:107], v[20:23], v[72:75], v[104:107]
    ds_read_b64_tr_b16 v[40:41], v6 offset:28672
    ds_read_b64_tr_b16 v[42:43], v6 offset:30720
    v_mfma_f32_16x16x32_bf16 v[120:123], v[20:23], v[76:79], v[120:123]
    ds_read_b64_tr_b16 v[44:45], v7 offset:28672
    ds_read_b64_tr_b16 v[46:47], v7 offset:30720
    v_mfma_f32_16x16x32_bf16 v[108:111], v[24:27], v[72:75], v[108:111]
    buffer_load_dwordx4 v[64:67], v98, s[16:19], s30 offen offset:0 sc1
    v_mfma_f32_16x16x32_bf16 v[124:127], v[24:27], v[76:79], v[124:127]
    v_mfma_f32_16x16x32_bf16 v[112:115], v[28:31], v[72:75], v[112:115]
    buffer_load_dwordx4 v[68:71], v97, s[16:19], s30 offen offset:0 sc1
    v_mfma_f32_16x16x32_bf16 v[128:131], v[28:31], v[76:79], v[128:131]
    s_waitcnt vmcnt(10) lgkmcnt(0)
    v_mfma_f32_16x16x32_bf16 v[100:103], v[32:35], v[80:83], v[100:103]
    ds_read_b64_tr_b16 v[16:17], v12 offset:16384
    ds_read_b64_tr_b16 v[18:19], v12 offset:18432
    v_mfma_f32_16x16x32_bf16 v[116:119], v[32:35], v[84:87], v[116:119]
    ds_read_b64_tr_b16 v[20:21], v13 offset:16384
    ds_read_b64_tr_b16 v[22:23], v13 offset:18432
    v_mfma_f32_16x16x32_bf16 v[104:107], v[36:39], v[80:83], v[104:107]
    ds_read_b64_tr_b16 v[24:25], v14 offset:16384
    ds_read_b64_tr_b16 v[26:27], v14 offset:18432
    v_mfma_f32_16x16x32_bf16 v[120:123], v[36:39], v[84:87], v[120:123]
    ds_read_b64_tr_b16 v[28:29], v15 offset:16384
    ds_read_b64_tr_b16 v[30:31], v15 offset:18432
    v_mfma_f32_16x16x32_bf16 v[108:111], v[40:43], v[80:83], v[108:111]
    buffer_load_dwordx4 v[72:75], v98, s[16:19], s30 offen offset:1024 sc1
    v_mfma_f32_16x16x32_bf16 v[124:127], v[40:43], v[84:87], v[124:127]
    v_mfma_f32_16x16x32_bf16 v[112:115], v[44:47], v[80:83], v[112:115]
    buffer_load_dwordx4 v[76:79], v97, s[16:19], s30 offen offset:1024 sc1
    v_mfma_f32_16x16x32_bf16 v[128:131], v[44:47], v[84:87], v[128:131]
    s_waitcnt vmcnt(10) lgkmcnt(0)
    v_mfma_f32_16x16x32_bf16 v[100:103], v[16:19], v[88:91], v[100:103]
    ds_read_b64_tr_b16 v[32:33], v12 offset:20480
    ds_read_b64_tr_b16 v[34:35], v12 offset:22528
    v_mfma_f32_16x16x32_bf16 v[116:119], v[16:19], v[92:95], v[116:119]
    ds_read_b64_tr_b16 v[36:37], v13 offset:20480
    ds_read_b64_tr_b16 v[38:39], v13 offset:22528
    v_mfma_f32_16x16x32_bf16 v[104:107], v[20:23], v[88:91], v[104:107]
    ds_read_b64_tr_b16 v[40:41], v14 offset:20480
    ds_read_b64_tr_b16 v[42:43], v14 offset:22528
    v_mfma_f32_16x16x32_bf16 v[120:123], v[20:23], v[92:95], v[120:123]
    ds_read_b64_tr_b16 v[44:45], v15 offset:20480
    ds_read_b64_tr_b16 v[46:47], v15 offset:22528
    v_mfma_f32_16x16x32_bf16 v[108:111], v[24:27], v[88:91], v[108:111]
    buffer_load_dwordx4 v[80:83], v98, s[16:19], s31 offen offset:0 sc1
    v_mfma_f32_16x16x32_bf16 v[124:127], v[24:27], v[92:95], v[124:127]
    v_mfma_f32_16x16x32_bf16 v[112:115], v[28:31], v[88:91], v[112:115]
    buffer_load_dwordx4 v[84:87], v97, s[16:19], s31 offen offset:0 sc1
    v_mfma_f32_16x16x32_bf16 v[128:131], v[28:31], v[92:95], v[128:131]
    s_waitcnt vmcnt(10) lgkmcnt(0)
    v_mfma_f32_16x16x32_bf16 v[100:103], v[32:35], v[132:135], v[100:103]
    ds_read_b64_tr_b16 v[16:17], v8 offset:24576
    ds_read_b64_tr_b16 v[18:19], v8 offset:26624
    v_mfma_f32_16x16x32_bf16 v[116:119], v[32:35], v[136:139], v[116:119]
    ds_read_b64_tr_b16 v[20:21], v9 offset:24576
    ds_read_b64_tr_b16 v[22:23], v9 offset:26624
    v_mfma_f32_16x16x32_bf16 v[104:107], v[36:39], v[132:135], v[104:107]
    ds_read_b64_tr_b16 v[24:25], v10 offset:24576
    ds_read_b64_tr_b16 v[26:27], v10 offset:26624
    v_mfma_f32_16x16x32_bf16 v[120:123], v[36:39], v[136:139], v[120:123]
    ds_read_b64_tr_b16 v[28:29], v11 offset:24576
    ds_read_b64_tr_b16 v[30:31], v11 offset:26624
    v_mfma_f32_16x16x32_bf16 v[108:111], v[40:43], v[132:135], v[108:111]
    buffer_load_dwordx4 v[88:91], v98, s[16:19], s31 offen offset:1024 sc1
    v_mfma_f32_16x16x32_bf16 v[124:127], v[40:43], v[136:139], v[124:127]
    v_mfma_f32_16x16x32_bf16 v[112:115], v[44:47], v[132:135], v[112:115]
    buffer_load_dwordx4 v[92:95], v97, s[16:19], s31 offen offset:1024 sc1
    v_mfma_f32_16x16x32_bf16 v[128:131], v[44:47], v[136:139], v[128:131]
    s_waitcnt vmcnt(10) lgkmcnt(0)
    v_mfma_f32_16x16x32_bf16 v[100:103], v[16:19], v[48:51], v[100:103]
    ds_read_b64_tr_b16 v[32:33], v8 offset:28672
    ds_read_b64_tr_b16 v[34:35], v8 offset:30720
    v_mfma_f32_16x16x32_bf16 v[116:119], v[16:19], v[52:55], v[116:119]
    ds_read_b64_tr_b16 v[36:37], v9 offset:28672
    ds_read_b64_tr_b16 v[38:39], v9 offset:30720
    v_mfma_f32_16x16x32_bf16 v[104:107], v[20:23], v[48:51], v[104:107]
    ds_read_b64_tr_b16 v[40:41], v10 offset:28672
    ds_read_b64_tr_b16 v[42:43], v10 offset:30720
    v_mfma_f32_16x16x32_bf16 v[120:123], v[20:23], v[52:55], v[120:123]
    ds_read_b64_tr_b16 v[44:45], v11 offset:28672
    ds_read_b64_tr_b16 v[46:47], v11 offset:30720
    v_mfma_f32_16x16x32_bf16 v[108:111], v[24:27], v[48:51], v[108:111]
    buffer_load_dwordx4 v[132:135], v98, s[16:19], s32 offen offset:0 sc1
    v_mfma_f32_16x16x32_bf16 v[124:127], v[24:27], v[52:55], v[124:127]
    v_mfma_f32_16x16x32_bf16 v[112:115], v[28:31], v[48:51], v[112:115]
    buffer_load_dwordx4 v[136:139], v97, s[16:19], s32 offen offset:0 sc1
    v_mfma_f32_16x16x32_bf16 v[128:131], v[28:31], v[52:55], v[128:131]
    s_waitcnt vmcnt(10) lgkmcnt(0)
    v_mfma_f32_16x16x32_bf16 v[100:103], v[32:35], v[56:59], v[100:103]
    ds_read_b64_tr_b16 v[16:17], v4 offset:49152
    ds_read_b64_tr_b16 v[18:19], v4 offset:51200
    v_mfma_f32_16x16x32_bf16 v[116:119], v[32:35], v[60:63], v[116:119]
    ds_read_b64_tr_b16 v[20:21], v5 offset:49152
    ds_read_b64_tr_b16 v[22:23], v5 offset:51200
    v_mfma_f32_16x16x32_bf16 v[104:107], v[36:39], v[56:59], v[104:107]
    ds_read_b64_tr_b16 v[24:25], v6 offset:49152
    ds_read_b64_tr_b16 v[26:27], v6 offset:51200
    v_mfma_f32_16x16x32_bf16 v[120:123], v[36:39], v[60:63], v[120:123]
    ds_read_b64_tr_b16 v[28:29], v7 offset:49152
    ds_read_b64_tr_b16 v[30:31], v7 offset:51200
    v_mfma_f32_16x16x32_bf16 v[108:111], v[40:43], v[56:59], v[108:111]
    buffer_load_dwordx4 v[48:51], v98, s[16:19], s32 offen offset:1024 sc1
    v_mfma_f32_16x16x32_bf16 v[124:127], v[40:43], v[60:63], v[124:127]
    v_mfma_f32_16x16x32_bf16 v[112:115], v[44:47], v[56:59], v[112:115]
    buffer_load_dwordx4 v[52:55], v97, s[16:19], s32 offen offset:1024 sc1
    v_mfma_f32_16x16x32_bf16 v[128:131], v[44:47], v[60:63], v[128:131]
    s_waitcnt vmcnt(10) lgkmcnt(0)
    v_mfma_f32_16x16x32_bf16 v[100:103], v[16:19], v[64:67], v[100:103]
    ds_read_b64_tr_b16 v[32:33], v4 offset:53248
    ds_read_b64_tr_b16 v[34:35], v4 offset:55296
    v_mfma_f32_16x16x32_bf16 v[116:119], v[16:19], v[68:71], v[116:119]
    ds_read_b64_tr_b16 v[36:37], v5 offset:53248
    ds_read_b64_tr_b16 v[38:39], v5 offset:55296
    v_mfma_f32_16x16x32_bf16 v[104:107], v[20:23], v[64:67], v[104:107]
    ds_read_b64_tr_b16 v[40:41], v6 offset:53248
    ds_read_b64_tr_b16 v[42:43], v6 offset:55296
    v_mfma_f32_16x16x32_bf16 v[120:123], v[20:23], v[68:71], v[120:123]
    ds_read_b64_tr_b16 v[44:45], v7 offset:53248
    ds_read_b64_tr_b16 v[46:47], v7 offset:55296
    v_mfma_f32_16x16x32_bf16 v[108:111], v[24:27], v[64:67], v[108:111]
    s_branch IW_s7
IW_w7:
    s_branch IW_r7
IW_s7:
    buffer_load_dwordx4 v[56:59], v98, s[16:19], s33 offen offset:0 sc1
    v_mfma_f32_16x16x32_bf16 v[124:127], v[24:27], v[68:71], v[124:127]
    v_mfma_f32_16x16x32_bf16 v[112:115], v[28:31], v[64:67], v[112:115]
    buffer_load_dwordx4 v[60:63], v97, s[16:19], s33 offen offset:0 sc1
    v_mfma_f32_16x16x32_bf16 v[128:131], v[28:31], v[68:71], v[128:131]
    s_waitcnt vmcnt(10) lgkmcnt(0)
    v_mfma_f32_16x16x32_bf16 v[100:103], v[32:35], v[72:75], v[100:103]
    ds_read_b64_tr_b16 v[16:17], v8 offset:0
    ds_read_b64_tr_b16 v[18:19], v8 offset:2048
    v_mfma_f32_16x16x32_bf16 v[116:119], v[32:35], v[76:79], v[116:119]
    ds_read_b64_tr_b16 v[20:21], v9 offset:0
    ds_read_b64_tr_b16 v[22:23], v9 offset:2048
    v_mfma_f32_16x16x32_bf16 v[104:107], v[36:39], v[72:75], v[104:107]
    ds_read_b64_tr_b16 v[24:25], v10 offset:0
    ds_read_b64_tr_b16 v[26:27], v10 offset:2048
    v_mfma_f32_16x16x32_bf16 v[120:123], v[36:39], v[76:79], v[120:123]
    ds_read_b64_tr_b16 v[28:29], v11 offset:0
    ds_read_b64_tr_b16 v[30:31], v11 offset:2048
    v_mfma_f32_16x16x32_bf16 v[108:111], v[40:43], v[72:75], v[108:111]
    buffer_load_dwordx4 v[64:67], v98, s[16:19], s33 offen offset:1024 sc1
    v_mfma_f32_16x16x32_bf16 v[124:127], v[40:43], v[76:79], v[124:127]
    v_mfma_f32_16x16x32_bf16 v[112:115], v[44:47], v[72:75], v[112:115]
    buffer_load_dwordx4 v[68:71], v97, s[16:19], s33 offen offset:1024 sc1
    v_mfma_f32_16x16x32_bf16 v[128:131], v[44:47], v[76:79], v[128:131]
    s_waitcnt vmcnt(10) lgkmcnt(0)
    v_mfma_f32_16x16x32_bf16 v[100:103], v[16:19], v[80:83], v[100:103]
    ds_read_b64_tr_b16 v[32:33], v8 offset:4096
    ds_read_b64_tr_b16 v[34:35], v8 offset:6144
    v_mfma_f32_16x16x32_bf16 v[116:119], v[16:19], v[84:87], v[116:119]
    ds_read_b64_tr_b16 v[36:37], v9 offset:4096
    ds_read_b64_tr_b16 v[38:39], v9 offset:6144
    v_mfma_f32_16x16x32_bf16 v[104:107], v[20:23], v[80:83], v[104:107]
    ds_read_b64_tr_b16 v[40:41], v10 offset:4096
    ds_read_b64_tr_b16 v[42:43], v10 offset:6144
    v_mfma_f32_16x16x32_bf16 v[120:123], v[20:23], v[84:87], v[120:123]
    ds_read_b64_tr_b16 v[44:45], v11 offset:4096
    ds_read_b64_tr_b16 v[46:47], v11 offset:6144
    v_mfma_f32_16x16x32_bf16 v[108:111], v[24:27], v[80:83], v[108:111]
    buffer_load_dwordx4 v[72:75], v98, s[16:19], s34 offen offset:0 sc1
    v_mfma_f32_16x16x32_bf16 v[124:127], v[24:27], v[84:87], v[124:127]
    v_mfma_f32_16x16x32_bf16 v[112:115], v[28:31], v[80:83], v[112:115]
    buffer_load_dwordx4 v[76:79], v97, s[16:19], s34 offen offset:0 sc1
    v_mfma_f32_16x16x32_bf16 v[128:131], v[28:31], v[84:87], v[128:131]
    s_waitcnt vmcnt(10) lgkmcnt(0)
    v_mfma_f32_16x16x32_bf16 v[100:103], v[32:35], v[88:91], v[100:103]
    ds_read_b64_tr_b16 v[16:17], v8 offset:16384
    ds_read_b64_tr_b16 v[18:19], v8 offset:18432
    v_mfma_f32_16x16x32_bf16 v[116:119], v[32:35], v[92:95], v[116:119]
    ds_read_b64_tr_b16 v[20:21], v9 offset:16384
    ds_read_b64_tr_b16 v[22:23], v9 offset:18432
    v_mfma_f32_16x16x32_bf16 v[104:107], v[36:39], v[88:91], v[104:107]
    ds_read_b64_tr_b16 v[24:25], v10 offset:16384
    ds_read_b64_tr_b16 v[26:27], v10 offset:18432
    v_mfma_f32_16x16x32_bf16 v[120:123], v[36:39], v[92:95], v[120:123]
    ds_read_b64_tr_b16 v[28:29], v11 offset:16384
    ds_read_b64_tr_b16 v[30:31], v11 offset:18432
    v_mfma_f32_16x16x32_bf16 v[108:111], v[40:43], v[88:91], v[108:111]
    buffer_load_dwordx4 v[80:83], v98, s[16:19], s34 offen offset:1024 sc1
    v_mfma_f32_16x16x32_bf16 v[124:127], v[40:43], v[92:95], v[124:127]
    v_mfma_f32_16x16x32_bf16 v[112:115], v[44:47], v[88:91], v[112:115]
    buffer_load_dwordx4 v[84:87], v97, s[16:19], s34 offen offset:1024 sc1
    v_mfma_f32_16x16x32_bf16 v[128:131], v[44:47], v[92:95], v[128:131]
    s_waitcnt vmcnt(10) lgkmcnt(0)
    v_mfma_f32_16x16x32_bf16 v[100:103], v[16:19], v[132:135], v[100:103]
    ds_read_b64_tr_b16 v[32:33], v8 offset:20480
    ds_read_b64_tr_b16 v[34:35], v8 offset:22528
    v_mfma_f32_16x16x32_bf16 v[116:119], v[16:19], v[136:139], v[116:119]
    ds_read_b64_tr_b16 v[36:37], v9 offset:20480
    ds_read_b64_tr_b16 v[38:39], v9 offset:22528
    v_mfma_f32_16x16x32_bf16 v[104:107], v[20:23], v[132:135], v[104:107]
    ds_read_b64_tr_b16 v[40:41], v10 offset:20480
    ds_read_b64_tr_b16 v[42:43], v10 offset:22528
    v_mfma_f32_16x16x32_bf16 v[120:123], v[20:23], v[136:139], v[120:123]
    ds_read_b64_tr_b16 v[44:45], v11 offset:20480
    ds_read_b64_tr_b16 v[46:47], v11 offset:22528
    v_mfma_f32_16x16x32_bf16 v[108:111], v[24:27], v[132:135], v[108:111]
    buffer_load_dwordx4 v[88:91], v98, s[16:19], s35 offen offset:0 sc1
    v_mfma_f32_16x16x32_bf16 v[124:127], v[24:27], v[136:139], v[124:127]
    v_mfma_f32_16x16x32_bf16 v[112:115], v[28:31], v[132:135], v[112:115]
    buffer_load_dwordx4 v[92:95], v97, s[16:19], s35 offen offset:0 sc1
    v_mfma_f32_16x16x32_bf16 v[128:131], v[28:31], v[136:139], v[128:131]
    s_waitcnt vmcnt(10) lgkmcnt(0)
    v_mfma_f32_16x16x32_bf16 v[100:103], v[32:35], v[48:51], v[100:103]
    ds_read_b64_tr_b16 v[16:17], v8 offset:40960
    ds_read_b64_tr_b16 v[18:19], v8 offset:43008
    v_mfma_f32_16x16x32_bf16 v[116:119], v[32:35], v[52:55], v[116:119]
    ds_read_b64_tr_b16 v[20:21], v9 offset:40960
    ds_read_b64_tr_b16 v[22:23], v9 offset:43008
    v_mfma_f32_16x16x32_bf16 v[104:107], v[36:39], v[48:51], v[104:107]
    ds_read_b64_tr_b16 v[24:25], v10 offset:40960
    ds_read_b64_tr_b16 v[26:27], v10 offset:43008
    v_mfma_f32_16x16x32_bf16 v[120:123], v[36:39], v[52:55], v[120:123]
    ds_read_b64_tr_b16 v[28:29], v11 offset:40960
    ds_read_b64_tr_b16 v[30:31], v11 offset:43008
    v_mfma_f32_16x16x32_bf16 v[108:111], v[40:43], v[48:51], v[108:111]
    buffer_load_dwordx4 v[132:135], v98, s[16:19], s35 offen offset:1024 sc1
    v_mfma_f32_16x16x32_bf16 v[124:127], v[40:43], v[52:55], v[124:127]
    v_mfma_f32_16x16x32_bf16 v[112:115], v[44:47], v[48:51], v[112:115]
    buffer_load_dwordx4 v[136:139], v97, s[16:19], s35 offen offset:1024 sc1
    v_mfma_f32_16x16x32_bf16 v[128:131], v[44:47], v[52:55], v[128:131]
    s_waitcnt vmcnt(10) lgkmcnt(0)
    v_mfma_f32_16x16x32_bf16 v[100:103], v[16:19], v[56:59], v[100:103]
    ds_read_b64_tr_b16 v[32:33], v8 offset:45056
    ds_read_b64_tr_b16 v[34:35], v8 offset:47104
    v_mfma_f32_16x16x32_bf16 v[116:119], v[16:19], v[60:63], v[116:119]
    ds_read_b64_tr_b16 v[36:37], v9 offset:45056
    ds_read_b64_tr_b16 v[38:39], v9 offset:47104
    v_mfma_f32_16x16x32_bf16 v[104:107], v[20:23], v[56:59], v[104:107]
    ds_read_b64_tr_b16 v[40:41], v10 offset:45056
    ds_read_b64_tr_b16 v[42:43], v10 offset:47104
    v_mfma_f32_16x16x32_bf16 v[120:123], v[20:23], v[60:63], v[120:123]
    ds_read_b64_tr_b16 v[44:45], v11 offset:45056
    ds_read_b64_tr_b16 v[46:47], v11 offset:47104
    v_mfma_f32_16x16x32_bf16 v[108:111], v[24:27], v[56:59], v[108:111]
    buffer_load_dwordx4 v[48:51], v98, s[16:19], s36 offen offset:0 sc1
    v_mfma_f32_16x16x32_bf16 v[124:127], v[24:27], v[60:63], v[124:127]
    v_mfma_f32_16x16x32_bf16 v[112:115], v[28:31], v[56:59], v[112:115]
    buffer_load_dwordx4 v[52:55], v97, s[16:19], s36 offen offset:0 sc1
    v_mfma_f32_16x16x32_bf16 v[128:131], v[28:31], v[60:63], v[128:131]
    s_waitcnt vmcnt(10) lgkmcnt(0)
    v_mfma_f32_16x16x32_bf16 v[100:103], v[32:35], v[64:67], v[100:103]
    ds_read_b64_tr_b16 v[16:17], v8 offset:32768
    ds_read_b64_tr_b16 v[18:19], v8 offset:34816
    v_mfma_f32_16x16x32_bf16 v[116:119], v[32:35], v[68:71], v[116:119]
    ds_read_b64_tr_b16 v[20:21], v9 offset:32768
    ds_read_b64_tr_b16 v[22:23], v9 offset:34816
    v_mfma_f32_16x16x32_bf16 v[104:107], v[36:39], v[64:67], v[104:107]
    ds_read_b64_tr_b16 v[24:25], v10 offset:32768
    ds_read_b64_tr_b16 v[26:27], v10 offset:34816
    v_mfma_f32_16x16x32_bf16 v[120:123], v[36:39], v[68:71], v[120:123]
    ds_read_b64_tr_b16 v[28:29], v11 offset:32768
    ds_read_b64_tr_b16 v[30:31], v11 offset:34816
    v_mfma_f32_16x16x32_bf16 v[108:111], v[40:43], v[64:67], v[108:111]
    buffer_load_dwordx4 v[56:59], v98, s[16:19], s36 offen offset:1024 sc1
    v_mfma_f32_16x16x32_bf16 v[124:127], v[40:43], v[68:71], v[124:127]
    v_mfma_f32_16x16x32_bf16 v[112:115], v[44:47], v[64:67], v[112:115]
    buffer_load_dwordx4 v[60:63], v97, s[16:19], s36 offen offset:1024 sc1
    v_mfma_f32_16x16x32_bf16 v[128:131], v[44:47], v[68:71], v[128:131]
    s_waitcnt vmcnt(10) lgkmcnt(0)
    v_mfma_f32_16x16x32_bf16 v[100:103], v[16:19], v[72:75], v[100:103]
    ds_read_b64_tr_b16 v[32:33], v8 offset:36864
    ds_read_b64_tr_b16 v[34:35], v8 offset:38912
    v_mfma_f32_16x16x32_bf16 v[116:119], v[16:19], v[76:79], v[116:119]
    ds_read_b64_tr_b16 v[36:37], v9 offset:36864
    ds_read_b64_tr_b16 v[38:39], v9 offset:38912
    v_mfma_f32_16x16x32_bf16 v[104:107], v[20:23], v[72:75], v[104:107]
    ds_read_b64_tr_b16 v[40:41], v10 offset:36864
    ds_read_b64_tr_b16 v[42:43], v10 offset:38912
    v_mfma_f32_16x16x32_bf16 v[120:123], v[20:23], v[76:79], v[120:123]
    ds_read_b64_tr_b16 v[44:45], v11 offset:36864
    ds_read_b64_tr_b16 v[46:47], v11 offset:38912
    v_mfma_f32_16x16x32_bf16 v[108:111], v[24:27], v[72:75], v[108:111]
    buffer_load_dwordx4 v[64:67], v98, s[16:19], s37 offen offset:0 sc1
    v_mfma_f32_16x16x32_bf16 v[124:127], v[24:27], v[76:79], v[124:127]
    v_mfma_f32_16x16x32_bf16 v[112:115], v[28:31], v[72:75], v[112:115]
    buffer_load_dwordx4 v[68:71], v97, s[16:19], s37 offen offset:0 sc1
    v_mfma_f32_16x16x32_bf16 v[128:131], v[28:31], v[76:79], v[128:131]
    s_waitcnt vmcnt(10) lgkmcnt(0)
    v_mfma_f32_16x16x32_bf16 v[100:103], v[32:35], v[80:83], v[100:103]
    ds_read_b64_tr_b16 v[16:17], v12 offset:0
    ds_read_b64_tr_b16 v[18:19], v12 offset:2048
    v_mfma_f32_16x16x32_bf16 v[116:119], v[32:35], v[84:87], v[116:119]
    ds_read_b64_tr_b16 v[20:21], v13 offset:0
    ds_read_b64_tr_b16 v[22:23], v13 offset:2048
    v_mfma_f32_16x16x32_bf16 v[104:107], v[36:39], v[80:83], v[104:107]
    ds_read_b64_tr_b16 v[24:25], v14 offset:0
    ds_read_b64_tr_b16 v[26:27], v14 offset:2048
    v_mfma_f32_16x16x32_bf16 v[120:123], v[36:39], v[84:87], v[120:123]
    ds_read_b64_tr_b16 v[28:29], v15 offset:0
    ds_read_b64_tr_b16 v[30:31], v15 offset:2048
    v_mfma_f32_16x16x32_bf16 v[108:111], v[40:43], v[80:83], v[108:111]
    buffer_load_dwordx4 v[72:75], v98, s[16:19], s37 offen offset:1024 sc1
    v_mfma_f32_16x16x32_bf16 v[124:127], v[40:43], v[84:87], v[124:127]
    v_mfma_f32_16x16x32_bf16 v[112:115], v[44:47], v[80:83], v[112:115]
    buffer_load_dwordx4 v[76:79], v97, s[16:19], s37 offen offset:1024 sc1
    v_mfma_f32_16x16x32_bf16 v[128:131], v[44:47], v[84:87], v[128:131]
    s_waitcnt vmcnt(10) lgkmcnt(0)
    v_mfma_f32_16x16x32_bf16 v[100:103], v[16:19], v[88:91], v[100:103]
    ds_read_b64_tr_b16 v[32:33], v12 offset:4096
    ds_read_b64_tr_b16 v[34:35], v12 offset:6144
    v_mfma_f32_16x16x32_bf16 v[116:119], v[16:19], v[92:95], v[116:119]
    ds_read_b64_tr_b16 v[36:37], v13 offset:4096
    ds_read_b64_tr_b16 v[38:39], v13 offset:6144
    v_mfma_f32_16x16x32_bf16 v[104:107], v[20:23], v[88:91], v[104:107]
    ds_read_b64_tr_b16 v[40:41], v14 offset:4096
    ds_read_b64_tr_b16 v[42:43], v14 offset:6144
    v_mfma_f32_16x16x32_bf16 v[120:123], v[20:23], v[92:95], v[120:123]
    ds_read_b64_tr_b16 v[44:45], v15 offset:4096
    ds_read_b64_tr_b16 v[46:47], v15 offset:6144
    v_mfma_f32_16x16x32_bf16 v[108:111], v[24:27], v[88:91], v[108:111]
    v_mfma_f32_16x16x32_bf16 v[124:127], v[24:27], v[92:95], v[124:127]
    v_mfma_f32_16x16x32_bf16 v[112:115], v[28:31], v[88:91], v[112:115]
    v_mfma_f32_16x16x32_bf16 v[128:131], v[28:31], v[92:95], v[128:131]
    s_waitcnt vmcnt(8) lgkmcnt(0)
    v_mfma_f32_16x16x32_bf16 v[100:103], v[32:35], v[132:135], v[100:103]
    ds_read_b64_tr_b16 v[16:17], v8 offset:49152
    ds_read_b64_tr_b16 v[18:19], v8 offset:51200
    v_mfma_f32_16x16x32_bf16 v[116:119], v[32:35], v[136:139], v[116:119]
    ds_read_b64_tr_b16 v[20:21], v9 offset:49152
    ds_read_b64_tr_b16 v[22:23], v9 offset:51200
    v_mfma_f32_16x16x32_bf16 v[104:107], v[36:39], v[132:135], v[104:107]
    ds_read_b64_tr_b16 v[24:25], v10 offset:49152
    ds_read_b64_tr_b16 v[26:27], v10 offset:51200
    v_mfma_f32_16x16x32_bf16 v[120:123], v[36:39], v[136:139], v[120:123]
    ds_read_b64_tr_b16 v[28:29], v11 offset:49152
    ds_read_b64_tr_b16 v[30:31], v11 offset:51200
    v_mfma_f32_16x16x32_bf16 v[108:111], v[40:43], v[132:135], v[108:111]
    v_mfma_f32_16x16x32_bf16 v[124:127], v[40:43], v[136:139], v[124:127]
    v_mfma_f32_16x16x32_bf16 v[112:115], v[44:47], v[132:135], v[112:115]
    v_mfma_f32_16x16x32_bf16 v[128:131], v[44:47], v[136:139], v[128:131]
    s_waitcnt vmcnt(6) lgkmcnt(0)
    v_mfma_f32_16x16x32_bf16 v[100:103], v[16:19], v[48:51], v[100:103]
    ds_read_b64_tr_b16 v[32:33], v8 offset:53248
    ds_read_b64_tr_b16 v[34:35], v8 offset:55296
    v_mfma_f32_16x16x32_bf16 v[116:119], v[16:19], v[52:55], v[116:119]
    ds_read_b64_tr_b16 v[36:37], v9 offset:53248
    ds_read_b64_tr_b16 v[38:39], v9 offset:55296
    v_mfma_f32_16x16x32_bf16 v[104:107], v[20:23], v[48:51], v[104:107]
    ds_read_b64_tr_b16 v[40:41], v10 offset:53248
    ds_read_b64_tr_b16 v[42:43], v10 offset:55296
    v_mfma_f32_16x16x32_bf16 v[120:123], v[20:23], v[52:55], v[120:123]
    ds_read_b64_tr_b16 v[44:45], v11 offset:53248
    ds_read_b64_tr_b16 v[46:47], v11 offset:55296
    v_mfma_f32_16x16x32_bf16 v[108:111], v[24:27], v[48:51], v[108:111]
    v_mfma_f32_16x16x32_bf16 v[124:127], v[24:27], v[52:55], v[124:127]
    v_mfma_f32_16x16x32_bf16 v[112:115], v[28:31], v[48:51], v[112:115]
    v_mfma_f32_16x16x32_bf16 v[128:131], v[28:31], v[52:55], v[128:131]
    s_waitcnt vmcnt(4) lgkmcnt(0)
    v_mfma_f32_16x16x32_bf16 v[100:103], v[32:35], v[56:59], v[100:103]
    ds_read_b64_tr_b16 v[16:17], v12 offset:8192
    ds_read_b64_tr_b16 v[18:19], v12 offset:10240
    v_mfma_f32_16x16x32_bf16 v[116:119], v[32:35], v[60:63], v[116:119]
    ds_read_b64_tr_b16 v[20:21], v13 offset:8192
    ds_read_b64_tr_b16 v[22:23], v13 offset:10240
    v_mfma_f32_16x16x32_bf16 v[104:107], v[36:39], v[56:59], v[104:107]
    ds_read_b64_tr_b16 v[24:25], v14 offset:8192
    ds_read_b64_tr_b16 v[26:27], v14 offset:10240
    v_mfma_f32_16x16x32_bf16 v[120:123], v[36:39], v[60:63], v[120:123]
    ds_read_b64_tr_b16 v[28:29], v15 offset:8192
    ds_read_b64_tr_b16 v[30:31], v15 offset:10240
    v_mfma_f32_16x16x32_bf16 v[108:111], v[40:43], v[56:59], v[108:111]
    v_mfma_f32_16x16x32_bf16 v[124:127], v[40:43], v[60:63], v[124:127]
    v_mfma_f32_16x16x32_bf16 v[112:115], v[44:47], v[56:59], v[112:115]
    v_mfma_f32_16x16x32_bf16 v[128:131], v[44:47], v[60:63], v[128:131]
    s_waitcnt vmcnt(2) lgkmcnt(0)
    v_mfma_f32_16x16x32_bf16 v[100:103], v[16:19], v[64:67], v[100:103]
    ds_read_b64_tr_b16 v[32:33], v12 offset:12288
    ds_read_b64_tr_b16 v[34:35], v12 offset:14336
    v_mfma_f32_16x16x32_bf16 v[116:119], v[16:19], v[68:71], v[116:119]
    ds_read_b64_tr_b16 v[36:37], v13 offset:12288
    ds_read_b64_tr_b16 v[38:39], v13 offset:14336
    v_mfma_f32_16x16x32_bf16 v[104:107], v[20:23], v[64:67], v[104:107]
    ds_read_b64_tr_b16 v[40:41], v14 offset:12288
    ds_read_b64_tr_b16 v[42:43], v14 offset:14336
    v_mfma_f32_16x16x32_bf16 v[120:123], v[20:23], v[68:71], v[120:123]
    ds_read_b64_tr_b16 v[44:45], v15 offset:12288
    ds_read_b64_tr_b16 v[46:47], v15 offset:14336
    v_mfma_f32_16x16x32_bf16 v[108:111], v[24:27], v[64:67], v[108:111]
    v_mfma_f32_16x16x32_bf16 v[124:127], v[24:27], v[68:71], v[124:127]
    v_mfma_f32_16x16x32_bf16 v[112:115], v[28:31], v[64:67], v[112:115]
    v_mfma_f32_16x16x32_bf16 v[128:131], v[28:31], v[68:71], v[128:131]
    s_waitcnt vmcnt(0) lgkmcnt(0)
    s_cmp_eq_u64 s[60:61], 0
    s_cbranch_scc1 F_y0
    ds_read_b32 v160, v161
    ds_read_b128 v[48:51], v162 offset:0
    ds_read_b128 v[52:55], v162 offset:64
    ds_read_b128 v[56:59], v162 offset:128
    ds_read_b128 v[60:63], v162 offset:192
    ds_read_b128 v[64:67], v163 offset:0
    ds_read_b128 v[68:71], v163 offset:64
    ds_read_b128 v[80:83], v163 offset:128
    ds_read_b128 v[84:87], v163 offset:192
F_y0:
    v_mfma_f32_16x16x32_bf16 v[100:103], v[32:35], v[72:75], v[100:103]
    v_mfma_f32_16x16x32_bf16 v[104:107], v[36:39], v[72:75], v[104:107]
    v_mfma_f32_16x16x32_bf16 v[108:111], v[40:43], v[72:75], v[108:111]
    v_mfma_f32_16x16x32_bf16 v[112:115], v[44:47], v[72:75], v[112:115]
    v_mfma_f32_16x16x32_bf16 v[116:119], v[32:35], v[76:79], v[116:119]
    v_mfma_f32_16x16x32_bf16 v[120:123], v[36:39], v[76:79], v[120:123]
    v_mfma_f32_16x16x32_bf16 v[124:127], v[40:43], v[76:79], v[124:127]
    v_mfma_f32_16x16x32_bf16 v[128:131], v[44:47], v[76:79], v[128:131]
    s_cmp_eq_u64 s[60:61], 0
    s_cbranch_scc1 F_fin
F_y1:
    s_waitcnt lgkmcnt(0)
    v_cmp_eq_u32 vcc, 0, v160
    s_cbranch_vccz F_y2
    ds_read_b32 v160, v161
    ds_read_b128 v[48:51], v162 offset:0
    ds_read_b128 v[52:55], v162 offset:64
    ds_read_b128 v[56:59], v162 offset:128
    ds_read_b128 v[60:63], v162 offset:192
    ds_read_b128 v[64:67], v163 offset:0
    ds_read_b128 v[68:71], v163 offset:64
    ds_read_b128 v[80:83], v163 offset:128
    ds_read_b128 v[84:87], v163 offset:192
    s_branch F_y1
F_y2:
    s_nop 4
    s_mov_b64 exec, s[74:75]
    s_cbranch_execz F_rb_75
    v_fmac_f32 v100, v48, v164
    v_fmac_f32 v101, v49, v164
    v_fmac_f32 v102, v50, v164
    v_fmac_f32 v103, v51, v164
    v_fmac_f32 v104, v52, v164
    v_fmac_f32 v105, v53, v164
    v_fmac_f32 v106, v54, v164
    v_fmac_f32 v107, v55, v164
    v_fmac_f32 v108, v56, v164
    v_fmac_f32 v109, v57, v164
    v_fmac_f32 v110, v58, v164
    v_fmac_f32 v111, v59, v164
    v_fmac_f32 v112, v60, v164
    v_fmac_f32 v113, v61, v164
    v_fmac_f32 v114, v62, v164
    v_fmac_f32 v115, v63, v164
F_rb_75:
    s_mov_b64 exec, s[76:77]
    s_cbranch_execz F_rb_76
    v_fmac_f32 v116, v64, v165
    v_fmac_f32 v117, v65, v165
    v_fmac_f32 v118, v66, v165
    v_fmac_f32 v119, v67, v165
    v_fmac_f32 v120, v68, v165
    v_fmac_f32 v121, v69, v165
    v_fmac_f32 v122, v70, v165
    v_fmac_f32 v123, v71, v165
    v_fmac_f32 v124, v80, v165
    v_fmac_f32 v125, v81, v165
    v_fmac_f32 v126, v82, v165
    v_fmac_f32 v127, v83, v165
    v_fmac_f32 v128, v84, v165
    v_fmac_f32 v129, v85, v165
    v_fmac_f32 v130, v86, v165
    v_fmac_f32 v131, v87, v165
F_rb_76:
    s_mov_b64 exec, -1
F_fin:
    v_cvt_pk_bf16_f32 v16, v100, v101
    v_cvt_pk_bf16_f32 v17, v102, v103
    v_cvt_pk_bf16_f32 v18, v104, v105
    v_cvt_pk_bf16_f32 v19, v106, v107
    v_cvt_pk_bf16_f32 v20, v108, v109
    v_cvt_pk_bf16_f32 v21, v110, v111
    v_cvt_pk_bf16_f32 v22, v112, v113
    v_cvt_pk_bf16_f32 v23, v114, v115
    v_permlane16_swap_b32 v16, v18
    v_permlane16_swap_b32 v17, v19
    v_permlane16_swap_b32 v20, v22
    v_permlane16_swap_b32 v21, v23
    v_mov_b32 v4, v16
    v_mov_b32 v5, v17
    v_mov_b32 v6, v18
    v_mov_b32 v7, v19
    v_mov_b32_dpp v16, v20 row_ror:8 row_mask:0xf bank_mask:0xc
    v_mov_b32_dpp v17, v21 row_ror:8 row_mask:0xf bank_mask:0xc
    v_mov_b32_dpp v18, v22 row_ror:8 row_mask:0xf bank_mask:0xc
    v_mov_b32_dpp v19, v23 row_ror:8 row_mask:0xf bank_mask:0xc
    v_mov_b32_dpp v20, v4 row_ror:8 row_mask:0xf bank_mask:0x3
    v_mov_b32_dpp v21, v5 row_ror:8 row_mask:0xf bank_mask:0x3
    v_mov_b32_dpp v22, v6 row_ror:8 row_mask:0xf bank_mask:0x3
    v_mov_b32_dpp v23, v7 row_ror:8 row_mask:0xf bank_mask:0x3
    s_add_u32 s44, s42, 0x4000
    buffer_store_dwordx4 v[16:19], v1, s[12:15], s42 offen sc1
    buffer_store_dwordx4 v[20:23], v1, s[12:15], s44 offen sc1
    v_cvt_pk_bf16_f32 v24, v116, v117
    v_cvt_pk_bf16_f32 v25, v118, v119
    v_cvt_pk_bf16_f32 v26, v120, v121
    v_cvt_pk_bf16_f32 v27, v122, v123
    v_cvt_pk_bf16_f32 v28, v124, v125
    v_cvt_pk_bf16_f32 v29, v126, v127
    v_cvt_pk_bf16_f32 v30, v128, v129
    v_cvt_pk_bf16_f32 v31, v130, v131
    v_permlane16_swap_b32 v24, v26
    v_permlane16_swap_b32 v25, v27
    v_permlane16_swap_b32 v28, v30
    v_permlane16_swap_b32 v29, v31
    v_mov_b32 v4, v24
    v_mov_b32 v5, v25
    v_mov_b32 v6, v26
    v_mov_b32 v7, v27
    v_mov_b32_dpp v24, v28 row_ror:8 row_mask:0xf bank_mask:0xc
    v_mov_b32_dpp v25, v29 row_ror:8 row_mask:0xf bank_mask:0xc
    v_mov_b32_dpp v26, v30 row_ror:8 row_mask:0xf bank_mask:0xc
    v_mov_b32_dpp v27, v31 row_ror:8 row_mask:0xf bank_mask:0xc
    v_mov_b32_dpp v28, v4 row_ror:8 row_mask:0xf bank_mask:0x3
    v_mov_b32_dpp v29, v5 row_ror:8 row_mask:0xf bank_mask:0x3
    v_mov_b32_dpp v30, v6 row_ror:8 row_mask:0xf bank_mask:0x3
    v_mov_b32_dpp v31, v7 row_ror:8 row_mask:0xf bank_mask:0x3
    s_add_u32 s44, s43, 0x4000
    buffer_store_dwordx4 v[24:27], v1, s[12:15], s43 offen sc1
    buffer_store_dwordx4 v[28:31], v1, s[12:15], s44 offen sc1
    s_endpgm
F_aux:
    s_setprio 3
    s_sub_u32 s3, s3, 8
    s_mov_b32 s88, s3
    v_lshrrev_b32 v5, 4, v0
    s_cmp_eq_u32 s3, 1
    s_mov_b32 s45, 73728
    s_cselect_b32 s45, 65536, s45
    s_cmp_eq_u32 s3, 2
    s_cselect_b32 s45, 147456, s45
    v_bfe_u32 v60, v0, 2, 2
    v_lshl_add_u32 v62, v5, 3, v60
    v_lshrrev_b32 v60, 1, v60
    v_and_b32 v63, 1, v5
    v_lshl_add_u32 v60, v63, 1, v60
    v_lshlrev_b32 v60, 5, v60
    v_lshl_add_u32 v60, v62, 7, v60
    v_and_b32 v63, 3, v0
    v_lshl_add_u32 v60, v63, 3, v60
    v_add_u32 v62, s45, v60
    v_xor_b32 v63, 32, v62
    v_xor_b32 v64, 64, v62
    v_xor_b32 v65, 96, v62
    v_lshlrev_b32 v2, 4, v0
    v_lshlrev_b32 v3, 2, v0
    v_and_b32 v7, 15, v0
    v_and_b32 v8, 7, v0
    v_lshlrev_b32 v8, 4, v8
    v_lshl_add_u32 v8, v5, 7, v8
    v_bfe_u32 v9, v0, 3, 1
    v_lshl_add_u32 v4, v9, 11, v8
    v_and_b32 v9, 1, v0
    v_lshlrev_b32 v59, 2, v7
    s_lshl_b32 s76, s32, 4
    s_add_u32 s76, s76, s33
    s_lshl_b32 s77, s76, 3
    s_lshl_b32 s44, s3, 1
    s_add_u32 s77, s77, s44
    v_mov_b32 v12, 0
    v_mov_b32 v13, 0
    v_mov_b32 v14, 0
    v_mov_b32 v15, 0
    s_lshl_b32 s75, s3, 4
    s_add_u32 s75, s75, s33
    s_lshl_b32 s44, s3, 2
    s_add_u32 s44, s44, 159040
    v_mov_b32 v10, s44

    v_mov_b32 v32, 0x3f803f80
    v_mov_b32 v33, 0x3f803f80
    v_mov_b32 v34, 0x3f803f80
    v_mov_b32 v35, 0x3f803f80
    v_mov_b32 v36, 0x3f803f80
    v_mov_b32 v37, 0x3f803f80
    v_mov_b32 v38, 0x3f803f80
    v_mov_b32 v39, 0x3f803f80
    v_mov_b32 v40, 0x3f803f80
    v_mov_b32 v41, 0x3f803f80
    v_mov_b32 v42, 0x3f803f80
    v_mov_b32 v43, 0x3f803f80
    v_mov_b32 v44, 0x3f803f80
    v_mov_b32 v45, 0x3f803f80
    v_mov_b32 v46, 0x3f803f80
    v_mov_b32 v47, 0x3f803f80
    s_waitcnt lgkmcnt(0)
    s_mov_b32 s20, s4
    s_mov_b32 s21, s5
    s_mov_b32 s22, 0x400000
    s_mov_b32 s23, 0x00020000
    s_mov_b32 s19, 0x20000
    s_add_u32 s40, s72, 0x850000
    s_addc_u32 s41, s73, 0
    s_mov_b32 s42, 0xd000
    s_mov_b32 s43, 0x00020000
    s_cmp_lg_u32 s3, 0
    s_cbranch_scc1 F_z0
    s_getpc_b64 s[46:47]
F_pc:
    s_sub_u32 s46, s46, F_pc-parallel_sum__linear_attn_block__moe_arch_mod__prompt_kernel
    s_subb_u32 s47, s47, 0
    s_and_b32 s44, s31, 7
    s_lshl_b32 s44, s44, 13
    v_lshlrev_b32 v67, 7, v0
    v_add_u32 v67, s44, v67
    v_min_u32 v67, F_codeend-parallel_sum__linear_attn_block__moe_arch_mod__prompt_kernel-4, v67
    global_load_dword v61, v67, s[46:47]
    s_cmp_lg_u32 s75, 0
    s_cbranch_scc1 F_z0
    s_lshl_b32 s44, s32, 9
    s_add_u32 s44, s44, 32768
    s_mov_b32 exec_hi, 0
    buffer_store_dwordx4 v[12:15], v2, s[40:43], s44 offen sc0 sc1
    s_mul_i32 s44, s32, 768
    s_add_u32 s44, s44, 40960
    s_mov_b32 exec_hi, 0xffff
    buffer_store_dwordx4 v[12:15], v2, s[40:43], s44 offen sc0 sc1
    s_mov_b64 exec, -1
F_z0:

    s_and_b32 s89, s2, 0xdd
    s_bfe_u32 s44, s2, 0x10005
    s_lshl_b32 s44, s44, 1
    s_or_b32 s89, s89, s44
    s_bfe_u32 s44, s2, 0x10001
    s_xor_b32 s44, s44, 1
    s_lshl_b32 s44, s44, 5
    s_or_b32 s89, s89, s44
    s_xor_b32 s89, s89, 0

    s_and_b32 s36, s89, 3
    s_bfe_u32 s37, s89, 0x10002
    s_lshr_b32 s38, s89, 3
    s_cmp_eq_u32 s37, 0
    s_cselect_b32 s16, s62, s64
    s_cselect_b32 s17, s63, s65
    s_cmp_lt_u32 s89, 224
    s_cselect_b32 s18, 7340032, 0
    v_mul_u32_u24 v6, 57344, v5
    v_lshl_add_u32 v6, v7, 4, v6
    s_lshl_b32 s44, s36, 2
    s_add_u32 s44, s44, s3
    s_mul_i32 s54, s44, 458752
    s_lshl_b32 s45, s38, 8
    s_add_u32 s54, s54, s45
    s_lshl_b32 s55, s44, 7

    s_add_u32 s39, s35, 2
    s_and_b32 s39, s39, 7
    s_lshl_b32 s10, s34, 3
    s_add_u32 s10, s10, s30

    s_mul_i32 s10, s10, 112
    s_mul_i32 s79, s3, 28
    s_add_u32 s10, s10, s79
    s_lshl_b32 s78, s10, 11
    s_lshl_b32 s79, s39, 8
    s_add_u32 s78, s78, s79
    v_mul_u32_u24 v160, 14336, v5
    v_lshl_add_u32 v160, v7, 4, v160

    s_mov_b32 s80, s66
    s_mov_b32 s81, s67
    s_mov_b32 s82, 0x700000
    s_mov_b32 s83, 0x00020000
    s_barrier
    s_bitcmp0_b32 s3, 0
    s_cbranch_scc1 F_cs1
    ds_read_b64_tr_b16 v[72:73], v62 offset:0
    ds_read_b64_tr_b16 v[74:75], v62 offset:512
    ds_read_b64_tr_b16 v[76:77], v62 offset:4096
    ds_read_b64_tr_b16 v[78:79], v62 offset:4608
    ds_read_b64_tr_b16 v[80:81], v63 offset:0
    ds_read_b64_tr_b16 v[82:83], v63 offset:512
    ds_read_b64_tr_b16 v[84:85], v63 offset:4096
    ds_read_b64_tr_b16 v[86:87], v63 offset:4608
    s_waitcnt lgkmcnt(4)
    ds_read_b64_tr_b16 v[88:89], v64 offset:0
    ds_read_b64_tr_b16 v[90:91], v64 offset:512
    ds_read_b64_tr_b16 v[92:93], v64 offset:4096
    ds_read_b64_tr_b16 v[94:95], v64 offset:4608
    ds_read_b64_tr_b16 v[96:97], v65 offset:0
    ds_read_b64_tr_b16 v[98:99], v65 offset:512
    ds_read_b64_tr_b16 v[100:101], v65 offset:4096
    ds_read_b64_tr_b16 v[102:103], v65 offset:4608
    s_branch F_cs2
F_cs1:
    v_add_u32 v60, 159040, v3
    s_mov_b32 exec_hi, 0xffff
    ds_write_b32 v60, v12
    s_mov_b64 exec, -1
F_cs2:
    s_add_u32 s24, s72, 0x800000
    s_addc_u32 s25, s73, 0
    s_mov_b32 s26, 0x48000
    s_mov_b32 s27, 0x00020000
    s_mov_b32 s48, s70
    s_mov_b32 s49, s71
    s_mov_b32 s50, 0x100
    s_mov_b32 s51, 0x00020000
    s_lshl_b32 s47, s32, 9
    s_add_u32 s56, s47, 0x858000
    s_add_u32 s56, s72, s56
    s_addc_u32 s57, s73, 0
    s_lshl_b32 s47, s33, 9
    s_add_u32 s58, s47, 0x858100
    s_add_u32 s58, s72, s58
    s_addc_u32 s59, s73, 0
    v_mov_b32 v68, 0x3f803f80
    v_mov_b32 v69, 0x3f803f80
    v_mov_b32 v70, 0x3f803f80
    v_mov_b32 v71, 0x3f803f80
    s_waitcnt lgkmcnt(0)
    s_cmp_lg_u32 s75, 0
    s_cbranch_scc1 F_z4
    s_lshl_b32 s45, s32, 2
    s_add_u32 s44, s70, s45
    s_addc_u32 s45, s71, 0
    s_mov_b32 s46, 1
    s_waitcnt vmcnt(0)
    s_atomic_add s46, s[44:45], 0
F_z4:

    s_bitcmp0_b32 s3, 0
    s_cbranch_scc1 F_c2a
    v_mfma_f32_16x16x32_bf16 v[104:107], v[68:71], v[72:75], 0
    v_mfma_f32_16x16x32_bf16 v[108:111], v[68:71], v[80:83], 0
    v_mfma_f32_16x16x32_bf16 v[112:115], v[68:71], v[88:91], 0
    v_mfma_f32_16x16x32_bf16 v[116:119], v[68:71], v[96:99], 0
    v_mfma_f32_16x16x32_bf16 v[104:107], v[68:71], v[76:79], v[104:107]
    v_mfma_f32_16x16x32_bf16 v[108:111], v[68:71], v[84:87], v[108:111]
    v_mfma_f32_16x16x32_bf16 v[112:115], v[68:71], v[92:95], v[112:115]
    v_mfma_f32_16x16x32_bf16 v[116:119], v[68:71], v[100:103], v[116:119]
    v_cmp_eq_u32 vcc, 1, v5
    s_nop 4
    v_cndmask_b32 v66, v104, v108, vcc
    v_cmp_eq_u32 vcc, 2, v5
    s_nop 1
    v_cndmask_b32 v66, v66, v112, vcc
    v_cmp_eq_u32 vcc, 3, v5
    s_nop 1
    v_cndmask_b32 v66, v66, v116, vcc

F_c2a:
    s_barrier
    s_cmp_lg_u32 s3, 2
    s_cbranch_scc1 F_cs3
    ds_read_b64_tr_b16 v[72:73], v62 offset:0
    ds_read_b64_tr_b16 v[74:75], v62 offset:512
    ds_read_b64_tr_b16 v[76:77], v62 offset:4096
    ds_read_b64_tr_b16 v[78:79], v62 offset:4608
    ds_read_b64_tr_b16 v[80:81], v63 offset:0
    ds_read_b64_tr_b16 v[82:83], v63 offset:512
    ds_read_b64_tr_b16 v[84:85], v63 offset:4096
    s_branch IW_s8
IW_w8:
    s_branch IW_r8
IW_s8:
    ds_read_b64_tr_b16 v[86:87], v63 offset:4608
    s_waitcnt lgkmcnt(4)
    ds_read_b64_tr_b16 v[88:89], v64 offset:0
    ds_read_b64_tr_b16 v[90:91], v64 offset:512
    ds_read_b64_tr_b16 v[92:93], v64 offset:4096
    ds_read_b64_tr_b16 v[94:95], v64 offset:4608
    ds_read_b64_tr_b16 v[96:97], v65 offset:0
    ds_read_b64_tr_b16 v[98:99], v65 offset:512
    ds_read_b64_tr_b16 v[100:101], v65 offset:4096
    ds_read_b64_tr_b16 v[102:103], v65 offset:4608
    s_waitcnt lgkmcnt(0)
F_cs3:
    s_cmp_lg_u32 s3, 0
    s_cbranch_scc1 EV_78
    s_branch IW_w8
IW_r8:
EV_78:
    s_cmp_lg_u32 s3, 1
    s_cbranch_scc1 EV_79
    s_branch IW_w0
IW_r0:
EV_79:
    s_cmp_lg_u32 s3, 2
    s_cbranch_scc1 EV_80
    s_branch IW_w1
IW_r1:
EV_80:
    s_cmp_lg_u32 s3, 3
    s_cbranch_scc1 EV_81
    s_branch IW_w3
IW_r3:
EV_81:
    s_barrier
    s_cmp_lt_u32 s3, 2
    s_mov_b32 s44, 98304
    s_cselect_b32 s44, 98304, s44
    s_lshl_b32 s45, s3, 12
    s_add_u32 s44, s44, s45
    v_add_u32 v4, s44, v4
    v_add_u32 v8, 161792, v8
    ds_read_b128 v[16:19], v4 offset:0
    ds_read_b128 v[20:23], v4 offset:512
    ds_read_b128 v[24:27], v4 offset:1024
    ds_read_b128 v[28:31], v4 offset:1536
    s_mov_b32 exec_lo, 0x00ff00ff
    s_mov_b32 exec_hi, 0x00ff00ff
    ds_read_b128 v[32:35], v8 offset:0
    ds_read_b128 v[36:39], v8 offset:512
    ds_read_b128 v[40:43], v8 offset:1024
    ds_read_b128 v[44:47], v8 offset:1536
    s_mov_b64 exec, -1
    s_waitcnt lgkmcnt(0)
    v_mfma_f32_16x16x32_bf16 v[120:123], v[16:19], v[16:19], 0
    v_mfma_f32_16x16x32_bf16 v[124:127], v[16:19], v[32:35], 0
    v_mfma_f32_16x16x32_bf16 v[128:131], v[32:35], v[32:35], 0
    v_mfma_f32_16x16x32_bf16 v[120:123], v[20:23], v[20:23], v[120:123]
    v_mfma_f32_16x16x32_bf16 v[124:127], v[20:23], v[36:39], v[124:127]
    v_mfma_f32_16x16x32_bf16 v[128:131], v[36:39], v[36:39], v[128:131]
    v_mfma_f32_16x16x32_bf16 v[120:123], v[24:27], v[24:27], v[120:123]
    v_mfma_f32_16x16x32_bf16 v[124:127], v[24:27], v[40:43], v[124:127]
    v_mfma_f32_16x16x32_bf16 v[128:131], v[40:43], v[40:43], v[128:131]
    v_mfma_f32_16x16x32_bf16 v[120:123], v[28:31], v[28:31], v[120:123]
    v_mfma_f32_16x16x32_bf16 v[124:127], v[28:31], v[44:47], v[124:127]
    v_mfma_f32_16x16x32_bf16 v[128:131], v[44:47], v[44:47], v[128:131]
    s_cmp_lg_u32 s3, 2
    s_cbranch_scc1 F_c2b
    v_mfma_f32_16x16x32_bf16 v[104:107], v[68:71], v[72:75], 0
    v_mfma_f32_16x16x32_bf16 v[108:111], v[68:71], v[80:83], 0
    v_mfma_f32_16x16x32_bf16 v[112:115], v[68:71], v[88:91], 0
    v_mfma_f32_16x16x32_bf16 v[116:119], v[68:71], v[96:99], 0
    v_mfma_f32_16x16x32_bf16 v[104:107], v[68:71], v[76:79], v[104:107]
    v_mfma_f32_16x16x32_bf16 v[108:111], v[68:71], v[84:87], v[108:111]
    v_mfma_f32_16x16x32_bf16 v[112:115], v[68:71], v[92:95], v[112:115]
    v_mfma_f32_16x16x32_bf16 v[116:119], v[68:71], v[100:103], v[116:119]
    v_cmp_eq_u32 vcc, 1, v5
    s_nop 4
    v_cndmask_b32 v66, v104, v108, vcc
    v_cmp_eq_u32 vcc, 2, v5
    s_nop 1
    v_cndmask_b32 v66, v66, v112, vcc
    v_cmp_eq_u32 vcc, 3, v5
    s_nop 1
    v_cndmask_b32 v66, v66, v116, vcc

F_c2b:
    s_cmp_lg_u32 s3, 0
    s_cbranch_scc1 F_r1
    buffer_load_dword v11, v59, s[48:51], 0 offen sc0 sc1
F_r1:
    s_cmp_lg_u32 s3, 0
    s_cbranch_scc1 EV_83
    s_branch IW_w4
IW_r4:
EV_83:
    s_cmp_lg_u32 s3, 1
    s_cbranch_scc1 EV_84
    s_branch IW_w9
IW_r9:
EV_84:
    s_cmp_lg_u32 s3, 2
    s_cbranch_scc1 EV_85
    s_branch IW_w10
IW_r10:
EV_85:
    s_cmp_lg_u32 s3, 3
    s_cbranch_scc1 EV_86
    s_nop 0
EV_86:
    s_barrier
    v_and_b32 v52, 3, v0
    v_cmp_eq_u32 vcc, 1, v52
    s_nop 1
    v_cndmask_b32 v120, v120, v121, vcc
    v_cndmask_b32 v124, v124, v125, vcc
    v_cndmask_b32 v128, v128, v129, vcc
    v_cmp_eq_u32 vcc, 2, v52
    s_nop 1
    v_cndmask_b32 v120, v120, v122, vcc
    v_cndmask_b32 v124, v124, v126, vcc
    v_cndmask_b32 v128, v128, v130, vcc
    v_cmp_eq_u32 vcc, 3, v52
    s_nop 1
    v_cndmask_b32 v120, v120, v123, vcc
    v_cndmask_b32 v124, v124, v127, vcc
    v_cndmask_b32 v128, v128, v131, vcc
    v_add_f32_dpp v120, v120, v120 quad_perm:[1,0,3,2] row_mask:0xf bank_mask:0xf
    v_add_f32_dpp v124, v124, v124 quad_perm:[1,0,3,2] row_mask:0xf bank_mask:0xf
    v_add_f32_dpp v128, v128, v128 quad_perm:[1,0,3,2] row_mask:0xf bank_mask:0xf
    v_add_f32_dpp v120, v120, v120 quad_perm:[2,3,0,1] row_mask:0xf bank_mask:0xf
    v_add_f32_dpp v124, v124, v124 quad_perm:[2,3,0,1] row_mask:0xf bank_mask:0xf
    v_add_f32_dpp v128, v128, v128 quad_perm:[2,3,0,1] row_mask:0xf bank_mask:0xf
    v_readlane_b32 s44, v124, 8
    v_readlane_b32 s45, v124, 24
    v_readlane_b32 s46, v124, 40
    v_readlane_b32 s47, v124, 56
    v_mov_b32 v48, s44
    v_mov_b32 v52, s45
    s_nop 0
    v_writelane_b32 v48, s46, 1
    v_writelane_b32 v52, s47, 1
    v_readlane_b32 s44, v120, 0
    v_readlane_b32 s45, v120, 20
    v_readlane_b32 s46, v120, 40
    v_readlane_b32 s47, v120, 60
    v_mov_b32 v49, s44
    v_mov_b32 v53, s45
    s_nop 0
    v_writelane_b32 v49, s46, 1
    v_writelane_b32 v53, s47, 1
    v_readlane_b32 s44, v124, 0
    v_readlane_b32 s45, v124, 20
    v_readlane_b32 s46, v124, 32
    v_readlane_b32 s47, v124, 52
    v_mov_b32 v50, s44
    v_mov_b32 v54, s45
    s_nop 0
    v_writelane_b32 v50, s46, 1
    v_writelane_b32 v54, s47, 1
    v_readlane_b32 s44, v128, 8
    v_readlane_b32 s45, v128, 24
    v_readlane_b32 s46, v128, 8
    v_readlane_b32 s47, v128, 24
    v_mov_b32 v51, s44
    v_mov_b32 v55, s45
    s_nop 0
    v_writelane_b32 v51, s46, 1
    v_writelane_b32 v55, s47, 1
    v_add_f32 v48, v48, v52
    v_add_f32 v49, v49, v53
    v_add_f32 v50, v50, v54
    v_add_f32 v51, v51, v55
    v_mul_f32 v48, 0x3a800000, v48
    v_mul_f32 v49, 0x3a800000, v49
    v_fma_f32 v49, -v48, v48, v49
    v_max_f32 v49, 0, v49
    v_cvt_pk_bf16_f32 v52, v48, v49
    v_lshlrev_b32 v48, 16, v52
    v_and_b32 v49, 0xffff0000, v52
    v_add_f32 v49, 0x3727c5ac, v49
    v_cvt_pk_bf16_f32 v49, v49, v49
    v_lshlrev_b32 v49, 16, v49
    v_sqrt_f32 v49, v49
    s_nop 0
    v_cvt_pk_bf16_f32 v49, v49, v49
    v_lshlrev_b32 v49, 16, v49
    v_rcp_f32 v49, v49
    v_xor_b32 v48, 0x80000000, v48
    v_fma_f32 v50, v48, v51, v50
    v_mul_f32 v50, v50, v49
    v_add_u32 v50, 0x8000, v50
    v_ashrrev_i32 v51, 31, v50
    v_or_b32 v51, 0x80000000, v51
    v_xor_b32 v50, v50, v51
    v_and_b32 v50, 0xfffff800, v50
    s_sub_u32 s44, 2047, s77
    v_sub_u32 v51, s44, v9
    v_or_b32 v50, v50, v51
    s_lshl_b32 s44, s3, 1
    v_add_u32 v52, s44, v9
    v_lshlrev_b32 v53, 3, v52
    v_lshlrev_b32 v52, 2, v52
    v_add_u32 v53, 159744, v53
    v_add_u32 v52, 159808, v52
    s_mov_b64 exec, 3
    ds_write_b64 v53, v[48:49]
    ds_write_b32 v52, v50
    s_mov_b64 exec, -1
    s_waitcnt lgkmcnt(0)

    s_cmp_lg_u32 s3, 0
    s_cbranch_scc1 F_a0r
F_a0p:
    s_waitcnt vmcnt(0)
    v_cmp_eq_u32 vcc, 0, v11
    s_cbranch_vccz F_a0r
    s_sleep 4
    buffer_load_dword v11, v59, s[48:51], 0 offen sc0 sc1
    s_branch F_a0p
F_a0r:
    s_barrier
    s_cmp_eq_u32 s3, 0
    s_cbranch_scc1 F_ax0
    s_mul_i32 s44, s33, 768
    s_add_u32 s44, s44, 40960
    s_add_u32 s45, s3, 1
    s_lshr_b32 s45, s45, 1
    s_cmp_eq_u32 s3, 2
    s_cselect_b32 s45, 0, s45
    s_lshl_b32 s45, s45, 8
    s_add_u32 s44, s44, s45
    buffer_atomic_add_f32 v66, v3, s[40:43], s44 offen
    s_mul_i32 s44, s2, 1152
    s_mul_i32 s45, s3, 384
    s_add_u32 s44, s44, s45
    s_sub_u32 s44, s44, 384
    s_mov_b64 exec, 0xffffff
    buffer_store_dwordx4 v[12:15], v2, s[24:27], s44 offen sc0 sc1
    s_mov_b64 exec, -1
    s_branch F_s1
F_ax0:
    v_add_u32 v60, 159744, v3
    ds_read_b32 v60, v60
    s_lshl_b32 s44, s76, 7
    s_mov_b32 exec_hi, 0
    s_waitcnt lgkmcnt(0)
    buffer_store_dword v60, v3, s[40:43], s44 offen sc0 sc1
    s_mov_b64 exec, -1
F_s1:

    s_barrier
    v_mov_b32 v4, 159144
    v_mov_b32 v8, 1
    s_lshr_b32 s47, s32, 2
    s_lshl_b32 s47, s47, 11
    s_add_u32 s86, s47, 0x858180
    s_add_u32 s86, s72, s86
    s_addc_u32 s87, s73, 0
    s_waitcnt vmcnt(0)
    s_mov_b64 exec, 1
    ds_add_rtn_u32 v9, v4, v8
    s_waitcnt lgkmcnt(0)
    v_readfirstlane_b32 s44, v9
    s_mov_b64 exec, -1
    s_cmp_lg_u32 s44, 3
    s_cbranch_scc1 F_a0s
    s_mov_b32 s74, 1
    s_atomic_add s74, s[86:87], 0
    s_atomic_add s74, s[56:57], 0
    s_atomic_add s74, s[58:59], 0
F_a0s:

    s_barrier
    s_mul_i32 s53, s2, 37
    s_and_b32 s53, s53, 255
    s_mul_i32 s53, s53, 4
    s_lshr_b32 s53, s53, 8
    s_branch F_swx
F_sw0:
    s_add_u32 s91, s54, 0
    buffer_load_dwordx4 v[72:75], v6, s[16:19], s91 offen nt
    s_add_u32 s91, s54, 7168
    buffer_load_dwordx4 v[76:79], v6, s[16:19], s91 offen nt
    s_add_u32 s91, s54, 14336
    buffer_load_dwordx4 v[80:83], v6, s[16:19], s91 offen nt
    s_add_u32 s91, s54, 21504
    buffer_load_dwordx4 v[84:87], v6, s[16:19], s91 offen nt
    s_add_u32 s91, s54, 28672
    buffer_load_dwordx4 v[88:91], v6, s[16:19], s91 offen nt
    s_add_u32 s91, s54, 35840
    buffer_load_dwordx4 v[92:95], v6, s[16:19], s91 offen nt
    s_add_u32 s91, s54, 43008
    buffer_load_dwordx4 v[96:99], v6, s[16:19], s91 offen nt
    s_add_u32 s91, s54, 50176
    buffer_load_dwordx4 v[100:103], v6, s[16:19], s91 offen nt
    s_setpc_b64 s[34:35]
F_swx:
    s_cmp_eq_u32 s3, 2
    s_cbranch_scc1 F_ax2
    s_cmp_eq_u32 s3, 1
    s_cbranch_scc1 F_ax1
    s_cmp_eq_u32 s3, 0
    s_cbranch_scc1 F_ax0b
    s_barrier
    s_cmp_lg_u32 s53, 0
    s_cbranch_scc1 SW_87
    s_call_b64 s[34:35], F_sw0
SW_87:
    s_branch IW_w5
IW_r5:
    s_barrier
    s_cmp_lg_u32 s53, 1
    s_cbranch_scc1 SW_88
    s_call_b64 s[34:35], F_sw0
SW_88:
    s_branch IW_w7
IW_r7:
    s_barrier
    s_cmp_lg_u32 s53, 2
    s_cbranch_scc1 SW_89
    s_call_b64 s[34:35], F_sw0
SW_89:
    s_nop 0
    s_barrier
    s_cmp_lg_u32 s53, 3
    s_cbranch_scc1 SW_90
    s_call_b64 s[34:35], F_sw0
SW_90:
    s_nop 0
    s_barrier
    s_nop 0
    s_barrier
    s_nop 0
    s_barrier
    s_add_u32 s91, s54, 229376
    buffer_load_dwordx4 v[104:107], v6, s[16:19], s91 offen nt
    s_add_u32 s91, s54, 236544
    buffer_load_dwordx4 v[108:111], v6, s[16:19], s91 offen nt
    s_add_u32 s91, s54, 243712
    buffer_load_dwordx4 v[112:115], v6, s[16:19], s91 offen nt
    s_add_u32 s91, s54, 250880
    buffer_load_dwordx4 v[116:119], v6, s[16:19], s91 offen nt
    s_nop 0
    s_load_dword s76, s[56:57], 0 glc
    s_barrier
    s_add_u32 s91, s54, 258048
    buffer_load_dwordx4 v[120:123], v6, s[16:19], s91 offen nt
    s_add_u32 s91, s54, 265216
    buffer_load_dwordx4 v[124:127], v6, s[16:19], s91 offen nt
    s_add_u32 s91, s54, 272384
    buffer_load_dwordx4 v[128:131], v6, s[16:19], s91 offen nt
    s_add_u32 s91, s54, 279552
    buffer_load_dwordx4 v[132:135], v6, s[16:19], s91 offen nt
    s_waitcnt lgkmcnt(0)
    s_cmp_lt_u32 s76, 1000
    s_cbranch_scc1 F_g3
    v_mov_b32 v4, 1
    s_mov_b64 exec, 1
    ds_write_b32 v10, v4 offset:48
    s_mov_b64 exec, -1
    s_mov_b32 s88, 0
F_g3:
    s_barrier
    s_branch F_aj
F_ax1:
    s_barrier
    s_cmp_lg_u32 s53, 0
    s_cbranch_scc1 SW_91
    s_call_b64 s[34:35], F_sw0
SW_91:
    s_branch IW_w6
IW_r6:
    s_barrier
    s_cmp_lg_u32 s53, 1
    s_cbranch_scc1 SW_92
    s_call_b64 s[34:35], F_sw0
SW_92:
    s_nop 0
    s_barrier
    s_cmp_lg_u32 s53, 2
    s_cbranch_scc1 SW_93
    s_call_b64 s[34:35], F_sw0
SW_93:
    s_nop 0
    s_mul_i32 s44, s33, 768
    s_add_u32 s44, s44, 40960
    s_barrier
    s_cmp_lg_u32 s53, 3
    s_cbranch_scc1 SW_94
    s_call_b64 s[34:35], F_sw0
SW_94:
    s_load_dword s76, s[58:59], 0 glc
    s_barrier
    s_waitcnt lgkmcnt(0)
    s_cmp_ge_u32 s76, 16
    s_cbranch_scc1 GC_95
SP_96:
    s_load_dword s76, s[58:59], 0 glc
    s_waitcnt lgkmcnt(0)
    s_cmp_ge_u32 s76, 16
    s_cbranch_scc1 SD_97
    s_sleep 3
    s_branch SP_96
SD_97:
GC_95:
    s_barrier
    s_sleep 4
    s_mov_b32 m0, 158208
    s_mov_b32 exec_hi, 0xffff
    buffer_load_dwordx4 v2, s[40:43], s44 offen sc0 sc1 lds
    s_mov_b64 exec, -1
    s_barrier
    s_add_u32 s91, s54, 229376
    buffer_load_dwordx4 v[104:107], v6, s[16:19], s91 offen nt
    s_add_u32 s91, s54, 236544
    buffer_load_dwordx4 v[108:111], v6, s[16:19], s91 offen nt
    s_add_u32 s91, s54, 243712
    buffer_load_dwordx4 v[112:115], v6, s[16:19], s91 offen nt
    s_add_u32 s91, s54, 250880
    buffer_load_dwordx4 v[116:119], v6, s[16:19], s91 offen nt
    s_barrier
    s_add_u32 s91, s54, 258048
    buffer_load_dwordx4 v[120:123], v6, s[16:19], s91 offen nt
    s_add_u32 s91, s54, 265216
    buffer_load_dwordx4 v[124:127], v6, s[16:19], s91 offen nt
    s_add_u32 s91, s54, 272384
    buffer_load_dwordx4 v[128:131], v6, s[16:19], s91 offen nt
    s_add_u32 s91, s54, 279552
    buffer_load_dwordx4 v[132:135], v6, s[16:19], s91 offen nt
    s_waitcnt vmcnt(8)
    v_mov_b32 v4, 1
    s_mov_b64 exec, 1
    ds_write_b32 v10, v4 offset:48
    s_mov_b64 exec, -1
    s_barrier
    s_branch F_aj
IW_w9:
    s_branch IW_r9
F_ax0b:
    s_barrier
    s_cmp_lg_u32 s53, 0
    s_cbranch_scc1 SW_98
    s_call_b64 s[34:35], F_sw0
SW_98:
    s_branch IW_w2
IW_r2:
    s_barrier
    s_cmp_lg_u32 s53, 1
    s_cbranch_scc1 SW_99
    s_call_b64 s[34:35], F_sw0
SW_99:
    s_nop 0
    s_barrier
    s_cmp_lg_u32 s53, 2
    s_cbranch_scc1 SW_100
    s_call_b64 s[34:35], F_sw0
SW_100:
    s_nop 0
    s_lshl_b32 s47, s28, 9
    s_waitcnt lgkmcnt(0)
    s_add_u32 s58, s47, 0x858000
    s_add_u32 s58, s72, s58
    s_addc_u32 s59, s73, 0
    s_lshl_b32 s44, s32, 11
    s_lshl_b32 s45, s28, 11
    v_lshrrev_b32 v11, 2, v0
    v_and_b32 v9, 3, v0
    v_lshlrev_b32 v9, 4, v9
    v_lshl_add_u32 v11, v11, 7, v9

    s_barrier
    s_cmp_lg_u32 s53, 3
    s_cbranch_scc1 SW_101
    s_call_b64 s[34:35], F_sw0
SW_101:
    s_load_dword s76, s[56:57], 0 glc
    s_load_dword s77, s[58:59], 0 glc
    s_barrier
    s_waitcnt lgkmcnt(0)
    s_cmp_ge_u32 s76, 16
    s_cbranch_scc1 GC_102
SP_103:
    s_load_dword s76, s[56:57], 0 glc
    s_waitcnt lgkmcnt(0)
    s_cmp_ge_u32 s76, 16
    s_cbranch_scc1 SD_104
    s_sleep 3
    s_branch SP_103
SD_104:
GC_102:
    s_cmp_ge_u32 s77, 16
    s_cbranch_scc1 GC_105
SP_106:
    s_load_dword s77, s[58:59], 0 glc
    s_waitcnt lgkmcnt(0)
    s_cmp_ge_u32 s77, 16
    s_cbranch_scc1 SD_107
    s_sleep 3
    s_branch SP_106
SD_107:
GC_105:
    s_barrier
    s_sleep 4
    buffer_load_dwordx4 v[32:35], v11, s[40:43], s44 offen sc0 sc1
    buffer_load_dwordx4 v[36:39], v11, s[40:43], s45 offen sc0 sc1
    v_lshlrev_b32 v9, 3, v0
    v_add_u32 v9, 155648, v9
    s_mov_b32 s44, 0x3fb8aa3b

    s_barrier
    s_add_u32 s91, s54, 229376
    buffer_load_dwordx4 v[104:107], v6, s[16:19], s91 offen nt
    s_add_u32 s91, s54, 236544
    buffer_load_dwordx4 v[108:111], v6, s[16:19], s91 offen nt
    s_add_u32 s91, s54, 243712
    buffer_load_dwordx4 v[112:115], v6, s[16:19], s91 offen nt
    s_add_u32 s91, s54, 250880
    buffer_load_dwordx4 v[116:119], v6, s[16:19], s91 offen nt
    s_barrier
    s_add_u32 s91, s54, 258048
    buffer_load_dwordx4 v[120:123], v6, s[16:19], s91 offen nt
    s_add_u32 s91, s54, 265216
    buffer_load_dwordx4 v[124:127], v6, s[16:19], s91 offen nt
    s_add_u32 s91, s54, 272384
    buffer_load_dwordx4 v[128:131], v6, s[16:19], s91 offen nt
    s_add_u32 s91, s54, 279552
    buffer_load_dwordx4 v[132:135], v6, s[16:19], s91 offen nt
    s_waitcnt vmcnt(8)
    v_swap_b32 v33, v34
    v_swap_b32 v37, v38
    v_mul_f32 v40, s44, v34
    v_mul_f32 v41, s44, v35
    ds_write_b64 v9, v[32:33]
    ds_write_b64 v9, v[40:41] offset:1024
    ds_write_b64 v9, v[36:37] offset:1536
    ds_write_b64 v9, v[38:39] offset:2048

    v_mov_b32 v4, 1
    s_mov_b64 exec, 1
    ds_write_b32 v10, v4 offset:48
    s_mov_b64 exec, -1
    s_barrier
    s_branch F_aj
F_ax2:
    s_cmp_lg_u32 s2, 248
    s_cbranch_scc1 F_a2n
    s_waitcnt lgkmcnt(0)
    s_mov_b32 s74, 7
    v_lshrrev_b32 v11, 1, v0
    v_and_b32 v9, 1, v0
    v_lshlrev_b32 v9, 4, v9
    v_lshl_add_u32 v11, v11, 7, v9
    v_lshlrev_b32 v9, 9, v0
    v_mov_b32 v8, 1000
F_a2l:

    s_load_dword s60, s[40:41], 0x8180 glc
    s_load_dword s61, s[40:41], 0x8980 glc
    s_load_dword s62, s[40:41], 0x9180 glc
    s_load_dword s63, s[40:41], 0x9980 glc
    s_waitcnt lgkmcnt(0)
    s_add_u32 s60, s60, s61
    s_add_u32 s62, s62, s63
    s_add_u32 s60, s60, s62
    s_cmp_ge_u32 s60, 256
    s_cbranch_scc1 F_a2t

    s_cmp_ge_u32 s74, 17
    s_cbranch_scc1 DB_108
    s_barrier
    s_add_u32 s74, s74, 1
DB_108:
    s_branch F_a2l
F_a2t:
    s_movk_i32 s44, 0
    buffer_load_dwordx4 v[16:19], v11, s[40:43], s44 offen offset:64 sc0 sc1
    s_movk_i32 s44, 4096
    buffer_load_dwordx4 v[20:23], v11, s[40:43], s44 offen offset:64 sc0 sc1
    s_movk_i32 s44, 8192
    buffer_load_dwordx4 v[24:27], v11, s[40:43], s44 offen offset:64 sc0 sc1
    s_movk_i32 s44, 12288
    buffer_load_dwordx4 v[28:31], v11, s[40:43], s44 offen offset:64 sc0 sc1
    s_movk_i32 s44, 16384
    buffer_load_dwordx4 v[32:35], v11, s[40:43], s44 offen offset:64 sc0 sc1
    s_movk_i32 s44, 20480
    buffer_load_dwordx4 v[36:39], v11, s[40:43], s44 offen offset:64 sc0 sc1
    s_movk_i32 s44, 24576
    buffer_load_dwordx4 v[40:43], v11, s[40:43], s44 offen offset:64 sc0 sc1
    s_movk_i32 s44, 28672
    buffer_load_dwordx4 v[44:47], v11, s[40:43], s44 offen offset:64 sc0 sc1
    s_mov_b32 s44, 32768
    s_mov_b64 exec, 0xffff
    buffer_atomic_add v8, v9, s[40:43], s44 offen
    s_mov_b64 exec, -1

    s_cmp_ge_u32 s74, 17
    s_cbranch_scc1 DB_109
    s_barrier
    s_add_u32 s74, s74, 1
DB_109:
    s_waitcnt vmcnt(1)
    v_max3_u32 v48, v16, v17, v18
    v_med3_u32 v49, v16, v17, v18
    v_min3_u32 v50, v16, v17, v18
    v_med3_u32 v50, v49, v50, v19
    v_med3_u32 v49, v48, v49, v19
    v_max_u32 v48, v48, v19
    v_med3_u32 v50, v49, v50, v20
    v_med3_u32 v49, v48, v49, v20
    v_max_u32 v48, v48, v20
    v_med3_u32 v50, v49, v50, v21
    v_med3_u32 v49, v48, v49, v21
    v_max_u32 v48, v48, v21
    v_med3_u32 v50, v49, v50, v22
    v_med3_u32 v49, v48, v49, v22
    v_max_u32 v48, v48, v22
    v_med3_u32 v50, v49, v50, v23
    v_med3_u32 v49, v48, v49, v23
    v_max_u32 v48, v48, v23
    v_med3_u32 v50, v49, v50, v24
    v_med3_u32 v49, v48, v49, v24
    v_max_u32 v48, v48, v24
    v_med3_u32 v50, v49, v50, v25
    v_med3_u32 v49, v48, v49, v25
    v_max_u32 v48, v48, v25
    v_med3_u32 v50, v49, v50, v26
    v_med3_u32 v49, v48, v49, v26
    v_max_u32 v48, v48, v26
    v_med3_u32 v50, v49, v50, v27
    v_med3_u32 v49, v48, v49, v27
    v_max_u32 v48, v48, v27
    v_med3_u32 v50, v49, v50, v28
    v_med3_u32 v49, v48, v49, v28
    v_max_u32 v48, v48, v28
    v_med3_u32 v50, v49, v50, v29
    v_med3_u32 v49, v48, v49, v29
    v_max_u32 v48, v48, v29
    v_med3_u32 v50, v49, v50, v30
    v_med3_u32 v49, v48, v49, v30
    v_max_u32 v48, v48, v30
    v_med3_u32 v50, v49, v50, v31
    v_med3_u32 v49, v48, v49, v31
    v_max_u32 v48, v48, v31
    v_med3_u32 v50, v49, v50, v32
    v_med3_u32 v49, v48, v49, v32
    v_max_u32 v48, v48, v32
    v_med3_u32 v50, v49, v50, v33
    v_med3_u32 v49, v48, v49, v33
    v_max_u32 v48, v48, v33
    v_med3_u32 v50, v49, v50, v34
    v_med3_u32 v49, v48, v49, v34
    v_max_u32 v48, v48, v34
    v_med3_u32 v50, v49, v50, v35
    v_med3_u32 v49, v48, v49, v35
    v_max_u32 v48, v48, v35
    v_med3_u32 v50, v49, v50, v36
    v_med3_u32 v49, v48, v49, v36
    v_max_u32 v48, v48, v36
    v_med3_u32 v50, v49, v50, v37
    v_med3_u32 v49, v48, v49, v37
    v_max_u32 v48, v48, v37
    v_med3_u32 v50, v49, v50, v38
    v_med3_u32 v49, v48, v49, v38
    v_max_u32 v48, v48, v38
    v_med3_u32 v50, v49, v50, v39
    v_med3_u32 v49, v48, v49, v39
    v_max_u32 v48, v48, v39
    v_med3_u32 v50, v49, v50, v40
    v_med3_u32 v49, v48, v49, v40
    v_max_u32 v48, v48, v40
    v_med3_u32 v50, v49, v50, v41
    v_med3_u32 v49, v48, v49, v41
    v_max_u32 v48, v48, v41
    v_med3_u32 v50, v49, v50, v42
    v_med3_u32 v49, v48, v49, v42
    v_max_u32 v48, v48, v42
    v_med3_u32 v50, v49, v50, v43
    v_med3_u32 v49, v48, v49, v43
    v_max_u32 v48, v48, v43
    v_med3_u32 v50, v49, v50, v44
    v_med3_u32 v49, v48, v49, v44
    v_max_u32 v48, v48, v44
    v_med3_u32 v50, v49, v50, v45
    v_med3_u32 v49, v48, v49, v45
    v_max_u32 v48, v48, v45
    v_med3_u32 v50, v49, v50, v46
    v_med3_u32 v49, v48, v49, v46
    v_max_u32 v48, v48, v46
    v_med3_u32 v50, v49, v50, v47
    v_med3_u32 v49, v48, v49, v47
    v_max_u32 v48, v48, v47
    s_mov_b32 s53, 0
    v_max_u32 v4, v48, v49
    s_nop 1
    v_max_u32_dpp v4, v4, v4 row_shr:1 row_mask:0xf bank_mask:0xf bound_ctrl:0
    s_nop 1
    v_max_u32_dpp v4, v4, v4 row_shr:2 row_mask:0xf bank_mask:0xf bound_ctrl:0
    s_nop 1
    v_max_u32_dpp v4, v4, v4 row_shr:4 row_mask:0xf bank_mask:0xf bound_ctrl:0
    s_nop 1
    v_max_u32_dpp v4, v4, v4 row_shr:8 row_mask:0xf bank_mask:0xf bound_ctrl:0
    s_nop 1
    v_max_u32_dpp v4, v4, v4 row_bcast:15 row_mask:0xa bank_mask:0xf
    s_nop 1
    v_max_u32_dpp v4, v4, v4 row_bcast:31 row_mask:0xc bank_mask:0xf
    s_nop 0
    v_readlane_b32 s52, v4, 63
    s_nop 0
    s_add_u32 s53, s53, s52
    v_writelane_b32 v13, s53, 0
    v_subrev_u32 v48, s52, v48
    v_subrev_u32 v49, s52, v49
    v_max_u32 v4, v48, v49
    s_nop 1
    v_max_u32_dpp v4, v4, v4 row_shr:1 row_mask:0xf bank_mask:0xf bound_ctrl:0
    s_nop 1
    v_max_u32_dpp v4, v4, v4 row_shr:2 row_mask:0xf bank_mask:0xf bound_ctrl:0
    s_nop 1
    v_max_u32_dpp v4, v4, v4 row_shr:4 row_mask:0xf bank_mask:0xf bound_ctrl:0
    s_nop 1
    v_max_u32_dpp v4, v4, v4 row_shr:8 row_mask:0xf bank_mask:0xf bound_ctrl:0
    s_nop 1
    v_max_u32_dpp v4, v4, v4 row_bcast:15 row_mask:0xa bank_mask:0xf
    s_nop 1
    v_max_u32_dpp v4, v4, v4 row_bcast:31 row_mask:0xc bank_mask:0xf
    s_nop 0
    v_readlane_b32 s52, v4, 63
    s_nop 0
    s_add_u32 s53, s53, s52
    v_writelane_b32 v13, s53, 1
    v_subrev_u32 v48, s52, v48
    v_subrev_u32 v49, s52, v49
    v_max_u32 v4, v48, v49
    s_nop 1
    v_max_u32_dpp v4, v4, v4 row_shr:1 row_mask:0xf bank_mask:0xf bound_ctrl:0
    s_nop 1
    v_max_u32_dpp v4, v4, v4 row_shr:2 row_mask:0xf bank_mask:0xf bound_ctrl:0
    s_nop 1
    v_max_u32_dpp v4, v4, v4 row_shr:4 row_mask:0xf bank_mask:0xf bound_ctrl:0
    s_nop 1
    v_max_u32_dpp v4, v4, v4 row_shr:8 row_mask:0xf bank_mask:0xf bound_ctrl:0
    s_nop 1
    v_max_u32_dpp v4, v4, v4 row_bcast:15 row_mask:0xa bank_mask:0xf
    s_nop 1
    v_max_u32_dpp v4, v4, v4 row_bcast:31 row_mask:0xc bank_mask:0xf
    s_nop 0
    v_readlane_b32 s52, v4, 63
    s_nop 0
    s_add_u32 s53, s53, s52
    v_writelane_b32 v13, s53, 2
    v_subrev_u32 v48, s52, v48
    v_subrev_u32 v49, s52, v49
    v_max_u32 v4, v48, v49
    s_nop 1
    v_max_u32_dpp v4, v4, v4 row_shr:1 row_mask:0xf bank_mask:0xf bound_ctrl:0
    s_nop 1
    v_max_u32_dpp v4, v4, v4 row_shr:2 row_mask:0xf bank_mask:0xf bound_ctrl:0
    s_nop 1
    v_max_u32_dpp v4, v4, v4 row_shr:4 row_mask:0xf bank_mask:0xf bound_ctrl:0
    s_nop 1
    v_max_u32_dpp v4, v4, v4 row_shr:8 row_mask:0xf bank_mask:0xf bound_ctrl:0
    s_nop 1
    v_max_u32_dpp v4, v4, v4 row_bcast:15 row_mask:0xa bank_mask:0xf
    s_nop 1
    v_max_u32_dpp v4, v4, v4 row_bcast:31 row_mask:0xc bank_mask:0xf
    s_nop 0
    v_readlane_b32 s52, v4, 63
    s_nop 0
    s_add_u32 s53, s53, s52
    v_writelane_b32 v13, s53, 3
    v_subrev_u32 v48, s52, v48
    v_subrev_u32 v49, s52, v49
    v_max_u32 v4, v48, v49
    s_nop 1
    v_max_u32_dpp v4, v4, v4 row_shr:1 row_mask:0xf bank_mask:0xf bound_ctrl:0
    s_nop 1
    v_max_u32_dpp v4, v4, v4 row_shr:2 row_mask:0xf bank_mask:0xf bound_ctrl:0
    s_nop 1
    v_max_u32_dpp v4, v4, v4 row_shr:4 row_mask:0xf bank_mask:0xf bound_ctrl:0
    s_nop 1
    v_max_u32_dpp v4, v4, v4 row_shr:8 row_mask:0xf bank_mask:0xf bound_ctrl:0
    s_nop 1
    v_max_u32_dpp v4, v4, v4 row_bcast:15 row_mask:0xa bank_mask:0xf
    s_nop 1
    v_max_u32_dpp v4, v4, v4 row_bcast:31 row_mask:0xc bank_mask:0xf
    s_nop 0
    v_readlane_b32 s52, v4, 63
    s_nop 0
    s_add_u32 s53, s53, s52
    v_writelane_b32 v13, s53, 4
    v_subrev_u32 v48, s52, v48
    v_subrev_u32 v49, s52, v49
    v_max_u32 v4, v48, v49
    s_nop 1
    v_max_u32_dpp v4, v4, v4 row_shr:1 row_mask:0xf bank_mask:0xf bound_ctrl:0
    s_nop 1
    v_max_u32_dpp v4, v4, v4 row_shr:2 row_mask:0xf bank_mask:0xf bound_ctrl:0
    s_nop 1
    v_max_u32_dpp v4, v4, v4 row_shr:4 row_mask:0xf bank_mask:0xf bound_ctrl:0
    s_nop 1
    v_max_u32_dpp v4, v4, v4 row_shr:8 row_mask:0xf bank_mask:0xf bound_ctrl:0
    s_nop 1
    v_max_u32_dpp v4, v4, v4 row_bcast:15 row_mask:0xa bank_mask:0xf
    s_nop 1
    v_max_u32_dpp v4, v4, v4 row_bcast:31 row_mask:0xc bank_mask:0xf
    s_nop 0
    v_readlane_b32 s52, v4, 63
    s_nop 0
    s_add_u32 s53, s53, s52
    v_writelane_b32 v13, s53, 5
    v_subrev_u32 v48, s52, v48
    v_subrev_u32 v49, s52, v49
    v_max_u32 v4, v48, v49
    s_nop 1
    v_max_u32_dpp v4, v4, v4 row_shr:1 row_mask:0xf bank_mask:0xf bound_ctrl:0
    s_nop 1
    v_max_u32_dpp v4, v4, v4 row_shr:2 row_mask:0xf bank_mask:0xf bound_ctrl:0
    s_nop 1
    v_max_u32_dpp v4, v4, v4 row_shr:4 row_mask:0xf bank_mask:0xf bound_ctrl:0
    s_nop 1
    v_max_u32_dpp v4, v4, v4 row_shr:8 row_mask:0xf bank_mask:0xf bound_ctrl:0
    s_nop 1
    v_max_u32_dpp v4, v4, v4 row_bcast:15 row_mask:0xa bank_mask:0xf
    s_nop 1
    v_max_u32_dpp v4, v4, v4 row_bcast:31 row_mask:0xc bank_mask:0xf
    s_nop 0
    v_readlane_b32 s52, v4, 63
    s_nop 0
    s_add_u32 s53, s53, s52
    v_writelane_b32 v13, s53, 6
    v_subrev_u32 v48, s52, v48
    v_subrev_u32 v49, s52, v49
    v_max_u32 v4, v48, v49
    s_nop 1
    v_max_u32_dpp v4, v4, v4 row_shr:1 row_mask:0xf bank_mask:0xf bound_ctrl:0
    s_nop 1
    v_max_u32_dpp v4, v4, v4 row_shr:2 row_mask:0xf bank_mask:0xf bound_ctrl:0
    s_nop 1
    v_max_u32_dpp v4, v4, v4 row_shr:4 row_mask:0xf bank_mask:0xf bound_ctrl:0
    s_nop 1
    v_max_u32_dpp v4, v4, v4 row_shr:8 row_mask:0xf bank_mask:0xf bound_ctrl:0
    s_nop 1
    v_max_u32_dpp v4, v4, v4 row_bcast:15 row_mask:0xa bank_mask:0xf
    s_nop 1
    v_max_u32_dpp v4, v4, v4 row_bcast:31 row_mask:0xc bank_mask:0xf
    s_nop 0
    v_readlane_b32 s52, v4, 63
    s_nop 0
    s_add_u32 s53, s53, s52
    v_writelane_b32 v13, s53, 7
    v_cmp_lt_u32 vcc, s53, v50
    s_cbranch_vccz F_a2k
    s_mov_b32 s53, 0
    s_mov_b32 s52, 0
    s_mov_b32 s64, 0
F_a2f:
    v_subrev_u32 v16, s52, v16
    v_subrev_u32 v17, s52, v17
    v_subrev_u32 v18, s52, v18
    v_subrev_u32 v19, s52, v19
    v_subrev_u32 v20, s52, v20
    v_subrev_u32 v21, s52, v21
    v_subrev_u32 v22, s52, v22
    v_subrev_u32 v23, s52, v23
    v_subrev_u32 v24, s52, v24
    v_subrev_u32 v25, s52, v25
    v_subrev_u32 v26, s52, v26
    v_subrev_u32 v27, s52, v27
    v_subrev_u32 v28, s52, v28
    v_subrev_u32 v29, s52, v29
    v_subrev_u32 v30, s52, v30
    v_subrev_u32 v31, s52, v31
    v_subrev_u32 v32, s52, v32
    v_subrev_u32 v33, s52, v33
    v_subrev_u32 v34, s52, v34
    v_subrev_u32 v35, s52, v35
    v_subrev_u32 v36, s52, v36
    v_subrev_u32 v37, s52, v37
    v_subrev_u32 v38, s52, v38
    v_subrev_u32 v39, s52, v39
    v_subrev_u32 v40, s52, v40
    v_subrev_u32 v41, s52, v41
    v_subrev_u32 v42, s52, v42
    v_subrev_u32 v43, s52, v43
    v_subrev_u32 v44, s52, v44
    v_subrev_u32 v45, s52, v45
    v_subrev_u32 v46, s52, v46
    v_subrev_u32 v47, s52, v47
    v_max3_u32 v4, v16, v17, v18
    v_max3_u32 v12, v19, v20, v21
    v_max3_u32 v4, v4, v22, v23
    v_max3_u32 v12, v12, v24, v25
    v_max3_u32 v4, v4, v26, v27
    v_max3_u32 v12, v12, v28, v29
    v_max3_u32 v4, v4, v30, v31
    v_max3_u32 v12, v12, v32, v33
    v_max3_u32 v4, v4, v34, v35
    v_max3_u32 v12, v12, v36, v37
    v_max3_u32 v4, v4, v38, v39
    v_max3_u32 v12, v12, v40, v41
    v_max3_u32 v4, v4, v42, v43
    v_max3_u32 v12, v12, v44, v45
    v_max3_u32 v4, v4, v46, v47
    v_max_u32 v4, v4, v12
    s_nop 1
    v_max_u32_dpp v4, v4, v4 row_shr:1 row_mask:0xf bank_mask:0xf bound_ctrl:0
    s_nop 1
    v_max_u32_dpp v4, v4, v4 row_shr:2 row_mask:0xf bank_mask:0xf bound_ctrl:0
    s_nop 1
    v_max_u32_dpp v4, v4, v4 row_shr:4 row_mask:0xf bank_mask:0xf bound_ctrl:0
    s_nop 1
    v_max_u32_dpp v4, v4, v4 row_shr:8 row_mask:0xf bank_mask:0xf bound_ctrl:0
    s_nop 1
    v_max_u32_dpp v4, v4, v4 row_bcast:15 row_mask:0xa bank_mask:0xf
    s_nop 1
    v_max_u32_dpp v4, v4, v4 row_bcast:31 row_mask:0xc bank_mask:0xf
    s_nop 0
    v_readlane_b32 s52, v4, 63
    s_nop 0
    s_add_u32 s53, s53, s52
    s_mov_b32 m0, s64
    v_writelane_b32 v13, s53, m0
    s_cmp_ge_u32 s74, 17
    s_cbranch_scc1 DB_110
    s_barrier
    s_add_u32 s74, s74, 1
DB_110:
    s_add_u32 s64, s64, 1
    s_cmp_lt_u32 s64, 8
    s_cbranch_scc1 F_a2f
F_a2k:
    v_and_b32 v4, 7, v0
    v_lshlrev_b32 v4, 2, v4
    ds_bpermute_b32 v12, v4, v13
    v_lshrrev_b32 v9, 3, v0
    v_lshl_add_u32 v4, v9, 9, v4
    s_mov_b32 s44, 32896
    s_mov_b32 s45, 36992
    s_waitcnt lgkmcnt(0)
    v_and_b32 v12, 0xffff07ff, v12
    v_or_b32 v12, 0x8000, v12
    buffer_store_dword v12, v4, s[40:43], s44 offen sc0 sc1
    buffer_store_dword v12, v4, s[40:43], s45 offen sc0 sc1

F_a2m:
    s_cmp_ge_u32 s74, 17
    s_cbranch_scc1 DB_111
    s_barrier
    s_add_u32 s74, s74, 1
DB_111:
    s_cmp_lt_u32 s74, 17
    s_cbranch_scc1 F_a2m
    s_add_u32 s91, s54, 0
    buffer_load_dwordx4 v[72:75], v6, s[16:19], s91 offen nt
    s_add_u32 s91, s54, 7168
    buffer_load_dwordx4 v[76:79], v6, s[16:19], s91 offen nt
    s_add_u32 s91, s54, 14336
    buffer_load_dwordx4 v[80:83], v6, s[16:19], s91 offen nt
    s_add_u32 s91, s54, 21504
    buffer_load_dwordx4 v[84:87], v6, s[16:19], s91 offen nt
    s_add_u32 s91, s54, 28672
    buffer_load_dwordx4 v[88:91], v6, s[16:19], s91 offen nt
    s_add_u32 s91, s54, 35840
    buffer_load_dwordx4 v[92:95], v6, s[16:19], s91 offen nt
    s_add_u32 s91, s54, 43008
    buffer_load_dwordx4 v[96:99], v6, s[16:19], s91 offen nt
    s_add_u32 s91, s54, 50176
    buffer_load_dwordx4 v[100:103], v6, s[16:19], s91 offen nt
    s_add_u32 s91, s54, 229376
    buffer_load_dwordx4 v[104:107], v6, s[16:19], s91 offen nt
    s_add_u32 s91, s54, 236544
    buffer_load_dwordx4 v[108:111], v6, s[16:19], s91 offen nt
    s_add_u32 s91, s54, 243712
    buffer_load_dwordx4 v[112:115], v6, s[16:19], s91 offen nt
    s_add_u32 s91, s54, 250880
    buffer_load_dwordx4 v[116:119], v6, s[16:19], s91 offen nt
    s_add_u32 s91, s54, 258048
    buffer_load_dwordx4 v[120:123], v6, s[16:19], s91 offen nt
    s_add_u32 s91, s54, 265216
    buffer_load_dwordx4 v[124:127], v6, s[16:19], s91 offen nt
    s_add_u32 s91, s54, 272384
    buffer_load_dwordx4 v[128:131], v6, s[16:19], s91 offen nt
    s_add_u32 s91, s54, 279552
    buffer_load_dwordx4 v[132:135], v6, s[16:19], s91 offen nt
    s_branch F_aj2
IW_w10:
    s_branch IW_r10
F_a2n:
    s_barrier
    s_cmp_lg_u32 s53, 0
    s_cbranch_scc1 SW_112
    s_call_b64 s[34:35], F_sw0
SW_112:
    s_branch IW_w11
IW_r11:
    s_barrier
    s_cmp_lg_u32 s53, 1
    s_cbranch_scc1 SW_113
    s_call_b64 s[34:35], F_sw0
SW_113:
    s_nop 0
    s_barrier
    s_cmp_lg_u32 s53, 2
    s_cbranch_scc1 SW_114
    s_call_b64 s[34:35], F_sw0
SW_114:
    s_nop 0
    s_barrier
    s_cmp_lg_u32 s53, 3
    s_cbranch_scc1 SW_115
    s_call_b64 s[34:35], F_sw0
SW_115:
    s_nop 0
    s_barrier
    s_nop 0
    s_barrier
    s_nop 0
    s_barrier
    s_add_u32 s91, s54, 229376
    buffer_load_dwordx4 v[104:107], v6, s[16:19], s91 offen nt
    s_add_u32 s91, s54, 236544
    buffer_load_dwordx4 v[108:111], v6, s[16:19], s91 offen nt
    s_add_u32 s91, s54, 243712
    buffer_load_dwordx4 v[112:115], v6, s[16:19], s91 offen nt
    s_add_u32 s91, s54, 250880
    buffer_load_dwordx4 v[116:119], v6, s[16:19], s91 offen nt
    s_nop 0
    s_load_dwordx8 s[60:67], s[56:57], 128 glc
    s_barrier
    s_add_u32 s91, s54, 258048
    buffer_load_dwordx4 v[120:123], v6, s[16:19], s91 offen nt
    s_add_u32 s91, s54, 265216
    buffer_load_dwordx4 v[124:127], v6, s[16:19], s91 offen nt
    s_add_u32 s91, s54, 272384
    buffer_load_dwordx4 v[128:131], v6, s[16:19], s91 offen nt
    s_add_u32 s91, s54, 279552
    buffer_load_dwordx4 v[132:135], v6, s[16:19], s91 offen nt
    s_waitcnt lgkmcnt(0)
    s_and_b64 s[44:45], s[60:61], s[62:63]
    s_and_b64 s[44:45], s[44:45], s[64:65]
    s_and_b64 s[44:45], s[44:45], s[66:67]
    s_and_b32 s44, s44, s45
    s_bitcmp1_b32 s44, 15
    s_cbranch_scc0 F_a2q
    s_andn2_b32 s60, s60, 0x8000
    v_writelane_b32 v12, s60, 0
    s_andn2_b32 s61, s61, 0x8000
    v_writelane_b32 v12, s61, 1
    s_andn2_b32 s62, s62, 0x8000
    v_writelane_b32 v12, s62, 2
    s_andn2_b32 s63, s63, 0x8000
    v_writelane_b32 v12, s63, 3
    s_andn2_b32 s64, s64, 0x8000
    v_writelane_b32 v12, s64, 4
    s_andn2_b32 s65, s65, 0x8000
    v_writelane_b32 v12, s65, 5
    s_andn2_b32 s66, s66, 0x8000
    v_writelane_b32 v12, s66, 6
    s_andn2_b32 s67, s67, 0x8000
    v_writelane_b32 v12, s67, 7
    v_add_u32 v4, 158976, v3
    s_mov_b64 exec, 0xff
    ds_write_b32 v4, v12
    s_mov_b64 exec, -1
    v_mov_b32 v4, 1
    s_mov_b64 exec, 1
    ds_write_b32 v10, v4 offset:48
    s_mov_b64 exec, -1
    s_waitcnt lgkmcnt(0)
    s_mov_b32 s88, 1
    s_branch F_a2r
F_a2q:
    s_load_dwordx8 s[60:67], s[56:57], 128 glc
F_a2r:
    s_barrier
    s_cmp_lg_u32 s88, 2
    s_cbranch_scc1 F_aj
    s_waitcnt lgkmcnt(0)
    s_and_b64 s[44:45], s[60:61], s[62:63]
    s_and_b64 s[44:45], s[44:45], s[64:65]
    s_and_b64 s[44:45], s[44:45], s[66:67]
    s_and_b32 s44, s44, s45
    s_bitcmp1_b32 s44, 15
    s_cbranch_scc0 F_a2s
    s_andn2_b32 s60, s60, 0x8000
    v_writelane_b32 v12, s60, 0
    s_andn2_b32 s61, s61, 0x8000
    v_writelane_b32 v12, s61, 1
    s_andn2_b32 s62, s62, 0x8000
    v_writelane_b32 v12, s62, 2
    s_andn2_b32 s63, s63, 0x8000
    v_writelane_b32 v12, s63, 3
    s_andn2_b32 s64, s64, 0x8000
    v_writelane_b32 v12, s64, 4
    s_andn2_b32 s65, s65, 0x8000
    v_writelane_b32 v12, s65, 5
    s_andn2_b32 s66, s66, 0x8000
    v_writelane_b32 v12, s66, 6
    s_andn2_b32 s67, s67, 0x8000
    v_writelane_b32 v12, s67, 7
    v_add_u32 v4, 158976, v3
    s_mov_b64 exec, 0xff
    ds_write_b32 v4, v12
    s_mov_b64 exec, -1
    v_mov_b32 v4, 1
    s_mov_b64 exec, 1
    ds_write_b32 v10, v4 offset:48
    s_mov_b64 exec, -1
    s_mov_b32 s88, 1
F_a2s:
    v_mov_b32 v4, 1
    s_mov_b64 exec, 1
    ds_write_b32 v10, v4 offset:176
    s_mov_b64 exec, -1
F_aj:
    s_mov_b32 s74, 0
F_aj2:
    v_and_b32 v13, 3, v0
    v_lshlrev_b32 v13, 2, v13
    v_add_u32 v13, 159040, v13

    s_cmp_lt_u32 s3, 2
    s_mov_b32 s75, 65536
    s_cselect_b32 s75, 32768, s75
    s_and_b32 s44, s3, 1
    s_lshl_b32 s44, s44, 12
    s_add_u32 s75, s75, s44
    s_add_u32 s12, s72, 0x900000
    s_addc_u32 s13, s73, 0
    s_mov_b32 s14, 0xe0000
    s_mov_b32 s15, 0x00020000
    s_mov_b32 s47, s10
    v_mov_b32 v4, 159096
    ds_read_b32 v9, v4
    s_waitcnt lgkmcnt(0)
    v_readfirstlane_b32 s79, v9
    s_nop 0
    s_cmp_lg_u32 s79, 0
    s_cbranch_scc1 F_xf
    s_cmp_eq_u32 s2, 248
    s_cbranch_scc1 F_xe
    ds_read_b32 v9, v4 offset:128
FW_116:
    s_waitcnt lgkmcnt(0)
    v_cmp_gt_u32 vcc, 1, v9
    s_cbranch_vccz FO_117
    ds_read_b32 v9, v4 offset:128
    s_branch FW_116
FO_117:
    ds_read_b32 v9, v4
    s_waitcnt lgkmcnt(0)
    v_readfirstlane_b32 s79, v9
    s_nop 0
    s_cmp_eq_u32 s79, 0
    s_cbranch_scc1 F_xe
F_xf:
    v_and_b32 v4, 7, v0
    v_lshlrev_b32 v4, 2, v4
    v_add_u32 v4, 158976, v4
    ds_read_b32 v4, v4
    s_waitcnt lgkmcnt(0)
    v_and_b32 v4, 0x7ff, v4
    v_sub_u32 v4, 2047, v4
    v_and_b32 v11, 7, v4
    v_lshrrev_b32 v9, 3, v4
    v_lshlrev_b32 v9, 7, v9
    v_lshl_add_u32 v9, v11, 3, v9
    v_lshlrev_b32 v4, 11, v4
    v_lshl_add_u32 v4, v5, 4, v4
    buffer_load_dwordx4 v[64:67], v4, s[20:23], s55 offen
    buffer_load_dwordx4 v[68:71], v4, s[20:23], s55 offen offset:64
    buffer_load_dwordx2 v[14:15], v9, s[40:43], 0 offen sc0 sc1

F_xe:
    s_cmp_lg_u32 s74, 0
    s_cbranch_scc1 JB_118
    s_barrier
JB_118:
    s_cmp_lg_u32 s88, 3
    s_cbranch_scc1 F_g4
SP_119:
    s_load_dword s76, s[56:57], 0 glc
    s_waitcnt lgkmcnt(0)
    s_cmp_ge_u32 s76, 1000
    s_cbranch_scc1 SD_120
    s_sleep 3
    s_branch SP_119
SD_120:
    v_mov_b32 v4, 1
    s_mov_b64 exec, 1
    ds_write_b32 v10, v4 offset:48
    s_mov_b64 exec, -1
F_g4:
    s_setprio 1
    s_cmp_lg_u32 s79, 0
    s_cbranch_scc1 F_xd
    s_cmp_lg_u32 s88, 2
    s_cbranch_scc1 F_se
F_sc:
    s_load_dwordx8 s[60:67], s[56:57], 128 glc
    s_waitcnt lgkmcnt(0)
    s_and_b64 s[44:45], s[60:61], s[62:63]
    s_and_b64 s[44:45], s[44:45], s[64:65]
    s_and_b64 s[44:45], s[44:45], s[66:67]
    s_and_b32 s44, s44, s45
    s_bitcmp1_b32 s44, 15
    s_cbranch_scc1 F_sd
    s_sleep 4
    s_branch F_sc
F_sd:
    s_andn2_b32 s60, s60, 0x8000
    v_writelane_b32 v12, s60, 0
    s_andn2_b32 s61, s61, 0x8000
    v_writelane_b32 v12, s61, 1
    s_andn2_b32 s62, s62, 0x8000
    v_writelane_b32 v12, s62, 2
    s_andn2_b32 s63, s63, 0x8000
    v_writelane_b32 v12, s63, 3
    s_andn2_b32 s64, s64, 0x8000
    v_writelane_b32 v12, s64, 4
    s_andn2_b32 s65, s65, 0x8000
    v_writelane_b32 v12, s65, 5
    s_andn2_b32 s66, s66, 0x8000
    v_writelane_b32 v12, s66, 6
    s_andn2_b32 s67, s67, 0x8000
    v_writelane_b32 v12, s67, 7
    v_add_u32 v4, 158976, v3
    s_mov_b64 exec, 0xff
    ds_write_b32 v4, v12
    s_mov_b64 exec, -1
    v_mov_b32 v4, 1
    s_mov_b64 exec, 1
    ds_write_b32 v10, v4 offset:48
    s_mov_b64 exec, -1
F_se:
    v_mov_b32 v4, 159096
    ds_read_b32 v9, v4 offset:0
FW_121:
    s_waitcnt lgkmcnt(0)
    v_cmp_gt_u32 vcc, 1, v9
    s_cbranch_vccz FO_122
    s_sleep 1
    ds_read_b32 v9, v4 offset:0
    s_branch FW_121
FO_122:
    v_and_b32 v4, 7, v0
    v_lshlrev_b32 v4, 2, v4
    v_add_u32 v4, 158976, v4
    ds_read_b32 v4, v4
    s_waitcnt lgkmcnt(0)
    v_and_b32 v4, 0x7ff, v4
    v_sub_u32 v4, 2047, v4
    v_and_b32 v11, 7, v4
    v_lshrrev_b32 v9, 3, v4
    v_lshlrev_b32 v9, 7, v9
    v_lshl_add_u32 v9, v11, 3, v9
    v_lshlrev_b32 v4, 11, v4
    v_lshl_add_u32 v4, v5, 4, v4
    buffer_load_dwordx4 v[64:67], v4, s[20:23], s55 offen
    buffer_load_dwordx4 v[68:71], v4, s[20:23], s55 offen offset:64
    buffer_load_dwordx2 v[14:15], v9, s[40:43], 0 offen sc0 sc1

F_xd:
    s_mov_b32 s52, 0x05040100
    s_mov_b32 s53, 0x07060302
    s_setprio 1
    s_cmp_ge_u32 s89, 224
    s_cbranch_scc1 F_adown
    s_waitcnt vmcnt(11)
    v_perm_b32 v16, v76, v72, s52
    v_perm_b32 v17, v84, v80, s52
    v_perm_b32 v18, v92, v88, s52
    v_perm_b32 v19, v100, v96, s52
    v_perm_b32 v20, v76, v72, s53
    v_perm_b32 v21, v84, v80, s53
    v_perm_b32 v22, v92, v88, s53
    v_perm_b32 v23, v100, v96, s53
    v_perm_b32 v24, v77, v73, s52
    v_perm_b32 v25, v85, v81, s52
    v_perm_b32 v26, v93, v89, s52
    v_perm_b32 v27, v101, v97, s52
    v_perm_b32 v28, v77, v73, s53
    v_perm_b32 v29, v85, v81, s53
    v_perm_b32 v30, v93, v89, s53
    v_perm_b32 v31, v101, v97, s53
    v_perm_b32 v144, v78, v74, s52
    v_perm_b32 v145, v86, v82, s52
    v_perm_b32 v146, v94, v90, s52
    v_perm_b32 v147, v102, v98, s52
    v_perm_b32 v148, v78, v74, s53
    v_perm_b32 v149, v86, v82, s53
    v_perm_b32 v150, v94, v90, s53
    v_perm_b32 v151, v102, v98, s53
    v_perm_b32 v152, v79, v75, s52
    v_perm_b32 v153, v87, v83, s52
    v_perm_b32 v154, v95, v91, s52
    v_perm_b32 v155, v103, v99, s52
    v_perm_b32 v156, v79, v75, s53
    v_perm_b32 v157, v87, v83, s53
    v_perm_b32 v158, v95, v91, s53
    v_perm_b32 v159, v103, v99, s53
    s_and_b32 s44, s3, 1
    s_lshl_b32 s44, s44, 12
    s_add_u32 s44, s44, 65536

    v_and_b32 v8, 1, v5
    v_lshrrev_b32 v9, 1, v5
    v_lshl_add_u32 v4, v9, 3, v8
    v_lshlrev_b32 v9, 8, v4
    v_xor_b32 v4, v7, v4
    v_lshl_add_u32 v4, v4, 4, v9
    v_add_u32 v136, s44, v4
    v_xor_b32 v137, 32, v136
    v_xor_b32 v138, 64, v136
    v_xor_b32 v139, 96, v136
    v_add_u32 v8, 8, v10
    s_lshl_b32 s44, s3, 2
    v_add_u32 v140, s44, v5
    v_xor_b32 v140, v140, v7
    v_lshlrev_b32 v140, 4, v140
    v_lshl_add_u32 v140, v7, 8, v140
    v_add_u32 v140, 65536, v140
    s_lshl_b32 s44, s3, 10
    s_lshl_b32 s77, s36, 1
    s_add_u32 s77, s77, s37
    s_mul_i32 s77, s77, 114688
    s_lshl_b32 s46, s38, 12
    s_add_u32 s77, s77, s46
    s_add_u32 s77, s77, s44
    s_lshl_b32 s46, s38, 9
    v_mov_b32 v9, 159148
    v_mov_b32 v11, 1
    v_and_b32 v141, 0xfffffff7, v13

    s_add_u32 s56, s46, 0x829000
    s_add_u32 s56, s72, s56
    s_addc_u32 s57, s73, 0
    s_waitcnt vmcnt(3)
    v_perm_b32 v72, v108, v104, s52
    v_perm_b32 v73, v116, v112, s52
    v_perm_b32 v74, v124, v120, s52
    v_perm_b32 v75, v132, v128, s52
    v_perm_b32 v76, v108, v104, s53
    v_perm_b32 v77, v116, v112, s53
    v_perm_b32 v78, v124, v120, s53
    v_perm_b32 v79, v132, v128, s53
    v_perm_b32 v80, v109, v105, s52
    v_perm_b32 v81, v117, v113, s52
    v_perm_b32 v82, v125, v121, s52
    v_perm_b32 v83, v133, v129, s52
    v_perm_b32 v84, v109, v105, s53
    v_perm_b32 v85, v117, v113, s53
    v_perm_b32 v86, v125, v121, s53
    v_perm_b32 v87, v133, v129, s53
    v_perm_b32 v88, v110, v106, s52
    v_perm_b32 v89, v118, v114, s52
    v_perm_b32 v90, v126, v122, s52
    v_perm_b32 v91, v134, v130, s52
    v_perm_b32 v92, v110, v106, s53
    v_perm_b32 v93, v118, v114, s53
    v_perm_b32 v94, v126, v122, s53
    v_perm_b32 v95, v134, v130, s53
    v_perm_b32 v96, v111, v107, s52
    v_perm_b32 v97, v119, v115, s52
    v_perm_b32 v98, v127, v123, s52
    v_perm_b32 v99, v135, v131, s52
    v_perm_b32 v100, v111, v107, s53
    v_perm_b32 v101, v119, v115, s53
    v_perm_b32 v102, v127, v123, s53
    v_perm_b32 v103, v135, v131, s53
    s_waitcnt vmcnt(0)
    s_setprio 1
    v_lshlrev_b32 v34, 16, v64
    v_and_b32 v35, 0xffff0000, v64
    v_lshlrev_b32 v36, 16, v65
    v_and_b32 v37, 0xffff0000, v65
    v_lshlrev_b32 v38, 16, v66
    v_and_b32 v39, 0xffff0000, v66
    v_lshlrev_b32 v40, 16, v67
    v_and_b32 v41, 0xffff0000, v67
    v_lshlrev_b32 v42, 16, v68
    v_and_b32 v43, 0xffff0000, v68
    v_lshlrev_b32 v44, 16, v69
    v_and_b32 v45, 0xffff0000, v69
    v_lshlrev_b32 v46, 16, v70
    v_and_b32 v47, 0xffff0000, v70
    v_lshlrev_b32 v48, 16, v71
    v_and_b32 v49, 0xffff0000, v71
    v_add_f32 v34, v34, v14
    v_add_f32 v35, v35, v14
    v_add_f32 v36, v36, v14
    v_add_f32 v37, v37, v14
    v_add_f32 v38, v38, v14
    v_add_f32 v39, v39, v14
    v_add_f32 v40, v40, v14
    v_add_f32 v41, v41, v14
    v_add_f32 v42, v42, v14
    v_add_f32 v43, v43, v14
    v_add_f32 v44, v44, v14
    v_add_f32 v45, v45, v14
    v_add_f32 v46, v46, v14
    v_add_f32 v47, v47, v14
    v_add_f32 v48, v48, v14
    v_add_f32 v49, v49, v14
    v_cvt_pk_bf16_f32 v64, v34, v35
    v_cvt_pk_bf16_f32 v65, v36, v37
    v_cvt_pk_bf16_f32 v66, v38, v39
    v_cvt_pk_bf16_f32 v67, v40, v41
    v_cvt_pk_bf16_f32 v68, v42, v43
    v_cvt_pk_bf16_f32 v69, v44, v45
    v_cvt_pk_bf16_f32 v70, v46, v47
    v_cvt_pk_bf16_f32 v71, v48, v49
    v_lshlrev_b32 v34, 16, v64
    v_and_b32 v35, 0xffff0000, v64
    v_lshlrev_b32 v36, 16, v65
    v_and_b32 v37, 0xffff0000, v65
    v_lshlrev_b32 v38, 16, v66
    v_and_b32 v39, 0xffff0000, v66
    v_lshlrev_b32 v40, 16, v67
    v_and_b32 v41, 0xffff0000, v67
    v_lshlrev_b32 v42, 16, v68
    v_and_b32 v43, 0xffff0000, v68
    v_lshlrev_b32 v44, 16, v69
    v_and_b32 v45, 0xffff0000, v69
    v_lshlrev_b32 v46, 16, v70
    v_and_b32 v47, 0xffff0000, v70
    v_lshlrev_b32 v48, 16, v71
    v_and_b32 v49, 0xffff0000, v71
    v_mul_f32 v34, v34, v15
    v_mul_f32 v35, v35, v15
    v_mul_f32 v36, v36, v15
    v_mul_f32 v37, v37, v15
    v_mul_f32 v38, v38, v15
    v_mul_f32 v39, v39, v15
    v_mul_f32 v40, v40, v15
    v_mul_f32 v41, v41, v15
    v_mul_f32 v42, v42, v15
    v_mul_f32 v43, v43, v15
    v_mul_f32 v44, v44, v15
    v_mul_f32 v45, v45, v15
    v_mul_f32 v46, v46, v15
    v_mul_f32 v47, v47, v15
    v_mul_f32 v48, v48, v15
    v_mul_f32 v49, v49, v15
    v_cvt_pk_bf16_f32 v64, v34, v35
    v_cvt_pk_bf16_f32 v65, v36, v37
    v_cvt_pk_bf16_f32 v66, v38, v39
    v_cvt_pk_bf16_f32 v67, v40, v41
    v_cvt_pk_bf16_f32 v68, v42, v43
    v_cvt_pk_bf16_f32 v69, v44, v45
    v_cvt_pk_bf16_f32 v70, v46, v47
    v_cvt_pk_bf16_f32 v71, v48, v49
    v_cmp_gt_u32 vcc, 32, v0
    v_mfma_f32_16x16x32_bf16 v[32:35], v[64:67], v[16:19], 0
    v_mfma_f32_16x16x32_bf16 v[48:51], v[64:67], v[144:147], 0
    v_mfma_f32_16x16x32_bf16 v[36:39], v[64:67], v[20:23], 0
    v_mfma_f32_16x16x32_bf16 v[52:55], v[64:67], v[148:151], 0
    v_mfma_f32_16x16x32_bf16 v[40:43], v[64:67], v[24:27], 0
    v_mfma_f32_16x16x32_bf16 v[56:59], v[64:67], v[152:155], 0
    v_mfma_f32_16x16x32_bf16 v[44:47], v[64:67], v[28:31], 0
    v_mfma_f32_16x16x32_bf16 v[60:63], v[64:67], v[156:159], 0
    v_mfma_f32_16x16x32_bf16 v[32:35], v[68:71], v[72:75], v[32:35]
    v_mfma_f32_16x16x32_bf16 v[48:51], v[68:71], v[88:91], v[48:51]
    v_mfma_f32_16x16x32_bf16 v[36:39], v[68:71], v[76:79], v[36:39]
    v_mfma_f32_16x16x32_bf16 v[52:55], v[68:71], v[92:95], v[52:55]
    v_mfma_f32_16x16x32_bf16 v[40:43], v[68:71], v[80:83], v[40:43]
    v_mfma_f32_16x16x32_bf16 v[56:59], v[68:71], v[96:99], v[56:59]
    v_mfma_f32_16x16x32_bf16 v[44:47], v[68:71], v[84:87], v[44:47]
    v_mfma_f32_16x16x32_bf16 v[60:63], v[68:71], v[100:103], v[60:63]
    s_nop 1
    v_cndmask_b32 v32, v48, v32, vcc
    v_cndmask_b32 v33, v49, v33, vcc
    v_cndmask_b32 v34, v50, v34, vcc
    v_cndmask_b32 v35, v51, v35, vcc
    v_cndmask_b32 v36, v52, v36, vcc
    v_cndmask_b32 v37, v53, v37, vcc
    v_cndmask_b32 v38, v54, v38, vcc
    v_cndmask_b32 v39, v55, v39, vcc
    v_cndmask_b32 v40, v56, v40, vcc
    v_cndmask_b32 v41, v57, v41, vcc
    v_cndmask_b32 v42, v58, v42, vcc
    v_cndmask_b32 v43, v59, v43, vcc
    v_cndmask_b32 v44, v60, v44, vcc
    v_cndmask_b32 v45, v61, v45, vcc
    v_cndmask_b32 v46, v62, v46, vcc
    v_cndmask_b32 v47, v63, v47, vcc
    s_setprio 3
    ds_read_b32 v12, v13 offset:32
FW_123:
    s_waitcnt lgkmcnt(0)
    v_cmp_gt_u32 vcc, 2, v12
    s_cbranch_vccz FO_124
    s_sleep 1
    ds_read_b32 v12, v13 offset:32
    s_branch FW_123
FO_124:
    s_cmp_lt_u32 s3, 2
    s_cbranch_scc1 F_t1
    ds_write_b128 v136, v[32:35] offset:0
    ds_write_b128 v137, v[36:39] offset:512
    ds_write_b128 v138, v[40:43] offset:1024
    ds_write_b128 v139, v[44:47] offset:1536
    s_mov_b64 exec, 1
    s_branch IW_s11
IW_w11:
    s_branch IW_r11
IW_s11:
    ds_write_b32 v10, v11 offset:64
    s_mov_b64 exec, -1
    s_add_u32 s45, s78, 0
    buffer_load_dwordx4 v[16:19], v160, s[80:83], s45 offen nt
    s_add_u32 s45, s78, 2048
    buffer_load_dwordx4 v[20:23], v160, s[80:83], s45 offen nt
    s_add_u32 s45, s78, 4096
    buffer_load_dwordx4 v[24:27], v160, s[80:83], s45 offen nt
    s_add_u32 s45, s78, 6144
    buffer_load_dwordx4 v[28:31], v160, s[80:83], s45 offen nt
    s_add_u32 s45, s78, 8192
    buffer_load_dwordx4 v[144:147], v160, s[80:83], s45 offen nt
    s_add_u32 s45, s78, 10240
    buffer_load_dwordx4 v[148:151], v160, s[80:83], s45 offen nt
    s_add_u32 s45, s78, 12288
    buffer_load_dwordx4 v[152:155], v160, s[80:83], s45 offen nt
    s_branch F_t2
F_t1:
    s_add_u32 s45, s78, 0
    buffer_load_dwordx4 v[16:19], v160, s[80:83], s45 offen nt
    s_add_u32 s45, s78, 2048
    buffer_load_dwordx4 v[20:23], v160, s[80:83], s45 offen nt
    s_add_u32 s45, s78, 4096
    buffer_load_dwordx4 v[24:27], v160, s[80:83], s45 offen nt
    s_add_u32 s45, s78, 6144
    buffer_load_dwordx4 v[28:31], v160, s[80:83], s45 offen nt
    s_add_u32 s45, s78, 8192
    buffer_load_dwordx4 v[144:147], v160, s[80:83], s45 offen nt
    s_add_u32 s45, s78, 10240
    buffer_load_dwordx4 v[148:151], v160, s[80:83], s45 offen nt
    s_add_u32 s45, s78, 12288
    buffer_load_dwordx4 v[152:155], v160, s[80:83], s45 offen nt
F_t3:
    ds_read_b32 v12, v8 offset:64
    ds_read_b128 v[80:83], v136 offset:0
    ds_read_b128 v[84:87], v137 offset:512
    ds_read_b128 v[88:91], v138 offset:1024
    ds_read_b128 v[92:95], v139 offset:1536
    s_waitcnt lgkmcnt(0)
    v_cmp_eq_u32 vcc, 0, v12
    s_cbranch_vccnz F_t3
    v_add_f32 v32, v32, v80
    v_add_f32 v33, v33, v81
    v_add_f32 v34, v34, v82
    v_add_f32 v35, v35, v83
    v_add_f32 v36, v36, v84
    v_add_f32 v37, v37, v85
    v_add_f32 v38, v38, v86
    v_add_f32 v39, v39, v87
    v_add_f32 v40, v40, v88
    v_add_f32 v41, v41, v89
    v_add_f32 v42, v42, v90
    v_add_f32 v43, v43, v91
    v_add_f32 v44, v44, v92
    v_add_f32 v45, v45, v93
    v_add_f32 v46, v46, v94
    v_add_f32 v47, v47, v95
    ds_write_b128 v136, v[32:35] offset:0
    ds_write_b128 v137, v[36:39] offset:512
    ds_write_b128 v138, v[40:43] offset:1024
    ds_write_b128 v139, v[44:47] offset:1536
    s_mov_b64 exec, 1
    ds_write_b32 v10, v11 offset:64
    s_mov_b64 exec, -1
F_t2:
F_t4:
    ds_read_b32 v12, v141 offset:64
    ds_read_b128 v[80:83], v140
    ds_read_b128 v[84:87], v140 offset:4096
    s_waitcnt lgkmcnt(0)
    v_cmp_eq_u32 vcc, 0, v12
    s_cbranch_vccnz F_t4
    v_add_f32 v72, v80, v84
    v_add_f32 v73, v81, v85
    v_add_f32 v74, v82, v86
    v_add_f32 v75, v83, v87
    buffer_store_dwordx4 v[72:75], v2, s[12:15], s77 offen sc0 sc1
    v_mov_b32 v4, 2
    s_mov_b64 exec, 1
    ds_write_b32 v10, v4 offset:64
    s_mov_b64 exec, -1
    s_waitcnt vmcnt(0)
    s_mov_b64 exec, 1
    ds_add_rtn_u32 v9, v9, v11
    s_waitcnt lgkmcnt(0)
    v_readfirstlane_b32 s44, v9
    s_mov_b64 exec, -1
    s_cmp_lg_u32 s44, 3
    s_cbranch_scc1 F_ad2

    s_mov_b32 s74, 1
    s_atomic_add s74, s[56:57], 0x0
    s_atomic_add s74, s[56:57], 0x80
    s_atomic_add s74, s[56:57], 0x100
    s_atomic_add s74, s[56:57], 0x180
    s_branch F_ad2
F_adown:
    s_add_u32 s45, s78, 0
    buffer_load_dwordx4 v[16:19], v160, s[80:83], s45 offen nt
    s_add_u32 s45, s78, 2048
    buffer_load_dwordx4 v[20:23], v160, s[80:83], s45 offen nt
    s_add_u32 s45, s78, 4096
    buffer_load_dwordx4 v[24:27], v160, s[80:83], s45 offen nt
    s_add_u32 s45, s78, 6144
    buffer_load_dwordx4 v[28:31], v160, s[80:83], s45 offen nt
    s_add_u32 s45, s78, 8192
    buffer_load_dwordx4 v[144:147], v160, s[80:83], s45 offen nt
    s_add_u32 s45, s78, 10240
    buffer_load_dwordx4 v[148:151], v160, s[80:83], s45 offen nt
    s_add_u32 s45, s78, 12288
    buffer_load_dwordx4 v[152:155], v160, s[80:83], s45 offen nt
    v_mov_b32 v4, 2
    s_mov_b64 exec, 1
    ds_write_b32 v10, v4 offset:64
    s_mov_b64 exec, -1
F_ad2:
    v_min_u32 v4, 55, v0
    v_lshlrev_b32 v4, 4, v4
    s_lshl_b32 s38, s47, 5
    s_and_b32 s46, s39, 3
    s_lshr_b32 s44, s47, 7
    s_lshl_b32 s44, s44, 2
    s_add_u32 s44, s44, s46
    s_lshl_b32 s44, s44, 7
    s_add_u32 s45, s47, 111
    s_lshr_b32 s45, s45, 7
    s_lshl_b32 s45, s45, 2
    s_add_u32 s45, s45, s46
    s_lshl_b32 s45, s45, 7
    s_waitcnt lgkmcnt(0)

    s_add_u32 s56, s44, 0x829000
    s_add_u32 s56, s72, s56
    s_addc_u32 s57, s73, 0
    s_add_u32 s58, s45, 0x829000
    s_add_u32 s58, s72, s58
    s_addc_u32 s59, s73, 0
    v_mov_b32 v156, 0
    v_mov_b32 v157, 0
    v_mov_b32 v158, 0
    v_mov_b32 v159, 0
    s_mov_b32 s48, 0xbfb8aa3b
    ds_read_b32 v12, v13 offset:0
FW_125:
    s_waitcnt lgkmcnt(0)
    v_cmp_gt_u32 vcc, 4, v12
    s_cbranch_vccz FO_126
    s_sleep 1
    ds_read_b32 v12, v13 offset:0
    s_branch FW_125
FO_126:
    ds_read_b32 v12, v13 offset:64
FW_127:
    s_waitcnt lgkmcnt(0)
    v_cmp_gt_u32 vcc, 2, v12
    s_cbranch_vccz FO_128
    s_sleep 1
    ds_read_b32 v12, v13 offset:64
    s_branch FW_127
FO_128:
    ds_read_b32 v12, v13 offset:32
FW_129:
    s_waitcnt lgkmcnt(0)
    v_cmp_gt_u32 vcc, 2, v12
    s_cbranch_vccz FO_130
    s_sleep 1
    ds_read_b32 v12, v13 offset:32
    s_branch FW_129
FO_130:
    s_mov_b32 s44, s75
    v_lshlrev_b32 v9, 3, v0
    v_add_u32 v9, s44, v9
    ds_write_b64 v9, v[156:157]
    v_lshrrev_b32 v11, 1, v0
    v_mul_u32_u24 v9, 37, v11
    v_lshrrev_b32 v9, 8, v9
    v_add_u32 v11, v11, v9
    v_lshlrev_b32 v11, 1, v11
    v_and_b32 v9, 1, v0
    v_lshl_add_u32 v11, v9, 8, v11
    v_add_u32 v11, s44, v11
    v_and_b32 v9, 7, v0
    v_lshlrev_b32 v9, 6, v9
    v_lshl_add_u32 v9, v5, 4, v9
    v_add_u32 v9, s44, v9

    s_setprio 1
    s_waitcnt vmcnt(0)
    v_perm_b32 v72, v20, v16, s52
    v_perm_b32 v73, v28, v24, s52
    v_perm_b32 v74, v148, v144, s52
    v_perm_b32 v75, v156, v152, s52
    v_perm_b32 v76, v20, v16, s53
    v_perm_b32 v77, v28, v24, s53
    v_perm_b32 v78, v148, v144, s53
    v_perm_b32 v79, v156, v152, s53
    v_perm_b32 v80, v21, v17, s52
    v_perm_b32 v81, v29, v25, s52
    v_perm_b32 v82, v149, v145, s52
    v_perm_b32 v83, v157, v153, s52
    v_perm_b32 v84, v21, v17, s53
    v_perm_b32 v85, v29, v25, s53
    v_perm_b32 v86, v149, v145, s53
    v_perm_b32 v87, v157, v153, s53
    v_perm_b32 v88, v22, v18, s52
    v_perm_b32 v89, v30, v26, s52
    v_perm_b32 v90, v150, v146, s52
    v_perm_b32 v91, v158, v154, s52
    v_perm_b32 v92, v22, v18, s53
    v_perm_b32 v93, v30, v26, s53
    v_perm_b32 v94, v150, v146, s53
    v_perm_b32 v95, v158, v154, s53
    v_perm_b32 v96, v23, v19, s52
    v_perm_b32 v97, v31, v27, s52
    v_perm_b32 v98, v151, v147, s52
    v_perm_b32 v99, v159, v155, s52
    v_perm_b32 v100, v23, v19, s53
    v_perm_b32 v101, v31, v27, s53
    v_perm_b32 v102, v151, v147, s53
    v_perm_b32 v103, v159, v155, s53
    v_and_b32 v16, 1, v5
    v_lshlrev_b32 v16, 11, v16
    v_lshl_add_u32 v16, v7, 5, v16
    v_lshrrev_b32 v8, 1, v5
    v_lshl_add_u32 v16, v8, 4, v16
    v_add_u32 v16, s75, v16
    s_lshl_b32 s44, s3, 10
    s_add_u32 s44, s44, 32768
    v_add_u32 v17, s44, v3
    v_add_u32 v18, 32768, v17
    v_mov_b32 v19, 1
    s_lshl_b32 s60, s3, 13
    s_lshl_b32 s45, s39, 9
    s_add_u32 s60, s60, s45
    s_add_u32 s60, s60, 135168
    s_add_u32 s61, s60, 4096

    s_add_u32 s62, s45, 0x845000
    s_add_u32 s62, s72, s62
    s_addc_u32 s63, s73, 0
    s_setprio 3
    s_cmp_lg_u32 s3, 0
    s_cbranch_scc1 F_pp
F_p1:
    s_load_dword s76, s[56:57], 0 glc
    s_load_dword s77, s[58:59], 0 glc
    s_waitcnt lgkmcnt(0)
    s_min_u32 s76, s76, s77
    s_cmp_ge_u32 s76, 8
    s_cbranch_scc1 F_p2
    s_sleep 2
    s_branch F_p1
F_p2:
    v_mov_b32 v12, 3
    s_mov_b64 exec, 1
    ds_write_b32 v10, v12 offset:64
    s_mov_b64 exec, -1
F_pp:
    v_mov_b32 v8, 159104
    ds_read_b32 v12, v8 offset:0
FW_131:
    s_waitcnt lgkmcnt(0)
    v_cmp_gt_u32 vcc, 3, v12
    s_cbranch_vccz FO_132
    s_sleep 1
    ds_read_b32 v12, v8 offset:0
    s_branch FW_131
FO_132:
    s_add_u32 s45, s38, 0
    buffer_load_dwordx4 v[32:35], v4, s[12:15], s45 offen sc0 sc1
    s_add_u32 s45, s38, 114688
    buffer_load_dwordx4 v[36:39], v4, s[12:15], s45 offen sc0 sc1
    s_add_u32 s45, s38, 229376
    buffer_load_dwordx4 v[40:43], v4, s[12:15], s45 offen sc0 sc1
    s_add_u32 s45, s38, 344064
    buffer_load_dwordx4 v[44:47], v4, s[12:15], s45 offen sc0 sc1
    s_add_u32 s45, s38, 458752
    buffer_load_dwordx4 v[48:51], v4, s[12:15], s45 offen sc0 sc1
    s_add_u32 s45, s38, 573440
    buffer_load_dwordx4 v[52:55], v4, s[12:15], s45 offen sc0 sc1
    s_add_u32 s45, s38, 688128
    buffer_load_dwordx4 v[56:59], v4, s[12:15], s45 offen sc0 sc1
    s_add_u32 s45, s38, 802816
    buffer_load_dwordx4 v[60:63], v4, s[12:15], s45 offen sc0 sc1
    s_waitcnt vmcnt(0)
    v_add_f32 v32, v32, v40
    v_add_f32 v48, v48, v56
    v_add_f32 v33, v33, v41
    v_add_f32 v49, v49, v57
    v_add_f32 v34, v34, v42
    v_add_f32 v50, v50, v58
    v_add_f32 v35, v35, v43
    v_add_f32 v51, v51, v59
    v_add_f32 v32, v32, v48
    v_add_f32 v33, v33, v49
    v_add_f32 v34, v34, v50
    v_add_f32 v35, v35, v51
    v_add_f32 v36, v36, v44
    v_add_f32 v52, v52, v60
    v_add_f32 v37, v37, v45
    v_add_f32 v53, v53, v61
    v_add_f32 v38, v38, v46
    v_add_f32 v54, v54, v62
    v_add_f32 v39, v39, v47
    v_add_f32 v55, v55, v63
    v_add_f32 v36, v36, v52
    v_add_f32 v37, v37, v53
    v_add_f32 v38, v38, v54
    v_add_f32 v39, v39, v55
    v_cvt_pk_bf16_f32 v40, v32, v36
    v_cvt_pk_bf16_f32 v41, v33, v37
    v_cvt_pk_bf16_f32 v42, v34, v38
    v_cvt_pk_bf16_f32 v43, v35, v39
    v_lshlrev_b32 v32, 16, v40
    v_and_b32 v36, 0xffff0000, v40
    v_lshlrev_b32 v33, 16, v41
    v_and_b32 v37, 0xffff0000, v41
    v_lshlrev_b32 v34, 16, v42
    v_and_b32 v38, 0xffff0000, v42
    v_lshlrev_b32 v35, 16, v43
    v_and_b32 v39, 0xffff0000, v43
    v_mul_f32 v40, s48, v32
    v_mul_f32 v41, s48, v33
    v_mul_f32 v42, s48, v34
    v_mul_f32 v43, s48, v35
    v_exp_f32 v40, v40
    v_exp_f32 v41, v41
    v_exp_f32 v42, v42
    v_exp_f32 v43, v43
    v_add_f32 v40, 1.0, v40
    v_add_f32 v41, 1.0, v41
    v_add_f32 v42, 1.0, v42
    v_add_f32 v43, 1.0, v43
    v_rcp_f32 v40, v40
    v_rcp_f32 v41, v41
    v_rcp_f32 v42, v42
    v_rcp_f32 v43, v43
    v_mul_f32 v32, v32, v40
    v_mul_f32 v33, v33, v41
    v_mul_f32 v34, v34, v42
    v_mul_f32 v35, v35, v43
    v_cvt_pk_bf16_f32 v32, v32, v32
    v_cvt_pk_bf16_f32 v33, v33, v33
    v_cvt_pk_bf16_f32 v34, v34, v34
    v_cvt_pk_bf16_f32 v35, v35, v35
    v_lshlrev_b32 v32, 16, v32
    v_lshlrev_b32 v33, 16, v33
    v_lshlrev_b32 v34, 16, v34
    v_lshlrev_b32 v35, 16, v35
    v_mul_f32 v32, v32, v36
    v_mul_f32 v33, v33, v37
    v_mul_f32 v34, v34, v38
    v_mul_f32 v35, v35, v39
    v_cvt_pk_bf16_f32 v32, v32, v32
    v_cvt_pk_bf16_f32 v33, v33, v33
    v_cvt_pk_bf16_f32 v34, v34, v34
    v_cvt_pk_bf16_f32 v35, v35, v35
    s_mov_b32 exec_hi, 0xffffff
    ds_write_b16 v11, v32 offset:0
    ds_write_b16 v11, v33 offset:64
    ds_write_b16 v11, v34 offset:128
    ds_write_b16 v11, v35 offset:192
    s_mov_b64 exec, -1
    ds_read_b128 v[64:67], v9
    v_cmp_gt_u32 vcc, 32, v0
    s_waitcnt lgkmcnt(0)
    v_mfma_f32_16x16x32_bf16 v[104:107], v[64:67], v[72:75], 0
    v_mfma_f32_16x16x32_bf16 v[120:123], v[64:67], v[88:91], 0
    v_mfma_f32_16x16x32_bf16 v[108:111], v[64:67], v[76:79], 0
    v_mfma_f32_16x16x32_bf16 v[124:127], v[64:67], v[92:95], 0
    v_mfma_f32_16x16x32_bf16 v[112:115], v[64:67], v[80:83], 0
    v_mfma_f32_16x16x32_bf16 v[128:131], v[64:67], v[96:99], 0
    v_mfma_f32_16x16x32_bf16 v[116:119], v[64:67], v[84:87], 0
    v_mfma_f32_16x16x32_bf16 v[132:135], v[64:67], v[100:103], 0
    s_nop 1
    v_cndmask_b32 v136, v120, v104, vcc
    v_cndmask_b32 v140, v121, v105, vcc
    v_cndmask_b32 v144, v122, v106, vcc
    v_cndmask_b32 v148, v123, v107, vcc
    v_cndmask_b32 v137, v124, v108, vcc
    v_cndmask_b32 v141, v125, v109, vcc
    v_cndmask_b32 v145, v126, v110, vcc
    v_cndmask_b32 v149, v127, v111, vcc
    v_cndmask_b32 v138, v128, v112, vcc
    v_cndmask_b32 v142, v129, v113, vcc
    v_cndmask_b32 v146, v130, v114, vcc
    v_cndmask_b32 v150, v131, v115, vcc
    v_cndmask_b32 v139, v132, v116, vcc
    v_cndmask_b32 v143, v133, v117, vcc
    v_cndmask_b32 v147, v134, v118, vcc
    v_cndmask_b32 v151, v135, v119, vcc
    ds_write_b128 v16, v[136:139] offset:0
    ds_write_b128 v16, v[140:143] offset:512
    ds_write_b128 v16, v[144:147] offset:1024
    ds_write_b128 v16, v[148:151] offset:1536
    s_mov_b64 exec, 1
    ds_write_b32 v10, v19 offset:80
    s_mov_b64 exec, -1
F_d1:
    ds_read_b32 v12, v13 offset:80
    ds_read2st64_b32 v[32:33], v17 offset0:0 offset1:1
    ds_read2st64_b32 v[34:35], v17 offset0:2 offset1:3
    ds_read2st64_b32 v[36:37], v17 offset0:16 offset1:17
    ds_read2st64_b32 v[38:39], v17 offset0:18 offset1:19
    ds_read2st64_b32 v[40:41], v18 offset0:0 offset1:1
    ds_read2st64_b32 v[42:43], v18 offset0:2 offset1:3
    ds_read2st64_b32 v[44:45], v18 offset0:16 offset1:17
    ds_read2st64_b32 v[46:47], v18 offset0:18 offset1:19
    s_waitcnt lgkmcnt(0)
    v_cmp_eq_u32 vcc, 0, v12
    s_cbranch_vccnz F_d1
    v_add_f32 v32, v32, v36
    v_add_f32 v40, v40, v44
    v_add_f32 v33, v33, v37
    v_add_f32 v41, v41, v45
    v_add_f32 v34, v34, v38
    v_add_f32 v42, v42, v46
    v_add_f32 v35, v35, v39
    v_add_f32 v43, v43, v47
    v_add_f32 v32, v32, v40
    buffer_atomic_add_f32 v32, v3, s[24:27], s60 offen offset:0
    v_add_f32 v33, v33, v41
    buffer_atomic_add_f32 v33, v3, s[24:27], s60 offen offset:256
    v_add_f32 v34, v34, v42
    buffer_atomic_add_f32 v34, v3, s[24:27], s61 offen offset:0
    v_add_f32 v35, v35, v43
    buffer_atomic_add_f32 v35, v3, s[24:27], s61 offen offset:256
    v_mov_b32 v4, 159140
    v_mov_b32 v8, 1
    s_waitcnt vmcnt(0)
    s_mov_b64 exec, 1
    ds_add_rtn_u32 v9, v4, v8
    s_waitcnt lgkmcnt(0)
    v_readfirstlane_b32 s44, v9
    s_mov_b64 exec, -1
    s_cmp_lg_u32 s44, 3
    s_cbranch_scc1 F_ye
    s_mov_b32 s44, 1
    s_atomic_add s44, s[62:63], 0
    s_atomic_add s44, s[62:63], 0x80
    s_atomic_add s44, s[62:63], 0x100
    s_atomic_add s44, s[62:63], 0x180
F_ye:

    s_endpgm
F_codeend:
.section .rodata,"a"
.p2align 6
.amdhsa_kernel parallel_sum__linear_attn_block__moe_arch_mod__prompt_kernel
  .amdhsa_next_free_vgpr 168
  .amdhsa_next_free_sgpr 98
  .amdhsa_accum_offset 168
  .amdhsa_group_segment_fixed_size 0
  .amdhsa_kernarg_size 88
  .amdhsa_user_sgpr_count 2
  .amdhsa_user_sgpr_kernarg_segment_ptr 1
  .amdhsa_system_sgpr_workgroup_id_x 1
  .amdhsa_float_denorm_mode_32 3
  .amdhsa_float_denorm_mode_16_64 3
.end_amdhsa_kernel
```
